```python
import torch

def _softmax(x, axis=-1):
    return torch.softmax(x, dim=axis)

def _gelu(x):
    return torch.nn.functional.gelu(x, approximate='tanh')

def _silu(x):
    return torch.nn.functional.silu(x)

def _sigmoid(x):
    return torch.sigmoid(x)

def _layernorm(x, axis=-1, eps=1e-05):
    m = x.mean(dim=axis, keepdim=True)
    v = x.var(dim=axis, keepdim=True, unbiased=False)
    return (x - m) / torch.sqrt(v + eps)

def _scatter_add(tgt, idx, src, axis=0):
    return tgt.clone().index_add_(axis, idx, src)

def _segment_sum(src, seg, n):
    out = torch.zeros((n,) + src.shape[1:], dtype=src.dtype)
    return out.index_add_(0, seg, src)

def _pad(x, pw):
    flat = tuple((v for pair in reversed(pw) for v in pair))
    return torch.nn.functional.pad(x, flat)
kernel_name = 'adaLN_cond__compressed_kv_cla__glu_gated_geglu__decode'

def setup_inputs():

    _w = lambda a: (lambda t: t.to(torch.bfloat16) if t.is_floating_point() else t)(torch.as_tensor(a))

    def _A_setup():
        B, H, Sq, Sk, D, M = (1, 32, 1, 32768, 128, 512)
        Dc = 4 * D
        return {'x': _w((lambda *s: torch.randn(*s, dtype=torch.bfloat16) * 0.1)(B, Sq, M)), 'c_kv': _w((lambda *s: torch.randn(*s, dtype=torch.bfloat16) * 3.2)(B, Sk, Dc)), 'w_q': _w((lambda *s: torch.randn(*s, dtype=torch.bfloat16) * 0.8)(M, H, D) * M ** (-0.5)), 'w_uk': _w((lambda *s: torch.randn(*s, dtype=torch.bfloat16) * 0.8)(Dc, H, D) * Dc ** (-0.5)), 'w_uv': _w((lambda *s: torch.randn(*s, dtype=torch.bfloat16) * 3.2)(Dc, H, D) * Dc ** (-0.5)), 'w_o': _w((lambda *s: torch.randn(*s, dtype=torch.bfloat16) * 3.2)(H, D, M) * (H * D) ** (-0.5))}
    _A_in = _A_setup()

    def _B_setup():
        B, S, Dm, Df = (1, 1, 512, 1792)
        return {'x': _w((lambda *s: torch.randn(*s, dtype=torch.bfloat16) * 0.1)(B, S, Dm)), 'w_gate': _w((lambda *s: torch.randn(*s, dtype=torch.bfloat16) * 1.6)(Dm, Df) * Dm ** (-0.5)), 'w_up': _w((lambda *s: torch.randn(*s, dtype=torch.bfloat16) * 1.6)(Dm, Df) * Dm ** (-0.5)), 'w_down': _w((lambda *s: torch.randn(*s, dtype=torch.bfloat16) * 1.6)(Df, Dm) * Df ** (-0.5))}
    _B_in = _B_setup()
    return {'A_x': _A_in['x'], 'A_c_kv': _A_in['c_kv'], 'A_w_q': _A_in['w_q'], 'A_w_uk': _A_in['w_uk'], 'A_w_uv': _A_in['w_uv'], 'A_w_o': _A_in['w_o'], 'B_x': _B_in['x'], 'B_w_gate': _B_in['w_gate'], 'B_w_up': _B_in['w_up'], 'B_w_down': _B_in['w_down'], 'c': _w((lambda *s: torch.randn(*s, dtype=torch.bfloat16) * 0.1)(1, 512) * 8.0), 'w_mod': _w((lambda *s: torch.randn(*s, dtype=torch.bfloat16) * 0.1)(512, 6 * 512) * 512 ** (-0.5) * 8.0)}

def reference(A_x, A_c_kv, A_w_q, A_w_uk, A_w_uv, A_w_o, B_x, B_w_gate, B_w_up, B_w_down, c, w_mod):

    def _A_ref(x, c_kv, w_q, w_uk, w_uv, w_o):
        B, Sq, M = (x.shape[0], x.shape[1], x.shape[2])
        Sk = c_kv.shape[1]
        H, D = (w_q.shape[1], w_q.shape[2])
        q = torch.einsum('bqm,mhd->bhqd', x, w_q)
        k = torch.einsum('bkc,chd->bhkd', c_kv, w_uk)
        v = torch.einsum('bkc,chd->bhkd', c_kv, w_uv)
        scores = torch.einsum('bhqd,bhkd->bhqk', q, k) * D ** (-0.5)
        off = Sk - Sq
        qi = torch.arange(Sq)[:, None]
        kj = torch.arange(Sk)[None, :]
        cmask = kj <= qi + off
        scores = torch.where(cmask[None, None], scores, -1000000000.0)
        p = _softmax(scores, axis=-1)
        ctx = torch.einsum('bhqk,bhkd->bhqd', p, v)
        return torch.einsum('bhqd,hdm->bqm', ctx, w_o)

    def _B_ref(x, w_gate, w_up, w_down):
        g = torch.einsum('bsd,df->bsf', x, w_gate)
        u = torch.einsum('bsd,df->bsf', x, w_up)
        h = _gelu(g) * u
        return torch.einsum('bsf,fd->bsd', h, w_down)
    x = A_x
    mod = (_silu(c) @ w_mod).reshape(c.shape[0], 6, 1, -1)
    sa, ca, ga, sb, cb, gb = (mod[:, 0].clone(), mod[:, 1].clone(), mod[:, 2].clone(), mod[:, 3].clone(), mod[:, 4].clone(), mod[:, 5].clone())
    h = _layernorm(x, axis=-1) * (1 + ca) + sa
    x = x + ga * _A_ref(h, A_c_kv, A_w_q, A_w_uk, A_w_uv, A_w_o)
    h = _layernorm(x, axis=-1) * (1 + cb) + sb
    x = x + gb * _B_ref(h, B_w_gate, B_w_up, B_w_down)
    return x
```

```asm
; @launch grid=(256,1,1) block=(512,1,1) lds=163840
.amdgcn_target "amdgcn-amd-amdhsa--gfx950"
.text
.globl adaLN_cond__compressed_kv_cla__glu_gated_geglu__decode_kernel
.p2align 8
.type adaLN_cond__compressed_kv_cla__glu_gated_geglu__decode_kernel,@function
adaLN_cond__compressed_kv_cla__glu_gated_geglu__decode_kernel:
  s_cmp_ge_u32 s2, 256
  s_cbranch_scc1 L_end
  s_load_dwordx2 s[12:13], s[0:1], 8
  s_load_dwordx2 s[8:9], s[0:1], 112
  s_load_dwordx4 s[40:43], s[0:1], 80
  s_load_dwordx2 s[60:61], s[0:1], 104
  v_lshrrev_b32 v1, 6, v0
  s_mov_b32 s10, 0x10000000
  s_mov_b32 s11, 0x20000
  v_readfirstlane_b32 s3, v1
  v_and_b32 v1, 63, v0
  s_mov_b32 s14, 0x2000000
  s_mov_b32 s15, 0x20000
  s_lshr_b32 s53, s2, 7
  s_lshl_b32 s53, s53, 3
  s_add_u32 s53, s53, s3
  s_cmp_lt_u32 s53, 12
  s_cbranch_scc1 L_notld
  s_and_b32 s93, s3, 3
  v_lshlrev_b32 v244, 4, v1
  s_lshl_b32 s94, s2, 17
  s_lshl_b32 s95, s93, 15
  v_xor_b32 v245, 64, v244
  v_xor_b32 v246, 128, v244
  v_xor_b32 v247, 192, v244
  s_add_u32 s94, s94, s95
  s_mov_b32 m0, s95
  s_mov_b32 s95, 0
  s_waitcnt lgkmcnt(0)
L_ldb0:
  buffer_load_dwordx4 v244, s[12:15], s94 offen offset:0 nt lds
  s_waitcnt vmcnt(2)
  buffer_load_dwordx4 v245, s[12:15], s94 offen offset:1024 nt lds
  s_waitcnt vmcnt(2)
  buffer_load_dwordx4 v246, s[12:15], s94 offen offset:2048 nt lds
  s_waitcnt vmcnt(2)
  buffer_load_dwordx4 v247, s[12:15], s94 offen offset:3072 nt lds
  s_waitcnt vmcnt(2)
  s_add_u32 s96, s95, 1
  s_xor_b32 s97, s96, s95
  s_and_b32 s97, s97, 3
  s_lshl_b32 s97, s97, 4
  s_mov_b32 s95, s96
  v_xor_b32 v244, s97, v244
  v_xor_b32 v245, s97, v245
  v_xor_b32 v246, s97, v246
  v_xor_b32 v247, s97, v247
  s_add_u32 s94, s94, 4096
  s_add_u32 m0, m0, 4096
  s_cmp_lt_u32 s95, 1
  s_cbranch_scc1 L_ldb0
L_ldb1:
  buffer_load_dwordx4 v244, s[12:15], s94 offen offset:0 nt lds
  s_waitcnt vmcnt(3)
  buffer_load_dwordx4 v245, s[12:15], s94 offen offset:1024 nt lds
  s_waitcnt vmcnt(3)
  buffer_load_dwordx4 v246, s[12:15], s94 offen offset:2048 nt lds
  s_waitcnt vmcnt(3)
  buffer_load_dwordx4 v247, s[12:15], s94 offen offset:3072 nt lds
  s_waitcnt vmcnt(3)
  s_add_u32 s96, s95, 1
  s_xor_b32 s97, s96, s95
  s_and_b32 s97, s97, 3
  s_lshl_b32 s97, s97, 4
  s_mov_b32 s95, s96
  v_xor_b32 v244, s97, v244
  v_xor_b32 v245, s97, v245
  v_xor_b32 v246, s97, v246
  v_xor_b32 v247, s97, v247
  s_add_u32 s94, s94, 4096
  s_add_u32 m0, m0, 4096
  s_cmp_lt_u32 s95, 8
  s_cbranch_scc1 L_ldb1
  s_and_b32 s92, s2, 127
  s_and_b32 s7, s2, 31
  s_bfe_u32 s6, s2, 0x20005
  s_and_b32 s5, s2, 7
  s_lshl_b32 s5, s5, 2
  s_bfe_u32 s53, s2, 0x20003
  s_add_u32 s5, s5, s53
  s_sub_u32 s93, s3, 4
  s_mov_b32 s48, 0x05040100
  s_mov_b32 s49, 0x07060302
  s_mov_b32 s50, 0x0c0c0400
  s_mov_b32 s51, 0x0c040100
  s_mov_b32 s52, 0x04020100
  v_mov_b32 v3, 0xffffff00
  v_and_b32 v2, 255, v0
  s_waitcnt lgkmcnt(0)
  s_mov_b32 s100, 0
  v_mov_b32 v253, 0
L_ep_1:
  global_load_dword v252, v253, s[60:61] sc1
  s_add_u32 s100, s100, 1
  s_cmp_gt_u32 s100, 1000000
  s_cbranch_scc1 L_abort
  s_waitcnt vmcnt(0)
L_epc_2:
  v_readfirstlane_b32 s4, v252
  s_nop 0
  s_cmp_eq_u32 s4, 0
  s_nop 1
  s_cbranch_scc1 L_ep_1
  s_mul_i32 s4, s4, 0x9e3779b1
  s_and_b32 s44, s4, 0xff
  s_bfe_u32 s45, s4, 0x80008
  s_bfe_u32 s46, s4, 0x80010
  s_lshr_b32 s47, s4, 24
  s_branch L_back
L_loader:
  buffer_load_dwordx4 v244, s[12:15], s94 offen offset:0 nt lds
  s_waitcnt vmcnt(8)
  buffer_load_dwordx4 v245, s[12:15], s94 offen offset:1024 nt lds
  s_waitcnt vmcnt(8)
  buffer_load_dwordx4 v246, s[12:15], s94 offen offset:2048 nt lds
  s_waitcnt vmcnt(8)
  buffer_load_dwordx4 v247, s[12:15], s94 offen offset:3072 nt lds
  s_waitcnt vmcnt(8)
  s_add_u32 s96, s95, 1
  s_xor_b32 s97, s96, s95
  s_and_b32 s97, s97, 3
  s_lshl_b32 s97, s97, 4
  s_mov_b32 s95, s96
  v_xor_b32 v244, s97, v244
  v_xor_b32 v245, s97, v245
  v_xor_b32 v246, s97, v246
  v_xor_b32 v247, s97, v247
  s_add_u32 s94, s94, 4096
  s_add_u32 m0, m0, 4096
  s_cmp_lt_u32 s95, 8
  s_cbranch_scc1 L_loader
  s_branch L_back
L_notld:
  s_cmp_lt_u32 s2, 128
  s_cbranch_scc1 L_a
  v_lshrrev_b32 v4, 3, v1
  v_mul_u32_u24 v5, 24576, v4
  v_lshlrev_b32 v4, 3, v4
  v_and_b32 v6, 7, v1
  v_lshl_add_u32 v5, v6, 4, v5
  s_mov_b32 s22, 1024
  s_mov_b32 s23, 0x20000
  s_mov_b32 s26, 0x300000
  s_mov_b32 s27, 0x20000
  s_bfe_u32 s58, s2, 0x20004
  s_and_b32 s59, s2, 15
  s_lshl_b32 s56, s58, 2
  s_add_u32 s56, s56, s3
  s_lshl_b32 s57, s56, 6
  s_mul_i32 s56, s56, 196608
  s_lshl_b32 s53, s59, 7
  s_add_u32 s56, s56, s53
  s_waitcnt lgkmcnt(0)
  s_mov_b64 s[20:21], s[40:41]
  s_mov_b64 s[24:25], s[42:43]
  s_bitcmp1_b32 s2, 6
  s_cbranch_scc1 L_nou0
  buffer_load_dwordx2 v[112:113], v4, s[20:23], s57 offen
  buffer_load_dwordx4 v[124:127], v5, s[24:27], s56 offen nt
  s_add_u32 s56, s56, 6144
  buffer_load_dwordx4 v[128:131], v5, s[24:27], s56 offen nt
  s_add_u32 s56, s56, 6144
  buffer_load_dwordx4 v[132:135], v5, s[24:27], s56 offen nt
  s_add_u32 s56, s56, 6144
  buffer_load_dwordx4 v[136:139], v5, s[24:27], s56 offen nt
L_nou0:
  s_lshl_b32 s43, s59, 2
  s_add_u32 s43, s43, s58
  s_lshl_b32 s43, s43, 8
  s_add_u32 s43, s43, 524288
  s_and_b32 s92, s2, 127
  s_and_b32 s7, s2, 31
  s_bfe_u32 s6, s2, 0x20005
  s_and_b32 s5, s2, 7
  s_lshl_b32 s5, s5, 2
  s_bfe_u32 s53, s2, 0x20003
  s_add_u32 s5, s5, s53
  s_sub_u32 s93, s3, 4
  s_mov_b32 s48, 0x05040100
  s_mov_b32 s49, 0x07060302
  s_mov_b32 s50, 0x0c0c0400
  s_mov_b32 s51, 0x0c040100
  s_mov_b32 s52, 0x04020100
  v_mov_b32 v3, 0xffffff00
  v_and_b32 v2, 255, v0
  v_lshlrev_b32 v8, 7, v6
  v_lshrrev_b32 v9, 4, v1
  v_lshl_add_u32 v8, v9, 5, v8
  s_lshl_b32 s53, s3, 2
  s_add_u32 s53, s53, 133120
  v_add_u32 v8, s53, v8
  v_and_b32 v10, 15, v1
  v_lshlrev_b32 v9, 6, v10
  v_add_u32 v9, 133120, v9
  v_lshlrev_b32 v10, 4, v10
  s_waitcnt lgkmcnt(0)
  s_mov_b32 s100, 0
  v_mov_b32 v253, 0
L_ep_3:
  global_load_dword v252, v253, s[60:61] sc1
  s_add_u32 s100, s100, 1
  s_cmp_gt_u32 s100, 1000000
  s_cbranch_scc1 L_abort
  s_waitcnt vmcnt(0)
L_epc_4:
  v_readfirstlane_b32 s4, v252
  s_nop 0
  s_cmp_eq_u32 s4, 0
  s_nop 1
  s_cbranch_scc1 L_ep_3
  s_mul_i32 s4, s4, 0x9e3779b1
  s_and_b32 s44, s4, 0xff
  s_bfe_u32 s45, s4, 0x80008
  s_bfe_u32 s46, s4, 0x80010
  s_lshr_b32 s47, s4, 24
  s_bitcmp1_b32 s2, 6
  s_cbranch_scc1 L_pf
  s_waitcnt vmcnt(4)
  v_lshlrev_b32 v120, 16, v112
  v_and_b32 v121, 0xffff0000, v112
  v_lshlrev_b32 v122, 16, v113
  v_and_b32 v123, 0xffff0000, v113
  v_mul_f32 v116, 0xbfb8aa3b, v120
  v_mul_f32 v117, 0xbfb8aa3b, v121
  v_mul_f32 v118, 0xbfb8aa3b, v122
  v_mul_f32 v119, 0xbfb8aa3b, v123
  v_exp_f32 v116, v116
  v_exp_f32 v117, v117
  v_exp_f32 v118, v118
  v_exp_f32 v119, v119
  v_add_f32 v116, 1.0, v116
  v_add_f32 v117, 1.0, v117
  v_add_f32 v118, 1.0, v118
  v_add_f32 v119, 1.0, v119
  v_rcp_f32 v116, v116
  v_rcp_f32 v117, v117
  v_rcp_f32 v118, v118
  v_rcp_f32 v119, v119
  v_mul_f32 v120, v120, v116
  v_mul_f32 v121, v121, v117
  v_mul_f32 v122, v122, v118
  v_mul_f32 v123, v123, v119
  v_cvt_pk_bf16_f32 v120, v120, v120
  v_cvt_pk_bf16_f32 v121, v121, v121
  v_cvt_pk_bf16_f32 v122, v122, v122
  v_cvt_pk_bf16_f32 v123, v123, v123
  v_lshrrev_b32 v116, 16, v120
  v_lshrrev_b32 v117, 16, v121
  v_lshrrev_b32 v118, 16, v122
  v_lshrrev_b32 v119, 16, v123
  v_and_b32 v120, 0xffff0000, v120
  v_and_b32 v121, 0xffff0000, v121
  v_and_b32 v122, 0xffff0000, v122
  v_and_b32 v123, 0xffff0000, v123
  v_mov_b32 v96, 0
  v_mov_b32 v97, 0
  v_mov_b32 v98, 0
  v_mov_b32 v99, 0
  v_mov_b32 v100, 0
  v_mov_b32 v101, 0
  v_mov_b32 v102, 0
  v_mov_b32 v103, 0
  s_waitcnt vmcnt(3)
  v_dot2c_f32_bf16 v96, v116, v124
  v_dot2c_f32_bf16 v97, v120, v124
  v_dot2c_f32_bf16 v98, v116, v125
  v_dot2c_f32_bf16 v99, v120, v125
  v_dot2c_f32_bf16 v100, v116, v126
  v_dot2c_f32_bf16 v101, v120, v126
  v_dot2c_f32_bf16 v102, v116, v127
  v_dot2c_f32_bf16 v103, v120, v127
  s_waitcnt vmcnt(2)
  v_dot2c_f32_bf16 v96, v117, v128
  v_dot2c_f32_bf16 v97, v121, v128
  v_dot2c_f32_bf16 v98, v117, v129
  v_dot2c_f32_bf16 v99, v121, v129
  v_dot2c_f32_bf16 v100, v117, v130
  v_dot2c_f32_bf16 v101, v121, v130
  v_dot2c_f32_bf16 v102, v117, v131
  v_dot2c_f32_bf16 v103, v121, v131
  s_waitcnt vmcnt(1)
  v_dot2c_f32_bf16 v96, v118, v132
  v_dot2c_f32_bf16 v97, v122, v132
  v_dot2c_f32_bf16 v98, v118, v133
  v_dot2c_f32_bf16 v99, v122, v133
  v_dot2c_f32_bf16 v100, v118, v134
  v_dot2c_f32_bf16 v101, v122, v134
  v_dot2c_f32_bf16 v102, v118, v135
  v_dot2c_f32_bf16 v103, v122, v135
  s_waitcnt vmcnt(0)
  v_dot2c_f32_bf16 v96, v119, v136
  v_dot2c_f32_bf16 v97, v123, v136
  v_dot2c_f32_bf16 v98, v119, v137
  v_dot2c_f32_bf16 v99, v123, v137
  v_dot2c_f32_bf16 v100, v119, v138
  v_dot2c_f32_bf16 v101, v123, v138
  v_dot2c_f32_bf16 v102, v119, v139
  v_dot2c_f32_bf16 v103, v123, v139
  v_permlane32_swap_b32 v96, v100
  v_permlane32_swap_b32 v97, v101
  v_permlane32_swap_b32 v98, v102
  v_permlane32_swap_b32 v99, v103
  v_add_f32 v96, v96, v100
  v_add_f32 v97, v97, v101
  v_add_f32 v98, v98, v102
  v_add_f32 v99, v99, v103
  s_nop 0
  v_permlane16_swap_b32 v96, v98
  v_permlane16_swap_b32 v97, v99
  v_add_f32 v96, v96, v98
  v_add_f32 v97, v97, v99
  s_nop 0
  v_add_f32_dpp v96, v96, v96 row_ror:8 row_mask:0xf bank_mask:0xf
  v_add_f32_dpp v97, v97, v97 row_ror:8 row_mask:0xf bank_mask:0xf
  ds_write2_b32 v8, v96, v97 offset0:0 offset1:4
  s_lshl_b32 s53, s3, 2
  s_add_u32 s53, s53, 132096
  v_mov_b32 v104, s53
  v_mov_b32 v105, s4
  s_waitcnt lgkmcnt(0)
  ds_write_b32 v104, v105
  s_cmp_lg_u32 s3, 0
  s_cbranch_scc1 L_nopub_5
  v_mov_b32 v104, 132096
  s_mov_b32 s100, 0
L_sync_6:
  ds_read_b128 v[108:111], v104
  s_add_u32 s100, s100, 1
  s_cmp_gt_u32 s100, 4000000
  s_cbranch_scc1 L_abort
  s_waitcnt lgkmcnt(0)
  v_xor_b32 v108, s4, v108
  v_xor_b32 v109, s4, v109
  v_xor_b32 v110, s4, v110
  v_xor_b32 v111, s4, v111
  v_or3_b32 v108, v108, v109, v110
  v_or_b32 v108, v108, v111
  v_cmp_ne_u32 vcc, 0, v108
  s_nop 0
  s_cbranch_vccnz L_sync_6
  ds_read_b128 v[124:127], v9 offset:0
  ds_read_b128 v[128:131], v9 offset:16
  ds_read_b128 v[132:135], v9 offset:32
  ds_read_b128 v[136:139], v9 offset:48
  s_waitcnt lgkmcnt(0)
  v_add_f32 v124, v124, v125
  v_add_f32 v126, v126, v127
  v_add_f32 v128, v128, v129
  v_add_f32 v130, v130, v131
  v_add_f32 v132, v132, v133
  v_add_f32 v134, v134, v135
  v_add_f32 v136, v136, v137
  v_add_f32 v138, v138, v139
  v_add_f32 v96, v124, v126
  v_add_f32 v97, v128, v130
  v_add_f32 v98, v132, v134
  v_add_f32 v99, v136, v138
  v_and_or_b32 v96, v96, v3, s44
  v_and_or_b32 v97, v97, v3, s45
  v_and_or_b32 v98, v98, v3, s46
  v_and_or_b32 v99, v99, v3, s47
  s_mov_b64 exec, 0xffff
  buffer_store_dwordx4 v[96:99], v10, s[8:11], s43 offen sc1
  s_mov_b64 exec, -1
L_nopub_5:
  s_branch L_u1
L_pf:
  s_getpc_b64 s[40:41]
L_pc:
  s_sub_u32 s40, s40, L_pc-adaLN_cond__compressed_kv_cla__glu_gated_geglu__decode_kernel
  s_subb_u32 s41, s41, 0
  v_lshlrev_b32 v11, 4, v2
  s_bfe_u32 s57, s2, 0x30003
  s_lshl_b32 s57, s57, 12
  v_add_u32 v11, s57, v11
  v_min_u32 v11, L_codeend-adaLN_cond__compressed_kv_cla__glu_gated_geglu__decode_kernel-16, v11
  global_load_dwordx4 v[248:251], v11, s[40:41]
L_u1:
  s_bfe_u32 s58, s2, 0x20005
  s_and_b32 s59, s2, 31
  s_add_u32 s59, s59, 16
  s_lshl_b32 s56, s58, 2
  s_add_u32 s56, s56, s3
  s_lshl_b32 s57, s56, 6
  s_mul_i32 s56, s56, 196608
  s_lshl_b32 s53, s59, 7
  s_add_u32 s56, s56, s53
  buffer_load_dwordx2 v[112:113], v4, s[20:23], s57 offen
  buffer_load_dwordx4 v[124:127], v5, s[24:27], s56 offen nt
  s_add_u32 s56, s56, 6144
  buffer_load_dwordx4 v[128:131], v5, s[24:27], s56 offen nt
  s_add_u32 s56, s56, 6144
  buffer_load_dwordx4 v[132:135], v5, s[24:27], s56 offen nt
  s_add_u32 s56, s56, 6144
  buffer_load_dwordx4 v[136:139], v5, s[24:27], s56 offen nt
  s_lshl_b32 s43, s59, 2
  s_add_u32 s43, s43, s58
  s_lshl_b32 s43, s43, 8
  s_add_u32 s43, s43, 524288
  s_waitcnt vmcnt(4)
  v_lshlrev_b32 v120, 16, v112
  v_and_b32 v121, 0xffff0000, v112
  v_lshlrev_b32 v122, 16, v113
  v_and_b32 v123, 0xffff0000, v113
  v_mul_f32 v116, 0xbfb8aa3b, v120
  v_mul_f32 v117, 0xbfb8aa3b, v121
  v_mul_f32 v118, 0xbfb8aa3b, v122
  v_mul_f32 v119, 0xbfb8aa3b, v123
  v_exp_f32 v116, v116
  v_exp_f32 v117, v117
  v_exp_f32 v118, v118
  v_exp_f32 v119, v119
  v_add_f32 v116, 1.0, v116
  v_add_f32 v117, 1.0, v117
  v_add_f32 v118, 1.0, v118
  v_add_f32 v119, 1.0, v119
  v_rcp_f32 v116, v116
  v_rcp_f32 v117, v117
  v_rcp_f32 v118, v118
  v_rcp_f32 v119, v119
  v_mul_f32 v120, v120, v116
  v_mul_f32 v121, v121, v117
  v_mul_f32 v122, v122, v118
  v_mul_f32 v123, v123, v119
  v_cvt_pk_bf16_f32 v120, v120, v120
  v_cvt_pk_bf16_f32 v121, v121, v121
  v_cvt_pk_bf16_f32 v122, v122, v122
  v_cvt_pk_bf16_f32 v123, v123, v123
  v_lshrrev_b32 v116, 16, v120
  v_lshrrev_b32 v117, 16, v121
  v_lshrrev_b32 v118, 16, v122
  v_lshrrev_b32 v119, 16, v123
  v_and_b32 v120, 0xffff0000, v120
  v_and_b32 v121, 0xffff0000, v121
  v_and_b32 v122, 0xffff0000, v122
  v_and_b32 v123, 0xffff0000, v123
  v_mov_b32 v96, 0
  v_mov_b32 v97, 0
  v_mov_b32 v98, 0
  v_mov_b32 v99, 0
  v_mov_b32 v100, 0
  v_mov_b32 v101, 0
  v_mov_b32 v102, 0
  v_mov_b32 v103, 0
  s_waitcnt vmcnt(3)
  v_dot2c_f32_bf16 v96, v116, v124
  v_dot2c_f32_bf16 v97, v120, v124
  v_dot2c_f32_bf16 v98, v116, v125
  v_dot2c_f32_bf16 v99, v120, v125
  v_dot2c_f32_bf16 v100, v116, v126
  v_dot2c_f32_bf16 v101, v120, v126
  v_dot2c_f32_bf16 v102, v116, v127
  v_dot2c_f32_bf16 v103, v120, v127
  s_waitcnt vmcnt(2)
  v_dot2c_f32_bf16 v96, v117, v128
  v_dot2c_f32_bf16 v97, v121, v128
  v_dot2c_f32_bf16 v98, v117, v129
  v_dot2c_f32_bf16 v99, v121, v129
  v_dot2c_f32_bf16 v100, v117, v130
  v_dot2c_f32_bf16 v101, v121, v130
  v_dot2c_f32_bf16 v102, v117, v131
  v_dot2c_f32_bf16 v103, v121, v131
  s_waitcnt vmcnt(1)
  v_dot2c_f32_bf16 v96, v118, v132
  v_dot2c_f32_bf16 v97, v122, v132
  v_dot2c_f32_bf16 v98, v118, v133
  v_dot2c_f32_bf16 v99, v122, v133
  v_dot2c_f32_bf16 v100, v118, v134
  v_dot2c_f32_bf16 v101, v122, v134
  v_dot2c_f32_bf16 v102, v118, v135
  v_dot2c_f32_bf16 v103, v122, v135
  s_waitcnt vmcnt(0)
  v_dot2c_f32_bf16 v96, v119, v136
  v_dot2c_f32_bf16 v97, v123, v136
  v_dot2c_f32_bf16 v98, v119, v137
  v_dot2c_f32_bf16 v99, v123, v137
  v_dot2c_f32_bf16 v100, v119, v138
  v_dot2c_f32_bf16 v101, v123, v138
  v_dot2c_f32_bf16 v102, v119, v139
  v_dot2c_f32_bf16 v103, v123, v139
  v_permlane32_swap_b32 v96, v100
  v_permlane32_swap_b32 v97, v101
  v_permlane32_swap_b32 v98, v102
  v_permlane32_swap_b32 v99, v103
  v_add_f32 v96, v96, v100
  v_add_f32 v97, v97, v101
  v_add_f32 v98, v98, v102
  v_add_f32 v99, v99, v103
  s_nop 0
  v_permlane16_swap_b32 v96, v98
  v_permlane16_swap_b32 v97, v99
  v_add_f32 v96, v96, v98
  v_add_f32 v97, v97, v99
  s_nop 0
  v_add_f32_dpp v96, v96, v96 row_ror:8 row_mask:0xf bank_mask:0xf
  v_add_f32_dpp v97, v97, v97 row_ror:8 row_mask:0xf bank_mask:0xf
  v_add_u32 v8, 1024, v8
  ds_write2_b32 v8, v96, v97 offset0:0 offset1:4
  s_lshl_b32 s53, s3, 2
  s_add_u32 s53, s53, 132112
  v_mov_b32 v104, s53
  v_mov_b32 v105, s4
  s_waitcnt lgkmcnt(0)
  ds_write_b32 v104, v105
  s_cmp_lg_u32 s3, 0
  s_cbranch_scc1 L_nopub_7
  v_mov_b32 v104, 132112
  s_mov_b32 s100, 0
L_sync_8:
  ds_read_b128 v[108:111], v104
  s_add_u32 s100, s100, 1
  s_cmp_gt_u32 s100, 4000000
  s_cbranch_scc1 L_abort
  s_waitcnt lgkmcnt(0)
  v_xor_b32 v108, s4, v108
  v_xor_b32 v109, s4, v109
  v_xor_b32 v110, s4, v110
  v_xor_b32 v111, s4, v111
  v_or3_b32 v108, v108, v109, v110
  v_or_b32 v108, v108, v111
  v_cmp_ne_u32 vcc, 0, v108
  s_nop 0
  s_cbranch_vccnz L_sync_8
  ds_read_b128 v[124:127], v9 offset:1024
  ds_read_b128 v[128:131], v9 offset:1040
  ds_read_b128 v[132:135], v9 offset:1056
  ds_read_b128 v[136:139], v9 offset:1072
  s_waitcnt lgkmcnt(0)
  v_add_f32 v124, v124, v125
  v_add_f32 v126, v126, v127
  v_add_f32 v128, v128, v129
  v_add_f32 v130, v130, v131
  v_add_f32 v132, v132, v133
  v_add_f32 v134, v134, v135
  v_add_f32 v136, v136, v137
  v_add_f32 v138, v138, v139
  v_add_f32 v96, v124, v126
  v_add_f32 v97, v128, v130
  v_add_f32 v98, v132, v134
  v_add_f32 v99, v136, v138
  v_and_or_b32 v96, v96, v3, s44
  v_and_or_b32 v97, v97, v3, s45
  v_and_or_b32 v98, v98, v3, s46
  v_and_or_b32 v99, v99, v3, s47
  s_mov_b64 exec, 0xffff
  buffer_store_dwordx4 v[96:99], v10, s[8:11], s43 offen sc1
  s_mov_b64 exec, -1
L_nopub_7:
  s_cmp_lg_u32 s3, 0
  s_cbranch_scc1 L_nogo
  v_lshlrev_b32 v11, 5, v1
  v_add_u32 v11, 131072, v11
  v_mov_b32 v12, s4
  s_mov_b64 exec, 15
  ds_write_b32 v11, v12
  s_mov_b64 exec, -1
L_nogo:
  s_load_dwordx2 s[12:13], s[0:1], 56
  s_mov_b32 s14, 0x1c0000
  s_mov_b32 s15, 0x20000
  s_load_dwordx2 s[36:37], s[0:1], 64
  s_mov_b32 s38, 0x1c0000
  s_mov_b32 s39, 0x20000
  s_load_dwordx2 s[16:17], s[0:1], 0
  s_mov_b32 s18, 0x400
  s_mov_b32 s19, 0x20000
  s_and_b32 s42, s2, 7
  s_lshl_b32 s42, s42, 1
  s_bfe_u32 s56, s2, 0x10003
  s_add_u32 s42, s42, s56
  s_bfe_u32 s43, s2, 0x30004
  v_and_b32 v5, 3, v1
  v_lshrrev_b32 v7, 4, v1
  v_lshrrev_b32 v8, 5, v1
  v_and_b32 v9, 31, v1
  v_bfe_u32 v10, v1, 3, 2
  v_lshlrev_b32 v6, 4, v6
  v_bfe_u32 v4, v1, 3, 1
  v_lshlrev_b32 v11, 13, v4
  v_lshl_add_u32 v11, v7, 8, v11
  v_add_u32 v11, v11, v6
  s_lshr_b32 s56, s42, 1
  s_lshl_b32 s56, s56, 10
  s_and_b32 s57, s42, 1
  s_lshl_b32 s57, s57, 7
  s_add_u32 s56, s56, s57
  s_add_u32 s56, s56, 540672
  v_add_u32 v11, s56, v11
  s_movk_i32 s57, 0x4000
  v_mul_u32_u24 v12, 57344, v8
  v_mul_u32_u24 v4, 28, v10
  v_add_u32 v12, v12, v4
  v_lshl_add_u32 v12, v5, 3, v12
  v_lshlrev_b32 v13, 1, v9
  s_lshl_b32 s58, s43, 2
  s_add_u32 s58, s58, s3
  s_lshl_b32 s59, s58, 6
  s_add_u32 s59, s59, s42
  s_lshl_b32 s59, s59, 8
  s_add_u32 s59, s59, 1572864
  v_lshl_add_u32 v14, v10, 12, v6
  s_mul_i32 s58, s58, 112
  s_mul_i32 s56, s42, 114688
  s_add_u32 s58, s58, s56
  s_lshl_b32 s53, s3, 5
  s_add_u32 s53, s53, 131200
  v_and_b32 v15, 15, v1
  v_lshlrev_b32 v15, 1, v15
  v_and_b32 v4, 1, v7
  v_lshl_add_u32 v15, v4, 7, v15
  v_add_u32 v15, s53, v15
  v_lshlrev_b32 v16, 7, v8
  v_add_u32 v16, s53, v16
  s_mov_b64 s[60:61], -1
  s_mov_b32 s100, 0
  s_branch L_gf_10
L_g_9:
  s_add_u32 s100, s100, 1
  s_cmp_gt_u32 s100, 1000000
  s_cbranch_scc1 L_abort
  s_sleep 8
L_gf_10:
  s_mov_b64 exec, s[60:61]
  buffer_load_dwordx4 v[112:115], v11, s[8:11], 0 offen offset:0 sc1
  buffer_load_dwordx4 v[116:119], v11, s[8:11], s57 offen offset:0 sc1
L_gc_11:
  s_waitcnt vmcnt(0)
  v_perm_b32 v94, v113, v112, s50
  v_perm_b32 v94, v114, v94, s51
  v_perm_b32 v94, v115, v94, s52
  v_cmp_ne_u32 s[60:61], s4, v94
  v_perm_b32 v94, v117, v116, s50
  v_perm_b32 v94, v118, v94, s51
  v_perm_b32 v94, v119, v94, s52
  v_cmp_ne_u32 vcc, s4, v94
  s_nop 0
  s_or_b64 s[60:61], s[60:61], vcc
  s_cmp_lg_u64 s[60:61], 0
  s_cbranch_scc1 L_g_9
  s_mov_b64 exec, -1
  s_lshl_b32 s56, s42, 6
  s_waitcnt lgkmcnt(0)
  buffer_load_ushort v89, v13, s[16:19], s56 offen
  s_mov_b32 exec_lo, 0xf0f0f0f
  s_mov_b32 exec_hi, 0xf0f0f0f
  buffer_load_dwordx2 v[28:29], v12, s[12:15], s58 offen nt
  s_mov_b32 exec_lo, 0xf0f0f0f0
  s_mov_b32 exec_hi, 0xf0f0f0f0
  buffer_load_dwordx2 v[28:29], v12, s[36:39], s58 offen nt
  s_add_u32 s58, s58, 3584
  s_waitcnt vmcnt(12)
  s_mov_b32 exec_lo, 0xf0f0f0f
  s_mov_b32 exec_hi, 0xf0f0f0f
  buffer_load_dwordx2 v[30:31], v12, s[12:15], s58 offen nt
  s_mov_b32 exec_lo, 0xf0f0f0f0
  s_mov_b32 exec_hi, 0xf0f0f0f0
  buffer_load_dwordx2 v[30:31], v12, s[36:39], s58 offen nt
  s_add_u32 s58, s58, 3584
  s_waitcnt vmcnt(12)
  s_mov_b32 exec_lo, 0xf0f0f0f
  s_mov_b32 exec_hi, 0xf0f0f0f
  buffer_load_dwordx2 v[32:33], v12, s[12:15], s58 offen nt
  s_mov_b32 exec_lo, 0xf0f0f0f0
  s_mov_b32 exec_hi, 0xf0f0f0f0
  buffer_load_dwordx2 v[32:33], v12, s[36:39], s58 offen nt
  s_add_u32 s58, s58, 3584
  s_waitcnt vmcnt(12)
  s_mov_b32 exec_lo, 0xf0f0f0f
  s_mov_b32 exec_hi, 0xf0f0f0f
  buffer_load_dwordx2 v[34:35], v12, s[12:15], s58 offen nt
  s_mov_b32 exec_lo, 0xf0f0f0f0
  s_mov_b32 exec_hi, 0xf0f0f0f0
  buffer_load_dwordx2 v[34:35], v12, s[36:39], s58 offen nt
  s_add_u32 s58, s58, 3584
  s_waitcnt vmcnt(12)
  s_mov_b32 exec_lo, 0xf0f0f0f
  s_mov_b32 exec_hi, 0xf0f0f0f
  buffer_load_dwordx2 v[36:37], v12, s[12:15], s58 offen nt
  s_mov_b32 exec_lo, 0xf0f0f0f0
  s_mov_b32 exec_hi, 0xf0f0f0f0
  buffer_load_dwordx2 v[36:37], v12, s[36:39], s58 offen nt
  s_add_u32 s58, s58, 3584
  s_waitcnt vmcnt(12)
  s_mov_b32 exec_lo, 0xf0f0f0f
  s_mov_b32 exec_hi, 0xf0f0f0f
  buffer_load_dwordx2 v[38:39], v12, s[12:15], s58 offen nt
  s_mov_b32 exec_lo, 0xf0f0f0f0
  s_mov_b32 exec_hi, 0xf0f0f0f0
  buffer_load_dwordx2 v[38:39], v12, s[36:39], s58 offen nt
  s_add_u32 s58, s58, 3584
  s_waitcnt vmcnt(12)
  s_mov_b32 exec_lo, 0xf0f0f0f
  s_mov_b32 exec_hi, 0xf0f0f0f
  buffer_load_dwordx2 v[40:41], v12, s[12:15], s58 offen nt
  s_mov_b32 exec_lo, 0xf0f0f0f0
  s_mov_b32 exec_hi, 0xf0f0f0f0
  buffer_load_dwordx2 v[40:41], v12, s[36:39], s58 offen nt
  s_add_u32 s58, s58, 3584
  s_waitcnt vmcnt(12)
  s_mov_b32 exec_lo, 0xf0f0f0f
  s_mov_b32 exec_hi, 0xf0f0f0f
  buffer_load_dwordx2 v[42:43], v12, s[12:15], s58 offen nt
  s_mov_b32 exec_lo, 0xf0f0f0f0
  s_mov_b32 exec_hi, 0xf0f0f0f0
  buffer_load_dwordx2 v[42:43], v12, s[36:39], s58 offen nt
  s_add_u32 s58, s58, 3584
  s_waitcnt vmcnt(12)
  s_mov_b32 exec_lo, 0xf0f0f0f
  s_mov_b32 exec_hi, 0xf0f0f0f
  buffer_load_dwordx2 v[44:45], v12, s[12:15], s58 offen nt
  s_mov_b32 exec_lo, 0xf0f0f0f0
  s_mov_b32 exec_hi, 0xf0f0f0f0
  buffer_load_dwordx2 v[44:45], v12, s[36:39], s58 offen nt
  s_add_u32 s58, s58, 3584
  s_waitcnt vmcnt(12)
  s_mov_b32 exec_lo, 0xf0f0f0f
  s_mov_b32 exec_hi, 0xf0f0f0f
  buffer_load_dwordx2 v[46:47], v12, s[12:15], s58 offen nt
  s_mov_b32 exec_lo, 0xf0f0f0f0
  s_mov_b32 exec_hi, 0xf0f0f0f0
  buffer_load_dwordx2 v[46:47], v12, s[36:39], s58 offen nt
  s_add_u32 s58, s58, 3584
  s_waitcnt vmcnt(12)
  s_mov_b32 exec_lo, 0xf0f0f0f
  s_mov_b32 exec_hi, 0xf0f0f0f
  buffer_load_dwordx2 v[48:49], v12, s[12:15], s58 offen nt
  s_mov_b32 exec_lo, 0xf0f0f0f0
  s_mov_b32 exec_hi, 0xf0f0f0f0
  buffer_load_dwordx2 v[48:49], v12, s[36:39], s58 offen nt
  s_add_u32 s58, s58, 3584
  s_waitcnt vmcnt(12)
  s_mov_b32 exec_lo, 0xf0f0f0f
  s_mov_b32 exec_hi, 0xf0f0f0f
  buffer_load_dwordx2 v[50:51], v12, s[12:15], s58 offen nt
  s_mov_b32 exec_lo, 0xf0f0f0f0
  s_mov_b32 exec_hi, 0xf0f0f0f0
  buffer_load_dwordx2 v[50:51], v12, s[36:39], s58 offen nt
  s_add_u32 s58, s58, 3584
  s_waitcnt vmcnt(12)
  s_mov_b32 exec_lo, 0xf0f0f0f
  s_mov_b32 exec_hi, 0xf0f0f0f
  buffer_load_dwordx2 v[52:53], v12, s[12:15], s58 offen nt
  s_mov_b32 exec_lo, 0xf0f0f0f0
  s_mov_b32 exec_hi, 0xf0f0f0f0
  buffer_load_dwordx2 v[52:53], v12, s[36:39], s58 offen nt
  s_add_u32 s58, s58, 3584
  s_waitcnt vmcnt(12)
  s_mov_b32 exec_lo, 0xf0f0f0f
  s_mov_b32 exec_hi, 0xf0f0f0f
  buffer_load_dwordx2 v[54:55], v12, s[12:15], s58 offen nt
  s_mov_b32 exec_lo, 0xf0f0f0f0
  s_mov_b32 exec_hi, 0xf0f0f0f0
  buffer_load_dwordx2 v[54:55], v12, s[36:39], s58 offen nt
  s_add_u32 s58, s58, 3584
  s_waitcnt vmcnt(12)
  s_mov_b32 exec_lo, 0xf0f0f0f
  s_mov_b32 exec_hi, 0xf0f0f0f
  buffer_load_dwordx2 v[56:57], v12, s[12:15], s58 offen nt
  s_mov_b32 exec_lo, 0xf0f0f0f0
  s_mov_b32 exec_hi, 0xf0f0f0f0
  buffer_load_dwordx2 v[56:57], v12, s[36:39], s58 offen nt
  s_add_u32 s58, s58, 3584
  s_waitcnt vmcnt(12)
  s_mov_b32 exec_lo, 0xf0f0f0f
  s_mov_b32 exec_hi, 0xf0f0f0f
  buffer_load_dwordx2 v[58:59], v12, s[12:15], s58 offen nt
  s_mov_b32 exec_lo, 0xf0f0f0f0
  s_mov_b32 exec_hi, 0xf0f0f0f0
  buffer_load_dwordx2 v[58:59], v12, s[36:39], s58 offen nt
  s_mov_b64 exec, -1
  v_and_b32 v112, v3, v112
  v_and_b32 v113, v3, v113
  v_and_b32 v114, v3, v114
  v_and_b32 v115, v3, v115
  v_and_b32 v116, v3, v116
  v_and_b32 v117, v3, v117
  v_and_b32 v118, v3, v118
  v_and_b32 v119, v3, v119
  v_permlane32_swap_b32 v112, v114
  v_permlane32_swap_b32 v113, v115
  v_add_f32 v112, v112, v114
  v_add_f32 v113, v113, v115
  s_nop 1
  v_permlane16_swap_b32 v112, v113
  v_add_f32 v112, v112, v113
  v_permlane32_swap_b32 v116, v118
  v_permlane32_swap_b32 v117, v119
  v_add_f32 v116, v116, v118
  v_add_f32 v117, v117, v119
  s_nop 1
  v_permlane16_swap_b32 v116, v117
  v_add_f32 v116, v116, v117
  v_cvt_pk_bf16_f32 v94, v112, v112
  v_and_b32 v112, 0xffff0000, v94
  v_cvt_pk_bf16_f32 v95, v116, v116
  v_and_b32 v116, 0xffff0000, v95
  v_lshlrev_b32 v94, 6, v5
  v_and_b32 v95, 28, v1
  v_add_u32 v94, v94, v95
  ds_bpermute_b32 v90, v94, v112 offset:0
  ds_bpermute_b32 v91, v94, v112 offset:32
  ds_bpermute_b32 v92, v94, v116 offset:0
  ds_bpermute_b32 v93, v94, v116 offset:32
  s_waitcnt vmcnt(0) lgkmcnt(0)
  v_add_f32 v92, 1.0, v92
  v_lshlrev_b32 v89, 16, v89
  v_cvt_pk_bf16_f32 v94, v92, v92
  v_and_b32 v92, 0xffff0000, v94
  v_perm_b32 v60, v30, v28, s48
  v_perm_b32 v28, v30, v28, s49
  v_perm_b32 v30, v31, v29, s48
  v_perm_b32 v29, v31, v29, s49
  v_perm_b32 v31, v34, v32, s48
  v_perm_b32 v32, v34, v32, s49
  v_perm_b32 v34, v35, v33, s48
  v_perm_b32 v33, v35, v33, s49
  v_perm_b32 v35, v38, v36, s48
  v_perm_b32 v36, v38, v36, s49
  v_perm_b32 v38, v39, v37, s48
  v_perm_b32 v37, v39, v37, s49
  v_perm_b32 v39, v42, v40, s48
  v_perm_b32 v40, v42, v40, s49
  v_perm_b32 v42, v43, v41, s48
  v_perm_b32 v41, v43, v41, s49
  v_perm_b32 v43, v46, v44, s48
  v_perm_b32 v44, v46, v44, s49
  v_perm_b32 v46, v47, v45, s48
  v_perm_b32 v45, v47, v45, s49
  v_perm_b32 v47, v50, v48, s48
  v_perm_b32 v48, v50, v48, s49
  v_perm_b32 v50, v51, v49, s48
  v_perm_b32 v49, v51, v49, s49
  v_perm_b32 v51, v54, v52, s48
  v_perm_b32 v52, v54, v52, s49
  v_perm_b32 v54, v55, v53, s48
  v_perm_b32 v53, v55, v53, s49
  v_perm_b32 v55, v58, v56, s48
  v_perm_b32 v56, v58, v56, s49
  v_perm_b32 v58, v59, v57, s48
  v_perm_b32 v57, v59, v57, s49
  v_lshrrev_b32 v94, 16, v92
  ds_write_b16 v15, v94
  ds_read_b128 v[96:99], v16
  ds_read_b128 v[104:107], v16 offset:16
  v_mov_b32 v100, 0
  v_mov_b32 v101, 0
  v_mov_b32 v102, 0
  v_mov_b32 v103, 0
  s_waitcnt lgkmcnt(1)
  v_dot2c_f32_bf16 v100, v96, v60
  v_dot2c_f32_bf16 v101, v96, v28
  v_dot2c_f32_bf16 v102, v96, v30
  v_dot2c_f32_bf16 v103, v96, v29
  v_dot2c_f32_bf16 v100, v97, v31
  v_dot2c_f32_bf16 v101, v97, v32
  v_dot2c_f32_bf16 v102, v97, v34
  v_dot2c_f32_bf16 v103, v97, v33
  v_dot2c_f32_bf16 v100, v98, v35
  v_dot2c_f32_bf16 v101, v98, v36
  v_dot2c_f32_bf16 v102, v98, v38
  v_dot2c_f32_bf16 v103, v98, v37
  v_dot2c_f32_bf16 v100, v99, v39
  v_dot2c_f32_bf16 v101, v99, v40
  v_dot2c_f32_bf16 v102, v99, v42
  v_dot2c_f32_bf16 v103, v99, v41
  s_waitcnt lgkmcnt(0)
  v_dot2c_f32_bf16 v100, v104, v43
  v_dot2c_f32_bf16 v101, v104, v44
  v_dot2c_f32_bf16 v102, v104, v46
  v_dot2c_f32_bf16 v103, v104, v45
  v_dot2c_f32_bf16 v100, v105, v47
  v_dot2c_f32_bf16 v101, v105, v48
  v_dot2c_f32_bf16 v102, v105, v50
  v_dot2c_f32_bf16 v103, v105, v49
  v_dot2c_f32_bf16 v100, v106, v51
  v_dot2c_f32_bf16 v101, v106, v52
  v_dot2c_f32_bf16 v102, v106, v54
  v_dot2c_f32_bf16 v103, v106, v53
  v_dot2c_f32_bf16 v100, v107, v55
  v_dot2c_f32_bf16 v101, v107, v56
  v_dot2c_f32_bf16 v102, v107, v58
  v_dot2c_f32_bf16 v103, v107, v57
  v_mov_b32 v108, v100
  v_mov_b32 v109, v101
  v_mov_b32 v110, v102
  v_mov_b32 v111, v103
  v_permlane32_swap_b32 v100, v108
  v_permlane32_swap_b32 v101, v109
  v_permlane32_swap_b32 v102, v110
  v_permlane32_swap_b32 v103, v111
  v_add_f32 v100, v100, v108
  v_add_f32 v101, v101, v109
  v_add_f32 v102, v102, v110
  v_add_f32 v103, v103, v111
  v_and_or_b32 v100, v100, v3, s44
  v_and_or_b32 v101, v101, v3, s45
  v_and_or_b32 v102, v102, v3, s46
  v_and_or_b32 v103, v103, v3, s47
  s_mov_b32 exec_hi, 0
  buffer_store_dwordx4 v[100:103], v14, s[8:11], s59 offen offset:0 sc1
  s_mov_b64 exec, -1
  v_lshrrev_b32 v94, 16, v91
  ds_write_b16 v15, v94
  ds_read_b128 v[96:99], v16
  ds_read_b128 v[104:107], v16 offset:16
  v_mov_b32 v112, 0
  v_mov_b32 v113, 0
  v_mov_b32 v114, 0
  v_mov_b32 v115, 0
  s_waitcnt lgkmcnt(1)
  v_dot2c_f32_bf16 v112, v96, v60
  v_dot2c_f32_bf16 v113, v96, v28
  v_dot2c_f32_bf16 v114, v96, v30
  v_dot2c_f32_bf16 v115, v96, v29
  v_dot2c_f32_bf16 v112, v97, v31
  v_dot2c_f32_bf16 v113, v97, v32
  v_dot2c_f32_bf16 v114, v97, v34
  v_dot2c_f32_bf16 v115, v97, v33
  v_dot2c_f32_bf16 v112, v98, v35
  v_dot2c_f32_bf16 v113, v98, v36
  v_dot2c_f32_bf16 v114, v98, v38
  v_dot2c_f32_bf16 v115, v98, v37
  v_dot2c_f32_bf16 v112, v99, v39
  v_dot2c_f32_bf16 v113, v99, v40
  v_dot2c_f32_bf16 v114, v99, v42
  v_dot2c_f32_bf16 v115, v99, v41
  s_waitcnt lgkmcnt(0)
  v_dot2c_f32_bf16 v112, v104, v43
  v_dot2c_f32_bf16 v113, v104, v44
  v_dot2c_f32_bf16 v114, v104, v46
  v_dot2c_f32_bf16 v115, v104, v45
  v_dot2c_f32_bf16 v112, v105, v47
  v_dot2c_f32_bf16 v113, v105, v48
  v_dot2c_f32_bf16 v114, v105, v50
  v_dot2c_f32_bf16 v115, v105, v49
  v_dot2c_f32_bf16 v112, v106, v51
  v_dot2c_f32_bf16 v113, v106, v52
  v_dot2c_f32_bf16 v114, v106, v54
  v_dot2c_f32_bf16 v115, v106, v53
  v_dot2c_f32_bf16 v112, v107, v55
  v_dot2c_f32_bf16 v113, v107, v56
  v_dot2c_f32_bf16 v114, v107, v58
  v_dot2c_f32_bf16 v115, v107, v57
  v_mov_b32 v108, v112
  v_mov_b32 v109, v113
  v_mov_b32 v110, v114
  v_mov_b32 v111, v115
  v_permlane32_swap_b32 v112, v108
  v_permlane32_swap_b32 v113, v109
  v_permlane32_swap_b32 v114, v110
  v_permlane32_swap_b32 v115, v111
  v_add_f32 v112, v112, v108
  v_add_f32 v113, v113, v109
  v_add_f32 v114, v114, v110
  v_add_f32 v115, v115, v111
  v_and_or_b32 v112, v112, v3, s44
  v_and_or_b32 v113, v113, v3, s45
  v_and_or_b32 v114, v114, v3, s46
  v_and_or_b32 v115, v115, v3, s47
  s_mov_b32 exec_hi, 0
  buffer_store_dwordx4 v[112:115], v14, s[8:11], s59 offen offset:128 sc1
  s_mov_b64 exec, -1
  s_branch L_front
L_a:
  s_load_dwordx2 s[28:29], s[0:1], 16
  s_mov_b32 s30, 0x400000
  s_mov_b32 s31, 0x20000
  s_load_dwordx2 s[16:17], s[0:1], 0
  s_mov_b32 s18, 0x400
  s_mov_b32 s19, 0x20000
  s_load_dwordx2 s[24:25], s[0:1], 24
  s_mov_b32 s26, 0x400000
  s_mov_b32 s27, 0x20000
  v_lshrrev_b32 v6, 4, v1
  v_and_b32 v9, 15, v1
  v_lshlrev_b32 v5, 17, v6
  v_lshl_add_u32 v5, v9, 4, v5
  s_and_b32 s7, s2, 31
  s_bfe_u32 s6, s2, 0x20005
  s_lshl_b32 s39, s6, 1
  s_add_u32 s39, s39, s3
  s_and_b32 s39, s39, 7
  s_lshl_b32 s57, s7, 8
  v_lshrrev_b32 v10, 3, v1
  v_and_b32 v11, 7, v1
  v_lshlrev_b32 v4, 13, v10
  v_lshl_add_u32 v4, v11, 4, v4
  s_lshl_b32 s56, s6, 20
  s_lshl_b32 s58, s3, 17
  s_add_u32 s56, s56, s58
  s_add_u32 s56, s56, s57
  s_add_u32 s58, s56, 0x10000
  v_lshlrev_b32 v7, 4, v1
  v_lshl_add_u32 v8, v9, 2, v6
  v_lshlrev_b32 v8, 1, v8
  s_lshl_b32 s59, s39, 7
  s_memrealtime s[62:63]
  s_waitcnt lgkmcnt(0)
  s_or_b32 s63, s2, s3
  s_cbranch_scc1 L_nononce
  s_or_b32 s62, s62, 1
  v_mov_b32 v12, 0
  v_mov_b32 v13, s62
  s_mov_b64 exec, 1
  global_store_dword v12, v13, s[60:61] sc0 sc1
  s_mov_b64 exec, -1
L_nononce:
  buffer_load_dwordx4 v[12:15], v7, s[16:19], 0 offen
  buffer_load_ushort v16, v8, s[16:19], s59 offen
  buffer_load_dwordx4 v[52:55], v4, s[24:27], s56 offen offset:0 nt
  buffer_load_dwordx4 v[56:59], v4, s[24:27], s56 offen offset:128 nt
  buffer_load_dwordx4 v[60:63], v4, s[24:27], s58 offen offset:0 nt
  buffer_load_dwordx4 v[64:67], v4, s[24:27], s58 offen offset:128 nt
  s_lshl_b32 s56, s39, 19
  s_add_u32 s56, s56, s57
  s_barrier
  buffer_load_dwordx4 v[112:115], v5, s[28:31], s56 offen nt
  s_add_u32 s56, s56, 8192
  buffer_load_dwordx4 v[116:119], v5, s[28:31], s56 offen nt
  s_add_u32 s56, s56, 8192
  buffer_load_dwordx4 v[120:123], v5, s[28:31], s56 offen nt
  s_add_u32 s56, s56, 8192
  buffer_load_dwordx4 v[124:127], v5, s[28:31], s56 offen nt
  s_add_u32 s56, s56, 8192
  buffer_load_dwordx4 v[128:131], v5, s[28:31], s56 offen nt
  s_add_u32 s56, s56, 8192
  buffer_load_dwordx4 v[132:135], v5, s[28:31], s56 offen nt
  s_add_u32 s56, s56, 8192
  s_and_b32 s92, s2, 127
  s_and_b32 s7, s2, 31
  s_bfe_u32 s6, s2, 0x20005
  s_and_b32 s5, s2, 7
  s_lshl_b32 s5, s5, 2
  s_bfe_u32 s53, s2, 0x20003
  s_add_u32 s5, s5, s53
  s_sub_u32 s93, s3, 4
  s_mov_b32 s48, 0x05040100
  s_mov_b32 s49, 0x07060302
  s_mov_b32 s50, 0x0c0c0400
  s_mov_b32 s51, 0x0c040100
  s_mov_b32 s52, 0x04020100
  v_mov_b32 v3, 0xffffff00
  v_and_b32 v2, 255, v0
  s_waitcnt vmcnt(10)
  v_lshlrev_b32 v92, 16, v12
  v_and_b32 v93, 0xffff0000, v12
  v_lshlrev_b32 v94, 16, v13
  v_and_b32 v95, 0xffff0000, v13
  v_lshlrev_b32 v96, 16, v14
  v_and_b32 v97, 0xffff0000, v14
  v_lshlrev_b32 v98, 16, v15
  v_and_b32 v99, 0xffff0000, v15
  v_add_f32 v100, v92, v93
  v_add_f32 v100, v100, v94
  v_add_f32 v100, v100, v95
  v_add_f32 v100, v100, v96
  v_add_f32 v100, v100, v97
  v_add_f32 v100, v100, v98
  v_add_f32 v100, v100, v99
  s_nop 1
  v_add_f32_dpp v100, v100, v100 row_ror:8 row_mask:0xf bank_mask:0xf
  s_nop 1
  v_add_f32_dpp v100, v100, v100 row_ror:4 row_mask:0xf bank_mask:0xf
  s_nop 1
  v_add_f32_dpp v100, v100, v100 row_ror:2 row_mask:0xf bank_mask:0xf
  s_nop 1
  v_add_f32_dpp v100, v100, v100 row_ror:1 row_mask:0xf bank_mask:0xf
  v_mov_b32 v101, v100
  s_nop 1
  v_permlane16_swap_b32 v100, v101
  v_add_f32 v100, v100, v101
  v_mov_b32 v101, v100
  s_nop 1
  v_permlane32_swap_b32 v100, v101
  v_add_f32 v100, v100, v101
  buffer_load_dwordx4 v[136:139], v5, s[28:31], s56 offen nt
  s_add_u32 s56, s56, 8192
  buffer_load_dwordx4 v[140:143], v5, s[28:31], s56 offen nt
  s_add_u32 s56, s56, 8192
  buffer_load_dwordx4 v[144:147], v5, s[28:31], s56 offen nt
  s_add_u32 s56, s56, 8192
  buffer_load_dwordx4 v[148:151], v5, s[28:31], s56 offen nt
  s_add_u32 s56, s56, 8192
  v_mul_f32 v100, 0x3b000000, v100
  v_sub_f32 v92, v92, v100
  v_sub_f32 v93, v93, v100
  v_sub_f32 v94, v94, v100
  v_sub_f32 v95, v95, v100
  v_sub_f32 v96, v96, v100
  v_sub_f32 v97, v97, v100
  v_sub_f32 v98, v98, v100
  v_sub_f32 v99, v99, v100
  v_mul_f32 v102, v92, v92
  v_fmac_f32 v102, v93, v93
  v_fmac_f32 v102, v94, v94
  v_fmac_f32 v102, v95, v95
  v_fmac_f32 v102, v96, v96
  v_fmac_f32 v102, v97, v97
  v_fmac_f32 v102, v98, v98
  v_fmac_f32 v102, v99, v99
  s_nop 1
  v_add_f32_dpp v102, v102, v102 row_ror:8 row_mask:0xf bank_mask:0xf
  s_nop 1
  v_add_f32_dpp v102, v102, v102 row_ror:4 row_mask:0xf bank_mask:0xf
  s_nop 1
  v_add_f32_dpp v102, v102, v102 row_ror:2 row_mask:0xf bank_mask:0xf
  s_nop 1
  v_add_f32_dpp v102, v102, v102 row_ror:1 row_mask:0xf bank_mask:0xf
  v_mov_b32 v101, v102
  s_nop 1
  v_permlane16_swap_b32 v102, v101
  v_add_f32 v102, v102, v101
  v_mov_b32 v101, v102
  s_nop 1
  v_permlane32_swap_b32 v102, v101
  v_add_f32 v102, v102, v101
  v_mul_f32 v102, 0x3b000000, v102
  v_cvt_pk_bf16_f32 v101, v100, v100
  v_and_b32 v100, 0xffff0000, v101
  v_cvt_pk_bf16_f32 v101, v102, v102
  v_and_b32 v102, 0xffff0000, v101
  v_add_f32 v102, 0x3727c5ac, v102
  v_cvt_pk_bf16_f32 v101, v102, v102
  v_and_b32 v102, 0xffff0000, v101
  v_sqrt_f32 v102, v102
  s_nop 0
  v_cvt_pk_bf16_f32 v101, v102, v102
  v_and_b32 v102, 0xffff0000, v101
  v_rcp_f32 v102, v102
  v_lshlrev_b32 v103, 16, v16
  v_sub_f32 v103, v103, v100
  v_cvt_pk_bf16_f32 v101, v103, v103
  v_and_b32 v103, 0xffff0000, v101
  v_mul_f32 v103, v103, v102
  v_cvt_pk_bf16_f32 v101, v103, v103
  v_and_b32 v103, 0xffff0000, v101
  buffer_load_dwordx4 v[152:155], v5, s[28:31], s56 offen nt
  s_add_u32 s56, s56, 8192
  buffer_load_dwordx4 v[156:159], v5, s[28:31], s56 offen nt
  s_add_u32 s56, s56, 8192
  buffer_load_dwordx4 v[160:163], v5, s[28:31], s56 offen nt
  s_add_u32 s56, s56, 8192
  buffer_load_dwordx4 v[164:167], v5, s[28:31], s56 offen nt
  s_add_u32 s56, s56, 8192
  buffer_load_dwordx4 v[168:171], v5, s[28:31], s56 offen nt
  s_add_u32 s56, s56, 8192
  buffer_load_dwordx4 v[172:175], v5, s[28:31], s56 offen nt
  s_and_b32 s93, s3, 3
  v_lshlrev_b32 v244, 4, v1
  s_lshl_b32 s94, s2, 17
  s_lshl_b32 s95, s93, 15
  s_lshr_b32 s96, s3, 2
  s_mul_i32 s96, s96, 1
  s_lshl_b32 s97, s96, 12
  s_add_u32 s95, s95, s97
  s_lshl_b32 s97, s96, 4
  v_xor_b32 v244, s97, v244
  v_xor_b32 v245, 64, v244
  v_xor_b32 v246, 128, v244
  v_xor_b32 v247, 192, v244
  s_add_u32 s94, s94, s95
  s_mov_b32 m0, s95
  s_mov_b32 s95, s96
  s_lshl_b32 s42, s39, 10
  s_add_u32 s42, s42, 524288
  s_add_u32 s43, s42, 8192
  s_lshl_b32 s53, s3, 7
  s_add_u32 s53, s53, 133120
  v_add_u32 v40, s53, v8
  v_lshlrev_b32 v41, 5, v6
  v_add_u32 v41, s53, v41
  v_lshlrev_b32 v42, 5, v9
  v_lshl_add_u32 v42, v6, 3, v42
  s_lshl_b32 s53, s3, 9
  s_add_u32 s53, s53, 135168
  v_add_u32 v42, s53, v42
  v_lshlrev_b32 v43, 3, v1
  v_add_u32 v43, 135168, v43
  v_lshlrev_b32 v44, 2, v1
  v_add_u32 v44, 132608, v44
  v_lshlrev_b32 v45, 4, v11
  v_add_u32 v45, 132608, v45
  v_lshlrev_b32 v46, 1, v10
  s_lshl_b32 s53, s3, 4
  s_add_u32 s53, s53, 132224
  v_add_u32 v46, s53, v46
  v_add_u32 v47, 128, v46
  v_add_u32 v48, 244, v46
  v_add_u32 v49, 248, v46
  v_cmp_lt_u32 vcc, 47, v1
  s_nop 1
  v_cndmask_b32 v46, v46, v48, vcc
  v_cndmask_b32 v47, v47, v49, vcc
  v_add_u32 v48, 132224, v7
  v_lshlrev_b32 v49, 14, v10
  v_lshl_add_u32 v49, v11, 4, v49
  s_lshl_b32 s40, s7, 2
  s_add_u32 s40, s40, s6
  s_lshl_b32 s40, s40, 7
  s_add_u32 s40, s40, 131072
  s_lshl_b32 s56, s92, 7
  s_add_u32 s56, s56, 196608
  v_mov_b32 v4, 0
  s_lshl_b32 s57, s3, 7
  s_add_u32 s57, s57, s92
  s_cmp_ge_u32 s57, 64
  s_waitcnt lgkmcnt(0)
  s_cbranch_scc1 L_nocnt
  s_mov_b64 exec, 1
  buffer_store_dword v4, v4, s[8:11], s56 offen sc1
  s_mov_b64 exec, -1
L_nocnt:
  s_barrier
  v_mov_b32 v253, 0
  global_load_dword v252, v253, s[60:61] sc1
  buffer_load_dwordx4 v[20:23], v7, s[8:11], s42 offen offset:0 sc1
  buffer_load_dwordx4 v[24:27], v7, s[8:11], s43 offen offset:0 sc1
  s_waitcnt vmcnt(17)
  v_perm_b32 v176, v116, v112, s48
  v_perm_b32 v112, v116, v112, s49
  v_perm_b32 v116, v117, v113, s48
  v_perm_b32 v113, v117, v113, s49
  v_perm_b32 v117, v118, v114, s48
  v_perm_b32 v114, v118, v114, s49
  v_perm_b32 v118, v119, v115, s48
  v_perm_b32 v115, v119, v115, s49
  s_waitcnt vmcnt(15)
  v_perm_b32 v119, v124, v120, s48
  v_perm_b32 v120, v124, v120, s49
  v_perm_b32 v124, v125, v121, s48
  v_perm_b32 v121, v125, v121, s49
  v_perm_b32 v125, v126, v122, s48
  v_perm_b32 v122, v126, v122, s49
  v_perm_b32 v126, v127, v123, s48
  v_perm_b32 v123, v127, v123, s49
  s_waitcnt vmcnt(13)
  v_perm_b32 v127, v132, v128, s48
  v_perm_b32 v128, v132, v128, s49
  v_perm_b32 v132, v133, v129, s48
  v_perm_b32 v129, v133, v129, s49
  v_perm_b32 v133, v134, v130, s48
  v_perm_b32 v130, v134, v130, s49
  v_perm_b32 v134, v135, v131, s48
  v_perm_b32 v131, v135, v131, s49
  s_waitcnt vmcnt(11)
  v_perm_b32 v135, v140, v136, s48
  v_perm_b32 v136, v140, v136, s49
  v_perm_b32 v140, v141, v137, s48
  v_perm_b32 v137, v141, v137, s49
  v_perm_b32 v141, v142, v138, s48
  v_perm_b32 v138, v142, v138, s49
  v_perm_b32 v142, v143, v139, s48
  v_perm_b32 v139, v143, v139, s49
  s_waitcnt vmcnt(9)
  v_perm_b32 v143, v148, v144, s48
  v_perm_b32 v144, v148, v144, s49
  v_perm_b32 v148, v149, v145, s48
  v_perm_b32 v145, v149, v145, s49
  v_perm_b32 v149, v150, v146, s48
  v_perm_b32 v146, v150, v146, s49
  v_perm_b32 v150, v151, v147, s48
  v_perm_b32 v147, v151, v147, s49
  s_waitcnt vmcnt(7)
  v_perm_b32 v151, v156, v152, s48
  v_perm_b32 v152, v156, v152, s49
  v_perm_b32 v156, v157, v153, s48
  v_perm_b32 v153, v157, v153, s49
  v_perm_b32 v157, v158, v154, s48
  v_perm_b32 v154, v158, v154, s49
  v_perm_b32 v158, v159, v155, s48
  v_perm_b32 v155, v159, v155, s49
  s_waitcnt vmcnt(5)
  v_perm_b32 v159, v164, v160, s48
  v_perm_b32 v160, v164, v160, s49
  v_perm_b32 v164, v165, v161, s48
  v_perm_b32 v161, v165, v161, s49
  v_perm_b32 v165, v166, v162, s48
  v_perm_b32 v162, v166, v162, s49
  v_perm_b32 v166, v167, v163, s48
  v_perm_b32 v163, v167, v163, s49
  s_waitcnt vmcnt(3)
  v_perm_b32 v167, v172, v168, s48
  v_perm_b32 v168, v172, v168, s49
  v_perm_b32 v172, v173, v169, s48
  v_perm_b32 v169, v173, v169, s49
  v_perm_b32 v173, v174, v170, s48
  v_perm_b32 v170, v174, v170, s49
  v_perm_b32 v174, v175, v171, s48
  v_perm_b32 v171, v175, v171, s49
  v_mov_b32 v84, 0
  v_mov_b32 v85, 0
  v_mov_b32 v86, 0
  v_mov_b32 v87, 0
  v_mov_b32 v88, 0
  v_mov_b32 v89, 0
  v_mov_b32 v90, 0
  v_mov_b32 v91, 0
  s_mov_b32 s100, 0
  s_waitcnt vmcnt(2)
  s_branch L_epc_15
L_ep_14:
  global_load_dword v252, v253, s[60:61] sc1
  s_add_u32 s100, s100, 1
  s_cmp_gt_u32 s100, 1000000
  s_cbranch_scc1 L_abort
  s_waitcnt vmcnt(0)
L_epc_15:
  v_readfirstlane_b32 s4, v252
  s_nop 0
  s_cmp_eq_u32 s4, 0
  s_nop 1
  s_cbranch_scc1 L_ep_14
  s_mul_i32 s4, s4, 0x9e3779b1
  s_and_b32 s44, s4, 0xff
  s_bfe_u32 s45, s4, 0x80008
  s_bfe_u32 s46, s4, 0x80010
  s_lshr_b32 s47, s4, 24
  s_mov_b64 s[60:61], -1
  s_mov_b32 s100, 0
  s_branch L_gc_18
L_g_16:
  s_add_u32 s100, s100, 1
  s_cmp_gt_u32 s100, 1000000
  s_cbranch_scc1 L_abort
  s_sleep 1
L_gf_17:
  s_mov_b64 exec, s[60:61]
  buffer_load_dwordx4 v[20:23], v7, s[8:11], s42 offen offset:0 sc1
  buffer_load_dwordx4 v[24:27], v7, s[8:11], s43 offen offset:0 sc1
L_gc_18:
  s_waitcnt vmcnt(0)
  s_mov_b64 exec, s[60:61]
  v_perm_b32 v92, v21, v20, s50
  v_perm_b32 v92, v22, v92, s51
  v_perm_b32 v92, v23, v92, s52
  v_cmp_ne_u32 s[60:61], s4, v92
  v_perm_b32 v92, v25, v24, s50
  v_perm_b32 v92, v26, v92, s51
  v_perm_b32 v92, v27, v92, s52
  v_cmp_ne_u32 vcc, s4, v92
  s_nop 0
  s_or_b64 s[60:61], s[60:61], vcc
  s_cmp_lg_u64 s[60:61], 0
  s_cbranch_scc1 L_g_16
  s_mov_b64 exec, -1
  buffer_load_dwordx4 v244, s[12:15], s94 offen offset:0 nt lds
  buffer_load_dwordx4 v245, s[12:15], s94 offen offset:1024 nt lds
  buffer_load_dwordx4 v246, s[12:15], s94 offen offset:2048 nt lds
  buffer_load_dwordx4 v247, s[12:15], s94 offen offset:3072 nt lds
  s_add_u32 s96, s95, 1
  s_xor_b32 s97, s96, s95
  s_and_b32 s97, s97, 3
  s_lshl_b32 s97, s97, 4
  s_mov_b32 s95, s96
  v_xor_b32 v244, s97, v244
  v_xor_b32 v245, s97, v245
  v_xor_b32 v246, s97, v246
  v_xor_b32 v247, s97, v247
  s_add_u32 s94, s94, 4096
  s_add_u32 m0, m0, 4096
  v_and_b32 v20, v3, v20
  v_and_b32 v21, v3, v21
  v_and_b32 v22, v3, v22
  v_and_b32 v23, v3, v23
  v_and_b32 v24, v3, v24
  v_and_b32 v25, v3, v25
  v_and_b32 v26, v3, v26
  v_and_b32 v27, v3, v27
  v_permlane32_swap_b32 v20, v22
  v_permlane32_swap_b32 v21, v23
  v_permlane32_swap_b32 v24, v26
  v_permlane32_swap_b32 v25, v27
  v_add_f32 v20, v20, v22
  v_add_f32 v21, v21, v23
  v_add_f32 v24, v24, v26
  v_add_f32 v25, v25, v27
  v_permlane16_swap_b32 v20, v21
  s_nop 0
  v_permlane16_swap_b32 v24, v25
  v_add_f32 v20, v20, v21
  v_add_f32 v24, v24, v25
  v_cvt_pk_bf16_f32 v21, v20, v20
  v_and_b32 v20, 0xffff0000, v21
  v_cvt_pk_bf16_f32 v25, v24, v24
  v_and_b32 v24, 0xffff0000, v25
  v_add_f32 v24, 1.0, v24
  v_cvt_pk_bf16_f32 v25, v24, v24
  v_and_b32 v24, 0xffff0000, v25
  v_mul_f32 v24, v103, v24
  v_cvt_pk_bf16_f32 v25, v24, v24
  v_and_b32 v24, 0xffff0000, v25
  v_add_f32 v24, v24, v20
  v_cvt_pk_bf16_f32 v24, v24, v24
  ds_write_b16 v40, v24
  ds_read_b128 v[28:31], v41
  ds_read_b128 v[32:35], v41 offset:16
  s_waitcnt lgkmcnt(1)
  v_dot2c_f32_bf16 v84, v28, v176
  v_dot2c_f32_bf16 v85, v28, v112
  v_dot2c_f32_bf16 v86, v28, v116
  v_dot2c_f32_bf16 v87, v28, v113
  v_dot2c_f32_bf16 v88, v28, v117
  v_dot2c_f32_bf16 v89, v28, v114
  v_dot2c_f32_bf16 v90, v28, v118
  v_dot2c_f32_bf16 v91, v28, v115
  v_dot2c_f32_bf16 v84, v29, v119
  v_dot2c_f32_bf16 v85, v29, v120
  v_dot2c_f32_bf16 v86, v29, v124
  v_dot2c_f32_bf16 v87, v29, v121
  v_dot2c_f32_bf16 v88, v29, v125
  v_dot2c_f32_bf16 v89, v29, v122
  v_dot2c_f32_bf16 v90, v29, v126
  v_dot2c_f32_bf16 v91, v29, v123
  v_dot2c_f32_bf16 v84, v30, v127
  v_dot2c_f32_bf16 v85, v30, v128
  v_dot2c_f32_bf16 v86, v30, v132
  v_dot2c_f32_bf16 v87, v30, v129
  v_dot2c_f32_bf16 v88, v30, v133
  v_dot2c_f32_bf16 v89, v30, v130
  v_dot2c_f32_bf16 v90, v30, v134
  v_dot2c_f32_bf16 v91, v30, v131
  v_dot2c_f32_bf16 v84, v31, v135
  v_dot2c_f32_bf16 v85, v31, v136
  v_dot2c_f32_bf16 v86, v31, v140
  v_dot2c_f32_bf16 v87, v31, v137
  v_dot2c_f32_bf16 v88, v31, v141
  v_dot2c_f32_bf16 v89, v31, v138
  v_dot2c_f32_bf16 v90, v31, v142
  v_dot2c_f32_bf16 v91, v31, v139
  s_waitcnt lgkmcnt(0)
  v_dot2c_f32_bf16 v84, v32, v143
  v_dot2c_f32_bf16 v85, v32, v144
  v_dot2c_f32_bf16 v86, v32, v148
  v_dot2c_f32_bf16 v87, v32, v145
  v_dot2c_f32_bf16 v88, v32, v149
  v_dot2c_f32_bf16 v89, v32, v146
  v_dot2c_f32_bf16 v90, v32, v150
  v_dot2c_f32_bf16 v91, v32, v147
  v_dot2c_f32_bf16 v84, v33, v151
  v_dot2c_f32_bf16 v85, v33, v152
  v_dot2c_f32_bf16 v86, v33, v156
  v_dot2c_f32_bf16 v87, v33, v153
  v_dot2c_f32_bf16 v88, v33, v157
  v_dot2c_f32_bf16 v89, v33, v154
  v_dot2c_f32_bf16 v90, v33, v158
  v_dot2c_f32_bf16 v91, v33, v155
  v_dot2c_f32_bf16 v84, v34, v159
  v_dot2c_f32_bf16 v85, v34, v160
  v_dot2c_f32_bf16 v86, v34, v164
  v_dot2c_f32_bf16 v87, v34, v161
  v_dot2c_f32_bf16 v88, v34, v165
  v_dot2c_f32_bf16 v89, v34, v162
  v_dot2c_f32_bf16 v90, v34, v166
  v_dot2c_f32_bf16 v91, v34, v163
  v_dot2c_f32_bf16 v84, v35, v167
  v_dot2c_f32_bf16 v85, v35, v168
  v_dot2c_f32_bf16 v86, v35, v172
  v_dot2c_f32_bf16 v87, v35, v169
  v_dot2c_f32_bf16 v88, v35, v173
  v_dot2c_f32_bf16 v89, v35, v170
  v_dot2c_f32_bf16 v90, v35, v174
  v_dot2c_f32_bf16 v91, v35, v171
  v_permlane32_swap_b32 v84, v88
  v_permlane32_swap_b32 v85, v89
  v_permlane32_swap_b32 v86, v90
  v_permlane32_swap_b32 v87, v91
  v_add_f32 v84, v84, v88
  v_add_f32 v85, v85, v89
  v_add_f32 v86, v86, v90
  v_add_f32 v87, v87, v91
  s_nop 0
  v_permlane16_swap_b32 v84, v86
  v_permlane16_swap_b32 v85, v87
  v_add_f32 v84, v84, v86
  v_add_f32 v85, v85, v87
  ds_write_b64 v42, v[84:85]
  s_waitcnt lgkmcnt(0)
  s_barrier
  ds_read_b64 v[112:113], v43 offset:0
  ds_read_b64 v[114:115], v43 offset:512
  ds_read_b64 v[116:117], v43 offset:1024
  ds_read_b64 v[118:119], v43 offset:1536
  ds_read_b64 v[120:121], v43 offset:2048
  ds_read_b64 v[122:123], v43 offset:2560
  ds_read_b64 v[124:125], v43 offset:3072
  ds_read_b64 v[126:127], v43 offset:3584
  v_mov_b32 v20, 0
  v_mov_b32 v21, 0
  v_mov_b32 v22, 0
  v_mov_b32 v23, 0
  s_waitcnt lgkmcnt(0)
  v_add_f32 v112, v112, v114
  v_add_f32 v116, v116, v118
  v_add_f32 v120, v120, v122
  v_add_f32 v124, v124, v126
  v_add_f32 v112, v112, v116
  v_add_f32 v120, v120, v124
  v_add_f32 v112, v112, v120
  v_add_f32 v113, v113, v115
  v_add_f32 v117, v117, v119
  v_add_f32 v121, v121, v123
  v_add_f32 v125, v125, v127
  v_add_f32 v113, v113, v117
  v_add_f32 v121, v121, v125
  v_add_f32 v113, v113, v121
  v_cvt_pk_bf16_f32 v112, v112, v113
  ds_write_b32 v44, v112
  ds_read_b128 v[28:31], v45
  ds_read_b128 v[32:35], v45 offset:128
  s_waitcnt lgkmcnt(0)
  v_dot2c_f32_bf16 v20, v28, v52
  v_dot2c_f32_bf16 v21, v32, v56
  v_dot2c_f32_bf16 v22, v28, v60
  v_dot2c_f32_bf16 v23, v32, v64
  v_dot2c_f32_bf16 v20, v29, v53
  v_dot2c_f32_bf16 v21, v33, v57
  v_dot2c_f32_bf16 v22, v29, v61
  v_dot2c_f32_bf16 v23, v33, v65
  v_dot2c_f32_bf16 v20, v30, v54
  v_dot2c_f32_bf16 v21, v34, v58
  v_dot2c_f32_bf16 v22, v30, v62
  v_dot2c_f32_bf16 v23, v34, v66
  v_dot2c_f32_bf16 v20, v31, v55
  v_dot2c_f32_bf16 v21, v35, v59
  v_dot2c_f32_bf16 v22, v31, v63
  v_dot2c_f32_bf16 v23, v35, v67
  s_nop 0
  v_add_f32 v20, v20, v21
  s_nop 0
  v_add_f32 v22, v22, v23
  v_add_f32_dpp v20, v20, v20 quad_perm:[1,0,3,2] row_mask:0xf bank_mask:0xf
  s_nop 0
  v_add_f32_dpp v22, v22, v22 quad_perm:[1,0,3,2] row_mask:0xf bank_mask:0xf
  v_add_f32_dpp v20, v20, v20 quad_perm:[2,3,0,1] row_mask:0xf bank_mask:0xf
  s_nop 0
  v_add_f32_dpp v22, v22, v22 quad_perm:[2,3,0,1] row_mask:0xf bank_mask:0xf
  v_add_f32_dpp v20, v20, v20 row_half_mirror row_mask:0xf bank_mask:0xf
  s_nop 0
  v_add_f32_dpp v22, v22, v22 row_half_mirror row_mask:0xf bank_mask:0xf
  v_mul_f32 v20, 0x3e0293ee, v20
  v_mul_f32 v22, 0x3e0293ee, v22
  v_cvt_pk_bf16_f32 v20, v20, v20
  v_cvt_pk_bf16_f32 v22, v22, v22
  ds_write_b16 v46, v20
  ds_write_b16 v47, v22
  s_waitcnt lgkmcnt(0)
  s_barrier
  s_cmp_lg_u32 s3, 0
  s_cbranch_scc1 L_nopub
  s_mov_b32 exec_lo, 0xffffff
  s_mov_b32 exec_hi, 0x0
  ds_read_b128 v[52:55], v48
  s_waitcnt lgkmcnt(0)
  v_mov_b32 v55, s4
  buffer_store_dwordx4 v[52:55], v49, s[8:11], s40 offen sc1
  s_mov_b64 exec, -1
L_nopub:
  s_barrier
  s_cmp_ge_u32 s3, 4
  s_cbranch_scc1 L_loader
L_front:
  v_lshlrev_b32 v69, 4, v2
  v_add_u32 v69, 131072, v69
  v_add_u32 v70, 16384, v69
  v_add_u32 v71, 32768, v69
  v_and_b32 v72, 31, v1
  s_lshl_b32 s53, s3, 15
  v_lshlrev_b32 v73, 10, v72
  v_add_u32 v73, s53, v73
  v_and_b32 v74, 3, v72
  v_lshlrev_b32 v74, 2, v74
  v_bfe_u32 v75, v72, 2, 2
  v_or_b32 v74, v74, v75
  v_lshrrev_b32 v75, 5, v1
  v_xor_b32 v74, v74, v75
  v_xor_b32 v75, 0, v74
  v_lshl_add_u32 v4, v75, 4, v73
  v_xor_b32 v75, 2, v74
  v_lshl_add_u32 v5, v75, 4, v73
  v_xor_b32 v75, 4, v74
  v_lshl_add_u32 v6, v75, 4, v73
  v_xor_b32 v75, 6, v74
  v_lshl_add_u32 v7, v75, 4, v73
  v_xor_b32 v75, 8, v74
  v_lshl_add_u32 v8, v75, 4, v73
  v_xor_b32 v75, 10, v74
  v_lshl_add_u32 v9, v75, 4, v73
  v_xor_b32 v75, 12, v74
  v_lshl_add_u32 v10, v75, 4, v73
  v_xor_b32 v75, 14, v74
  v_lshl_add_u32 v11, v75, 4, v73
  v_lshlrev_b32 v67, 4, v1
  v_add_u32 v73, 131072, v67
  v_xor_b32 v12, 0, v73
  v_xor_b32 v13, 16, v73
  v_xor_b32 v14, 32, v73
  v_xor_b32 v15, 48, v73
  v_xor_b32 v16, 64, v73
  v_xor_b32 v17, 80, v73
  v_xor_b32 v18, 96, v73
  v_xor_b32 v19, 112, v73
  v_lshrrev_b32 v73, 5, v2
  v_and_b32 v74, 7, v2
  v_xor_b32 v73, v73, v74
  v_lshlrev_b32 v73, 4, v73
  v_lshl_add_u32 v68, v72, 10, v73
  v_add_u32 v68, 131072, v68
  v_lshlrev_b32 v63, 6, v72
  v_add_u32 v63, 131072, v63
  s_lshl_b32 s56, s3, 4
  v_add_u32 v64, s56, v63
  v_add_u32 v65, 133120, v67
  s_lshl_b32 s56, s3, 11
  v_add_u32 v66, s56, v65
  v_bfe_u32 v72, v1, 2, 2
  v_lshrrev_b32 v73, 5, v1
  v_lshl_add_u32 v74, v73, 2, v72
  v_lshlrev_b32 v74, 10, v74
  s_lshl_b32 s96, s3, 8
  v_add_u32 v74, s96, v74
  v_and_b32 v75, 1, v1
  v_lshl_add_u32 v74, v75, 3, v74
  v_lshlrev_b32 v72, 2, v72
  v_bfe_u32 v75, v1, 4, 1
  v_lshl_or_b32 v72, v75, 1, v72
  v_bfe_u32 v75, v1, 1, 1
  v_xor_b32 v75, v75, v73
  v_or_b32 v72, v72, v75
  v_xor_b32 v75, 0, v72
  v_lshl_add_u32 v20, v75, 4, v74
  v_xor_b32 v75, 2, v72
  v_lshl_add_u32 v21, v75, 4, v74
  v_add_u32 v21, 8192, v21
  v_xor_b32 v75, 4, v72
  v_lshl_add_u32 v22, v75, 4, v74
  v_xor_b32 v75, 6, v72
  v_lshl_add_u32 v23, v75, 4, v74
  v_add_u32 v23, 8192, v23
  v_xor_b32 v75, 8, v72
  v_lshl_add_u32 v24, v75, 4, v74
  v_xor_b32 v75, 10, v72
  v_lshl_add_u32 v25, v75, 4, v74
  v_add_u32 v25, 8192, v25
  v_xor_b32 v75, 12, v72
  v_lshl_add_u32 v26, v75, 4, v74
  v_xor_b32 v75, 14, v72
  v_lshl_add_u32 v27, v75, 4, v74
  v_add_u32 v27, 8192, v27
  v_and_b32 v72, 3, v1
  v_lshlrev_b32 v72, 6, v72
  v_bfe_u32 v74, v1, 2, 1
  v_lshl_add_u32 v72, v74, 5, v72
  v_bfe_u32 v74, v1, 1, 1
  v_lshl_add_u32 v72, v74, 4, v72
  v_lshl_add_u32 v62, v1, 10, v72
  v_add_u32 v62, s96, v62
  v_lshrrev_b32 v73, 3, v1
  v_and_b32 v72, 3, v73
  v_lshlrev_b32 v72, 6, v72
  v_bfe_u32 v74, v73, 2, 1
  v_lshl_add_u32 v72, v74, 5, v72
  v_bfe_u32 v74, v73, 1, 1
  v_lshl_add_u32 v72, v74, 4, v72
  v_lshl_add_u32 v61, v73, 10, v72
  v_add_u32 v61, s96, v61
  v_bfe_u32 v72, v1, 1, 2
  v_lshlrev_b32 v72, 6, v72
  v_and_b32 v74, 1, v1
  v_lshl_add_u32 v72, v74, 4, v72
  v_xor_b32 v61, v61, v72
  s_lshr_b32 s56, s2, 7
  s_lshl_b32 s56, s56, 3
  s_and_b32 s57, s2, 7
  s_add_u32 s56, s56, s57
  s_lshl_b32 s76, s56, 2
  s_add_u32 s76, s76, s3
  s_lshl_b32 s76, s76, 7
  s_add_u32 s76, s76, 196608
  s_add_u32 s77, s76, 16384
  s_mul_i32 s56, s2, 32896
  s_lshl_b32 s57, s3, 13
  s_add_u32 s56, s56, s57
  s_add_u32 s79, s56, 4194304
  s_add_u32 s80, s79, 4096
  v_mov_b32 v86, 0
  v_mov_b32 v87, s4
  v_mov_b32 v88, 1
  s_movk_i32 s57, 0x1000
  s_movk_i32 s58, 0x2000
  s_movk_i32 s59, 0x3000
L_hopb:
  s_setprio 2
  s_mov_b64 s[60:61], -1
  s_mov_b32 s100, 0
  s_branch L_gf_22
L_g_21:
  s_add_u32 s100, s100, 1
  s_cmp_gt_u32 s100, 1000000
  s_cbranch_scc1 L_abort
  s_sleep 4
L_gf_22:
  s_mov_b64 exec, s[60:61]
  buffer_load_dwordx4 v[184:187], v71, s[8:11], 0 offen offset:0 sc1
L_gc_23:
  s_waitcnt vmcnt(0)
  v_cmp_ne_u32 s[60:61], s4, v187
  s_nop 0
  s_cmp_lg_u64 s[60:61], 0
  s_cbranch_scc1 L_g_21
  s_mov_b64 exec, -1
  s_mov_b64 s[60:61], -1
  s_mov_b64 s[62:63], -1
  s_mov_b64 s[64:65], -1
  s_mov_b64 s[66:67], -1
  s_mov_b32 s100, 0
  s_branch L_gf_27
L_g_26:
  s_add_u32 s100, s100, 1
  s_cmp_gt_u32 s100, 1000000
  s_cbranch_scc1 L_abort
  s_sleep 1
L_gf_27:
  s_mov_b64 exec, s[60:61]
  s_cbranch_execz L_gs_29
  buffer_load_dwordx4 v[176:179], v69, s[8:11], 0 offen offset:0 sc1
  buffer_load_dwordx4 v[180:183], v70, s[8:11], 0 offen offset:0 sc1
  buffer_load_dwordx4 v[184:187], v71, s[8:11], 0 offen offset:0 sc1
L_gs_29:
  s_mov_b64 exec, s[62:63]
  s_cbranch_execz L_gs_30
  buffer_load_dwordx4 v[188:191], v69, s[8:11], s57 offen offset:0 sc1
  buffer_load_dwordx4 v[192:195], v70, s[8:11], s57 offen offset:0 sc1
  buffer_load_dwordx4 v[196:199], v71, s[8:11], s57 offen offset:0 sc1
L_gs_30:
  s_mov_b64 exec, s[64:65]
  s_cbranch_execz L_gs_31
  buffer_load_dwordx4 v[200:203], v69, s[8:11], s58 offen offset:0 sc1
  buffer_load_dwordx4 v[204:207], v70, s[8:11], s58 offen offset:0 sc1
  buffer_load_dwordx4 v[208:211], v71, s[8:11], s58 offen offset:0 sc1
L_gs_31:
  s_mov_b64 exec, s[66:67]
  s_cbranch_execz L_gs_32
  buffer_load_dwordx4 v[212:215], v69, s[8:11], s59 offen offset:0 sc1
  buffer_load_dwordx4 v[216:219], v70, s[8:11], s59 offen offset:0 sc1
  buffer_load_dwordx4 v[220:223], v71, s[8:11], s59 offen offset:0 sc1
L_gs_32:
L_gc_28:
  s_waitcnt vmcnt(0)
  s_mov_b64 exec, s[60:61]
  s_cbranch_execz L_gk_33
  v_cmp_ne_u32 s[60:61], s4, v179
  v_cmp_ne_u32 vcc, s4, v183
  s_nop 0
  s_or_b64 s[60:61], s[60:61], vcc
  v_cmp_ne_u32 vcc, s4, v187
  s_nop 0
  s_or_b64 s[60:61], s[60:61], vcc
L_gk_33:
  s_mov_b64 exec, s[62:63]
  s_cbranch_execz L_gk_34
  v_cmp_ne_u32 s[62:63], s4, v191
  v_cmp_ne_u32 vcc, s4, v195
  s_nop 0
  s_or_b64 s[62:63], s[62:63], vcc
  v_cmp_ne_u32 vcc, s4, v199
  s_nop 0
  s_or_b64 s[62:63], s[62:63], vcc
L_gk_34:
  s_mov_b64 exec, s[64:65]
  s_cbranch_execz L_gk_35
  v_cmp_ne_u32 s[64:65], s4, v203
  v_cmp_ne_u32 vcc, s4, v207
  s_nop 0
  s_or_b64 s[64:65], s[64:65], vcc
  v_cmp_ne_u32 vcc, s4, v211
  s_nop 0
  s_or_b64 s[64:65], s[64:65], vcc
L_gk_35:
  s_mov_b64 exec, s[66:67]
  s_cbranch_execz L_gk_36
  v_cmp_ne_u32 s[66:67], s4, v215
  v_cmp_ne_u32 vcc, s4, v219
  s_nop 0
  s_or_b64 s[66:67], s[66:67], vcc
  v_cmp_ne_u32 vcc, s4, v223
  s_nop 0
  s_or_b64 s[66:67], s[66:67], vcc
L_gk_36:
  s_or_b64 s[54:55], s[60:61], s[62:63]
  s_or_b64 s[54:55], s[54:55], s[64:65]
  s_or_b64 s[54:55], s[54:55], s[66:67]
  s_cbranch_scc1 L_g_26
  s_mov_b64 exec, -1
  s_cmp_lt_u32 s2, 128
  s_cbranch_scc1 L_noinbox
  s_lshl_b32 s53, s3, 5
  s_add_u32 s53, s53, 131072
  v_mov_b32 v72, s53
  s_mov_b32 s100, 0
L_inbox_37:
  ds_read_b32 v73, v72
  s_add_u32 s100, s100, 1
  s_cmp_gt_u32 s100, 4000000
  s_cbranch_scc1 L_abort
  s_waitcnt lgkmcnt(0)
  v_cmp_ne_u32 vcc, s4, v73
  s_nop 0
  s_cbranch_vccnz L_inbox_37
L_noinbox:
  v_mov_b32 v179, v184
  v_mov_b32 v183, v185
  ds_write_b128 v68, v[176:179] offset:0
  ds_write_b128 v68, v[180:183] offset:512
  v_mov_b32 v191, v196
  v_mov_b32 v195, v197
  ds_write_b128 v68, v[188:191] offset:128
  ds_write_b128 v68, v[192:195] offset:640
  v_mov_b32 v203, v208
  v_mov_b32 v207, v209
  ds_write_b128 v68, v[200:203] offset:256
  ds_write_b128 v68, v[204:207] offset:768
  v_mov_b32 v215, v220
  v_mov_b32 v219, v221
  ds_write_b128 v68, v[212:215] offset:384
  ds_write_b128 v68, v[216:219] offset:896
  s_waitcnt lgkmcnt(0)
  s_barrier
  ds_read_b128 v[112:115], v4 offset:0
  ds_read_b128 v[116:119], v12 offset:0
  ds_read_b128 v[120:123], v5 offset:0
  ds_read_b128 v[124:127], v13 offset:1024
  ds_read_b128 v[128:131], v6 offset:0
  ds_read_b128 v[132:135], v14 offset:2048
  ds_read_b128 v[136:139], v7 offset:0
  ds_read_b128 v[140:143], v15 offset:3072
  ds_read_b128 v[144:147], v8 offset:0
  ds_read_b128 v[148:151], v16 offset:4096
  ds_read_b128 v[152:155], v9 offset:0
  ds_read_b128 v[156:159], v17 offset:5120
  s_waitcnt lgkmcnt(10)
  v_mfma_f32_32x32x16_bf16 v[96:111], v[112:115], v[116:119], 0
  ds_read_b128 v[160:163], v10 offset:0
  ds_read_b128 v[164:167], v18 offset:6144
  s_waitcnt lgkmcnt(10)
  v_mfma_f32_32x32x16_bf16 v[96:111], v[120:123], v[124:127], v[96:111]
  ds_read_b128 v[168:171], v11 offset:0
  ds_read_b128 v[172:175], v19 offset:7168
  s_waitcnt lgkmcnt(10)
  v_mfma_f32_32x32x16_bf16 v[96:111], v[128:131], v[132:135], v[96:111]
  ds_read_b128 v[112:115], v4 offset:256
  ds_read_b128 v[116:119], v12 offset:8192
  s_waitcnt lgkmcnt(10)
  v_mfma_f32_32x32x16_bf16 v[96:111], v[136:139], v[140:143], v[96:111]
  ds_read_b128 v[120:123], v5 offset:256
  ds_read_b128 v[124:127], v13 offset:9216
  s_waitcnt lgkmcnt(10)
  v_mfma_f32_32x32x16_bf16 v[96:111], v[144:147], v[148:151], v[96:111]
  ds_read_b128 v[128:131], v6 offset:256
  ds_read_b128 v[132:135], v14 offset:10240
  s_waitcnt lgkmcnt(10)
  v_mfma_f32_32x32x16_bf16 v[96:111], v[152:155], v[156:159], v[96:111]
  ds_read_b128 v[136:139], v7 offset:256
  ds_read_b128 v[140:143], v15 offset:11264
  s_waitcnt lgkmcnt(10)
  v_mfma_f32_32x32x16_bf16 v[96:111], v[160:163], v[164:167], v[96:111]
  ds_read_b128 v[144:147], v8 offset:256
  ds_read_b128 v[148:151], v16 offset:12288
  s_waitcnt lgkmcnt(10)
  v_mfma_f32_32x32x16_bf16 v[96:111], v[168:171], v[172:175], v[96:111]
  ds_read_b128 v[152:155], v9 offset:256
  ds_read_b128 v[156:159], v17 offset:13312
  s_waitcnt lgkmcnt(10)
  v_mfma_f32_32x32x16_bf16 v[96:111], v[112:115], v[116:119], v[96:111]
  ds_read_b128 v[160:163], v10 offset:256
  ds_read_b128 v[164:167], v18 offset:14336
  s_waitcnt lgkmcnt(10)
  v_mfma_f32_32x32x16_bf16 v[96:111], v[120:123], v[124:127], v[96:111]
  ds_read_b128 v[168:171], v11 offset:256
  ds_read_b128 v[172:175], v19 offset:15360
  s_waitcnt lgkmcnt(10)
  v_mfma_f32_32x32x16_bf16 v[96:111], v[128:131], v[132:135], v[96:111]
  ds_read_b128 v[112:115], v4 offset:512
  ds_read_b128 v[116:119], v12 offset:16384
  s_waitcnt lgkmcnt(10)
  v_mfma_f32_32x32x16_bf16 v[96:111], v[136:139], v[140:143], v[96:111]
  ds_read_b128 v[120:123], v5 offset:512
  ds_read_b128 v[124:127], v13 offset:17408
  s_waitcnt lgkmcnt(10)
  v_mfma_f32_32x32x16_bf16 v[96:111], v[144:147], v[148:151], v[96:111]
  ds_read_b128 v[128:131], v6 offset:512
  ds_read_b128 v[132:135], v14 offset:18432
  s_barrier
  s_waitcnt lgkmcnt(10)
  v_mfma_f32_32x32x16_bf16 v[96:111], v[152:155], v[156:159], v[96:111]
  ds_read_b128 v[136:139], v7 offset:512
  ds_read_b128 v[140:143], v15 offset:19456
  s_waitcnt lgkmcnt(10)
  v_mfma_f32_32x32x16_bf16 v[96:111], v[160:163], v[164:167], v[96:111]
  ds_read_b128 v[144:147], v8 offset:512
  ds_read_b128 v[148:151], v16 offset:20480
  s_waitcnt lgkmcnt(10)
  v_mfma_f32_32x32x16_bf16 v[96:111], v[168:171], v[172:175], v[96:111]
  ds_read_b128 v[152:155], v9 offset:512
  ds_read_b128 v[156:159], v17 offset:21504
  s_waitcnt lgkmcnt(10)
  v_mfma_f32_32x32x16_bf16 v[96:111], v[112:115], v[116:119], v[96:111]
  ds_read_b128 v[160:163], v10 offset:512
  ds_read_b128 v[164:167], v18 offset:22528
  s_waitcnt lgkmcnt(10)
  v_mfma_f32_32x32x16_bf16 v[96:111], v[120:123], v[124:127], v[96:111]
  ds_read_b128 v[168:171], v11 offset:512
  ds_read_b128 v[172:175], v19 offset:23552
  s_waitcnt lgkmcnt(10)
  v_mfma_f32_32x32x16_bf16 v[96:111], v[128:131], v[132:135], v[96:111]
  ds_read_b128 v[112:115], v4 offset:768
  ds_read_b128 v[116:119], v12 offset:24576
  s_waitcnt lgkmcnt(10)
  v_mfma_f32_32x32x16_bf16 v[96:111], v[136:139], v[140:143], v[96:111]
  ds_read_b128 v[120:123], v5 offset:768
  ds_read_b128 v[124:127], v13 offset:25600
  s_waitcnt lgkmcnt(10)
  v_mfma_f32_32x32x16_bf16 v[96:111], v[144:147], v[148:151], v[96:111]
  ds_read_b128 v[128:131], v6 offset:768
  ds_read_b128 v[132:135], v14 offset:26624
  s_waitcnt lgkmcnt(10)
  v_mfma_f32_32x32x16_bf16 v[96:111], v[152:155], v[156:159], v[96:111]
  ds_read_b128 v[136:139], v7 offset:768
  ds_read_b128 v[140:143], v15 offset:27648
  s_waitcnt lgkmcnt(10)
  v_mfma_f32_32x32x16_bf16 v[96:111], v[160:163], v[164:167], v[96:111]
  ds_read_b128 v[144:147], v8 offset:768
  ds_read_b128 v[148:151], v16 offset:28672
  s_waitcnt lgkmcnt(10)
  v_mfma_f32_32x32x16_bf16 v[96:111], v[168:171], v[172:175], v[96:111]
  ds_read_b128 v[152:155], v9 offset:768
  ds_read_b128 v[156:159], v17 offset:29696
  s_waitcnt lgkmcnt(10)
  v_mfma_f32_32x32x16_bf16 v[96:111], v[112:115], v[116:119], v[96:111]
  ds_read_b128 v[160:163], v10 offset:768
  ds_read_b128 v[164:167], v18 offset:30720
  s_waitcnt lgkmcnt(10)
  v_mfma_f32_32x32x16_bf16 v[96:111], v[120:123], v[124:127], v[96:111]
  ds_read_b128 v[168:171], v11 offset:768
  ds_read_b128 v[172:175], v19 offset:31744
  s_waitcnt lgkmcnt(10)
  v_mfma_f32_32x32x16_bf16 v[96:111], v[128:131], v[132:135], v[96:111]
  s_waitcnt lgkmcnt(8)
  v_mfma_f32_32x32x16_bf16 v[96:111], v[136:139], v[140:143], v[96:111]
  s_waitcnt lgkmcnt(6)
  v_mfma_f32_32x32x16_bf16 v[96:111], v[144:147], v[148:151], v[96:111]
  s_waitcnt lgkmcnt(4)
  v_mfma_f32_32x32x16_bf16 v[96:111], v[152:155], v[156:159], v[96:111]
  s_waitcnt lgkmcnt(2)
  v_mfma_f32_32x32x16_bf16 v[96:111], v[160:163], v[164:167], v[96:111]
  s_waitcnt lgkmcnt(0)
  v_mfma_f32_32x32x16_bf16 v[96:111], v[168:171], v[172:175], v[96:111]
  ds_read_b64_tr_b16 v[4:5], v20 offset:0
  ds_read_b64_tr_b16 v[6:7], v21 offset:0
  ds_read_b64_tr_b16 v[8:9], v20 offset:16384
  ds_read_b64_tr_b16 v[10:11], v21 offset:16384
  ds_read_b64_tr_b16 v[12:13], v20 offset:32768
  ds_read_b64_tr_b16 v[14:15], v21 offset:32768
  ds_read_b64_tr_b16 v[16:17], v20 offset:49152
  ds_read_b64_tr_b16 v[18:19], v21 offset:49152
  s_nop 3
  v_max3_f32 v72, v96, v97, v98
  v_max3_f32 v73, v99, v100, v101
  v_max3_f32 v72, v72, v102, v103
  v_max3_f32 v73, v73, v104, v105
  v_max3_f32 v72, v72, v106, v107
  v_max3_f32 v73, v73, v108, v109
  v_max3_f32 v72, v72, v110, v111
  v_max_f32 v72, v72, v73
  v_mov_b32 v73, v72
  s_nop 1
  v_permlane32_swap_b32 v72, v73
  v_max_f32 v72, v72, v73
  v_ceil_f32 v72, v72
  v_mov_b32 v74, s4
  v_mov_b32 v75, s4
  v_sub_f32 v96, v96, v72
  v_sub_f32 v97, v97, v72
  v_sub_f32 v98, v98, v72
  v_sub_f32 v99, v99, v72
  v_sub_f32 v100, v100, v72
  v_sub_f32 v101, v101, v72
  v_sub_f32 v102, v102, v72
  v_sub_f32 v103, v103, v72
  v_sub_f32 v104, v104, v72
  v_sub_f32 v105, v105, v72
  v_sub_f32 v106, v106, v72
  v_sub_f32 v107, v107, v72
  v_sub_f32 v108, v108, v72
  v_sub_f32 v109, v109, v72
  v_sub_f32 v110, v110, v72
  v_sub_f32 v111, v111, v72
  v_exp_f32 v96, v96
  v_exp_f32 v97, v97
  v_exp_f32 v98, v98
  v_exp_f32 v99, v99
  v_exp_f32 v100, v100
  v_exp_f32 v101, v101
  v_exp_f32 v102, v102
  v_exp_f32 v103, v103
  v_exp_f32 v104, v104
  v_exp_f32 v105, v105
  v_exp_f32 v106, v106
  v_exp_f32 v107, v107
  v_exp_f32 v108, v108
  v_exp_f32 v109, v109
  v_exp_f32 v110, v110
  v_exp_f32 v111, v111
  v_cvt_pk_bf16_f32 v156, v96, v97
  v_cvt_pk_bf16_f32 v157, v98, v99
  v_cvt_pk_bf16_f32 v158, v100, v101
  v_cvt_pk_bf16_f32 v159, v102, v103
  v_cvt_pk_bf16_f32 v160, v104, v105
  v_cvt_pk_bf16_f32 v161, v106, v107
  v_cvt_pk_bf16_f32 v162, v108, v109
  v_cvt_pk_bf16_f32 v163, v110, v111
  ds_write_b128 v66, v[156:159]
  ds_write_b128 v66, v[160:163] offset:1024
  v_add_f32 v96, v96, v97
  v_add_f32 v98, v98, v99
  v_add_f32 v100, v100, v101
  v_add_f32 v102, v102, v103
  v_add_f32 v104, v104, v105
  v_add_f32 v106, v106, v107
  v_add_f32 v108, v108, v109
  v_add_f32 v110, v110, v111
  v_add_f32 v96, v96, v98
  v_add_f32 v100, v100, v102
  v_add_f32 v104, v104, v106
  v_add_f32 v108, v108, v110
  v_add_f32 v96, v96, v100
  v_add_f32 v104, v104, v108
  v_add_f32 v96, v96, v104
  v_mov_b32 v73, v96
  s_nop 1
  v_permlane32_swap_b32 v96, v73
  v_add_f32 v73, v96, v73
  ds_write_b128 v64, v[72:75]
  s_mov_b32 s100, 0
L_ms_38:
  ds_read_b128 v[112:115], v63 offset:0
  ds_read_b128 v[116:119], v63 offset:16
  ds_read_b128 v[120:123], v63 offset:32
  ds_read_b128 v[124:127], v63 offset:48
  ds_read_b128 v[156:159], v65 offset:0
  ds_read_b128 v[160:163], v65 offset:1024
  ds_read_b128 v[164:167], v65 offset:2048
  ds_read_b128 v[168:171], v65 offset:3072
  s_add_u32 s100, s100, 1
  s_cmp_gt_u32 s100, 4000000
  s_cbranch_scc1 L_abort
  s_waitcnt lgkmcnt(4)
  v_xor_b32 v114, v114, v118
  v_xor_b32 v122, v122, v126
  v_xor_b32 v118, s4, v118
  v_xor_b32 v126, s4, v126
  v_or3_b32 v114, v114, v118, v122
  v_or_b32 v114, v114, v126
  v_cmp_ne_u32 vcc, 0, v114
  s_nop 0
  s_cbranch_vccnz L_ms_38
  ds_read_b128 v[172:175], v65 offset:4096
  ds_read_b128 v[176:179], v65 offset:5120
  ds_read_b128 v[180:183], v65 offset:6144
  ds_read_b128 v[184:187], v65 offset:7168
  v_add_u32 v20, 0x10000, v20
  ds_read_b64_tr_b16 v[96:97], v20 offset:0
  v_add_u32 v21, 0x10000, v21
  ds_read_b64_tr_b16 v[98:99], v21 offset:0
  ds_read_b64_tr_b16 v[100:101], v20 offset:16384
  ds_read_b64_tr_b16 v[102:103], v21 offset:16384
  v_max3_f32 v72, v112, v116, v120
  v_max_f32 v72, v72, v124
  v_mov_b32 v73, 0x437f0000
  s_mov_b32 s56, 0x800080
  v_sub_f32 v76, v72, v112
  v_sub_f32 v77, v72, v116
  v_sub_f32 v78, v72, v120
  v_sub_f32 v79, v72, v124
  v_min_f32 v76, v76, v73
  v_min_f32 v77, v77, v73
  v_min_f32 v78, v78, v73
  v_min_f32 v79, v79, v73
  v_cvt_u32_f32 v76, v76
  v_cvt_u32_f32 v77, v77
  v_cvt_u32_f32 v78, v78
  v_cvt_u32_f32 v79, v79
  v_mul_u32_u24 v76, s56, v76
  v_mul_u32_u24 v77, s56, v77
  v_mul_u32_u24 v78, s56, v78
  v_mul_u32_u24 v79, s56, v79
  s_waitcnt lgkmcnt(11)
  v_pk_sub_u16 v156, v156, v76 clamp
  v_pk_sub_u16 v157, v157, v76 clamp
  v_pk_sub_u16 v158, v158, v76 clamp
  v_pk_sub_u16 v159, v159, v76 clamp
  s_waitcnt lgkmcnt(10)
  v_pk_sub_u16 v160, v160, v76 clamp
  v_pk_sub_u16 v161, v161, v76 clamp
  v_pk_sub_u16 v162, v162, v76 clamp
  v_pk_sub_u16 v163, v163, v76 clamp
  v_mfma_f32_32x32x16_bf16 v[188:203], v[4:7], v[156:159], 0
  ds_read_b64_tr_b16 v[104:105], v20 offset:32768
  ds_read_b64_tr_b16 v[106:107], v21 offset:32768
  s_waitcnt lgkmcnt(11)
  v_pk_sub_u16 v164, v164, v77 clamp
  v_pk_sub_u16 v165, v165, v77 clamp
  v_pk_sub_u16 v166, v166, v77 clamp
  v_pk_sub_u16 v167, v167, v77 clamp
  v_mfma_f32_32x32x16_bf16 v[188:203], v[8:11], v[160:163], v[188:203]
  ds_read_b64_tr_b16 v[108:109], v20 offset:49152
  ds_read_b64_tr_b16 v[110:111], v21 offset:49152
  s_waitcnt lgkmcnt(12)
  v_pk_sub_u16 v168, v168, v77 clamp
  v_pk_sub_u16 v169, v169, v77 clamp
  v_pk_sub_u16 v170, v170, v77 clamp
  v_pk_sub_u16 v171, v171, v77 clamp
  v_mfma_f32_32x32x16_bf16 v[188:203], v[12:15], v[164:167], v[188:203]
  ds_read_b64_tr_b16 v[4:5], v22 offset:0
  ds_read_b64_tr_b16 v[6:7], v23 offset:0
  s_waitcnt lgkmcnt(13)
  v_pk_sub_u16 v172, v172, v78 clamp
  v_pk_sub_u16 v173, v173, v78 clamp
  v_pk_sub_u16 v174, v174, v78 clamp
  v_pk_sub_u16 v175, v175, v78 clamp
  v_mfma_f32_32x32x16_bf16 v[188:203], v[16:19], v[168:171], v[188:203]
  ds_read_b64_tr_b16 v[8:9], v22 offset:16384
  ds_read_b64_tr_b16 v[10:11], v23 offset:16384
  s_waitcnt lgkmcnt(14)
  v_pk_sub_u16 v176, v176, v78 clamp
  v_pk_sub_u16 v177, v177, v78 clamp
  v_pk_sub_u16 v178, v178, v78 clamp
  v_pk_sub_u16 v179, v179, v78 clamp
  s_waitcnt lgkmcnt(10)
  v_mfma_f32_32x32x16_bf16 v[188:203], v[96:99], v[172:175], v[188:203]
  ds_read_b64_tr_b16 v[12:13], v22 offset:32768
  ds_read_b64_tr_b16 v[14:15], v23 offset:32768
  v_pk_sub_u16 v180, v180, v79 clamp
  v_pk_sub_u16 v181, v181, v79 clamp
  v_pk_sub_u16 v182, v182, v79 clamp
  v_pk_sub_u16 v183, v183, v79 clamp
  s_waitcnt lgkmcnt(10)
  v_mfma_f32_32x32x16_bf16 v[188:203], v[100:103], v[176:179], v[188:203]
  ds_read_b64_tr_b16 v[16:17], v22 offset:49152
  ds_read_b64_tr_b16 v[18:19], v23 offset:49152
  v_pk_sub_u16 v184, v184, v79 clamp
  v_pk_sub_u16 v185, v185, v79 clamp
  v_pk_sub_u16 v186, v186, v79 clamp
  v_pk_sub_u16 v187, v187, v79 clamp
  s_waitcnt lgkmcnt(10)
  v_mfma_f32_32x32x16_bf16 v[188:203], v[104:107], v[180:183], v[188:203]
  v_add_u32 v22, 0x10000, v22
  ds_read_b64_tr_b16 v[96:97], v22 offset:0
  v_add_u32 v23, 0x10000, v23
  ds_read_b64_tr_b16 v[98:99], v23 offset:0
  s_waitcnt lgkmcnt(10)
  v_mfma_f32_32x32x16_bf16 v[188:203], v[108:111], v[184:187], v[188:203]
  ds_read_b64_tr_b16 v[100:101], v22 offset:16384
  ds_read_b64_tr_b16 v[102:103], v23 offset:16384
  s_waitcnt lgkmcnt(10)
  v_mfma_f32_32x32x16_bf16 v[204:219], v[4:7], v[156:159], 0
  ds_read_b64_tr_b16 v[104:105], v22 offset:32768
  ds_read_b64_tr_b16 v[106:107], v23 offset:32768
  s_waitcnt lgkmcnt(10)
  v_mfma_f32_32x32x16_bf16 v[204:219], v[8:11], v[160:163], v[204:219]
  ds_read_b64_tr_b16 v[108:109], v22 offset:49152
  ds_read_b64_tr_b16 v[110:111], v23 offset:49152
  s_waitcnt lgkmcnt(10)
  v_mfma_f32_32x32x16_bf16 v[204:219], v[12:15], v[164:167], v[204:219]
  ds_read_b64_tr_b16 v[4:5], v24 offset:0
  ds_read_b64_tr_b16 v[6:7], v25 offset:0
  s_waitcnt lgkmcnt(10)
  v_mfma_f32_32x32x16_bf16 v[204:219], v[16:19], v[168:171], v[204:219]
  ds_read_b64_tr_b16 v[8:9], v24 offset:16384
  ds_read_b64_tr_b16 v[10:11], v25 offset:16384
  v_cvt_pk_bf16_f32 v112, v188, v189
  v_cvt_pk_bf16_f32 v113, v190, v191
  v_cvt_pk_bf16_f32 v114, v192, v193
  v_cvt_pk_bf16_f32 v115, v194, v195
  v_xor_b32 v74, 0, v62
  ds_write_b128 v74, v[112:115]
  s_waitcnt lgkmcnt(11)
  v_mfma_f32_32x32x16_bf16 v[204:219], v[96:99], v[172:175], v[204:219]
  ds_read_b64_tr_b16 v[12:13], v24 offset:32768
  ds_read_b64_tr_b16 v[14:15], v25 offset:32768
  s_waitcnt lgkmcnt(11)
  v_mfma_f32_32x32x16_bf16 v[204:219], v[100:103], v[176:179], v[204:219]
  ds_read_b64_tr_b16 v[16:17], v24 offset:49152
  ds_read_b64_tr_b16 v[18:19], v25 offset:49152
  v_cvt_pk_bf16_f32 v116, v196, v197
  v_cvt_pk_bf16_f32 v117, v198, v199
  v_cvt_pk_bf16_f32 v118, v200, v201
  v_cvt_pk_bf16_f32 v119, v202, v203
  v_xor_b32 v75, 16, v62
  ds_write_b128 v75, v[116:119]
  s_waitcnt lgkmcnt(12)
  v_mfma_f32_32x32x16_bf16 v[204:219], v[104:107], v[180:183], v[204:219]
  v_add_u32 v24, 0x10000, v24
  ds_read_b64_tr_b16 v[96:97], v24 offset:0
  v_add_u32 v25, 0x10000, v25
  ds_read_b64_tr_b16 v[98:99], v25 offset:0
  s_waitcnt lgkmcnt(12)
  v_mfma_f32_32x32x16_bf16 v[204:219], v[108:111], v[184:187], v[204:219]
  ds_read_b64_tr_b16 v[100:101], v24 offset:16384
  ds_read_b64_tr_b16 v[102:103], v25 offset:16384
  s_waitcnt lgkmcnt(12)
  v_mfma_f32_32x32x16_bf16 v[220:235], v[4:7], v[156:159], 0
  ds_read_b64_tr_b16 v[104:105], v24 offset:32768
  ds_read_b64_tr_b16 v[106:107], v25 offset:32768
  s_waitcnt lgkmcnt(12)
  v_mfma_f32_32x32x16_bf16 v[220:235], v[8:11], v[160:163], v[220:235]
  ds_read_b64_tr_b16 v[108:109], v24 offset:49152
  ds_read_b64_tr_b16 v[110:111], v25 offset:49152
  s_waitcnt lgkmcnt(11)
  v_mfma_f32_32x32x16_bf16 v[220:235], v[12:15], v[164:167], v[220:235]
  ds_read_b64_tr_b16 v[4:5], v26 offset:0
  ds_read_b64_tr_b16 v[6:7], v27 offset:0
  s_waitcnt lgkmcnt(11)
  v_mfma_f32_32x32x16_bf16 v[220:235], v[16:19], v[168:171], v[220:235]
  ds_read_b64_tr_b16 v[8:9], v26 offset:16384
  ds_read_b64_tr_b16 v[10:11], v27 offset:16384
  v_cvt_pk_bf16_f32 v120, v204, v205
  v_cvt_pk_bf16_f32 v121, v206, v207
  v_cvt_pk_bf16_f32 v122, v208, v209
  v_cvt_pk_bf16_f32 v123, v210, v211
  v_xor_b32 v74, 64, v62
  ds_write_b128 v74, v[120:123]
  s_waitcnt lgkmcnt(11)
  v_mfma_f32_32x32x16_bf16 v[220:235], v[96:99], v[172:175], v[220:235]
  ds_read_b64_tr_b16 v[12:13], v26 offset:32768
  ds_read_b64_tr_b16 v[14:15], v27 offset:32768
  s_waitcnt lgkmcnt(11)
  v_mfma_f32_32x32x16_bf16 v[220:235], v[100:103], v[176:179], v[220:235]
  ds_read_b64_tr_b16 v[16:17], v26 offset:49152
  ds_read_b64_tr_b16 v[18:19], v27 offset:49152
  v_cvt_pk_bf16_f32 v124, v212, v213
  v_cvt_pk_bf16_f32 v125, v214, v215
  v_cvt_pk_bf16_f32 v126, v216, v217
  v_cvt_pk_bf16_f32 v127, v218, v219
  v_xor_b32 v75, 80, v62
  ds_write_b128 v75, v[124:127]
  s_waitcnt lgkmcnt(12)
  v_mfma_f32_32x32x16_bf16 v[220:235], v[104:107], v[180:183], v[220:235]
  v_add_u32 v26, 0x10000, v26
  ds_read_b64_tr_b16 v[96:97], v26 offset:0
  v_add_u32 v27, 0x10000, v27
  ds_read_b64_tr_b16 v[98:99], v27 offset:0
  s_waitcnt lgkmcnt(12)
  v_mfma_f32_32x32x16_bf16 v[220:235], v[108:111], v[184:187], v[220:235]
  ds_read_b64_tr_b16 v[100:101], v26 offset:16384
  ds_read_b64_tr_b16 v[102:103], v27 offset:16384
  s_waitcnt lgkmcnt(12)
  v_mfma_f32_32x32x16_bf16 v[236:251], v[4:7], v[156:159], 0
  ds_read_b64_tr_b16 v[104:105], v26 offset:32768
  ds_read_b64_tr_b16 v[106:107], v27 offset:32768
  s_waitcnt lgkmcnt(12)
  v_mfma_f32_32x32x16_bf16 v[236:251], v[8:11], v[160:163], v[236:251]
  ds_read_b64_tr_b16 v[108:109], v26 offset:49152
  ds_read_b64_tr_b16 v[110:111], v27 offset:49152
  s_waitcnt lgkmcnt(11)
  v_mfma_f32_32x32x16_bf16 v[236:251], v[12:15], v[164:167], v[236:251]
  s_waitcnt lgkmcnt(9)
  v_mfma_f32_32x32x16_bf16 v[236:251], v[16:19], v[168:171], v[236:251]
  v_cvt_pk_bf16_f32 v128, v220, v221
  v_cvt_pk_bf16_f32 v129, v222, v223
  v_cvt_pk_bf16_f32 v130, v224, v225
  v_cvt_pk_bf16_f32 v131, v226, v227
  v_xor_b32 v74, 128, v62
  ds_write_b128 v74, v[128:131]
  s_waitcnt lgkmcnt(7)
  v_mfma_f32_32x32x16_bf16 v[236:251], v[96:99], v[172:175], v[236:251]
  s_waitcnt lgkmcnt(5)
  v_mfma_f32_32x32x16_bf16 v[236:251], v[100:103], v[176:179], v[236:251]
  v_cvt_pk_bf16_f32 v132, v228, v229
  v_cvt_pk_bf16_f32 v133, v230, v231
  v_cvt_pk_bf16_f32 v134, v232, v233
  v_cvt_pk_bf16_f32 v135, v234, v235
  v_xor_b32 v75, 144, v62
  ds_write_b128 v75, v[132:135]
  s_waitcnt lgkmcnt(4)
  v_mfma_f32_32x32x16_bf16 v[236:251], v[104:107], v[180:183], v[236:251]
  s_waitcnt lgkmcnt(2)
  v_mfma_f32_32x32x16_bf16 v[236:251], v[108:111], v[184:187], v[236:251]
  s_nop 11
  v_cvt_pk_bf16_f32 v136, v236, v237
  v_cvt_pk_bf16_f32 v137, v238, v239
  v_cvt_pk_bf16_f32 v138, v240, v241
  v_cvt_pk_bf16_f32 v139, v242, v243
  v_xor_b32 v74, 192, v62
  ds_write_b128 v74, v[136:139]
  v_cvt_pk_bf16_f32 v140, v244, v245
  v_cvt_pk_bf16_f32 v141, v246, v247
  v_cvt_pk_bf16_f32 v142, v248, v249
  v_cvt_pk_bf16_f32 v143, v250, v251
  v_xor_b32 v75, 208, v62
  ds_write_b128 v75, v[140:143]
  ds_read_b128 v[188:191], v61 offset:0
  ds_read_b128 v[192:195], v61 offset:8192
  ds_read_b128 v[196:199], v61 offset:16384
  ds_read_b128 v[200:203], v61 offset:24576
  ds_read_b128 v[204:207], v61 offset:32768
  ds_read_b128 v[208:211], v61 offset:40960
  ds_read_b128 v[212:215], v61 offset:49152
  ds_read_b128 v[216:219], v61 offset:57344
  s_waitcnt lgkmcnt(7)
  buffer_store_dwordx4 v[188:191], v67, s[8:11], s79 offen offset:0 sc1
  s_waitcnt lgkmcnt(6)
  buffer_store_dwordx4 v[192:195], v67, s[8:11], s79 offen offset:1024 sc1
  s_waitcnt lgkmcnt(5)
  buffer_store_dwordx4 v[196:199], v67, s[8:11], s79 offen offset:2048 sc1
  s_waitcnt lgkmcnt(4)
  buffer_store_dwordx4 v[200:203], v67, s[8:11], s79 offen offset:3072 sc1
  s_waitcnt lgkmcnt(3)
  buffer_store_dwordx4 v[204:207], v67, s[8:11], s80 offen offset:0 sc1
  s_waitcnt lgkmcnt(2)
  buffer_store_dwordx4 v[208:211], v67, s[8:11], s80 offen offset:1024 sc1
  s_waitcnt lgkmcnt(1)
  buffer_store_dwordx4 v[212:215], v67, s[8:11], s80 offen offset:2048 sc1
  s_waitcnt lgkmcnt(0)
  buffer_store_dwordx4 v[216:219], v67, s[8:11], s80 offen offset:3072 sc1
  s_mov_b64 exec, 1
  s_waitcnt vmcnt(0)
  buffer_atomic_add v88, v86, s[8:11], s76 offen sc0 sc1
  s_waitcnt vmcnt(0)
  v_cmp_eq_u32 vcc, 15, v88
  s_nop 0
  s_cbranch_vccz L_notlast
  buffer_store_dword v87, v86, s[8:11], s77 offen sc1
L_notlast:
  s_mov_b64 exec, -1
  s_setprio 0
  s_cmp_lt_u32 s2, 128
  s_cbranch_scc1 L_fin
  s_load_dwordx2 s[20:21], s[0:1], 96
  s_mov_b32 s22, 0x400
  s_mov_b32 s23, 0x20000
  v_and_b32 v5, 3, v1
  v_lshrrev_b32 v6, 4, v1
  v_and_b32 v7, 15, v1
  v_lshrrev_b32 v9, 5, v1
  v_and_b32 v10, 31, v1
  v_lshrrev_b32 v11, 3, v1
  v_and_b32 v12, 7, v1
  v_bfe_u32 v13, v1, 3, 2
  v_lshlrev_b32 v25, 4, v1
  v_lshlrev_b32 v24, 4, v12
  v_lshlrev_b32 v14, 4, v0
  s_lshl_b32 s56, s42, 13
  s_add_u32 s56, s56, 1048576
  v_add_u32 v14, s56, v14
  v_lshlrev_b32 v15, 7, v12
  v_lshl_add_u32 v15, v6, 5, v15
  s_lshl_b32 s56, s3, 2
  s_add_u32 s56, s56, 147584
  v_add_u32 v15, s56, v15
  s_mov_b32 s88, 131072
  s_lshl_b32 s53, s3, 7
  s_add_u32 s53, s53, 145536
  v_lshlrev_b32 v16, 5, v10
  v_add_u32 v16, 147584, v16
  v_lshlrev_b32 v17, 1, v10
  v_add_u32 v20, s53, v17
  v_lshlrev_b32 v21, 5, v9
  v_add_u32 v21, s53, v21
  s_lshl_b32 s56, s43, 2
  s_add_u32 s56, s56, s3
  s_lshl_b32 s56, s56, 6
  s_add_u32 s56, s56, s42
  s_lshl_b32 s56, s56, 7
  s_add_u32 s56, s56, 1310720
  v_lshl_add_u32 v19, v13, 11, v24
  v_add_u32 v19, s56, v19
  s_lshl_b32 s94, s42, 6
  buffer_load_dwordx4 v[144:147], v14, s[8:11], 0 offen offset:0 sc1
  buffer_load_dwordx4 v[148:151], v14, s[8:11], s88 offen offset:0 sc1
  s_barrier
  s_barrier
  s_mov_b64 s[60:61], -1
  s_mov_b32 s100, 0
  s_branch L_gf_40
L_g_39:
  s_add_u32 s100, s100, 1
  s_cmp_gt_u32 s100, 1000000
  s_cbranch_scc1 L_abort
L_gf_40:
  s_mov_b64 exec, s[60:61]
  buffer_load_dwordx4 v[144:147], v14, s[8:11], 0 offen offset:0 sc1
L_gc_41:
  s_waitcnt vmcnt(0)
  v_perm_b32 v94, v145, v144, s50
  v_perm_b32 v94, v146, v94, s51
  v_perm_b32 v94, v147, v94, s52
  v_cmp_ne_u32 s[60:61], s4, v94
  s_nop 0
  s_cmp_lg_u64 s[60:61], 0
  s_cbranch_scc1 L_g_39
  s_mov_b64 exec, -1
  v_and_b32 v144, v3, v144
  v_and_b32 v145, v3, v145
  v_and_b32 v146, v3, v146
  v_and_b32 v147, v3, v147
  s_nop 0
  v_permlane32_swap_b32 v144, v146
  v_permlane32_swap_b32 v145, v147
  v_add_f32 v144, v144, v146
  v_add_f32 v145, v145, v147
  s_nop 1
  v_permlane16_swap_b32 v144, v145
  v_add_f32 v144, v144, v145
  s_nop 1
  v_add_f32_dpp v144, v144, v144 row_ror:8 row_mask:0xf bank_mask:0xf
  ds_write_b32 v15, v144 offset:0
  s_waitcnt lgkmcnt(0)
  s_barrier
  ds_read_b128 v[144:147], v16 offset:0
  ds_read_b128 v[148:151], v16 offset:16
  s_waitcnt lgkmcnt(0)
  v_add_f32 v144, v144, v145
  v_add_f32 v146, v146, v147
  v_add_f32 v148, v148, v149
  v_add_f32 v150, v150, v151
  v_add_f32 v144, v144, v146
  v_add_f32 v148, v148, v150
  v_add_f32 v144, v144, v148
  v_cvt_pk_bf16_f32 v94, v144, v144
  v_and_b32 v144, 0xffff0000, v94
  v_mul_f32 v18, v90, v144
  v_cvt_pk_bf16_f32 v94, v18, v18
  v_and_b32 v18, 0xffff0000, v94
  v_add_f32 v18, v89, v18
  v_cvt_pk_bf16_f32 v94, v18, v18
  v_and_b32 v18, 0xffff0000, v94
  v_mul_f32 v94, v18, v92
  v_cvt_pk_bf16_f32 v94, v94, v94
  ds_write_b16 v20, v94
  ds_read_b128 v[96:99], v21
  ds_read_b128 v[104:107], v21 offset:16
  v_mov_b32 v100, 0
  v_mov_b32 v101, 0
  v_mov_b32 v102, 0
  v_mov_b32 v103, 0
  v_mov_b32 v152, v18
  v_mul_f32 v153, v18, v18
  s_nop 0
  v_add_f32_dpp v152, v152, v152 row_ror:8 row_mask:0xf bank_mask:0xf
  v_add_f32_dpp v153, v153, v153 row_ror:8 row_mask:0xf bank_mask:0xf
  s_nop 0
  v_add_f32_dpp v152, v152, v152 row_ror:4 row_mask:0xf bank_mask:0xf
  v_add_f32_dpp v153, v153, v153 row_ror:4 row_mask:0xf bank_mask:0xf
  s_nop 0
  v_add_f32_dpp v152, v152, v152 row_ror:2 row_mask:0xf bank_mask:0xf
  v_add_f32_dpp v153, v153, v153 row_ror:2 row_mask:0xf bank_mask:0xf
  s_nop 0
  v_add_f32_dpp v152, v152, v152 row_ror:1 row_mask:0xf bank_mask:0xf
  v_add_f32_dpp v153, v153, v153 row_ror:1 row_mask:0xf bank_mask:0xf
  v_mov_b32 v154, v152
  v_mov_b32 v155, v153
  s_nop 0
  v_permlane16_swap_b32 v152, v154
  v_permlane16_swap_b32 v153, v155
  v_add_f32 v152, v152, v154
  v_add_f32 v153, v153, v155
  v_and_b32 v154, v3, v152
  v_and_b32 v155, v3, v153
  v_sub_f32 v152, v152, v154
  v_sub_f32 v153, v153, v155
  s_waitcnt lgkmcnt(1)
  v_dot2c_f32_bf16 v100, v96, v60
  v_dot2c_f32_bf16 v101, v96, v28
  v_dot2c_f32_bf16 v102, v96, v30
  v_dot2c_f32_bf16 v103, v96, v29
  v_dot2c_f32_bf16 v100, v97, v31
  v_dot2c_f32_bf16 v101, v97, v32
  v_dot2c_f32_bf16 v102, v97, v34
  v_dot2c_f32_bf16 v103, v97, v33
  v_dot2c_f32_bf16 v100, v98, v35
  v_dot2c_f32_bf16 v101, v98, v36
  v_dot2c_f32_bf16 v102, v98, v38
  v_dot2c_f32_bf16 v103, v98, v37
  v_dot2c_f32_bf16 v100, v99, v39
  v_dot2c_f32_bf16 v101, v99, v40
  v_dot2c_f32_bf16 v102, v99, v42
  v_dot2c_f32_bf16 v103, v99, v41
  s_waitcnt lgkmcnt(0)
  v_dot2c_f32_bf16 v100, v104, v43
  v_dot2c_f32_bf16 v101, v104, v44
  v_dot2c_f32_bf16 v102, v104, v46
  v_dot2c_f32_bf16 v103, v104, v45
  v_dot2c_f32_bf16 v100, v105, v47
  v_dot2c_f32_bf16 v101, v105, v48
  v_dot2c_f32_bf16 v102, v105, v50
  v_dot2c_f32_bf16 v103, v105, v49
  v_dot2c_f32_bf16 v100, v106, v51
  v_dot2c_f32_bf16 v101, v106, v52
  v_dot2c_f32_bf16 v102, v106, v54
  v_dot2c_f32_bf16 v103, v106, v53
  v_dot2c_f32_bf16 v100, v107, v55
  v_dot2c_f32_bf16 v101, v107, v56
  v_dot2c_f32_bf16 v102, v107, v58
  v_dot2c_f32_bf16 v103, v107, v57
  v_mov_b32 v108, v100
  v_mov_b32 v109, v101
  v_mov_b32 v110, v102
  v_mov_b32 v111, v103
  v_permlane32_swap_b32 v100, v108
  v_permlane32_swap_b32 v101, v109
  v_permlane32_swap_b32 v102, v110
  v_permlane32_swap_b32 v103, v111
  v_add_f32 v100, v100, v108
  v_add_f32 v101, v101, v109
  v_add_f32 v102, v102, v110
  v_add_f32 v103, v103, v111
  s_mov_b32 exec_lo, 0x8080808
  s_mov_b32 exec_hi, 0x0
  v_mov_b32 v102, v154
  v_mov_b32 v103, v155
  s_mov_b32 exec_lo, 0x80808080
  v_mov_b32 v102, v152
  v_mov_b32 v103, v153
  s_mov_b32 exec_lo, -1
  v_and_or_b32 v100, v100, v3, s44
  v_and_or_b32 v101, v101, v3, s45
  v_and_or_b32 v102, v102, v3, s46
  v_and_or_b32 v103, v103, v3, s47
  buffer_store_dwordx4 v[100:103], v19, s[8:11], 0 offen sc1
  s_mov_b64 exec, -1
  s_cmp_lg_u32 s43, 0
  s_cbranch_scc1 L_fin
  s_barrier
  s_mov_b64 s[60:61], -1
  s_mov_b32 s100, 0
  s_branch L_gf_45
L_g_44:
  s_add_u32 s100, s100, 1
  s_cmp_gt_u32 s100, 1000000
  s_cbranch_scc1 L_abort
L_gf_45:
  s_mov_b64 exec, s[60:61]
  buffer_load_dwordx4 v[144:147], v14, s[8:11], s88 offen offset:0 sc1
L_gc_46:
  s_waitcnt vmcnt(0)
  v_perm_b32 v94, v145, v144, s50
  v_perm_b32 v94, v146, v94, s51
  v_perm_b32 v94, v147, v94, s52
  v_cmp_ne_u32 s[60:61], s4, v94
  s_nop 0
  s_cmp_lg_u64 s[60:61], 0
  s_cbranch_scc1 L_g_44
  s_mov_b64 exec, -1
  v_and_b32 v144, v3, v144
  v_and_b32 v145, v3, v145
  v_and_b32 v146, v3, v146
  v_and_b32 v147, v3, v147
  s_nop 0
  v_permlane32_swap_b32 v144, v146
  v_permlane32_swap_b32 v145, v147
  v_add_f32 v144, v144, v146
  v_add_f32 v145, v145, v147
  s_nop 1
  v_permlane16_swap_b32 v144, v145
  v_add_f32 v144, v144, v145
  s_nop 1
  v_add_f32_dpp v144, v144, v144 row_ror:8 row_mask:0xf bank_mask:0xf
  ds_write_b32 v15, v144 offset:1024
  s_waitcnt lgkmcnt(0)
  s_barrier
  ds_read_b128 v[144:147], v16 offset:1024
  ds_read_b128 v[148:151], v16 offset:1040
  s_waitcnt lgkmcnt(0)
  v_add_f32 v144, v144, v145
  v_add_f32 v146, v146, v147
  v_add_f32 v148, v148, v149
  v_add_f32 v150, v150, v151
  v_add_f32 v144, v144, v146
  v_add_f32 v148, v148, v150
  v_add_f32 v144, v144, v148
  v_cvt_pk_bf16_f32 v94, v144, v144
  v_and_b32 v144, 0xffff0000, v94
  v_mul_f32 v144, v93, v144
  v_cvt_pk_bf16_f32 v94, v144, v144
  v_and_b32 v144, 0xffff0000, v94
  v_add_f32 v144, v18, v144
  v_cvt_pk_bf16_f32 v144, v144, v144
  s_cmp_lg_u32 s3, 0
  s_cbranch_scc1 L_fin
  s_mov_b32 exec_hi, 0
  buffer_store_short v144, v17, s[20:23], s94 offen
  s_load_dwordx2 s[60:61], s[0:1], 104
  s_cmp_lg_u32 s2, 128
  s_cbranch_scc1 L_noep
  s_mov_b64 exec, 1
  s_waitcnt lgkmcnt(0)
  global_store_dword v86, v86, s[60:61]
L_noep:
L_fin:
  s_endpgm
L_back:
  s_load_dwordx2 s[32:33], s[0:1], 32
  s_mov_b32 s34, 0x400000
  s_mov_b32 s35, 0x20000
  s_load_dwordx2 s[24:25], s[0:1], 40
  s_mov_b32 s26, 0x400000
  s_mov_b32 s27, 0x20000
  s_load_dwordx2 s[28:29], s[0:1], 72
  s_mov_b32 s30, 0x1c0000
  s_mov_b32 s31, 0x20000
  s_and_b32 s42, s2, 7
  s_lshl_b32 s42, s42, 1
  s_bfe_u32 s56, s2, 0x10003
  s_add_u32 s42, s42, s56
  s_bfe_u32 s43, s2, 0x30004
  v_and_b32 v5, 3, v1
  v_lshrrev_b32 v6, 4, v1
  v_and_b32 v7, 15, v1
  v_lshrrev_b32 v9, 5, v1
  v_and_b32 v10, 31, v1
  v_lshrrev_b32 v11, 3, v1
  v_and_b32 v12, 7, v1
  v_bfe_u32 v13, v1, 3, 2
  v_lshlrev_b32 v25, 4, v1
  v_lshlrev_b32 v24, 4, v12
  v_lshlrev_b32 v14, 4, v0
  s_lshl_b32 s56, s42, 13
  s_add_u32 s56, s56, 1048576
  v_add_u32 v14, s56, v14
  v_lshlrev_b32 v15, 7, v12
  v_lshl_add_u32 v15, v6, 5, v15
  s_lshl_b32 s56, s3, 2
  s_add_u32 s56, s56, 147584
  v_add_u32 v15, s56, v15
  s_mov_b32 s88, 131072
  s_lshl_b32 s53, s3, 7
  s_add_u32 s53, s53, 145536
  s_lshr_b32 s41, s2, 5
  v_lshlrev_b32 v20, 1, v10
  v_add_u32 v20, s53, v20
  v_lshlrev_b32 v21, 4, v6
  v_add_u32 v21, s53, v21
  v_lshlrev_b32 v23, 1, v1
  v_add_u32 v23, s53, v23
  v_lshlrev_b32 v26, 5, v6
  v_add_u32 v26, s53, v26
  v_bfe_u32 v4, v1, 3, 1
  v_lshlrev_b32 v22, 3, v5
  v_lshl_add_u32 v22, v6, 1, v22
  v_lshl_add_u32 v22, v4, 5, v22
  v_add_u32 v22, s53, v22
  v_lshlrev_b32 v90, 17, v6
  v_lshl_add_u32 v90, v7, 3, v90
  s_lshr_b32 s40, s41, 1
  s_lshl_b32 s40, s40, 20
  s_lshr_b32 s57, s93, 1
  s_lshl_b32 s57, s57, 19
  s_add_u32 s40, s40, s57
  s_and_b32 s57, s41, 1
  s_lshl_b32 s57, s57, 15
  s_add_u32 s40, s40, s57
  s_lshl_b32 s57, s7, 8
  s_add_u32 s40, s40, s57
  s_and_b32 s57, s93, 1
  s_lshl_b32 s57, s57, 7
  s_add_u32 s40, s40, s57
  s_mov_b32 s56, 263168
  v_mul_lo_u32 v47, s56, v11
  v_add_u32 v47, v47, v24
  s_mul_i32 s56, s93, 65792
  s_lshr_b32 s94, s41, 1
  s_lshl_b32 s94, s94, 13
  s_add_u32 s56, s56, s94
  s_and_b32 s94, s41, 1
  s_lshl_b32 s94, s94, 5
  s_add_u32 s94, s94, s7
  s_lshl_b32 s94, s94, 7
  s_add_u32 s56, s56, s94
  s_add_u32 s56, s56, 4194304
  v_add_u32 v47, s56, v47
  v_lshlrev_b32 v48, 4, v10
  v_lshl_add_u32 v48, v9, 11, v48
  s_lshl_b32 s56, s93, 9
  s_lshl_b32 s94, s7, 12
  s_add_u32 s56, s56, s94
  s_add_u32 s56, s56, 262144
  v_add_u32 v48, s56, v48
  v_and_b32 v53, 1, v1
  v_lshlrev_b32 v53, 9, v53
  v_bfe_u32 v4, v1, 1, 1
  v_lshl_add_u32 v53, v4, 12, v53
  s_lshl_b32 s56, s93, 10
  s_lshr_b32 s94, s41, 1
  s_lshl_b32 s94, s94, 7
  s_add_u32 s56, s56, s94
  s_add_u32 s56, s56, 212992
  v_add_u32 v53, s56, v53
  v_lshlrev_b32 v49, 7, v12
  v_lshl_add_u32 v49, v6, 5, v49
  s_lshl_b32 s56, s93, 2
  v_mov_b32 v51, 145408
  v_add_u32 v52, s56, v51
  s_add_u32 s94, s56, 143360
  v_add_u32 v49, s94, v49
  v_lshlrev_b32 v56, 6, v7
  v_lshl_add_u32 v56, v6, 4, v56
  s_add_u32 s94, s56, 146560
  v_add_u32 v56, s94, v56
  v_add_u32 v77, 146560, v25
  s_lshr_b32 s56, s93, 1
  s_lshl_b32 s56, s56, 9
  s_add_u32 s56, s56, 143360
  v_lshlrev_b32 v50, 4, v10
  v_add_u32 v50, s56, v50
  s_lshl_b32 s56, s93, 8
  s_add_u32 s56, s56, 144384
  v_lshlrev_b32 v54, 5, v12
  v_lshl_add_u32 v54, v11, 2, v54
  v_add_u32 v54, s56, v54
  v_lshlrev_b32 v55, 5, v11
  v_add_u32 v55, s56, v55
  s_lshl_b32 s96, s7, 13
  s_and_b32 s94, s93, 1
  s_lshl_b32 s94, s94, 12
  s_add_u32 s96, s96, s94
  s_lshl_b32 s94, s41, 9
  s_add_u32 s96, s96, s94
  s_lshr_b32 s94, s93, 1
  s_lshl_b32 s94, s94, 8
  s_add_u32 s96, s96, s94
  s_add_u32 s96, s96, 786432
  s_lshl_b32 s56, s7, 13
  s_lshr_b32 s57, s6, 1
  s_lshl_b32 s57, s57, 12
  s_add_u32 s56, s56, s57
  s_lshl_b32 s57, s93, 10
  s_add_u32 s56, s56, s57
  s_add_u32 s56, s56, 786432
  v_add_u32 v16, s56, v25
  s_and_b32 s58, s2, 63
  s_lshl_b32 s56, s58, 12
  s_add_u32 s56, s56, s57
  s_add_u32 s59, s56, 1310720
  v_add_u32 v18, s59, v25
  s_lshl_b32 s56, s56, 1
  s_add_u32 s56, s56, 1572864
  v_add_u32 v19, s56, v25
  v_lshl_add_u32 v17, v11, 13, v24
  s_lshl_b32 s56, s93, 14
  s_and_b32 s57, s6, 1
  s_lshl_b32 s84, s57, 16
  s_add_u32 s84, s84, s56
  s_lshl_b32 s59, s7, 8
  s_add_u32 s84, s84, s59
  s_lshr_b32 s59, s6, 1
  s_lshl_b32 s85, s59, 16
  s_lshl_b32 s59, s59, 7
  s_add_u32 s84, s84, s59
  s_add_u32 s84, s84, 1048576
  s_add_u32 s85, s85, s56
  s_lshl_b32 s59, s58, 7
  s_add_u32 s85, s85, s59
  s_add_u32 s85, s85, 1179648
  v_lshlrev_b32 v79, 5, v7
  v_lshl_add_u32 v79, v6, 3, v79
  v_and_b32 v78, 0xff, v79
  v_add_u32 v79, 149632, v79
  s_lshr_b32 s56, s93, 1
  s_lshl_b32 s56, s56, 8
  s_and_b32 s59, s93, 1
  s_lshl_b32 s59, s59, 2
  s_add_u32 s56, s56, s59
  s_add_u32 s56, s56, 149632
  v_add_u32 v78, s56, v78
  v_lshlrev_b32 v88, 14, v6
  v_lshl_add_u32 v88, v7, 3, v88
  v_mul_u32_u24 v89, 14336, v9
  v_and_b32 v4, 1, v6
  v_lshl_add_u32 v89, v4, 13, v89
  v_lshl_add_u32 v89, v7, 3, v89
  s_lshl_b32 s38, s7, 17
  s_lshr_b32 s56, s6, 1
  s_lshl_b32 s59, s56, 16
  s_add_u32 s38, s38, s59
  s_lshl_b32 s57, s57, 9
  s_add_u32 s38, s38, s57
  s_lshl_b32 s57, s93, 7
  s_add_u32 s38, s38, s57
  s_mul_i32 s39, s58, 28672
  s_lshl_b32 s56, s56, 9
  s_add_u32 s39, s39, s56
  s_add_u32 s39, s39, s57
  s_mov_b32 s76, 0
  s_mov_b32 s77, 2105344
  s_mov_b32 s78, 32896
  s_mov_b32 s79, 2138240
  s_mov_b32 s80, 4210688
  s_mov_b32 s81, 6316032
  s_mov_b32 s82, 4243584
  s_mov_b32 s83, 6348928
  s_waitcnt vmcnt(0) lgkmcnt(0)
  s_barrier
  s_add_u32 s57, s40, 0
  buffer_load_dwordx2 v[28:29], v90, s[32:35], s57 offen nt
  s_add_u32 s57, s40, 8192
  buffer_load_dwordx2 v[30:31], v90, s[32:35], s57 offen nt
  s_add_u32 s57, s40, 16384
  buffer_load_dwordx2 v[32:33], v90, s[32:35], s57 offen nt
  s_add_u32 s57, s40, 24576
  buffer_load_dwordx2 v[34:35], v90, s[32:35], s57 offen nt
  s_add_u32 s57, s40, 65536
  buffer_load_dwordx2 v[36:37], v90, s[32:35], s57 offen nt
  s_add_u32 s57, s40, 73728
  buffer_load_dwordx2 v[38:39], v90, s[32:35], s57 offen nt
  s_add_u32 s57, s40, 81920
  buffer_load_dwordx2 v[40:41], v90, s[32:35], s57 offen nt
  s_add_u32 s57, s40, 90112
  buffer_load_dwordx2 v[42:43], v90, s[32:35], s57 offen nt
  s_barrier
  s_cmp_lt_u32 s2, 128
  s_cbranch_scc1 L_now0
  buffer_load_dwordx2 v[160:161], v88, s[24:27], s38 offen offset:0 nt
  buffer_load_dwordx2 v[162:163], v88, s[24:27], s38 offen offset:1024 nt
  buffer_load_dwordx2 v[164:165], v88, s[24:27], s38 offen offset:2048 nt
  buffer_load_dwordx2 v[166:167], v88, s[24:27], s38 offen offset:3072 nt
  s_add_u32 s38, s38, 4096
  buffer_load_dwordx2 v[168:169], v88, s[24:27], s38 offen offset:0 nt
  buffer_load_dwordx2 v[170:171], v88, s[24:27], s38 offen offset:1024 nt
  buffer_load_dwordx2 v[172:173], v88, s[24:27], s38 offen offset:2048 nt
  buffer_load_dwordx2 v[174:175], v88, s[24:27], s38 offen offset:3072 nt
  s_add_u32 s38, s38, 4096
  buffer_load_dwordx2 v[176:177], v88, s[24:27], s38 offen offset:0 nt
  buffer_load_dwordx2 v[178:179], v88, s[24:27], s38 offen offset:1024 nt
  buffer_load_dwordx2 v[180:181], v88, s[24:27], s38 offen offset:2048 nt
  buffer_load_dwordx2 v[182:183], v88, s[24:27], s38 offen offset:3072 nt
  s_add_u32 s38, s38, 4096
  buffer_load_dwordx2 v[184:185], v88, s[24:27], s38 offen offset:0 nt
  buffer_load_dwordx2 v[186:187], v88, s[24:27], s38 offen offset:1024 nt
  buffer_load_dwordx2 v[188:189], v88, s[24:27], s38 offen offset:2048 nt
  buffer_load_dwordx2 v[190:191], v88, s[24:27], s38 offen offset:3072 nt
  buffer_load_dwordx2 v[60:61], v89, s[28:31], s39 offen offset:0 nt
  buffer_load_dwordx2 v[62:63], v89, s[28:31], s39 offen offset:1024 nt
  buffer_load_dwordx2 v[64:65], v89, s[28:31], s39 offen offset:2048 nt
  buffer_load_dwordx2 v[66:67], v89, s[28:31], s39 offen offset:3072 nt
  s_add_u32 s39, s39, 4096
  buffer_load_dwordx2 v[68:69], v89, s[28:31], s39 offen offset:0 nt
  buffer_load_dwordx2 v[70:71], v89, s[28:31], s39 offen offset:1024 nt
  buffer_load_dwordx2 v[72:73], v89, s[28:31], s39 offen offset:2048 nt
  buffer_load_dwordx2 v[74:75], v89, s[28:31], s39 offen offset:3072 nt
  buffer_load_dwordx4 v[236:239], v19, s[8:11], 0 offen offset:0 sc1
  buffer_load_dwordx4 v[240:243], v19, s[8:11], 0 offen offset:1024 sc1
  buffer_load_dwordx4 v[152:155], v16, s[8:11], 0 offen offset:0 sc1
  buffer_load_dwordx4 v[152:155], v18, s[8:11], 0 offen offset:0 sc1
  buffer_load_dwordx4 v[152:155], v14, s[8:11], 0 offen offset:0 sc1
  buffer_load_dwordx4 v[152:155], v14, s[8:11], s88 offen offset:0 sc1
L_now0:
  v_lshlrev_b32 v4, 12, v10
  v_lshlrev_b32 v8, 6, v10
  v_add_u32 v8, 131072, v8
  s_lshr_b32 s56, s2, 7
  s_lshl_b32 s56, s56, 3
  s_and_b32 s97, s2, 7
  s_add_u32 s56, s56, s97
  s_lshl_b32 s56, s56, 4
  s_bfe_u32 s97, s2, 0x40003
  s_add_u32 s56, s56, s97
  s_lshl_b32 s56, s56, 4
  s_add_u32 s56, s56, 262144
  s_mov_b32 s100, 0
L_ms_49:
  s_sleep 4
  ds_read_b128 v[112:115], v8 offset:0
  ds_read_b128 v[116:119], v8 offset:16
  ds_read_b128 v[120:123], v8 offset:32
  ds_read_b128 v[124:127], v8 offset:48
  s_add_u32 s100, s100, 1
  s_cmp_gt_u32 s100, 4000000
  s_cbranch_scc1 L_abort
  s_waitcnt lgkmcnt(0)
  v_xor_b32 v114, v114, v118
  v_xor_b32 v122, v122, v126
  v_xor_b32 v118, s4, v118
  v_xor_b32 v126, s4, v126
  v_or3_b32 v114, v114, v118, v122
  v_or_b32 v114, v114, v126
  v_cmp_ne_u32 vcc, 0, v114
  s_nop 0
  s_cbranch_vccnz L_ms_49
  v_max3_f32 v96, v112, v116, v120
  v_max_f32 v96, v96, v124
  v_sub_f32 v112, v112, v96
  v_sub_f32 v116, v116, v96
  v_sub_f32 v120, v120, v96
  v_sub_f32 v124, v124, v96
  v_exp_f32 v112, v112
  v_exp_f32 v116, v116
  v_exp_f32 v120, v120
  v_exp_f32 v124, v124
  v_mul_f32 v97, v112, v113
  v_fmac_f32 v97, v116, v117
  v_fmac_f32 v97, v120, v121
  v_fmac_f32 v97, v124, v125
  v_mov_b32 v98, 0
  v_mov_b32 v99, s4
  s_lshl_b32 s97, s93, 3
  s_lshl_b32 exec_lo, 0xff, s97
  s_mov_b32 exec_hi, 0
  buffer_store_dwordx4 v[96:99], v4, s[8:11], s56 offen sc1
  s_mov_b64 exec, -1
  s_waitcnt vmcnt(1)
  v_perm_b32 v44, v30, v28, s48
  v_perm_b32 v28, v30, v28, s49
  v_perm_b32 v30, v31, v29, s48
  v_perm_b32 v29, v31, v29, s49
  v_perm_b32 v31, v34, v32, s48
  v_perm_b32 v32, v34, v32, s49
  v_perm_b32 v34, v35, v33, s48
  v_perm_b32 v33, v35, v33, s49
  v_perm_b32 v35, v38, v36, s48
  v_perm_b32 v36, v38, v36, s49
  v_perm_b32 v38, v39, v37, s48
  v_perm_b32 v37, v39, v37, s49
  v_perm_b32 v39, v42, v40, s48
  v_perm_b32 v40, v42, v40, s49
  v_perm_b32 v42, v43, v41, s48
  v_perm_b32 v41, v43, v41, s49
  s_cmp_lt_u32 s2, 128
  s_cbranch_scc1 L_4a
  v_perm_b32 v192, v162, v160, s48
  v_perm_b32 v160, v162, v160, s49
  v_perm_b32 v162, v163, v161, s48
  v_perm_b32 v161, v163, v161, s49
  v_perm_b32 v163, v166, v164, s48
  v_perm_b32 v164, v166, v164, s49
  v_perm_b32 v166, v167, v165, s48
  v_perm_b32 v165, v167, v165, s49
  v_perm_b32 v167, v170, v168, s48
  v_perm_b32 v168, v170, v168, s49
  v_perm_b32 v170, v171, v169, s48
  v_perm_b32 v169, v171, v169, s49
  v_perm_b32 v171, v174, v172, s48
  v_perm_b32 v172, v174, v172, s49
  v_perm_b32 v174, v175, v173, s48
  v_perm_b32 v173, v175, v173, s49
  v_perm_b32 v175, v178, v176, s48
  v_perm_b32 v176, v178, v176, s49
  v_perm_b32 v178, v179, v177, s48
  v_perm_b32 v177, v179, v177, s49
  v_perm_b32 v179, v182, v180, s48
  v_perm_b32 v180, v182, v180, s49
  v_perm_b32 v182, v183, v181, s48
  v_perm_b32 v181, v183, v181, s49
  v_perm_b32 v183, v186, v184, s48
  v_perm_b32 v184, v186, v184, s49
  v_perm_b32 v186, v187, v185, s48
  v_perm_b32 v185, v187, v185, s49
  v_perm_b32 v187, v190, v188, s48
  v_perm_b32 v188, v190, v188, s49
  v_perm_b32 v190, v191, v189, s48
  v_perm_b32 v189, v191, v189, s49
  v_perm_b32 v76, v62, v60, s48
  v_perm_b32 v60, v62, v60, s49
  v_perm_b32 v62, v63, v61, s48
  v_perm_b32 v61, v63, v61, s49
  v_perm_b32 v63, v66, v64, s48
  v_perm_b32 v64, v66, v64, s49
  v_perm_b32 v66, v67, v65, s48
  v_perm_b32 v65, v67, v65, s49
  v_perm_b32 v67, v70, v68, s48
  v_perm_b32 v68, v70, v68, s49
  v_perm_b32 v70, v71, v69, s48
  v_perm_b32 v69, v71, v69, s49
  v_perm_b32 v71, v74, v72, s48
  v_perm_b32 v72, v74, v72, s49
  v_perm_b32 v74, v75, v73, s48
  v_perm_b32 v73, v75, v73, s49
  s_mov_b64 s[60:61], -1
  s_waitcnt vmcnt(1)
  s_mov_b32 s100, 0
  s_branch L_gc_52
L_g_50:
  s_add_u32 s100, s100, 1
  s_cmp_gt_u32 s100, 1000000
  s_cbranch_scc1 L_abort
  s_sleep 2
L_gf_51:
  s_mov_b64 exec, s[60:61]
  buffer_load_dwordx4 v[236:239], v19, s[8:11], 0 offen offset:0 sc1
  buffer_load_dwordx4 v[240:243], v19, s[8:11], 0 offen offset:1024 sc1
  s_waitcnt vmcnt(0)
L_gc_52:
  s_mov_b64 exec, s[60:61]
  v_perm_b32 v94, v237, v236, s50
  v_perm_b32 v94, v238, v94, s51
  v_perm_b32 v94, v239, v94, s52
  v_cmp_ne_u32 s[60:61], s4, v94
  v_perm_b32 v94, v241, v240, s50
  v_perm_b32 v94, v242, v94, s51
  v_perm_b32 v94, v243, v94, s52
  v_cmp_ne_u32 vcc, s4, v94
  s_nop 0
  s_or_b64 s[60:61], s[60:61], vcc
  s_cmp_lg_u64 s[60:61], 0
  s_cbranch_scc1 L_g_50
  s_mov_b64 exec, -1
  v_and_b32 v236, v3, v236
  v_and_b32 v237, v3, v237
  v_and_b32 v238, v3, v238
  v_and_b32 v239, v3, v239
  v_and_b32 v240, v3, v240
  v_and_b32 v241, v3, v241
  v_and_b32 v242, v3, v242
  v_and_b32 v243, v3, v243
  v_add_f32 v236, v236, v240
  v_add_f32 v237, v237, v241
  v_add_f32 v238, v238, v242
  v_add_f32 v239, v239, v243
  s_nop 0
  v_permlane32_swap_b32 v236, v238
  v_permlane32_swap_b32 v237, v239
  v_add_f32 v236, v236, v238
  v_add_f32 v237, v237, v239
  s_nop 1
  v_permlane16_swap_b32 v236, v237
  v_add_f32 v236, v236, v237
  v_bfe_u32 v94, v1, 3, 1
  v_lshl_add_u32 v94, v94, 9, v78
  ds_write_b32 v94, v236 offset:512
L_4a:
  s_mov_b64 s[94:95], 15
  s_mov_b32 s100, 0
L_fl:
  s_mov_b64 exec, s[94:95]
  s_mov_b32 s97, s94
  buffer_load_dword v57, v53, s[8:11], 0 offen sc1
  s_add_u32 s100, s100, 1
  s_cmp_gt_u32 s100, 1000000
  s_cbranch_scc1 L_abort
  s_waitcnt vmcnt(0)
  v_cmp_ne_u32 s[94:95], s4, v57
  s_nop 0
  s_xor_b32 s97, s97, s94
  s_cbranch_scc0 L_fl
  s_bitcmp1_b32 s97, 0
  s_cbranch_scc0 L_fq_55
  s_mov_b32 exec_lo, 0xffff
  s_mov_b32 exec_hi, 0x0
  buffer_load_dwordx4 v[96:99], v48, s[8:11], 0 offen sc1
  s_mov_b64 exec, -1
  buffer_load_dwordx4 v[112:115], v47, s[8:11], s76 offen offset:0 sc1
  buffer_load_dwordx4 v[116:119], v47, s[8:11], s77 offen offset:0 sc1
L_fq_55:
  s_bitcmp1_b32 s97, 1
  s_cbranch_scc0 L_fq_56
  s_mov_b32 exec_lo, 0xffff0000
  s_mov_b32 exec_hi, 0x0
  buffer_load_dwordx4 v[96:99], v48, s[8:11], 0 offen sc1
  s_mov_b64 exec, -1
  buffer_load_dwordx4 v[120:123], v47, s[8:11], s78 offen offset:0 sc1
  buffer_load_dwordx4 v[124:127], v47, s[8:11], s79 offen offset:0 sc1
L_fq_56:
  s_bitcmp1_b32 s97, 2
  s_cbranch_scc0 L_fq_57
  s_mov_b32 exec_lo, 0x0
  s_mov_b32 exec_hi, 0xffff
  buffer_load_dwordx4 v[96:99], v48, s[8:11], 0 offen sc1
  s_mov_b64 exec, -1
  buffer_load_dwordx4 v[128:131], v47, s[8:11], s80 offen offset:0 sc1
  buffer_load_dwordx4 v[132:135], v47, s[8:11], s81 offen offset:0 sc1
L_fq_57:
  s_bitcmp1_b32 s97, 3
  s_cbranch_scc0 L_fq_58
  s_mov_b32 exec_lo, 0x0
  s_mov_b32 exec_hi, 0xffff0000
  buffer_load_dwordx4 v[96:99], v48, s[8:11], 0 offen sc1
  s_mov_b64 exec, -1
  buffer_load_dwordx4 v[136:139], v47, s[8:11], s82 offen offset:0 sc1
  buffer_load_dwordx4 v[140:143], v47, s[8:11], s83 offen offset:0 sc1
L_fq_58:
  s_cmp_lg_u32 s94, 0
  s_cbranch_scc1 L_fl
  s_mov_b64 s[60:61], -1
  s_waitcnt vmcnt(2)
  s_mov_b32 s100, 0
  s_branch L_gc_61
L_g_59:
  s_add_u32 s100, s100, 1
  s_cmp_gt_u32 s100, 1000000
  s_cbranch_scc1 L_abort
  s_sleep 1
L_gf_60:
  s_mov_b64 exec, s[60:61]
  buffer_load_dwordx4 v[96:99], v48, s[8:11], 0 offen offset:0 sc1
  s_waitcnt vmcnt(0)
L_gc_61:
  s_mov_b64 exec, s[60:61]
  v_cmp_ne_u32 s[60:61], s4, v99
  s_nop 0
  s_cmp_lg_u64 s[60:61], 0
  s_cbranch_scc1 L_g_59
  s_mov_b64 exec, -1
  v_mov_b32 v57, v96
  s_nop 1
  v_max_f32_dpp v57, v57, v57 row_ror:8 row_mask:0xf bank_mask:0xf
  s_nop 1
  v_max_f32_dpp v57, v57, v57 row_ror:4 row_mask:0xf bank_mask:0xf
  s_nop 1
  v_max_f32_dpp v57, v57, v57 row_ror:2 row_mask:0xf bank_mask:0xf
  s_nop 1
  v_max_f32_dpp v57, v57, v57 row_ror:1 row_mask:0xf bank_mask:0xf
  v_mov_b32 v94, v57
  s_nop 1
  v_permlane16_swap_b32 v57, v94
  v_max_f32 v57, v57, v94
  v_mov_b32 v94, v57
  s_nop 1
  v_permlane32_swap_b32 v57, v94
  v_max_f32 v57, v57, v94
  v_sub_f32 v58, v96, v57
  v_exp_f32 v58, v58
  s_nop 0
  v_cvt_pk_bf16_f32 v94, v58, v58
  v_and_b32 v58, 0xffff0000, v94
  ds_write_b32 v54, v58
  ds_read_b128 v[80:83], v55
  ds_read_b128 v[84:87], v55 offset:16
  v_mul_f32 v59, v58, v97
  s_nop 1
  v_add_f32_dpp v59, v59, v59 row_ror:8 row_mask:0xf bank_mask:0xf
  s_nop 1
  v_add_f32_dpp v59, v59, v59 row_ror:4 row_mask:0xf bank_mask:0xf
  s_nop 1
  v_add_f32_dpp v59, v59, v59 row_ror:2 row_mask:0xf bank_mask:0xf
  s_nop 1
  v_add_f32_dpp v59, v59, v59 row_ror:1 row_mask:0xf bank_mask:0xf
  s_waitcnt lgkmcnt(0)
  v_lshrrev_b32 v228, 16, v80
  v_lshrrev_b32 v229, 16, v81
  v_lshrrev_b32 v230, 16, v82
  v_lshrrev_b32 v231, 16, v83
  v_lshrrev_b32 v232, 16, v84
  v_lshrrev_b32 v233, 16, v85
  v_lshrrev_b32 v234, 16, v86
  v_lshrrev_b32 v235, 16, v87
  v_mov_b32 v94, v59
  s_nop 1
  v_permlane16_swap_b32 v59, v94
  v_add_f32 v59, v59, v94
  v_mov_b32 v94, v59
  s_nop 1
  v_permlane32_swap_b32 v59, v94
  v_add_f32 v59, v59, v94
  ds_write2_b32 v52, v57, v59 offset0:0 offset1:4
  s_waitcnt vmcnt(0)
  v_mov_b32 v100, 0
  v_mov_b32 v101, 0
  v_mov_b32 v102, 0
  v_mov_b32 v103, 0
  v_mov_b32 v104, 0
  v_mov_b32 v105, 0
  v_mov_b32 v106, 0
  v_mov_b32 v107, 0
  v_dot2c_f32_bf16 v100, v228, v112
  v_dot2c_f32_bf16 v101, v80, v112
  v_dot2c_f32_bf16 v102, v228, v113
  v_dot2c_f32_bf16 v103, v80, v113
  v_dot2c_f32_bf16 v104, v228, v114
  v_dot2c_f32_bf16 v105, v80, v114
  v_dot2c_f32_bf16 v106, v228, v115
  v_dot2c_f32_bf16 v107, v80, v115
  v_dot2c_f32_bf16 v100, v229, v116
  v_dot2c_f32_bf16 v101, v81, v116
  v_dot2c_f32_bf16 v102, v229, v117
  v_dot2c_f32_bf16 v103, v81, v117
  v_dot2c_f32_bf16 v104, v229, v118
  v_dot2c_f32_bf16 v105, v81, v118
  v_dot2c_f32_bf16 v106, v229, v119
  v_dot2c_f32_bf16 v107, v81, v119
  v_dot2c_f32_bf16 v100, v230, v120
  v_dot2c_f32_bf16 v101, v82, v120
  v_dot2c_f32_bf16 v102, v230, v121
  v_dot2c_f32_bf16 v103, v82, v121
  v_dot2c_f32_bf16 v104, v230, v122
  v_dot2c_f32_bf16 v105, v82, v122
  v_dot2c_f32_bf16 v106, v230, v123
  v_dot2c_f32_bf16 v107, v82, v123
  v_dot2c_f32_bf16 v100, v231, v124
  v_dot2c_f32_bf16 v101, v83, v124
  v_dot2c_f32_bf16 v102, v231, v125
  v_dot2c_f32_bf16 v103, v83, v125
  v_dot2c_f32_bf16 v104, v231, v126
  v_dot2c_f32_bf16 v105, v83, v126
  v_dot2c_f32_bf16 v106, v231, v127
  v_dot2c_f32_bf16 v107, v83, v127
  v_dot2c_f32_bf16 v100, v232, v128
  v_dot2c_f32_bf16 v101, v84, v128
  v_dot2c_f32_bf16 v102, v232, v129
  v_dot2c_f32_bf16 v103, v84, v129
  v_dot2c_f32_bf16 v104, v232, v130
  v_dot2c_f32_bf16 v105, v84, v130
  v_dot2c_f32_bf16 v106, v232, v131
  v_dot2c_f32_bf16 v107, v84, v131
  v_dot2c_f32_bf16 v100, v233, v132
  v_dot2c_f32_bf16 v101, v85, v132
  v_dot2c_f32_bf16 v102, v233, v133
  v_dot2c_f32_bf16 v103, v85, v133
  v_dot2c_f32_bf16 v104, v233, v134
  v_dot2c_f32_bf16 v105, v85, v134
  v_dot2c_f32_bf16 v106, v233, v135
  v_dot2c_f32_bf16 v107, v85, v135
  v_dot2c_f32_bf16 v100, v234, v136
  v_dot2c_f32_bf16 v101, v86, v136
  v_dot2c_f32_bf16 v102, v234, v137
  v_dot2c_f32_bf16 v103, v86, v137
  v_dot2c_f32_bf16 v104, v234, v138
  v_dot2c_f32_bf16 v105, v86, v138
  v_dot2c_f32_bf16 v106, v234, v139
  v_dot2c_f32_bf16 v107, v86, v139
  v_dot2c_f32_bf16 v100, v235, v140
  v_dot2c_f32_bf16 v101, v87, v140
  v_dot2c_f32_bf16 v102, v235, v141
  v_dot2c_f32_bf16 v103, v87, v141
  v_dot2c_f32_bf16 v104, v235, v142
  v_dot2c_f32_bf16 v105, v87, v142
  v_dot2c_f32_bf16 v106, v235, v143
  v_dot2c_f32_bf16 v107, v87, v143
  v_permlane32_swap_b32 v100, v104
  v_permlane32_swap_b32 v101, v105
  v_permlane32_swap_b32 v102, v106
  v_permlane32_swap_b32 v103, v107
  v_add_f32 v100, v100, v104
  v_add_f32 v101, v101, v105
  v_add_f32 v102, v102, v106
  v_add_f32 v103, v103, v107
  s_nop 0
  v_permlane16_swap_b32 v100, v102
  v_permlane16_swap_b32 v101, v103
  v_add_f32 v100, v100, v102
  v_add_f32 v101, v101, v103
  s_nop 0
  v_add_f32_dpp v100, v100, v100 row_ror:8 row_mask:0xf bank_mask:0xf
  v_add_f32_dpp v101, v101, v101 row_ror:8 row_mask:0xf bank_mask:0xf
  ds_write2_b32 v49, v100, v101 offset0:0 offset1:4
  s_waitcnt lgkmcnt(0)
  s_barrier
  ds_read_b128 v[112:115], v51
  ds_read_b128 v[116:119], v51 offset:16
  ds_read_b128 v[100:103], v50
  s_waitcnt lgkmcnt(2)
  v_max3_f32 v94, v112, v113, v114
  v_max_f32 v94, v94, v115
  v_sub_f32 v112, v112, v94
  v_sub_f32 v113, v113, v94
  v_sub_f32 v114, v114, v94
  v_sub_f32 v115, v115, v94
  v_exp_f32 v112, v112
  v_exp_f32 v113, v113
  v_exp_f32 v114, v114
  v_exp_f32 v115, v115
  s_waitcnt lgkmcnt(0)
  v_mul_f32 v116, v112, v116
  v_mul_f32 v100, v112, v100
  v_fmac_f32 v116, v113, v117
  v_fmac_f32 v100, v113, v101
  v_fmac_f32 v116, v114, v118
  v_fmac_f32 v100, v114, v102
  v_fmac_f32 v116, v115, v119
  v_fmac_f32 v100, v115, v103
  v_rcp_f32 v116, v116
  s_nop 0
  v_mul_f32 v100, v100, v116
  v_cvt_pk_bf16_f32 v94, v100, v100
  ds_write_b16 v20, v94
  ds_read_b128 v[96:99], v21
  v_mov_b32 v100, 0
  v_mov_b32 v101, 0
  v_mov_b32 v102, 0
  v_mov_b32 v103, 0
  s_waitcnt lgkmcnt(0)
  v_dot2c_f32_bf16 v100, v96, v44
  v_dot2c_f32_bf16 v101, v96, v28
  v_dot2c_f32_bf16 v102, v96, v30
  v_dot2c_f32_bf16 v103, v96, v29
  v_dot2c_f32_bf16 v100, v97, v31
  v_dot2c_f32_bf16 v101, v97, v32
  v_dot2c_f32_bf16 v102, v97, v34
  v_dot2c_f32_bf16 v103, v97, v33
  v_dot2c_f32_bf16 v100, v98, v35
  v_dot2c_f32_bf16 v101, v98, v36
  v_dot2c_f32_bf16 v102, v98, v38
  v_dot2c_f32_bf16 v103, v98, v37
  v_dot2c_f32_bf16 v100, v99, v39
  v_dot2c_f32_bf16 v101, v99, v40
  v_dot2c_f32_bf16 v102, v99, v42
  v_dot2c_f32_bf16 v103, v99, v41
  v_mov_b32 v108, v100
  v_mov_b32 v109, v101
  v_mov_b32 v110, v102
  v_mov_b32 v111, v103
  v_permlane32_swap_b32 v100, v108
  v_permlane32_swap_b32 v101, v109
  v_permlane32_swap_b32 v102, v110
  v_permlane32_swap_b32 v103, v111
  v_add_f32 v100, v100, v108
  v_add_f32 v101, v101, v109
  v_add_f32 v102, v102, v110
  v_add_f32 v103, v103, v111
  v_mov_b32 v108, v100
  v_mov_b32 v109, v101
  v_mov_b32 v110, v102
  v_mov_b32 v111, v103
  v_permlane16_swap_b32 v100, v108
  v_permlane16_swap_b32 v101, v109
  v_permlane16_swap_b32 v102, v110
  v_permlane16_swap_b32 v103, v111
  v_add_f32 v100, v100, v108
  v_add_f32 v101, v101, v109
  v_add_f32 v102, v102, v110
  v_add_f32 v103, v103, v111
  v_and_or_b32 v100, v100, v3, s44
  v_and_or_b32 v101, v101, v3, s45
  v_and_or_b32 v102, v102, v3, s46
  v_and_or_b32 v103, v103, v3, s47
  s_mov_b64 exec, 0xffff
  buffer_store_dwordx4 v[100:103], v25, s[8:11], s96 offen sc1
  s_mov_b64 exec, -1
  s_cmp_lt_u32 s2, 128
  s_cbranch_scc1 L_fin
  ds_read_b64 v[236:237], v79 offset:512
  ds_read_b64 v[238:239], v79 offset:1024
  s_mov_b64 s[60:61], -1
  s_mov_b32 s100, 0
  s_branch L_gf_65
L_g_64:
  s_add_u32 s100, s100, 1
  s_cmp_gt_u32 s100, 1000000
  s_cbranch_scc1 L_abort
L_gf_65:
  s_mov_b64 exec, s[60:61]
  buffer_load_dwordx4 v[144:147], v16, s[8:11], 0 offen offset:0 sc1
L_gc_66:
  s_waitcnt vmcnt(0)
  v_perm_b32 v94, v145, v144, s50
  v_perm_b32 v94, v146, v94, s51
  v_perm_b32 v94, v147, v94, s52
  v_cmp_ne_u32 s[60:61], s4, v94
  s_nop 0
  s_cmp_lg_u64 s[60:61], 0
  s_cbranch_scc1 L_g_64
  s_mov_b64 exec, -1
  v_and_b32 v144, v3, v144
  v_and_b32 v145, v3, v145
  v_and_b32 v146, v3, v146
  v_and_b32 v147, v3, v147
  s_nop 0
  v_permlane32_swap_b32 v144, v146
  v_permlane32_swap_b32 v145, v147
  v_add_f32 v144, v144, v146
  v_add_f32 v145, v145, v147
  s_nop 1
  v_permlane16_swap_b32 v144, v145
  v_add_f32 v144, v144, v145
  ds_write_b32 v56, v144
  s_waitcnt lgkmcnt(0)
  s_barrier
  ds_read_b128 v[144:147], v77
  v_add_f32 v236, v236, v237
  v_add_f32 v238, v238, v239
  s_waitcnt lgkmcnt(0)
  v_add_f32 v144, v144, v145
  v_add_f32 v146, v146, v147
  v_add_f32 v144, v144, v146
  v_cvt_pk_bf16_f32 v94, v144, v144
  ds_write_b16 v23, v94
  ds_read_b128 v[96:99], v26
  ds_read_b128 v[104:107], v26 offset:16
  v_mov_b32 v100, 0
  v_mov_b32 v101, 0
  v_mov_b32 v102, 0
  v_mov_b32 v103, 0
  s_waitcnt lgkmcnt(1)
  v_dot2c_f32_bf16 v100, v96, v192
  v_dot2c_f32_bf16 v101, v96, v160
  v_dot2c_f32_bf16 v102, v96, v162
  v_dot2c_f32_bf16 v103, v96, v161
  v_dot2c_f32_bf16 v100, v97, v163
  v_dot2c_f32_bf16 v101, v97, v164
  v_dot2c_f32_bf16 v102, v97, v166
  v_dot2c_f32_bf16 v103, v97, v165
  v_dot2c_f32_bf16 v100, v98, v167
  v_dot2c_f32_bf16 v101, v98, v168
  v_dot2c_f32_bf16 v102, v98, v170
  v_dot2c_f32_bf16 v103, v98, v169
  v_dot2c_f32_bf16 v100, v99, v171
  v_dot2c_f32_bf16 v101, v99, v172
  v_dot2c_f32_bf16 v102, v99, v174
  v_dot2c_f32_bf16 v103, v99, v173
  s_waitcnt lgkmcnt(0)
  v_dot2c_f32_bf16 v100, v104, v175
  v_dot2c_f32_bf16 v101, v104, v176
  v_dot2c_f32_bf16 v102, v104, v178
  v_dot2c_f32_bf16 v103, v104, v177
  v_dot2c_f32_bf16 v100, v105, v179
  v_dot2c_f32_bf16 v101, v105, v180
  v_dot2c_f32_bf16 v102, v105, v182
  v_dot2c_f32_bf16 v103, v105, v181
  v_dot2c_f32_bf16 v100, v106, v183
  v_dot2c_f32_bf16 v101, v106, v184
  v_dot2c_f32_bf16 v102, v106, v186
  v_dot2c_f32_bf16 v103, v106, v185
  v_dot2c_f32_bf16 v100, v107, v187
  v_dot2c_f32_bf16 v101, v107, v188
  v_dot2c_f32_bf16 v102, v107, v190
  v_dot2c_f32_bf16 v103, v107, v189
  v_mov_b32 v108, v100
  v_mov_b32 v109, v101
  v_mov_b32 v110, v102
  v_mov_b32 v111, v103
  v_permlane32_swap_b32 v100, v108
  v_permlane32_swap_b32 v101, v109
  v_permlane32_swap_b32 v102, v110
  v_permlane32_swap_b32 v103, v111
  v_add_f32 v100, v100, v108
  v_add_f32 v101, v101, v109
  v_add_f32 v102, v102, v110
  v_add_f32 v103, v103, v111
  v_mov_b32 v108, v100
  v_mov_b32 v109, v101
  v_mov_b32 v110, v102
  v_mov_b32 v111, v103
  v_permlane16_swap_b32 v100, v108
  v_permlane16_swap_b32 v101, v109
  v_permlane16_swap_b32 v102, v110
  v_permlane16_swap_b32 v103, v111
  v_add_f32 v100, v100, v108
  v_add_f32 v101, v101, v109
  v_add_f32 v102, v102, v110
  v_add_f32 v103, v103, v111
  v_and_or_b32 v100, v100, v3, s44
  v_and_or_b32 v101, v101, v3, s45
  v_and_or_b32 v102, v102, v3, s46
  v_and_or_b32 v103, v103, v3, s47
  s_mov_b64 exec, 0xffff
  buffer_store_dwordx4 v[100:103], v17, s[8:11], s84 offen sc1
  s_mov_b64 exec, -1
  s_mov_b64 s[60:61], -1
  s_mov_b32 s100, 0
  s_branch L_gf_70
L_g_69:
  s_add_u32 s100, s100, 1
  s_cmp_gt_u32 s100, 1000000
  s_cbranch_scc1 L_abort
L_gf_70:
  s_mov_b64 exec, s[60:61]
  buffer_load_dwordx4 v[144:147], v14, s[8:11], 0 offen offset:0 sc1
L_gc_71:
  s_waitcnt vmcnt(0)
  v_perm_b32 v94, v145, v144, s50
  v_perm_b32 v94, v146, v94, s51
  v_perm_b32 v94, v147, v94, s52
  v_cmp_ne_u32 s[60:61], s4, v94
  s_nop 0
  s_cmp_lg_u64 s[60:61], 0
  s_cbranch_scc1 L_g_69
  s_mov_b64 exec, -1
  v_and_b32 v144, v3, v144
  v_and_b32 v145, v3, v145
  v_and_b32 v146, v3, v146
  v_and_b32 v147, v3, v147
  s_nop 0
  v_permlane32_swap_b32 v144, v146
  v_permlane32_swap_b32 v145, v147
  v_add_f32 v144, v144, v146
  v_add_f32 v145, v145, v147
  s_nop 1
  v_permlane16_swap_b32 v144, v145
  v_add_f32 v144, v144, v145
  s_nop 1
  v_add_f32_dpp v144, v144, v144 row_ror:8 row_mask:0xf bank_mask:0xf
  ds_write_b32 v15, v144 offset:0
  s_waitcnt lgkmcnt(0)
  s_barrier
  s_mov_b64 s[60:61], -1
  s_mov_b32 s100, 0
  s_branch L_gf_75
L_g_74:
  s_add_u32 s100, s100, 1
  s_cmp_gt_u32 s100, 1000000
  s_cbranch_scc1 L_abort
L_gf_75:
  s_mov_b64 exec, s[60:61]
  buffer_load_dwordx4 v[144:147], v18, s[8:11], 0 offen offset:0 sc1
L_gc_76:
  s_waitcnt vmcnt(0)
  v_perm_b32 v94, v145, v144, s50
  v_perm_b32 v94, v146, v94, s51
  v_perm_b32 v94, v147, v94, s52
  v_cmp_ne_u32 s[60:61], s4, v94
  s_nop 0
  s_cmp_lg_u64 s[60:61], 0
  s_cbranch_scc1 L_g_74
  s_mov_b64 exec, -1
  v_and_b32 v144, v3, v144
  v_and_b32 v145, v3, v145
  v_and_b32 v146, v3, v146
  v_and_b32 v147, v3, v147
  s_nop 0
  v_permlane32_swap_b32 v144, v146
  v_permlane32_swap_b32 v145, v147
  v_add_f32 v144, v144, v146
  v_add_f32 v145, v145, v147
  s_nop 1
  v_permlane16_swap_b32 v144, v145
  v_add_f32 v144, v144, v145
  s_nop 1
  v_add_f32_dpp v144, v144, v144 row_ror:8 row_mask:0xf bank_mask:0xf
  ds_write_b32 v78, v144
  s_waitcnt lgkmcnt(0)
  s_barrier
  ds_read_b64 v[144:145], v79
  s_waitcnt lgkmcnt(0)
  v_add_f32 v144, v144, v145
  s_nop 1
  v_add_f32_dpp v94, v144, v144 row_shl:4 row_mask:0xf bank_mask:0xf
  s_nop 0
  v_readlane_b32 s56, v94, 35
  v_readlane_b32 s57, v94, 51
  v_mov_b32 v95, 0x3b000000
  v_mul_f32 v146, s56, v95
  v_mul_f32 v147, s57, v95
  v_fma_f32 v147, -v146, v146, v147
  v_max_f32 v147, 0, v147
  v_cvt_pk_bf16_f32 v95, v147, v147
  v_and_b32 v147, 0xffff0000, v95
  v_cvt_pk_bf16_f32 v94, v146, v146
  v_and_b32 v146, 0xffff0000, v94
  v_add_f32 v147, 0x3727c5ac, v147
  v_fma_f32 v144, -v146, v236, v144
  v_cvt_pk_bf16_f32 v95, v147, v147
  v_and_b32 v147, 0xffff0000, v95
  v_sqrt_f32 v147, v147
  s_nop 0
  v_cvt_pk_bf16_f32 v95, v147, v147
  v_and_b32 v147, 0xffff0000, v95
  v_rcp_f32 v147, v147
  s_nop 0
  v_fma_f32 v144, v144, v147, v238
  v_cvt_pk_bf16_f32 v94, v144, v144
  v_and_b32 v144, 0xffff0000, v94
  v_mul_f32 v94, v144, v144
  v_mov_b32 v95, 0xc0135761
  v_mov_b32_dpp v145, v144 row_shl:4 row_mask:0xf bank_mask:0xf
  v_fmac_f32 v95, 0xbdd2d3e8, v94
  v_mul_f32 v94, v95, v144
  v_exp_f32 v94, v94
  s_nop 0
  v_add_f32 v94, 1.0, v94
  v_rcp_f32 v94, v94
  s_nop 0
  v_mul_f32 v144, v144, v94
  v_cvt_pk_bf16_f32 v94, v144, v144
  v_and_b32 v144, 0xffff0000, v94
  v_mul_f32 v144, v144, v145
  v_cvt_pk_bf16_f32 v144, v144, v144
  s_mov_b32 exec_lo, 0x0
  s_mov_b32 exec_hi, 0x8080808
  v_mov_b32 v144, 0
  s_mov_b32 exec_lo, 0xf0f0f0f
  s_mov_b32 exec_hi, 0xf0f0f0f
  ds_write_b16 v22, v144
  s_mov_b64 exec, -1
  ds_read_b128 v[96:99], v21
  v_mov_b32 v100, 0
  v_mov_b32 v101, 0
  v_mov_b32 v102, 0
  v_mov_b32 v103, 0
  s_waitcnt lgkmcnt(0)
  v_dot2c_f32_bf16 v100, v96, v76
  v_dot2c_f32_bf16 v101, v96, v60
  v_dot2c_f32_bf16 v102, v96, v62
  v_dot2c_f32_bf16 v103, v96, v61
  v_dot2c_f32_bf16 v100, v97, v63
  v_dot2c_f32_bf16 v101, v97, v64
  v_dot2c_f32_bf16 v102, v97, v66
  v_dot2c_f32_bf16 v103, v97, v65
  v_dot2c_f32_bf16 v100, v98, v67
  v_dot2c_f32_bf16 v101, v98, v68
  v_dot2c_f32_bf16 v102, v98, v70
  v_dot2c_f32_bf16 v103, v98, v69
  v_dot2c_f32_bf16 v100, v99, v71
  v_dot2c_f32_bf16 v101, v99, v72
  v_dot2c_f32_bf16 v102, v99, v74
  v_dot2c_f32_bf16 v103, v99, v73
  v_mov_b32 v108, v100
  v_mov_b32 v109, v101
  v_mov_b32 v110, v102
  v_mov_b32 v111, v103
  v_permlane32_swap_b32 v100, v108
  v_permlane32_swap_b32 v101, v109
  v_permlane32_swap_b32 v102, v110
  v_permlane32_swap_b32 v103, v111
  v_add_f32 v100, v100, v108
  v_add_f32 v101, v101, v109
  v_add_f32 v102, v102, v110
  v_add_f32 v103, v103, v111
  v_mov_b32 v108, v100
  v_mov_b32 v109, v101
  v_mov_b32 v110, v102
  v_mov_b32 v111, v103
  v_permlane16_swap_b32 v100, v108
  v_permlane16_swap_b32 v101, v109
  v_permlane16_swap_b32 v102, v110
  v_permlane16_swap_b32 v103, v111
  v_add_f32 v100, v100, v108
  v_add_f32 v101, v101, v109
  v_add_f32 v102, v102, v110
  v_add_f32 v103, v103, v111
  v_and_or_b32 v100, v100, v3, s44
  v_and_or_b32 v101, v101, v3, s45
  v_and_or_b32 v102, v102, v3, s46
  v_and_or_b32 v103, v103, v3, s47
  s_mov_b64 exec, 0xffff
  buffer_store_dwordx4 v[100:103], v17, s[8:11], s85 offen sc1
  s_mov_b64 exec, -1
  s_cmp_lg_u32 s43, 0
  s_cbranch_scc1 L_fin
  s_mov_b64 s[60:61], -1
  s_mov_b32 s100, 0
  s_branch L_gf_80
L_g_79:
  s_add_u32 s100, s100, 1
  s_cmp_gt_u32 s100, 1000000
  s_cbranch_scc1 L_abort
L_gf_80:
  s_mov_b64 exec, s[60:61]
  buffer_load_dwordx4 v[144:147], v14, s[8:11], s88 offen offset:0 sc1
L_gc_81:
  s_waitcnt vmcnt(0)
  v_perm_b32 v94, v145, v144, s50
  v_perm_b32 v94, v146, v94, s51
  v_perm_b32 v94, v147, v94, s52
  v_cmp_ne_u32 s[60:61], s4, v94
  s_nop 0
  s_cmp_lg_u64 s[60:61], 0
  s_cbranch_scc1 L_g_79
  s_mov_b64 exec, -1
  v_and_b32 v144, v3, v144
  v_and_b32 v145, v3, v145
  v_and_b32 v146, v3, v146
  v_and_b32 v147, v3, v147
  s_nop 0
  v_permlane32_swap_b32 v144, v146
  v_permlane32_swap_b32 v145, v147
  v_add_f32 v144, v144, v146
  v_add_f32 v145, v145, v147
  s_nop 1
  v_permlane16_swap_b32 v144, v145
  v_add_f32 v144, v144, v145
  s_nop 1
  v_add_f32_dpp v144, v144, v144 row_ror:8 row_mask:0xf bank_mask:0xf
  ds_write_b32 v15, v144 offset:1024
  s_waitcnt lgkmcnt(0)
  s_barrier
  s_endpgm
L_abort:
L_end:
  s_endpgm
L_codeend:
.section .rodata,"a"
.p2align 6
.amdhsa_kernel adaLN_cond__compressed_kv_cla__glu_gated_geglu__decode_kernel
  .amdhsa_next_free_vgpr 256
  .amdhsa_next_free_sgpr 102
  .amdhsa_accum_offset 256
  .amdhsa_group_segment_fixed_size 0
  .amdhsa_kernarg_size 120
  .amdhsa_user_sgpr_count 2
  .amdhsa_user_sgpr_kernarg_segment_ptr 1
  .amdhsa_system_sgpr_workgroup_id_x 1
.end_amdhsa_kernel
```

```asm
; @launch grid=(256,1,1) block=(512,1,1) lds=163840
.amdgcn_target "amdgcn-amd-amdhsa--gfx950"
.text
.globl adaLN_cond__compressed_kv_cla__glu_gated_geglu__decode_kernel
.p2align 8
.type adaLN_cond__compressed_kv_cla__glu_gated_geglu__decode_kernel,@function
adaLN_cond__compressed_kv_cla__glu_gated_geglu__decode_kernel:
  s_cmp_ge_u32 s2, 256
  s_cbranch_scc1 L_end
  s_load_dwordx16 s[4:19], s[0:1], 0
  s_load_dwordx8 s[20:27], s[0:1], 64
  s_load_dwordx4 s[28:31], s[0:1], 96
  s_load_dwordx2 s[32:33], s[0:1], 112
  v_lshrrev_b32 v1, 6, v0
  s_mov_b32 s34, 0x10000000
  s_mov_b32 s35, 0x20000
  v_readfirstlane_b32 s3, v1
  v_and_b32 v1, 63, v0
  v_mov_b32 v8, 0
  v_mov_b32 v251, 0
  v_mov_b32 v253, 0
  s_cmp_lt_u32 s2, 128
  s_cbranch_scc0 L_B
  v_lshlrev_b32 v38, 4, v1
  s_bfe_u32 s82, s2, 0x30003
  s_lshl_b32 s82, s82, 19
  s_lshl_b32 s97, s3, 16
  s_add_u32 s82, s82, s97
  s_and_b32 s97, s2, 7
  s_lshl_b32 s97, s97, 10
  s_add_u32 s82, s82, s97
  s_mov_b32 s42, 0x400000
  s_mov_b32 s43, 0x20000
  s_bitcmp1_b32 s2, 6
  s_cbranch_scc1 L_K
  v_and_b32 v8, 15, v1
  v_lshlrev_b32 v8, 3, v8
  v_lshrrev_b32 v3, 4, v1
  v_lshl_add_u32 v8, v3, 1, v8
  s_bfe_u32 s92, s2, 0x30003
  s_lshl_b32 s92, s92, 7
  v_add_u32 v17, s92, v8
  s_mul_i32 s83, s3, 8576
  s_lshl_b32 s92, s2, 17
  v_mov_b32 v18, s92
  v_mov_b32 v19, 0xf000
  s_waitcnt lgkmcnt(0)
  s_mov_b64 s[40:41], s[8:9]
  global_load_dwordx4 v[12:15], v38, s[4:5]
  global_load_ushort v16, v17, s[4:5]
  s_add_u32 m0, s83, 0
  s_add_u32 s92, s82, 0
  buffer_load_dwordx4 v38, s[40:43], s92 offen nt lds
  s_add_u32 m0, s83, 1056
  s_add_u32 s92, s82, 8192
  buffer_load_dwordx4 v38, s[40:43], s92 offen nt lds
  s_add_u32 m0, s83, 2112
  s_add_u32 s92, s82, 16384
  buffer_load_dwordx4 v38, s[40:43], s92 offen nt lds
  s_add_u32 m0, s83, 3168
  s_add_u32 s92, s82, 24576
  buffer_load_dwordx4 v38, s[40:43], s92 offen nt lds
  s_add_u32 m0, s83, 4224
  s_add_u32 s92, s82, 32768
  buffer_load_dwordx4 v38, s[40:43], s92 offen nt lds
  s_add_u32 m0, s83, 5280
  s_add_u32 s92, s82, 40960
  buffer_load_dwordx4 v38, s[40:43], s92 offen nt lds
  s_add_u32 m0, s83, 6336
  s_add_u32 s92, s82, 49152
  buffer_load_dwordx4 v38, s[40:43], s92 offen nt lds
  s_add_u32 m0, s83, 7392
  s_add_u32 s92, s82, 57344
  buffer_load_dwordx4 v38, s[40:43], s92 offen nt lds
  s_cmp_lg_u32 s3, 7
  s_cbranch_scc1 L_nt_1
  s_mov_b64 exec, 1
  global_load_dword v20, v18, s[6:7] nt
  global_load_dword v21, v19, s[32:33]
  global_load_dword v22, v38, s[30:31] offset:128
  s_mov_b64 exec, -1
L_nt_1:
  s_branch L_Q2
L_K:
  s_bfe_u32 s81, s2, 0x10004
  s_xor_b32 s81, s81, 1
  s_lshl_b32 s81, s81, 16
  s_and_b32 s92, s3, 1
  s_lshl_b32 s92, s92, 7
  v_xor_b32 v39, s92, v38
  s_lshl_b32 s83, s3, 13
  s_add_u32 s83, s83, s81
  v_mov_b32 v19, 0xf000
  s_waitcnt lgkmcnt(0)
  s_mov_b64 s[40:41], s[10:11]
  s_mov_b64 exec, 1
  global_load_dword v21, v19, s[32:33]
  s_mov_b64 exec, -1
  v_xor_b32 v40, 0, v39
  s_add_u32 m0, s83, 0
  s_add_u32 s92, s82, 0
  buffer_load_dwordx4 v40, s[40:43], s92 offen nt lds
  v_xor_b32 v41, 16, v39
  s_add_u32 m0, s83, 1024
  s_add_u32 s92, s82, 8192
  buffer_load_dwordx4 v41, s[40:43], s92 offen nt lds
  v_xor_b32 v40, 32, v39
  s_add_u32 m0, s83, 2048
  s_add_u32 s92, s82, 16384
  buffer_load_dwordx4 v40, s[40:43], s92 offen nt lds
  v_xor_b32 v41, 48, v39
  s_add_u32 m0, s83, 3072
  s_add_u32 s92, s82, 24576
  buffer_load_dwordx4 v41, s[40:43], s92 offen nt lds
  v_xor_b32 v40, 64, v39
  s_add_u32 m0, s83, 4096
  s_add_u32 s92, s82, 32768
  buffer_load_dwordx4 v40, s[40:43], s92 offen nt lds
  v_xor_b32 v41, 80, v39
  s_add_u32 m0, s83, 5120
  s_add_u32 s92, s82, 40960
  buffer_load_dwordx4 v41, s[40:43], s92 offen nt lds
  v_xor_b32 v40, 96, v39
  s_add_u32 m0, s83, 6144
  s_add_u32 s92, s82, 49152
  buffer_load_dwordx4 v40, s[40:43], s92 offen nt lds
  v_xor_b32 v41, 112, v39
  s_add_u32 m0, s83, 7168
  s_add_u32 s92, s82, 57344
  buffer_load_dwordx4 v41, s[40:43], s92 offen nt lds
  s_branch L_K2
L_B:
  s_cmp_ge_u32 s3, 4
  s_cbranch_scc0 L_Bfront
  v_lshrrev_b32 v10, 3, v1
  v_mul_u32_u24 v5, 24576, v10
  v_lshlrev_b32 v10, 3, v10
  v_and_b32 v11, 7, v1
  v_lshl_add_u32 v5, v11, 4, v5
  s_bfe_u32 s94, s2, 0x20004
  s_and_b32 s95, s2, 15
  s_lshl_b32 s92, s94, 2
  s_add_u32 s92, s92, s3
  s_sub_u32 s92, s92, 4
  s_lshl_b32 s93, s92, 6
  v_add_u32 v10, s93, v10
  s_mul_i32 s92, s92, 196608
  s_lshl_b32 s93, s95, 7
  s_add_u32 s92, s92, s93
  s_mov_b32 s42, 0x300000
  s_mov_b32 s43, 0x20000
  v_mov_b32 v253, 0
  s_waitcnt lgkmcnt(0)
  s_mov_b64 s[40:41], s[26:27]
  s_bitcmp1_b32 s2, 6
  s_cbranch_scc1 L_nou0
  global_load_dwordx2 v[112:113], v10, s[24:25]
  buffer_load_dwordx4 v[124:127], v5, s[40:43], s92 offen nt
  s_add_u32 s92, s92, 6144
  buffer_load_dwordx4 v[128:131], v5, s[40:43], s92 offen nt
  s_add_u32 s92, s92, 6144
  buffer_load_dwordx4 v[132:135], v5, s[40:43], s92 offen nt
  s_add_u32 s92, s92, 6144
  buffer_load_dwordx4 v[136:139], v5, s[40:43], s92 offen nt
L_nou0:
  s_branch L_Bback2
L_Bfront:
  s_memrealtime s[62:63]
  s_bfe_u32 s64, s2, 0x40003
  s_or_b32 s64, s64, s3
  s_cbranch_scc1 L_nononce
  v_mov_b32 v18, 0
  v_mov_b32 v21, 0
  s_waitcnt lgkmcnt(0)
  s_or_b32 s62, s62, 1
  v_mov_b32 v20, s62
  s_mov_b64 exec, 1
  global_atomic_cmpswap v18, v[20:21], s[30:31] sc1
  s_mov_b64 exec, -1
L_nononce:
  v_lshrrev_b32 v245, 4, v1
  v_and_b32 v246, 15, v1
  v_lshlrev_b32 v247, 2, v245
  v_xor_b32 v246, v246, v247
  v_lshlrev_b32 v246, 4, v246
  v_lshl_add_u32 v244, v245, 10, v246
  v_xor_b32 v245, 16, v244
  v_xor_b32 v246, 32, v244
  v_xor_b32 v247, 48, v244
  v_add_u32 v245, 3072, v245
  v_add_u32 v246, 6144, v246
  v_add_u32 v247, 9216, v247
  s_and_b32 s91, s3, 3
  s_lshl_b32 s90, s91, 15
  s_lshl_b32 s91, s91, 13
  s_lshl_b32 s92, s2, 17
  s_add_u32 s90, s90, s92
  s_bfe_u32 s93, s2, 0x20003
  s_lshl_b32 s92, s93, 15
  s_add_u32 s91, s91, s92
  s_lshl_b32 s92, s93, 8
  s_add_u32 s90, s90, s92
  s_getpc_b64 s[94:95]
L_pc:
  s_sub_u32 s94, s94, L_pc-adaLN_cond__compressed_kv_cla__glu_gated_geglu__decode_kernel
  s_subb_u32 s95, s95, 0
  s_bfe_u32 s92, s2, 0x40003
  s_lshl_b32 s92, s92, 2
  s_add_u32 s92, s92, s3
  s_lshl_b32 s92, s92, 10
  v_lshlrev_b32 v11, 4, v1
  v_add_u32 v11, s92, v11
  s_mov_b32 s38, 0x2000000
  s_mov_b32 s39, 0x20000
  s_cmp_ge_u32 s92, L_codeend-adaLN_cond__compressed_kv_cla__glu_gated_geglu__decode_kernel
  s_cbranch_scc1 L_nopf
  v_min_u32 v11, L_codeend-adaLN_cond__compressed_kv_cla__glu_gated_geglu__decode_kernel-16, v11
  global_load_dwordx4 v[12:15], v11, s[94:95]
L_nopf:
  s_waitcnt lgkmcnt(0)
  s_mov_b64 s[36:37], s[6:7]
  s_barrier
  s_barrier
  s_mov_b32 s54, 0x05040100
  s_mov_b32 s55, 0x07060302
  s_mov_b32 s56, 0x0c0c0400
  s_mov_b32 s57, 0x0c040100
  s_mov_b32 s58, 0x04020100
  s_mov_b32 s53, 0x10001
  v_mov_b32 v2, 0xffffff00
  s_lshr_b32 s77, s2, 5
  s_and_b32 s78, s2, 127
  s_and_b32 s76, s2, 7
  s_lshl_b32 s76, s76, 2
  s_bfe_u32 s97, s2, 0x20003
  s_add_u32 s76, s76, s97
  s_and_b32 s79, s2, 7
  s_lshl_b32 s79, s79, 1
  s_bfe_u32 s97, s2, 0x10003
  s_add_u32 s79, s79, s97
  s_bfe_u32 s80, s2, 0x30004
  s_bfe_u32 s17, s2, 0x20003
  s_bfe_u32 s59, s2, 0x10004
  s_lshl_b32 s59, s59, 14
  s_xor_b32 m0, s91, 0
  s_xor_b32 s101, s90, 0
  buffer_load_dwordx4 v244, s[36:39], s101 offen offset:0 nt lds
  s_waitcnt vmcnt(0)
  buffer_load_dwordx4 v245, s[36:39], s101 offen offset:1024 nt lds
  s_waitcnt vmcnt(1)
  buffer_load_dwordx4 v246, s[36:39], s101 offen offset:2048 nt lds
  s_waitcnt vmcnt(1)
  buffer_load_dwordx4 v247, s[36:39], s101 offen offset:3072 nt lds
  s_waitcnt vmcnt(1)
  s_xor_b32 m0, s91, 32768
  s_xor_b32 s101, s90, 256
  buffer_load_dwordx4 v244, s[36:39], s101 offen offset:0 nt lds
  buffer_load_dwordx4 v245, s[36:39], s101 offen offset:1024 nt lds
  buffer_load_dwordx4 v246, s[36:39], s101 offen offset:2048 nt lds
  buffer_load_dwordx4 v247, s[36:39], s101 offen offset:3072 nt lds
  s_xor_b32 m0, s91, 65536
  s_xor_b32 s101, s90, 512
  buffer_load_dwordx4 v244, s[36:39], s101 offen offset:0 nt lds
  buffer_load_dwordx4 v245, s[36:39], s101 offen offset:1024 nt lds
  buffer_load_dwordx4 v246, s[36:39], s101 offen offset:2048 nt lds
  buffer_load_dwordx4 v247, s[36:39], s101 offen offset:3072 nt lds
  v_mov_b32 v253, 0
  global_load_dword v252, v253, s[30:31] sc1
  s_xor_b32 m0, s91, 98304
  s_xor_b32 s101, s90, 768
  buffer_load_dwordx4 v244, s[36:39], s101 offen offset:0 nt lds
  buffer_load_dwordx4 v245, s[36:39], s101 offen offset:1024 nt lds
  buffer_load_dwordx4 v246, s[36:39], s101 offen offset:2048 nt lds
  buffer_load_dwordx4 v247, s[36:39], s101 offen offset:3072 nt lds
  s_barrier
  s_branch L_front
L_Q2:
  s_mov_b32 s54, 0x05040100
  s_mov_b32 s55, 0x07060302
  s_mov_b32 s56, 0x0c0c0400
  s_mov_b32 s57, 0x0c040100
  s_mov_b32 s58, 0x04020100
  s_mov_b32 s53, 0x10001
  v_mov_b32 v2, 0xffffff00
  s_lshr_b32 s77, s2, 5
  s_and_b32 s78, s2, 127
  s_and_b32 s76, s2, 7
  s_lshl_b32 s76, s76, 2
  s_bfe_u32 s97, s2, 0x20003
  s_add_u32 s76, s76, s97
  s_and_b32 s79, s2, 7
  s_lshl_b32 s79, s79, 1
  s_bfe_u32 s97, s2, 0x10003
  s_add_u32 s79, s79, s97
  s_bfe_u32 s80, s2, 0x30004
  s_bfe_u32 s17, s2, 0x20003
  s_bfe_u32 s59, s2, 0x10004
  s_lshl_b32 s59, s59, 14
  v_lshrrev_b32 v245, 4, v1
  v_and_b32 v246, 15, v1
  v_lshlrev_b32 v247, 2, v245
  v_xor_b32 v246, v246, v247
  v_lshlrev_b32 v246, 4, v246
  v_lshl_add_u32 v244, v245, 10, v246
  v_xor_b32 v245, 16, v244
  v_xor_b32 v246, 32, v244
  v_xor_b32 v247, 48, v244
  v_add_u32 v245, 3072, v245
  v_add_u32 v246, 6144, v246
  v_add_u32 v247, 9216, v247
  s_and_b32 s91, s3, 3
  s_lshl_b32 s90, s91, 15
  s_lshl_b32 s91, s91, 13
  s_lshl_b32 s92, s2, 17
  s_add_u32 s90, s90, s92
  s_bfe_u32 s93, s2, 0x20003
  s_lshl_b32 s92, s93, 15
  s_add_u32 s91, s91, s92
  s_lshl_b32 s92, s93, 8
  s_add_u32 s90, s90, s92
  s_mov_b64 s[36:37], s[6:7]
  s_mov_b32 s38, 0x2000000
  s_mov_b32 s39, 0x20000
  s_bfe_u32 s82, s2, 0x30003
  s_lshl_b32 s82, s82, 10
  s_add_u32 s83, s82, 8192
  s_lshl_b32 s92, s3, 7
  s_add_u32 s92, s92, 131072
  v_add_u32 v40, s92, v8
  v_lshrrev_b32 v41, 4, v1
  v_lshlrev_b32 v41, 4, v41
  v_add_u32 v41, s92, v41
  s_lshl_b32 s92, s3, 7
  v_lshrrev_b32 v44, 4, v1
  v_mul_u32_u24 v44, 8576, v44
  v_bfe_u32 v3, v1, 2, 2
  v_mul_u32_u24 v3, 1056, v3
  v_add_u32 v44, v3, v44
  v_and_b32 v3, 3, v1
  v_lshl_add_u32 v44, v3, 3, v44
  v_add_u32 v44, s92, v44
  v_and_b32 v39, 1, v1
  v_lshlrev_b32 v39, 6, v39
  v_bfe_u32 v3, v1, 4, 1
  v_lshl_add_u32 v39, v3, 5, v39
  v_lshrrev_b32 v3, 5, v1
  v_lshl_add_u32 v39, v3, 4, v39
  s_and_b32 s85, s2, 7
  s_lshl_b32 s85, s85, 13
  s_bfe_u32 s97, s2, 0x30003
  s_lshl_b32 s97, s97, 10
  s_add_u32 s85, s85, s97
  s_lshl_b32 s97, s3, 7
  s_add_u32 s85, s85, s97
  s_add_u32 s85, s85, 524288
  s_mov_b32 s74, 0x20002
  s_mov_b32 s75, 0x20002
  s_waitcnt vmcnt(8)
  v_lshlrev_b32 v92, 16, v12
  v_and_b32 v93, 0xffff0000, v12
  v_lshlrev_b32 v94, 16, v13
  v_and_b32 v95, 0xffff0000, v13
  v_lshlrev_b32 v96, 16, v14
  v_and_b32 v97, 0xffff0000, v14
  v_lshlrev_b32 v98, 16, v15
  v_and_b32 v99, 0xffff0000, v15
  v_add_f32 v100, v92, v93
  v_add_f32 v100, v100, v94
  v_add_f32 v100, v100, v95
  v_add_f32 v100, v100, v96
  v_add_f32 v100, v100, v97
  v_add_f32 v100, v100, v98
  v_add_f32 v100, v100, v99
  s_nop 1
  v_add_f32_dpp v100, v100, v100 row_ror:8 row_mask:0xf bank_mask:0xf
  s_nop 1
  v_add_f32_dpp v100, v100, v100 row_ror:4 row_mask:0xf bank_mask:0xf
  s_nop 1
  v_add_f32_dpp v100, v100, v100 row_ror:2 row_mask:0xf bank_mask:0xf
  s_nop 1
  v_add_f32_dpp v100, v100, v100 row_ror:1 row_mask:0xf bank_mask:0xf
  v_mov_b32 v101, v100
  s_nop 1
  v_permlane16_swap_b32 v100, v101
  v_add_f32 v100, v100, v101
  v_mov_b32 v101, v100
  s_nop 1
  v_permlane32_swap_b32 v100, v101
  v_add_f32 v100, v100, v101
  v_mul_f32 v100, 0x3b000000, v100
  v_sub_f32 v92, v92, v100
  v_sub_f32 v93, v93, v100
  v_sub_f32 v94, v94, v100
  v_sub_f32 v95, v95, v100
  v_sub_f32 v96, v96, v100
  v_sub_f32 v97, v97, v100
  v_sub_f32 v98, v98, v100
  v_sub_f32 v99, v99, v100
  v_mul_f32 v102, v92, v92
  v_fmac_f32 v102, v93, v93
  v_fmac_f32 v102, v94, v94
  v_fmac_f32 v102, v95, v95
  v_fmac_f32 v102, v96, v96
  v_fmac_f32 v102, v97, v97
  v_fmac_f32 v102, v98, v98
  v_fmac_f32 v102, v99, v99
  s_nop 1
  v_add_f32_dpp v102, v102, v102 row_ror:8 row_mask:0xf bank_mask:0xf
  s_nop 1
  v_add_f32_dpp v102, v102, v102 row_ror:4 row_mask:0xf bank_mask:0xf
  s_nop 1
  v_add_f32_dpp v102, v102, v102 row_ror:2 row_mask:0xf bank_mask:0xf
  s_nop 1
  v_add_f32_dpp v102, v102, v102 row_ror:1 row_mask:0xf bank_mask:0xf
  v_mov_b32 v101, v102
  s_nop 1
  v_permlane16_swap_b32 v102, v101
  v_add_f32 v102, v102, v101
  v_mov_b32 v101, v102
  s_nop 1
  v_permlane32_swap_b32 v102, v101
  v_add_f32 v102, v102, v101
  v_mov_b32 v253, 0
  global_load_dword v252, v253, s[30:31] sc1
  v_mul_f32 v102, 0x3b000000, v102
  v_cvt_pk_bf16_f32 v101, v100, v100
  v_and_b32 v100, 0xffff0000, v101
  v_cvt_pk_bf16_f32 v101, v102, v102
  v_and_b32 v102, 0xffff0000, v101
  v_add_f32 v102, 0x3727c5ac, v102
  v_cvt_pk_bf16_f32 v101, v102, v102
  v_and_b32 v102, 0xffff0000, v101
  v_sqrt_f32 v102, v102
  s_nop 0
  v_cvt_pk_bf16_f32 v101, v102, v102
  v_and_b32 v102, 0xffff0000, v101
  v_rcp_f32 v102, v102
  v_lshlrev_b32 v103, 16, v16
  v_sub_f32 v103, v103, v100
  v_cvt_pk_bf16_f32 v101, v103, v103
  v_and_b32 v103, 0xffff0000, v101
  v_mul_f32 v103, v103, v102
  v_cvt_pk_bf16_f32 v101, v103, v103
  v_and_b32 v103, 0xffff0000, v101
  s_mov_b32 s100, 0
  s_waitcnt vmcnt(0)
  s_branch L_epc_3
L_ep_2:
  global_load_dword v252, v253, s[30:31] sc1
  s_add_u32 s100, s100, 1
  s_cmp_gt_u32 s100, 1000000
  s_cbranch_scc1 L_abort
  s_waitcnt vmcnt(0)
L_epc_3:
  v_readfirstlane_b32 s48, v252
  s_nop 0
  s_cmp_eq_u32 s48, 0
  s_nop 1
  s_cbranch_scc1 L_ep_2
  s_mul_i32 s48, s48, 0x9e3779b1
  s_and_b32 s49, s48, 0xff
  s_bfe_u32 s50, s48, 0x80008
  s_bfe_u32 s51, s48, 0x80010
  s_lshr_b32 s52, s48, 24
  s_lshr_b32 s97, s48, 15
  s_xor_b32 s97, s97, s48
  s_mul_i32 s97, s97, 0x85ebca6b
  v_mov_b32 v4, s48
  v_mov_b32 v5, s97
  v_mov_b32 v249, s48
  v_mov_b32 v250, s97
  v_and_b32 v6, 4, v1
  v_cmp_eq_u32 vcc, 0, v6
  v_and_b32 v7, 3, v1
  v_lshlrev_b32 v7, 2, v7
  v_cndmask_b32 v4, v5, v4, vcc
  v_lshrrev_b32 v4, v7, v4
  v_lshrrev_b32 v5, 1, v4
  v_lshrrev_b32 v6, 2, v4
  v_lshrrev_b32 v7, 3, v4
  v_bfe_u32 v28, v1, 4, 1
  v_lshlrev_b32 v28, 3, v28
  v_lshrrev_b32 v3, 5, v1
  v_lshl_add_u32 v28, v3, 2, v28
  v_mov_b32 v68, s48
  v_mov_b32 v69, s97
  v_cndmask_b32 v68, v68, v69, s[74:75]
  v_lshrrev_b32 v68, v28, v68
  v_lshrrev_b32 v69, 1, v68
  v_lshrrev_b32 v70, 2, v68
  v_lshrrev_b32 v71, 3, v68
  s_barrier
  buffer_load_dwordx4 v[20:23], v38, s[32:35], s82 offen offset:0 sc1
  buffer_load_dwordx4 v[24:27], v38, s[32:35], s83 offen offset:0 sc1
  ds_read_b64_tr_b16 v[112:113], v44 offset:0
  ds_read_b64_tr_b16 v[114:115], v44 offset:4224
  ds_read_b64_tr_b16 v[116:117], v44 offset:34304
  ds_read_b64_tr_b16 v[118:119], v44 offset:38528
  ds_read_b64_tr_b16 v[120:121], v44 offset:32
  ds_read_b64_tr_b16 v[122:123], v44 offset:4256
  ds_read_b64_tr_b16 v[124:125], v44 offset:34336
  ds_read_b64_tr_b16 v[126:127], v44 offset:38560
  ds_read_b64_tr_b16 v[128:129], v44 offset:64
  ds_read_b64_tr_b16 v[130:131], v44 offset:4288
  ds_read_b64_tr_b16 v[132:133], v44 offset:34368
  ds_read_b64_tr_b16 v[134:135], v44 offset:38592
  s_waitcnt lgkmcnt(4)
  ds_read_b64_tr_b16 v[136:137], v44 offset:96
  ds_read_b64_tr_b16 v[138:139], v44 offset:4320
  ds_read_b64_tr_b16 v[140:141], v44 offset:34400
  ds_read_b64_tr_b16 v[142:143], v44 offset:38624
  s_waitcnt lgkmcnt(0)
  s_barrier
  s_mov_b64 s[60:61], -1
  s_waitcnt vmcnt(0)
  s_mov_b32 s100, 0
  s_branch L_gc_6
L_g_4:
  s_add_u32 s100, s100, 1
  s_cmp_gt_u32 s100, 1000000
  s_cbranch_scc1 L_abort
  s_sleep 2
L_gf_5:
  s_mov_b64 exec, s[60:61]
  buffer_load_dwordx4 v[20:23], v38, s[32:35], s82 offen offset:0 sc1
  buffer_load_dwordx4 v[24:27], v38, s[32:35], s83 offen offset:0 sc1
  s_waitcnt vmcnt(0)
L_gc_6:
  s_mov_b64 exec, s[60:61]
  v_perm_b32 v92, v21, v20, s56
  v_perm_b32 v92, v22, v92, s57
  v_perm_b32 v92, v23, v92, s58
  v_cmp_ne_u32 s[60:61], s48, v92
  v_perm_b32 v92, v25, v24, s56
  v_perm_b32 v92, v26, v92, s57
  v_perm_b32 v92, v27, v92, s58
  v_cmp_ne_u32 vcc, s48, v92
  s_nop 0
  s_or_b64 s[60:61], s[60:61], vcc
  s_cmp_lg_u64 s[60:61], 0
  s_cbranch_scc1 L_g_4
  s_mov_b64 exec, -1
  v_permlane32_swap_b32 v20, v22
  v_permlane32_swap_b32 v21, v23
  v_permlane32_swap_b32 v24, v26
  v_permlane32_swap_b32 v25, v27
  v_add_f32 v20, v20, v22
  v_add_f32 v21, v21, v23
  v_add_f32 v24, v24, v26
  v_add_f32 v25, v25, v27
  v_permlane16_swap_b32 v20, v21
  s_nop 0
  v_permlane16_swap_b32 v24, v25
  v_add_f32 v20, v20, v21
  v_add_f32 v24, v24, v25
  v_cvt_pk_bf16_f32 v25, v24, v24
  v_and_b32 v24, 0xffff0000, v25
  v_cvt_pk_bf16_f32 v21, v20, v20
  v_and_b32 v20, 0xffff0000, v21
  v_add_f32 v24, 1.0, v24
  v_cvt_pk_bf16_f32 v25, v24, v24
  v_and_b32 v24, 0xffff0000, v25
  v_mul_f32 v24, v103, v24
  v_cvt_pk_bf16_f32 v25, v24, v24
  v_and_b32 v24, 0xffff0000, v25
  v_add_f32 v24, v24, v20
  v_cvt_pk_bf16_f32 v24, v24, v24
  ds_write_b16 v40, v24
  ds_read_b128 v[28:31], v41
  ds_read_b128 v[32:35], v41 offset:64
  s_waitcnt lgkmcnt(1)
  v_mfma_f32_16x16x32_bf16 v[80:83], v[112:115], v[28:31], 0
  v_mfma_f32_16x16x32_bf16 v[84:87], v[120:123], v[28:31], 0
  v_mfma_f32_16x16x32_bf16 v[88:91], v[128:131], v[28:31], 0
  v_mfma_f32_16x16x32_bf16 v[92:95], v[136:139], v[28:31], 0
  s_waitcnt lgkmcnt(0)
  v_mfma_f32_16x16x32_bf16 v[80:83], v[116:119], v[32:35], v[80:83]
  v_mfma_f32_16x16x32_bf16 v[84:87], v[124:127], v[32:35], v[84:87]
  v_mfma_f32_16x16x32_bf16 v[88:91], v[132:135], v[32:35], v[88:91]
  v_mfma_f32_16x16x32_bf16 v[92:95], v[140:143], v[32:35], v[92:95]
  s_nop 4
  v_cvt_pk_bf16_f32 v20, v80, v81
  v_cvt_pk_bf16_f32 v21, v82, v83
  v_cvt_pk_bf16_f32 v22, v84, v85
  v_cvt_pk_bf16_f32 v23, v86, v87
  v_cvt_pk_bf16_f32 v24, v88, v89
  v_cvt_pk_bf16_f32 v25, v90, v91
  v_cvt_pk_bf16_f32 v26, v92, v93
  v_cvt_pk_bf16_f32 v27, v94, v95
  v_permlane16_swap_b32 v20, v22
  v_permlane16_swap_b32 v21, v23
  v_permlane16_swap_b32 v24, v26
  v_permlane16_swap_b32 v25, v27
  v_cndmask_b32 v20, v20, v24, s[74:75]
  v_cndmask_b32 v21, v21, v25, s[74:75]
  v_cndmask_b32 v22, v22, v26, s[74:75]
  v_cndmask_b32 v23, v23, v27, s[74:75]
  v_bfi_b32 v20, s53, v68, v20
  v_bfi_b32 v21, s53, v69, v21
  v_bfi_b32 v22, s53, v70, v22
  v_bfi_b32 v23, s53, v71, v23
  s_mov_b32 exec_lo, 0x30003
  s_mov_b32 exec_hi, 0x30003
  buffer_store_dwordx4 v[20:23], v39, s[32:35], s85 offen sc1
  s_mov_b64 exec, -1
  s_barrier
  s_lshr_b32 s92, s3, 2
  s_lshl_b32 s93, s92, 12
  s_xor_b32 s93, s93, 0
  s_xor_b32 m0, s91, s93
  s_lshl_b32 s93, s92, 14
  s_xor_b32 s93, s93, 0
  s_xor_b32 s101, s90, s93
  buffer_load_dwordx4 v244, s[36:39], s101 offen offset:0 nt lds
  buffer_load_dwordx4 v245, s[36:39], s101 offen offset:1024 nt lds
  buffer_load_dwordx4 v246, s[36:39], s101 offen offset:2048 nt lds
  buffer_load_dwordx4 v247, s[36:39], s101 offen offset:3072 nt lds
  s_lshr_b32 s92, s3, 2
  s_lshl_b32 s93, s92, 12
  s_xor_b32 s93, s93, 32768
  s_xor_b32 m0, s91, s93
  s_lshl_b32 s93, s92, 14
  s_xor_b32 s93, s93, 256
  s_xor_b32 s101, s90, s93
  buffer_load_dwordx4 v244, s[36:39], s101 offen offset:0 nt lds
  buffer_load_dwordx4 v245, s[36:39], s101 offen offset:1024 nt lds
  buffer_load_dwordx4 v246, s[36:39], s101 offen offset:2048 nt lds
  buffer_load_dwordx4 v247, s[36:39], s101 offen offset:3072 nt lds
  s_lshr_b32 s92, s3, 2
  s_lshl_b32 s93, s92, 12
  s_xor_b32 s93, s93, 65536
  s_xor_b32 m0, s91, s93
  s_lshl_b32 s93, s92, 14
  s_xor_b32 s93, s93, 512
  s_xor_b32 s101, s90, s93
  buffer_load_dwordx4 v244, s[36:39], s101 offen offset:0 nt lds
  buffer_load_dwordx4 v245, s[36:39], s101 offen offset:1024 nt lds
  buffer_load_dwordx4 v246, s[36:39], s101 offen offset:2048 nt lds
  buffer_load_dwordx4 v247, s[36:39], s101 offen offset:3072 nt lds
  s_lshr_b32 s92, s3, 2
  s_lshl_b32 s93, s92, 12
  s_xor_b32 s93, s93, 98304
  s_xor_b32 m0, s91, s93
  s_lshl_b32 s93, s92, 14
  s_xor_b32 s93, s93, 768
  s_xor_b32 s101, s90, s93
  buffer_load_dwordx4 v244, s[36:39], s101 offen offset:0 nt lds
  buffer_load_dwordx4 v245, s[36:39], s101 offen offset:1024 nt lds
  buffer_load_dwordx4 v246, s[36:39], s101 offen offset:2048 nt lds
  buffer_load_dwordx4 v247, s[36:39], s101 offen offset:3072 nt lds
  s_cmp_ge_u32 s3, 4
  s_cbranch_scc1 L_back
  s_barrier
  s_branch L_setup
L_K2:
  s_mov_b32 s54, 0x05040100
  s_mov_b32 s55, 0x07060302
  s_mov_b32 s56, 0x0c0c0400
  s_mov_b32 s57, 0x0c040100
  s_mov_b32 s58, 0x04020100
  s_mov_b32 s53, 0x10001
  v_mov_b32 v2, 0xffffff00
  s_lshr_b32 s77, s2, 5
  s_and_b32 s78, s2, 127
  s_and_b32 s76, s2, 7
  s_lshl_b32 s76, s76, 2
  s_bfe_u32 s97, s2, 0x20003
  s_add_u32 s76, s76, s97
  s_and_b32 s79, s2, 7
  s_lshl_b32 s79, s79, 1
  s_bfe_u32 s97, s2, 0x10003
  s_add_u32 s79, s79, s97
  s_bfe_u32 s80, s2, 0x30004
  s_bfe_u32 s17, s2, 0x20003
  s_bfe_u32 s59, s2, 0x10004
  s_lshl_b32 s59, s59, 14
  v_lshrrev_b32 v245, 4, v1
  v_and_b32 v246, 15, v1
  v_lshlrev_b32 v247, 2, v245
  v_xor_b32 v246, v246, v247
  v_lshlrev_b32 v246, 4, v246
  v_lshl_add_u32 v244, v245, 10, v246
  v_xor_b32 v245, 16, v244
  v_xor_b32 v246, 32, v244
  v_xor_b32 v247, 48, v244
  v_add_u32 v245, 3072, v245
  v_add_u32 v246, 6144, v246
  v_add_u32 v247, 9216, v247
  s_and_b32 s91, s3, 3
  s_lshl_b32 s90, s91, 15
  s_lshl_b32 s91, s91, 13
  s_lshl_b32 s92, s2, 17
  s_add_u32 s90, s90, s92
  s_bfe_u32 s93, s2, 0x20003
  s_lshl_b32 s92, s93, 15
  s_add_u32 s91, s91, s92
  s_lshl_b32 s92, s93, 8
  s_add_u32 s90, s90, s92
  s_mov_b64 s[36:37], s[6:7]
  s_mov_b32 s38, 0x2000000
  s_mov_b32 s39, 0x20000
  s_barrier
  s_lshr_b32 s92, s3, 2
  s_lshl_b32 s93, s92, 12
  s_xor_b32 s93, s93, 0
  s_xor_b32 m0, s91, s93
  s_lshl_b32 s93, s92, 14
  s_xor_b32 s93, s93, 0
  s_xor_b32 s101, s90, s93
  buffer_load_dwordx4 v244, s[36:39], s101 offen offset:0 nt lds
  buffer_load_dwordx4 v245, s[36:39], s101 offen offset:1024 nt lds
  buffer_load_dwordx4 v246, s[36:39], s101 offen offset:2048 nt lds
  buffer_load_dwordx4 v247, s[36:39], s101 offen offset:3072 nt lds
  s_lshr_b32 s92, s3, 2
  s_lshl_b32 s93, s92, 12
  s_xor_b32 s93, s93, 32768
  s_xor_b32 m0, s91, s93
  s_lshl_b32 s93, s92, 14
  s_xor_b32 s93, s93, 256
  s_xor_b32 s101, s90, s93
  buffer_load_dwordx4 v244, s[36:39], s101 offen offset:0 nt lds
  buffer_load_dwordx4 v245, s[36:39], s101 offen offset:1024 nt lds
  buffer_load_dwordx4 v246, s[36:39], s101 offen offset:2048 nt lds
  buffer_load_dwordx4 v247, s[36:39], s101 offen offset:3072 nt lds
  s_and_b32 s92, s3, 1
  s_lshl_b32 s92, s92, 15
  s_lshr_b32 s97, s3, 1
  s_lshl_b32 s97, s97, 8
  s_add_u32 s92, s92, s97
  s_add_u32 s92, s92, s81
  v_and_b32 v45, 15, v1
  v_mul_u32_u24 v45, 1040, v45
  v_add_u32 v45, s92, v45
  v_lshrrev_b32 v34, 4, v1
  v_lshlrev_b32 v34, 4, v34
  v_xor_b32 v45, v45, v34
  v_lshrrev_b32 v37, 3, v1
  v_lshlrev_b32 v37, 10, v37
  v_and_b32 v3, 7, v1
  v_lshl_add_u32 v37, v3, 4, v37
  s_and_b32 s83, s2, 7
  s_lshl_b32 s83, s83, 13
  s_lshl_b32 s97, s3, 7
  s_add_u32 s83, s83, s97
  s_add_u32 s83, s83, 524288
  s_lshl_b32 s92, s3, 7
  s_add_u32 s92, s92, 135168
  v_and_b32 v47, 7, v1
  v_lshlrev_b32 v47, 4, v47
  v_lshrrev_b32 v3, 4, v1
  v_lshl_add_u32 v47, v3, 2, v47
  v_add_u32 v47, s92, v47
  s_lshr_b32 s92, s3, 1
  s_lshl_b32 s92, s92, 8
  s_add_u32 s92, s92, 135168
  v_lshrrev_b32 v35, 4, v1
  v_lshlrev_b32 v35, 4, v35
  v_add_u32 v35, s92, v35
  v_mov_b32 v50, 0x3f80
  v_mov_b32 v51, 0x3f800000
  v_bfe_u32 v39, v1, 4, 1
  v_lshlrev_b32 v39, 5, v39
  v_lshrrev_b32 v3, 5, v1
  v_lshl_add_u32 v39, v3, 4, v39
  s_and_b32 s84, s2, 7
  s_lshl_b32 s84, s84, 12
  s_lshr_b32 s97, s3, 1
  s_lshl_b32 s97, s97, 10
  s_add_u32 s84, s84, s97
  s_bfe_u32 s97, s2, 0x30003
  s_lshl_b32 s97, s97, 7
  s_add_u32 s84, s84, s97
  s_and_b32 s97, s3, 1
  s_lshl_b32 s97, s97, 6
  s_add_u32 s84, s84, s97
  s_add_u32 s84, s84, 65536
  v_mov_b32 v72, 0
  v_mov_b32 v73, 0
  v_mov_b32 v74, 0
  v_mov_b32 v75, 0
  v_mov_b32 v76, 0
  v_mov_b32 v77, 0
  v_mov_b32 v78, 0
  v_mov_b32 v79, 0
  s_waitcnt vmcnt(8)
  s_barrier
  v_xor_b32 v32, 0, v45
  ds_read_b128 v[112:115], v32 offset:0
  v_xor_b32 v33, 64, v45
  ds_read_b128 v[116:119], v33 offset:0
  v_xor_b32 v32, 128, v45
  ds_read_b128 v[120:123], v32 offset:0
  v_xor_b32 v33, 192, v45
  ds_read_b128 v[124:127], v33 offset:0
  v_xor_b32 v32, 0, v45
  ds_read_b128 v[128:131], v32 offset:16384
  v_xor_b32 v33, 64, v45
  ds_read_b128 v[132:135], v33 offset:16384
  v_xor_b32 v32, 128, v45
  ds_read_b128 v[136:139], v32 offset:16384
  v_xor_b32 v33, 192, v45
  ds_read_b128 v[140:143], v33 offset:16384
  s_waitcnt lgkmcnt(0)
  s_barrier
  s_mov_b32 s100, 0
  v_mov_b32 v253, 0
L_ep_8:
  global_load_dword v252, v253, s[30:31] sc1
  s_add_u32 s100, s100, 1
  s_cmp_gt_u32 s100, 1000000
  s_cbranch_scc1 L_abort
  s_waitcnt vmcnt(0)
L_epc_9:
  v_readfirstlane_b32 s48, v252
  s_nop 0
  s_cmp_eq_u32 s48, 0
  s_nop 1
  s_cbranch_scc1 L_ep_8
  s_mul_i32 s48, s48, 0x9e3779b1
  s_and_b32 s49, s48, 0xff
  s_bfe_u32 s50, s48, 0x80008
  s_bfe_u32 s51, s48, 0x80010
  s_lshr_b32 s52, s48, 24
  s_lshr_b32 s97, s48, 15
  s_xor_b32 s97, s97, s48
  s_mul_i32 s97, s97, 0x85ebca6b
  v_mov_b32 v4, s48
  v_mov_b32 v5, s97
  v_mov_b32 v249, s48
  v_mov_b32 v250, s97
  v_and_b32 v6, 4, v1
  v_cmp_eq_u32 vcc, 0, v6
  v_and_b32 v7, 3, v1
  v_lshlrev_b32 v7, 2, v7
  v_cndmask_b32 v4, v5, v4, vcc
  v_lshrrev_b32 v4, v7, v4
  v_lshrrev_b32 v5, 1, v4
  v_lshrrev_b32 v6, 2, v4
  v_lshrrev_b32 v7, 3, v4
  s_and_b32 s92, s3, 1
  s_sub_u32 s74, 0, s92
  s_mov_b32 s75, s74
  v_bfe_u32 v28, v1, 4, 1
  v_lshlrev_b32 v28, 3, v28
  v_lshrrev_b32 v3, 5, v1
  v_lshl_add_u32 v28, v3, 2, v28
  v_mov_b32 v68, s48
  v_mov_b32 v69, s97
  v_cndmask_b32 v68, v68, v69, s[74:75]
  v_lshrrev_b32 v68, v28, v68
  v_lshrrev_b32 v69, 1, v68
  v_lshrrev_b32 v70, 2, v68
  v_lshrrev_b32 v71, 3, v68
  s_mov_b64 s[60:61], -1
  s_mov_b32 s100, 0
  s_branch L_gf_11
L_g_10:
  s_add_u32 s100, s100, 1
  s_cmp_gt_u32 s100, 1000000
  s_cbranch_scc1 L_abort
  s_sleep 2
L_gf_11:
  s_mov_b64 exec, s[60:61]
  buffer_load_dwordx4 v[20:23], v37, s[32:35], s83 offen offset:0 sc1
  s_waitcnt vmcnt(0)
L_gc_12:
  s_mov_b64 exec, s[60:61]
  v_xor_b32 v92, v20, v4
  v_bitop3_b32 v92, v21, v5, v92 bitop3:0xbe
  v_bitop3_b32 v92, v22, v6, v92 bitop3:0xbe
  v_bitop3_b32 v92, v23, v7, v92 bitop3:0xbe
  v_and_b32 v92, s53, v92
  v_cmp_ne_u32 s[60:61], 0, v92
  s_nop 0
  s_cmp_lg_u64 s[60:61], 0
  s_cselect_b64 s[60:61], -1, 0
  s_cmp_lg_u64 s[60:61], 0
  s_cbranch_scc1 L_g_10
  s_mov_b64 exec, -1
  v_dot2c_f32_bf16 v72, v50, v20
  v_dot2c_f32_bf16 v73, v51, v20
  v_dot2c_f32_bf16 v74, v50, v21
  v_dot2c_f32_bf16 v75, v51, v21
  v_dot2c_f32_bf16 v76, v50, v22
  v_dot2c_f32_bf16 v77, v51, v22
  v_dot2c_f32_bf16 v78, v50, v23
  v_dot2c_f32_bf16 v79, v51, v23
  v_permlane32_swap_b32 v72, v76
  v_permlane32_swap_b32 v73, v77
  v_permlane32_swap_b32 v74, v78
  v_permlane32_swap_b32 v75, v79
  v_add_f32 v72, v72, v76
  v_add_f32 v73, v73, v77
  v_add_f32 v74, v74, v78
  v_add_f32 v75, v75, v79
  s_nop 0
  v_permlane16_swap_b32 v72, v74
  v_permlane16_swap_b32 v73, v75
  v_add_f32 v72, v72, v74
  v_add_f32 v73, v73, v75
  s_nop 0
  v_add_f32_dpp v72, v72, v72 row_ror:8 row_mask:0xf bank_mask:0xf
  v_add_f32_dpp v73, v73, v73 row_ror:8 row_mask:0xf bank_mask:0xf
  v_cvt_pk_bf16_f32 v72, v72, v73
  ds_write_b32 v47, v72
  s_waitcnt lgkmcnt(0)
  s_barrier
  ds_read_b128 v[52:55], v35 offset:0
  ds_read_b128 v[56:59], v35 offset:64
  ds_read_b128 v[60:63], v35 offset:128
  ds_read_b128 v[64:67], v35 offset:192
  s_waitcnt lgkmcnt(3)
  v_mfma_f32_16x16x32_bf16 v[80:83], v[112:115], v[52:55], 0
  v_mfma_f32_16x16x32_bf16 v[84:87], v[128:131], v[52:55], 0
  s_waitcnt lgkmcnt(2)
  v_mfma_f32_16x16x32_bf16 v[80:83], v[116:119], v[56:59], v[80:83]
  v_mfma_f32_16x16x32_bf16 v[84:87], v[132:135], v[56:59], v[84:87]
  s_waitcnt lgkmcnt(1)
  v_mfma_f32_16x16x32_bf16 v[80:83], v[120:123], v[60:63], v[80:83]
  v_mfma_f32_16x16x32_bf16 v[84:87], v[136:139], v[60:63], v[84:87]
  s_waitcnt lgkmcnt(0)
  v_mfma_f32_16x16x32_bf16 v[80:83], v[124:127], v[64:67], v[80:83]
  v_mfma_f32_16x16x32_bf16 v[84:87], v[140:143], v[64:67], v[84:87]
  s_nop 6
  v_mul_f32 v80, 0x3e0293ee, v80
  v_mul_f32 v81, 0x3e0293ee, v81
  v_mul_f32 v82, 0x3e0293ee, v82
  v_mul_f32 v83, 0x3e0293ee, v83
  v_mul_f32 v84, 0x3e0293ee, v84
  v_mul_f32 v85, 0x3e0293ee, v85
  v_mul_f32 v86, 0x3e0293ee, v86
  v_mul_f32 v87, 0x3e0293ee, v87
  v_cvt_pk_bf16_f32 v20, v80, v81
  v_cvt_pk_bf16_f32 v21, v82, v83
  v_cvt_pk_bf16_f32 v22, v84, v85
  v_cvt_pk_bf16_f32 v23, v86, v87
  s_nop 0
  v_permlane16_swap_b32 v20, v22
  v_permlane16_swap_b32 v21, v23
  v_bfi_b32 v20, s53, v68, v20
  v_bfi_b32 v21, s53, v69, v21
  v_bfi_b32 v22, s53, v70, v22
  v_bfi_b32 v23, s53, v71, v23
  s_mov_b32 exec_lo, 0x10001
  s_mov_b32 exec_hi, 0x10001
  buffer_store_dwordx4 v[20:23], v39, s[32:35], s84 offen sc1
  s_mov_b64 exec, -1
  s_barrier
  s_lshr_b32 s92, s3, 2
  s_lshl_b32 s93, s92, 12
  s_xor_b32 s93, s93, 65536
  s_xor_b32 m0, s91, s93
  s_lshl_b32 s93, s92, 14
  s_xor_b32 s93, s93, 512
  s_xor_b32 s101, s90, s93
  buffer_load_dwordx4 v244, s[36:39], s101 offen offset:0 nt lds
  buffer_load_dwordx4 v245, s[36:39], s101 offen offset:1024 nt lds
  buffer_load_dwordx4 v246, s[36:39], s101 offen offset:2048 nt lds
  buffer_load_dwordx4 v247, s[36:39], s101 offen offset:3072 nt lds
  s_lshr_b32 s92, s3, 2
  s_lshl_b32 s93, s92, 12
  s_xor_b32 s93, s93, 98304
  s_xor_b32 m0, s91, s93
  s_lshl_b32 s93, s92, 14
  s_xor_b32 s93, s93, 768
  s_xor_b32 s101, s90, s93
  buffer_load_dwordx4 v244, s[36:39], s101 offen offset:0 nt lds
  buffer_load_dwordx4 v245, s[36:39], s101 offen offset:1024 nt lds
  buffer_load_dwordx4 v246, s[36:39], s101 offen offset:2048 nt lds
  buffer_load_dwordx4 v247, s[36:39], s101 offen offset:3072 nt lds
  s_cmp_ge_u32 s3, 4
  s_cbranch_scc0 L_kf
  s_branch L_back
L_kf:
  s_barrier
  s_branch L_setup
L_Bback2:
  s_mov_b32 s54, 0x05040100
  s_mov_b32 s55, 0x07060302
  s_mov_b32 s56, 0x0c0c0400
  s_mov_b32 s57, 0x0c040100
  s_mov_b32 s58, 0x04020100
  s_mov_b32 s53, 0x10001
  v_mov_b32 v2, 0xffffff00
  s_lshr_b32 s77, s2, 5
  s_and_b32 s78, s2, 127
  s_and_b32 s76, s2, 7
  s_lshl_b32 s76, s76, 2
  s_bfe_u32 s97, s2, 0x20003
  s_add_u32 s76, s76, s97
  s_and_b32 s79, s2, 7
  s_lshl_b32 s79, s79, 1
  s_bfe_u32 s97, s2, 0x10003
  s_add_u32 s79, s79, s97
  s_bfe_u32 s80, s2, 0x30004
  s_bfe_u32 s17, s2, 0x20003
  s_bfe_u32 s59, s2, 0x10004
  s_lshl_b32 s59, s59, 14
  s_lshl_b32 s81, s95, 2
  s_add_u32 s81, s81, s94
  s_lshl_b32 s81, s81, 8
  s_add_u32 s81, s81, 0
  v_and_b32 v8, 7, v1
  v_lshlrev_b32 v8, 2, v8
  v_lshrrev_b32 v9, 4, v1
  v_add_u32 v8, v8, v9
  v_lshlrev_b32 v8, 5, v8
  s_lshl_b32 s92, s3, 2
  s_add_u32 s92, s92, 139248
  v_add_u32 v8, s92, v8
  v_lshlrev_b32 v9, 6, v1
  v_add_u32 v9, 139264, v9
  v_lshlrev_b32 v10, 4, v1
  s_bitcmp1_b32 s2, 6
  s_cbranch_scc1 L_nou0b
  s_waitcnt vmcnt(4)
  v_mov_b32 v253, 0
  global_load_dword v252, v253, s[30:31] sc1
  v_lshlrev_b32 v120, 16, v112
  v_and_b32 v121, 0xffff0000, v112
  v_lshlrev_b32 v122, 16, v113
  v_and_b32 v123, 0xffff0000, v113
  v_mul_f32 v116, 0xbfb8aa3b, v120
  v_mul_f32 v117, 0xbfb8aa3b, v121
  v_mul_f32 v118, 0xbfb8aa3b, v122
  v_mul_f32 v119, 0xbfb8aa3b, v123
  v_exp_f32 v116, v116
  v_exp_f32 v117, v117
  v_exp_f32 v118, v118
  v_exp_f32 v119, v119
  v_add_f32 v116, 1.0, v116
  v_add_f32 v117, 1.0, v117
  v_add_f32 v118, 1.0, v118
  v_add_f32 v119, 1.0, v119
  v_rcp_f32 v116, v116
  v_rcp_f32 v117, v117
  v_rcp_f32 v118, v118
  v_rcp_f32 v119, v119
  v_mul_f32 v120, v120, v116
  v_mul_f32 v121, v121, v117
  v_mul_f32 v122, v122, v118
  v_mul_f32 v123, v123, v119
  v_cvt_pk_bf16_f32 v120, v120, v120
  v_cvt_pk_bf16_f32 v121, v121, v121
  v_cvt_pk_bf16_f32 v122, v122, v122
  v_cvt_pk_bf16_f32 v123, v123, v123
  v_lshrrev_b32 v116, 16, v120
  v_lshrrev_b32 v117, 16, v121
  v_lshrrev_b32 v118, 16, v122
  v_lshrrev_b32 v119, 16, v123
  v_and_b32 v120, 0xffff0000, v120
  v_and_b32 v121, 0xffff0000, v121
  v_and_b32 v122, 0xffff0000, v122
  v_and_b32 v123, 0xffff0000, v123
  v_mov_b32 v96, 0
  v_mov_b32 v97, 0
  v_mov_b32 v98, 0
  v_mov_b32 v99, 0
  v_mov_b32 v100, 0
  v_mov_b32 v101, 0
  v_mov_b32 v102, 0
  v_mov_b32 v103, 0
  s_waitcnt vmcnt(4)
  v_dot2c_f32_bf16 v96, v116, v124
  v_dot2c_f32_bf16 v97, v120, v124
  v_dot2c_f32_bf16 v98, v116, v125
  v_dot2c_f32_bf16 v99, v120, v125
  v_dot2c_f32_bf16 v100, v116, v126
  v_dot2c_f32_bf16 v101, v120, v126
  v_dot2c_f32_bf16 v102, v116, v127
  v_dot2c_f32_bf16 v103, v120, v127
  s_waitcnt vmcnt(3)
  v_dot2c_f32_bf16 v96, v117, v128
  v_dot2c_f32_bf16 v97, v121, v128
  v_dot2c_f32_bf16 v98, v117, v129
  v_dot2c_f32_bf16 v99, v121, v129
  v_dot2c_f32_bf16 v100, v117, v130
  v_dot2c_f32_bf16 v101, v121, v130
  v_dot2c_f32_bf16 v102, v117, v131
  v_dot2c_f32_bf16 v103, v121, v131
  s_waitcnt vmcnt(2)
  v_dot2c_f32_bf16 v96, v118, v132
  v_dot2c_f32_bf16 v97, v122, v132
  v_dot2c_f32_bf16 v98, v118, v133
  v_dot2c_f32_bf16 v99, v122, v133
  v_dot2c_f32_bf16 v100, v118, v134
  v_dot2c_f32_bf16 v101, v122, v134
  v_dot2c_f32_bf16 v102, v118, v135
  v_dot2c_f32_bf16 v103, v122, v135
  s_waitcnt vmcnt(1)
  v_dot2c_f32_bf16 v96, v119, v136
  v_dot2c_f32_bf16 v97, v123, v136
  v_dot2c_f32_bf16 v98, v119, v137
  v_dot2c_f32_bf16 v99, v123, v137
  v_dot2c_f32_bf16 v100, v119, v138
  v_dot2c_f32_bf16 v101, v123, v138
  v_dot2c_f32_bf16 v102, v119, v139
  v_dot2c_f32_bf16 v103, v123, v139
  v_permlane32_swap_b32 v96, v100
  v_permlane32_swap_b32 v97, v101
  v_permlane32_swap_b32 v98, v102
  v_permlane32_swap_b32 v99, v103
  v_add_f32 v96, v96, v100
  v_add_f32 v97, v97, v101
  v_add_f32 v98, v98, v102
  v_add_f32 v99, v99, v103
  s_nop 0
  v_permlane16_swap_b32 v96, v98
  v_permlane16_swap_b32 v97, v99
  v_add_f32 v96, v96, v98
  v_add_f32 v97, v97, v99
  s_nop 0
  v_add_f32_dpp v96, v96, v96 row_ror:8 row_mask:0xf bank_mask:0xf
  v_add_f32_dpp v97, v97, v97 row_ror:8 row_mask:0xf bank_mask:0xf
  s_mov_b32 s100, 0
  s_waitcnt vmcnt(0)
  s_branch L_epc_15
L_ep_14:
  global_load_dword v252, v253, s[30:31] sc1
  s_add_u32 s100, s100, 1
  s_cmp_gt_u32 s100, 1000000
  s_cbranch_scc1 L_abort
  s_waitcnt vmcnt(0)
L_epc_15:
  v_readfirstlane_b32 s48, v252
  s_nop 0
  s_cmp_eq_u32 s48, 0
  s_nop 1
  s_cbranch_scc1 L_ep_14
  s_mul_i32 s48, s48, 0x9e3779b1
  s_and_b32 s49, s48, 0xff
  s_bfe_u32 s50, s48, 0x80008
  s_bfe_u32 s51, s48, 0x80010
  s_lshr_b32 s52, s48, 24
  ds_write2_b32 v8, v96, v97 offset0:0 offset1:4
  s_waitcnt lgkmcnt(0)
  s_barrier
  s_cmp_lg_u32 s3, 4
  s_cbranch_scc1 L_nopub_16
  s_mov_b64 exec, 0xffff
  ds_read_b128 v[124:127], v9 offset:0
  ds_read_b128 v[128:131], v9 offset:16
  ds_read_b128 v[132:135], v9 offset:32
  ds_read_b128 v[136:139], v9 offset:48
  s_waitcnt lgkmcnt(3)
  v_add_f32 v124, v124, v125
  v_add_f32 v126, v126, v127
  v_add_f32 v124, v124, v126
  s_waitcnt lgkmcnt(2)
  v_add_f32 v128, v128, v129
  v_add_f32 v130, v130, v131
  v_add_f32 v128, v128, v130
  s_waitcnt lgkmcnt(1)
  v_add_f32 v132, v132, v133
  v_add_f32 v134, v134, v135
  v_add_f32 v132, v132, v134
  s_waitcnt lgkmcnt(0)
  v_add_f32 v136, v136, v137
  v_add_f32 v138, v138, v139
  v_add_f32 v136, v136, v138
  v_and_or_b32 v100, v124, v2, s49
  v_and_or_b32 v101, v128, v2, s50
  v_and_or_b32 v102, v132, v2, s51
  v_and_or_b32 v103, v136, v2, s52
  buffer_store_dwordx4 v[100:103], v10, s[32:35], s81 offen sc1
L_nopub_16:
  s_mov_b64 exec, -1
  s_barrier
  s_branch L_nou0c
L_nou0b:
  s_barrier
  s_barrier
  s_mov_b32 s100, 0
  v_mov_b32 v253, 0
L_ep_17:
  global_load_dword v252, v253, s[30:31] sc1
  s_add_u32 s100, s100, 1
  s_cmp_gt_u32 s100, 1000000
  s_cbranch_scc1 L_abort
  s_waitcnt vmcnt(0)
L_epc_18:
  v_readfirstlane_b32 s48, v252
  s_nop 0
  s_cmp_eq_u32 s48, 0
  s_nop 1
  s_cbranch_scc1 L_ep_17
  s_mul_i32 s48, s48, 0x9e3779b1
  s_and_b32 s49, s48, 0xff
  s_bfe_u32 s50, s48, 0x80008
  s_bfe_u32 s51, s48, 0x80010
  s_lshr_b32 s52, s48, 24
L_nou0c:
  s_lshr_b32 s97, s48, 15
  s_xor_b32 s97, s97, s48
  s_mul_i32 s97, s97, 0x85ebca6b
  v_mov_b32 v4, s48
  v_mov_b32 v5, s97
  v_mov_b32 v249, s48
  v_mov_b32 v250, s97
  v_and_b32 v6, 4, v1
  v_cmp_eq_u32 vcc, 0, v6
  v_and_b32 v7, 3, v1
  v_lshlrev_b32 v7, 2, v7
  v_cndmask_b32 v4, v5, v4, vcc
  v_lshrrev_b32 v4, v7, v4
  v_lshrrev_b32 v5, 1, v4
  v_lshrrev_b32 v6, 2, v4
  v_lshrrev_b32 v7, 3, v4
  v_lshrrev_b32 v245, 4, v1
  v_and_b32 v246, 15, v1
  v_lshlrev_b32 v247, 2, v245
  v_xor_b32 v246, v246, v247
  v_lshlrev_b32 v246, 4, v246
  v_lshl_add_u32 v244, v245, 10, v246
  v_xor_b32 v245, 16, v244
  v_xor_b32 v246, 32, v244
  v_xor_b32 v247, 48, v244
  v_add_u32 v245, 3072, v245
  v_add_u32 v246, 6144, v246
  v_add_u32 v247, 9216, v247
  s_and_b32 s91, s3, 3
  s_lshl_b32 s90, s91, 15
  s_lshl_b32 s91, s91, 13
  s_lshl_b32 s92, s2, 17
  s_add_u32 s90, s90, s92
  s_bfe_u32 s93, s2, 0x20003
  s_lshl_b32 s92, s93, 15
  s_add_u32 s91, s91, s92
  s_lshl_b32 s92, s93, 8
  s_add_u32 s90, s90, s92
  s_mov_b64 s[36:37], s[6:7]
  s_mov_b32 s38, 0x2000000
  s_mov_b32 s39, 0x20000
  v_lshlrev_b32 v12, 21, v1
  v_add_u32 v12, 0xf000, v12
  s_mov_b64 exec, 0x3f
  buffer_load_dword v254, v12, s[32:35], 0 offen
  s_mov_b64 exec, -1
  s_cmp_lg_u32 s3, 5
  s_cbranch_scc1 L_nwt
  v_lshlrev_b32 v12, 7, v1
  s_mov_b32 exec_hi, 0
  s_and_b32 s93, s2, 7
  s_lshl_b32 s93, s93, 1
  s_bfe_u32 s97, s2, 0x10003
  s_add_u32 s93, s93, s97
  s_sub_u32 s94, s78, 56
  s_cmp_ge_u32 s78, 56
  s_cselect_b32 s94, s94, s78
  s_lshl_b32 s92, s76, 12
  s_add_u32 s92, s92, 262144
  buffer_load_dword v254, v12, s[32:35], s92 offen sc1
  s_mul_i32 s92, s93, 4224
  s_add_u32 s92, s92, 393216
  buffer_load_dword v254, v12, s[32:35], s92 offen sc1
  s_lshl_b32 s92, s94, 12
  s_add_u32 s92, s92, 851968
  buffer_load_dword v254, v12, s[32:35], s92 offen sc1
  s_mov_b32 exec_lo, 0xffff
  s_mul_i32 s94, s94, 37
  s_lshr_b32 s94, s94, 8
  s_lshl_b32 s92, s94, 11
  s_add_u32 s92, s92, 98304
  buffer_load_dword v254, v12, s[32:35], s92 offen sc1
  v_lshlrev_b32 v14, 9, v1
  s_bfe_u32 s92, s2, 0x40003
  s_lshl_b32 s92, s92, 13
  s_lshr_b32 s97, s76, 3
  s_lshl_b32 s97, s97, 7
  s_add_u32 s92, s92, s97
  s_add_u32 s92, s92, 131072
  buffer_load_dword v254, v14, s[32:35], s92 offen sc1
  s_mov_b64 exec, -1
  s_mul_i32 s92, s93, 8448
  s_add_u32 s92, s92, 655360
  buffer_load_dword v254, v12, s[32:35], s92 offen sc1
  s_and_b32 s92, s2, 7
  s_lshl_b32 s92, s92, 13
  s_add_u32 s92, s92, 524288
  buffer_load_dword v254, v12, s[32:35], s92 offen sc1
L_nwt:
  s_and_b32 s81, s3, 3
  s_lshl_b32 s81, s81, 13
  s_add_u32 s81, s81, 65536
  v_lshlrev_b32 v8, 4, v1
  s_add_u32 s82, s81, 4096
  v_lshrrev_b32 v9, 4, v1
  v_lshlrev_b32 v9, 13, v9
  v_and_b32 v3, 15, v1
  v_lshl_add_u32 v9, v3, 4, v9
  s_and_b32 s93, s3, 3
  s_lshl_b32 s93, s93, 11
  s_and_b32 s97, s3, 1
  s_lshl_b32 s97, s97, 5
  s_add_u32 s93, s93, s97
  s_add_u32 s93, s93, 131072
  v_xor_b32 v9, s93, v9
  s_cmp_ge_u32 s2, 136
  s_cbranch_scc1 L_nwq
  buffer_load_dwordx4 v[48:51], v8, s[32:35], s81 offen offset:0 sc1
  buffer_load_dwordx4 v[52:55], v8, s[32:35], s81 offen offset:1024 sc1
  buffer_load_dwordx4 v[56:59], v8, s[32:35], s81 offen offset:2048 sc1
  buffer_load_dwordx4 v[60:63], v8, s[32:35], s81 offen offset:3072 sc1
  buffer_load_dwordx4 v[64:67], v8, s[32:35], s82 offen offset:0 sc1
  buffer_load_dwordx4 v[68:71], v8, s[32:35], s82 offen offset:1024 sc1
  buffer_load_dwordx4 v[72:75], v8, s[32:35], s82 offen offset:2048 sc1
  buffer_load_dwordx4 v[76:79], v8, s[32:35], s82 offen offset:3072 sc1
L_nwq:
  s_xor_b32 m0, s91, 4096
  s_xor_b32 s101, s90, 16384
  buffer_load_dwordx4 v244, s[36:39], s101 offen offset:0 nt lds
  s_waitcnt vmcnt(1)
  buffer_load_dwordx4 v245, s[36:39], s101 offen offset:1024 nt lds
  s_waitcnt vmcnt(1)
  buffer_load_dwordx4 v246, s[36:39], s101 offen offset:2048 nt lds
  s_waitcnt vmcnt(1)
  buffer_load_dwordx4 v247, s[36:39], s101 offen offset:3072 nt lds
  s_waitcnt vmcnt(1)
  s_xor_b32 m0, s91, 36864
  s_xor_b32 s101, s90, 16640
  buffer_load_dwordx4 v244, s[36:39], s101 offen offset:0 nt lds
  buffer_load_dwordx4 v245, s[36:39], s101 offen offset:1024 nt lds
  buffer_load_dwordx4 v246, s[36:39], s101 offen offset:2048 nt lds
  buffer_load_dwordx4 v247, s[36:39], s101 offen offset:3072 nt lds
  s_xor_b32 m0, s91, 69632
  s_xor_b32 s101, s90, 16896
  buffer_load_dwordx4 v244, s[36:39], s101 offen offset:0 nt lds
  buffer_load_dwordx4 v245, s[36:39], s101 offen offset:1024 nt lds
  buffer_load_dwordx4 v246, s[36:39], s101 offen offset:2048 nt lds
  buffer_load_dwordx4 v247, s[36:39], s101 offen offset:3072 nt lds
  s_xor_b32 m0, s91, 102400
  s_xor_b32 s101, s90, 17152
  buffer_load_dwordx4 v244, s[36:39], s101 offen offset:0 nt lds
  buffer_load_dwordx4 v245, s[36:39], s101 offen offset:1024 nt lds
  buffer_load_dwordx4 v246, s[36:39], s101 offen offset:2048 nt lds
  buffer_load_dwordx4 v247, s[36:39], s101 offen offset:3072 nt lds
  s_mov_b64 s[40:41], s[26:27]
  s_mov_b32 s42, 0x300000
  s_mov_b32 s43, 0x20000
  v_lshrrev_b32 v13, 3, v1
  v_mul_u32_u24 v13, 24576, v13
  v_and_b32 v3, 7, v1
  v_lshl_add_u32 v13, v3, 4, v13
  s_lshr_b32 s94, s78, 5
  s_lshl_b32 s94, s94, 2
  s_and_b32 s97, s3, 3
  s_add_u32 s94, s94, s97
  s_lshl_b32 s95, s94, 6
  v_lshrrev_b32 v14, 3, v1
  v_lshlrev_b32 v14, 3, v14
  v_add_u32 v14, s95, v14
  s_mul_i32 s92, s94, 196608
  s_and_b32 s97, s2, 31
  s_lshl_b32 s97, s97, 7
  s_add_u32 s92, s92, s97
  s_add_u32 s92, s92, 2048
  global_load_dwordx2 v[144:145], v14, s[24:25]
  buffer_load_dwordx4 v[128:131], v13, s[40:43], s92 offen nt
  s_add_u32 s92, s92, 6144
  buffer_load_dwordx4 v[132:135], v13, s[40:43], s92 offen nt
  s_add_u32 s92, s92, 6144
  buffer_load_dwordx4 v[136:139], v13, s[40:43], s92 offen nt
  s_add_u32 s92, s92, 6144
  buffer_load_dwordx4 v[140:143], v13, s[40:43], s92 offen nt
  v_lshrrev_b32 v253, 4, v1
  v_lshlrev_b32 v253, 13, v253
  v_and_b32 v3, 15, v1
  v_lshl_add_u32 v253, v3, 4, v253
  s_lshl_b32 s88, s77, 19
  s_bfe_u32 s97, s3, 0x10001
  s_lshl_b32 s97, s97, 18
  s_add_u32 s88, s88, s97
  s_and_b32 s97, s3, 1
  s_lshl_b32 s97, s97, 15
  s_add_u32 s88, s88, s97
  s_lshl_b32 s97, s76, 8
  s_add_u32 s88, s88, s97
  v_lshrrev_b32 v251, 5, v1
  v_mul_u32_u24 v251, 3584, v251
  v_and_b32 v3, 31, v1
  v_lshl_add_u32 v251, v3, 4, v251
  s_mul_i32 s89, s79, 114688
  s_and_b32 s97, s3, 3
  s_mul_i32 s97, s97, 28672
  s_add_u32 s89, s89, s97
  s_mul_i32 s97, s80, 448
  s_add_u32 s89, s89, s97
  s_barrier
  s_branch L_back1
L_back:
  v_lshlrev_b32 v12, 21, v1
  v_add_u32 v12, 0xf000, v12
  s_mov_b64 exec, 0x3f
  buffer_load_dword v254, v12, s[32:35], 0 offen
  s_mov_b64 exec, -1
  s_and_b32 s81, s3, 3
  s_lshl_b32 s81, s81, 13
  s_add_u32 s81, s81, 65536
  v_lshlrev_b32 v8, 4, v1
  s_add_u32 s82, s81, 4096
  v_lshrrev_b32 v9, 4, v1
  v_lshlrev_b32 v9, 13, v9
  v_and_b32 v3, 15, v1
  v_lshl_add_u32 v9, v3, 4, v9
  s_and_b32 s93, s3, 3
  s_lshl_b32 s93, s93, 11
  s_and_b32 s97, s3, 1
  s_lshl_b32 s97, s97, 5
  s_add_u32 s93, s93, s97
  s_add_u32 s93, s93, 131072
  v_xor_b32 v9, s93, v9
  v_lshrrev_b32 v253, 4, v1
  v_lshlrev_b32 v253, 13, v253
  v_and_b32 v3, 15, v1
  v_lshl_add_u32 v253, v3, 4, v253
  s_lshl_b32 s88, s77, 19
  s_bfe_u32 s97, s3, 0x10001
  s_lshl_b32 s97, s97, 18
  s_add_u32 s88, s88, s97
  s_and_b32 s97, s3, 1
  s_lshl_b32 s97, s97, 15
  s_add_u32 s88, s88, s97
  s_lshl_b32 s97, s76, 8
  s_add_u32 s88, s88, s97
  v_lshrrev_b32 v251, 4, v1
  v_lshlrev_b32 v251, 10, v251
  v_and_b32 v3, 15, v1
  v_lshl_add_u32 v251, v3, 4, v251
  s_lshl_b32 s89, s76, 17
  s_and_b32 s97, s3, 3
  s_lshl_b32 s97, s97, 15
  s_add_u32 s89, s89, s97
  s_lshl_b32 s97, s77, 8
  s_add_u32 s89, s89, s97
  s_barrier
L_back1:
  buffer_load_dwordx4 v[48:51], v8, s[32:35], s81 offen offset:0 sc1
  buffer_load_dwordx4 v[52:55], v8, s[32:35], s81 offen offset:1024 sc1
  buffer_load_dwordx4 v[56:59], v8, s[32:35], s81 offen offset:2048 sc1
  buffer_load_dwordx4 v[60:63], v8, s[32:35], s81 offen offset:3072 sc1
  buffer_load_dwordx4 v[64:67], v8, s[32:35], s82 offen offset:0 sc1
  buffer_load_dwordx4 v[68:71], v8, s[32:35], s82 offen offset:1024 sc1
  buffer_load_dwordx4 v[72:75], v8, s[32:35], s82 offen offset:2048 sc1
  buffer_load_dwordx4 v[76:79], v8, s[32:35], s82 offen offset:3072 sc1
  s_branch L_setup
L_back2:
  s_mov_b64 s[60:61], -1
  s_mov_b64 s[62:63], -1
  s_mov_b64 s[64:65], -1
  s_mov_b64 s[66:67], -1
  s_mov_b64 s[68:69], -1
  s_mov_b64 s[70:71], -1
  s_mov_b64 s[72:73], -1
  s_mov_b64 s[74:75], -1
  s_waitcnt vmcnt(0)
  s_mov_b32 s100, 0
  s_branch L_gc_21
L_g_19:
  s_add_u32 s100, s100, 1
  s_cmp_gt_u32 s100, 1000000
  s_cbranch_scc1 L_abort
  s_mov_b32 s92, 0
  s_cmp_lg_u32 s74, 0
  s_cselect_b32 s92, 7168, s92
  s_cmp_lg_u32 s72, 0
  s_cselect_b32 s92, 6144, s92
  s_cmp_lg_u32 s70, 0
  s_cselect_b32 s92, 5120, s92
  s_cmp_lg_u32 s68, 0
  s_cselect_b32 s92, 4096, s92
  s_cmp_lg_u32 s66, 0
  s_cselect_b32 s92, 3072, s92
  s_cmp_lg_u32 s64, 0
  s_cselect_b32 s92, 2048, s92
  s_cmp_lg_u32 s62, 0
  s_cselect_b32 s92, 1024, s92
  s_cmp_lg_u32 s60, 0
  s_cselect_b32 s92, 0, s92
  s_add_u32 s92, s92, s81
  s_mov_b64 exec, -1
L_qg_22:
  buffer_load_dwordx4 v[16:19], v8, s[32:35], s92 offen sc1
  s_add_u32 s100, s100, 1
  s_cmp_gt_u32 s100, 1000000
  s_cbranch_scc1 L_abort
  s_waitcnt vmcnt(0)
  v_xor_b32 v16, v16, v4
  v_bitop3_b32 v16, v17, v5, v16 bitop3:0xbe
  v_bitop3_b32 v16, v18, v6, v16 bitop3:0xbe
  v_bitop3_b32 v16, v19, v7, v16 bitop3:0xbe
  v_and_b32 v16, s53, v16
  v_cmp_ne_u32 vcc, 0, v16
  s_nop 0
  s_cbranch_vccz L_qg_22x
  s_sleep 4
  s_branch L_qg_22
L_qg_22x:
L_gf_20:
  s_mov_b64 exec, s[60:61]
  s_cbranch_execz L_gs_23
  buffer_load_dwordx4 v[48:51], v8, s[32:35], s81 offen offset:0 sc1
L_gs_23:
  s_mov_b64 exec, s[62:63]
  s_cbranch_execz L_gs_24
  buffer_load_dwordx4 v[52:55], v8, s[32:35], s81 offen offset:1024 sc1
L_gs_24:
  s_mov_b64 exec, s[64:65]
  s_cbranch_execz L_gs_25
  buffer_load_dwordx4 v[56:59], v8, s[32:35], s81 offen offset:2048 sc1
L_gs_25:
  s_mov_b64 exec, s[66:67]
  s_cbranch_execz L_gs_26
  buffer_load_dwordx4 v[60:63], v8, s[32:35], s81 offen offset:3072 sc1
L_gs_26:
  s_mov_b64 exec, s[68:69]
  s_cbranch_execz L_gs_27
  buffer_load_dwordx4 v[64:67], v8, s[32:35], s82 offen offset:0 sc1
L_gs_27:
  s_mov_b64 exec, s[70:71]
  s_cbranch_execz L_gs_28
  buffer_load_dwordx4 v[68:71], v8, s[32:35], s82 offen offset:1024 sc1
L_gs_28:
  s_mov_b64 exec, s[72:73]
  s_cbranch_execz L_gs_29
  buffer_load_dwordx4 v[72:75], v8, s[32:35], s82 offen offset:2048 sc1
L_gs_29:
  s_mov_b64 exec, s[74:75]
  s_cbranch_execz L_gs_30
  buffer_load_dwordx4 v[76:79], v8, s[32:35], s82 offen offset:3072 sc1
L_gs_30:
  s_waitcnt vmcnt(0)
L_gc_21:
  s_mov_b64 exec, s[60:61]
  v_xor_b32 v44, v48, v4
  v_bitop3_b32 v44, v49, v5, v44 bitop3:0xbe
  v_bitop3_b32 v44, v50, v6, v44 bitop3:0xbe
  v_bitop3_b32 v44, v51, v7, v44 bitop3:0xbe
  v_and_b32 v44, s53, v44
  v_cmp_ne_u32 s[60:61], 0, v44
  s_nop 0
  s_cmp_lg_u64 s[60:61], 0
  s_cselect_b64 s[60:61], -1, 0
  s_mov_b64 exec, s[62:63]
  v_xor_b32 v44, v52, v4
  v_bitop3_b32 v44, v53, v5, v44 bitop3:0xbe
  v_bitop3_b32 v44, v54, v6, v44 bitop3:0xbe
  v_bitop3_b32 v44, v55, v7, v44 bitop3:0xbe
  v_and_b32 v44, s53, v44
  v_cmp_ne_u32 s[62:63], 0, v44
  s_nop 0
  s_cmp_lg_u64 s[62:63], 0
  s_cselect_b64 s[62:63], -1, 0
  s_mov_b64 exec, s[64:65]
  v_xor_b32 v44, v56, v4
  v_bitop3_b32 v44, v57, v5, v44 bitop3:0xbe
  v_bitop3_b32 v44, v58, v6, v44 bitop3:0xbe
  v_bitop3_b32 v44, v59, v7, v44 bitop3:0xbe
  v_and_b32 v44, s53, v44
  v_cmp_ne_u32 s[64:65], 0, v44
  s_nop 0
  s_cmp_lg_u64 s[64:65], 0
  s_cselect_b64 s[64:65], -1, 0
  s_mov_b64 exec, s[66:67]
  v_xor_b32 v44, v60, v4
  v_bitop3_b32 v44, v61, v5, v44 bitop3:0xbe
  v_bitop3_b32 v44, v62, v6, v44 bitop3:0xbe
  v_bitop3_b32 v44, v63, v7, v44 bitop3:0xbe
  v_and_b32 v44, s53, v44
  v_cmp_ne_u32 s[66:67], 0, v44
  s_nop 0
  s_cmp_lg_u64 s[66:67], 0
  s_cselect_b64 s[66:67], -1, 0
  s_mov_b64 exec, s[68:69]
  v_xor_b32 v44, v64, v4
  v_bitop3_b32 v44, v65, v5, v44 bitop3:0xbe
  v_bitop3_b32 v44, v66, v6, v44 bitop3:0xbe
  v_bitop3_b32 v44, v67, v7, v44 bitop3:0xbe
  v_and_b32 v44, s53, v44
  v_cmp_ne_u32 s[68:69], 0, v44
  s_nop 0
  s_cmp_lg_u64 s[68:69], 0
  s_cselect_b64 s[68:69], -1, 0
  s_mov_b64 exec, s[70:71]
  v_xor_b32 v44, v68, v4
  v_bitop3_b32 v44, v69, v5, v44 bitop3:0xbe
  v_bitop3_b32 v44, v70, v6, v44 bitop3:0xbe
  v_bitop3_b32 v44, v71, v7, v44 bitop3:0xbe
  v_and_b32 v44, s53, v44
  v_cmp_ne_u32 s[70:71], 0, v44
  s_nop 0
  s_cmp_lg_u64 s[70:71], 0
  s_cselect_b64 s[70:71], -1, 0
  s_mov_b64 exec, s[72:73]
  v_xor_b32 v44, v72, v4
  v_bitop3_b32 v44, v73, v5, v44 bitop3:0xbe
  v_bitop3_b32 v44, v74, v6, v44 bitop3:0xbe
  v_bitop3_b32 v44, v75, v7, v44 bitop3:0xbe
  v_and_b32 v44, s53, v44
  v_cmp_ne_u32 s[72:73], 0, v44
  s_nop 0
  s_cmp_lg_u64 s[72:73], 0
  s_cselect_b64 s[72:73], -1, 0
  s_mov_b64 exec, s[74:75]
  v_xor_b32 v44, v76, v4
  v_bitop3_b32 v44, v77, v5, v44 bitop3:0xbe
  v_bitop3_b32 v44, v78, v6, v44 bitop3:0xbe
  v_bitop3_b32 v44, v79, v7, v44 bitop3:0xbe
  v_and_b32 v44, s53, v44
  v_cmp_ne_u32 s[74:75], 0, v44
  s_nop 0
  s_cmp_lg_u64 s[74:75], 0
  s_cselect_b64 s[74:75], -1, 0
  s_or_b64 s[96:97], s[60:61], s[62:63]
  s_or_b64 s[96:97], s[96:97], s[64:65]
  s_or_b64 s[96:97], s[96:97], s[66:67]
  s_or_b64 s[96:97], s[96:97], s[68:69]
  s_or_b64 s[96:97], s[96:97], s[70:71]
  s_or_b64 s[96:97], s[96:97], s[72:73]
  s_or_b64 s[96:97], s[96:97], s[74:75]
  s_cbranch_scc1 L_g_19
  s_mov_b64 exec, -1
  v_xor_b32 v10, 0, v9
  ds_write_b128 v10, v[48:51] offset:0
  v_xor_b32 v11, 64, v9
  ds_write_b128 v11, v[52:55] offset:256
  v_xor_b32 v10, 128, v9
  ds_write_b128 v10, v[56:59] offset:512
  v_xor_b32 v11, 192, v9
  ds_write_b128 v11, v[60:63] offset:768
  v_xor_b32 v10, 16, v9
  ds_write_b128 v10, v[64:67] offset:1024
  v_xor_b32 v11, 80, v9
  ds_write_b128 v11, v[68:71] offset:1280
  v_xor_b32 v10, 144, v9
  ds_write_b128 v10, v[72:75] offset:1536
  v_xor_b32 v11, 208, v9
  ds_write_b128 v11, v[76:79] offset:1792
  s_mov_b64 s[40:41], s[14:15]
  s_mov_b32 s42, 0x400000
  s_mov_b32 s43, 0x20000
  s_mov_b64 s[44:45], s[12:13]
  s_mov_b32 s46, 0x400000
  s_mov_b32 s47, 0x20000
  s_waitcnt lgkmcnt(0)
  s_setprio 3
  s_barrier
  s_cmp_lt_u32 s2, 128
  s_cbranch_scc0 L_lwB
  buffer_load_dwordx4 v[176:179], v253, s[44:47], s88 offen nt
  s_add_u32 s88, s88, 65536
  buffer_load_dwordx4 v[180:183], v253, s[44:47], s88 offen nt
  s_add_u32 s88, s88, 65536
  buffer_load_dwordx4 v[184:187], v253, s[44:47], s88 offen nt
  s_add_u32 s88, s88, 65536
  buffer_load_dwordx4 v[188:191], v253, s[44:47], s88 offen nt
  buffer_load_dwordx4 v[208:211], v251, s[40:43], s89 offen nt
  s_add_u32 s89, s89, 4096
  buffer_load_dwordx4 v[212:215], v251, s[40:43], s89 offen nt
  s_add_u32 s89, s89, 4096
  buffer_load_dwordx4 v[216:219], v251, s[40:43], s89 offen nt
  s_add_u32 s89, s89, 4096
  buffer_load_dwordx4 v[220:223], v251, s[40:43], s89 offen nt
  s_add_u32 s89, s89, 4096
  buffer_load_dwordx4 v[224:227], v251, s[40:43], s89 offen nt
  s_add_u32 s89, s89, 4096
  buffer_load_dwordx4 v[228:231], v251, s[40:43], s89 offen nt
  s_add_u32 s89, s89, 4096
  buffer_load_dwordx4 v[232:235], v251, s[40:43], s89 offen nt
  s_add_u32 s89, s89, 4096
  buffer_load_dwordx4 v[236:239], v251, s[40:43], s89 offen nt
L_lwX:
  s_barrier
  s_barrier
  s_barrier
  s_branch L_pv
L_lwB:
  buffer_load_dwordx4 v[176:179], v253, s[44:47], s88 offen nt
  s_add_u32 s88, s88, 65536
  buffer_load_dwordx4 v[180:183], v253, s[44:47], s88 offen nt
  s_add_u32 s88, s88, 65536
  buffer_load_dwordx4 v[184:187], v253, s[44:47], s88 offen nt
  s_add_u32 s88, s88, 65536
  buffer_load_dwordx4 v[188:191], v253, s[44:47], s88 offen nt
  s_mov_b64 s[40:41], s[18:19]
  s_mov_b32 s42, 0x1c0000
  s_mov_b32 s43, 0x20000
  s_mov_b64 s[44:45], s[20:21]
  s_mov_b32 s46, 0x1c0000
  s_mov_b32 s47, 0x20000
  s_mov_b32 exec_lo, 0xfffffff
  s_mov_b32 exec_hi, 0xfffffff
  buffer_load_dwordx4 v[208:211], v251, s[40:43], s89 offen nt
  buffer_load_dwordx4 v[212:215], v251, s[44:47], s89 offen nt
  s_add_u32 s89, s89, 7168
  buffer_load_dwordx4 v[216:219], v251, s[40:43], s89 offen nt
  buffer_load_dwordx4 v[220:223], v251, s[44:47], s89 offen nt
  s_add_u32 s89, s89, 7168
  buffer_load_dwordx4 v[224:227], v251, s[40:43], s89 offen nt
  buffer_load_dwordx4 v[228:231], v251, s[44:47], s89 offen nt
  s_add_u32 s89, s89, 7168
  buffer_load_dwordx4 v[232:235], v251, s[40:43], s89 offen nt
  buffer_load_dwordx4 v[236:239], v251, s[44:47], s89 offen nt
  s_mov_b64 exec, -1
  s_and_b32 s74, s2, 31
  s_lshl_b32 s74, s74, 10
  s_lshr_b32 s97, s78, 5
  s_lshl_b32 s97, s97, 8
  s_add_u32 s74, s74, s97
  s_add_u32 s74, s74, 16384
  v_and_b32 v13, 7, v1
  v_lshlrev_b32 v13, 2, v13
  v_lshrrev_b32 v14, 4, v1
  v_add_u32 v13, v13, v14
  v_lshlrev_b32 v13, 5, v13
  s_lshl_b32 s92, s3, 2
  s_add_u32 s92, s92, 141296
  v_add_u32 v13, s92, v13
  v_lshlrev_b32 v14, 6, v1
  v_add_u32 v14, 141312, v14
  v_lshlrev_b32 v15, 4, v1
  v_xor_b32 v13, s59, v13
  v_xor_b32 v14, s59, v14
  s_waitcnt vmcnt(63)
  v_lshlrev_b32 v116, 16, v144
  v_and_b32 v117, 0xffff0000, v144
  v_lshlrev_b32 v118, 16, v145
  v_and_b32 v119, 0xffff0000, v145
  v_mul_f32 v112, 0xbfb8aa3b, v116
  v_mul_f32 v113, 0xbfb8aa3b, v117
  v_mul_f32 v114, 0xbfb8aa3b, v118
  v_mul_f32 v115, 0xbfb8aa3b, v119
  v_exp_f32 v112, v112
  v_exp_f32 v113, v113
  v_exp_f32 v114, v114
  v_exp_f32 v115, v115
  v_add_f32 v112, 1.0, v112
  v_add_f32 v113, 1.0, v113
  v_add_f32 v114, 1.0, v114
  v_add_f32 v115, 1.0, v115
  v_rcp_f32 v112, v112
  v_rcp_f32 v113, v113
  v_rcp_f32 v114, v114
  v_rcp_f32 v115, v115
  v_mul_f32 v116, v116, v112
  v_mul_f32 v117, v117, v113
  v_mul_f32 v118, v118, v114
  v_mul_f32 v119, v119, v115
  v_cvt_pk_bf16_f32 v116, v116, v116
  v_cvt_pk_bf16_f32 v117, v117, v117
  v_cvt_pk_bf16_f32 v118, v118, v118
  v_cvt_pk_bf16_f32 v119, v119, v119
  v_lshrrev_b32 v112, 16, v116
  v_lshrrev_b32 v113, 16, v117
  v_lshrrev_b32 v114, 16, v118
  v_lshrrev_b32 v115, 16, v119
  v_and_b32 v116, 0xffff0000, v116
  v_and_b32 v117, 0xffff0000, v117
  v_and_b32 v118, 0xffff0000, v118
  v_and_b32 v119, 0xffff0000, v119
  v_mov_b32 v96, 0
  v_mov_b32 v97, 0
  v_mov_b32 v98, 0
  v_mov_b32 v99, 0
  v_mov_b32 v100, 0
  v_mov_b32 v101, 0
  v_mov_b32 v102, 0
  v_mov_b32 v103, 0
  s_waitcnt vmcnt(63)
  v_dot2c_f32_bf16 v96, v112, v128
  v_dot2c_f32_bf16 v97, v116, v128
  v_dot2c_f32_bf16 v98, v112, v129
  v_dot2c_f32_bf16 v99, v116, v129
  v_dot2c_f32_bf16 v100, v112, v130
  v_dot2c_f32_bf16 v101, v116, v130
  v_dot2c_f32_bf16 v102, v112, v131
  v_dot2c_f32_bf16 v103, v116, v131
  s_waitcnt vmcnt(62)
  v_dot2c_f32_bf16 v96, v113, v132
  v_dot2c_f32_bf16 v97, v117, v132
  v_dot2c_f32_bf16 v98, v113, v133
  v_dot2c_f32_bf16 v99, v117, v133
  v_dot2c_f32_bf16 v100, v113, v134
  v_dot2c_f32_bf16 v101, v117, v134
  v_dot2c_f32_bf16 v102, v113, v135
  v_dot2c_f32_bf16 v103, v117, v135
  s_waitcnt vmcnt(61)
  v_dot2c_f32_bf16 v96, v114, v136
  v_dot2c_f32_bf16 v97, v118, v136
  v_dot2c_f32_bf16 v98, v114, v137
  v_dot2c_f32_bf16 v99, v118, v137
  v_dot2c_f32_bf16 v100, v114, v138
  v_dot2c_f32_bf16 v101, v118, v138
  v_dot2c_f32_bf16 v102, v114, v139
  v_dot2c_f32_bf16 v103, v118, v139
  s_waitcnt vmcnt(60)
  v_dot2c_f32_bf16 v96, v115, v140
  v_dot2c_f32_bf16 v97, v119, v140
  v_dot2c_f32_bf16 v98, v115, v141
  v_dot2c_f32_bf16 v99, v119, v141
  v_dot2c_f32_bf16 v100, v115, v142
  v_dot2c_f32_bf16 v101, v119, v142
  v_dot2c_f32_bf16 v102, v115, v143
  v_dot2c_f32_bf16 v103, v119, v143
  v_permlane32_swap_b32 v96, v100
  v_permlane32_swap_b32 v97, v101
  v_permlane32_swap_b32 v98, v102
  v_permlane32_swap_b32 v99, v103
  v_add_f32 v96, v96, v100
  v_add_f32 v97, v97, v101
  v_add_f32 v98, v98, v102
  v_add_f32 v99, v99, v103
  s_nop 0
  v_permlane16_swap_b32 v96, v98
  v_permlane16_swap_b32 v97, v99
  v_add_f32 v96, v96, v98
  v_add_f32 v97, v97, v99
  s_nop 0
  v_add_f32_dpp v96, v96, v96 row_ror:8 row_mask:0xf bank_mask:0xf
  v_add_f32_dpp v97, v97, v97 row_ror:8 row_mask:0xf bank_mask:0xf
  s_barrier
  ds_write2_b32 v13, v96, v97 offset0:0 offset1:4
  s_waitcnt lgkmcnt(0)
  s_barrier
  s_cmp_lg_u32 s3, 4
  s_cbranch_scc1 L_nopub_31
  s_mov_b64 exec, 0xffff
  ds_read_b128 v[128:131], v14 offset:0
  ds_read_b128 v[132:135], v14 offset:16
  ds_read_b128 v[136:139], v14 offset:32
  ds_read_b128 v[140:143], v14 offset:48
  s_waitcnt lgkmcnt(3)
  v_add_f32 v128, v128, v129
  v_add_f32 v130, v130, v131
  v_add_f32 v128, v128, v130
  s_waitcnt lgkmcnt(2)
  v_add_f32 v132, v132, v133
  v_add_f32 v134, v134, v135
  v_add_f32 v132, v132, v134
  s_waitcnt lgkmcnt(1)
  v_add_f32 v136, v136, v137
  v_add_f32 v138, v138, v139
  v_add_f32 v136, v136, v138
  s_waitcnt lgkmcnt(0)
  v_add_f32 v140, v140, v141
  v_add_f32 v142, v142, v143
  v_add_f32 v140, v140, v142
  v_and_or_b32 v100, v128, v2, s49
  v_and_or_b32 v101, v132, v2, s50
  v_and_or_b32 v102, v136, v2, s51
  v_and_or_b32 v103, v140, v2, s52
  buffer_store_dwordx4 v[100:103], v15, s[32:35], s74 offen sc1
L_nopub_31:
  s_mov_b64 exec, -1
  s_barrier
  s_branch L_pv
L_front:
  s_mov_b32 s100, 0
  s_waitcnt vmcnt(4)
  s_branch L_epc_33
L_ep_32:
  global_load_dword v252, v253, s[30:31] sc1
  s_add_u32 s100, s100, 1
  s_cmp_gt_u32 s100, 1000000
  s_cbranch_scc1 L_abort
  s_waitcnt vmcnt(0)
L_epc_33:
  v_readfirstlane_b32 s48, v252
  s_nop 0
  s_cmp_eq_u32 s48, 0
  s_nop 1
  s_cbranch_scc1 L_ep_32
  s_mul_i32 s48, s48, 0x9e3779b1
  s_and_b32 s49, s48, 0xff
  s_bfe_u32 s50, s48, 0x80008
  s_bfe_u32 s51, s48, 0x80010
  s_lshr_b32 s52, s48, 24
  s_lshr_b32 s97, s48, 15
  s_xor_b32 s97, s97, s48
  s_mul_i32 s97, s97, 0x85ebca6b
  v_mov_b32 v4, s48
  v_mov_b32 v5, s97
  v_mov_b32 v249, s48
  v_mov_b32 v250, s97
  v_and_b32 v6, 4, v1
  v_cmp_eq_u32 vcc, 0, v6
  v_and_b32 v7, 3, v1
  v_lshlrev_b32 v7, 2, v7
  v_cndmask_b32 v4, v5, v4, vcc
  v_lshrrev_b32 v4, v7, v4
  v_lshrrev_b32 v5, 1, v4
  v_lshrrev_b32 v6, 2, v4
  v_lshrrev_b32 v7, 3, v4
L_setup:
  s_lshr_b32 s92, s3, 1
  s_lshl_b32 s92, s92, 15
  s_and_b32 s93, s3, 1
  v_lshlrev_b32 v34, 4, v1
  v_bfe_u32 v44, v1, 2, 2
  v_lshrrev_b32 v45, 5, v1
  v_lshl_add_u32 v46, v45, 2, v44
  v_lshlrev_b32 v46, 8, v46
  v_add_u32 v46, s92, v46
  v_and_b32 v47, 1, v1
  v_lshl_add_u32 v46, v47, 3, v46
  v_lshl_or_b32 v44, v44, 2, v45
  v_bfe_u32 v47, v1, 4, 1
  v_lshlrev_b32 v47, 1, v47
  v_xor_b32 v44, v44, v47
  v_bfe_u32 v47, v1, 1, 1
  v_xor_b32 v44, v44, v47
  s_lshl_b32 s94, s93, 3
  v_xor_b32 v44, s94, v44
  v_xor_b32 v47, 0, v44
  v_lshl_add_u32 v24, v47, 4, v46
  v_xor_b32 v47, 2, v44
  v_lshl_add_u32 v25, v47, 4, v46
  v_add_u32 v25, 2048, v25
  v_xor_b32 v47, 4, v44
  v_lshl_add_u32 v26, v47, 4, v46
  v_xor_b32 v47, 6, v44
  v_lshl_add_u32 v27, v47, 4, v46
  v_add_u32 v27, 2048, v27
  v_add_u32 v28, 132096, v34
  v_and_b32 v44, 31, v1
  v_lshlrev_b32 v29, 5, v44
  v_add_u32 v29, 131072, v29
  v_xor_b32 v28, s59, v28
  v_xor_b32 v29, s59, v29
  s_lshl_b32 s94, s93, 7
  s_add_u32 s94, s94, s92
  v_and_b32 v46, 3, v44
  v_lshlrev_b32 v46, 6, v46
  v_lshl_add_u32 v46, v44, 8, v46
  v_bfe_u32 v47, v44, 1, 2
  v_lshlrev_b32 v45, 1, v45
  v_xor_b32 v47, v47, v45
  v_lshl_add_u32 v46, v47, 4, v46
  v_xor_b32 v196, s94, v46
  v_xor_b32 v197, 16, v196
  v_xor_b32 v198, 64, v196
  v_xor_b32 v199, 0x50, v196
  v_lshrrev_b32 v44, 2, v1
  v_and_b32 v46, 3, v44
  v_lshlrev_b32 v46, 6, v46
  v_lshl_add_u32 v46, v44, 8, v46
  v_bfe_u32 v47, v44, 1, 2
  v_and_b32 v45, 3, v1
  v_xor_b32 v47, v47, v45
  v_lshl_add_u32 v46, v47, 4, v46
  v_xor_b32 v32, s94, v46
  v_xor_b32 v33, 64, v32
  v_lshrrev_b32 v248, 2, v1
  v_lshlrev_b32 v248, 7, v248
  v_and_b32 v3, 3, v1
  v_lshl_add_u32 v248, v3, 4, v248
  v_lshrrev_b32 v44, 3, v1
  v_bfe_u32 v45, v1, 2, 1
  v_and_b32 v46, 3, v44
  v_xor_b32 v46, v46, v45
  v_lshlrev_b32 v46, 6, v46
  v_lshl_add_u32 v46, v44, 8, v46
  v_lshrrev_b32 v47, 1, v44
  v_and_b32 v45, 3, v1
  v_xor_b32 v47, v47, v45
  v_lshl_add_u32 v46, v47, 4, v46
  v_xor_b32 v32, s94, v46
  s_mul_i32 s87, s2, 32896
  s_lshl_b32 s97, s3, 12
  s_add_u32 s87, s87, s97
  s_add_u32 s87, s87, 2097152
  s_lshl_b32 s94, s76, 4
  s_lshl_b32 s97, s3, 9
  s_add_u32 s94, s94, s97
  s_add_u32 s94, s94, 131072
  v_lshrrev_b32 v35, 3, v1
  v_lshlrev_b32 v35, 12, v35
  v_add_u32 v35, s94, v35
  v_lshrrev_b32 v36, 3, v1
  v_mul_u32_u24 v36, 263168, v36
  v_and_b32 v3, 7, v1
  v_lshl_add_u32 v36, v3, 4, v36
  s_mul_i32 s94, s3, 32896
  s_lshl_b32 s97, s77, 12
  s_add_u32 s94, s94, s97
  s_lshl_b32 s97, s76, 7
  s_add_u32 s94, s94, s97
  s_add_u32 s83, s94, 6307840
  s_add_u32 s84, s94, 8413184
  s_add_u32 s85, s94, 2097152
  s_add_u32 s86, s94, 4202496
  s_mul_i32 s94, s3, 144
  s_add_u32 s94, s94, 81920
  v_and_b32 v37, 7, v1
  v_lshlrev_b32 v37, 4, v37
  v_lshrrev_b32 v3, 4, v1
  v_lshl_add_u32 v37, v3, 2, v37
  v_add_u32 v37, s94, v37
  v_and_b32 v38, 7, v1
  v_mul_u32_u24 v38, 144, v38
  v_lshrrev_b32 v3, 4, v1
  v_lshl_add_u32 v38, v3, 4, v38
  v_add_u32 v38, 81920, v38
  s_lshl_b32 s94, s3, 7
  s_add_u32 s94, s94, 93184
  v_lshrrev_b32 v41, 4, v1
  v_lshlrev_b32 v41, 4, v41
  v_add_u32 v41, s94, v41
  v_and_b32 v40, 7, v1
  v_mul_u32_u24 v40, 272, v40
  v_lshrrev_b32 v3, 4, v1
  v_lshl_add_u32 v40, v3, 4, v40
  v_add_u32 v40, 94208, v40
  s_lshl_b32 s94, s76, 12
  s_lshl_b32 s97, s3, 6
  s_add_u32 s94, s94, s97
  s_add_u32 s94, s94, 262144
  v_bfe_u32 v39, v1, 2, 3
  v_lshlrev_b32 v39, 9, v39
  v_and_b32 v3, 3, v1
  v_lshl_add_u32 v39, v3, 4, v39
  v_add_u32 v39, s94, v39
  s_lshl_b32 s95, s77, 9
  s_add_u32 s16, s94, s95
  s_and_b32 s94, s3, 3
  s_mul_i32 s94, s94, 4864
  v_lshrrev_b32 v240, 4, v1
  v_mul_u32_u24 v240, 288, v240
  v_and_b32 v3, 15, v1
  v_lshl_add_u32 v240, v3, 4, v240
  v_add_u32 v240, s94, v240
  s_and_b32 s94, s3, 3
  s_mul_i32 s94, s94, 9728
  s_add_u32 s94, s94, 20480
  v_lshrrev_b32 v241, 4, v1
  v_mul_u32_u24 v241, 288, v241
  v_and_b32 v3, 15, v1
  v_lshl_add_u32 v241, v3, 4, v241
  v_add_u32 v241, s94, v241
  s_lshl_b32 s94, s3, 5
  v_lshrrev_b32 v242, 4, v1
  v_mul_u32_u24 v242, 2432, v242
  v_bfe_u32 v3, v1, 2, 2
  v_mul_u32_u24 v3, 288, v3
  v_add_u32 v242, v3, v242
  v_and_b32 v3, 3, v1
  v_lshl_add_u32 v242, v3, 3, v242
  v_add_u32 v242, s94, v242
  v_lshrrev_b32 v243, 4, v1
  v_mul_u32_u24 v243, 2432, v243
  v_bfe_u32 v3, v1, 2, 2
  v_mul_u32_u24 v3, 288, v3
  v_add_u32 v243, v3, v243
  v_and_b32 v3, 3, v1
  v_lshl_add_u32 v243, v3, 3, v243
  v_add_u32 v243, 20480, v243
  v_add_u32 v243, s94, v243
  v_bfe_u32 v43, v1, 2, 3
  v_mul_u32_u24 v43, 272, v43
  v_and_b32 v3, 3, v1
  v_lshl_add_u32 v43, v3, 3, v43
  v_add_u32 v43, 94208, v43
  v_add_u32 v43, s94, v43
  s_cmp_ge_u32 s3, 4
  s_cbranch_scc1 L_back2
  v_and_b32 v44, 31, v1
  v_and_b32 v46, 3, v44
  v_lshlrev_b32 v46, 2, v46
  v_bfe_u32 v47, v44, 2, 2
  v_or_b32 v46, v46, v47
  v_lshrrev_b32 v47, 5, v1
  v_xor_b32 v46, v46, v47
  v_lshlrev_b32 v45, 8, v44
  v_xor_b32 v47, 0, v46
  v_lshl_add_u32 v16, v47, 4, v45
  v_xor_b32 v47, 2, v46
  v_lshl_add_u32 v17, v47, 4, v45
  v_xor_b32 v47, 4, v46
  v_lshl_add_u32 v18, v47, 4, v45
  v_xor_b32 v47, 6, v46
  v_lshl_add_u32 v19, v47, 4, v45
  v_xor_b32 v47, 8, v46
  v_lshl_add_u32 v20, v47, 4, v45
  v_xor_b32 v47, 10, v46
  v_lshl_add_u32 v21, v47, 4, v45
  v_xor_b32 v47, 12, v46
  v_lshl_add_u32 v22, v47, 4, v45
  v_xor_b32 v47, 14, v46
  v_lshl_add_u32 v23, v47, 4, v45
  s_lshl_b32 s92, s17, 13
  s_add_u32 s92, s92, 131072
  v_add_u32 v8, s91, v16
  v_add_u32 v16, s92, v16
  v_add_u32 v9, s91, v17
  v_add_u32 v17, s92, v17
  v_add_u32 v10, s91, v18
  v_add_u32 v18, s92, v18
  v_add_u32 v11, s91, v19
  v_add_u32 v19, s92, v19
  v_add_u32 v12, s91, v20
  v_add_u32 v20, s92, v20
  v_add_u32 v13, s91, v21
  v_add_u32 v21, s92, v21
  v_add_u32 v14, s91, v22
  v_add_u32 v22, s92, v22
  v_add_u32 v15, s91, v23
  v_add_u32 v23, s92, v23
  s_lshl_b32 s92, s3, 2
  v_lshrrev_b32 v47, 5, v1
  v_lshl_add_u32 v30, v47, 4, v29
  v_add_u32 v30, s92, v30
  s_lshl_b32 s92, s3, 11
  v_add_u32 v31, s92, v28
  s_setprio 2
  s_waitcnt vmcnt(4)
  s_barrier
  ds_read_b128 v[112:115], v8
  ds_read_b128 v[116:119], v16
  ds_read_b128 v[120:123], v9
  ds_read_b128 v[124:127], v17
  ds_read_b128 v[128:131], v10
  ds_read_b128 v[132:135], v18
  ds_read_b128 v[136:139], v11
  ds_read_b128 v[140:143], v19
  ds_read_b128 v[144:147], v12
  ds_read_b128 v[148:151], v20
  ds_read_b128 v[152:155], v13
  ds_read_b128 v[156:159], v21
  v_xor_b32 v8, 0x8000, v8
  v_xor_b32 v16, 0x2000, v16
  v_xor_b32 v9, 0x8000, v9
  v_xor_b32 v17, 0x2000, v17
  v_xor_b32 v10, 0x8000, v10
  v_xor_b32 v18, 0x2000, v18
  v_xor_b32 v11, 0x8000, v11
  v_xor_b32 v19, 0x2000, v19
  v_xor_b32 v12, 0x8000, v12
  v_xor_b32 v20, 0x2000, v20
  v_xor_b32 v13, 0x8000, v13
  v_xor_b32 v21, 0x2000, v21
  s_waitcnt lgkmcnt(10)
  v_mfma_f32_32x32x16_bf16 v[96:111], v[112:115], v[116:119], 0
  ds_read_b128 v[160:163], v14
  ds_read_b128 v[164:167], v22
  v_xor_b32 v14, 0x8000, v14
  v_xor_b32 v22, 0x2000, v22
  s_waitcnt lgkmcnt(10)
  v_mfma_f32_32x32x16_bf16 v[96:111], v[120:123], v[124:127], v[96:111]
  ds_read_b128 v[168:171], v15
  ds_read_b128 v[172:175], v23
  v_xor_b32 v15, 0x8000, v15
  v_xor_b32 v23, 0x2000, v23
  s_waitcnt lgkmcnt(10)
  v_mfma_f32_32x32x16_bf16 v[96:111], v[128:131], v[132:135], v[96:111]
  ds_read_b128 v[112:115], v8
  ds_read_b128 v[116:119], v16
  v_xor_b32 v8, 0x18000, v8
  v_xor_b32 v16, 0x6000, v16
  s_waitcnt lgkmcnt(10)
  v_mfma_f32_32x32x16_bf16 v[96:111], v[136:139], v[140:143], v[96:111]
  ds_read_b128 v[120:123], v9
  ds_read_b128 v[124:127], v17
  v_xor_b32 v9, 0x18000, v9
  v_xor_b32 v17, 0x6000, v17
  s_waitcnt lgkmcnt(10)
  v_mfma_f32_32x32x16_bf16 v[96:111], v[144:147], v[148:151], v[96:111]
  ds_read_b128 v[128:131], v10
  ds_read_b128 v[132:135], v18
  v_xor_b32 v10, 0x18000, v10
  v_xor_b32 v18, 0x6000, v18
  s_waitcnt lgkmcnt(10)
  v_mfma_f32_32x32x16_bf16 v[96:111], v[152:155], v[156:159], v[96:111]
  ds_read_b128 v[136:139], v11
  ds_read_b128 v[140:143], v19
  v_xor_b32 v11, 0x18000, v11
  v_xor_b32 v19, 0x6000, v19
  s_waitcnt lgkmcnt(10)
  v_mfma_f32_32x32x16_bf16 v[96:111], v[160:163], v[164:167], v[96:111]
  ds_read_b128 v[144:147], v12
  ds_read_b128 v[148:151], v20
  v_xor_b32 v12, 0x18000, v12
  v_xor_b32 v20, 0x6000, v20
  s_waitcnt lgkmcnt(10)
  v_mfma_f32_32x32x16_bf16 v[96:111], v[168:171], v[172:175], v[96:111]
  ds_read_b128 v[152:155], v13
  ds_read_b128 v[156:159], v21
  v_xor_b32 v13, 0x18000, v13
  v_xor_b32 v21, 0x6000, v21
  s_waitcnt lgkmcnt(10)
  v_mfma_f32_32x32x16_bf16 v[96:111], v[112:115], v[116:119], v[96:111]
  ds_read_b128 v[160:163], v14
  ds_read_b128 v[164:167], v22
  v_xor_b32 v14, 0x18000, v14
  v_xor_b32 v22, 0x6000, v22
  s_waitcnt lgkmcnt(10)
  v_mfma_f32_32x32x16_bf16 v[96:111], v[120:123], v[124:127], v[96:111]
  ds_read_b128 v[168:171], v15
  ds_read_b128 v[172:175], v23
  v_xor_b32 v15, 0x18000, v15
  v_xor_b32 v23, 0x6000, v23
  s_waitcnt lgkmcnt(10)
  v_mfma_f32_32x32x16_bf16 v[96:111], v[128:131], v[132:135], v[96:111]
  ds_read_b128 v[112:115], v8
  ds_read_b128 v[116:119], v16
  v_xor_b32 v8, 0x8000, v8
  v_xor_b32 v16, 0x2000, v16
  s_waitcnt lgkmcnt(10)
  v_mfma_f32_32x32x16_bf16 v[96:111], v[136:139], v[140:143], v[96:111]
  ds_read_b128 v[120:123], v9
  ds_read_b128 v[124:127], v17
  v_xor_b32 v9, 0x8000, v9
  v_xor_b32 v17, 0x2000, v17
  s_waitcnt lgkmcnt(10)
  v_mfma_f32_32x32x16_bf16 v[96:111], v[144:147], v[148:151], v[96:111]
  ds_read_b128 v[128:131], v10
  ds_read_b128 v[132:135], v18
  v_xor_b32 v10, 0x8000, v10
  v_xor_b32 v18, 0x2000, v18
  s_waitcnt lgkmcnt(10)
  v_mfma_f32_32x32x16_bf16 v[96:111], v[152:155], v[156:159], v[96:111]
  ds_read_b128 v[136:139], v11
  ds_read_b128 v[140:143], v19
  v_xor_b32 v11, 0x8000, v11
  v_xor_b32 v19, 0x2000, v19
  s_waitcnt lgkmcnt(10)
  v_mfma_f32_32x32x16_bf16 v[96:111], v[160:163], v[164:167], v[96:111]
  ds_read_b128 v[144:147], v12
  ds_read_b128 v[148:151], v20
  v_xor_b32 v12, 0x8000, v12
  v_xor_b32 v20, 0x2000, v20
  s_waitcnt lgkmcnt(10)
  v_mfma_f32_32x32x16_bf16 v[96:111], v[168:171], v[172:175], v[96:111]
  ds_read_b128 v[152:155], v13
  ds_read_b128 v[156:159], v21
  v_xor_b32 v13, 0x8000, v13
  v_xor_b32 v21, 0x2000, v21
  s_barrier
  s_waitcnt lgkmcnt(10)
  v_mfma_f32_32x32x16_bf16 v[96:111], v[112:115], v[116:119], v[96:111]
  ds_read_b128 v[160:163], v14
  ds_read_b128 v[164:167], v22
  v_xor_b32 v14, 0x8000, v14
  v_xor_b32 v22, 0x2000, v22
  s_waitcnt lgkmcnt(10)
  v_mfma_f32_32x32x16_bf16 v[96:111], v[120:123], v[124:127], v[96:111]
  ds_read_b128 v[168:171], v15
  ds_read_b128 v[172:175], v23
  v_xor_b32 v15, 0x8000, v15
  v_xor_b32 v23, 0x2000, v23
  s_waitcnt lgkmcnt(10)
  v_mfma_f32_32x32x16_bf16 v[96:111], v[128:131], v[132:135], v[96:111]
  s_waitcnt vmcnt(0)
  ds_read_b128 v[112:115], v8
  ds_read_b128 v[116:119], v16
  s_waitcnt lgkmcnt(10)
  v_mfma_f32_32x32x16_bf16 v[96:111], v[136:139], v[140:143], v[96:111]
  ds_read_b128 v[120:123], v9
  ds_read_b128 v[124:127], v17
  s_waitcnt lgkmcnt(10)
  v_mfma_f32_32x32x16_bf16 v[96:111], v[144:147], v[148:151], v[96:111]
  ds_read_b128 v[128:131], v10
  ds_read_b128 v[132:135], v18
  s_waitcnt lgkmcnt(10)
  v_mfma_f32_32x32x16_bf16 v[96:111], v[152:155], v[156:159], v[96:111]
  ds_read_b128 v[136:139], v11
  ds_read_b128 v[140:143], v19
  s_waitcnt lgkmcnt(10)
  v_mfma_f32_32x32x16_bf16 v[96:111], v[160:163], v[164:167], v[96:111]
  ds_read_b128 v[144:147], v12
  ds_read_b128 v[148:151], v20
  s_waitcnt lgkmcnt(10)
  v_mfma_f32_32x32x16_bf16 v[96:111], v[168:171], v[172:175], v[96:111]
  ds_read_b128 v[152:155], v13
  ds_read_b128 v[156:159], v21
  s_waitcnt lgkmcnt(10)
  v_mfma_f32_32x32x16_bf16 v[96:111], v[112:115], v[116:119], v[96:111]
  ds_read_b128 v[160:163], v14
  ds_read_b128 v[164:167], v22
  s_waitcnt lgkmcnt(10)
  v_mfma_f32_32x32x16_bf16 v[96:111], v[120:123], v[124:127], v[96:111]
  ds_read_b128 v[168:171], v15
  ds_read_b128 v[172:175], v23
  s_waitcnt lgkmcnt(10)
  v_mfma_f32_32x32x16_bf16 v[96:111], v[128:131], v[132:135], v[96:111]
  s_waitcnt lgkmcnt(8)
  v_mfma_f32_32x32x16_bf16 v[96:111], v[136:139], v[140:143], v[96:111]
  s_waitcnt lgkmcnt(6)
  v_mfma_f32_32x32x16_bf16 v[96:111], v[144:147], v[148:151], v[96:111]
  s_waitcnt lgkmcnt(4)
  v_mfma_f32_32x32x16_bf16 v[96:111], v[152:155], v[156:159], v[96:111]
  s_waitcnt lgkmcnt(2)
  v_mfma_f32_32x32x16_bf16 v[96:111], v[160:163], v[164:167], v[96:111]
  s_waitcnt lgkmcnt(0)
  v_mfma_f32_32x32x16_bf16 v[96:111], v[168:171], v[172:175], v[96:111]
  s_nop 11
  v_max3_f32 v44, v96, v97, v98
  v_max3_f32 v45, v99, v100, v101
  v_max3_f32 v46, v102, v103, v104
  v_max3_f32 v47, v105, v106, v107
  v_max3_f32 v44, v44, v108, v109
  v_max3_f32 v45, v45, v110, v111
  v_max3_f32 v44, v44, v46, v47
  v_max_f32 v44, v44, v45
  ds_write_b32 v30, v44
  v_sub_f32 v96, v96, v44
  v_sub_f32 v97, v97, v44
  v_sub_f32 v98, v98, v44
  v_sub_f32 v99, v99, v44
  v_sub_f32 v100, v100, v44
  v_sub_f32 v101, v101, v44
  v_sub_f32 v102, v102, v44
  v_sub_f32 v103, v103, v44
  s_waitcnt lgkmcnt(0)
  s_barrier
  ds_read_b128 v[48:51], v29
  ds_read_b128 v[52:55], v29 offset:16
  v_exp_f32 v96, v96
  v_sub_f32 v104, v104, v44
  v_exp_f32 v97, v97
  v_sub_f32 v105, v105, v44
  v_exp_f32 v98, v98
  v_sub_f32 v106, v106, v44
  v_exp_f32 v99, v99
  v_sub_f32 v107, v107, v44
  v_exp_f32 v100, v100
  v_sub_f32 v108, v108, v44
  v_exp_f32 v101, v101
  v_sub_f32 v109, v109, v44
  v_exp_f32 v102, v102
  v_sub_f32 v110, v110, v44
  v_exp_f32 v103, v103
  v_sub_f32 v111, v111, v44
  s_waitcnt lgkmcnt(0)
  v_max3_f32 v45, v48, v49, v50
  v_max3_f32 v46, v51, v52, v53
  v_exp_f32 v104, v104
  v_max3_f32 v45, v45, v54, v55
  v_exp_f32 v105, v105
  v_max_f32 v45, v45, v46
  v_exp_f32 v106, v106
  v_sub_f32 v45, v44, v45
  v_exp_f32 v107, v107
  v_exp_f32 v45, v45
  v_exp_f32 v108, v108
  v_exp_f32 v109, v109
  v_exp_f32 v110, v110
  v_exp_f32 v111, v111
  v_mul_f32 v96, v96, v45
  v_mul_f32 v97, v97, v45
  v_mul_f32 v98, v98, v45
  v_mul_f32 v99, v99, v45
  v_mul_f32 v100, v100, v45
  v_mul_f32 v101, v101, v45
  v_mul_f32 v102, v102, v45
  v_mul_f32 v103, v103, v45
  v_cvt_pk_bf16_f32 v48, v96, v97
  v_cvt_pk_bf16_f32 v49, v98, v99
  v_cvt_pk_bf16_f32 v50, v100, v101
  v_cvt_pk_bf16_f32 v51, v102, v103
  ds_write_b128 v31, v[48:51] offset:0
  v_mul_f32 v104, v104, v45
  v_mul_f32 v105, v105, v45
  v_mul_f32 v106, v106, v45
  v_mul_f32 v107, v107, v45
  v_mul_f32 v108, v108, v45
  v_mul_f32 v109, v109, v45
  v_mul_f32 v110, v110, v45
  v_mul_f32 v111, v111, v45
  v_cvt_pk_bf16_f32 v52, v104, v105
  v_cvt_pk_bf16_f32 v53, v106, v107
  v_cvt_pk_bf16_f32 v54, v108, v109
  v_cvt_pk_bf16_f32 v55, v110, v111
  ds_write_b128 v31, v[52:55] offset:1024
  v_add_f32 v96, v96, v97
  v_add_f32 v98, v98, v99
  v_add_f32 v100, v100, v101
  v_add_f32 v102, v102, v103
  v_add_f32 v104, v104, v105
  v_add_f32 v106, v106, v107
  v_add_f32 v108, v108, v109
  v_add_f32 v110, v110, v111
  v_add_f32 v96, v96, v98
  v_add_f32 v100, v100, v102
  v_add_f32 v104, v104, v106
  v_add_f32 v108, v108, v110
  v_add_f32 v96, v96, v100
  v_add_f32 v104, v104, v108
  v_add_f32 v96, v96, v104
  ds_write_b32 v30, v96 offset:9216
  s_waitcnt lgkmcnt(0)
  s_barrier
L_pv:
  s_setprio 2
  ds_read_b128 v[48:51], v28 offset:0
  ds_read_b64_tr_b16 v[112:113], v24 offset:0
  ds_read_b64_tr_b16 v[114:115], v25 offset:0
  ds_read_b128 v[52:55], v28 offset:1024
  ds_read_b64_tr_b16 v[116:117], v24 offset:4096
  ds_read_b64_tr_b16 v[118:119], v25 offset:4096
  ds_read_b128 v[56:59], v28 offset:2048
  ds_read_b64_tr_b16 v[120:121], v24 offset:8192
  ds_read_b64_tr_b16 v[122:123], v25 offset:8192
  ds_read_b128 v[60:63], v28 offset:3072
  ds_read_b64_tr_b16 v[124:125], v24 offset:12288
  ds_read_b64_tr_b16 v[126:127], v25 offset:12288
  s_mov_b32 s70, 0x10000
  s_mov_b32 s71, 0x18000
  s_mov_b32 s72, 0x8000
  s_cmp_lg_u32 s3, 7
  s_cbranch_scc1 L_nolse
  ds_read_b128 v[8:11], v29
  ds_read_b128 v[12:15], v29 offset:16
  s_waitcnt lgkmcnt(6)
  ds_read_b128 v[16:19], v29 offset:9216
  ds_read_b128 v[20:23], v29 offset:9232
  s_lshl_b32 s74, s2, 9
  s_add_u32 s74, s74, 131072
  s_andn2_b32 s92, s48, 1
  v_mov_b32 v195, s92
  s_waitcnt lgkmcnt(2)
  v_max3_f32 v192, v8, v9, v10
  v_max3_f32 v193, v11, v12, v13
  v_max3_f32 v192, v192, v14, v15
  v_max_f32 v192, v192, v193
  s_waitcnt lgkmcnt(0)
  v_add_f32 v16, v16, v17
  v_add_f32 v18, v18, v19
  v_add_f32 v20, v20, v21
  v_add_f32 v22, v22, v23
  v_add_f32 v16, v16, v18
  v_add_f32 v20, v20, v22
  v_add_f32 v16, v16, v20
  v_mov_b32 v193, v16
  s_mov_b32 exec_hi, 0
  buffer_store_dwordx4 v[192:195], v34, s[32:35], s74 offen sc1
  s_mov_b32 exec_hi, -1
L_nolse:
  s_waitcnt lgkmcnt(9)
  v_mfma_f32_32x32x16_bf16 v[144:159], v[112:115], v[48:51], 0
  ds_read_b128 v[64:67], v28 offset:4096
  ds_read_b64_tr_b16 v[128:129], v24 offset:16384
  ds_read_b64_tr_b16 v[130:131], v25 offset:16384
  s_waitcnt lgkmcnt(9)
  v_mfma_f32_32x32x16_bf16 v[144:159], v[116:119], v[52:55], v[144:159]
  ds_read_b128 v[68:71], v28 offset:5120
  ds_read_b64_tr_b16 v[132:133], v24 offset:20480
  ds_read_b64_tr_b16 v[134:135], v25 offset:20480
  v_lshrrev_b32 v44, 5, v1
  v_lshlrev_b32 v44, 3, v44
  v_lshrrev_b32 v96, v44, v249
  v_lshrrev_b32 v104, v44, v250
  s_waitcnt lgkmcnt(9)
  v_mfma_f32_32x32x16_bf16 v[144:159], v[120:123], v[56:59], v[144:159]
  ds_read_b128 v[72:75], v28 offset:6144
  ds_read_b64_tr_b16 v[136:137], v24 offset:24576
  ds_read_b64_tr_b16 v[138:139], v25 offset:24576
  v_lshrrev_b32 v97, 1, v96
  v_lshrrev_b32 v98, 2, v96
  v_lshrrev_b32 v99, 3, v96
  s_waitcnt lgkmcnt(9)
  v_mfma_f32_32x32x16_bf16 v[144:159], v[124:127], v[60:63], v[144:159]
  ds_read_b128 v[76:79], v28 offset:7168
  ds_read_b64_tr_b16 v[140:141], v24 offset:28672
  ds_read_b64_tr_b16 v[142:143], v25 offset:28672
  v_lshrrev_b32 v100, 4, v96
  v_lshrrev_b32 v101, 5, v96
  v_lshrrev_b32 v102, 6, v96
  v_lshrrev_b32 v103, 7, v96
  s_waitcnt lgkmcnt(9)
  v_mfma_f32_32x32x16_bf16 v[144:159], v[128:131], v[64:67], v[144:159]
  ds_read_b64_tr_b16 v[112:113], v26 offset:0
  ds_read_b64_tr_b16 v[114:115], v27 offset:0
  v_lshrrev_b32 v105, 1, v104
  v_lshrrev_b32 v106, 2, v104
  v_lshrrev_b32 v107, 3, v104
  s_waitcnt lgkmcnt(8)
  v_mfma_f32_32x32x16_bf16 v[144:159], v[132:135], v[68:71], v[144:159]
  ds_read_b64_tr_b16 v[116:117], v26 offset:4096
  ds_read_b64_tr_b16 v[118:119], v27 offset:4096
  v_lshrrev_b32 v108, 4, v104
  v_lshrrev_b32 v109, 5, v104
  v_lshrrev_b32 v110, 6, v104
  v_lshrrev_b32 v111, 7, v104
  s_waitcnt lgkmcnt(7)
  v_mfma_f32_32x32x16_bf16 v[144:159], v[136:139], v[72:75], v[144:159]
  ds_read_b64_tr_b16 v[120:121], v26 offset:8192
  ds_read_b64_tr_b16 v[122:123], v27 offset:8192
  s_waitcnt lgkmcnt(6)
  v_mfma_f32_32x32x16_bf16 v[144:159], v[140:143], v[76:79], v[144:159]
  ds_read_b64_tr_b16 v[124:125], v26 offset:12288
  ds_read_b64_tr_b16 v[126:127], v27 offset:12288
  s_waitcnt lgkmcnt(6)
  v_mfma_f32_32x32x16_bf16 v[160:175], v[112:115], v[48:51], 0
  ds_read_b64_tr_b16 v[128:129], v26 offset:16384
  ds_read_b64_tr_b16 v[130:131], v27 offset:16384
  s_waitcnt lgkmcnt(6)
  v_mfma_f32_32x32x16_bf16 v[160:175], v[116:119], v[52:55], v[160:175]
  ds_read_b64_tr_b16 v[132:133], v26 offset:20480
  ds_read_b64_tr_b16 v[134:135], v27 offset:20480
  s_waitcnt lgkmcnt(6)
  v_mfma_f32_32x32x16_bf16 v[160:175], v[120:123], v[56:59], v[160:175]
  ds_read_b64_tr_b16 v[136:137], v26 offset:24576
  ds_read_b64_tr_b16 v[138:139], v27 offset:24576
  v_cvt_pk_bf16_f32 v80, v144, v145
  v_cvt_pk_bf16_f32 v81, v146, v147
  v_cvt_pk_bf16_f32 v82, v148, v149
  v_cvt_pk_bf16_f32 v83, v150, v151
  v_bfi_b32 v80, s53, v96, v80
  v_bfi_b32 v81, s53, v97, v81
  v_bfi_b32 v82, s53, v98, v82
  v_bfi_b32 v83, s53, v99, v83
  ds_write_b128 v196, v[80:83]
  s_waitcnt lgkmcnt(7)
  v_mfma_f32_32x32x16_bf16 v[160:175], v[124:127], v[60:63], v[160:175]
  ds_read_b64_tr_b16 v[140:141], v26 offset:28672
  ds_read_b64_tr_b16 v[142:143], v27 offset:28672
  v_cvt_pk_bf16_f32 v84, v152, v153
  v_cvt_pk_bf16_f32 v85, v154, v155
  v_cvt_pk_bf16_f32 v86, v156, v157
  v_cvt_pk_bf16_f32 v87, v158, v159
  v_bfi_b32 v84, s53, v100, v84
  v_bfi_b32 v85, s53, v101, v85
  v_bfi_b32 v86, s53, v102, v86
  v_bfi_b32 v87, s53, v103, v87
  ds_write_b128 v197, v[84:87]
  s_waitcnt lgkmcnt(8)
  v_mfma_f32_32x32x16_bf16 v[160:175], v[128:131], v[64:67], v[160:175]
  s_waitcnt lgkmcnt(6)
  v_mfma_f32_32x32x16_bf16 v[160:175], v[132:135], v[68:71], v[160:175]
  s_waitcnt lgkmcnt(4)
  v_mfma_f32_32x32x16_bf16 v[160:175], v[136:139], v[72:75], v[160:175]
  s_waitcnt lgkmcnt(1)
  v_mfma_f32_32x32x16_bf16 v[160:175], v[140:143], v[76:79], v[160:175]
  s_setprio 2
  s_nop 10
  v_cvt_pk_bf16_f32 v88, v160, v161
  v_cvt_pk_bf16_f32 v89, v162, v163
  v_cvt_pk_bf16_f32 v90, v164, v165
  v_cvt_pk_bf16_f32 v91, v166, v167
  v_bfi_b32 v88, s53, v104, v88
  v_bfi_b32 v89, s53, v105, v89
  v_bfi_b32 v90, s53, v106, v90
  v_bfi_b32 v91, s53, v107, v91
  ds_write_b128 v198, v[88:91]
  v_cvt_pk_bf16_f32 v92, v168, v169
  v_cvt_pk_bf16_f32 v93, v170, v171
  v_cvt_pk_bf16_f32 v94, v172, v173
  v_cvt_pk_bf16_f32 v95, v174, v175
  v_bfi_b32 v92, s53, v108, v92
  v_bfi_b32 v93, s53, v109, v93
  v_bfi_b32 v94, s53, v110, v94
  v_bfi_b32 v95, s53, v111, v95
  ds_write_b128 v199, v[92:95]
  ds_read_b128 v[112:115], v32 offset:0
  ds_read_b128 v[116:119], v32 offset:2048
  ds_read_b128 v[120:123], v32 offset:4096
  ds_read_b128 v[124:127], v32 offset:6144
  s_waitcnt lgkmcnt(3)
  buffer_store_dwordx4 v[112:115], v34, s[32:35], s87 offen offset:0 sc1
  s_waitcnt lgkmcnt(2)
  buffer_store_dwordx4 v[116:119], v34, s[32:35], s87 offen offset:1024 sc1
  s_waitcnt lgkmcnt(1)
  buffer_store_dwordx4 v[120:123], v34, s[32:35], s87 offen offset:2048 sc1
  s_waitcnt lgkmcnt(0)
  buffer_store_dwordx4 v[124:127], v34, s[32:35], s87 offen offset:3072 sc1
  s_setprio 0
  s_barrier
  s_cmp_lg_u32 s3, 7
  s_cbranch_scc1 L_nolse2
  v_or_b32 v195, 1, v195
  s_mov_b32 exec_hi, 0
  buffer_store_dwordx4 v[192:195], v34, s[32:35], s74 offen sc1
  s_mov_b32 exec_hi, -1
L_nolse2:
  s_mov_b32 s73, 0
  s_or_b32 s69, s48, 1
  buffer_load_dwordx4 v[8:11], v35, s[32:35], s70 offen offset:0 sc1
  buffer_load_dwordx4 v[12:15], v35, s[32:35], s71 offen offset:0 sc1
  buffer_load_dwordx4 v[16:19], v35, s[32:35], 0 offen offset:0 sc1
  buffer_load_dwordx4 v[20:23], v35, s[32:35], s72 offen offset:0 sc1
  s_cmp_lt_u32 s2, 128
  s_cbranch_scc1 L_prepA
  s_and_b32 s92, s3, 3
  s_mul_i32 s92, s92, 7552
  s_add_u32 s92, s92, 20480
  v_lshrrev_b32 v62, 5, v1
  v_mul_u32_u24 v62, 928, v62
  v_and_b32 v3, 31, v1
  v_lshl_add_u32 v62, v3, 4, v62
  v_add_u32 v62, s92, v62
  s_lshl_b32 s92, s3, 6
  v_lshrrev_b32 v63, 4, v1
  v_mul_u32_u24 v63, 7552, v63
  v_bfe_u32 v3, v1, 2, 2
  v_mul_u32_u24 v3, 928, v3
  v_add_u32 v63, v3, v63
  v_and_b32 v3, 3, v1
  v_lshl_add_u32 v63, v3, 3, v63
  v_add_u32 v63, 20480, v63
  v_add_u32 v63, s92, v63
  s_mul_i32 s82, s80, 28672
  s_lshl_b32 s97, s3, 12
  s_add_u32 s82, s82, s97
  s_lshl_b32 s97, s79, 8
  s_add_u32 s82, s82, s97
  s_lshr_b32 s92, s79, 1
  s_lshl_b32 s92, s92, 10
  s_and_b32 s97, s79, 1
  s_lshl_b32 s97, s97, 7
  s_add_u32 s92, s92, s97
  s_add_u32 s92, s92, 16384
  v_bfe_u32 v56, v1, 3, 1
  v_lshlrev_b32 v56, 13, v56
  v_lshrrev_b32 v3, 4, v1
  v_lshl_add_u32 v56, v3, 8, v56
  v_and_b32 v3, 7, v1
  v_lshl_add_u32 v56, v3, 4, v56
  v_add_u32 v56, s92, v56
  v_and_b32 v60, 31, v1
  v_lshlrev_b32 v60, 5, v60
  v_add_u32 v60, 90112, v60
  s_lshl_b32 s92, s3, 2
  s_add_u32 s92, s92, 90112
  v_and_b32 v59, 7, v1
  v_lshlrev_b32 v59, 7, v59
  v_lshrrev_b32 v3, 4, v1
  v_lshl_add_u32 v59, v3, 5, v59
  v_add_u32 v59, s92, v59
  s_lshl_b32 s92, s3, 7
  s_add_u32 s92, s92, 93184
  v_and_b32 v57, 31, v1
  v_lshlrev_b32 v57, 1, v57
  v_add_u32 v57, s92, v57
  s_mul_i32 s90, s79, 4224
  s_lshl_b32 s97, s3, 9
  s_add_u32 s90, s90, s97
  s_add_u32 s90, s90, 393216
  v_and_b32 v61, 31, v1
  v_lshlrev_b32 v61, 4, v61
  v_and_b32 v58, 3, v1
  v_lshlrev_b32 v58, 6, v58
  v_lshrrev_b32 v3, 4, v1
  v_lshl_add_u32 v58, v3, 4, v58
  s_nop 0
  s_branch L_prep2
L_prepA:
  s_sub_u32 s92, s2, 56
  s_cmp_ge_u32 s2, 56
  s_cselect_b32 s81, s92, s2
  s_cselect_b32 s93, 1, 0
  s_lshl_b32 s91, s81, 15
  s_lshl_b32 s97, s3, 12
  s_add_u32 s91, s91, s97
  s_lshl_b32 s97, s93, 9
  s_add_u32 s91, s91, s97
  s_mul_i32 s75, s77, 16896
  s_lshr_b32 s97, s3, 1
  s_mul_i32 s97, s97, 4224
  s_add_u32 s75, s75, s97
  s_lshl_b32 s97, s76, 7
  s_add_u32 s75, s75, s97
  s_and_b32 s97, s3, 1
  s_lshl_b32 s97, s97, 6
  s_add_u32 s75, s75, s97
  s_add_u32 s75, s75, 393216
  s_mul_i32 s90, s93, 67584
  s_mul_i32 s97, s3, 8448
  s_add_u32 s90, s90, s97
  s_lshl_b32 s97, s81, 7
  s_add_u32 s90, s90, s97
  s_add_u32 s90, s90, 655360
  s_mul_i32 s92, s3, 2176
  s_lshr_b32 s97, s3, 1
  s_lshl_b32 s97, s97, 7
  s_add_u32 s92, s92, s97
  s_add_u32 s92, s92, 59392
  v_lshrrev_b32 v62, 5, v1
  v_mul_u32_u24 v62, 544, v62
  v_and_b32 v3, 31, v1
  v_lshl_add_u32 v62, v3, 4, v62
  v_add_u32 v62, s92, v62
  s_lshl_b32 s92, s3, 6
  v_lshrrev_b32 v63, 4, v1
  v_mul_u32_u24 v63, 4480, v63
  v_bfe_u32 v3, v1, 2, 2
  v_mul_u32_u24 v3, 544, v3
  v_add_u32 v63, v3, v63
  v_and_b32 v3, 3, v1
  v_lshl_add_u32 v63, v3, 3, v63
  v_add_u32 v63, 59392, v63
  v_add_u32 v63, s92, v63
  s_lshl_b32 s82, s81, 12
  s_lshl_b32 s97, s3, 9
  s_add_u32 s82, s82, s97
  s_add_u32 s82, s82, 851968
  s_lshl_b32 s92, s3, 7
  s_add_u32 s92, s92, 93184
  v_and_b32 v57, 7, v1
  v_lshlrev_b32 v57, 3, v57
  v_lshrrev_b32 v3, 4, v1
  v_lshl_add_u32 v57, v3, 1, v57
  v_add_u32 v57, s92, v57
  v_and_b32 v61, 31, v1
  v_lshlrev_b32 v61, 4, v61
  v_and_b32 v58, 1, v1
  v_lshlrev_b32 v58, 6, v58
  v_lshrrev_b32 v3, 4, v1
  v_lshl_add_u32 v58, v3, 4, v58
  s_mul_i32 s92, s81, 37
  s_lshr_b32 s92, s92, 8
  s_lshl_b32 s92, s92, 11
  v_and_b32 v56, 15, v1
  v_lshlrev_b32 v56, 7, v56
  v_add_u32 v56, 98304, v56
  v_add_u32 v56, s92, v56
  s_lshl_b32 s92, s3, 2
  s_add_u32 s92, s92, 83968
  v_lshlrev_b32 v59, 5, v1
  v_add_u32 v59, s92, v59
  s_bfe_u32 s92, s3, 0x10002
  s_lshl_b32 s92, s92, 10
  s_and_b32 s97, s3, 3
  s_lshl_b32 s97, s97, 2
  s_add_u32 s92, s92, s97
  s_add_u32 s92, s92, 88064
  v_lshlrev_b32 v60, 4, v1
  v_add_u32 v60, s92, v60
L_prep2:
  s_cmp_lt_u32 s3, 4
  s_cbranch_scc1 L_nsg
  s_waitcnt vmcnt(8)
  ds_write_b128 v240, v[176:179] offset:0
  ds_write_b128 v240, v[180:183] offset:1152
  ds_write_b128 v240, v[184:187] offset:2432
  ds_write_b128 v240, v[188:191] offset:3584
  s_cmp_lt_u32 s2, 128
  s_cbranch_scc1 L_sf_34a
  s_mov_b32 exec_lo, 0xfffffff
  s_mov_b32 exec_hi, 0xfffffff
  ds_write_b128 v62, v[208:211] offset:0
  ds_write_b128 v62, v[212:215] offset:448
  ds_write_b128 v62, v[216:219] offset:1856
  ds_write_b128 v62, v[220:223] offset:2304
  ds_write_b128 v62, v[224:227] offset:3712
  ds_write_b128 v62, v[228:231] offset:4160
  ds_write_b128 v62, v[232:235] offset:5568
  ds_write_b128 v62, v[236:239] offset:6016
  s_mov_b64 exec, -1
  s_branch L_sf_34x
L_sf_34a:
  ds_write_b128 v241, v[208:211] offset:0
  ds_write_b128 v241, v[212:215] offset:1152
  ds_write_b128 v241, v[216:219] offset:2432
  ds_write_b128 v241, v[220:223] offset:3584
  ds_write_b128 v241, v[224:227] offset:4864
  ds_write_b128 v241, v[228:231] offset:6016
  ds_write_b128 v241, v[232:235] offset:7296
  ds_write_b128 v241, v[236:239] offset:8448
L_sf_34x:
L_nsg:
  s_mov_b32 s100, 0
L_p1:
  s_waitcnt vmcnt(0)
  s_bitcmp1_b32 s73, 0
  s_cbranch_scc1 L_lp_35
  v_cmp_ne_u32 s[60:61], s69, v11
  s_nop 0
  s_cmp_lg_u64 s[60:61], 0
  s_cbranch_scc1 L_lp_35
  s_bitset1_b32 s73, 0
  buffer_load_dwordx4 v[128:131], v36, s[32:35], s83 offen offset:0 sc1
L_lp_35:
  s_bitcmp1_b32 s73, 1
  s_cbranch_scc1 L_lp_36
  v_cmp_ne_u32 s[62:63], s69, v15
  s_nop 0
  s_cmp_lg_u64 s[62:63], 0
  s_cbranch_scc1 L_lp_36
  s_bitset1_b32 s73, 1
  buffer_load_dwordx4 v[132:135], v36, s[32:35], s84 offen offset:0 sc1
L_lp_36:
  s_bitcmp1_b32 s73, 2
  s_cbranch_scc1 L_lp_37
  v_cmp_ne_u32 s[64:65], s69, v19
  s_nop 0
  s_cmp_lg_u64 s[64:65], 0
  s_cbranch_scc1 L_lp_37
  s_bitset1_b32 s73, 2
  buffer_load_dwordx4 v[136:139], v36, s[32:35], s85 offen offset:0 sc1
L_lp_37:
  s_bitcmp1_b32 s73, 3
  s_cbranch_scc1 L_lp_38
  v_cmp_ne_u32 s[66:67], s69, v23
  s_nop 0
  s_cmp_lg_u64 s[66:67], 0
  s_cbranch_scc1 L_lp_38
  s_bitset1_b32 s73, 3
  buffer_load_dwordx4 v[140:143], v36, s[32:35], s86 offen offset:0 sc1
L_lp_38:
  v_xor_b32 v44, s69, v11
  v_bitop3_b32 v44, v15, s69, v44 bitop3:0xbe
  v_bitop3_b32 v44, v19, s69, v44 bitop3:0xbe
  v_bitop3_b32 v44, v23, s69, v44 bitop3:0xbe
  v_cmp_lt_u32 vcc, 1, v44
  s_nop 0
  s_cbranch_vccz L_p1x
  s_add_u32 s100, s100, 1
  s_cmp_gt_u32 s100, 1000000
  s_cbranch_scc1 L_abort
  s_sleep 4
  s_bitcmp1_b32 s73, 0
  s_cbranch_scc1 L_ll_39
  s_mov_b64 exec, s[60:61]
  buffer_load_dwordx4 v[8:11], v35, s[32:35], s70 offen offset:0 sc1
L_ll_39:
  s_bitcmp1_b32 s73, 1
  s_cbranch_scc1 L_ll_40
  s_mov_b64 exec, s[62:63]
  buffer_load_dwordx4 v[12:15], v35, s[32:35], s71 offen offset:0 sc1
L_ll_40:
  s_bitcmp1_b32 s73, 2
  s_cbranch_scc1 L_ll_41
  s_mov_b64 exec, s[64:65]
  buffer_load_dwordx4 v[16:19], v35, s[32:35], 0 offen offset:0 sc1
L_ll_41:
  s_bitcmp1_b32 s73, 3
  s_cbranch_scc1 L_ll_42
  s_mov_b64 exec, s[66:67]
  buffer_load_dwordx4 v[20:23], v35, s[32:35], s72 offen offset:0 sc1
L_ll_42:
  s_mov_b64 exec, -1
  s_branch L_p1
L_p1x:
  s_bitcmp1_b32 s73, 0
  s_cbranch_scc1 L_ll_43
  s_mov_b64 exec, s[60:61]
  buffer_load_dwordx4 v[8:11], v35, s[32:35], s70 offen offset:0 sc1
L_ll_43:
  s_bitcmp1_b32 s73, 1
  s_cbranch_scc1 L_ll_44
  s_mov_b64 exec, s[62:63]
  buffer_load_dwordx4 v[12:15], v35, s[32:35], s71 offen offset:0 sc1
L_ll_44:
  s_bitcmp1_b32 s73, 2
  s_cbranch_scc1 L_ll_45
  s_mov_b64 exec, s[64:65]
  buffer_load_dwordx4 v[16:19], v35, s[32:35], 0 offen offset:0 sc1
L_ll_45:
  s_bitcmp1_b32 s73, 3
  s_cbranch_scc1 L_ll_46
  s_mov_b64 exec, s[66:67]
  buffer_load_dwordx4 v[20:23], v35, s[32:35], s72 offen offset:0 sc1
L_ll_46:
  s_mov_b64 exec, -1
  v_max3_f32 v44, v8, v12, v16
  v_max_f32 v44, v44, v20
  s_nop 1
  v_max_f32_dpp v44, v44, v44 row_ror:8 row_mask:0xf bank_mask:0xf
  v_mov_b32 v45, v44
  s_nop 1
  v_permlane16_swap_b32 v44, v45
  v_max_f32 v44, v44, v45
  v_mov_b32 v45, v44
  s_nop 1
  v_permlane32_swap_b32 v44, v45
  v_max_f32 v44, v44, v45
  s_lshl_b32 s92, s3, 2
  s_add_u32 s92, s92, 92160
  v_mov_b32 v47, s92
  v_mov_b32 v46, 92160
  ds_write_b32 v47, v44
  s_waitcnt lgkmcnt(0)
  s_barrier
  ds_read_b128 v[144:147], v46
  ds_read_b128 v[148:151], v46 offset:16
  ds_read_b64_tr_b16 v[48:49], v242 offset:0
  ds_read_b64_tr_b16 v[50:51], v242 offset:1152
  ds_read_b64_tr_b16 v[52:53], v242 offset:9728
  ds_read_b64_tr_b16 v[54:55], v242 offset:10880
  s_waitcnt lgkmcnt(4)
  v_max3_f32 v44, v144, v145, v146
  v_max3_f32 v45, v147, v148, v149
  v_max3_f32 v44, v44, v150, v151
  v_max_f32 v44, v44, v45
  v_sub_f32 v152, v8, v44
  v_sub_f32 v153, v12, v44
  v_sub_f32 v154, v16, v44
  v_sub_f32 v155, v20, v44
  v_exp_f32 v152, v152
  v_exp_f32 v153, v153
  v_exp_f32 v154, v154
  v_exp_f32 v155, v155
  v_cvt_pk_bf16_f32 v152, v152, v152
  v_cvt_pk_bf16_f32 v153, v153, v153
  v_cvt_pk_bf16_f32 v154, v154, v154
  v_cvt_pk_bf16_f32 v155, v155, v155
  v_lshrrev_b32 v156, 16, v152
  v_lshrrev_b32 v157, 16, v153
  v_lshrrev_b32 v158, 16, v154
  v_lshrrev_b32 v159, 16, v155
  v_and_b32 v152, 0xffff0000, v152
  v_and_b32 v153, 0xffff0000, v153
  v_and_b32 v154, 0xffff0000, v154
  v_and_b32 v155, 0xffff0000, v155
  v_mul_f32 v44, v152, v9
  v_fmac_f32 v44, v153, v13
  v_fmac_f32 v44, v154, v17
  v_fmac_f32 v44, v155, v21
  s_nop 1
  v_add_f32_dpp v44, v44, v44 row_ror:8 row_mask:0xf bank_mask:0xf
  v_mov_b32 v45, v44
  s_nop 1
  v_permlane16_swap_b32 v44, v45
  v_add_f32 v44, v44, v45
  v_mov_b32 v45, v44
  s_nop 1
  v_permlane32_swap_b32 v44, v45
  v_add_f32 v44, v44, v45
  ds_write_b32 v47, v44 offset:32
  s_cmp_lt_u32 s2, 128
  s_cbranch_scc1 L_fgA
  ds_read_b64_tr_b16 v[80:81], v63 offset:0
  ds_read_b64_tr_b16 v[82:83], v63 offset:3712
  ds_read_b64_tr_b16 v[84:85], v63 offset:32
  ds_read_b64_tr_b16 v[86:87], v63 offset:3744
  ds_read_b64_tr_b16 v[88:89], v63 offset:448
  ds_read_b64_tr_b16 v[90:91], v63 offset:4160
  ds_read_b64_tr_b16 v[92:93], v63 offset:480
  ds_read_b64_tr_b16 v[94:95], v63 offset:4192
  s_branch L_fgx
L_fgA:
  ds_read_b64_tr_b16 v[80:81], v243 offset:0
  ds_read_b64_tr_b16 v[82:83], v243 offset:1152
  ds_read_b64_tr_b16 v[84:85], v243 offset:9728
  ds_read_b64_tr_b16 v[86:87], v243 offset:10880
  ds_read_b64_tr_b16 v[88:89], v243 offset:19456
  ds_read_b64_tr_b16 v[90:91], v243 offset:20608
  ds_read_b64_tr_b16 v[92:93], v243 offset:29184
  ds_read_b64_tr_b16 v[94:95], v243 offset:30336
L_fgx:
  s_waitcnt lgkmcnt(0)
  s_barrier
  ds_read_b128 v[160:163], v46 offset:32
  ds_read_b128 v[164:167], v46 offset:48
  v_mov_b32 v144, 0
  v_mov_b32 v145, 0
  v_mov_b32 v146, 0
  v_mov_b32 v147, 0
  v_mov_b32 v148, 0
  v_mov_b32 v149, 0
  v_mov_b32 v150, 0
  v_mov_b32 v151, 0
  s_waitcnt lgkmcnt(0)
  v_add_f32 v160, v160, v161
  v_add_f32 v162, v162, v163
  v_add_f32 v164, v164, v165
  v_add_f32 v166, v166, v167
  v_add_f32 v160, v160, v162
  v_add_f32 v164, v164, v166
  v_add_f32 v160, v160, v164
  v_rcp_f32 v168, v160
  s_mov_b32 s100, 0
L_p2:
  s_mov_b32 s95, s73
  s_waitcnt vmcnt(0)
  s_bitcmp1_b32 s73, 0
  s_cbranch_scc1 L_lp_47
  v_cmp_ne_u32 s[60:61], s69, v11
  s_nop 0
  s_cmp_lg_u64 s[60:61], 0
  s_cbranch_scc1 L_lp_47
  s_bitset1_b32 s73, 0
  buffer_load_dwordx4 v[128:131], v36, s[32:35], s83 offen offset:0 sc1
L_lp_47:
  s_bitcmp1_b32 s73, 1
  s_cbranch_scc1 L_lp_48
  v_cmp_ne_u32 s[62:63], s69, v15
  s_nop 0
  s_cmp_lg_u64 s[62:63], 0
  s_cbranch_scc1 L_lp_48
  s_bitset1_b32 s73, 1
  buffer_load_dwordx4 v[132:135], v36, s[32:35], s84 offen offset:0 sc1
L_lp_48:
  s_bitcmp1_b32 s73, 2
  s_cbranch_scc1 L_lp_49
  v_cmp_ne_u32 s[64:65], s69, v19
  s_nop 0
  s_cmp_lg_u64 s[64:65], 0
  s_cbranch_scc1 L_lp_49
  s_bitset1_b32 s73, 2
  buffer_load_dwordx4 v[136:139], v36, s[32:35], s85 offen offset:0 sc1
L_lp_49:
  s_bitcmp1_b32 s73, 3
  s_cbranch_scc1 L_lp_50
  v_cmp_ne_u32 s[66:67], s69, v23
  s_nop 0
  s_cmp_lg_u64 s[66:67], 0
  s_cbranch_scc1 L_lp_50
  s_bitset1_b32 s73, 3
  buffer_load_dwordx4 v[140:143], v36, s[32:35], s86 offen offset:0 sc1
L_lp_50:
  s_bitcmp1_b32 s95, 0
  s_cbranch_scc0 L_dc_51
  s_bitcmp1_b32 s95, 4
  s_cbranch_scc1 L_dc_51
  v_xor_b32 v44, v128, v4
  v_bitop3_b32 v44, v129, v5, v44 bitop3:0xbe
  v_bitop3_b32 v44, v130, v6, v44 bitop3:0xbe
  v_bitop3_b32 v44, v131, v7, v44 bitop3:0xbe
  v_and_b32 v44, s53, v44
  v_cmp_ne_u32 vcc, 0, v44
  s_nop 0
  s_cbranch_vccz L_dc_51k
  buffer_load_dwordx4 v[128:131], v36, s[32:35], s83 offen offset:0 sc1
  s_branch L_dc_51
L_dc_51k:
  s_bitset1_b32 s73, 4
  v_dot2c_f32_bf16 v144, v156, v128
  v_dot2c_f32_bf16 v145, v152, v128
  v_dot2c_f32_bf16 v146, v156, v129
  v_dot2c_f32_bf16 v147, v152, v129
  v_dot2c_f32_bf16 v148, v156, v130
  v_dot2c_f32_bf16 v149, v152, v130
  v_dot2c_f32_bf16 v150, v156, v131
  v_dot2c_f32_bf16 v151, v152, v131
L_dc_51:
  s_bitcmp1_b32 s95, 1
  s_nop 0
  s_cbranch_scc0 L_dc_52
  s_bitcmp1_b32 s95, 5
  s_cbranch_scc1 L_dc_52
  v_xor_b32 v44, v132, v4
  v_bitop3_b32 v44, v133, v5, v44 bitop3:0xbe
  v_bitop3_b32 v44, v134, v6, v44 bitop3:0xbe
  v_bitop3_b32 v44, v135, v7, v44 bitop3:0xbe
  v_and_b32 v44, s53, v44
  v_cmp_ne_u32 vcc, 0, v44
  s_nop 0
  s_cbranch_vccz L_dc_52k
  buffer_load_dwordx4 v[132:135], v36, s[32:35], s84 offen offset:0 sc1
  s_branch L_dc_52
L_dc_52k:
  s_bitset1_b32 s73, 5
  v_dot2c_f32_bf16 v144, v157, v132
  v_dot2c_f32_bf16 v145, v153, v132
  v_dot2c_f32_bf16 v146, v157, v133
  v_dot2c_f32_bf16 v147, v153, v133
  v_dot2c_f32_bf16 v148, v157, v134
  v_dot2c_f32_bf16 v149, v153, v134
  v_dot2c_f32_bf16 v150, v157, v135
  v_dot2c_f32_bf16 v151, v153, v135
L_dc_52:
  s_bitcmp1_b32 s95, 2
  s_nop 0
  s_cbranch_scc0 L_dc_53
  s_bitcmp1_b32 s95, 6
  s_cbranch_scc1 L_dc_53
  v_xor_b32 v44, v136, v4
  v_bitop3_b32 v44, v137, v5, v44 bitop3:0xbe
  v_bitop3_b32 v44, v138, v6, v44 bitop3:0xbe
  v_bitop3_b32 v44, v139, v7, v44 bitop3:0xbe
  v_and_b32 v44, s53, v44
  v_cmp_ne_u32 vcc, 0, v44
  s_nop 0
  s_cbranch_vccz L_dc_53k
  buffer_load_dwordx4 v[136:139], v36, s[32:35], s85 offen offset:0 sc1
  s_branch L_dc_53
L_dc_53k:
  s_bitset1_b32 s73, 6
  v_dot2c_f32_bf16 v144, v158, v136
  v_dot2c_f32_bf16 v145, v154, v136
  v_dot2c_f32_bf16 v146, v158, v137
  v_dot2c_f32_bf16 v147, v154, v137
  v_dot2c_f32_bf16 v148, v158, v138
  v_dot2c_f32_bf16 v149, v154, v138
  v_dot2c_f32_bf16 v150, v158, v139
  v_dot2c_f32_bf16 v151, v154, v139
L_dc_53:
  s_bitcmp1_b32 s95, 3
  s_nop 0
  s_cbranch_scc0 L_dc_54
  s_bitcmp1_b32 s95, 7
  s_cbranch_scc1 L_dc_54
  v_xor_b32 v44, v140, v4
  v_bitop3_b32 v44, v141, v5, v44 bitop3:0xbe
  v_bitop3_b32 v44, v142, v6, v44 bitop3:0xbe
  v_bitop3_b32 v44, v143, v7, v44 bitop3:0xbe
  v_and_b32 v44, s53, v44
  v_cmp_ne_u32 vcc, 0, v44
  s_nop 0
  s_cbranch_vccz L_dc_54k
  buffer_load_dwordx4 v[140:143], v36, s[32:35], s86 offen offset:0 sc1
  s_branch L_dc_54
L_dc_54k:
  s_bitset1_b32 s73, 7
  v_dot2c_f32_bf16 v144, v159, v140
  v_dot2c_f32_bf16 v145, v155, v140
  v_dot2c_f32_bf16 v146, v159, v141
  v_dot2c_f32_bf16 v147, v155, v141
  v_dot2c_f32_bf16 v148, v159, v142
  v_dot2c_f32_bf16 v149, v155, v142
  v_dot2c_f32_bf16 v150, v159, v143
  v_dot2c_f32_bf16 v151, v155, v143
L_dc_54:
  s_cmp_eq_u32 s73, 0xff
  s_nop 0
  s_cbranch_scc1 L_p2x
  s_add_u32 s100, s100, 1
  s_cmp_gt_u32 s100, 1000000
  s_cbranch_scc1 L_abort
  s_lshr_b32 s95, s73, 4
  s_xor_b32 s95, s95, s73
  s_and_b32 s95, s95, 15
  s_cbranch_scc1 L_p2n
  s_sleep 2
L_p2n:
  s_bitcmp1_b32 s73, 0
  s_cbranch_scc1 L_ll_55
  s_mov_b64 exec, s[60:61]
  buffer_load_dwordx4 v[8:11], v35, s[32:35], s70 offen offset:0 sc1
L_ll_55:
  s_bitcmp1_b32 s73, 1
  s_cbranch_scc1 L_ll_56
  s_mov_b64 exec, s[62:63]
  buffer_load_dwordx4 v[12:15], v35, s[32:35], s71 offen offset:0 sc1
L_ll_56:
  s_bitcmp1_b32 s73, 2
  s_cbranch_scc1 L_ll_57
  s_mov_b64 exec, s[64:65]
  buffer_load_dwordx4 v[16:19], v35, s[32:35], 0 offen offset:0 sc1
L_ll_57:
  s_bitcmp1_b32 s73, 3
  s_cbranch_scc1 L_ll_58
  s_mov_b64 exec, s[66:67]
  buffer_load_dwordx4 v[20:23], v35, s[32:35], s72 offen offset:0 sc1
L_ll_58:
  s_mov_b64 exec, -1
  s_branch L_p2
L_p2x:
  v_permlane32_swap_b32 v144, v148
  v_permlane32_swap_b32 v145, v149
  v_permlane32_swap_b32 v146, v150
  v_permlane32_swap_b32 v147, v151
  v_add_f32 v144, v144, v148
  v_add_f32 v145, v145, v149
  v_add_f32 v146, v146, v150
  v_add_f32 v147, v147, v151
  s_nop 0
  v_permlane16_swap_b32 v144, v146
  v_permlane16_swap_b32 v145, v147
  v_add_f32 v144, v144, v146
  v_add_f32 v145, v145, v147
  s_nop 0
  v_add_f32_dpp v144, v144, v144 row_ror:8 row_mask:0xf bank_mask:0xf
  v_add_f32_dpp v145, v145, v145 row_ror:8 row_mask:0xf bank_mask:0xf
  v_mul_f32 v144, v144, v168
  v_mul_f32 v145, v145, v168
  v_cvt_pk_bf16_f32 v44, v144, v145
  ds_write_b32 v37, v44
  s_waitcnt lgkmcnt(0)
  s_barrier
  ds_read_b128 v[160:163], v38
  ds_read_b128 v[164:167], v38 offset:64
  s_waitcnt lgkmcnt(1)
  v_mfma_f32_16x16x32_bf16 v[144:147], v[48:51], v[160:163], 0
  s_waitcnt lgkmcnt(0)
  v_mfma_f32_16x16x32_bf16 v[144:147], v[52:55], v[164:167], v[144:147]
  s_nop 7
  v_add_f32_dpp v144, v144, v144 quad_perm:[1,0,3,2] row_mask:0xf bank_mask:0xf
  v_add_f32_dpp v145, v145, v145 quad_perm:[1,0,3,2] row_mask:0xf bank_mask:0xf
  v_add_f32_dpp v146, v146, v146 quad_perm:[1,0,3,2] row_mask:0xf bank_mask:0xf
  v_add_f32_dpp v147, v147, v147 quad_perm:[1,0,3,2] row_mask:0xf bank_mask:0xf
  v_add_f32_dpp v144, v144, v144 quad_perm:[2,3,0,1] row_mask:0xf bank_mask:0xf
  v_add_f32_dpp v145, v145, v145 quad_perm:[2,3,0,1] row_mask:0xf bank_mask:0xf
  v_add_f32_dpp v146, v146, v146 quad_perm:[2,3,0,1] row_mask:0xf bank_mask:0xf
  v_add_f32_dpp v147, v147, v147 quad_perm:[2,3,0,1] row_mask:0xf bank_mask:0xf
  v_add_f32_dpp v144, v144, v144 row_half_mirror row_mask:0xf bank_mask:0xf
  v_add_f32_dpp v145, v145, v145 row_half_mirror row_mask:0xf bank_mask:0xf
  v_add_f32_dpp v146, v146, v146 row_half_mirror row_mask:0xf bank_mask:0xf
  v_add_f32_dpp v147, v147, v147 row_half_mirror row_mask:0xf bank_mask:0xf
  s_mov_b32 exec_lo, 0x10001
  s_mov_b32 exec_hi, 0x10001
  v_and_or_b32 v144, v144, v2, s49
  v_and_or_b32 v145, v145, v2, s50
  v_and_or_b32 v146, v146, v2, s51
  v_and_or_b32 v147, v147, v2, s52
  buffer_store_dwordx4 v[144:147], v1, s[32:35], s16 offen sc1
  s_mov_b64 exec, -1
  s_cmp_lt_u32 s2, 128
  s_cbranch_scc0 L_X
  s_mov_b32 s60, 0xffffffff
  s_mov_b32 s61, 0x0
  s_mov_b32 s100, 0
  s_branch L_gf_60
L_g_59:
  s_add_u32 s100, s100, 1
  s_cmp_gt_u32 s100, 1000000
  s_cbranch_scc1 L_abort
  s_sleep 1
L_gf_60:
  s_mov_b64 exec, s[60:61]
  buffer_load_dwordx4 v[128:131], v39, s[32:35], 0 offen offset:0 sc1
  s_waitcnt vmcnt(0)
L_gc_61:
  s_mov_b64 exec, s[60:61]
  v_perm_b32 v44, v129, v128, s56
  v_perm_b32 v44, v130, v44, s57
  v_perm_b32 v44, v131, v44, s58
  v_cmp_ne_u32 s[60:61], s48, v44
  s_nop 0
  s_cmp_lg_u64 s[60:61], 0
  s_cbranch_scc1 L_g_59
  s_mov_b64 exec, -1
  v_cvt_pk_bf16_f32 v44, v128, v129
  v_cvt_pk_bf16_f32 v45, v130, v131
  s_mov_b32 exec_hi, 0
  ds_write_b64 v43, v[44:45]
  s_mov_b32 exec_hi, -1
  s_waitcnt lgkmcnt(0)
  s_barrier
  ds_read_b128 v[128:131], v40 offset:0
  ds_read_b128 v[132:135], v40 offset:64
  ds_read_b128 v[136:139], v40 offset:128
  ds_read_b128 v[140:143], v40 offset:192
  s_waitcnt lgkmcnt(3)
  v_mfma_f32_16x16x32_bf16 v[144:147], v[80:83], v[128:131], 0
  s_waitcnt lgkmcnt(2)
  v_mfma_f32_16x16x32_bf16 v[144:147], v[84:87], v[132:135], v[144:147]
  s_waitcnt lgkmcnt(1)
  v_mfma_f32_16x16x32_bf16 v[144:147], v[88:91], v[136:139], v[144:147]
  s_waitcnt lgkmcnt(0)
  v_mfma_f32_16x16x32_bf16 v[144:147], v[92:95], v[140:143], v[144:147]
  s_nop 7
  v_add_f32_dpp v144, v144, v144 quad_perm:[1,0,3,2] row_mask:0xf bank_mask:0xf
  v_add_f32_dpp v145, v145, v145 quad_perm:[1,0,3,2] row_mask:0xf bank_mask:0xf
  v_add_f32_dpp v146, v146, v146 quad_perm:[1,0,3,2] row_mask:0xf bank_mask:0xf
  v_add_f32_dpp v147, v147, v147 quad_perm:[1,0,3,2] row_mask:0xf bank_mask:0xf
  v_add_f32_dpp v144, v144, v144 quad_perm:[2,3,0,1] row_mask:0xf bank_mask:0xf
  v_add_f32_dpp v145, v145, v145 quad_perm:[2,3,0,1] row_mask:0xf bank_mask:0xf
  v_add_f32_dpp v146, v146, v146 quad_perm:[2,3,0,1] row_mask:0xf bank_mask:0xf
  v_add_f32_dpp v147, v147, v147 quad_perm:[2,3,0,1] row_mask:0xf bank_mask:0xf
  v_add_f32_dpp v144, v144, v144 row_half_mirror row_mask:0xf bank_mask:0xf
  v_add_f32_dpp v145, v145, v145 row_half_mirror row_mask:0xf bank_mask:0xf
  v_add_f32_dpp v146, v146, v146 row_half_mirror row_mask:0xf bank_mask:0xf
  v_add_f32_dpp v147, v147, v147 row_half_mirror row_mask:0xf bank_mask:0xf
  s_mov_b32 exec_lo, 0x10001
  s_mov_b32 exec_hi, 0x10001
  v_and_or_b32 v144, v144, v2, s49
  v_and_or_b32 v145, v145, v2, s50
  v_and_or_b32 v146, v146, v2, s51
  v_and_or_b32 v147, v147, v2, s52
  buffer_store_dwordx4 v[144:147], v1, s[32:35], s75 offen sc1
  s_mov_b64 exec, -1
  s_branch L_Y
L_X:
  s_lshl_b32 s92, s79, 6
  v_and_b32 v44, 31, v1
  v_lshlrev_b32 v44, 1, v44
  v_add_u32 v44, s92, v44
  global_load_ushort v66, v44, s[4:5]
  s_movk_i32 s95, 0x4000
  s_mov_b64 s[60:61], -1
  s_mov_b32 s100, 0
  s_branch L_gf_65
L_g_64:
  s_add_u32 s100, s100, 1
  s_cmp_gt_u32 s100, 1000000
  s_cbranch_scc1 L_abort
  s_sleep 2
L_gf_65:
  s_mov_b64 exec, s[60:61]
  buffer_load_dwordx4 v[68:71], v56, s[32:35], 0 offen offset:0 sc1
  buffer_load_dwordx4 v[72:75], v56, s[32:35], s95 offen offset:0 sc1
  s_waitcnt vmcnt(0)
L_gc_66:
  s_mov_b64 exec, s[60:61]
  v_perm_b32 v44, v69, v68, s56
  v_perm_b32 v44, v70, v44, s57
  v_perm_b32 v44, v71, v44, s58
  v_cmp_ne_u32 s[60:61], s48, v44
  v_perm_b32 v44, v73, v72, s56
  v_perm_b32 v44, v74, v44, s57
  v_perm_b32 v44, v75, v44, s58
  v_cmp_ne_u32 vcc, s48, v44
  s_nop 0
  s_or_b64 s[60:61], s[60:61], vcc
  s_cmp_lg_u64 s[60:61], 0
  s_cbranch_scc1 L_g_64
  s_mov_b64 exec, -1
  v_permlane32_swap_b32 v68, v70
  v_permlane32_swap_b32 v69, v71
  v_add_f32 v68, v68, v70
  v_add_f32 v69, v69, v71
  s_nop 1
  v_permlane16_swap_b32 v68, v69
  v_add_f32 v68, v68, v69
  v_permlane32_swap_b32 v72, v74
  v_permlane32_swap_b32 v73, v75
  v_add_f32 v72, v72, v74
  v_add_f32 v73, v73, v75
  s_nop 1
  v_permlane16_swap_b32 v72, v73
  v_add_f32 v72, v72, v73
  v_cvt_pk_bf16_f32 v44, v68, v68
  v_and_b32 v68, 0xffff0000, v44
  v_cvt_pk_bf16_f32 v45, v72, v72
  v_and_b32 v72, 0xffff0000, v45
  v_and_b32 v44, 3, v1
  v_lshlrev_b32 v44, 6, v44
  v_bfe_u32 v3, v1, 2, 3
  v_lshl_add_u32 v44, v3, 2, v44
  ds_bpermute_b32 v76, v44, v68 offset:0
  ds_bpermute_b32 v77, v44, v68 offset:32
  ds_bpermute_b32 v78, v44, v72 offset:0
  ds_bpermute_b32 v79, v44, v72 offset:32
  s_lshr_b32 s92, s82, 12
  s_lshl_b32 s92, s92, 12
  s_add_u32 s94, s82, s92
  s_add_u32 s94, s94, 1114112
  s_add_u32 s95, s94, 4096
  s_add_u32 s82, s82, 851968
  s_waitcnt lgkmcnt(0)
  v_add_f32 v78, 1.0, v78
  v_lshlrev_b32 v66, 16, v66
  v_cvt_pk_bf16_f32 v44, v78, v78
  v_and_b32 v78, 0xffff0000, v44
  s_cmp_eq_u32 s3, 7
  s_cbranch_scc1 L_ab_63
  v_lshrrev_b32 v44, 16, v78
  ds_write_b16 v57, v44
  ds_read_b128 v[160:163], v41
  s_waitcnt lgkmcnt(0)
  v_mfma_f32_16x16x32_bf16 v[208:211], v[80:83], v[160:163], 0
  v_mfma_f32_16x16x32_bf16 v[212:215], v[84:87], v[160:163], 0
  v_mfma_f32_16x16x32_bf16 v[216:219], v[88:91], v[160:163], 0
  v_mfma_f32_16x16x32_bf16 v[220:223], v[92:95], v[160:163], 0
  s_mov_b32 exec_lo, 0x20002
  s_mov_b32 exec_hi, 0x20002
  s_nop 3
  v_mov_b32 v208, v212
  v_mov_b32 v209, v213
  v_mov_b32 v210, v214
  v_mov_b32 v211, v215
  s_mov_b32 exec_lo, 0x40004
  s_mov_b32 exec_hi, 0x40004
  v_mov_b32 v208, v216
  v_mov_b32 v209, v217
  v_mov_b32 v210, v218
  v_mov_b32 v211, v219
  s_mov_b32 exec_lo, 0x80008
  s_mov_b32 exec_hi, 0x80008
  v_mov_b32 v208, v220
  v_mov_b32 v209, v221
  v_mov_b32 v210, v222
  v_mov_b32 v211, v223
  s_mov_b32 exec_lo, 0xf000f
  s_mov_b32 exec_hi, 0xf000f
  v_and_or_b32 v208, v208, v2, s49
  v_and_or_b32 v209, v209, v2, s50
  v_and_or_b32 v210, v210, v2, s51
  v_and_or_b32 v211, v211, v2, s52
  buffer_store_dwordx4 v[208:211], v58, s[32:35], s94 offen sc1
  s_mov_b64 exec, -1
  v_lshrrev_b32 v44, 16, v77
  ds_write_b16 v57, v44
  ds_read_b128 v[160:163], v41
  s_waitcnt lgkmcnt(0)
  v_mfma_f32_16x16x32_bf16 v[224:227], v[80:83], v[160:163], 0
  v_mfma_f32_16x16x32_bf16 v[228:231], v[84:87], v[160:163], 0
  v_mfma_f32_16x16x32_bf16 v[232:235], v[88:91], v[160:163], 0
  v_mfma_f32_16x16x32_bf16 v[236:239], v[92:95], v[160:163], 0
  s_mov_b32 exec_lo, 0x20002
  s_mov_b32 exec_hi, 0x20002
  s_nop 3
  v_mov_b32 v224, v228
  v_mov_b32 v225, v229
  v_mov_b32 v226, v230
  v_mov_b32 v227, v231
  s_mov_b32 exec_lo, 0x40004
  s_mov_b32 exec_hi, 0x40004
  v_mov_b32 v224, v232
  v_mov_b32 v225, v233
  v_mov_b32 v226, v234
  v_mov_b32 v227, v235
  s_mov_b32 exec_lo, 0x80008
  s_mov_b32 exec_hi, 0x80008
  v_mov_b32 v224, v236
  v_mov_b32 v225, v237
  v_mov_b32 v226, v238
  v_mov_b32 v227, v239
  s_mov_b32 exec_lo, 0xf000f
  s_mov_b32 exec_hi, 0xf000f
  v_and_or_b32 v224, v224, v2, s49
  v_and_or_b32 v225, v225, v2, s50
  v_and_or_b32 v226, v226, v2, s51
  v_and_or_b32 v227, v227, v2, s52
  buffer_store_dwordx4 v[224:227], v58, s[32:35], s95 offen sc1
  s_mov_b64 exec, -1
L_ab_63:
  v_mov_b32 v112, 0
  v_mov_b32 v113, 0
  v_mov_b32 v114, 0
  v_mov_b32 v115, 0
  s_mov_b32 s60, 0xffffffff
  s_mov_b32 s61, 0x0
  s_mov_b32 s100, 0
  s_branch L_gf_69
L_g_68:
  s_add_u32 s100, s100, 1
  s_cmp_gt_u32 s100, 1000000
  s_cbranch_scc1 L_abort
  s_sleep 1
L_gf_69:
  s_mov_b64 exec, s[60:61]
  buffer_load_dwordx4 v[112:115], v61, s[32:35], s90 offen offset:0 sc1
  s_waitcnt vmcnt(0)
L_gc_70:
  s_mov_b64 exec, s[60:61]
  v_perm_b32 v44, v113, v112, s56
  v_perm_b32 v44, v114, v44, s57
  v_perm_b32 v44, v115, v44, s58
  v_cmp_ne_u32 s[60:61], s48, v44
  s_nop 0
  s_cmp_lg_u64 s[60:61], 0
  s_cbranch_scc1 L_g_68
  s_mov_b64 exec, -1
  v_permlane32_swap_b32 v112, v114
  v_permlane32_swap_b32 v113, v115
  v_add_f32 v112, v112, v114
  v_add_f32 v113, v113, v115
  s_nop 1
  v_permlane16_swap_b32 v112, v113
  v_add_f32 v112, v112, v113
  s_nop 1
  v_add_f32_dpp v112, v112, v112 row_ror:8 row_mask:0xf bank_mask:0xf
  ds_write_b32 v59, v112
  s_waitcnt lgkmcnt(0)
  s_barrier
  ds_read_b128 v[112:115], v60
  ds_read_b128 v[116:119], v60 offset:16
  s_waitcnt lgkmcnt(0)
  v_add_f32 v112, v112, v113
  v_add_f32 v114, v114, v115
  v_add_f32 v116, v116, v117
  v_add_f32 v118, v118, v119
  v_add_f32 v112, v112, v114
  v_add_f32 v116, v116, v118
  v_add_f32 v112, v112, v116
  v_cvt_pk_bf16_f32 v44, v112, v112
  v_and_b32 v112, 0xffff0000, v44
  v_mul_f32 v67, v76, v112
  v_cvt_pk_bf16_f32 v44, v67, v67
  v_and_b32 v67, 0xffff0000, v44
  v_add_f32 v67, v66, v67
  v_cvt_pk_bf16_f32 v44, v67, v67
  v_and_b32 v67, 0xffff0000, v44
  s_cmp_eq_u32 s3, 7
  s_cbranch_scc1 L_stat
  v_mul_f32 v44, v67, v78
  v_cvt_pk_bf16_f32 v44, v44, v44
  ds_write_b16 v57, v44
  ds_read_b128 v[160:163], v41
  s_waitcnt lgkmcnt(0)
  v_mfma_f32_16x16x32_bf16 v[128:131], v[80:83], v[160:163], 0
  v_mfma_f32_16x16x32_bf16 v[132:135], v[84:87], v[160:163], 0
  v_mfma_f32_16x16x32_bf16 v[136:139], v[88:91], v[160:163], 0
  v_mfma_f32_16x16x32_bf16 v[140:143], v[92:95], v[160:163], 0
  s_mov_b32 exec_lo, 0x20002
  s_mov_b32 exec_hi, 0x20002
  s_nop 3
  v_mov_b32 v128, v132
  v_mov_b32 v129, v133
  v_mov_b32 v130, v134
  v_mov_b32 v131, v135
  s_mov_b32 exec_lo, 0x40004
  s_mov_b32 exec_hi, 0x40004
  v_mov_b32 v128, v136
  v_mov_b32 v129, v137
  v_mov_b32 v130, v138
  v_mov_b32 v131, v139
  s_mov_b32 exec_lo, 0x80008
  s_mov_b32 exec_hi, 0x80008
  v_mov_b32 v128, v140
  v_mov_b32 v129, v141
  v_mov_b32 v130, v142
  v_mov_b32 v131, v143
  s_mov_b32 exec_lo, 0xf000f
  s_mov_b32 exec_hi, 0xf000f
  v_and_or_b32 v128, v128, v2, s49
  v_and_or_b32 v129, v129, v2, s50
  v_and_or_b32 v130, v130, v2, s51
  v_and_or_b32 v131, v131, v2, s52
  buffer_store_dwordx4 v[128:131], v58, s[32:35], s82 offen sc1
  s_mov_b64 exec, -1
  s_branch L_xdone
L_stat:
  v_mov_b32 v130, v67
  v_mul_f32 v131, v67, v67
  s_nop 0
  v_add_f32_dpp v130, v130, v130 row_ror:8 row_mask:0xf bank_mask:0xf
  v_add_f32_dpp v131, v131, v131 row_ror:8 row_mask:0xf bank_mask:0xf
  s_nop 0
  v_add_f32_dpp v130, v130, v130 row_ror:4 row_mask:0xf bank_mask:0xf
  v_add_f32_dpp v131, v131, v131 row_ror:4 row_mask:0xf bank_mask:0xf
  s_nop 0
  v_add_f32_dpp v130, v130, v130 row_ror:2 row_mask:0xf bank_mask:0xf
  v_add_f32_dpp v131, v131, v131 row_ror:2 row_mask:0xf bank_mask:0xf
  s_nop 0
  v_add_f32_dpp v130, v130, v130 row_ror:1 row_mask:0xf bank_mask:0xf
  v_add_f32_dpp v131, v131, v131 row_ror:1 row_mask:0xf bank_mask:0xf
  v_mov_b32 v128, v130
  v_mov_b32 v129, v131
  s_nop 0
  v_permlane16_swap_b32 v130, v128
  v_permlane16_swap_b32 v131, v129
  v_add_f32 v130, v130, v128
  v_add_f32 v131, v131, v129
  v_and_b32 v128, v2, v130
  v_and_b32 v129, v2, v131
  v_sub_f32 v130, v130, v128
  v_sub_f32 v131, v131, v129
  v_and_or_b32 v128, v128, v2, s49
  v_and_or_b32 v129, v129, v2, s50
  v_and_or_b32 v130, v130, v2, s51
  v_and_or_b32 v131, v131, v2, s52
  s_lshl_b32 s92, s80, 11
  s_lshl_b32 s97, s79, 7
  s_add_u32 s92, s92, s97
  s_add_u32 s92, s92, 98304
  s_mov_b64 exec, 1
  buffer_store_dwordx4 v[128:131], v1, s[32:35], s92 offen sc1
  s_mov_b64 exec, -1
  v_mov_b32 v112, 0
L_xdone:
  s_cmp_lg_u32 s80, 0
  s_cbranch_scc1 L_fin
  s_mul_i32 s90, s79, 8448
  s_lshl_b32 s97, s3, 10
  s_add_u32 s90, s90, s97
  s_add_u32 s90, s90, 655360
  s_lshl_b32 s92, s79, 6
  v_and_b32 v46, 31, v1
  v_lshlrev_b32 v46, 1, v46
  v_add_u32 v46, s92, v46
  s_cmp_eq_u32 s3, 7
  s_cbranch_scc1 L_nof
  s_sleep 8
  s_mov_b64 s[60:61], -1
  s_mov_b32 s100, 0
  s_branch L_gf_73
L_g_72:
  s_add_u32 s100, s100, 1
  s_cmp_gt_u32 s100, 1000000
  s_cbranch_scc1 L_abort
  s_sleep 1
L_gf_73:
  s_mov_b64 exec, s[60:61]
  buffer_load_dwordx4 v[112:115], v34, s[32:35], s90 offen offset:0 sc1
  s_waitcnt vmcnt(0)
L_gc_74:
  s_mov_b64 exec, s[60:61]
  v_perm_b32 v44, v113, v112, s56
  v_perm_b32 v44, v114, v44, s57
  v_perm_b32 v44, v115, v44, s58
  v_cmp_ne_u32 s[60:61], s48, v44
  s_nop 0
  s_cmp_lg_u64 s[60:61], 0
  s_cbranch_scc1 L_g_72
  s_mov_b64 exec, -1
  v_permlane32_swap_b32 v112, v114
  v_permlane32_swap_b32 v113, v115
  v_add_f32 v112, v112, v114
  v_add_f32 v113, v113, v115
  s_nop 1
  v_permlane16_swap_b32 v112, v113
  v_add_f32 v112, v112, v113
  s_nop 1
  v_add_f32_dpp v112, v112, v112 row_ror:8 row_mask:0xf bank_mask:0xf
L_nof:
  ds_write_b32 v59, v112 offset:1024
  s_waitcnt lgkmcnt(0)
  s_barrier
  s_cmp_lg_u32 s3, 0
  s_cbranch_scc1 L_fin
  ds_read_b128 v[112:115], v60 offset:1024
  ds_read_b128 v[116:119], v60 offset:1040
  s_waitcnt lgkmcnt(0)
  v_add_f32 v112, v112, v113
  v_add_f32 v114, v114, v115
  v_add_f32 v116, v116, v117
  v_add_f32 v118, v118, v119
  v_add_f32 v112, v112, v114
  v_add_f32 v116, v116, v118
  v_add_f32 v112, v112, v116
  v_cvt_pk_bf16_f32 v45, v112, v112
  v_and_b32 v112, 0xffff0000, v45
  v_mul_f32 v44, v79, v112
  v_cvt_pk_bf16_f32 v45, v44, v44
  v_and_b32 v44, 0xffff0000, v45
  v_add_f32 v44, v67, v44
  v_cvt_pk_bf16_f32 v44, v44, v44
  s_mov_b32 exec_hi, 0
  global_store_short v46, v44, s[28:29]
  s_cmp_lg_u32 s2, 128
  s_cbranch_scc1 L_noep
  s_mov_b64 exec, 1
  v_mov_b32 v45, 0
  global_store_dword v45, v45, s[30:31]
L_noep:
L_fin:
  s_endpgm
L_Y:
  s_cmp_ge_u32 s2, 112
  s_cbranch_scc1 L_fin
  s_mov_b64 s[40:41], s[22:23]
  s_mov_b32 s42, 0x1c0000
  s_mov_b32 s43, 0x20000
  v_lshrrev_b32 v44, 5, v1
  v_lshlrev_b32 v44, 10, v44
  v_and_b32 v3, 31, v1
  v_lshl_add_u32 v44, v3, 4, v44
  buffer_load_dwordx4 v[176:179], v44, s[40:43], s91 offen offset:0 nt
  buffer_load_dwordx4 v[180:183], v44, s[40:43], s91 offen offset:2048 nt
  v_mov_b32 v112, 0
  v_mov_b32 v113, 0
  v_mov_b32 v114, 0
  v_mov_b32 v115, 0
  s_lshl_b32 s94, s81, 13
  s_lshl_b32 s97, s3, 10
  s_add_u32 s94, s94, s97
  s_add_u32 s94, s94, 1114112
  v_lshlrev_b32 v46, 4, v1
  v_add_u32 v46, 88064, v46
  v_lshlrev_b32 v47, 5, v1
  v_add_u32 v47, 83968, v47
  s_mov_b64 s[60:61], -1
  s_mov_b32 s100, 0
  s_branch L_gf_77
L_g_76:
  s_add_u32 s100, s100, 1
  s_cmp_gt_u32 s100, 1000000
  s_cbranch_scc1 L_abort
  s_sleep 2
L_gf_77:
  s_mov_b64 exec, s[60:61]
  buffer_load_dwordx4 v[128:131], v34, s[32:35], s94 offen offset:0 sc1
  s_waitcnt vmcnt(0)
L_gc_78:
  s_mov_b64 exec, s[60:61]
  v_perm_b32 v44, v129, v128, s56
  v_perm_b32 v44, v130, v44, s57
  v_perm_b32 v44, v131, v44, s58
  v_cmp_ne_u32 s[60:61], s48, v44
  s_nop 0
  s_cmp_lg_u64 s[60:61], 0
  s_cbranch_scc1 L_g_76
  s_mov_b64 exec, -1
  v_permlane32_swap_b32 v128, v130
  v_permlane32_swap_b32 v129, v131
  v_add_f32 v128, v128, v130
  v_add_f32 v129, v129, v131
  s_nop 1
  v_permlane16_swap_b32 v128, v129
  v_add_f32 v128, v128, v129
  ds_write_b128 v62, v[176:179] offset:0
  ds_write_b128 v62, v[180:183] offset:1088
  ds_write_b32 v60, v128
  s_waitcnt lgkmcnt(0)
  s_barrier
  ds_read_b64_tr_b16 v[80:81], v63 offset:0
  ds_read_b64_tr_b16 v[82:83], v63 offset:2176
  ds_read_b64_tr_b16 v[84:85], v63 offset:32
  ds_read_b64_tr_b16 v[86:87], v63 offset:2208
  ds_read_b128 v[128:131], v46
  ds_read_b128 v[132:135], v46 offset:1024
  s_waitcnt lgkmcnt(0)
  v_add_f32 v128, v128, v129
  v_add_f32 v130, v130, v131
  v_add_f32 v128, v128, v130
  v_add_f32 v132, v132, v133
  v_add_f32 v134, v134, v135
  v_add_f32 v132, v132, v134
  s_mov_b32 s60, 0xffffffff
  s_mov_b32 s61, 0x0
  s_mov_b32 s62, 0xffff
  s_mov_b32 s63, 0x0
  s_mov_b32 s100, 0
  s_branch L_gf_81
L_g_80:
  s_add_u32 s100, s100, 1
  s_cmp_gt_u32 s100, 1000000
  s_cbranch_scc1 L_abort
  s_sleep 1
L_gf_81:
  s_mov_b64 exec, s[60:61]
  s_cbranch_execz L_gs_83
  buffer_load_dwordx4 v[112:115], v61, s[32:35], s82 offen offset:0 sc1
L_gs_83:
  s_mov_b64 exec, s[62:63]
  s_cbranch_execz L_gs_84
  buffer_load_dwordx4 v[136:139], v56, s[32:35], 0 offen offset:0 sc1
L_gs_84:
  s_waitcnt vmcnt(0)
L_gc_82:
  s_mov_b64 exec, s[60:61]
  v_perm_b32 v44, v113, v112, s56
  v_perm_b32 v44, v114, v44, s57
  v_perm_b32 v44, v115, v44, s58
  v_cmp_ne_u32 s[60:61], s48, v44
  s_mov_b64 exec, s[62:63]
  v_perm_b32 v44, v137, v136, s56
  v_perm_b32 v44, v138, v44, s57
  v_perm_b32 v44, v139, v44, s58
  v_cmp_ne_u32 s[62:63], s48, v44
  s_nop 0
  s_or_b64 s[96:97], s[60:61], s[62:63]
  s_cbranch_scc1 L_g_80
  s_mov_b64 exec, -1
  v_permlane32_swap_b32 v112, v114
  v_permlane32_swap_b32 v113, v115
  v_add_f32 v112, v112, v114
  v_add_f32 v113, v113, v115
  s_nop 1
  v_permlane16_swap_b32 v112, v113
  v_add_f32 v112, v112, v113
  ds_write_b32 v59, v112
  v_add_f32 v136, v136, v138
  v_add_f32 v137, v137, v139
  s_nop 0
  v_add_f32_dpp v136, v136, v136 quad_perm:[1,0,3,2] row_mask:0xf bank_mask:0xf
  v_add_f32_dpp v137, v137, v137 quad_perm:[1,0,3,2] row_mask:0xf bank_mask:0xf
  s_nop 0
  v_add_f32_dpp v136, v136, v136 quad_perm:[2,3,0,1] row_mask:0xf bank_mask:0xf
  v_add_f32_dpp v137, v137, v137 quad_perm:[2,3,0,1] row_mask:0xf bank_mask:0xf
  s_nop 0
  v_add_f32_dpp v136, v136, v136 row_half_mirror row_mask:0xf bank_mask:0xf
  v_add_f32_dpp v137, v137, v137 row_half_mirror row_mask:0xf bank_mask:0xf
  s_nop 0
  v_add_f32_dpp v136, v136, v136 row_ror:8 row_mask:0xf bank_mask:0xf
  v_add_f32_dpp v137, v137, v137 row_ror:8 row_mask:0xf bank_mask:0xf
  s_waitcnt lgkmcnt(0)
  s_barrier
  ds_read_b128 v[112:115], v47
  ds_read_b128 v[116:119], v47 offset:16
  v_readfirstlane_b32 s92, v136
  v_readfirstlane_b32 s93, v137
  v_mov_b32 v44, 0x3b000000
  v_mul_f32 v136, s92, v44
  v_mul_f32 v137, s93, v44
  v_fma_f32 v137, -v136, v136, v137
  v_max_f32 v137, 0, v137
  v_cvt_pk_bf16_f32 v45, v137, v137
  v_and_b32 v137, 0xffff0000, v45
  v_cvt_pk_bf16_f32 v44, v136, v136
  v_and_b32 v136, 0xffff0000, v44
  v_add_f32 v137, 0x3727c5ac, v137
  v_mul_f32 v128, v136, v128
  v_cvt_pk_bf16_f32 v45, v137, v137
  v_and_b32 v137, 0xffff0000, v45
  v_sqrt_f32 v137, v137
  s_nop 0
  v_cvt_pk_bf16_f32 v45, v137, v137
  v_and_b32 v137, 0xffff0000, v45
  v_rcp_f32 v137, v137
  s_waitcnt lgkmcnt(0)
  v_add_f32 v112, v112, v113
  v_add_f32 v114, v114, v115
  v_add_f32 v116, v116, v117
  v_add_f32 v118, v118, v119
  v_add_f32 v112, v112, v114
  v_add_f32 v116, v116, v118
  v_add_f32 v112, v112, v116
  v_sub_f32 v112, v112, v128
  v_fma_f32 v112, v112, v137, v132
  v_cvt_pk_bf16_f32 v44, v112, v112
  v_and_b32 v112, 0xffff0000, v44
  v_mul_f32 v44, v112, v112
  v_mov_b32 v45, 0xc0135761
  v_mov_b32_dpp v113, v112 row_ror:8 row_mask:0xf bank_mask:0xf
  v_fmac_f32 v45, 0xbdd2d3e8, v44
  v_mul_f32 v44, v45, v112
  v_exp_f32 v44, v44
  s_nop 0
  v_add_f32 v44, 1.0, v44
  v_rcp_f32 v44, v44
  s_nop 0
  v_mul_f32 v112, v112, v44
  v_cvt_pk_bf16_f32 v44, v112, v112
  v_and_b32 v112, 0xffff0000, v44
  v_mul_f32 v112, v112, v113
  v_cvt_pk_bf16_f32 v44, v112, v112
  s_mov_b32 exec_lo, 0xff00ff
  s_mov_b32 exec_hi, 0xff00ff
  ds_write_b16 v57, v44
  s_mov_b64 exec, -1
  ds_read_b128 v[160:163], v41
  s_waitcnt lgkmcnt(0)
  v_mfma_f32_16x16x32_bf16 v[144:147], v[80:83], v[160:163], 0
  v_mfma_f32_16x16x32_bf16 v[148:151], v[84:87], v[160:163], 0
  s_mov_b32 exec_lo, 0x20002
  s_mov_b32 exec_hi, 0x20002
  s_nop 5
  v_mov_b32 v144, v148
  v_mov_b32 v145, v149
  v_mov_b32 v146, v150
  v_mov_b32 v147, v151
  s_mov_b32 exec_lo, 0x30003
  s_mov_b32 exec_hi, 0x30003
  v_and_or_b32 v144, v144, v2, s49
  v_and_or_b32 v145, v145, v2, s50
  v_and_or_b32 v146, v146, v2, s51
  v_and_or_b32 v147, v147, v2, s52
  buffer_store_dwordx4 v[144:147], v58, s[32:35], s90 offen sc1
  s_endpgm
L_abort:
  s_endpgm
L_end:
  s_endpgm
L_codeend:
.section .rodata,"a"
.p2align 6
.amdhsa_kernel adaLN_cond__compressed_kv_cla__glu_gated_geglu__decode_kernel
  .amdhsa_next_free_vgpr 256
  .amdhsa_next_free_sgpr 102
  .amdhsa_accum_offset 256
  .amdhsa_group_segment_fixed_size 0
  .amdhsa_kernarg_size 120
  .amdhsa_user_sgpr_count 2
  .amdhsa_user_sgpr_kernarg_segment_ptr 1
  .amdhsa_system_sgpr_workgroup_id_x 1
.end_amdhsa_kernel
```

```asm
; @launch grid=(256,1,1) block=(512,1,1) lds=163840
.amdgcn_target "amdgcn-amd-amdhsa--gfx950"
.text
.globl adaLN_cond__compressed_kv_cla__glu_gated_geglu__decode_kernel
.p2align 8
.type adaLN_cond__compressed_kv_cla__glu_gated_geglu__decode_kernel,@function
adaLN_cond__compressed_kv_cla__glu_gated_geglu__decode_kernel:
  s_cmp_ge_u32 s2, 256
  s_cbranch_scc1 L_end
  s_load_dwordx16 s[4:19], s[0:1], 0
  s_load_dwordx8 s[20:27], s[0:1], 64
  s_load_dwordx4 s[28:31], s[0:1], 96
  s_load_dwordx2 s[32:33], s[0:1], 112
  v_lshrrev_b32 v1, 6, v0
  s_mov_b32 s34, 0x10000000
  s_mov_b32 s35, 0x20000
  v_readfirstlane_b32 s3, v1
  v_and_b32 v1, 63, v0
  v_mov_b32 v8, 0
  v_mov_b32 v20, 0
  v_mov_b32 v251, 0
  v_mov_b32 v253, 0
  s_cmp_lt_u32 s2, 128
  s_cbranch_scc0 L_B
  v_lshlrev_b32 v38, 4, v1
  s_bfe_u32 s82, s2, 0x30003
  s_lshl_b32 s82, s82, 19
  s_lshl_b32 s97, s3, 16
  s_add_u32 s82, s82, s97
  s_and_b32 s97, s2, 7
  s_lshl_b32 s97, s97, 10
  s_add_u32 s82, s82, s97
  s_mov_b32 s42, 0x400000
  s_mov_b32 s43, 0x20000
  s_bitcmp1_b32 s2, 6
  s_cbranch_scc1 L_K
  v_and_b32 v8, 15, v1
  v_lshlrev_b32 v8, 3, v8
  v_lshrrev_b32 v3, 4, v1
  v_lshl_add_u32 v8, v3, 1, v8
  s_bfe_u32 s92, s2, 0x30003
  s_lshl_b32 s92, s92, 7
  v_add_u32 v17, s92, v8
  s_mul_i32 s83, s3, 8576
  s_lshl_b32 s92, s2, 17
  v_mov_b32 v18, s92
  v_mov_b32 v19, 0xf000
  s_waitcnt lgkmcnt(0)
  s_mov_b64 s[40:41], s[8:9]
  global_load_dwordx4 v[12:15], v38, s[4:5]
  global_load_ushort v16, v17, s[4:5]
  s_add_u32 m0, s83, 0
  s_add_u32 s92, s82, 0
  buffer_load_dwordx4 v38, s[40:43], s92 offen nt lds
  s_add_u32 m0, s83, 1056
  s_add_u32 s92, s82, 8192
  buffer_load_dwordx4 v38, s[40:43], s92 offen nt lds
  s_add_u32 m0, s83, 2112
  s_add_u32 s92, s82, 16384
  buffer_load_dwordx4 v38, s[40:43], s92 offen nt lds
  s_add_u32 m0, s83, 3168
  s_add_u32 s92, s82, 24576
  buffer_load_dwordx4 v38, s[40:43], s92 offen nt lds
  s_add_u32 m0, s83, 4224
  s_add_u32 s92, s82, 32768
  buffer_load_dwordx4 v38, s[40:43], s92 offen nt lds
  s_add_u32 m0, s83, 5280
  s_add_u32 s92, s82, 40960
  buffer_load_dwordx4 v38, s[40:43], s92 offen nt lds
  s_add_u32 m0, s83, 6336
  s_add_u32 s92, s82, 49152
  buffer_load_dwordx4 v38, s[40:43], s92 offen nt lds
  s_add_u32 m0, s83, 7392
  s_add_u32 s92, s82, 57344
  buffer_load_dwordx4 v38, s[40:43], s92 offen nt lds
  s_cmp_lg_u32 s3, 7
  s_cbranch_scc1 L_nt_1
  s_mov_b64 exec, 1
  global_load_dword v20, v18, s[6:7] nt
  global_load_dword v21, v19, s[32:33]
  global_load_dword v22, v38, s[30:31] offset:128
  s_mov_b64 exec, -1
L_nt_1:
  s_branch L_Q2
L_K:
  s_bfe_u32 s81, s2, 0x10004
  s_xor_b32 s81, s81, 1
  s_lshl_b32 s81, s81, 16
  s_and_b32 s92, s3, 1
  s_lshl_b32 s92, s92, 7
  v_xor_b32 v39, s92, v38
  s_lshl_b32 s83, s3, 13
  s_add_u32 s83, s83, s81
  v_mov_b32 v19, 0xf000
  s_waitcnt lgkmcnt(0)
  s_mov_b64 s[40:41], s[10:11]
  s_mov_b64 exec, 1
  global_load_dword v21, v19, s[32:33]
  s_mov_b64 exec, -1
  v_xor_b32 v40, 0, v39
  s_add_u32 m0, s83, 0
  s_add_u32 s92, s82, 0
  buffer_load_dwordx4 v40, s[40:43], s92 offen nt lds
  v_xor_b32 v41, 16, v39
  s_add_u32 m0, s83, 1024
  s_add_u32 s92, s82, 8192
  buffer_load_dwordx4 v41, s[40:43], s92 offen nt lds
  v_xor_b32 v40, 32, v39
  s_add_u32 m0, s83, 2048
  s_add_u32 s92, s82, 16384
  buffer_load_dwordx4 v40, s[40:43], s92 offen nt lds
  v_xor_b32 v41, 48, v39
  s_add_u32 m0, s83, 3072
  s_add_u32 s92, s82, 24576
  buffer_load_dwordx4 v41, s[40:43], s92 offen nt lds
  v_xor_b32 v40, 64, v39
  s_add_u32 m0, s83, 4096
  s_add_u32 s92, s82, 32768
  buffer_load_dwordx4 v40, s[40:43], s92 offen nt lds
  v_xor_b32 v41, 80, v39
  s_add_u32 m0, s83, 5120
  s_add_u32 s92, s82, 40960
  buffer_load_dwordx4 v41, s[40:43], s92 offen nt lds
  v_xor_b32 v40, 96, v39
  s_add_u32 m0, s83, 6144
  s_add_u32 s92, s82, 49152
  buffer_load_dwordx4 v40, s[40:43], s92 offen nt lds
  v_xor_b32 v41, 112, v39
  s_add_u32 m0, s83, 7168
  s_add_u32 s92, s82, 57344
  buffer_load_dwordx4 v41, s[40:43], s92 offen nt lds
  s_branch L_K2
L_B:
  s_cmp_ge_u32 s3, 4
  s_cbranch_scc0 L_Bfront
  v_lshrrev_b32 v10, 3, v1
  v_mul_u32_u24 v5, 24576, v10
  v_lshlrev_b32 v10, 3, v10
  v_and_b32 v11, 7, v1
  v_lshl_add_u32 v5, v11, 4, v5
  s_bfe_u32 s94, s2, 0x20004
  s_and_b32 s95, s2, 15
  s_lshl_b32 s92, s94, 2
  s_add_u32 s92, s92, s3
  s_sub_u32 s92, s92, 4
  s_lshl_b32 s93, s92, 6
  v_add_u32 v10, s93, v10
  s_mul_i32 s92, s92, 196608
  s_lshl_b32 s93, s95, 7
  s_add_u32 s92, s92, s93
  s_mov_b32 s42, 0x300000
  s_mov_b32 s43, 0x20000
  v_mov_b32 v253, 0
  s_waitcnt lgkmcnt(0)
  s_mov_b64 s[40:41], s[26:27]
  s_bitcmp1_b32 s2, 6
  s_cbranch_scc1 L_nou0
  global_load_dwordx2 v[112:113], v10, s[24:25]
  buffer_load_dwordx4 v[124:127], v5, s[40:43], s92 offen nt
  s_add_u32 s92, s92, 6144
  buffer_load_dwordx4 v[128:131], v5, s[40:43], s92 offen nt
  s_add_u32 s92, s92, 6144
  buffer_load_dwordx4 v[132:135], v5, s[40:43], s92 offen nt
  s_add_u32 s92, s92, 6144
  buffer_load_dwordx4 v[136:139], v5, s[40:43], s92 offen nt
L_nou0:
  s_branch L_Bback2
L_Bfront:
  s_memrealtime s[62:63]
  s_bfe_u32 s64, s2, 0x40003
  s_xor_b32 s64, s64, 8
  s_or_b32 s64, s64, s3
  s_cbranch_scc1 L_nononce
  v_mov_b32 v18, 0
  v_mov_b32 v21, 0
  s_waitcnt lgkmcnt(0)
  s_or_b32 s62, s62, 1
  v_mov_b32 v20, s62
  s_mov_b64 exec, 1
  global_atomic_cmpswap v18, v[20:21], s[30:31] sc1
  s_mov_b64 exec, -1
L_nononce:
  v_lshrrev_b32 v245, 4, v1
  v_and_b32 v246, 15, v1
  v_lshlrev_b32 v247, 2, v245
  v_xor_b32 v246, v246, v247
  v_lshlrev_b32 v246, 4, v246
  v_lshl_add_u32 v244, v245, 10, v246
  v_xor_b32 v245, 16, v244
  v_xor_b32 v246, 32, v244
  v_xor_b32 v247, 48, v244
  v_add_u32 v245, 3072, v245
  v_add_u32 v246, 6144, v246
  v_add_u32 v247, 9216, v247
  s_and_b32 s91, s3, 3
  s_lshl_b32 s90, s91, 15
  s_lshl_b32 s91, s91, 13
  s_lshl_b32 s92, s2, 17
  s_add_u32 s90, s90, s92
  s_bfe_u32 s93, s2, 0x20003
  s_lshl_b32 s92, s93, 15
  s_add_u32 s91, s91, s92
  s_lshl_b32 s92, s93, 8
  s_add_u32 s90, s90, s92
  s_getpc_b64 s[94:95]
L_pc:
  s_sub_u32 s94, s94, L_pc-adaLN_cond__compressed_kv_cla__glu_gated_geglu__decode_kernel
  s_subb_u32 s95, s95, 0
  s_bfe_u32 s92, s2, 0x40003
  s_lshl_b32 s92, s92, 2
  s_add_u32 s92, s92, s3
  s_lshl_b32 s92, s92, 10
  v_lshlrev_b32 v11, 4, v1
  v_add_u32 v11, s92, v11
  s_mov_b32 s38, 0x2000000
  s_mov_b32 s39, 0x20000
  s_cmp_ge_u32 s92, L_codeend-adaLN_cond__compressed_kv_cla__glu_gated_geglu__decode_kernel
  s_cbranch_scc1 L_nopf
  v_min_u32 v11, L_codeend-adaLN_cond__compressed_kv_cla__glu_gated_geglu__decode_kernel-16, v11
  global_load_dwordx4 v[12:15], v11, s[94:95]
L_nopf:
  s_waitcnt lgkmcnt(0)
  s_mov_b64 s[36:37], s[6:7]
  s_barrier
  s_barrier
  s_mov_b32 s54, 0x05040100
  s_mov_b32 s55, 0x07060302
  s_mov_b32 s56, 0x0c0c0400
  s_mov_b32 s57, 0x0c040100
  s_mov_b32 s58, 0x04020100
  s_mov_b32 s53, 0x10001
  v_mov_b32 v2, 0xffffff00
  s_lshr_b32 s77, s2, 5
  s_and_b32 s78, s2, 127
  s_and_b32 s76, s2, 7
  s_lshl_b32 s76, s76, 2
  s_bfe_u32 s97, s2, 0x20003
  s_add_u32 s76, s76, s97
  s_and_b32 s79, s2, 7
  s_lshl_b32 s79, s79, 1
  s_bfe_u32 s97, s2, 0x10003
  s_add_u32 s79, s79, s97
  s_bfe_u32 s80, s2, 0x30004
  s_bfe_u32 s17, s2, 0x20003
  s_bfe_u32 s59, s2, 0x10004
  s_lshl_b32 s59, s59, 14
  s_xor_b32 m0, s91, 0
  s_xor_b32 s101, s90, 0
  buffer_load_dwordx4 v244, s[36:39], s101 offen offset:0 nt lds
  s_waitcnt vmcnt(0)
  buffer_load_dwordx4 v245, s[36:39], s101 offen offset:1024 nt lds
  s_waitcnt vmcnt(2)
  buffer_load_dwordx4 v246, s[36:39], s101 offen offset:2048 nt lds
  s_waitcnt vmcnt(2)
  buffer_load_dwordx4 v247, s[36:39], s101 offen offset:3072 nt lds
  s_waitcnt vmcnt(2)
  s_xor_b32 m0, s91, 32768
  s_xor_b32 s101, s90, 256
  buffer_load_dwordx4 v244, s[36:39], s101 offen offset:0 nt lds
  s_waitcnt vmcnt(2)
  buffer_load_dwordx4 v245, s[36:39], s101 offen offset:1024 nt lds
  s_waitcnt vmcnt(2)
  buffer_load_dwordx4 v246, s[36:39], s101 offen offset:2048 nt lds
  s_waitcnt vmcnt(2)
  buffer_load_dwordx4 v247, s[36:39], s101 offen offset:3072 nt lds
  s_waitcnt vmcnt(2)
  s_xor_b32 m0, s91, 65536
  s_xor_b32 s101, s90, 512
  buffer_load_dwordx4 v244, s[36:39], s101 offen offset:0 nt lds
  buffer_load_dwordx4 v245, s[36:39], s101 offen offset:1024 nt lds
  buffer_load_dwordx4 v246, s[36:39], s101 offen offset:2048 nt lds
  buffer_load_dwordx4 v247, s[36:39], s101 offen offset:3072 nt lds
  v_mov_b32 v253, 0
  global_load_dword v252, v253, s[30:31] sc1
  s_xor_b32 m0, s91, 98304
  s_xor_b32 s101, s90, 768
  buffer_load_dwordx4 v244, s[36:39], s101 offen offset:0 nt lds
  buffer_load_dwordx4 v245, s[36:39], s101 offen offset:1024 nt lds
  buffer_load_dwordx4 v246, s[36:39], s101 offen offset:2048 nt lds
  buffer_load_dwordx4 v247, s[36:39], s101 offen offset:3072 nt lds
  s_barrier
  s_branch L_front
L_Q2:
  s_mov_b32 s54, 0x05040100
  s_mov_b32 s55, 0x07060302
  s_mov_b32 s56, 0x0c0c0400
  s_mov_b32 s57, 0x0c040100
  s_mov_b32 s58, 0x04020100
  s_mov_b32 s53, 0x10001
  v_mov_b32 v2, 0xffffff00
  s_lshr_b32 s77, s2, 5
  s_and_b32 s78, s2, 127
  s_and_b32 s76, s2, 7
  s_lshl_b32 s76, s76, 2
  s_bfe_u32 s97, s2, 0x20003
  s_add_u32 s76, s76, s97
  s_and_b32 s79, s2, 7
  s_lshl_b32 s79, s79, 1
  s_bfe_u32 s97, s2, 0x10003
  s_add_u32 s79, s79, s97
  s_bfe_u32 s80, s2, 0x30004
  s_bfe_u32 s17, s2, 0x20003
  s_bfe_u32 s59, s2, 0x10004
  s_lshl_b32 s59, s59, 14
  v_lshrrev_b32 v245, 4, v1
  v_and_b32 v246, 15, v1
  v_lshlrev_b32 v247, 2, v245
  v_xor_b32 v246, v246, v247
  v_lshlrev_b32 v246, 4, v246
  v_lshl_add_u32 v244, v245, 10, v246
  v_xor_b32 v245, 16, v244
  v_xor_b32 v246, 32, v244
  v_xor_b32 v247, 48, v244
  v_add_u32 v245, 3072, v245
  v_add_u32 v246, 6144, v246
  v_add_u32 v247, 9216, v247
  s_and_b32 s91, s3, 3
  s_lshl_b32 s90, s91, 15
  s_lshl_b32 s91, s91, 13
  s_lshl_b32 s92, s2, 17
  s_add_u32 s90, s90, s92
  s_bfe_u32 s93, s2, 0x20003
  s_lshl_b32 s92, s93, 15
  s_add_u32 s91, s91, s92
  s_lshl_b32 s92, s93, 8
  s_add_u32 s90, s90, s92
  s_mov_b64 s[36:37], s[6:7]
  s_mov_b32 s38, 0x2000000
  s_mov_b32 s39, 0x20000
  s_bfe_u32 s82, s2, 0x30003
  s_lshl_b32 s82, s82, 10
  s_add_u32 s83, s82, 8192
  s_lshl_b32 s92, s3, 7
  s_add_u32 s92, s92, 131072
  v_add_u32 v40, s92, v8
  v_lshrrev_b32 v41, 4, v1
  v_lshlrev_b32 v41, 4, v41
  v_add_u32 v41, s92, v41
  s_lshl_b32 s92, s3, 7
  v_lshrrev_b32 v44, 4, v1
  v_mul_u32_u24 v44, 8576, v44
  v_bfe_u32 v3, v1, 2, 2
  v_mul_u32_u24 v3, 1056, v3
  v_add_u32 v44, v3, v44
  v_and_b32 v3, 3, v1
  v_lshl_add_u32 v44, v3, 3, v44
  v_add_u32 v44, s92, v44
  v_and_b32 v39, 1, v1
  v_lshlrev_b32 v39, 6, v39
  v_bfe_u32 v3, v1, 4, 1
  v_lshl_add_u32 v39, v3, 5, v39
  v_lshrrev_b32 v3, 5, v1
  v_lshl_add_u32 v39, v3, 4, v39
  s_and_b32 s85, s2, 7
  s_lshl_b32 s85, s85, 13
  s_bfe_u32 s97, s2, 0x30003
  s_lshl_b32 s97, s97, 10
  s_add_u32 s85, s85, s97
  s_lshl_b32 s97, s3, 7
  s_add_u32 s85, s85, s97
  s_add_u32 s85, s85, 524288
  s_mov_b32 s74, 0x20002
  s_mov_b32 s75, 0x20002
  s_waitcnt vmcnt(8)
  v_lshlrev_b32 v92, 16, v12
  v_and_b32 v93, 0xffff0000, v12
  v_lshlrev_b32 v94, 16, v13
  v_and_b32 v95, 0xffff0000, v13
  v_lshlrev_b32 v96, 16, v14
  v_and_b32 v97, 0xffff0000, v14
  v_lshlrev_b32 v98, 16, v15
  v_and_b32 v99, 0xffff0000, v15
  v_add_f32 v100, v92, v93
  v_add_f32 v100, v100, v94
  v_add_f32 v100, v100, v95
  v_add_f32 v100, v100, v96
  v_add_f32 v100, v100, v97
  v_add_f32 v100, v100, v98
  v_add_f32 v100, v100, v99
  s_nop 1
  v_add_f32_dpp v100, v100, v100 row_ror:8 row_mask:0xf bank_mask:0xf
  s_nop 1
  v_add_f32_dpp v100, v100, v100 row_ror:4 row_mask:0xf bank_mask:0xf
  s_nop 1
  v_add_f32_dpp v100, v100, v100 row_ror:2 row_mask:0xf bank_mask:0xf
  s_nop 1
  v_add_f32_dpp v100, v100, v100 row_ror:1 row_mask:0xf bank_mask:0xf
  v_mov_b32 v101, v100
  s_nop 1
  v_permlane16_swap_b32 v100, v101
  v_add_f32 v100, v100, v101
  v_mov_b32 v101, v100
  s_nop 1
  v_permlane32_swap_b32 v100, v101
  v_add_f32 v100, v100, v101
  v_mul_f32 v100, 0x3b000000, v100
  v_sub_f32 v92, v92, v100
  v_sub_f32 v93, v93, v100
  v_sub_f32 v94, v94, v100
  v_sub_f32 v95, v95, v100
  v_sub_f32 v96, v96, v100
  v_sub_f32 v97, v97, v100
  v_sub_f32 v98, v98, v100
  v_sub_f32 v99, v99, v100
  v_mul_f32 v102, v92, v92
  v_fmac_f32 v102, v93, v93
  v_fmac_f32 v102, v94, v94
  v_fmac_f32 v102, v95, v95
  v_fmac_f32 v102, v96, v96
  v_fmac_f32 v102, v97, v97
  v_fmac_f32 v102, v98, v98
  v_fmac_f32 v102, v99, v99
  s_nop 1
  v_add_f32_dpp v102, v102, v102 row_ror:8 row_mask:0xf bank_mask:0xf
  s_nop 1
  v_add_f32_dpp v102, v102, v102 row_ror:4 row_mask:0xf bank_mask:0xf
  s_nop 1
  v_add_f32_dpp v102, v102, v102 row_ror:2 row_mask:0xf bank_mask:0xf
  s_nop 1
  v_add_f32_dpp v102, v102, v102 row_ror:1 row_mask:0xf bank_mask:0xf
  v_mov_b32 v101, v102
  s_nop 1
  v_permlane16_swap_b32 v102, v101
  v_add_f32 v102, v102, v101
  v_mov_b32 v101, v102
  s_nop 1
  v_permlane32_swap_b32 v102, v101
  v_add_f32 v102, v102, v101
  v_mov_b32 v253, 0
  global_load_dword v252, v253, s[30:31] sc1
  v_mul_f32 v102, 0x3b000000, v102
  v_cvt_pk_bf16_f32 v101, v100, v100
  v_and_b32 v100, 0xffff0000, v101
  v_cvt_pk_bf16_f32 v101, v102, v102
  v_and_b32 v102, 0xffff0000, v101
  v_add_f32 v102, 0x3727c5ac, v102
  v_cvt_pk_bf16_f32 v101, v102, v102
  v_and_b32 v102, 0xffff0000, v101
  v_sqrt_f32 v102, v102
  s_nop 0
  v_cvt_pk_bf16_f32 v101, v102, v102
  v_and_b32 v102, 0xffff0000, v101
  v_rcp_f32 v102, v102
  v_lshlrev_b32 v103, 16, v16
  v_sub_f32 v103, v103, v100
  v_cvt_pk_bf16_f32 v101, v103, v103
  v_and_b32 v103, 0xffff0000, v101
  v_mul_f32 v103, v103, v102
  v_cvt_pk_bf16_f32 v101, v103, v103
  v_and_b32 v103, 0xffff0000, v101
  s_mov_b32 s100, 0
  s_waitcnt vmcnt(0)
  s_branch L_epc_3
L_ep_2:
  global_load_dword v252, v253, s[30:31] sc1
  s_add_u32 s100, s100, 1
  s_cmp_gt_u32 s100, 1000000
  s_cbranch_scc1 L_abort
  s_waitcnt vmcnt(0)
L_epc_3:
  v_readfirstlane_b32 s48, v252
  s_nop 0
  s_cmp_eq_u32 s48, 0
  s_nop 1
  s_cbranch_scc1 L_ep_2
  s_mul_i32 s48, s48, 0x9e3779b1
  s_and_b32 s49, s48, 0xff
  s_bfe_u32 s50, s48, 0x80008
  s_bfe_u32 s51, s48, 0x80010
  s_lshr_b32 s52, s48, 24
  s_lshr_b32 s97, s48, 15
  s_xor_b32 s97, s97, s48
  s_mul_i32 s97, s97, 0x85ebca6b
  v_mov_b32 v4, s48
  v_mov_b32 v5, s97
  v_mov_b32 v249, s48
  v_mov_b32 v250, s97
  v_and_b32 v6, 4, v1
  v_cmp_eq_u32 vcc, 0, v6
  v_and_b32 v7, 3, v1
  v_lshlrev_b32 v7, 2, v7
  v_cndmask_b32 v4, v5, v4, vcc
  v_lshrrev_b32 v4, v7, v4
  v_lshrrev_b32 v5, 1, v4
  v_lshrrev_b32 v6, 2, v4
  v_lshrrev_b32 v7, 3, v4
  v_bfe_u32 v28, v1, 4, 1
  v_lshlrev_b32 v28, 3, v28
  v_lshrrev_b32 v3, 5, v1
  v_lshl_add_u32 v28, v3, 2, v28
  v_mov_b32 v68, s48
  v_mov_b32 v69, s97
  v_cndmask_b32 v68, v68, v69, s[74:75]
  v_lshrrev_b32 v68, v28, v68
  v_lshrrev_b32 v69, 1, v68
  v_lshrrev_b32 v70, 2, v68
  v_lshrrev_b32 v71, 3, v68
  s_barrier
  buffer_load_dwordx4 v[20:23], v38, s[32:35], s82 offen offset:0 sc1
  buffer_load_dwordx4 v[24:27], v38, s[32:35], s83 offen offset:0 sc1
  ds_read_b64_tr_b16 v[112:113], v44 offset:0
  ds_read_b64_tr_b16 v[114:115], v44 offset:4224
  ds_read_b64_tr_b16 v[116:117], v44 offset:34304
  ds_read_b64_tr_b16 v[118:119], v44 offset:38528
  ds_read_b64_tr_b16 v[120:121], v44 offset:32
  ds_read_b64_tr_b16 v[122:123], v44 offset:4256
  ds_read_b64_tr_b16 v[124:125], v44 offset:34336
  ds_read_b64_tr_b16 v[126:127], v44 offset:38560
  ds_read_b64_tr_b16 v[128:129], v44 offset:64
  ds_read_b64_tr_b16 v[130:131], v44 offset:4288
  ds_read_b64_tr_b16 v[132:133], v44 offset:34368
  ds_read_b64_tr_b16 v[134:135], v44 offset:38592
  s_waitcnt lgkmcnt(4)
  ds_read_b64_tr_b16 v[136:137], v44 offset:96
  ds_read_b64_tr_b16 v[138:139], v44 offset:4320
  ds_read_b64_tr_b16 v[140:141], v44 offset:34400
  ds_read_b64_tr_b16 v[142:143], v44 offset:38624
  s_waitcnt lgkmcnt(0)
  s_barrier
  s_mov_b64 s[60:61], -1
  s_waitcnt vmcnt(0)
  s_mov_b32 s100, 0
  s_branch L_gc_6
L_g_4:
  s_add_u32 s100, s100, 1
  s_cmp_gt_u32 s100, 1000000
  s_cbranch_scc1 L_abort
  s_sleep 2
L_gf_5:
  s_mov_b64 exec, s[60:61]
  buffer_load_dwordx4 v[20:23], v38, s[32:35], s82 offen offset:0 sc1
  buffer_load_dwordx4 v[24:27], v38, s[32:35], s83 offen offset:0 sc1
  s_waitcnt vmcnt(0)
L_gc_6:
  s_mov_b64 exec, s[60:61]
  v_perm_b32 v92, v21, v20, s56
  v_perm_b32 v92, v22, v92, s57
  v_perm_b32 v92, v23, v92, s58
  v_cmp_ne_u32 s[60:61], s48, v92
  v_perm_b32 v92, v25, v24, s56
  v_perm_b32 v92, v26, v92, s57
  v_perm_b32 v92, v27, v92, s58
  v_cmp_ne_u32 vcc, s48, v92
  s_nop 0
  s_or_b64 s[60:61], s[60:61], vcc
  s_cmp_lg_u64 s[60:61], 0
  s_cbranch_scc1 L_g_4
  s_mov_b64 exec, -1
  v_permlane32_swap_b32 v20, v22
  v_permlane32_swap_b32 v21, v23
  v_permlane32_swap_b32 v24, v26
  v_permlane32_swap_b32 v25, v27
  v_add_f32 v20, v20, v22
  v_add_f32 v21, v21, v23
  v_add_f32 v24, v24, v26
  v_add_f32 v25, v25, v27
  v_permlane16_swap_b32 v20, v21
  s_nop 0
  v_permlane16_swap_b32 v24, v25
  v_add_f32 v20, v20, v21
  v_add_f32 v24, v24, v25
  v_cvt_pk_bf16_f32 v25, v24, v24
  v_and_b32 v24, 0xffff0000, v25
  v_cvt_pk_bf16_f32 v21, v20, v20
  v_and_b32 v20, 0xffff0000, v21
  v_add_f32 v24, 1.0, v24
  v_cvt_pk_bf16_f32 v25, v24, v24
  v_and_b32 v24, 0xffff0000, v25
  v_mul_f32 v24, v103, v24
  v_cvt_pk_bf16_f32 v25, v24, v24
  v_and_b32 v24, 0xffff0000, v25
  v_add_f32 v24, v24, v20
  v_cvt_pk_bf16_f32 v24, v24, v24
  ds_write_b16 v40, v24
  ds_read_b128 v[28:31], v41
  ds_read_b128 v[32:35], v41 offset:64
  s_waitcnt lgkmcnt(1)
  v_mfma_f32_16x16x32_bf16 v[80:83], v[112:115], v[28:31], 0
  v_mfma_f32_16x16x32_bf16 v[84:87], v[120:123], v[28:31], 0
  v_mfma_f32_16x16x32_bf16 v[88:91], v[128:131], v[28:31], 0
  v_mfma_f32_16x16x32_bf16 v[92:95], v[136:139], v[28:31], 0
  s_waitcnt lgkmcnt(0)
  v_mfma_f32_16x16x32_bf16 v[80:83], v[116:119], v[32:35], v[80:83]
  v_mfma_f32_16x16x32_bf16 v[84:87], v[124:127], v[32:35], v[84:87]
  v_mfma_f32_16x16x32_bf16 v[88:91], v[132:135], v[32:35], v[88:91]
  v_mfma_f32_16x16x32_bf16 v[92:95], v[140:143], v[32:35], v[92:95]
  s_nop 4
  v_cvt_pk_bf16_f32 v20, v80, v81
  v_cvt_pk_bf16_f32 v21, v82, v83
  v_cvt_pk_bf16_f32 v22, v84, v85
  v_cvt_pk_bf16_f32 v23, v86, v87
  v_cvt_pk_bf16_f32 v24, v88, v89
  v_cvt_pk_bf16_f32 v25, v90, v91
  v_cvt_pk_bf16_f32 v26, v92, v93
  v_cvt_pk_bf16_f32 v27, v94, v95
  v_permlane16_swap_b32 v20, v22
  v_permlane16_swap_b32 v21, v23
  v_permlane16_swap_b32 v24, v26
  v_permlane16_swap_b32 v25, v27
  v_cndmask_b32 v20, v20, v24, s[74:75]
  v_cndmask_b32 v21, v21, v25, s[74:75]
  v_cndmask_b32 v22, v22, v26, s[74:75]
  v_cndmask_b32 v23, v23, v27, s[74:75]
  v_bfi_b32 v20, s53, v68, v20
  v_bfi_b32 v21, s53, v69, v21
  v_bfi_b32 v22, s53, v70, v22
  v_bfi_b32 v23, s53, v71, v23
  s_mov_b32 exec_lo, 0x30003
  s_mov_b32 exec_hi, 0x30003
  buffer_store_dwordx4 v[20:23], v39, s[32:35], s85 offen sc1
  s_mov_b64 exec, -1
  s_barrier
  s_lshr_b32 s92, s3, 2
  s_lshl_b32 s93, s92, 12
  s_xor_b32 s93, s93, 0
  s_xor_b32 m0, s91, s93
  s_lshl_b32 s93, s92, 14
  s_xor_b32 s93, s93, 0
  s_xor_b32 s101, s90, s93
  buffer_load_dwordx4 v244, s[36:39], s101 offen offset:0 nt lds
  buffer_load_dwordx4 v245, s[36:39], s101 offen offset:1024 nt lds
  buffer_load_dwordx4 v246, s[36:39], s101 offen offset:2048 nt lds
  buffer_load_dwordx4 v247, s[36:39], s101 offen offset:3072 nt lds
  s_lshr_b32 s92, s3, 2
  s_lshl_b32 s93, s92, 12
  s_xor_b32 s93, s93, 32768
  s_xor_b32 m0, s91, s93
  s_lshl_b32 s93, s92, 14
  s_xor_b32 s93, s93, 256
  s_xor_b32 s101, s90, s93
  buffer_load_dwordx4 v244, s[36:39], s101 offen offset:0 nt lds
  buffer_load_dwordx4 v245, s[36:39], s101 offen offset:1024 nt lds
  buffer_load_dwordx4 v246, s[36:39], s101 offen offset:2048 nt lds
  buffer_load_dwordx4 v247, s[36:39], s101 offen offset:3072 nt lds
  s_lshr_b32 s92, s3, 2
  s_lshl_b32 s93, s92, 12
  s_xor_b32 s93, s93, 65536
  s_xor_b32 m0, s91, s93
  s_lshl_b32 s93, s92, 14
  s_xor_b32 s93, s93, 512
  s_xor_b32 s101, s90, s93
  buffer_load_dwordx4 v244, s[36:39], s101 offen offset:0 nt lds
  buffer_load_dwordx4 v245, s[36:39], s101 offen offset:1024 nt lds
  buffer_load_dwordx4 v246, s[36:39], s101 offen offset:2048 nt lds
  buffer_load_dwordx4 v247, s[36:39], s101 offen offset:3072 nt lds
  s_lshr_b32 s92, s3, 2
  s_lshl_b32 s93, s92, 12
  s_xor_b32 s93, s93, 98304
  s_xor_b32 m0, s91, s93
  s_lshl_b32 s93, s92, 14
  s_xor_b32 s93, s93, 768
  s_xor_b32 s101, s90, s93
  buffer_load_dwordx4 v244, s[36:39], s101 offen offset:0 nt lds
  buffer_load_dwordx4 v245, s[36:39], s101 offen offset:1024 nt lds
  buffer_load_dwordx4 v246, s[36:39], s101 offen offset:2048 nt lds
  buffer_load_dwordx4 v247, s[36:39], s101 offen offset:3072 nt lds
  s_cmp_ge_u32 s3, 4
  s_cbranch_scc1 L_back
  s_barrier
  s_branch L_setup
L_K2:
  s_mov_b32 s54, 0x05040100
  s_mov_b32 s55, 0x07060302
  s_mov_b32 s56, 0x0c0c0400
  s_mov_b32 s57, 0x0c040100
  s_mov_b32 s58, 0x04020100
  s_mov_b32 s53, 0x10001
  v_mov_b32 v2, 0xffffff00
  s_lshr_b32 s77, s2, 5
  s_and_b32 s78, s2, 127
  s_and_b32 s76, s2, 7
  s_lshl_b32 s76, s76, 2
  s_bfe_u32 s97, s2, 0x20003
  s_add_u32 s76, s76, s97
  s_and_b32 s79, s2, 7
  s_lshl_b32 s79, s79, 1
  s_bfe_u32 s97, s2, 0x10003
  s_add_u32 s79, s79, s97
  s_bfe_u32 s80, s2, 0x30004
  s_bfe_u32 s17, s2, 0x20003
  s_bfe_u32 s59, s2, 0x10004
  s_lshl_b32 s59, s59, 14
  v_lshrrev_b32 v245, 4, v1
  v_and_b32 v246, 15, v1
  v_lshlrev_b32 v247, 2, v245
  v_xor_b32 v246, v246, v247
  v_lshlrev_b32 v246, 4, v246
  v_lshl_add_u32 v244, v245, 10, v246
  v_xor_b32 v245, 16, v244
  v_xor_b32 v246, 32, v244
  v_xor_b32 v247, 48, v244
  v_add_u32 v245, 3072, v245
  v_add_u32 v246, 6144, v246
  v_add_u32 v247, 9216, v247
  s_and_b32 s91, s3, 3
  s_lshl_b32 s90, s91, 15
  s_lshl_b32 s91, s91, 13
  s_lshl_b32 s92, s2, 17
  s_add_u32 s90, s90, s92
  s_bfe_u32 s93, s2, 0x20003
  s_lshl_b32 s92, s93, 15
  s_add_u32 s91, s91, s92
  s_lshl_b32 s92, s93, 8
  s_add_u32 s90, s90, s92
  s_mov_b64 s[36:37], s[6:7]
  s_mov_b32 s38, 0x2000000
  s_mov_b32 s39, 0x20000
  s_barrier
  s_lshr_b32 s92, s3, 2
  s_lshl_b32 s93, s92, 12
  s_xor_b32 s93, s93, 0
  s_xor_b32 m0, s91, s93
  s_lshl_b32 s93, s92, 14
  s_xor_b32 s93, s93, 0
  s_xor_b32 s101, s90, s93
  buffer_load_dwordx4 v244, s[36:39], s101 offen offset:0 nt lds
  buffer_load_dwordx4 v245, s[36:39], s101 offen offset:1024 nt lds
  buffer_load_dwordx4 v246, s[36:39], s101 offen offset:2048 nt lds
  buffer_load_dwordx4 v247, s[36:39], s101 offen offset:3072 nt lds
  s_lshr_b32 s92, s3, 2
  s_lshl_b32 s93, s92, 12
  s_xor_b32 s93, s93, 32768
  s_xor_b32 m0, s91, s93
  s_lshl_b32 s93, s92, 14
  s_xor_b32 s93, s93, 256
  s_xor_b32 s101, s90, s93
  buffer_load_dwordx4 v244, s[36:39], s101 offen offset:0 nt lds
  buffer_load_dwordx4 v245, s[36:39], s101 offen offset:1024 nt lds
  buffer_load_dwordx4 v246, s[36:39], s101 offen offset:2048 nt lds
  buffer_load_dwordx4 v247, s[36:39], s101 offen offset:3072 nt lds
  s_and_b32 s92, s3, 1
  s_lshl_b32 s92, s92, 15
  s_lshr_b32 s97, s3, 1
  s_lshl_b32 s97, s97, 8
  s_add_u32 s92, s92, s97
  s_add_u32 s92, s92, s81
  v_and_b32 v45, 15, v1
  v_mul_u32_u24 v45, 1040, v45
  v_add_u32 v45, s92, v45
  v_lshrrev_b32 v34, 4, v1
  v_lshlrev_b32 v34, 4, v34
  v_xor_b32 v45, v45, v34
  v_lshrrev_b32 v37, 3, v1
  v_lshlrev_b32 v37, 10, v37
  v_and_b32 v3, 7, v1
  v_lshl_add_u32 v37, v3, 4, v37
  s_and_b32 s83, s2, 7
  s_lshl_b32 s83, s83, 13
  s_lshl_b32 s97, s3, 7
  s_add_u32 s83, s83, s97
  s_add_u32 s83, s83, 524288
  s_lshl_b32 s92, s3, 7
  s_add_u32 s92, s92, 135168
  v_and_b32 v47, 7, v1
  v_lshlrev_b32 v47, 4, v47
  v_lshrrev_b32 v3, 4, v1
  v_lshl_add_u32 v47, v3, 2, v47
  v_add_u32 v47, s92, v47
  s_lshr_b32 s92, s3, 1
  s_lshl_b32 s92, s92, 8
  s_add_u32 s92, s92, 135168
  v_lshrrev_b32 v35, 4, v1
  v_lshlrev_b32 v35, 4, v35
  v_add_u32 v35, s92, v35
  v_mov_b32 v50, 0x3f80
  v_mov_b32 v51, 0x3f800000
  v_bfe_u32 v39, v1, 4, 1
  v_lshlrev_b32 v39, 5, v39
  v_lshrrev_b32 v3, 5, v1
  v_lshl_add_u32 v39, v3, 4, v39
  s_and_b32 s84, s2, 7
  s_lshl_b32 s84, s84, 12
  s_lshr_b32 s97, s3, 1
  s_lshl_b32 s97, s97, 10
  s_add_u32 s84, s84, s97
  s_bfe_u32 s97, s2, 0x30003
  s_lshl_b32 s97, s97, 7
  s_add_u32 s84, s84, s97
  s_and_b32 s97, s3, 1
  s_lshl_b32 s97, s97, 6
  s_add_u32 s84, s84, s97
  s_add_u32 s84, s84, 65536
  v_mov_b32 v72, 0
  v_mov_b32 v73, 0
  v_mov_b32 v74, 0
  v_mov_b32 v75, 0
  v_mov_b32 v76, 0
  v_mov_b32 v77, 0
  v_mov_b32 v78, 0
  v_mov_b32 v79, 0
  s_waitcnt vmcnt(8)
  s_barrier
  v_xor_b32 v32, 0, v45
  ds_read_b128 v[112:115], v32 offset:0
  v_xor_b32 v33, 64, v45
  ds_read_b128 v[116:119], v33 offset:0
  v_xor_b32 v32, 128, v45
  ds_read_b128 v[120:123], v32 offset:0
  v_xor_b32 v33, 192, v45
  ds_read_b128 v[124:127], v33 offset:0
  v_xor_b32 v32, 0, v45
  ds_read_b128 v[128:131], v32 offset:16384
  v_xor_b32 v33, 64, v45
  ds_read_b128 v[132:135], v33 offset:16384
  v_xor_b32 v32, 128, v45
  ds_read_b128 v[136:139], v32 offset:16384
  v_xor_b32 v33, 192, v45
  ds_read_b128 v[140:143], v33 offset:16384
  s_waitcnt lgkmcnt(0)
  s_barrier
  s_mov_b32 s100, 0
  v_mov_b32 v253, 0
L_ep_8:
  global_load_dword v252, v253, s[30:31] sc1
  s_add_u32 s100, s100, 1
  s_cmp_gt_u32 s100, 1000000
  s_cbranch_scc1 L_abort
  s_waitcnt vmcnt(0)
L_epc_9:
  v_readfirstlane_b32 s48, v252
  s_nop 0
  s_cmp_eq_u32 s48, 0
  s_nop 1
  s_cbranch_scc1 L_ep_8
  s_mul_i32 s48, s48, 0x9e3779b1
  s_and_b32 s49, s48, 0xff
  s_bfe_u32 s50, s48, 0x80008
  s_bfe_u32 s51, s48, 0x80010
  s_lshr_b32 s52, s48, 24
  s_lshr_b32 s97, s48, 15
  s_xor_b32 s97, s97, s48
  s_mul_i32 s97, s97, 0x85ebca6b
  v_mov_b32 v4, s48
  v_mov_b32 v5, s97
  v_mov_b32 v249, s48
  v_mov_b32 v250, s97
  v_and_b32 v6, 4, v1
  v_cmp_eq_u32 vcc, 0, v6
  v_and_b32 v7, 3, v1
  v_lshlrev_b32 v7, 2, v7
  v_cndmask_b32 v4, v5, v4, vcc
  v_lshrrev_b32 v4, v7, v4
  v_lshrrev_b32 v5, 1, v4
  v_lshrrev_b32 v6, 2, v4
  v_lshrrev_b32 v7, 3, v4
  s_and_b32 s92, s3, 1
  s_sub_u32 s74, 0, s92
  s_mov_b32 s75, s74
  v_bfe_u32 v28, v1, 4, 1
  v_lshlrev_b32 v28, 3, v28
  v_lshrrev_b32 v3, 5, v1
  v_lshl_add_u32 v28, v3, 2, v28
  v_mov_b32 v68, s48
  v_mov_b32 v69, s97
  v_cndmask_b32 v68, v68, v69, s[74:75]
  v_lshrrev_b32 v68, v28, v68
  v_lshrrev_b32 v69, 1, v68
  v_lshrrev_b32 v70, 2, v68
  v_lshrrev_b32 v71, 3, v68
  s_mov_b64 s[60:61], -1
  s_mov_b32 s100, 0
  s_branch L_gf_11
L_g_10:
  s_add_u32 s100, s100, 1
  s_cmp_gt_u32 s100, 1000000
  s_cbranch_scc1 L_abort
  s_sleep 2
L_gf_11:
  s_mov_b64 exec, s[60:61]
  buffer_load_dwordx4 v[20:23], v37, s[32:35], s83 offen offset:0 sc1
  s_waitcnt vmcnt(0)
L_gc_12:
  s_mov_b64 exec, s[60:61]
  v_xor_b32 v92, v20, v4
  v_bitop3_b32 v92, v21, v5, v92 bitop3:0xbe
  v_bitop3_b32 v92, v22, v6, v92 bitop3:0xbe
  v_bitop3_b32 v92, v23, v7, v92 bitop3:0xbe
  v_and_b32 v92, s53, v92
  v_cmp_ne_u32 s[60:61], 0, v92
  s_nop 0
  s_cmp_lg_u64 s[60:61], 0
  s_cselect_b64 s[60:61], -1, 0
  s_cmp_lg_u64 s[60:61], 0
  s_cbranch_scc1 L_g_10
  s_mov_b64 exec, -1
  v_dot2c_f32_bf16 v72, v50, v20
  v_dot2c_f32_bf16 v73, v51, v20
  v_dot2c_f32_bf16 v74, v50, v21
  v_dot2c_f32_bf16 v75, v51, v21
  v_dot2c_f32_bf16 v76, v50, v22
  v_dot2c_f32_bf16 v77, v51, v22
  v_dot2c_f32_bf16 v78, v50, v23
  v_dot2c_f32_bf16 v79, v51, v23
  v_permlane32_swap_b32 v72, v76
  v_permlane32_swap_b32 v73, v77
  v_permlane32_swap_b32 v74, v78
  v_permlane32_swap_b32 v75, v79
  v_add_f32 v72, v72, v76
  v_add_f32 v73, v73, v77
  v_add_f32 v74, v74, v78
  v_add_f32 v75, v75, v79
  s_nop 0
  v_permlane16_swap_b32 v72, v74
  v_permlane16_swap_b32 v73, v75
  v_add_f32 v72, v72, v74
  v_add_f32 v73, v73, v75
  s_nop 0
  v_add_f32_dpp v72, v72, v72 row_ror:8 row_mask:0xf bank_mask:0xf
  v_add_f32_dpp v73, v73, v73 row_ror:8 row_mask:0xf bank_mask:0xf
  v_cvt_pk_bf16_f32 v72, v72, v73
  ds_write_b32 v47, v72
  s_waitcnt lgkmcnt(0)
  s_barrier
  ds_read_b128 v[52:55], v35 offset:0
  ds_read_b128 v[56:59], v35 offset:64
  ds_read_b128 v[60:63], v35 offset:128
  ds_read_b128 v[64:67], v35 offset:192
  s_waitcnt lgkmcnt(3)
  v_mfma_f32_16x16x32_bf16 v[80:83], v[112:115], v[52:55], 0
  v_mfma_f32_16x16x32_bf16 v[84:87], v[128:131], v[52:55], 0
  s_waitcnt lgkmcnt(2)
  v_mfma_f32_16x16x32_bf16 v[80:83], v[116:119], v[56:59], v[80:83]
  v_mfma_f32_16x16x32_bf16 v[84:87], v[132:135], v[56:59], v[84:87]
  s_waitcnt lgkmcnt(1)
  v_mfma_f32_16x16x32_bf16 v[80:83], v[120:123], v[60:63], v[80:83]
  v_mfma_f32_16x16x32_bf16 v[84:87], v[136:139], v[60:63], v[84:87]
  s_waitcnt lgkmcnt(0)
  v_mfma_f32_16x16x32_bf16 v[80:83], v[124:127], v[64:67], v[80:83]
  v_mfma_f32_16x16x32_bf16 v[84:87], v[140:143], v[64:67], v[84:87]
  s_nop 6
  v_mul_f32 v80, 0x3e0293ee, v80
  v_mul_f32 v81, 0x3e0293ee, v81
  v_mul_f32 v82, 0x3e0293ee, v82
  v_mul_f32 v83, 0x3e0293ee, v83
  v_mul_f32 v84, 0x3e0293ee, v84
  v_mul_f32 v85, 0x3e0293ee, v85
  v_mul_f32 v86, 0x3e0293ee, v86
  v_mul_f32 v87, 0x3e0293ee, v87
  v_cvt_pk_bf16_f32 v20, v80, v81
  v_cvt_pk_bf16_f32 v21, v82, v83
  v_cvt_pk_bf16_f32 v22, v84, v85
  v_cvt_pk_bf16_f32 v23, v86, v87
  s_nop 0
  v_permlane16_swap_b32 v20, v22
  v_permlane16_swap_b32 v21, v23
  v_bfi_b32 v20, s53, v68, v20
  v_bfi_b32 v21, s53, v69, v21
  v_bfi_b32 v22, s53, v70, v22
  v_bfi_b32 v23, s53, v71, v23
  s_mov_b32 exec_lo, 0x10001
  s_mov_b32 exec_hi, 0x10001
  buffer_store_dwordx4 v[20:23], v39, s[32:35], s84 offen sc1
  s_mov_b64 exec, -1
  s_barrier
  s_lshr_b32 s92, s3, 2
  s_lshl_b32 s93, s92, 12
  s_xor_b32 s93, s93, 65536
  s_xor_b32 m0, s91, s93
  s_lshl_b32 s93, s92, 14
  s_xor_b32 s93, s93, 512
  s_xor_b32 s101, s90, s93
  buffer_load_dwordx4 v244, s[36:39], s101 offen offset:0 nt lds
  buffer_load_dwordx4 v245, s[36:39], s101 offen offset:1024 nt lds
  buffer_load_dwordx4 v246, s[36:39], s101 offen offset:2048 nt lds
  buffer_load_dwordx4 v247, s[36:39], s101 offen offset:3072 nt lds
  s_lshr_b32 s92, s3, 2
  s_lshl_b32 s93, s92, 12
  s_xor_b32 s93, s93, 98304
  s_xor_b32 m0, s91, s93
  s_lshl_b32 s93, s92, 14
  s_xor_b32 s93, s93, 768
  s_xor_b32 s101, s90, s93
  buffer_load_dwordx4 v244, s[36:39], s101 offen offset:0 nt lds
  buffer_load_dwordx4 v245, s[36:39], s101 offen offset:1024 nt lds
  buffer_load_dwordx4 v246, s[36:39], s101 offen offset:2048 nt lds
  buffer_load_dwordx4 v247, s[36:39], s101 offen offset:3072 nt lds
  s_cmp_ge_u32 s3, 4
  s_cbranch_scc0 L_kf
  s_branch L_back
L_kf:
  s_barrier
  s_branch L_setup
L_Bback2:
  s_mov_b32 s54, 0x05040100
  s_mov_b32 s55, 0x07060302
  s_mov_b32 s56, 0x0c0c0400
  s_mov_b32 s57, 0x0c040100
  s_mov_b32 s58, 0x04020100
  s_mov_b32 s53, 0x10001
  v_mov_b32 v2, 0xffffff00
  s_lshr_b32 s77, s2, 5
  s_and_b32 s78, s2, 127
  s_and_b32 s76, s2, 7
  s_lshl_b32 s76, s76, 2
  s_bfe_u32 s97, s2, 0x20003
  s_add_u32 s76, s76, s97
  s_and_b32 s79, s2, 7
  s_lshl_b32 s79, s79, 1
  s_bfe_u32 s97, s2, 0x10003
  s_add_u32 s79, s79, s97
  s_bfe_u32 s80, s2, 0x30004
  s_bfe_u32 s17, s2, 0x20003
  s_bfe_u32 s59, s2, 0x10004
  s_lshl_b32 s59, s59, 14
  s_lshl_b32 s81, s95, 2
  s_add_u32 s81, s81, s94
  s_lshl_b32 s81, s81, 8
  s_add_u32 s81, s81, 0
  v_and_b32 v8, 7, v1
  v_lshlrev_b32 v8, 2, v8
  v_lshrrev_b32 v9, 4, v1
  v_add_u32 v8, v8, v9
  v_lshlrev_b32 v8, 5, v8
  s_lshl_b32 s92, s3, 2
  s_add_u32 s92, s92, 139248
  v_add_u32 v8, s92, v8
  v_lshlrev_b32 v9, 6, v1
  v_add_u32 v9, 139264, v9
  v_lshlrev_b32 v10, 4, v1
  s_bitcmp1_b32 s2, 6
  s_cbranch_scc1 L_nou0b
  s_waitcnt vmcnt(4)
  v_mov_b32 v253, 0
  global_load_dword v252, v253, s[30:31] sc1
  v_lshlrev_b32 v120, 16, v112
  v_and_b32 v121, 0xffff0000, v112
  v_lshlrev_b32 v122, 16, v113
  v_and_b32 v123, 0xffff0000, v113
  v_mul_f32 v116, 0xbfb8aa3b, v120
  v_mul_f32 v117, 0xbfb8aa3b, v121
  v_mul_f32 v118, 0xbfb8aa3b, v122
  v_mul_f32 v119, 0xbfb8aa3b, v123
  v_exp_f32 v116, v116
  v_exp_f32 v117, v117
  v_exp_f32 v118, v118
  v_exp_f32 v119, v119
  v_add_f32 v116, 1.0, v116
  v_add_f32 v117, 1.0, v117
  v_add_f32 v118, 1.0, v118
  v_add_f32 v119, 1.0, v119
  v_rcp_f32 v116, v116
  v_rcp_f32 v117, v117
  v_rcp_f32 v118, v118
  v_rcp_f32 v119, v119
  v_mul_f32 v120, v120, v116
  v_mul_f32 v121, v121, v117
  v_mul_f32 v122, v122, v118
  v_mul_f32 v123, v123, v119
  v_cvt_pk_bf16_f32 v120, v120, v120
  v_cvt_pk_bf16_f32 v121, v121, v121
  v_cvt_pk_bf16_f32 v122, v122, v122
  v_cvt_pk_bf16_f32 v123, v123, v123
  v_lshrrev_b32 v116, 16, v120
  v_lshrrev_b32 v117, 16, v121
  v_lshrrev_b32 v118, 16, v122
  v_lshrrev_b32 v119, 16, v123
  v_and_b32 v120, 0xffff0000, v120
  v_and_b32 v121, 0xffff0000, v121
  v_and_b32 v122, 0xffff0000, v122
  v_and_b32 v123, 0xffff0000, v123
  v_mov_b32 v96, 0
  v_mov_b32 v97, 0
  v_mov_b32 v98, 0
  v_mov_b32 v99, 0
  v_mov_b32 v100, 0
  v_mov_b32 v101, 0
  v_mov_b32 v102, 0
  v_mov_b32 v103, 0
  s_waitcnt vmcnt(4)
  v_dot2c_f32_bf16 v96, v116, v124
  v_dot2c_f32_bf16 v97, v120, v124
  v_dot2c_f32_bf16 v98, v116, v125
  v_dot2c_f32_bf16 v99, v120, v125
  v_dot2c_f32_bf16 v100, v116, v126
  v_dot2c_f32_bf16 v101, v120, v126
  v_dot2c_f32_bf16 v102, v116, v127
  v_dot2c_f32_bf16 v103, v120, v127
  s_waitcnt vmcnt(3)
  v_dot2c_f32_bf16 v96, v117, v128
  v_dot2c_f32_bf16 v97, v121, v128
  v_dot2c_f32_bf16 v98, v117, v129
  v_dot2c_f32_bf16 v99, v121, v129
  v_dot2c_f32_bf16 v100, v117, v130
  v_dot2c_f32_bf16 v101, v121, v130
  v_dot2c_f32_bf16 v102, v117, v131
  v_dot2c_f32_bf16 v103, v121, v131
  s_waitcnt vmcnt(2)
  v_dot2c_f32_bf16 v96, v118, v132
  v_dot2c_f32_bf16 v97, v122, v132
  v_dot2c_f32_bf16 v98, v118, v133
  v_dot2c_f32_bf16 v99, v122, v133
  v_dot2c_f32_bf16 v100, v118, v134
  v_dot2c_f32_bf16 v101, v122, v134
  v_dot2c_f32_bf16 v102, v118, v135
  v_dot2c_f32_bf16 v103, v122, v135
  s_waitcnt vmcnt(1)
  v_dot2c_f32_bf16 v96, v119, v136
  v_dot2c_f32_bf16 v97, v123, v136
  v_dot2c_f32_bf16 v98, v119, v137
  v_dot2c_f32_bf16 v99, v123, v137
  v_dot2c_f32_bf16 v100, v119, v138
  v_dot2c_f32_bf16 v101, v123, v138
  v_dot2c_f32_bf16 v102, v119, v139
  v_dot2c_f32_bf16 v103, v123, v139
  v_permlane32_swap_b32 v96, v100
  v_permlane32_swap_b32 v97, v101
  v_permlane32_swap_b32 v98, v102
  v_permlane32_swap_b32 v99, v103
  v_add_f32 v96, v96, v100
  v_add_f32 v97, v97, v101
  v_add_f32 v98, v98, v102
  v_add_f32 v99, v99, v103
  s_nop 0
  v_permlane16_swap_b32 v96, v98
  v_permlane16_swap_b32 v97, v99
  v_add_f32 v96, v96, v98
  v_add_f32 v97, v97, v99
  s_nop 0
  v_add_f32_dpp v96, v96, v96 row_ror:8 row_mask:0xf bank_mask:0xf
  v_add_f32_dpp v97, v97, v97 row_ror:8 row_mask:0xf bank_mask:0xf
  s_mov_b32 s100, 0
  s_waitcnt vmcnt(0)
  s_branch L_epc_15
L_ep_14:
  global_load_dword v252, v253, s[30:31] sc1
  s_add_u32 s100, s100, 1
  s_cmp_gt_u32 s100, 1000000
  s_cbranch_scc1 L_abort
  s_waitcnt vmcnt(0)
L_epc_15:
  v_readfirstlane_b32 s48, v252
  s_nop 0
  s_cmp_eq_u32 s48, 0
  s_nop 1
  s_cbranch_scc1 L_ep_14
  s_mul_i32 s48, s48, 0x9e3779b1
  s_and_b32 s49, s48, 0xff
  s_bfe_u32 s50, s48, 0x80008
  s_bfe_u32 s51, s48, 0x80010
  s_lshr_b32 s52, s48, 24
  ds_write2_b32 v8, v96, v97 offset0:0 offset1:4
  s_waitcnt lgkmcnt(0)
  s_barrier
  s_cmp_lg_u32 s3, 4
  s_cbranch_scc1 L_nopub_16
  s_mov_b64 exec, 0xffff
  ds_read_b128 v[124:127], v9 offset:0
  ds_read_b128 v[128:131], v9 offset:16
  ds_read_b128 v[132:135], v9 offset:32
  ds_read_b128 v[136:139], v9 offset:48
  s_waitcnt lgkmcnt(3)
  v_add_f32 v124, v124, v125
  v_add_f32 v126, v126, v127
  v_add_f32 v124, v124, v126
  s_waitcnt lgkmcnt(2)
  v_add_f32 v128, v128, v129
  v_add_f32 v130, v130, v131
  v_add_f32 v128, v128, v130
  s_waitcnt lgkmcnt(1)
  v_add_f32 v132, v132, v133
  v_add_f32 v134, v134, v135
  v_add_f32 v132, v132, v134
  s_waitcnt lgkmcnt(0)
  v_add_f32 v136, v136, v137
  v_add_f32 v138, v138, v139
  v_add_f32 v136, v136, v138
  v_and_or_b32 v100, v124, v2, s49
  v_and_or_b32 v101, v128, v2, s50
  v_and_or_b32 v102, v132, v2, s51
  v_and_or_b32 v103, v136, v2, s52
  buffer_store_dwordx4 v[100:103], v10, s[32:35], s81 offen sc1
L_nopub_16:
  s_mov_b64 exec, -1
  s_barrier
  s_branch L_nou0c
L_nou0b:
  s_barrier
  s_barrier
  s_mov_b32 s100, 0
  v_mov_b32 v253, 0
L_ep_17:
  global_load_dword v252, v253, s[30:31] sc1
  s_add_u32 s100, s100, 1
  s_cmp_gt_u32 s100, 1000000
  s_cbranch_scc1 L_abort
  s_waitcnt vmcnt(0)
L_epc_18:
  v_readfirstlane_b32 s48, v252
  s_nop 0
  s_cmp_eq_u32 s48, 0
  s_nop 1
  s_cbranch_scc1 L_ep_17
  s_mul_i32 s48, s48, 0x9e3779b1
  s_and_b32 s49, s48, 0xff
  s_bfe_u32 s50, s48, 0x80008
  s_bfe_u32 s51, s48, 0x80010
  s_lshr_b32 s52, s48, 24
L_nou0c:
  s_lshr_b32 s97, s48, 15
  s_xor_b32 s97, s97, s48
  s_mul_i32 s97, s97, 0x85ebca6b
  v_mov_b32 v4, s48
  v_mov_b32 v5, s97
  v_mov_b32 v249, s48
  v_mov_b32 v250, s97
  v_and_b32 v6, 4, v1
  v_cmp_eq_u32 vcc, 0, v6
  v_and_b32 v7, 3, v1
  v_lshlrev_b32 v7, 2, v7
  v_cndmask_b32 v4, v5, v4, vcc
  v_lshrrev_b32 v4, v7, v4
  v_lshrrev_b32 v5, 1, v4
  v_lshrrev_b32 v6, 2, v4
  v_lshrrev_b32 v7, 3, v4
  v_lshrrev_b32 v245, 4, v1
  v_and_b32 v246, 15, v1
  v_lshlrev_b32 v247, 2, v245
  v_xor_b32 v246, v246, v247
  v_lshlrev_b32 v246, 4, v246
  v_lshl_add_u32 v244, v245, 10, v246
  v_xor_b32 v245, 16, v244
  v_xor_b32 v246, 32, v244
  v_xor_b32 v247, 48, v244
  v_add_u32 v245, 3072, v245
  v_add_u32 v246, 6144, v246
  v_add_u32 v247, 9216, v247
  s_and_b32 s91, s3, 3
  s_lshl_b32 s90, s91, 15
  s_lshl_b32 s91, s91, 13
  s_lshl_b32 s92, s2, 17
  s_add_u32 s90, s90, s92
  s_bfe_u32 s93, s2, 0x20003
  s_lshl_b32 s92, s93, 15
  s_add_u32 s91, s91, s92
  s_lshl_b32 s92, s93, 8
  s_add_u32 s90, s90, s92
  s_mov_b64 s[36:37], s[6:7]
  s_mov_b32 s38, 0x2000000
  s_mov_b32 s39, 0x20000
  v_lshlrev_b32 v12, 21, v1
  v_add_u32 v12, 0xf000, v12
  s_mov_b64 exec, 0x3f
  buffer_load_dword v254, v12, s[32:35], 0 offen
  s_mov_b64 exec, -1
  s_cmp_lg_u32 s3, 5
  s_cbranch_scc1 L_nwt
  v_lshlrev_b32 v12, 7, v1
  s_mov_b32 exec_hi, 0
  s_and_b32 s93, s2, 7
  s_lshl_b32 s93, s93, 1
  s_bfe_u32 s97, s2, 0x10003
  s_add_u32 s93, s93, s97
  s_sub_u32 s94, s78, 56
  s_cmp_ge_u32 s78, 56
  s_cselect_b32 s94, s94, s78
  s_lshl_b32 s92, s76, 12
  s_add_u32 s92, s92, 262144
  buffer_load_dword v254, v12, s[32:35], s92 offen sc1
  s_mul_i32 s92, s93, 4224
  s_add_u32 s92, s92, 393216
  buffer_load_dword v254, v12, s[32:35], s92 offen sc1
  s_lshl_b32 s92, s94, 12
  s_add_u32 s92, s92, 851968
  buffer_load_dword v254, v12, s[32:35], s92 offen sc1
  s_mov_b32 exec_lo, 0xffff
  s_mul_i32 s94, s94, 37
  s_lshr_b32 s94, s94, 8
  s_lshl_b32 s92, s94, 11
  s_add_u32 s92, s92, 98304
  buffer_load_dword v254, v12, s[32:35], s92 offen sc1
  v_lshlrev_b32 v14, 9, v1
  s_bfe_u32 s92, s2, 0x40003
  s_lshl_b32 s92, s92, 13
  s_lshr_b32 s97, s76, 3
  s_lshl_b32 s97, s97, 7
  s_add_u32 s92, s92, s97
  s_add_u32 s92, s92, 131072
  buffer_load_dword v254, v14, s[32:35], s92 offen sc1
  s_mov_b64 exec, -1
  s_mul_i32 s92, s93, 8448
  s_add_u32 s92, s92, 655360
  buffer_load_dword v254, v12, s[32:35], s92 offen sc1
  s_and_b32 s92, s2, 7
  s_lshl_b32 s92, s92, 13
  s_add_u32 s92, s92, 524288
  buffer_load_dword v254, v12, s[32:35], s92 offen sc1
L_nwt:
  s_and_b32 s81, s3, 3
  s_lshl_b32 s81, s81, 13
  s_add_u32 s81, s81, 65536
  v_lshlrev_b32 v8, 4, v1
  s_add_u32 s82, s81, 4096
  v_lshrrev_b32 v9, 4, v1
  v_lshlrev_b32 v9, 13, v9
  v_and_b32 v3, 15, v1
  v_lshl_add_u32 v9, v3, 4, v9
  s_and_b32 s93, s3, 3
  s_lshl_b32 s93, s93, 11
  s_and_b32 s97, s3, 1
  s_lshl_b32 s97, s97, 5
  s_add_u32 s93, s93, s97
  s_add_u32 s93, s93, 131072
  v_xor_b32 v9, s93, v9
  s_lshr_b32 s92, s2, 3
  s_cmp_lg_u32 s92, 25
  s_cbranch_scc1 L_nwq
  buffer_load_dwordx4 v[48:51], v8, s[32:35], s81 offen offset:0 sc1
  buffer_load_dwordx4 v[52:55], v8, s[32:35], s81 offen offset:1024 sc1
  buffer_load_dwordx4 v[56:59], v8, s[32:35], s81 offen offset:2048 sc1
  buffer_load_dwordx4 v[60:63], v8, s[32:35], s81 offen offset:3072 sc1
  buffer_load_dwordx4 v[64:67], v8, s[32:35], s82 offen offset:0 sc1
  buffer_load_dwordx4 v[68:71], v8, s[32:35], s82 offen offset:1024 sc1
  buffer_load_dwordx4 v[72:75], v8, s[32:35], s82 offen offset:2048 sc1
  buffer_load_dwordx4 v[76:79], v8, s[32:35], s82 offen offset:3072 sc1
L_nwq:
  s_xor_b32 m0, s91, 4096
  s_xor_b32 s101, s90, 16384
  buffer_load_dwordx4 v244, s[36:39], s101 offen offset:0 nt lds
  s_waitcnt vmcnt(2)
  buffer_load_dwordx4 v245, s[36:39], s101 offen offset:1024 nt lds
  s_waitcnt vmcnt(2)
  buffer_load_dwordx4 v246, s[36:39], s101 offen offset:2048 nt lds
  s_waitcnt vmcnt(2)
  buffer_load_dwordx4 v247, s[36:39], s101 offen offset:3072 nt lds
  s_waitcnt vmcnt(2)
  s_xor_b32 m0, s91, 36864
  s_xor_b32 s101, s90, 16640
  buffer_load_dwordx4 v244, s[36:39], s101 offen offset:0 nt lds
  s_waitcnt vmcnt(2)
  buffer_load_dwordx4 v245, s[36:39], s101 offen offset:1024 nt lds
  s_waitcnt vmcnt(2)
  buffer_load_dwordx4 v246, s[36:39], s101 offen offset:2048 nt lds
  s_waitcnt vmcnt(2)
  buffer_load_dwordx4 v247, s[36:39], s101 offen offset:3072 nt lds
  s_waitcnt vmcnt(2)
  s_xor_b32 m0, s91, 69632
  s_xor_b32 s101, s90, 16896
  buffer_load_dwordx4 v244, s[36:39], s101 offen offset:0 nt lds
  buffer_load_dwordx4 v245, s[36:39], s101 offen offset:1024 nt lds
  buffer_load_dwordx4 v246, s[36:39], s101 offen offset:2048 nt lds
  buffer_load_dwordx4 v247, s[36:39], s101 offen offset:3072 nt lds
  s_xor_b32 m0, s91, 102400
  s_xor_b32 s101, s90, 17152
  buffer_load_dwordx4 v244, s[36:39], s101 offen offset:0 nt lds
  buffer_load_dwordx4 v245, s[36:39], s101 offen offset:1024 nt lds
  buffer_load_dwordx4 v246, s[36:39], s101 offen offset:2048 nt lds
  buffer_load_dwordx4 v247, s[36:39], s101 offen offset:3072 nt lds
  s_mov_b64 s[40:41], s[26:27]
  s_mov_b32 s42, 0x300000
  s_mov_b32 s43, 0x20000
  v_lshrrev_b32 v13, 3, v1
  v_mul_u32_u24 v13, 24576, v13
  v_and_b32 v3, 7, v1
  v_lshl_add_u32 v13, v3, 4, v13
  s_lshr_b32 s94, s78, 5
  s_lshl_b32 s94, s94, 2
  s_and_b32 s97, s3, 3
  s_add_u32 s94, s94, s97
  s_lshl_b32 s95, s94, 6
  v_lshrrev_b32 v14, 3, v1
  v_lshlrev_b32 v14, 3, v14
  v_add_u32 v14, s95, v14
  s_mul_i32 s92, s94, 196608
  s_and_b32 s97, s2, 31
  s_lshl_b32 s97, s97, 7
  s_add_u32 s92, s92, s97
  s_add_u32 s92, s92, 2048
  global_load_dwordx2 v[144:145], v14, s[24:25]
  buffer_load_dwordx4 v[128:131], v13, s[40:43], s92 offen nt
  s_add_u32 s92, s92, 6144
  buffer_load_dwordx4 v[132:135], v13, s[40:43], s92 offen nt
  s_add_u32 s92, s92, 6144
  buffer_load_dwordx4 v[136:139], v13, s[40:43], s92 offen nt
  s_add_u32 s92, s92, 6144
  buffer_load_dwordx4 v[140:143], v13, s[40:43], s92 offen nt
  v_lshrrev_b32 v253, 4, v1
  v_lshlrev_b32 v253, 13, v253
  v_and_b32 v3, 15, v1
  v_lshl_add_u32 v253, v3, 4, v253
  s_lshl_b32 s88, s77, 19
  s_bfe_u32 s97, s3, 0x10001
  s_lshl_b32 s97, s97, 18
  s_add_u32 s88, s88, s97
  s_and_b32 s97, s3, 1
  s_lshl_b32 s97, s97, 15
  s_add_u32 s88, s88, s97
  s_lshl_b32 s97, s76, 8
  s_add_u32 s88, s88, s97
  v_lshrrev_b32 v251, 5, v1
  v_mul_u32_u24 v251, 3584, v251
  v_and_b32 v3, 31, v1
  v_lshl_add_u32 v251, v3, 4, v251
  s_mul_i32 s89, s79, 114688
  s_and_b32 s97, s3, 3
  s_mul_i32 s97, s97, 28672
  s_add_u32 s89, s89, s97
  s_mul_i32 s97, s80, 448
  s_add_u32 s89, s89, s97
  s_barrier
  s_branch L_back1
L_back:
  v_lshlrev_b32 v12, 21, v1
  v_add_u32 v12, 0xf000, v12
  s_mov_b64 exec, 0x3f
  buffer_load_dword v254, v12, s[32:35], 0 offen
  s_mov_b64 exec, -1
  s_and_b32 s81, s3, 3
  s_lshl_b32 s81, s81, 13
  s_add_u32 s81, s81, 65536
  v_lshlrev_b32 v8, 4, v1
  s_add_u32 s82, s81, 4096
  v_lshrrev_b32 v9, 4, v1
  v_lshlrev_b32 v9, 13, v9
  v_and_b32 v3, 15, v1
  v_lshl_add_u32 v9, v3, 4, v9
  s_and_b32 s93, s3, 3
  s_lshl_b32 s93, s93, 11
  s_and_b32 s97, s3, 1
  s_lshl_b32 s97, s97, 5
  s_add_u32 s93, s93, s97
  s_add_u32 s93, s93, 131072
  v_xor_b32 v9, s93, v9
  v_lshrrev_b32 v253, 4, v1
  v_lshlrev_b32 v253, 13, v253
  v_and_b32 v3, 15, v1
  v_lshl_add_u32 v253, v3, 4, v253
  s_lshl_b32 s88, s77, 19
  s_bfe_u32 s97, s3, 0x10001
  s_lshl_b32 s97, s97, 18
  s_add_u32 s88, s88, s97
  s_and_b32 s97, s3, 1
  s_lshl_b32 s97, s97, 15
  s_add_u32 s88, s88, s97
  s_lshl_b32 s97, s76, 8
  s_add_u32 s88, s88, s97
  v_lshrrev_b32 v251, 4, v1
  v_lshlrev_b32 v251, 10, v251
  v_and_b32 v3, 15, v1
  v_lshl_add_u32 v251, v3, 4, v251
  s_lshl_b32 s89, s76, 17
  s_and_b32 s97, s3, 3
  s_lshl_b32 s97, s97, 15
  s_add_u32 s89, s89, s97
  s_lshl_b32 s97, s77, 8
  s_add_u32 s89, s89, s97
  s_barrier
L_back1:
  buffer_load_dwordx4 v[48:51], v8, s[32:35], s81 offen offset:0 sc1
  buffer_load_dwordx4 v[52:55], v8, s[32:35], s81 offen offset:1024 sc1
  buffer_load_dwordx4 v[56:59], v8, s[32:35], s81 offen offset:2048 sc1
  buffer_load_dwordx4 v[60:63], v8, s[32:35], s81 offen offset:3072 sc1
  buffer_load_dwordx4 v[64:67], v8, s[32:35], s82 offen offset:0 sc1
  buffer_load_dwordx4 v[68:71], v8, s[32:35], s82 offen offset:1024 sc1
  buffer_load_dwordx4 v[72:75], v8, s[32:35], s82 offen offset:2048 sc1
  buffer_load_dwordx4 v[76:79], v8, s[32:35], s82 offen offset:3072 sc1
  s_branch L_setup
L_back2:
  s_mov_b64 s[60:61], -1
  s_mov_b64 s[62:63], -1
  s_mov_b64 s[64:65], -1
  s_mov_b64 s[66:67], -1
  s_mov_b64 s[68:69], -1
  s_mov_b64 s[70:71], -1
  s_mov_b64 s[72:73], -1
  s_mov_b64 s[74:75], -1
  s_waitcnt vmcnt(0)
  s_mov_b32 s100, 0
  s_branch L_gc_21
L_g_19:
  s_add_u32 s100, s100, 1
  s_cmp_gt_u32 s100, 1000000
  s_cbranch_scc1 L_abort
  s_mov_b32 s92, 0
  s_cmp_lg_u32 s74, 0
  s_cselect_b32 s92, 7168, s92
  s_cmp_lg_u32 s72, 0
  s_cselect_b32 s92, 6144, s92
  s_cmp_lg_u32 s70, 0
  s_cselect_b32 s92, 5120, s92
  s_cmp_lg_u32 s68, 0
  s_cselect_b32 s92, 4096, s92
  s_cmp_lg_u32 s66, 0
  s_cselect_b32 s92, 3072, s92
  s_cmp_lg_u32 s64, 0
  s_cselect_b32 s92, 2048, s92
  s_cmp_lg_u32 s62, 0
  s_cselect_b32 s92, 1024, s92
  s_cmp_lg_u32 s60, 0
  s_cselect_b32 s92, 0, s92
  s_add_u32 s92, s92, s81
  s_mov_b64 exec, -1
L_qg_22:
  buffer_load_dwordx4 v[16:19], v8, s[32:35], s92 offen sc1
  s_add_u32 s100, s100, 1
  s_cmp_gt_u32 s100, 1000000
  s_cbranch_scc1 L_abort
  s_waitcnt vmcnt(0)
  v_xor_b32 v16, v16, v4
  v_bitop3_b32 v16, v17, v5, v16 bitop3:0xbe
  v_bitop3_b32 v16, v18, v6, v16 bitop3:0xbe
  v_bitop3_b32 v16, v19, v7, v16 bitop3:0xbe
  v_and_b32 v16, s53, v16
  v_cmp_ne_u32 vcc, 0, v16
  s_nop 0
  s_cbranch_vccz L_qg_22x
  s_sleep 4
  s_branch L_qg_22
L_qg_22x:
L_gf_20:
  s_mov_b64 exec, s[60:61]
  s_cbranch_execz L_gs_23
  buffer_load_dwordx4 v[48:51], v8, s[32:35], s81 offen offset:0 sc1
L_gs_23:
  s_mov_b64 exec, s[62:63]
  s_cbranch_execz L_gs_24
  buffer_load_dwordx4 v[52:55], v8, s[32:35], s81 offen offset:1024 sc1
L_gs_24:
  s_mov_b64 exec, s[64:65]
  s_cbranch_execz L_gs_25
  buffer_load_dwordx4 v[56:59], v8, s[32:35], s81 offen offset:2048 sc1
L_gs_25:
  s_mov_b64 exec, s[66:67]
  s_cbranch_execz L_gs_26
  buffer_load_dwordx4 v[60:63], v8, s[32:35], s81 offen offset:3072 sc1
L_gs_26:
  s_mov_b64 exec, s[68:69]
  s_cbranch_execz L_gs_27
  buffer_load_dwordx4 v[64:67], v8, s[32:35], s82 offen offset:0 sc1
L_gs_27:
  s_mov_b64 exec, s[70:71]
  s_cbranch_execz L_gs_28
  buffer_load_dwordx4 v[68:71], v8, s[32:35], s82 offen offset:1024 sc1
L_gs_28:
  s_mov_b64 exec, s[72:73]
  s_cbranch_execz L_gs_29
  buffer_load_dwordx4 v[72:75], v8, s[32:35], s82 offen offset:2048 sc1
L_gs_29:
  s_mov_b64 exec, s[74:75]
  s_cbranch_execz L_gs_30
  buffer_load_dwordx4 v[76:79], v8, s[32:35], s82 offen offset:3072 sc1
L_gs_30:
  s_waitcnt vmcnt(0)
L_gc_21:
  s_mov_b64 exec, s[60:61]
  v_xor_b32 v44, v48, v4
  v_bitop3_b32 v44, v49, v5, v44 bitop3:0xbe
  v_bitop3_b32 v44, v50, v6, v44 bitop3:0xbe
  v_bitop3_b32 v44, v51, v7, v44 bitop3:0xbe
  v_and_b32 v44, s53, v44
  v_cmp_ne_u32 s[60:61], 0, v44
  s_nop 0
  s_cmp_lg_u64 s[60:61], 0
  s_cselect_b64 s[60:61], -1, 0
  s_mov_b64 exec, s[62:63]
  v_xor_b32 v44, v52, v4
  v_bitop3_b32 v44, v53, v5, v44 bitop3:0xbe
  v_bitop3_b32 v44, v54, v6, v44 bitop3:0xbe
  v_bitop3_b32 v44, v55, v7, v44 bitop3:0xbe
  v_and_b32 v44, s53, v44
  v_cmp_ne_u32 s[62:63], 0, v44
  s_nop 0
  s_cmp_lg_u64 s[62:63], 0
  s_cselect_b64 s[62:63], -1, 0
  s_mov_b64 exec, s[64:65]
  v_xor_b32 v44, v56, v4
  v_bitop3_b32 v44, v57, v5, v44 bitop3:0xbe
  v_bitop3_b32 v44, v58, v6, v44 bitop3:0xbe
  v_bitop3_b32 v44, v59, v7, v44 bitop3:0xbe
  v_and_b32 v44, s53, v44
  v_cmp_ne_u32 s[64:65], 0, v44
  s_nop 0
  s_cmp_lg_u64 s[64:65], 0
  s_cselect_b64 s[64:65], -1, 0
  s_mov_b64 exec, s[66:67]
  v_xor_b32 v44, v60, v4
  v_bitop3_b32 v44, v61, v5, v44 bitop3:0xbe
  v_bitop3_b32 v44, v62, v6, v44 bitop3:0xbe
  v_bitop3_b32 v44, v63, v7, v44 bitop3:0xbe
  v_and_b32 v44, s53, v44
  v_cmp_ne_u32 s[66:67], 0, v44
  s_nop 0
  s_cmp_lg_u64 s[66:67], 0
  s_cselect_b64 s[66:67], -1, 0
  s_mov_b64 exec, s[68:69]
  v_xor_b32 v44, v64, v4
  v_bitop3_b32 v44, v65, v5, v44 bitop3:0xbe
  v_bitop3_b32 v44, v66, v6, v44 bitop3:0xbe
  v_bitop3_b32 v44, v67, v7, v44 bitop3:0xbe
  v_and_b32 v44, s53, v44
  v_cmp_ne_u32 s[68:69], 0, v44
  s_nop 0
  s_cmp_lg_u64 s[68:69], 0
  s_cselect_b64 s[68:69], -1, 0
  s_mov_b64 exec, s[70:71]
  v_xor_b32 v44, v68, v4
  v_bitop3_b32 v44, v69, v5, v44 bitop3:0xbe
  v_bitop3_b32 v44, v70, v6, v44 bitop3:0xbe
  v_bitop3_b32 v44, v71, v7, v44 bitop3:0xbe
  v_and_b32 v44, s53, v44
  v_cmp_ne_u32 s[70:71], 0, v44
  s_nop 0
  s_cmp_lg_u64 s[70:71], 0
  s_cselect_b64 s[70:71], -1, 0
  s_mov_b64 exec, s[72:73]
  v_xor_b32 v44, v72, v4
  v_bitop3_b32 v44, v73, v5, v44 bitop3:0xbe
  v_bitop3_b32 v44, v74, v6, v44 bitop3:0xbe
  v_bitop3_b32 v44, v75, v7, v44 bitop3:0xbe
  v_and_b32 v44, s53, v44
  v_cmp_ne_u32 s[72:73], 0, v44
  s_nop 0
  s_cmp_lg_u64 s[72:73], 0
  s_cselect_b64 s[72:73], -1, 0
  s_mov_b64 exec, s[74:75]
  v_xor_b32 v44, v76, v4
  v_bitop3_b32 v44, v77, v5, v44 bitop3:0xbe
  v_bitop3_b32 v44, v78, v6, v44 bitop3:0xbe
  v_bitop3_b32 v44, v79, v7, v44 bitop3:0xbe
  v_and_b32 v44, s53, v44
  v_cmp_ne_u32 s[74:75], 0, v44
  s_nop 0
  s_cmp_lg_u64 s[74:75], 0
  s_cselect_b64 s[74:75], -1, 0
  s_or_b64 s[96:97], s[60:61], s[62:63]
  s_or_b64 s[96:97], s[96:97], s[64:65]
  s_or_b64 s[96:97], s[96:97], s[66:67]
  s_or_b64 s[96:97], s[96:97], s[68:69]
  s_or_b64 s[96:97], s[96:97], s[70:71]
  s_or_b64 s[96:97], s[96:97], s[72:73]
  s_or_b64 s[96:97], s[96:97], s[74:75]
  s_cbranch_scc1 L_g_19
  s_mov_b64 exec, -1
  s_cmp_le_u32 s100, 0
  s_cselect_b32 s101, 0, 0
  v_xor_b32 v10, 0, v9
  ds_write_b128 v10, v[48:51] offset:0
  v_xor_b32 v11, 64, v9
  ds_write_b128 v11, v[52:55] offset:256
  v_xor_b32 v10, 128, v9
  ds_write_b128 v10, v[56:59] offset:512
  v_xor_b32 v11, 192, v9
  ds_write_b128 v11, v[60:63] offset:768
  v_xor_b32 v10, 16, v9
  ds_write_b128 v10, v[64:67] offset:1024
  v_xor_b32 v11, 80, v9
  ds_write_b128 v11, v[68:71] offset:1280
  v_xor_b32 v10, 144, v9
  ds_write_b128 v10, v[72:75] offset:1536
  v_xor_b32 v11, 208, v9
  ds_write_b128 v11, v[76:79] offset:1792
  s_mov_b64 s[40:41], s[14:15]
  s_mov_b32 s42, 0x400000
  s_mov_b32 s43, 0x20000
  s_mov_b64 s[44:45], s[12:13]
  s_mov_b32 s46, 0x400000
  s_mov_b32 s47, 0x20000
  s_waitcnt lgkmcnt(0)
  s_setprio 3
  s_barrier
  s_cmp_lt_u32 s2, 128
  s_cbranch_scc0 L_lwB
  s_cmp_lg_u32 s101, 0
  s_cbranch_scc1 L_lwX
  buffer_load_dwordx4 v[176:179], v253, s[44:47], s88 offen nt
  s_add_u32 s88, s88, 65536
  buffer_load_dwordx4 v[180:183], v253, s[44:47], s88 offen nt
  s_add_u32 s88, s88, 65536
  buffer_load_dwordx4 v[184:187], v253, s[44:47], s88 offen nt
  s_add_u32 s88, s88, 65536
  buffer_load_dwordx4 v[188:191], v253, s[44:47], s88 offen nt
  buffer_load_dwordx4 v[208:211], v251, s[40:43], s89 offen nt
  s_add_u32 s89, s89, 4096
  buffer_load_dwordx4 v[212:215], v251, s[40:43], s89 offen nt
  s_add_u32 s89, s89, 4096
  buffer_load_dwordx4 v[216:219], v251, s[40:43], s89 offen nt
  s_add_u32 s89, s89, 4096
  buffer_load_dwordx4 v[220:223], v251, s[40:43], s89 offen nt
  s_add_u32 s89, s89, 4096
  buffer_load_dwordx4 v[224:227], v251, s[40:43], s89 offen nt
  s_add_u32 s89, s89, 4096
  buffer_load_dwordx4 v[228:231], v251, s[40:43], s89 offen nt
  s_add_u32 s89, s89, 4096
  buffer_load_dwordx4 v[232:235], v251, s[40:43], s89 offen nt
  s_add_u32 s89, s89, 4096
  buffer_load_dwordx4 v[236:239], v251, s[40:43], s89 offen nt
L_lwX:
  s_barrier
  s_barrier
  s_barrier
  s_branch L_pv
L_lwB:
  s_cmp_lg_u32 s101, 0
  s_cbranch_scc1 L_lwB2
  buffer_load_dwordx4 v[176:179], v253, s[44:47], s88 offen nt
  s_add_u32 s88, s88, 65536
  buffer_load_dwordx4 v[180:183], v253, s[44:47], s88 offen nt
  s_add_u32 s88, s88, 65536
  buffer_load_dwordx4 v[184:187], v253, s[44:47], s88 offen nt
  s_add_u32 s88, s88, 65536
  buffer_load_dwordx4 v[188:191], v253, s[44:47], s88 offen nt
  s_mov_b64 s[40:41], s[18:19]
  s_mov_b32 s42, 0x1c0000
  s_mov_b32 s43, 0x20000
  s_mov_b64 s[44:45], s[20:21]
  s_mov_b32 s46, 0x1c0000
  s_mov_b32 s47, 0x20000
  s_mov_b32 exec_lo, 0xfffffff
  s_mov_b32 exec_hi, 0xfffffff
  buffer_load_dwordx4 v[208:211], v251, s[40:43], s89 offen nt
  buffer_load_dwordx4 v[212:215], v251, s[44:47], s89 offen nt
  s_add_u32 s89, s89, 7168
  buffer_load_dwordx4 v[216:219], v251, s[40:43], s89 offen nt
  buffer_load_dwordx4 v[220:223], v251, s[44:47], s89 offen nt
  s_add_u32 s89, s89, 7168
  buffer_load_dwordx4 v[224:227], v251, s[40:43], s89 offen nt
  buffer_load_dwordx4 v[228:231], v251, s[44:47], s89 offen nt
  s_add_u32 s89, s89, 7168
  buffer_load_dwordx4 v[232:235], v251, s[40:43], s89 offen nt
  buffer_load_dwordx4 v[236:239], v251, s[44:47], s89 offen nt
  s_mov_b64 exec, -1
L_lwB2:
  s_and_b32 s74, s2, 31
  s_lshl_b32 s74, s74, 10
  s_lshr_b32 s97, s78, 5
  s_lshl_b32 s97, s97, 8
  s_add_u32 s74, s74, s97
  s_add_u32 s74, s74, 16384
  v_and_b32 v13, 7, v1
  v_lshlrev_b32 v13, 2, v13
  v_lshrrev_b32 v14, 4, v1
  v_add_u32 v13, v13, v14
  v_lshlrev_b32 v13, 5, v13
  s_lshl_b32 s92, s3, 2
  s_add_u32 s92, s92, 141296
  v_add_u32 v13, s92, v13
  v_lshlrev_b32 v14, 6, v1
  v_add_u32 v14, 141312, v14
  v_lshlrev_b32 v15, 4, v1
  v_xor_b32 v13, s59, v13
  v_xor_b32 v14, s59, v14
  s_waitcnt vmcnt(63)
  v_lshlrev_b32 v116, 16, v144
  v_and_b32 v117, 0xffff0000, v144
  v_lshlrev_b32 v118, 16, v145
  v_and_b32 v119, 0xffff0000, v145
  v_mul_f32 v112, 0xbfb8aa3b, v116
  v_mul_f32 v113, 0xbfb8aa3b, v117
  v_mul_f32 v114, 0xbfb8aa3b, v118
  v_mul_f32 v115, 0xbfb8aa3b, v119
  v_exp_f32 v112, v112
  v_exp_f32 v113, v113
  v_exp_f32 v114, v114
  v_exp_f32 v115, v115
  v_add_f32 v112, 1.0, v112
  v_add_f32 v113, 1.0, v113
  v_add_f32 v114, 1.0, v114
  v_add_f32 v115, 1.0, v115
  v_rcp_f32 v112, v112
  v_rcp_f32 v113, v113
  v_rcp_f32 v114, v114
  v_rcp_f32 v115, v115
  v_mul_f32 v116, v116, v112
  v_mul_f32 v117, v117, v113
  v_mul_f32 v118, v118, v114
  v_mul_f32 v119, v119, v115
  v_cvt_pk_bf16_f32 v116, v116, v116
  v_cvt_pk_bf16_f32 v117, v117, v117
  v_cvt_pk_bf16_f32 v118, v118, v118
  v_cvt_pk_bf16_f32 v119, v119, v119
  v_lshrrev_b32 v112, 16, v116
  v_lshrrev_b32 v113, 16, v117
  v_lshrrev_b32 v114, 16, v118
  v_lshrrev_b32 v115, 16, v119
  v_and_b32 v116, 0xffff0000, v116
  v_and_b32 v117, 0xffff0000, v117
  v_and_b32 v118, 0xffff0000, v118
  v_and_b32 v119, 0xffff0000, v119
  v_mov_b32 v96, 0
  v_mov_b32 v97, 0
  v_mov_b32 v98, 0
  v_mov_b32 v99, 0
  v_mov_b32 v100, 0
  v_mov_b32 v101, 0
  v_mov_b32 v102, 0
  v_mov_b32 v103, 0
  s_waitcnt vmcnt(63)
  v_dot2c_f32_bf16 v96, v112, v128
  v_dot2c_f32_bf16 v97, v116, v128
  v_dot2c_f32_bf16 v98, v112, v129
  v_dot2c_f32_bf16 v99, v116, v129
  v_dot2c_f32_bf16 v100, v112, v130
  v_dot2c_f32_bf16 v101, v116, v130
  v_dot2c_f32_bf16 v102, v112, v131
  v_dot2c_f32_bf16 v103, v116, v131
  s_waitcnt vmcnt(62)
  v_dot2c_f32_bf16 v96, v113, v132
  v_dot2c_f32_bf16 v97, v117, v132
  v_dot2c_f32_bf16 v98, v113, v133
  v_dot2c_f32_bf16 v99, v117, v133
  v_dot2c_f32_bf16 v100, v113, v134
  v_dot2c_f32_bf16 v101, v117, v134
  v_dot2c_f32_bf16 v102, v113, v135
  v_dot2c_f32_bf16 v103, v117, v135
  s_waitcnt vmcnt(61)
  v_dot2c_f32_bf16 v96, v114, v136
  v_dot2c_f32_bf16 v97, v118, v136
  v_dot2c_f32_bf16 v98, v114, v137
  v_dot2c_f32_bf16 v99, v118, v137
  v_dot2c_f32_bf16 v100, v114, v138
  v_dot2c_f32_bf16 v101, v118, v138
  v_dot2c_f32_bf16 v102, v114, v139
  v_dot2c_f32_bf16 v103, v118, v139
  s_waitcnt vmcnt(60)
  v_dot2c_f32_bf16 v96, v115, v140
  v_dot2c_f32_bf16 v97, v119, v140
  v_dot2c_f32_bf16 v98, v115, v141
  v_dot2c_f32_bf16 v99, v119, v141
  v_dot2c_f32_bf16 v100, v115, v142
  v_dot2c_f32_bf16 v101, v119, v142
  v_dot2c_f32_bf16 v102, v115, v143
  v_dot2c_f32_bf16 v103, v119, v143
  v_permlane32_swap_b32 v96, v100
  v_permlane32_swap_b32 v97, v101
  v_permlane32_swap_b32 v98, v102
  v_permlane32_swap_b32 v99, v103
  v_add_f32 v96, v96, v100
  v_add_f32 v97, v97, v101
  v_add_f32 v98, v98, v102
  v_add_f32 v99, v99, v103
  s_nop 0
  v_permlane16_swap_b32 v96, v98
  v_permlane16_swap_b32 v97, v99
  v_add_f32 v96, v96, v98
  v_add_f32 v97, v97, v99
  s_nop 0
  v_add_f32_dpp v96, v96, v96 row_ror:8 row_mask:0xf bank_mask:0xf
  v_add_f32_dpp v97, v97, v97 row_ror:8 row_mask:0xf bank_mask:0xf
  s_barrier
  ds_write2_b32 v13, v96, v97 offset0:0 offset1:4
  s_waitcnt lgkmcnt(0)
  s_barrier
  s_cmp_lg_u32 s3, 4
  s_cbranch_scc1 L_nopub_31
  s_mov_b64 exec, 0xffff
  ds_read_b128 v[128:131], v14 offset:0
  ds_read_b128 v[132:135], v14 offset:16
  ds_read_b128 v[136:139], v14 offset:32
  ds_read_b128 v[140:143], v14 offset:48
  s_waitcnt lgkmcnt(3)
  v_add_f32 v128, v128, v129
  v_add_f32 v130, v130, v131
  v_add_f32 v128, v128, v130
  s_waitcnt lgkmcnt(2)
  v_add_f32 v132, v132, v133
  v_add_f32 v134, v134, v135
  v_add_f32 v132, v132, v134
  s_waitcnt lgkmcnt(1)
  v_add_f32 v136, v136, v137
  v_add_f32 v138, v138, v139
  v_add_f32 v136, v136, v138
  s_waitcnt lgkmcnt(0)
  v_add_f32 v140, v140, v141
  v_add_f32 v142, v142, v143
  v_add_f32 v140, v140, v142
  v_and_or_b32 v100, v128, v2, s49
  v_and_or_b32 v101, v132, v2, s50
  v_and_or_b32 v102, v136, v2, s51
  v_and_or_b32 v103, v140, v2, s52
  buffer_store_dwordx4 v[100:103], v15, s[32:35], s74 offen sc1
L_nopub_31:
  s_mov_b64 exec, -1
  s_barrier
  s_branch L_pv
L_front:
  s_mov_b32 s100, 0
  s_waitcnt vmcnt(4)
  s_branch L_epc_33
L_ep_32:
  global_load_dword v252, v253, s[30:31] sc1
  s_add_u32 s100, s100, 1
  s_cmp_gt_u32 s100, 1000000
  s_cbranch_scc1 L_abort
  s_waitcnt vmcnt(0)
L_epc_33:
  v_readfirstlane_b32 s48, v252
  s_nop 0
  s_cmp_eq_u32 s48, 0
  s_nop 1
  s_cbranch_scc1 L_ep_32
  s_mul_i32 s48, s48, 0x9e3779b1
  s_and_b32 s49, s48, 0xff
  s_bfe_u32 s50, s48, 0x80008
  s_bfe_u32 s51, s48, 0x80010
  s_lshr_b32 s52, s48, 24
  s_lshr_b32 s97, s48, 15
  s_xor_b32 s97, s97, s48
  s_mul_i32 s97, s97, 0x85ebca6b
  v_mov_b32 v4, s48
  v_mov_b32 v5, s97
  v_mov_b32 v249, s48
  v_mov_b32 v250, s97
  v_and_b32 v6, 4, v1
  v_cmp_eq_u32 vcc, 0, v6
  v_and_b32 v7, 3, v1
  v_lshlrev_b32 v7, 2, v7
  v_cndmask_b32 v4, v5, v4, vcc
  v_lshrrev_b32 v4, v7, v4
  v_lshrrev_b32 v5, 1, v4
  v_lshrrev_b32 v6, 2, v4
  v_lshrrev_b32 v7, 3, v4
L_setup:
  s_lshr_b32 s92, s3, 1
  s_lshl_b32 s92, s92, 15
  s_and_b32 s93, s3, 1
  v_lshlrev_b32 v34, 4, v1
  v_bfe_u32 v44, v1, 2, 2
  v_lshrrev_b32 v45, 5, v1
  v_lshl_add_u32 v46, v45, 2, v44
  v_lshlrev_b32 v46, 8, v46
  v_add_u32 v46, s92, v46
  v_and_b32 v47, 1, v1
  v_lshl_add_u32 v46, v47, 3, v46
  v_lshl_or_b32 v44, v44, 2, v45
  v_bfe_u32 v47, v1, 4, 1
  v_lshlrev_b32 v47, 1, v47
  v_xor_b32 v44, v44, v47
  v_bfe_u32 v47, v1, 1, 1
  v_xor_b32 v44, v44, v47
  s_lshl_b32 s94, s93, 3
  v_xor_b32 v44, s94, v44
  v_xor_b32 v47, 0, v44
  v_lshl_add_u32 v24, v47, 4, v46
  v_xor_b32 v47, 2, v44
  v_lshl_add_u32 v25, v47, 4, v46
  v_add_u32 v25, 2048, v25
  v_xor_b32 v47, 4, v44
  v_lshl_add_u32 v26, v47, 4, v46
  v_xor_b32 v47, 6, v44
  v_lshl_add_u32 v27, v47, 4, v46
  v_add_u32 v27, 2048, v27
  v_add_u32 v28, 132096, v34
  v_and_b32 v44, 31, v1
  v_lshlrev_b32 v29, 5, v44
  v_add_u32 v29, 131072, v29
  v_xor_b32 v28, s59, v28
  v_xor_b32 v29, s59, v29
  s_lshl_b32 s94, s93, 7
  s_add_u32 s94, s94, s92
  v_and_b32 v46, 3, v44
  v_lshlrev_b32 v46, 6, v46
  v_lshl_add_u32 v46, v44, 8, v46
  v_bfe_u32 v47, v44, 1, 2
  v_lshlrev_b32 v45, 1, v45
  v_xor_b32 v47, v47, v45
  v_lshl_add_u32 v46, v47, 4, v46
  v_xor_b32 v244, s94, v46
  v_xor_b32 v245, 16, v244
  v_xor_b32 v246, 64, v244
  v_xor_b32 v247, 0x50, v244
  v_lshrrev_b32 v44, 2, v1
  v_and_b32 v46, 3, v44
  v_lshlrev_b32 v46, 6, v46
  v_lshl_add_u32 v46, v44, 8, v46
  v_bfe_u32 v47, v44, 1, 2
  v_and_b32 v45, 3, v1
  v_xor_b32 v47, v47, v45
  v_lshl_add_u32 v46, v47, 4, v46
  v_xor_b32 v32, s94, v46
  v_xor_b32 v33, 64, v32
  v_lshrrev_b32 v44, 3, v1
  v_bfe_u32 v45, v1, 2, 1
  v_and_b32 v46, 3, v44
  v_xor_b32 v46, v46, v45
  v_lshlrev_b32 v46, 6, v46
  v_lshl_add_u32 v46, v44, 8, v46
  v_lshrrev_b32 v47, 1, v44
  v_and_b32 v45, 3, v1
  v_xor_b32 v47, v47, v45
  v_lshl_add_u32 v46, v47, 4, v46
  v_xor_b32 v32, s94, v46
  s_mul_i32 s87, s2, 32896
  s_lshl_b32 s97, s3, 12
  s_add_u32 s87, s87, s97
  s_add_u32 s87, s87, 2097152
  s_lshl_b32 s94, s76, 4
  s_lshl_b32 s97, s3, 9
  s_add_u32 s94, s94, s97
  s_add_u32 s94, s94, 131072
  v_lshrrev_b32 v35, 3, v1
  v_lshlrev_b32 v35, 12, v35
  v_add_u32 v35, s94, v35
  v_lshlrev_b32 v248, 4, v1
  v_lshrrev_b32 v36, 3, v1
  v_mul_u32_u24 v36, 263168, v36
  v_and_b32 v3, 7, v1
  v_lshl_add_u32 v36, v3, 4, v36
  s_mul_i32 s94, s3, 32896
  s_lshl_b32 s97, s77, 12
  s_add_u32 s94, s94, s97
  s_lshl_b32 s97, s76, 7
  s_add_u32 s94, s94, s97
  s_add_u32 s83, s94, 6307840
  s_add_u32 s84, s94, 8413184
  s_add_u32 s85, s94, 2097152
  s_add_u32 s86, s94, 4202496
  s_mul_i32 s94, s3, 144
  s_add_u32 s94, s94, 81920
  v_and_b32 v37, 7, v1
  v_lshlrev_b32 v37, 4, v37
  v_lshrrev_b32 v3, 4, v1
  v_lshl_add_u32 v37, v3, 2, v37
  v_add_u32 v37, s94, v37
  v_and_b32 v38, 7, v1
  v_mul_u32_u24 v38, 144, v38
  v_lshrrev_b32 v3, 4, v1
  v_lshl_add_u32 v38, v3, 4, v38
  v_add_u32 v38, 81920, v38
  s_lshl_b32 s94, s3, 7
  s_add_u32 s94, s94, 93184
  v_lshrrev_b32 v41, 4, v1
  v_lshlrev_b32 v41, 4, v41
  v_add_u32 v41, s94, v41
  v_and_b32 v40, 7, v1
  v_mul_u32_u24 v40, 272, v40
  v_lshrrev_b32 v3, 4, v1
  v_lshl_add_u32 v40, v3, 4, v40
  v_add_u32 v40, 94208, v40
  s_lshl_b32 s94, s76, 12
  s_lshl_b32 s97, s3, 6
  s_add_u32 s94, s94, s97
  s_add_u32 s94, s94, 262144
  v_bfe_u32 v39, v1, 2, 3
  v_lshlrev_b32 v39, 9, v39
  v_and_b32 v3, 3, v1
  v_lshl_add_u32 v39, v3, 4, v39
  v_add_u32 v39, s94, v39
  s_lshl_b32 s95, s77, 9
  s_add_u32 s16, s94, s95
  s_and_b32 s94, s3, 3
  s_mul_i32 s94, s94, 4864
  v_lshrrev_b32 v240, 4, v1
  v_mul_u32_u24 v240, 288, v240
  v_and_b32 v3, 15, v1
  v_lshl_add_u32 v240, v3, 4, v240
  v_add_u32 v240, s94, v240
  s_and_b32 s94, s3, 3
  s_mul_i32 s94, s94, 9728
  s_add_u32 s94, s94, 20480
  v_lshrrev_b32 v241, 4, v1
  v_mul_u32_u24 v241, 288, v241
  v_and_b32 v3, 15, v1
  v_lshl_add_u32 v241, v3, 4, v241
  v_add_u32 v241, s94, v241
  s_lshl_b32 s94, s3, 5
  v_lshrrev_b32 v242, 4, v1
  v_mul_u32_u24 v242, 2432, v242
  v_bfe_u32 v3, v1, 2, 2
  v_mul_u32_u24 v3, 288, v3
  v_add_u32 v242, v3, v242
  v_and_b32 v3, 3, v1
  v_lshl_add_u32 v242, v3, 3, v242
  v_add_u32 v242, s94, v242
  v_lshrrev_b32 v243, 4, v1
  v_mul_u32_u24 v243, 2432, v243
  v_bfe_u32 v3, v1, 2, 2
  v_mul_u32_u24 v3, 288, v3
  v_add_u32 v243, v3, v243
  v_and_b32 v3, 3, v1
  v_lshl_add_u32 v243, v3, 3, v243
  v_add_u32 v243, 20480, v243
  v_add_u32 v243, s94, v243
  v_bfe_u32 v43, v1, 2, 3
  v_mul_u32_u24 v43, 272, v43
  v_and_b32 v3, 3, v1
  v_lshl_add_u32 v43, v3, 3, v43
  v_add_u32 v43, 94208, v43
  v_add_u32 v43, s94, v43
  s_cmp_ge_u32 s3, 4
  s_cbranch_scc1 L_back2
  v_and_b32 v44, 31, v1
  v_and_b32 v46, 3, v44
  v_lshlrev_b32 v46, 2, v46
  v_bfe_u32 v47, v44, 2, 2
  v_or_b32 v46, v46, v47
  v_lshrrev_b32 v47, 5, v1
  v_xor_b32 v46, v46, v47
  v_lshlrev_b32 v45, 8, v44
  v_xor_b32 v47, 0, v46
  v_lshl_add_u32 v16, v47, 4, v45
  v_xor_b32 v47, 2, v46
  v_lshl_add_u32 v17, v47, 4, v45
  v_xor_b32 v47, 4, v46
  v_lshl_add_u32 v18, v47, 4, v45
  v_xor_b32 v47, 6, v46
  v_lshl_add_u32 v19, v47, 4, v45
  v_xor_b32 v47, 8, v46
  v_lshl_add_u32 v20, v47, 4, v45
  v_xor_b32 v47, 10, v46
  v_lshl_add_u32 v21, v47, 4, v45
  v_xor_b32 v47, 12, v46
  v_lshl_add_u32 v22, v47, 4, v45
  v_xor_b32 v47, 14, v46
  v_lshl_add_u32 v23, v47, 4, v45
  s_lshl_b32 s92, s17, 13
  s_add_u32 s92, s92, 131072
  v_add_u32 v8, s91, v16
  v_add_u32 v16, s92, v16
  v_add_u32 v9, s91, v17
  v_add_u32 v17, s92, v17
  v_add_u32 v10, s91, v18
  v_add_u32 v18, s92, v18
  v_add_u32 v11, s91, v19
  v_add_u32 v19, s92, v19
  v_add_u32 v12, s91, v20
  v_add_u32 v20, s92, v20
  v_add_u32 v13, s91, v21
  v_add_u32 v21, s92, v21
  v_add_u32 v14, s91, v22
  v_add_u32 v22, s92, v22
  v_add_u32 v15, s91, v23
  v_add_u32 v23, s92, v23
  s_lshl_b32 s92, s3, 2
  v_lshrrev_b32 v47, 5, v1
  v_lshl_add_u32 v30, v47, 4, v29
  v_add_u32 v30, s92, v30
  s_lshl_b32 s92, s3, 11
  v_add_u32 v31, s92, v28
  s_setprio 2
  s_mov_b32 s101, 1
  s_waitcnt vmcnt(4)
  s_barrier
  ds_read_b128 v[112:115], v8
  ds_read_b128 v[116:119], v16
  ds_read_b128 v[120:123], v9
  ds_read_b128 v[124:127], v17
  ds_read_b128 v[128:131], v10
  ds_read_b128 v[132:135], v18
  ds_read_b128 v[136:139], v11
  ds_read_b128 v[140:143], v19
  ds_read_b128 v[144:147], v12
  ds_read_b128 v[148:151], v20
  ds_read_b128 v[152:155], v13
  ds_read_b128 v[156:159], v21
  v_xor_b32 v8, 0x8000, v8
  v_xor_b32 v16, 0x2000, v16
  v_xor_b32 v9, 0x8000, v9
  v_xor_b32 v17, 0x2000, v17
  v_xor_b32 v10, 0x8000, v10
  v_xor_b32 v18, 0x2000, v18
  v_xor_b32 v11, 0x8000, v11
  v_xor_b32 v19, 0x2000, v19
  v_xor_b32 v12, 0x8000, v12
  v_xor_b32 v20, 0x2000, v20
  v_xor_b32 v13, 0x8000, v13
  v_xor_b32 v21, 0x2000, v21
  s_waitcnt lgkmcnt(10)
  v_mfma_f32_32x32x16_bf16 v[96:111], v[112:115], v[116:119], 0
  ds_read_b128 v[160:163], v14
  ds_read_b128 v[164:167], v22
  v_xor_b32 v14, 0x8000, v14
  v_xor_b32 v22, 0x2000, v22
  s_waitcnt lgkmcnt(10)
  v_mfma_f32_32x32x16_bf16 v[96:111], v[120:123], v[124:127], v[96:111]
  ds_read_b128 v[168:171], v15
  ds_read_b128 v[172:175], v23
  v_xor_b32 v15, 0x8000, v15
  v_xor_b32 v23, 0x2000, v23
  s_waitcnt lgkmcnt(10)
  v_mfma_f32_32x32x16_bf16 v[96:111], v[128:131], v[132:135], v[96:111]
  ds_read_b128 v[112:115], v8
  ds_read_b128 v[116:119], v16
  v_xor_b32 v8, 0x18000, v8
  v_xor_b32 v16, 0x6000, v16
  s_waitcnt lgkmcnt(10)
  v_mfma_f32_32x32x16_bf16 v[96:111], v[136:139], v[140:143], v[96:111]
  ds_read_b128 v[120:123], v9
  ds_read_b128 v[124:127], v17
  v_xor_b32 v9, 0x18000, v9
  v_xor_b32 v17, 0x6000, v17
  s_waitcnt lgkmcnt(10)
  v_mfma_f32_32x32x16_bf16 v[96:111], v[144:147], v[148:151], v[96:111]
  ds_read_b128 v[128:131], v10
  ds_read_b128 v[132:135], v18
  v_xor_b32 v10, 0x18000, v10
  v_xor_b32 v18, 0x6000, v18
  s_waitcnt lgkmcnt(10)
  v_mfma_f32_32x32x16_bf16 v[96:111], v[152:155], v[156:159], v[96:111]
  ds_read_b128 v[136:139], v11
  ds_read_b128 v[140:143], v19
  v_xor_b32 v11, 0x18000, v11
  v_xor_b32 v19, 0x6000, v19
  s_waitcnt lgkmcnt(10)
  v_mfma_f32_32x32x16_bf16 v[96:111], v[160:163], v[164:167], v[96:111]
  ds_read_b128 v[144:147], v12
  ds_read_b128 v[148:151], v20
  v_xor_b32 v12, 0x18000, v12
  v_xor_b32 v20, 0x6000, v20
  s_waitcnt lgkmcnt(10)
  v_mfma_f32_32x32x16_bf16 v[96:111], v[168:171], v[172:175], v[96:111]
  ds_read_b128 v[152:155], v13
  ds_read_b128 v[156:159], v21
  v_xor_b32 v13, 0x18000, v13
  v_xor_b32 v21, 0x6000, v21
  s_waitcnt lgkmcnt(10)
  v_mfma_f32_32x32x16_bf16 v[96:111], v[112:115], v[116:119], v[96:111]
  ds_read_b128 v[160:163], v14
  ds_read_b128 v[164:167], v22
  v_xor_b32 v14, 0x18000, v14
  v_xor_b32 v22, 0x6000, v22
  s_waitcnt lgkmcnt(10)
  v_mfma_f32_32x32x16_bf16 v[96:111], v[120:123], v[124:127], v[96:111]
  ds_read_b128 v[168:171], v15
  ds_read_b128 v[172:175], v23
  v_xor_b32 v15, 0x18000, v15
  v_xor_b32 v23, 0x6000, v23
  s_waitcnt lgkmcnt(10)
  v_mfma_f32_32x32x16_bf16 v[96:111], v[128:131], v[132:135], v[96:111]
  ds_read_b128 v[112:115], v8
  ds_read_b128 v[116:119], v16
  v_xor_b32 v8, 0x8000, v8
  v_xor_b32 v16, 0x2000, v16
  s_waitcnt lgkmcnt(10)
  v_mfma_f32_32x32x16_bf16 v[96:111], v[136:139], v[140:143], v[96:111]
  ds_read_b128 v[120:123], v9
  ds_read_b128 v[124:127], v17
  v_xor_b32 v9, 0x8000, v9
  v_xor_b32 v17, 0x2000, v17
  s_waitcnt lgkmcnt(10)
  v_mfma_f32_32x32x16_bf16 v[96:111], v[144:147], v[148:151], v[96:111]
  ds_read_b128 v[128:131], v10
  ds_read_b128 v[132:135], v18
  v_xor_b32 v10, 0x8000, v10
  v_xor_b32 v18, 0x2000, v18
  s_waitcnt lgkmcnt(10)
  v_mfma_f32_32x32x16_bf16 v[96:111], v[152:155], v[156:159], v[96:111]
  ds_read_b128 v[136:139], v11
  ds_read_b128 v[140:143], v19
  v_xor_b32 v11, 0x8000, v11
  v_xor_b32 v19, 0x2000, v19
  s_waitcnt lgkmcnt(10)
  v_mfma_f32_32x32x16_bf16 v[96:111], v[160:163], v[164:167], v[96:111]
  ds_read_b128 v[144:147], v12
  ds_read_b128 v[148:151], v20
  v_xor_b32 v12, 0x8000, v12
  v_xor_b32 v20, 0x2000, v20
  s_waitcnt lgkmcnt(10)
  v_mfma_f32_32x32x16_bf16 v[96:111], v[168:171], v[172:175], v[96:111]
  ds_read_b128 v[152:155], v13
  ds_read_b128 v[156:159], v21
  v_xor_b32 v13, 0x8000, v13
  v_xor_b32 v21, 0x2000, v21
  s_barrier
  s_waitcnt lgkmcnt(10)
  v_mfma_f32_32x32x16_bf16 v[96:111], v[112:115], v[116:119], v[96:111]
  ds_read_b128 v[160:163], v14
  ds_read_b128 v[164:167], v22
  v_xor_b32 v14, 0x8000, v14
  v_xor_b32 v22, 0x2000, v22
  s_waitcnt lgkmcnt(10)
  v_mfma_f32_32x32x16_bf16 v[96:111], v[120:123], v[124:127], v[96:111]
  ds_read_b128 v[168:171], v15
  ds_read_b128 v[172:175], v23
  v_xor_b32 v15, 0x8000, v15
  v_xor_b32 v23, 0x2000, v23
  s_waitcnt lgkmcnt(10)
  v_mfma_f32_32x32x16_bf16 v[96:111], v[128:131], v[132:135], v[96:111]
  s_waitcnt vmcnt(0)
  ds_read_b128 v[112:115], v8
  ds_read_b128 v[116:119], v16
  s_waitcnt lgkmcnt(10)
  v_mfma_f32_32x32x16_bf16 v[96:111], v[136:139], v[140:143], v[96:111]
  ds_read_b128 v[120:123], v9
  ds_read_b128 v[124:127], v17
  s_waitcnt lgkmcnt(10)
  v_mfma_f32_32x32x16_bf16 v[96:111], v[144:147], v[148:151], v[96:111]
  ds_read_b128 v[128:131], v10
  ds_read_b128 v[132:135], v18
  s_waitcnt lgkmcnt(10)
  v_mfma_f32_32x32x16_bf16 v[96:111], v[152:155], v[156:159], v[96:111]
  ds_read_b128 v[136:139], v11
  ds_read_b128 v[140:143], v19
  s_waitcnt lgkmcnt(10)
  v_mfma_f32_32x32x16_bf16 v[96:111], v[160:163], v[164:167], v[96:111]
  ds_read_b128 v[144:147], v12
  ds_read_b128 v[148:151], v20
  s_waitcnt lgkmcnt(10)
  v_mfma_f32_32x32x16_bf16 v[96:111], v[168:171], v[172:175], v[96:111]
  ds_read_b128 v[152:155], v13
  ds_read_b128 v[156:159], v21
  s_waitcnt lgkmcnt(10)
  v_mfma_f32_32x32x16_bf16 v[96:111], v[112:115], v[116:119], v[96:111]
  ds_read_b128 v[160:163], v14
  ds_read_b128 v[164:167], v22
  s_waitcnt lgkmcnt(10)
  v_mfma_f32_32x32x16_bf16 v[96:111], v[120:123], v[124:127], v[96:111]
  ds_read_b128 v[168:171], v15
  ds_read_b128 v[172:175], v23
  s_waitcnt lgkmcnt(10)
  v_mfma_f32_32x32x16_bf16 v[96:111], v[128:131], v[132:135], v[96:111]
  s_waitcnt lgkmcnt(8)
  v_mfma_f32_32x32x16_bf16 v[96:111], v[136:139], v[140:143], v[96:111]
  s_waitcnt lgkmcnt(6)
  v_mfma_f32_32x32x16_bf16 v[96:111], v[144:147], v[148:151], v[96:111]
  s_waitcnt lgkmcnt(4)
  v_mfma_f32_32x32x16_bf16 v[96:111], v[152:155], v[156:159], v[96:111]
  s_waitcnt lgkmcnt(2)
  v_mfma_f32_32x32x16_bf16 v[96:111], v[160:163], v[164:167], v[96:111]
  s_waitcnt lgkmcnt(0)
  v_mfma_f32_32x32x16_bf16 v[96:111], v[168:171], v[172:175], v[96:111]
  s_nop 11
  v_max3_f32 v44, v96, v97, v98
  v_max3_f32 v45, v99, v100, v101
  v_max3_f32 v46, v102, v103, v104
  v_max3_f32 v47, v105, v106, v107
  v_max3_f32 v44, v44, v108, v109
  v_max3_f32 v45, v45, v110, v111
  v_max3_f32 v44, v44, v46, v47
  v_max_f32 v44, v44, v45
  ds_write_b32 v30, v44
  v_sub_f32 v96, v96, v44
  v_sub_f32 v97, v97, v44
  v_sub_f32 v98, v98, v44
  v_sub_f32 v99, v99, v44
  v_sub_f32 v100, v100, v44
  v_sub_f32 v101, v101, v44
  v_sub_f32 v102, v102, v44
  v_sub_f32 v103, v103, v44
  s_waitcnt lgkmcnt(0)
  s_barrier
  ds_read_b128 v[48:51], v29
  ds_read_b128 v[52:55], v29 offset:16
  v_exp_f32 v96, v96
  v_sub_f32 v104, v104, v44
  v_exp_f32 v97, v97
  v_sub_f32 v105, v105, v44
  v_exp_f32 v98, v98
  v_sub_f32 v106, v106, v44
  v_exp_f32 v99, v99
  v_sub_f32 v107, v107, v44
  v_exp_f32 v100, v100
  v_sub_f32 v108, v108, v44
  v_exp_f32 v101, v101
  v_sub_f32 v109, v109, v44
  v_exp_f32 v102, v102
  v_sub_f32 v110, v110, v44
  v_exp_f32 v103, v103
  v_sub_f32 v111, v111, v44
  s_waitcnt lgkmcnt(0)
  v_max3_f32 v45, v48, v49, v50
  v_max3_f32 v46, v51, v52, v53
  v_exp_f32 v104, v104
  v_max3_f32 v45, v45, v54, v55
  v_exp_f32 v105, v105
  v_max_f32 v45, v45, v46
  v_exp_f32 v106, v106
  v_sub_f32 v45, v44, v45
  v_exp_f32 v107, v107
  v_exp_f32 v45, v45
  v_exp_f32 v108, v108
  v_exp_f32 v109, v109
  v_exp_f32 v110, v110
  v_exp_f32 v111, v111
  v_mul_f32 v96, v96, v45
  v_mul_f32 v97, v97, v45
  v_mul_f32 v98, v98, v45
  v_mul_f32 v99, v99, v45
  v_mul_f32 v100, v100, v45
  v_mul_f32 v101, v101, v45
  v_mul_f32 v102, v102, v45
  v_mul_f32 v103, v103, v45
  v_cvt_pk_bf16_f32 v48, v96, v97
  v_cvt_pk_bf16_f32 v49, v98, v99
  v_cvt_pk_bf16_f32 v50, v100, v101
  v_cvt_pk_bf16_f32 v51, v102, v103
  ds_write_b128 v31, v[48:51] offset:0
  v_mul_f32 v104, v104, v45
  v_mul_f32 v105, v105, v45
  v_mul_f32 v106, v106, v45
  v_mul_f32 v107, v107, v45
  v_mul_f32 v108, v108, v45
  v_mul_f32 v109, v109, v45
  v_mul_f32 v110, v110, v45
  v_mul_f32 v111, v111, v45
  v_cvt_pk_bf16_f32 v52, v104, v105
  v_cvt_pk_bf16_f32 v53, v106, v107
  v_cvt_pk_bf16_f32 v54, v108, v109
  v_cvt_pk_bf16_f32 v55, v110, v111
  ds_write_b128 v31, v[52:55] offset:1024
  v_add_f32 v96, v96, v97
  v_add_f32 v98, v98, v99
  v_add_f32 v100, v100, v101
  v_add_f32 v102, v102, v103
  v_add_f32 v104, v104, v105
  v_add_f32 v106, v106, v107
  v_add_f32 v108, v108, v109
  v_add_f32 v110, v110, v111
  v_add_f32 v96, v96, v98
  v_add_f32 v100, v100, v102
  v_add_f32 v104, v104, v106
  v_add_f32 v108, v108, v110
  v_add_f32 v96, v96, v100
  v_add_f32 v104, v104, v108
  v_add_f32 v96, v96, v104
  ds_write_b32 v30, v96 offset:9216
  s_waitcnt lgkmcnt(0)
  s_barrier
L_pv:
  s_setprio 2
  ds_read_b128 v[48:51], v28 offset:0
  ds_read_b64_tr_b16 v[112:113], v24 offset:0
  ds_read_b64_tr_b16 v[114:115], v25 offset:0
  ds_read_b128 v[52:55], v28 offset:1024
  ds_read_b64_tr_b16 v[116:117], v24 offset:4096
  ds_read_b64_tr_b16 v[118:119], v25 offset:4096
  ds_read_b128 v[56:59], v28 offset:2048
  ds_read_b64_tr_b16 v[120:121], v24 offset:8192
  ds_read_b64_tr_b16 v[122:123], v25 offset:8192
  ds_read_b128 v[60:63], v28 offset:3072
  ds_read_b64_tr_b16 v[124:125], v24 offset:12288
  ds_read_b64_tr_b16 v[126:127], v25 offset:12288
  s_lshl_b32 s74, s2, 9
  s_add_u32 s74, s74, 131072
  s_mov_b32 s70, 0x10000
  s_mov_b32 s71, 0x18000
  s_mov_b32 s72, 0x8000
  s_cmp_lg_u32 s3, 7
  s_cbranch_scc1 L_nolse
  ds_read_b128 v[144:147], v29
  ds_read_b128 v[148:151], v29 offset:16
  s_waitcnt lgkmcnt(6)
  ds_read_b128 v[152:155], v29 offset:9216
  ds_read_b128 v[156:159], v29 offset:9232
  s_andn2_b32 s92, s48, 1
  v_mov_b32 v23, s92
  s_waitcnt lgkmcnt(2)
  v_max3_f32 v20, v144, v145, v146
  v_max3_f32 v21, v147, v148, v149
  v_max3_f32 v20, v20, v150, v151
  v_max_f32 v20, v20, v21
  s_waitcnt lgkmcnt(0)
  v_add_f32 v152, v152, v153
  v_add_f32 v154, v154, v155
  v_add_f32 v156, v156, v157
  v_add_f32 v158, v158, v159
  v_add_f32 v152, v152, v154
  v_add_f32 v156, v156, v158
  v_add_f32 v152, v152, v156
  v_mov_b32 v21, v152
  s_mov_b32 exec_hi, 0
  buffer_store_dwordx4 v[20:23], v248, s[32:35], s74 offen sc1
  s_mov_b32 exec_hi, -1
L_nolse:
  s_waitcnt lgkmcnt(9)
  v_mfma_f32_32x32x16_bf16 v[144:159], v[112:115], v[48:51], 0
  ds_read_b128 v[64:67], v28 offset:4096
  ds_read_b64_tr_b16 v[128:129], v24 offset:16384
  ds_read_b64_tr_b16 v[130:131], v25 offset:16384
  s_waitcnt lgkmcnt(9)
  v_mfma_f32_32x32x16_bf16 v[144:159], v[116:119], v[52:55], v[144:159]
  ds_read_b128 v[68:71], v28 offset:5120
  ds_read_b64_tr_b16 v[132:133], v24 offset:20480
  ds_read_b64_tr_b16 v[134:135], v25 offset:20480
  v_lshrrev_b32 v44, 5, v1
  v_lshlrev_b32 v44, 3, v44
  v_lshrrev_b32 v96, v44, v249
  v_lshrrev_b32 v104, v44, v250
  s_waitcnt lgkmcnt(9)
  v_mfma_f32_32x32x16_bf16 v[144:159], v[120:123], v[56:59], v[144:159]
  ds_read_b128 v[72:75], v28 offset:6144
  ds_read_b64_tr_b16 v[136:137], v24 offset:24576
  ds_read_b64_tr_b16 v[138:139], v25 offset:24576
  v_lshrrev_b32 v97, 1, v96
  v_lshrrev_b32 v98, 2, v96
  v_lshrrev_b32 v99, 3, v96
  s_waitcnt lgkmcnt(9)
  v_mfma_f32_32x32x16_bf16 v[144:159], v[124:127], v[60:63], v[144:159]
  ds_read_b128 v[76:79], v28 offset:7168
  ds_read_b64_tr_b16 v[140:141], v24 offset:28672
  ds_read_b64_tr_b16 v[142:143], v25 offset:28672
  v_lshrrev_b32 v100, 4, v96
  v_lshrrev_b32 v101, 5, v96
  v_lshrrev_b32 v102, 6, v96
  v_lshrrev_b32 v103, 7, v96
  s_waitcnt lgkmcnt(9)
  v_mfma_f32_32x32x16_bf16 v[144:159], v[128:131], v[64:67], v[144:159]
  ds_read_b64_tr_b16 v[112:113], v26 offset:0
  ds_read_b64_tr_b16 v[114:115], v27 offset:0
  v_lshrrev_b32 v105, 1, v104
  v_lshrrev_b32 v106, 2, v104
  v_lshrrev_b32 v107, 3, v104
  s_waitcnt lgkmcnt(8)
  v_mfma_f32_32x32x16_bf16 v[144:159], v[132:135], v[68:71], v[144:159]
  ds_read_b64_tr_b16 v[116:117], v26 offset:4096
  ds_read_b64_tr_b16 v[118:119], v27 offset:4096
  v_lshrrev_b32 v108, 4, v104
  v_lshrrev_b32 v109, 5, v104
  v_lshrrev_b32 v110, 6, v104
  v_lshrrev_b32 v111, 7, v104
  s_waitcnt lgkmcnt(7)
  v_mfma_f32_32x32x16_bf16 v[144:159], v[136:139], v[72:75], v[144:159]
  ds_read_b64_tr_b16 v[120:121], v26 offset:8192
  ds_read_b64_tr_b16 v[122:123], v27 offset:8192
  s_waitcnt lgkmcnt(6)
  v_mfma_f32_32x32x16_bf16 v[144:159], v[140:143], v[76:79], v[144:159]
  ds_read_b64_tr_b16 v[124:125], v26 offset:12288
  ds_read_b64_tr_b16 v[126:127], v27 offset:12288
  s_waitcnt lgkmcnt(6)
  v_mfma_f32_32x32x16_bf16 v[160:175], v[112:115], v[48:51], 0
  ds_read_b64_tr_b16 v[128:129], v26 offset:16384
  ds_read_b64_tr_b16 v[130:131], v27 offset:16384
  s_waitcnt lgkmcnt(6)
  v_mfma_f32_32x32x16_bf16 v[160:175], v[116:119], v[52:55], v[160:175]
  ds_read_b64_tr_b16 v[132:133], v26 offset:20480
  ds_read_b64_tr_b16 v[134:135], v27 offset:20480
  s_waitcnt lgkmcnt(6)
  v_mfma_f32_32x32x16_bf16 v[160:175], v[120:123], v[56:59], v[160:175]
  ds_read_b64_tr_b16 v[136:137], v26 offset:24576
  ds_read_b64_tr_b16 v[138:139], v27 offset:24576
  v_cvt_pk_bf16_f32 v80, v144, v145
  v_cvt_pk_bf16_f32 v81, v146, v147
  v_cvt_pk_bf16_f32 v82, v148, v149
  v_cvt_pk_bf16_f32 v83, v150, v151
  v_bfi_b32 v80, s53, v96, v80
  v_bfi_b32 v81, s53, v97, v81
  v_bfi_b32 v82, s53, v98, v82
  v_bfi_b32 v83, s53, v99, v83
  ds_write_b128 v244, v[80:83]
  s_waitcnt lgkmcnt(7)
  v_mfma_f32_32x32x16_bf16 v[160:175], v[124:127], v[60:63], v[160:175]
  ds_read_b64_tr_b16 v[140:141], v26 offset:28672
  ds_read_b64_tr_b16 v[142:143], v27 offset:28672
  v_cvt_pk_bf16_f32 v84, v152, v153
  v_cvt_pk_bf16_f32 v85, v154, v155
  v_cvt_pk_bf16_f32 v86, v156, v157
  v_cvt_pk_bf16_f32 v87, v158, v159
  v_bfi_b32 v84, s53, v100, v84
  v_bfi_b32 v85, s53, v101, v85
  v_bfi_b32 v86, s53, v102, v86
  v_bfi_b32 v87, s53, v103, v87
  ds_write_b128 v245, v[84:87]
  s_waitcnt lgkmcnt(8)
  v_mfma_f32_32x32x16_bf16 v[160:175], v[128:131], v[64:67], v[160:175]
  s_waitcnt lgkmcnt(6)
  v_mfma_f32_32x32x16_bf16 v[160:175], v[132:135], v[68:71], v[160:175]
  s_waitcnt lgkmcnt(4)
  v_mfma_f32_32x32x16_bf16 v[160:175], v[136:139], v[72:75], v[160:175]
  s_waitcnt lgkmcnt(1)
  v_mfma_f32_32x32x16_bf16 v[160:175], v[140:143], v[76:79], v[160:175]
  s_setprio 2
  s_nop 10
  v_cvt_pk_bf16_f32 v88, v160, v161
  v_cvt_pk_bf16_f32 v89, v162, v163
  v_cvt_pk_bf16_f32 v90, v164, v165
  v_cvt_pk_bf16_f32 v91, v166, v167
  v_bfi_b32 v88, s53, v104, v88
  v_bfi_b32 v89, s53, v105, v89
  v_bfi_b32 v90, s53, v106, v90
  v_bfi_b32 v91, s53, v107, v91
  ds_write_b128 v246, v[88:91]
  v_cvt_pk_bf16_f32 v92, v168, v169
  v_cvt_pk_bf16_f32 v93, v170, v171
  v_cvt_pk_bf16_f32 v94, v172, v173
  v_cvt_pk_bf16_f32 v95, v174, v175
  v_bfi_b32 v92, s53, v108, v92
  v_bfi_b32 v93, s53, v109, v93
  v_bfi_b32 v94, s53, v110, v94
  v_bfi_b32 v95, s53, v111, v95
  ds_write_b128 v247, v[92:95]
  ds_read_b128 v[112:115], v32 offset:0
  ds_read_b128 v[116:119], v32 offset:2048
  ds_read_b128 v[120:123], v32 offset:4096
  ds_read_b128 v[124:127], v32 offset:6144
  s_waitcnt lgkmcnt(3)
  buffer_store_dwordx4 v[112:115], v34, s[32:35], s87 offen offset:0 sc1
  s_waitcnt lgkmcnt(2)
  buffer_store_dwordx4 v[116:119], v34, s[32:35], s87 offen offset:1024 sc1
  s_waitcnt lgkmcnt(1)
  buffer_store_dwordx4 v[120:123], v34, s[32:35], s87 offen offset:2048 sc1
  s_waitcnt lgkmcnt(0)
  buffer_store_dwordx4 v[124:127], v34, s[32:35], s87 offen offset:3072 sc1
  s_setprio 0
  s_barrier
  s_cmp_lg_u32 s3, 7
  s_cbranch_scc1 L_nolse2
  v_or_b32 v23, 1, v23
  s_mov_b32 exec_hi, 0
  buffer_store_dwordx4 v[20:23], v248, s[32:35], s74 offen sc1
  s_mov_b32 exec_hi, -1
L_nolse2:
  s_mov_b32 s73, 0
  s_or_b32 s69, s48, 1
  buffer_load_dwordx4 v[8:11], v35, s[32:35], s70 offen offset:0 sc1
  buffer_load_dwordx4 v[12:15], v35, s[32:35], s71 offen offset:0 sc1
  buffer_load_dwordx4 v[16:19], v35, s[32:35], 0 offen offset:0 sc1
  buffer_load_dwordx4 v[20:23], v35, s[32:35], s72 offen offset:0 sc1
  s_cmp_lt_u32 s2, 128
  s_cbranch_scc1 L_prepA
  s_and_b32 s92, s3, 3
  s_mul_i32 s92, s92, 7552
  s_add_u32 s92, s92, 20480
  v_lshrrev_b32 v62, 5, v1
  v_mul_u32_u24 v62, 928, v62
  v_and_b32 v3, 31, v1
  v_lshl_add_u32 v62, v3, 4, v62
  v_add_u32 v62, s92, v62
  s_lshl_b32 s92, s3, 6
  v_lshrrev_b32 v63, 4, v1
  v_mul_u32_u24 v63, 7552, v63
  v_bfe_u32 v3, v1, 2, 2
  v_mul_u32_u24 v3, 928, v3
  v_add_u32 v63, v3, v63
  v_and_b32 v3, 3, v1
  v_lshl_add_u32 v63, v3, 3, v63
  v_add_u32 v63, 20480, v63
  v_add_u32 v63, s92, v63
  s_mul_i32 s82, s80, 28672
  s_lshl_b32 s97, s3, 12
  s_add_u32 s82, s82, s97
  s_lshl_b32 s97, s79, 8
  s_add_u32 s82, s82, s97
  s_lshr_b32 s92, s79, 1
  s_lshl_b32 s92, s92, 10
  s_and_b32 s97, s79, 1
  s_lshl_b32 s97, s97, 7
  s_add_u32 s92, s92, s97
  s_add_u32 s92, s92, 16384
  v_bfe_u32 v56, v1, 3, 1
  v_lshlrev_b32 v56, 13, v56
  v_lshrrev_b32 v3, 4, v1
  v_lshl_add_u32 v56, v3, 8, v56
  v_and_b32 v3, 7, v1
  v_lshl_add_u32 v56, v3, 4, v56
  v_add_u32 v56, s92, v56
  v_and_b32 v60, 31, v1
  v_lshlrev_b32 v60, 5, v60
  v_add_u32 v60, 90112, v60
  s_lshl_b32 s92, s3, 2
  s_add_u32 s92, s92, 90112
  v_and_b32 v59, 7, v1
  v_lshlrev_b32 v59, 7, v59
  v_lshrrev_b32 v3, 4, v1
  v_lshl_add_u32 v59, v3, 5, v59
  v_add_u32 v59, s92, v59
  s_lshl_b32 s92, s3, 7
  s_add_u32 s92, s92, 93184
  v_and_b32 v57, 31, v1
  v_lshlrev_b32 v57, 1, v57
  v_add_u32 v57, s92, v57
  s_mul_i32 s90, s79, 4224
  s_lshl_b32 s97, s3, 9
  s_add_u32 s90, s90, s97
  s_add_u32 s90, s90, 393216
  v_and_b32 v61, 31, v1
  v_lshlrev_b32 v61, 4, v61
  v_and_b32 v58, 3, v1
  v_lshlrev_b32 v58, 6, v58
  v_lshrrev_b32 v3, 4, v1
  v_lshl_add_u32 v58, v3, 4, v58
  s_lshl_b32 s92, s79, 6
  v_and_b32 v44, 31, v1
  v_lshlrev_b32 v44, 1, v44
  v_add_u32 v44, s92, v44
  global_load_ushort v66, v44, s[4:5]
  s_movk_i32 s68, 0x4000
  buffer_load_dwordx4 v[68:71], v56, s[32:35], 0 offen offset:0 sc1
  buffer_load_dwordx4 v[72:75], v56, s[32:35], s68 offen offset:0 sc1
  s_branch L_prep2
L_prepA:
  s_sub_u32 s92, s2, 56
  s_cmp_ge_u32 s2, 56
  s_cselect_b32 s81, s92, s2
  s_cselect_b32 s93, 1, 0
  s_lshl_b32 s91, s81, 15
  s_lshl_b32 s97, s3, 12
  s_add_u32 s91, s91, s97
  s_lshl_b32 s97, s93, 9
  s_add_u32 s91, s91, s97
  s_mul_i32 s75, s77, 16896
  s_lshr_b32 s97, s3, 1
  s_mul_i32 s97, s97, 4224
  s_add_u32 s75, s75, s97
  s_lshl_b32 s97, s76, 7
  s_add_u32 s75, s75, s97
  s_and_b32 s97, s3, 1
  s_lshl_b32 s97, s97, 6
  s_add_u32 s75, s75, s97
  s_add_u32 s75, s75, 393216
  s_mul_i32 s90, s93, 67584
  s_mul_i32 s97, s3, 8448
  s_add_u32 s90, s90, s97
  s_lshl_b32 s97, s81, 7
  s_add_u32 s90, s90, s97
  s_add_u32 s90, s90, 655360
  s_mul_i32 s92, s3, 2176
  s_lshr_b32 s97, s3, 1
  s_lshl_b32 s97, s97, 7
  s_add_u32 s92, s92, s97
  s_add_u32 s92, s92, 59392
  v_lshrrev_b32 v62, 5, v1
  v_mul_u32_u24 v62, 544, v62
  v_and_b32 v3, 31, v1
  v_lshl_add_u32 v62, v3, 4, v62
  v_add_u32 v62, s92, v62
  s_lshl_b32 s92, s3, 6
  v_lshrrev_b32 v63, 4, v1
  v_mul_u32_u24 v63, 4480, v63
  v_bfe_u32 v3, v1, 2, 2
  v_mul_u32_u24 v3, 544, v3
  v_add_u32 v63, v3, v63
  v_and_b32 v3, 3, v1
  v_lshl_add_u32 v63, v3, 3, v63
  v_add_u32 v63, 59392, v63
  v_add_u32 v63, s92, v63
  s_lshl_b32 s82, s81, 12
  s_lshl_b32 s97, s3, 9
  s_add_u32 s82, s82, s97
  s_add_u32 s82, s82, 851968
  s_lshl_b32 s92, s3, 7
  s_add_u32 s92, s92, 93184
  v_and_b32 v57, 7, v1
  v_lshlrev_b32 v57, 3, v57
  v_lshrrev_b32 v3, 4, v1
  v_lshl_add_u32 v57, v3, 1, v57
  v_add_u32 v57, s92, v57
  v_and_b32 v61, 31, v1
  v_lshlrev_b32 v61, 4, v61
  v_and_b32 v58, 1, v1
  v_lshlrev_b32 v58, 6, v58
  v_lshrrev_b32 v3, 4, v1
  v_lshl_add_u32 v58, v3, 4, v58
  s_mul_i32 s92, s81, 37
  s_lshr_b32 s92, s92, 8
  s_lshl_b32 s92, s92, 11
  v_and_b32 v56, 15, v1
  v_lshlrev_b32 v56, 7, v56
  v_add_u32 v56, 98304, v56
  v_add_u32 v56, s92, v56
  s_lshl_b32 s92, s3, 2
  s_add_u32 s92, s92, 83968
  v_lshlrev_b32 v59, 5, v1
  v_add_u32 v59, s92, v59
  s_bfe_u32 s92, s3, 0x10002
  s_lshl_b32 s92, s92, 10
  s_and_b32 s97, s3, 3
  s_lshl_b32 s97, s97, 2
  s_add_u32 s92, s92, s97
  s_add_u32 s92, s92, 88064
  v_lshlrev_b32 v60, 4, v1
  v_add_u32 v60, s92, v60
L_prep2:
  s_cmp_lg_u32 s101, 0
  s_cbranch_scc1 L_nsg
  s_waitcnt vmcnt(8)
  ds_write_b128 v240, v[176:179] offset:0
  ds_write_b128 v240, v[180:183] offset:1152
  ds_write_b128 v240, v[184:187] offset:2432
  ds_write_b128 v240, v[188:191] offset:3584
  s_cmp_lt_u32 s2, 128
  s_cbranch_scc1 L_sf_34a
  s_mov_b32 exec_lo, 0xfffffff
  s_mov_b32 exec_hi, 0xfffffff
  ds_write_b128 v62, v[208:211] offset:0
  ds_write_b128 v62, v[212:215] offset:448
  ds_write_b128 v62, v[216:219] offset:1856
  ds_write_b128 v62, v[220:223] offset:2304
  ds_write_b128 v62, v[224:227] offset:3712
  ds_write_b128 v62, v[228:231] offset:4160
  ds_write_b128 v62, v[232:235] offset:5568
  ds_write_b128 v62, v[236:239] offset:6016
  s_mov_b64 exec, -1
  s_branch L_sf_34x
L_sf_34a:
  ds_write_b128 v241, v[208:211] offset:0
  ds_write_b128 v241, v[212:215] offset:1152
  ds_write_b128 v241, v[216:219] offset:2432
  ds_write_b128 v241, v[220:223] offset:3584
  ds_write_b128 v241, v[224:227] offset:4864
  ds_write_b128 v241, v[228:231] offset:6016
  ds_write_b128 v241, v[232:235] offset:7296
  ds_write_b128 v241, v[236:239] offset:8448
L_sf_34x:
L_nsg:
  s_waitcnt vmcnt(0)
  s_mov_b32 s100, 0
L_p1:
  v_cmp_ne_u32 s[60:61], s69, v11
  v_cmp_ne_u32 s[62:63], s69, v15
  v_cmp_ne_u32 s[64:65], s69, v19
  v_cmp_ne_u32 s[66:67], s69, v23
  v_xor_b32 v44, s69, v11
  v_bitop3_b32 v44, v15, s69, v44 bitop3:0xbe
  v_bitop3_b32 v44, v19, s69, v44 bitop3:0xbe
  v_bitop3_b32 v44, v23, s69, v44 bitop3:0xbe
  v_cmp_lt_u32 s[92:93], 1, v44
  s_mov_b32 s94, 0
  s_cmp_eq_u64 s[92:93], 0
  s_cbranch_scc1 L_p1d
  s_add_u32 s100, s100, 1
  s_cmp_gt_u32 s100, 1000000
  s_cbranch_scc1 L_abort
  s_mov_b64 exec, s[60:61]
  s_cbranch_execz L_ll_35
  buffer_load_dwordx4 v[8:11], v35, s[32:35], s70 offen offset:0 sc1
L_ll_35:
  s_mov_b64 exec, s[62:63]
  s_cbranch_execz L_ll_36
  buffer_load_dwordx4 v[12:15], v35, s[32:35], s71 offen offset:0 sc1
L_ll_36:
  s_mov_b64 exec, s[64:65]
  s_cbranch_execz L_ll_37
  buffer_load_dwordx4 v[16:19], v35, s[32:35], 0 offen offset:0 sc1
L_ll_37:
  s_mov_b64 exec, s[66:67]
  s_cbranch_execz L_ll_38
  buffer_load_dwordx4 v[20:23], v35, s[32:35], s72 offen offset:0 sc1
L_ll_38:
  s_mov_b64 exec, -1
L_p1d:
  s_bitcmp1_b32 s73, 0
  s_cbranch_scc1 L_lp_39
  s_cmp_lg_u64 s[60:61], 0
  s_cbranch_scc1 L_lp_39
  s_bitset1_b32 s73, 0
  s_add_u32 s94, s94, 1
  buffer_load_dwordx4 v[128:131], v36, s[32:35], s83 offen offset:0 sc1
L_lp_39:
  s_bitcmp1_b32 s73, 1
  s_cbranch_scc1 L_lp_40
  s_cmp_lg_u64 s[62:63], 0
  s_cbranch_scc1 L_lp_40
  s_bitset1_b32 s73, 1
  s_add_u32 s94, s94, 1
  buffer_load_dwordx4 v[132:135], v36, s[32:35], s84 offen offset:0 sc1
L_lp_40:
  s_bitcmp1_b32 s73, 2
  s_cbranch_scc1 L_lp_41
  s_cmp_lg_u64 s[64:65], 0
  s_cbranch_scc1 L_lp_41
  s_bitset1_b32 s73, 2
  s_add_u32 s94, s94, 1
  buffer_load_dwordx4 v[136:139], v36, s[32:35], s85 offen offset:0 sc1
L_lp_41:
  s_bitcmp1_b32 s73, 3
  s_cbranch_scc1 L_lp_42
  s_cmp_lg_u64 s[66:67], 0
  s_cbranch_scc1 L_lp_42
  s_bitset1_b32 s73, 3
  s_add_u32 s94, s94, 1
  buffer_load_dwordx4 v[140:143], v36, s[32:35], s86 offen offset:0 sc1
L_lp_42:
  s_cmp_eq_u64 s[92:93], 0
  s_cbranch_scc1 L_p1x
  s_cmp_eq_u32 s94, 0
  s_cbranch_scc0 L_pw0
  s_waitcnt vmcnt(0)
  s_branch L_p1
L_pw0:
  s_cmp_eq_u32 s94, 1
  s_cbranch_scc0 L_pw1
  s_waitcnt vmcnt(1)
  s_branch L_p1
L_pw1:
  s_cmp_eq_u32 s94, 2
  s_cbranch_scc0 L_pw2
  s_waitcnt vmcnt(2)
  s_branch L_p1
L_pw2:
  s_cmp_eq_u32 s94, 3
  s_cbranch_scc0 L_pw3
  s_waitcnt vmcnt(3)
  s_branch L_p1
L_pw3:
  s_waitcnt vmcnt(4)
  s_branch L_p1
L_p1x:
  v_max3_f32 v44, v8, v12, v16
  v_max_f32 v44, v44, v20
  s_nop 1
  v_max_f32_dpp v44, v44, v44 row_ror:8 row_mask:0xf bank_mask:0xf
  v_mov_b32 v45, v44
  s_nop 1
  v_permlane16_swap_b32 v44, v45
  v_max_f32 v44, v44, v45
  v_mov_b32 v45, v44
  s_nop 1
  v_permlane32_swap_b32 v44, v45
  v_max_f32 v44, v44, v45
  s_lshl_b32 s92, s3, 2
  s_add_u32 s92, s92, 92160
  v_mov_b32 v47, s92
  v_mov_b32 v46, 92160
  ds_write_b32 v47, v44
  s_waitcnt lgkmcnt(0)
  s_barrier
  ds_read_b128 v[144:147], v46
  ds_read_b128 v[148:151], v46 offset:16
  ds_read_b64_tr_b16 v[48:49], v242 offset:0
  ds_read_b64_tr_b16 v[50:51], v242 offset:1152
  ds_read_b64_tr_b16 v[52:53], v242 offset:9728
  ds_read_b64_tr_b16 v[54:55], v242 offset:10880
  s_waitcnt lgkmcnt(4)
  v_max3_f32 v44, v144, v145, v146
  v_max3_f32 v45, v147, v148, v149
  v_max3_f32 v44, v44, v150, v151
  v_max_f32 v44, v44, v45
  v_sub_f32 v152, v8, v44
  v_sub_f32 v153, v12, v44
  v_sub_f32 v154, v16, v44
  v_sub_f32 v155, v20, v44
  v_exp_f32 v152, v152
  v_exp_f32 v153, v153
  v_exp_f32 v154, v154
  v_exp_f32 v155, v155
  v_cvt_pk_bf16_f32 v152, v152, v152
  v_cvt_pk_bf16_f32 v153, v153, v153
  v_cvt_pk_bf16_f32 v154, v154, v154
  v_cvt_pk_bf16_f32 v155, v155, v155
  v_lshrrev_b32 v156, 16, v152
  v_lshrrev_b32 v157, 16, v153
  v_lshrrev_b32 v158, 16, v154
  v_lshrrev_b32 v159, 16, v155
  v_and_b32 v152, 0xffff0000, v152
  v_and_b32 v153, 0xffff0000, v153
  v_and_b32 v154, 0xffff0000, v154
  v_and_b32 v155, 0xffff0000, v155
  v_mul_f32 v44, v152, v9
  v_fmac_f32 v44, v153, v13
  v_fmac_f32 v44, v154, v17
  v_fmac_f32 v44, v155, v21
  s_nop 1
  v_add_f32_dpp v44, v44, v44 row_ror:8 row_mask:0xf bank_mask:0xf
  v_mov_b32 v45, v44
  s_nop 1
  v_permlane16_swap_b32 v44, v45
  v_add_f32 v44, v44, v45
  v_mov_b32 v45, v44
  s_nop 1
  v_permlane32_swap_b32 v44, v45
  v_add_f32 v44, v44, v45
  ds_write_b32 v47, v44 offset:32
  s_cmp_lt_u32 s2, 128
  s_cbranch_scc1 L_fgA
  ds_read_b64_tr_b16 v[80:81], v63 offset:0
  ds_read_b64_tr_b16 v[82:83], v63 offset:3712
  ds_read_b64_tr_b16 v[84:85], v63 offset:32
  ds_read_b64_tr_b16 v[86:87], v63 offset:3744
  ds_read_b64_tr_b16 v[88:89], v63 offset:448
  ds_read_b64_tr_b16 v[90:91], v63 offset:4160
  ds_read_b64_tr_b16 v[92:93], v63 offset:480
  ds_read_b64_tr_b16 v[94:95], v63 offset:4192
  s_branch L_fgx
L_fgA:
  ds_read_b64_tr_b16 v[80:81], v243 offset:0
  ds_read_b64_tr_b16 v[82:83], v243 offset:1152
  ds_read_b64_tr_b16 v[84:85], v243 offset:9728
  ds_read_b64_tr_b16 v[86:87], v243 offset:10880
  ds_read_b64_tr_b16 v[88:89], v243 offset:19456
  ds_read_b64_tr_b16 v[90:91], v243 offset:20608
  ds_read_b64_tr_b16 v[92:93], v243 offset:29184
  ds_read_b64_tr_b16 v[94:95], v243 offset:30336
L_fgx:
  s_waitcnt lgkmcnt(0)
  s_barrier
  ds_read_b128 v[160:163], v46 offset:32
  ds_read_b128 v[164:167], v46 offset:48
  v_mov_b32 v144, 0
  v_mov_b32 v145, 0
  v_mov_b32 v146, 0
  v_mov_b32 v147, 0
  v_mov_b32 v148, 0
  v_mov_b32 v149, 0
  v_mov_b32 v150, 0
  v_mov_b32 v151, 0
  s_waitcnt lgkmcnt(0)
  v_add_f32 v160, v160, v161
  v_add_f32 v162, v162, v163
  v_add_f32 v164, v164, v165
  v_add_f32 v166, v166, v167
  v_add_f32 v160, v160, v162
  v_add_f32 v164, v164, v166
  v_add_f32 v160, v160, v164
  v_rcp_f32 v168, v160
  s_bitcmp1_b32 s73, 0
  s_cbranch_scc1 L_ir_43
  buffer_load_dwordx4 v[128:131], v36, s[32:35], s83 offen offset:0 sc1
L_ir_43:
  s_bitcmp1_b32 s73, 1
  s_cbranch_scc1 L_ir_44
  buffer_load_dwordx4 v[132:135], v36, s[32:35], s84 offen offset:0 sc1
L_ir_44:
  s_bitcmp1_b32 s73, 2
  s_cbranch_scc1 L_ir_45
  buffer_load_dwordx4 v[136:139], v36, s[32:35], s85 offen offset:0 sc1
L_ir_45:
  s_bitcmp1_b32 s73, 3
  s_cbranch_scc1 L_ir_46
  buffer_load_dwordx4 v[140:143], v36, s[32:35], s86 offen offset:0 sc1
L_ir_46:
  s_or_b32 s73, s73, 15
  s_mov_b32 s100, 0
L_p2:
  s_mov_b32 s95, s73
  s_waitcnt vmcnt(0)
  s_bitcmp1_b32 s95, 0
  s_cbranch_scc0 L_dc_47
  s_bitcmp1_b32 s95, 4
  s_cbranch_scc1 L_dc_47
  v_xor_b32 v44, v128, v4
  v_bitop3_b32 v44, v129, v5, v44 bitop3:0xbe
  v_bitop3_b32 v44, v130, v6, v44 bitop3:0xbe
  v_bitop3_b32 v44, v131, v7, v44 bitop3:0xbe
  v_and_b32 v44, s53, v44
  v_cmp_ne_u32 vcc, 0, v44
  s_nop 0
  s_cbranch_vccz L_dc_47k
  s_sleep 1
  buffer_load_dwordx4 v[128:131], v36, s[32:35], s83 offen offset:0 sc1
  s_branch L_dc_47
L_dc_47k:
  s_bitset1_b32 s73, 4
  v_dot2c_f32_bf16 v144, v156, v128
  v_dot2c_f32_bf16 v145, v152, v128
  v_dot2c_f32_bf16 v146, v156, v129
  v_dot2c_f32_bf16 v147, v152, v129
  v_dot2c_f32_bf16 v148, v156, v130
  v_dot2c_f32_bf16 v149, v152, v130
  v_dot2c_f32_bf16 v150, v156, v131
  v_dot2c_f32_bf16 v151, v152, v131
L_dc_47:
  s_bitcmp1_b32 s95, 1
  s_nop 0
  s_cbranch_scc0 L_dc_48
  s_bitcmp1_b32 s95, 5
  s_cbranch_scc1 L_dc_48
  v_xor_b32 v44, v132, v4
  v_bitop3_b32 v44, v133, v5, v44 bitop3:0xbe
  v_bitop3_b32 v44, v134, v6, v44 bitop3:0xbe
  v_bitop3_b32 v44, v135, v7, v44 bitop3:0xbe
  v_and_b32 v44, s53, v44
  v_cmp_ne_u32 vcc, 0, v44
  s_nop 0
  s_cbranch_vccz L_dc_48k
  s_sleep 1
  buffer_load_dwordx4 v[132:135], v36, s[32:35], s84 offen offset:0 sc1
  s_branch L_dc_48
L_dc_48k:
  s_bitset1_b32 s73, 5
  v_dot2c_f32_bf16 v144, v157, v132
  v_dot2c_f32_bf16 v145, v153, v132
  v_dot2c_f32_bf16 v146, v157, v133
  v_dot2c_f32_bf16 v147, v153, v133
  v_dot2c_f32_bf16 v148, v157, v134
  v_dot2c_f32_bf16 v149, v153, v134
  v_dot2c_f32_bf16 v150, v157, v135
  v_dot2c_f32_bf16 v151, v153, v135
L_dc_48:
  s_bitcmp1_b32 s95, 2
  s_nop 0
  s_cbranch_scc0 L_dc_49
  s_bitcmp1_b32 s95, 6
  s_cbranch_scc1 L_dc_49
  v_xor_b32 v44, v136, v4
  v_bitop3_b32 v44, v137, v5, v44 bitop3:0xbe
  v_bitop3_b32 v44, v138, v6, v44 bitop3:0xbe
  v_bitop3_b32 v44, v139, v7, v44 bitop3:0xbe
  v_and_b32 v44, s53, v44
  v_cmp_ne_u32 vcc, 0, v44
  s_nop 0
  s_cbranch_vccz L_dc_49k
  s_sleep 1
  buffer_load_dwordx4 v[136:139], v36, s[32:35], s85 offen offset:0 sc1
  s_branch L_dc_49
L_dc_49k:
  s_bitset1_b32 s73, 6
  v_dot2c_f32_bf16 v144, v158, v136
  v_dot2c_f32_bf16 v145, v154, v136
  v_dot2c_f32_bf16 v146, v158, v137
  v_dot2c_f32_bf16 v147, v154, v137
  v_dot2c_f32_bf16 v148, v158, v138
  v_dot2c_f32_bf16 v149, v154, v138
  v_dot2c_f32_bf16 v150, v158, v139
  v_dot2c_f32_bf16 v151, v154, v139
L_dc_49:
  s_bitcmp1_b32 s95, 3
  s_nop 0
  s_cbranch_scc0 L_dc_50
  s_bitcmp1_b32 s95, 7
  s_cbranch_scc1 L_dc_50
  v_xor_b32 v44, v140, v4
  v_bitop3_b32 v44, v141, v5, v44 bitop3:0xbe
  v_bitop3_b32 v44, v142, v6, v44 bitop3:0xbe
  v_bitop3_b32 v44, v143, v7, v44 bitop3:0xbe
  v_and_b32 v44, s53, v44
  v_cmp_ne_u32 vcc, 0, v44
  s_nop 0
  s_cbranch_vccz L_dc_50k
  s_sleep 1
  buffer_load_dwordx4 v[140:143], v36, s[32:35], s86 offen offset:0 sc1
  s_branch L_dc_50
L_dc_50k:
  s_bitset1_b32 s73, 7
  v_dot2c_f32_bf16 v144, v159, v140
  v_dot2c_f32_bf16 v145, v155, v140
  v_dot2c_f32_bf16 v146, v159, v141
  v_dot2c_f32_bf16 v147, v155, v141
  v_dot2c_f32_bf16 v148, v159, v142
  v_dot2c_f32_bf16 v149, v155, v142
  v_dot2c_f32_bf16 v150, v159, v143
  v_dot2c_f32_bf16 v151, v155, v143
L_dc_50:
  s_cmp_eq_u32 s73, 0xff
  s_nop 0
  s_cbranch_scc1 L_p2x
  s_add_u32 s100, s100, 1
  s_cmp_gt_u32 s100, 1000000
  s_cbranch_scc1 L_abort
  s_branch L_p2
L_p2x:
  v_permlane32_swap_b32 v144, v148
  v_permlane32_swap_b32 v145, v149
  v_permlane32_swap_b32 v146, v150
  v_permlane32_swap_b32 v147, v151
  v_add_f32 v144, v144, v148
  v_add_f32 v145, v145, v149
  v_add_f32 v146, v146, v150
  v_add_f32 v147, v147, v151
  s_nop 0
  v_permlane16_swap_b32 v144, v146
  v_permlane16_swap_b32 v145, v147
  v_add_f32 v144, v144, v146
  v_add_f32 v145, v145, v147
  s_nop 0
  v_add_f32_dpp v144, v144, v144 row_ror:8 row_mask:0xf bank_mask:0xf
  v_add_f32_dpp v145, v145, v145 row_ror:8 row_mask:0xf bank_mask:0xf
  v_mul_f32 v144, v144, v168
  v_mul_f32 v145, v145, v168
  v_cvt_pk_bf16_f32 v44, v144, v145
  ds_write_b32 v37, v44
  s_waitcnt lgkmcnt(0)
  s_barrier
  ds_read_b128 v[160:163], v38
  ds_read_b128 v[164:167], v38 offset:64
  s_waitcnt lgkmcnt(1)
  v_mfma_f32_16x16x32_bf16 v[144:147], v[48:51], v[160:163], 0
  s_waitcnt lgkmcnt(0)
  v_mfma_f32_16x16x32_bf16 v[144:147], v[52:55], v[164:167], v[144:147]
  s_nop 7
  v_add_f32_dpp v144, v144, v144 quad_perm:[1,0,3,2] row_mask:0xf bank_mask:0xf
  v_add_f32_dpp v145, v145, v145 quad_perm:[1,0,3,2] row_mask:0xf bank_mask:0xf
  v_add_f32_dpp v146, v146, v146 quad_perm:[1,0,3,2] row_mask:0xf bank_mask:0xf
  v_add_f32_dpp v147, v147, v147 quad_perm:[1,0,3,2] row_mask:0xf bank_mask:0xf
  v_add_f32_dpp v144, v144, v144 quad_perm:[2,3,0,1] row_mask:0xf bank_mask:0xf
  v_add_f32_dpp v145, v145, v145 quad_perm:[2,3,0,1] row_mask:0xf bank_mask:0xf
  v_add_f32_dpp v146, v146, v146 quad_perm:[2,3,0,1] row_mask:0xf bank_mask:0xf
  v_add_f32_dpp v147, v147, v147 quad_perm:[2,3,0,1] row_mask:0xf bank_mask:0xf
  v_add_f32_dpp v144, v144, v144 row_half_mirror row_mask:0xf bank_mask:0xf
  v_add_f32_dpp v145, v145, v145 row_half_mirror row_mask:0xf bank_mask:0xf
  v_add_f32_dpp v146, v146, v146 row_half_mirror row_mask:0xf bank_mask:0xf
  v_add_f32_dpp v147, v147, v147 row_half_mirror row_mask:0xf bank_mask:0xf
  s_mov_b32 exec_lo, 0x10001
  s_mov_b32 exec_hi, 0x10001
  v_and_or_b32 v144, v144, v2, s49
  v_and_or_b32 v145, v145, v2, s50
  v_and_or_b32 v146, v146, v2, s51
  v_and_or_b32 v147, v147, v2, s52
  buffer_store_dwordx4 v[144:147], v1, s[32:35], s16 offen sc1
  s_mov_b64 exec, -1
  s_cmp_lt_u32 s2, 128
  s_cbranch_scc0 L_X
  s_mov_b32 s60, 0xffffffff
  s_mov_b32 s61, 0x0
  s_mov_b32 s100, 0
  s_branch L_gf_52
L_g_51:
  s_add_u32 s100, s100, 1
  s_cmp_gt_u32 s100, 1000000
  s_cbranch_scc1 L_abort
  s_sleep 1
L_gf_52:
  s_mov_b64 exec, s[60:61]
  buffer_load_dwordx4 v[128:131], v39, s[32:35], 0 offen offset:0 sc1
  s_waitcnt vmcnt(0)
L_gc_53:
  s_mov_b64 exec, s[60:61]
  v_perm_b32 v44, v129, v128, s56
  v_perm_b32 v44, v130, v44, s57
  v_perm_b32 v44, v131, v44, s58
  v_cmp_ne_u32 s[60:61], s48, v44
  s_nop 0
  s_cmp_lg_u64 s[60:61], 0
  s_cbranch_scc1 L_g_51
  s_mov_b64 exec, -1
  v_cvt_pk_bf16_f32 v44, v128, v129
  v_cvt_pk_bf16_f32 v45, v130, v131
  s_mov_b32 exec_hi, 0
  ds_write_b64 v43, v[44:45]
  s_mov_b32 exec_hi, -1
  s_waitcnt lgkmcnt(0)
  s_barrier
  ds_read_b128 v[128:131], v40 offset:0
  ds_read_b128 v[132:135], v40 offset:64
  ds_read_b128 v[136:139], v40 offset:128
  ds_read_b128 v[140:143], v40 offset:192
  s_waitcnt lgkmcnt(3)
  v_mfma_f32_16x16x32_bf16 v[144:147], v[80:83], v[128:131], 0
  s_waitcnt lgkmcnt(2)
  v_mfma_f32_16x16x32_bf16 v[144:147], v[84:87], v[132:135], v[144:147]
  s_waitcnt lgkmcnt(1)
  v_mfma_f32_16x16x32_bf16 v[144:147], v[88:91], v[136:139], v[144:147]
  s_waitcnt lgkmcnt(0)
  v_mfma_f32_16x16x32_bf16 v[144:147], v[92:95], v[140:143], v[144:147]
  s_nop 7
  v_add_f32_dpp v144, v144, v144 quad_perm:[1,0,3,2] row_mask:0xf bank_mask:0xf
  v_add_f32_dpp v145, v145, v145 quad_perm:[1,0,3,2] row_mask:0xf bank_mask:0xf
  v_add_f32_dpp v146, v146, v146 quad_perm:[1,0,3,2] row_mask:0xf bank_mask:0xf
  v_add_f32_dpp v147, v147, v147 quad_perm:[1,0,3,2] row_mask:0xf bank_mask:0xf
  v_add_f32_dpp v144, v144, v144 quad_perm:[2,3,0,1] row_mask:0xf bank_mask:0xf
  v_add_f32_dpp v145, v145, v145 quad_perm:[2,3,0,1] row_mask:0xf bank_mask:0xf
  v_add_f32_dpp v146, v146, v146 quad_perm:[2,3,0,1] row_mask:0xf bank_mask:0xf
  v_add_f32_dpp v147, v147, v147 quad_perm:[2,3,0,1] row_mask:0xf bank_mask:0xf
  v_add_f32_dpp v144, v144, v144 row_half_mirror row_mask:0xf bank_mask:0xf
  v_add_f32_dpp v145, v145, v145 row_half_mirror row_mask:0xf bank_mask:0xf
  v_add_f32_dpp v146, v146, v146 row_half_mirror row_mask:0xf bank_mask:0xf
  v_add_f32_dpp v147, v147, v147 row_half_mirror row_mask:0xf bank_mask:0xf
  s_mov_b32 exec_lo, 0x10001
  s_mov_b32 exec_hi, 0x10001
  v_and_or_b32 v144, v144, v2, s49
  v_and_or_b32 v145, v145, v2, s50
  v_and_or_b32 v146, v146, v2, s51
  v_and_or_b32 v147, v147, v2, s52
  buffer_store_dwordx4 v[144:147], v1, s[32:35], s75 offen sc1
  s_mov_b64 exec, -1
  s_branch L_Y
L_X:
  s_mov_b64 s[60:61], -1
  s_waitcnt vmcnt(63)
  s_mov_b32 s100, 0
  s_branch L_gc_58
L_g_56:
  s_add_u32 s100, s100, 1
  s_cmp_gt_u32 s100, 1000000
  s_cbranch_scc1 L_abort
  s_sleep 2
L_gf_57:
  s_mov_b64 exec, s[60:61]
  buffer_load_dwordx4 v[68:71], v56, s[32:35], 0 offen offset:0 sc1
  buffer_load_dwordx4 v[72:75], v56, s[32:35], s68 offen offset:0 sc1
  s_waitcnt vmcnt(0)
L_gc_58:
  s_mov_b64 exec, s[60:61]
  v_perm_b32 v44, v69, v68, s56
  v_perm_b32 v44, v70, v44, s57
  v_perm_b32 v44, v71, v44, s58
  v_cmp_ne_u32 s[60:61], s48, v44
  v_perm_b32 v44, v73, v72, s56
  v_perm_b32 v44, v74, v44, s57
  v_perm_b32 v44, v75, v44, s58
  v_cmp_ne_u32 vcc, s48, v44
  s_nop 0
  s_or_b64 s[60:61], s[60:61], vcc
  s_cmp_lg_u64 s[60:61], 0
  s_cbranch_scc1 L_g_56
  s_mov_b64 exec, -1
  v_permlane32_swap_b32 v68, v70
  v_permlane32_swap_b32 v69, v71
  v_add_f32 v68, v68, v70
  v_add_f32 v69, v69, v71
  s_nop 1
  v_permlane16_swap_b32 v68, v69
  v_add_f32 v68, v68, v69
  v_permlane32_swap_b32 v72, v74
  v_permlane32_swap_b32 v73, v75
  v_add_f32 v72, v72, v74
  v_add_f32 v73, v73, v75
  s_nop 1
  v_permlane16_swap_b32 v72, v73
  v_add_f32 v72, v72, v73
  v_cvt_pk_bf16_f32 v44, v68, v68
  v_and_b32 v68, 0xffff0000, v44
  v_cvt_pk_bf16_f32 v45, v72, v72
  v_and_b32 v72, 0xffff0000, v45
  v_and_b32 v44, 3, v1
  v_lshlrev_b32 v44, 6, v44
  v_bfe_u32 v3, v1, 2, 3
  v_lshl_add_u32 v44, v3, 2, v44
  ds_bpermute_b32 v76, v44, v68 offset:0
  ds_bpermute_b32 v77, v44, v68 offset:32
  ds_bpermute_b32 v78, v44, v72 offset:0
  ds_bpermute_b32 v79, v44, v72 offset:32
  s_lshr_b32 s92, s82, 12
  s_lshl_b32 s92, s92, 12
  s_add_u32 s94, s82, s92
  s_add_u32 s94, s94, 1114112
  s_add_u32 s82, s82, 851968
  v_bfe_u32 v45, v1, 2, 1
  v_lshlrev_b32 v45, 6, v45
  v_add_u32 v45, v45, v41
  v_bfe_u32 v69, v1, 2, 1
  v_lshlrev_b32 v69, 12, v69
  v_and_b32 v3, 3, v1
  v_lshl_add_u32 v69, v3, 6, v69
  v_lshrrev_b32 v3, 4, v1
  v_lshl_add_u32 v69, v3, 4, v69
  s_waitcnt lgkmcnt(0)
  v_add_f32 v78, 1.0, v78
  v_lshlrev_b32 v66, 16, v66
  v_cvt_pk_bf16_f32 v44, v78, v78
  v_and_b32 v78, 0xffff0000, v44
  s_cmp_eq_u32 s3, 7
  s_cbranch_scc1 L_ab_55
  ds_write_b16_d16_hi v57, v78
  ds_write_b16_d16_hi v57, v77 offset:64
  ds_read_b128 v[72:75], v45
  s_waitcnt lgkmcnt(0)
  v_mfma_f32_16x16x32_bf16 v[208:211], v[80:83], v[72:75], 0
  v_mfma_f32_16x16x32_bf16 v[212:215], v[84:87], v[72:75], 0
  v_mfma_f32_16x16x32_bf16 v[216:219], v[88:91], v[72:75], 0
  v_mfma_f32_16x16x32_bf16 v[220:223], v[92:95], v[72:75], 0
  s_mov_b32 exec_lo, 0x220022
  s_mov_b32 exec_hi, 0x220022
  s_nop 3
  v_mov_b32 v208, v212
  v_mov_b32 v209, v213
  v_mov_b32 v210, v214
  v_mov_b32 v211, v215
  s_mov_b32 exec_lo, 0x440044
  s_mov_b32 exec_hi, 0x440044
  v_mov_b32 v208, v216
  v_mov_b32 v209, v217
  v_mov_b32 v210, v218
  v_mov_b32 v211, v219
  s_mov_b32 exec_lo, 0x880088
  s_mov_b32 exec_hi, 0x880088
  v_mov_b32 v208, v220
  v_mov_b32 v209, v221
  v_mov_b32 v210, v222
  v_mov_b32 v211, v223
  s_mov_b32 exec_lo, 0xff00ff
  s_mov_b32 exec_hi, 0xff00ff
  v_and_or_b32 v208, v208, v2, s49
  v_and_or_b32 v209, v209, v2, s50
  v_and_or_b32 v210, v210, v2, s51
  v_and_or_b32 v211, v211, v2, s52
  buffer_store_dwordx4 v[208:211], v69, s[32:35], s94 offen sc1
  s_mov_b64 exec, -1
L_ab_55:
  v_mov_b32 v112, 0
  v_mov_b32 v113, 0
  v_mov_b32 v114, 0
  v_mov_b32 v115, 0
  s_mov_b32 s60, 0xffffffff
  s_mov_b32 s61, 0x0
  s_mov_b32 s100, 0
  s_branch L_gf_61
L_g_60:
  s_add_u32 s100, s100, 1
  s_cmp_gt_u32 s100, 1000000
  s_cbranch_scc1 L_abort
  s_sleep 1
L_gf_61:
  s_mov_b64 exec, s[60:61]
  buffer_load_dwordx4 v[112:115], v61, s[32:35], s90 offen offset:0 sc1
  s_waitcnt vmcnt(0)
L_gc_62:
  s_mov_b64 exec, s[60:61]
  v_perm_b32 v44, v113, v112, s56
  v_perm_b32 v44, v114, v44, s57
  v_perm_b32 v44, v115, v44, s58
  v_cmp_ne_u32 s[60:61], s48, v44
  s_nop 0
  s_cmp_lg_u64 s[60:61], 0
  s_cbranch_scc1 L_g_60
  s_mov_b64 exec, -1
  v_permlane32_swap_b32 v112, v114
  v_permlane32_swap_b32 v113, v115
  v_add_f32 v112, v112, v114
  v_add_f32 v113, v113, v115
  s_nop 1
  v_permlane16_swap_b32 v112, v113
  v_add_f32 v112, v112, v113
  s_nop 1
  v_add_f32_dpp v112, v112, v112 row_ror:8 row_mask:0xf bank_mask:0xf
  ds_write_b32 v59, v112
  s_waitcnt lgkmcnt(0)
  s_barrier
  ds_read_b128 v[112:115], v60
  ds_read_b128 v[116:119], v60 offset:16
  s_waitcnt lgkmcnt(0)
  v_add_f32 v112, v112, v113
  v_add_f32 v114, v114, v115
  v_add_f32 v116, v116, v117
  v_add_f32 v118, v118, v119
  v_add_f32 v112, v112, v114
  v_add_f32 v116, v116, v118
  v_add_f32 v112, v112, v116
  v_cvt_pk_bf16_f32 v44, v112, v112
  v_and_b32 v112, 0xffff0000, v44
  v_mul_f32 v67, v76, v112
  v_cvt_pk_bf16_f32 v44, v67, v67
  v_and_b32 v67, 0xffff0000, v44
  v_add_f32 v67, v66, v67
  v_cvt_pk_bf16_f32 v44, v67, v67
  v_and_b32 v67, 0xffff0000, v44
  s_cmp_eq_u32 s3, 7
  s_cbranch_scc1 L_stat
  v_mul_f32 v44, v67, v78
  v_cvt_pk_bf16_f32 v44, v44, v44
  ds_write_b16 v57, v44
  ds_read_b128 v[160:163], v41
  s_waitcnt lgkmcnt(0)
  v_mfma_f32_16x16x32_bf16 v[128:131], v[80:83], v[160:163], 0
  v_mfma_f32_16x16x32_bf16 v[132:135], v[84:87], v[160:163], 0
  v_mfma_f32_16x16x32_bf16 v[136:139], v[88:91], v[160:163], 0
  v_mfma_f32_16x16x32_bf16 v[140:143], v[92:95], v[160:163], 0
  s_mov_b32 exec_lo, 0x20002
  s_mov_b32 exec_hi, 0x20002
  s_nop 3
  v_mov_b32 v128, v132
  v_mov_b32 v129, v133
  v_mov_b32 v130, v134
  v_mov_b32 v131, v135
  s_mov_b32 exec_lo, 0x40004
  s_mov_b32 exec_hi, 0x40004
  v_mov_b32 v128, v136
  v_mov_b32 v129, v137
  v_mov_b32 v130, v138
  v_mov_b32 v131, v139
  s_mov_b32 exec_lo, 0x80008
  s_mov_b32 exec_hi, 0x80008
  v_mov_b32 v128, v140
  v_mov_b32 v129, v141
  v_mov_b32 v130, v142
  v_mov_b32 v131, v143
  s_mov_b32 exec_lo, 0xf000f
  s_mov_b32 exec_hi, 0xf000f
  v_and_or_b32 v128, v128, v2, s49
  v_and_or_b32 v129, v129, v2, s50
  v_and_or_b32 v130, v130, v2, s51
  v_and_or_b32 v131, v131, v2, s52
  buffer_store_dwordx4 v[128:131], v58, s[32:35], s82 offen sc1
  s_mov_b64 exec, -1
  s_branch L_xdone
L_stat:
  v_mov_b32 v130, v67
  v_mul_f32 v131, v67, v67
  s_nop 0
  v_add_f32_dpp v130, v130, v130 row_ror:8 row_mask:0xf bank_mask:0xf
  v_add_f32_dpp v131, v131, v131 row_ror:8 row_mask:0xf bank_mask:0xf
  s_nop 0
  v_add_f32_dpp v130, v130, v130 row_ror:4 row_mask:0xf bank_mask:0xf
  v_add_f32_dpp v131, v131, v131 row_ror:4 row_mask:0xf bank_mask:0xf
  s_nop 0
  v_add_f32_dpp v130, v130, v130 row_ror:2 row_mask:0xf bank_mask:0xf
  v_add_f32_dpp v131, v131, v131 row_ror:2 row_mask:0xf bank_mask:0xf
  s_nop 0
  v_add_f32_dpp v130, v130, v130 row_ror:1 row_mask:0xf bank_mask:0xf
  v_add_f32_dpp v131, v131, v131 row_ror:1 row_mask:0xf bank_mask:0xf
  v_mov_b32 v128, v130
  v_mov_b32 v129, v131
  s_nop 0
  v_permlane16_swap_b32 v130, v128
  v_permlane16_swap_b32 v131, v129
  v_add_f32 v130, v130, v128
  v_add_f32 v131, v131, v129
  v_and_b32 v128, v2, v130
  v_and_b32 v129, v2, v131
  v_sub_f32 v130, v130, v128
  v_sub_f32 v131, v131, v129
  v_and_or_b32 v128, v128, v2, s49
  v_and_or_b32 v129, v129, v2, s50
  v_and_or_b32 v130, v130, v2, s51
  v_and_or_b32 v131, v131, v2, s52
  s_lshl_b32 s92, s80, 11
  s_lshl_b32 s97, s79, 7
  s_add_u32 s92, s92, s97
  s_add_u32 s92, s92, 98304
  s_mov_b64 exec, 1
  buffer_store_dwordx4 v[128:131], v1, s[32:35], s92 offen sc1
  s_mov_b64 exec, -1
  v_mov_b32 v112, 0
L_xdone:
  s_cmp_lg_u32 s80, 0
  s_cbranch_scc1 L_fin
  s_mul_i32 s90, s79, 8448
  s_lshl_b32 s97, s3, 10
  s_add_u32 s90, s90, s97
  s_add_u32 s90, s90, 655360
  s_lshl_b32 s92, s79, 6
  v_and_b32 v46, 31, v1
  v_lshlrev_b32 v46, 1, v46
  v_add_u32 v46, s92, v46
  s_cmp_eq_u32 s3, 7
  s_cbranch_scc1 L_nof
  s_mov_b64 s[60:61], -1
  s_mov_b32 s100, 0
  s_branch L_gf_65
L_g_64:
  s_add_u32 s100, s100, 1
  s_cmp_gt_u32 s100, 1000000
  s_cbranch_scc1 L_abort
  s_sleep 1
L_gf_65:
  s_mov_b64 exec, s[60:61]
  buffer_load_dwordx4 v[112:115], v34, s[32:35], s90 offen offset:0 sc1
  s_waitcnt vmcnt(0)
L_gc_66:
  s_mov_b64 exec, s[60:61]
  v_perm_b32 v44, v113, v112, s56
  v_perm_b32 v44, v114, v44, s57
  v_perm_b32 v44, v115, v44, s58
  v_cmp_ne_u32 s[60:61], s48, v44
  s_nop 0
  s_cmp_lg_u64 s[60:61], 0
  s_cbranch_scc1 L_g_64
  s_mov_b64 exec, -1
  v_permlane32_swap_b32 v112, v114
  v_permlane32_swap_b32 v113, v115
  v_add_f32 v112, v112, v114
  v_add_f32 v113, v113, v115
  s_nop 1
  v_permlane16_swap_b32 v112, v113
  v_add_f32 v112, v112, v113
  s_nop 1
  v_add_f32_dpp v112, v112, v112 row_ror:8 row_mask:0xf bank_mask:0xf
L_nof:
  ds_write_b32 v59, v112 offset:1024
  s_waitcnt lgkmcnt(0)
  s_barrier
  s_cmp_lg_u32 s3, 0
  s_cbranch_scc1 L_fin
  ds_read_b128 v[112:115], v60 offset:1024
  ds_read_b128 v[116:119], v60 offset:1040
  s_waitcnt lgkmcnt(0)
  v_add_f32 v112, v112, v113
  v_add_f32 v114, v114, v115
  v_add_f32 v116, v116, v117
  v_add_f32 v118, v118, v119
  v_add_f32 v112, v112, v114
  v_add_f32 v116, v116, v118
  v_add_f32 v112, v112, v116
  v_cvt_pk_bf16_f32 v45, v112, v112
  v_and_b32 v112, 0xffff0000, v45
  v_mul_f32 v44, v79, v112
  v_cvt_pk_bf16_f32 v45, v44, v44
  v_and_b32 v44, 0xffff0000, v45
  v_add_f32 v44, v67, v44
  v_cvt_pk_bf16_f32 v44, v44, v44
  s_mov_b32 exec_hi, 0
  global_store_short v46, v44, s[28:29]
  s_cmp_lg_u32 s2, 128
  s_cbranch_scc1 L_noep
  s_mov_b64 exec, 1
  v_mov_b32 v45, 0
  global_store_dword v45, v45, s[30:31]
L_noep:
L_fin:
  s_endpgm
L_Y:
  s_cmp_ge_u32 s2, 112
  s_cbranch_scc1 L_fin
  s_lshl_b32 s94, s81, 13
  s_lshl_b32 s97, s3, 10
  s_add_u32 s94, s94, s97
  s_add_u32 s94, s94, 1114112
  buffer_load_dwordx4 v[76:79], v34, s[32:35], s94 offen offset:0 sc1
  s_mov_b64 s[40:41], s[22:23]
  s_mov_b32 s42, 0x1c0000
  s_mov_b32 s43, 0x20000
  v_lshrrev_b32 v44, 5, v1
  v_lshlrev_b32 v44, 10, v44
  v_and_b32 v3, 31, v1
  v_lshl_add_u32 v44, v3, 4, v44
  buffer_load_dwordx4 v[176:179], v44, s[40:43], s91 offen offset:0 nt
  buffer_load_dwordx4 v[180:183], v44, s[40:43], s91 offen offset:2048 nt
  v_mov_b32 v112, 0
  v_mov_b32 v113, 0
  v_mov_b32 v114, 0
  v_mov_b32 v115, 0
  v_lshlrev_b32 v46, 4, v1
  v_add_u32 v46, 88064, v46
  v_lshlrev_b32 v47, 5, v1
  v_add_u32 v47, 83968, v47
  s_mov_b64 s[60:61], -1
  s_waitcnt vmcnt(2)
  s_mov_b32 s100, 0
  s_branch L_gc_70
L_g_68:
  s_add_u32 s100, s100, 1
  s_cmp_gt_u32 s100, 1000000
  s_cbranch_scc1 L_abort
  s_sleep 2
L_gf_69:
  s_mov_b64 exec, s[60:61]
  buffer_load_dwordx4 v[76:79], v34, s[32:35], s94 offen offset:0 sc1
  s_waitcnt vmcnt(0)
L_gc_70:
  s_mov_b64 exec, s[60:61]
  v_perm_b32 v44, v77, v76, s56
  v_perm_b32 v44, v78, v44, s57
  v_perm_b32 v44, v79, v44, s58
  v_cmp_ne_u32 s[60:61], s48, v44
  s_nop 0
  s_cmp_lg_u64 s[60:61], 0
  s_cbranch_scc1 L_g_68
  s_mov_b64 exec, -1
  v_permlane32_swap_b32 v76, v78
  v_permlane32_swap_b32 v77, v79
  v_add_f32 v76, v76, v78
  v_add_f32 v77, v77, v79
  s_nop 1
  v_permlane16_swap_b32 v76, v77
  v_add_f32 v76, v76, v77
  s_waitcnt vmcnt(0)
  ds_write_b128 v62, v[176:179] offset:0
  ds_write_b128 v62, v[180:183] offset:1088
  ds_write_b32 v60, v76
  s_waitcnt lgkmcnt(0)
  s_barrier
  ds_read_b128 v[128:131], v46
  ds_read_b128 v[132:135], v46 offset:1024
  ds_read_b64_tr_b16 v[68:69], v63 offset:0
  ds_read_b64_tr_b16 v[70:71], v63 offset:2176
  ds_read_b64_tr_b16 v[72:73], v63 offset:32
  ds_read_b64_tr_b16 v[74:75], v63 offset:2208
  s_waitcnt lgkmcnt(4)
  v_add_f32 v128, v128, v129
  v_add_f32 v130, v130, v131
  v_add_f32 v128, v128, v130
  v_add_f32 v132, v132, v133
  v_add_f32 v134, v134, v135
  v_add_f32 v132, v132, v134
  s_mov_b32 s60, 0xffffffff
  s_mov_b32 s61, 0x0
  s_mov_b32 s62, 0xffff
  s_mov_b32 s63, 0x0
  s_mov_b32 s100, 0
  s_branch L_gf_73
L_g_72:
  s_add_u32 s100, s100, 1
  s_cmp_gt_u32 s100, 1000000
  s_cbranch_scc1 L_abort
  s_sleep 1
L_gf_73:
  s_mov_b64 exec, s[60:61]
  s_cbranch_execz L_gs_75
  buffer_load_dwordx4 v[112:115], v61, s[32:35], s82 offen offset:0 sc1
L_gs_75:
  s_mov_b64 exec, s[62:63]
  s_cbranch_execz L_gs_76
  buffer_load_dwordx4 v[136:139], v56, s[32:35], 0 offen offset:0 sc1
L_gs_76:
  s_waitcnt vmcnt(0)
L_gc_74:
  s_mov_b64 exec, s[60:61]
  v_perm_b32 v44, v113, v112, s56
  v_perm_b32 v44, v114, v44, s57
  v_perm_b32 v44, v115, v44, s58
  v_cmp_ne_u32 s[60:61], s48, v44
  s_mov_b64 exec, s[62:63]
  v_perm_b32 v44, v137, v136, s56
  v_perm_b32 v44, v138, v44, s57
  v_perm_b32 v44, v139, v44, s58
  v_cmp_ne_u32 s[62:63], s48, v44
  s_nop 0
  s_or_b64 s[96:97], s[60:61], s[62:63]
  s_cbranch_scc1 L_g_72
  s_mov_b64 exec, -1
  v_permlane32_swap_b32 v112, v114
  v_permlane32_swap_b32 v113, v115
  v_add_f32 v112, v112, v114
  v_add_f32 v113, v113, v115
  s_nop 1
  v_permlane16_swap_b32 v112, v113
  v_add_f32 v112, v112, v113
  ds_write_b32 v59, v112
  v_add_f32 v136, v136, v138
  v_add_f32 v137, v137, v139
  s_nop 0
  v_add_f32_dpp v136, v136, v136 quad_perm:[1,0,3,2] row_mask:0xf bank_mask:0xf
  v_add_f32_dpp v137, v137, v137 quad_perm:[1,0,3,2] row_mask:0xf bank_mask:0xf
  s_nop 0
  v_add_f32_dpp v136, v136, v136 quad_perm:[2,3,0,1] row_mask:0xf bank_mask:0xf
  v_add_f32_dpp v137, v137, v137 quad_perm:[2,3,0,1] row_mask:0xf bank_mask:0xf
  s_nop 0
  v_add_f32_dpp v136, v136, v136 row_half_mirror row_mask:0xf bank_mask:0xf
  v_add_f32_dpp v137, v137, v137 row_half_mirror row_mask:0xf bank_mask:0xf
  s_nop 0
  v_add_f32_dpp v136, v136, v136 row_ror:8 row_mask:0xf bank_mask:0xf
  v_add_f32_dpp v137, v137, v137 row_ror:8 row_mask:0xf bank_mask:0xf
  s_waitcnt lgkmcnt(0)
  s_barrier
  ds_read_b128 v[112:115], v47
  ds_read_b128 v[116:119], v47 offset:16
  v_readfirstlane_b32 s92, v136
  v_readfirstlane_b32 s93, v137
  v_mov_b32 v44, 0x3b000000
  v_mul_f32 v136, s92, v44
  v_mul_f32 v137, s93, v44
  v_fma_f32 v137, -v136, v136, v137
  v_max_f32 v137, 0, v137
  v_cvt_pk_bf16_f32 v45, v137, v137
  v_and_b32 v137, 0xffff0000, v45
  v_cvt_pk_bf16_f32 v44, v136, v136
  v_and_b32 v136, 0xffff0000, v44
  v_add_f32 v137, 0x3727c5ac, v137
  v_mul_f32 v128, v136, v128
  v_cvt_pk_bf16_f32 v45, v137, v137
  v_and_b32 v137, 0xffff0000, v45
  v_sqrt_f32 v137, v137
  s_nop 0
  v_cvt_pk_bf16_f32 v45, v137, v137
  v_and_b32 v137, 0xffff0000, v45
  v_rcp_f32 v137, v137
  s_waitcnt lgkmcnt(0)
  v_add_f32 v112, v112, v113
  v_add_f32 v114, v114, v115
  v_add_f32 v116, v116, v117
  v_add_f32 v118, v118, v119
  v_add_f32 v112, v112, v114
  v_add_f32 v116, v116, v118
  v_add_f32 v112, v112, v116
  v_sub_f32 v112, v112, v128
  v_fma_f32 v112, v112, v137, v132
  v_cvt_pk_bf16_f32 v44, v112, v112
  v_and_b32 v112, 0xffff0000, v44
  v_mul_f32 v44, v112, v112
  v_mov_b32 v45, 0xc0135761
  v_mov_b32_dpp v113, v112 row_ror:8 row_mask:0xf bank_mask:0xf
  v_fmac_f32 v45, 0xbdd2d3e8, v44
  v_mul_f32 v44, v45, v112
  v_exp_f32 v44, v44
  s_nop 0
  v_add_f32 v44, 1.0, v44
  v_rcp_f32 v44, v44
  s_nop 0
  v_mul_f32 v112, v112, v44
  v_cvt_pk_bf16_f32 v44, v112, v112
  v_and_b32 v112, 0xffff0000, v44
  v_mul_f32 v112, v112, v113
  v_cvt_pk_bf16_f32 v44, v112, v112
  s_mov_b32 exec_lo, 0xff00ff
  s_mov_b32 exec_hi, 0xff00ff
  ds_write_b16 v57, v44
  s_mov_b64 exec, -1
  ds_read_b128 v[160:163], v41
  s_waitcnt lgkmcnt(0)
  v_mfma_f32_16x16x32_bf16 v[144:147], v[68:71], v[160:163], 0
  v_mfma_f32_16x16x32_bf16 v[148:151], v[72:75], v[160:163], 0
  s_mov_b32 exec_lo, 0x20002
  s_mov_b32 exec_hi, 0x20002
  s_nop 5
  v_mov_b32 v144, v148
  v_mov_b32 v145, v149
  v_mov_b32 v146, v150
  v_mov_b32 v147, v151
  s_mov_b32 exec_lo, 0x30003
  s_mov_b32 exec_hi, 0x30003
  v_and_or_b32 v144, v144, v2, s49
  v_and_or_b32 v145, v145, v2, s50
  v_and_or_b32 v146, v146, v2, s51
  v_and_or_b32 v147, v147, v2, s52
  buffer_store_dwordx4 v[144:147], v58, s[32:35], s90 offen sc1
  s_endpgm
L_abort:
  s_endpgm
L_end:
  s_endpgm
L_codeend:
.section .rodata,"a"
.p2align 6
.amdhsa_kernel adaLN_cond__compressed_kv_cla__glu_gated_geglu__decode_kernel
  .amdhsa_next_free_vgpr 256
  .amdhsa_next_free_sgpr 102
  .amdhsa_accum_offset 256
  .amdhsa_group_segment_fixed_size 0
  .amdhsa_kernarg_size 120
  .amdhsa_user_sgpr_count 2
  .amdhsa_user_sgpr_kernarg_segment_ptr 1
  .amdhsa_system_sgpr_workgroup_id_x 1
.end_amdhsa_kernel
```

```asm
; @launch grid=(256,1,1) block=(512,1,1) lds=163840
.amdgcn_target "amdgcn-amd-amdhsa--gfx950"
.text
.globl adaLN_cond__compressed_kv_cla__glu_gated_geglu__decode_kernel
.p2align 8
.type adaLN_cond__compressed_kv_cla__glu_gated_geglu__decode_kernel,@function
adaLN_cond__compressed_kv_cla__glu_gated_geglu__decode_kernel:
  s_cmp_ge_u32 s2, 256
  s_cbranch_scc1 L_end
  s_load_dwordx16 s[4:19], s[0:1], 0
  s_load_dwordx8 s[20:27], s[0:1], 64
  s_load_dwordx4 s[28:31], s[0:1], 96
  s_load_dwordx2 s[32:33], s[0:1], 112
  v_lshrrev_b32 v1, 6, v0
  s_mov_b32 s34, 0x10000000
  s_mov_b32 s35, 0x20000
  v_readfirstlane_b32 s3, v1
  v_and_b32 v1, 63, v0
  v_mov_b32 v8, 0
  v_mov_b32 v20, 0
  v_mov_b32 v251, 0
  v_mov_b32 v253, 0
  s_cmp_lt_u32 s2, 128
  s_cbranch_scc0 L_B
  v_lshlrev_b32 v38, 4, v1
  s_bfe_u32 s82, s2, 0x30003
  s_lshl_b32 s82, s82, 19
  s_lshl_b32 s97, s3, 16
  s_add_u32 s82, s82, s97
  s_and_b32 s97, s2, 7
  s_lshl_b32 s97, s97, 10
  s_add_u32 s82, s82, s97
  s_mov_b32 s42, 0x400000
  s_mov_b32 s43, 0x20000
  s_bitcmp1_b32 s2, 6
  s_cbranch_scc1 L_K
  v_and_b32 v8, 15, v1
  v_lshlrev_b32 v8, 3, v8
  v_lshrrev_b32 v3, 4, v1
  v_lshl_add_u32 v8, v3, 1, v8
  s_bfe_u32 s92, s2, 0x30003
  s_lshl_b32 s92, s92, 7
  v_add_u32 v17, s92, v8
  s_mul_i32 s83, s3, 8576
  s_lshl_b32 s92, s2, 17
  v_mov_b32 v18, s92
  v_mov_b32 v19, 0xf000
  s_waitcnt lgkmcnt(0)
  s_mov_b64 s[40:41], s[8:9]
  global_load_dwordx4 v[12:15], v38, s[4:5]
  global_load_ushort v16, v17, s[4:5]
  s_add_u32 m0, s83, 0
  s_add_u32 s92, s82, 0
  buffer_load_dwordx4 v38, s[40:43], s92 offen nt lds
  s_add_u32 m0, s83, 1056
  s_add_u32 s92, s82, 8192
  buffer_load_dwordx4 v38, s[40:43], s92 offen nt lds
  s_add_u32 m0, s83, 2112
  s_add_u32 s92, s82, 16384
  buffer_load_dwordx4 v38, s[40:43], s92 offen nt lds
  s_add_u32 m0, s83, 3168
  s_add_u32 s92, s82, 24576
  buffer_load_dwordx4 v38, s[40:43], s92 offen nt lds
  s_add_u32 m0, s83, 4224
  s_add_u32 s92, s82, 32768
  buffer_load_dwordx4 v38, s[40:43], s92 offen nt lds
  s_add_u32 m0, s83, 5280
  s_add_u32 s92, s82, 40960
  buffer_load_dwordx4 v38, s[40:43], s92 offen nt lds
  s_add_u32 m0, s83, 6336
  s_add_u32 s92, s82, 49152
  buffer_load_dwordx4 v38, s[40:43], s92 offen nt lds
  s_add_u32 m0, s83, 7392
  s_add_u32 s92, s82, 57344
  buffer_load_dwordx4 v38, s[40:43], s92 offen nt lds
  s_cmp_lg_u32 s3, 7
  s_cbranch_scc1 L_nt_1
  s_mov_b64 exec, 1
  global_load_dword v20, v18, s[6:7] nt
  global_load_dword v21, v19, s[32:33]
  global_load_dword v22, v38, s[30:31] offset:128
  s_mov_b64 exec, -1
L_nt_1:
  s_branch L_Q2
L_K:
  s_bfe_u32 s81, s2, 0x10004
  s_xor_b32 s81, s81, 1
  s_lshl_b32 s81, s81, 16
  s_and_b32 s92, s3, 1
  s_lshl_b32 s92, s92, 7
  v_xor_b32 v39, s92, v38
  s_lshl_b32 s83, s3, 13
  s_add_u32 s83, s83, s81
  v_mov_b32 v19, 0xf000
  s_waitcnt lgkmcnt(0)
  s_mov_b64 s[40:41], s[10:11]
  s_mov_b64 exec, 1
  global_load_dword v21, v19, s[32:33]
  s_mov_b64 exec, -1
  v_xor_b32 v40, 0, v39
  s_add_u32 m0, s83, 0
  s_add_u32 s92, s82, 0
  buffer_load_dwordx4 v40, s[40:43], s92 offen nt lds
  v_xor_b32 v41, 16, v39
  s_add_u32 m0, s83, 1024
  s_add_u32 s92, s82, 8192
  buffer_load_dwordx4 v41, s[40:43], s92 offen nt lds
  v_xor_b32 v40, 32, v39
  s_add_u32 m0, s83, 2048
  s_add_u32 s92, s82, 16384
  buffer_load_dwordx4 v40, s[40:43], s92 offen nt lds
  v_xor_b32 v41, 48, v39
  s_add_u32 m0, s83, 3072
  s_add_u32 s92, s82, 24576
  buffer_load_dwordx4 v41, s[40:43], s92 offen nt lds
  v_xor_b32 v40, 64, v39
  s_add_u32 m0, s83, 4096
  s_add_u32 s92, s82, 32768
  buffer_load_dwordx4 v40, s[40:43], s92 offen nt lds
  v_xor_b32 v41, 80, v39
  s_add_u32 m0, s83, 5120
  s_add_u32 s92, s82, 40960
  buffer_load_dwordx4 v41, s[40:43], s92 offen nt lds
  v_xor_b32 v40, 96, v39
  s_add_u32 m0, s83, 6144
  s_add_u32 s92, s82, 49152
  buffer_load_dwordx4 v40, s[40:43], s92 offen nt lds
  v_xor_b32 v41, 112, v39
  s_add_u32 m0, s83, 7168
  s_add_u32 s92, s82, 57344
  buffer_load_dwordx4 v41, s[40:43], s92 offen nt lds
  s_branch L_K2
L_B:
  s_cmp_ge_u32 s3, 4
  s_cbranch_scc0 L_Bfront
  v_lshrrev_b32 v10, 3, v1
  v_mul_u32_u24 v5, 24576, v10
  v_lshlrev_b32 v10, 3, v10
  v_and_b32 v11, 7, v1
  v_lshl_add_u32 v5, v11, 4, v5
  s_bfe_u32 s94, s2, 0x20004
  s_and_b32 s95, s2, 15
  s_lshl_b32 s92, s94, 2
  s_add_u32 s92, s92, s3
  s_sub_u32 s92, s92, 4
  s_lshl_b32 s93, s92, 6
  v_add_u32 v10, s93, v10
  s_mul_i32 s92, s92, 196608
  s_lshl_b32 s93, s95, 7
  s_add_u32 s92, s92, s93
  s_mov_b32 s42, 0x300000
  s_mov_b32 s43, 0x20000
  v_mov_b32 v253, 0
  s_waitcnt lgkmcnt(0)
  s_mov_b64 s[40:41], s[26:27]
  s_bitcmp1_b32 s2, 6
  s_cbranch_scc1 L_nou0
  global_load_dwordx2 v[112:113], v10, s[24:25]
  buffer_load_dwordx4 v[124:127], v5, s[40:43], s92 offen nt
  s_add_u32 s92, s92, 6144
  buffer_load_dwordx4 v[128:131], v5, s[40:43], s92 offen nt
  s_add_u32 s92, s92, 6144
  buffer_load_dwordx4 v[132:135], v5, s[40:43], s92 offen nt
  s_add_u32 s92, s92, 6144
  buffer_load_dwordx4 v[136:139], v5, s[40:43], s92 offen nt
L_nou0:
  s_branch L_Bback2
L_Bfront:
  s_memrealtime s[62:63]
  s_bfe_u32 s64, s2, 0x40003
  s_xor_b32 s64, s64, 8
  s_or_b32 s64, s64, s3
  s_cbranch_scc1 L_nononce
  v_mov_b32 v18, 0
  v_mov_b32 v21, 0
  s_waitcnt lgkmcnt(0)
  s_or_b32 s62, s62, 1
  v_mov_b32 v20, s62
  s_mov_b64 exec, 1
  global_atomic_cmpswap v18, v[20:21], s[30:31] sc1
  s_mov_b64 exec, -1
L_nononce:
  v_lshrrev_b32 v245, 4, v1
  v_and_b32 v246, 15, v1
  v_lshlrev_b32 v247, 2, v245
  v_xor_b32 v246, v246, v247
  v_lshlrev_b32 v246, 4, v246
  v_lshl_add_u32 v244, v245, 10, v246
  v_xor_b32 v245, 16, v244
  v_xor_b32 v246, 32, v244
  v_xor_b32 v247, 48, v244
  v_add_u32 v245, 3072, v245
  v_add_u32 v246, 6144, v246
  v_add_u32 v247, 9216, v247
  s_and_b32 s91, s3, 3
  s_lshl_b32 s90, s91, 15
  s_lshl_b32 s91, s91, 13
  s_lshl_b32 s92, s2, 17
  s_add_u32 s90, s90, s92
  s_bfe_u32 s93, s2, 0x20003
  s_lshl_b32 s92, s93, 15
  s_add_u32 s91, s91, s92
  s_lshl_b32 s92, s93, 8
  s_add_u32 s90, s90, s92
  s_getpc_b64 s[94:95]
L_pc:
  s_sub_u32 s94, s94, L_pc-adaLN_cond__compressed_kv_cla__glu_gated_geglu__decode_kernel
  s_subb_u32 s95, s95, 0
  s_bfe_u32 s92, s2, 0x40003
  s_lshl_b32 s92, s92, 2
  s_add_u32 s92, s92, s3
  s_lshl_b32 s92, s92, 10
  v_lshlrev_b32 v11, 4, v1
  v_add_u32 v11, s92, v11
  s_mov_b32 s38, 0x2000000
  s_mov_b32 s39, 0x20000
  s_cmp_ge_u32 s92, L_codeend-adaLN_cond__compressed_kv_cla__glu_gated_geglu__decode_kernel
  s_cbranch_scc1 L_nopf
  v_min_u32 v11, L_codeend-adaLN_cond__compressed_kv_cla__glu_gated_geglu__decode_kernel-16, v11
  global_load_dwordx4 v[12:15], v11, s[94:95]
L_nopf:
  s_waitcnt lgkmcnt(0)
  s_mov_b64 s[36:37], s[6:7]
  s_barrier
  s_barrier
  s_mov_b32 s54, 0x05040100
  s_mov_b32 s55, 0x07060302
  s_mov_b32 s56, 0x0c0c0400
  s_mov_b32 s57, 0x0c040100
  s_mov_b32 s58, 0x04020100
  s_mov_b32 s53, 0x10001
  v_mov_b32 v2, 0xffffff00
  s_lshr_b32 s77, s2, 5
  s_and_b32 s78, s2, 127
  s_and_b32 s76, s2, 7
  s_lshl_b32 s76, s76, 2
  s_bfe_u32 s97, s2, 0x20003
  s_add_u32 s76, s76, s97
  s_and_b32 s79, s2, 7
  s_lshl_b32 s79, s79, 1
  s_bfe_u32 s97, s2, 0x10003
  s_add_u32 s79, s79, s97
  s_bfe_u32 s80, s2, 0x30004
  s_bfe_u32 s17, s2, 0x20003
  s_bfe_u32 s59, s2, 0x10004
  s_lshl_b32 s59, s59, 14
  s_xor_b32 m0, s91, 0
  s_xor_b32 s101, s90, 0
  buffer_load_dwordx4 v244, s[36:39], s101 offen offset:0 nt lds
  s_waitcnt vmcnt(0)
  buffer_load_dwordx4 v245, s[36:39], s101 offen offset:1024 nt lds
  s_waitcnt vmcnt(0)
  buffer_load_dwordx4 v246, s[36:39], s101 offen offset:2048 nt lds
  s_waitcnt vmcnt(2)
  buffer_load_dwordx4 v247, s[36:39], s101 offen offset:3072 nt lds
  s_waitcnt vmcnt(2)
  s_xor_b32 m0, s91, 32768
  s_xor_b32 s101, s90, 256
  buffer_load_dwordx4 v244, s[36:39], s101 offen offset:0 nt lds
  s_waitcnt vmcnt(2)
  buffer_load_dwordx4 v245, s[36:39], s101 offen offset:1024 nt lds
  s_waitcnt vmcnt(2)
  buffer_load_dwordx4 v246, s[36:39], s101 offen offset:2048 nt lds
  s_waitcnt vmcnt(2)
  buffer_load_dwordx4 v247, s[36:39], s101 offen offset:3072 nt lds
  s_waitcnt vmcnt(2)
  s_xor_b32 m0, s91, 65536
  s_xor_b32 s101, s90, 512
  buffer_load_dwordx4 v244, s[36:39], s101 offen offset:0 nt lds
  buffer_load_dwordx4 v245, s[36:39], s101 offen offset:1024 nt lds
  buffer_load_dwordx4 v246, s[36:39], s101 offen offset:2048 nt lds
  buffer_load_dwordx4 v247, s[36:39], s101 offen offset:3072 nt lds
  v_mov_b32 v253, 0
  global_load_dword v252, v253, s[30:31] sc1
  s_xor_b32 m0, s91, 98304
  s_xor_b32 s101, s90, 768
  buffer_load_dwordx4 v244, s[36:39], s101 offen offset:0 nt lds
  buffer_load_dwordx4 v245, s[36:39], s101 offen offset:1024 nt lds
  buffer_load_dwordx4 v246, s[36:39], s101 offen offset:2048 nt lds
  buffer_load_dwordx4 v247, s[36:39], s101 offen offset:3072 nt lds
  s_barrier
  s_branch L_front
L_Q2:
  s_mov_b32 s54, 0x05040100
  s_mov_b32 s55, 0x07060302
  s_mov_b32 s56, 0x0c0c0400
  s_mov_b32 s57, 0x0c040100
  s_mov_b32 s58, 0x04020100
  s_mov_b32 s53, 0x10001
  v_mov_b32 v2, 0xffffff00
  s_lshr_b32 s77, s2, 5
  s_and_b32 s78, s2, 127
  s_and_b32 s76, s2, 7
  s_lshl_b32 s76, s76, 2
  s_bfe_u32 s97, s2, 0x20003
  s_add_u32 s76, s76, s97
  s_and_b32 s79, s2, 7
  s_lshl_b32 s79, s79, 1
  s_bfe_u32 s97, s2, 0x10003
  s_add_u32 s79, s79, s97
  s_bfe_u32 s80, s2, 0x30004
  s_bfe_u32 s17, s2, 0x20003
  s_bfe_u32 s59, s2, 0x10004
  s_lshl_b32 s59, s59, 14
  v_lshrrev_b32 v245, 4, v1
  v_and_b32 v246, 15, v1
  v_lshlrev_b32 v247, 2, v245
  v_xor_b32 v246, v246, v247
  v_lshlrev_b32 v246, 4, v246
  v_lshl_add_u32 v244, v245, 10, v246
  v_xor_b32 v245, 16, v244
  v_xor_b32 v246, 32, v244
  v_xor_b32 v247, 48, v244
  v_add_u32 v245, 3072, v245
  v_add_u32 v246, 6144, v246
  v_add_u32 v247, 9216, v247
  s_and_b32 s91, s3, 3
  s_lshl_b32 s90, s91, 15
  s_lshl_b32 s91, s91, 13
  s_lshl_b32 s92, s2, 17
  s_add_u32 s90, s90, s92
  s_bfe_u32 s93, s2, 0x20003
  s_lshl_b32 s92, s93, 15
  s_add_u32 s91, s91, s92
  s_lshl_b32 s92, s93, 8
  s_add_u32 s90, s90, s92
  s_mov_b64 s[36:37], s[6:7]
  s_mov_b32 s38, 0x2000000
  s_mov_b32 s39, 0x20000
  s_bfe_u32 s82, s2, 0x30003
  s_lshl_b32 s82, s82, 10
  s_add_u32 s83, s82, 8192
  s_lshl_b32 s92, s3, 7
  s_add_u32 s92, s92, 0x20000
  v_add_u32 v40, s92, v8
  v_lshrrev_b32 v41, 4, v1
  v_lshlrev_b32 v41, 4, v41
  v_add_u32 v41, s92, v41
  s_lshl_b32 s92, s3, 7
  v_lshrrev_b32 v44, 4, v1
  v_mul_u32_u24 v44, 8576, v44
  v_bfe_u32 v3, v1, 2, 2
  v_mul_u32_u24 v3, 1056, v3
  v_add_u32 v44, v3, v44
  v_and_b32 v3, 3, v1
  v_lshl_add_u32 v44, v3, 3, v44
  v_add_u32 v44, s92, v44
  v_and_b32 v39, 1, v1
  v_lshlrev_b32 v39, 6, v39
  v_bfe_u32 v3, v1, 4, 1
  v_lshl_add_u32 v39, v3, 5, v39
  v_lshrrev_b32 v3, 5, v1
  v_lshl_add_u32 v39, v3, 4, v39
  s_and_b32 s85, s2, 7
  s_lshl_b32 s85, s85, 13
  s_bfe_u32 s97, s2, 0x30003
  s_lshl_b32 s97, s97, 10
  s_add_u32 s85, s85, s97
  s_lshl_b32 s97, s3, 7
  s_add_u32 s85, s85, s97
  s_add_u32 s85, s85, 0x80000
  s_mov_b32 s74, 0x20002
  s_mov_b32 s75, 0x20002
  s_waitcnt vmcnt(8)
  v_lshlrev_b32 v92, 16, v12
  v_and_b32 v93, 0xffff0000, v12
  v_lshlrev_b32 v94, 16, v13
  v_and_b32 v95, 0xffff0000, v13
  v_lshlrev_b32 v96, 16, v14
  v_and_b32 v97, 0xffff0000, v14
  v_lshlrev_b32 v98, 16, v15
  v_and_b32 v99, 0xffff0000, v15
  v_add_f32 v100, v92, v93
  v_add_f32 v100, v100, v94
  v_add_f32 v100, v100, v95
  v_add_f32 v100, v100, v96
  v_add_f32 v100, v100, v97
  v_add_f32 v100, v100, v98
  v_add_f32 v100, v100, v99
  s_nop 1
  v_add_f32_dpp v100, v100, v100 row_ror:8 row_mask:0xf bank_mask:0xf
  s_nop 1
  v_add_f32_dpp v100, v100, v100 row_ror:4 row_mask:0xf bank_mask:0xf
  s_nop 1
  v_add_f32_dpp v100, v100, v100 row_ror:2 row_mask:0xf bank_mask:0xf
  s_nop 1
  v_add_f32_dpp v100, v100, v100 row_ror:1 row_mask:0xf bank_mask:0xf
  v_mov_b32 v101, v100
  s_nop 1
  v_permlane16_swap_b32 v100, v101
  v_add_f32 v100, v100, v101
  v_mov_b32 v101, v100
  s_nop 1
  v_permlane32_swap_b32 v100, v101
  v_add_f32 v100, v100, v101
  v_mul_f32 v100, 0x3b000000, v100
  v_sub_f32 v92, v92, v100
  v_sub_f32 v93, v93, v100
  v_sub_f32 v94, v94, v100
  v_sub_f32 v95, v95, v100
  v_sub_f32 v96, v96, v100
  v_sub_f32 v97, v97, v100
  v_sub_f32 v98, v98, v100
  v_sub_f32 v99, v99, v100
  v_mul_f32 v102, v92, v92
  v_fmac_f32 v102, v93, v93
  v_fmac_f32 v102, v94, v94
  v_fmac_f32 v102, v95, v95
  v_fmac_f32 v102, v96, v96
  v_fmac_f32 v102, v97, v97
  v_fmac_f32 v102, v98, v98
  v_fmac_f32 v102, v99, v99
  s_nop 1
  v_add_f32_dpp v102, v102, v102 row_ror:8 row_mask:0xf bank_mask:0xf
  s_nop 1
  v_add_f32_dpp v102, v102, v102 row_ror:4 row_mask:0xf bank_mask:0xf
  s_nop 1
  v_add_f32_dpp v102, v102, v102 row_ror:2 row_mask:0xf bank_mask:0xf
  s_nop 1
  v_add_f32_dpp v102, v102, v102 row_ror:1 row_mask:0xf bank_mask:0xf
  v_mov_b32 v101, v102
  s_nop 1
  v_permlane16_swap_b32 v102, v101
  v_add_f32 v102, v102, v101
  v_mov_b32 v101, v102
  s_nop 1
  v_permlane32_swap_b32 v102, v101
  v_add_f32 v102, v102, v101
  v_mov_b32 v253, 0
  global_load_dword v252, v253, s[30:31] sc1
  v_mul_f32 v102, 0x3b000000, v102
  v_cvt_pk_bf16_f32 v101, v100, v100
  v_and_b32 v100, 0xffff0000, v101
  v_cvt_pk_bf16_f32 v101, v102, v102
  v_and_b32 v102, 0xffff0000, v101
  v_add_f32 v102, 0x3727c5ac, v102
  v_cvt_pk_bf16_f32 v101, v102, v102
  v_and_b32 v102, 0xffff0000, v101
  v_sqrt_f32 v102, v102
  s_nop 0
  v_cvt_pk_bf16_f32 v101, v102, v102
  v_and_b32 v102, 0xffff0000, v101
  v_rcp_f32 v102, v102
  v_lshlrev_b32 v103, 16, v16
  v_sub_f32 v103, v103, v100
  v_cvt_pk_bf16_f32 v101, v103, v103
  v_and_b32 v103, 0xffff0000, v101
  v_mul_f32 v103, v103, v102
  v_cvt_pk_bf16_f32 v101, v103, v103
  v_and_b32 v103, 0xffff0000, v101
  s_mov_b32 s100, 0
  s_waitcnt vmcnt(0)
  s_branch L_epc_3
L_ep_2:
  global_load_dword v252, v253, s[30:31] sc1
  s_add_u32 s100, s100, 1
  s_cmp_gt_u32 s100, 1000000
  s_cbranch_scc1 L_abort
  s_waitcnt vmcnt(0)
L_epc_3:
  v_readfirstlane_b32 s48, v252
  s_nop 0
  s_cmp_eq_u32 s48, 0
  s_nop 1
  s_cbranch_scc1 L_ep_2
  s_mul_i32 s48, s48, 0x9e3779b1
  s_and_b32 s49, s48, 0xff
  s_bfe_u32 s50, s48, 0x80008
  s_bfe_u32 s51, s48, 0x80010
  s_lshr_b32 s52, s48, 24
  s_lshr_b32 s97, s48, 15
  s_xor_b32 s97, s97, s48
  s_mul_i32 s97, s97, 0x85ebca6b
  v_mov_b32 v4, s48
  v_mov_b32 v5, s97
  v_mov_b32 v249, s48
  v_mov_b32 v250, s97
  v_and_b32 v6, 4, v1
  v_cmp_eq_u32 vcc, 0, v6
  v_and_b32 v7, 3, v1
  v_lshlrev_b32 v7, 2, v7
  v_cndmask_b32 v4, v5, v4, vcc
  v_lshrrev_b32 v4, v7, v4
  v_lshrrev_b32 v5, 1, v4
  v_lshrrev_b32 v6, 2, v4
  v_lshrrev_b32 v7, 3, v4
  v_bfe_u32 v28, v1, 4, 1
  v_lshlrev_b32 v28, 3, v28
  v_lshrrev_b32 v3, 5, v1
  v_lshl_add_u32 v28, v3, 2, v28
  v_mov_b32 v68, s48
  v_mov_b32 v69, s97
  v_cndmask_b32 v68, v68, v69, s[74:75]
  v_lshrrev_b32 v68, v28, v68
  v_lshrrev_b32 v69, 1, v68
  v_lshrrev_b32 v70, 2, v68
  v_lshrrev_b32 v71, 3, v68
  s_barrier
  buffer_load_dwordx4 v[20:23], v38, s[32:35], s82 offen offset:0 sc1
  buffer_load_dwordx4 v[24:27], v38, s[32:35], s83 offen offset:0 sc1
  ds_read_b64_tr_b16 v[112:113], v44 offset:0
  ds_read_b64_tr_b16 v[114:115], v44 offset:4224
  ds_read_b64_tr_b16 v[116:117], v44 offset:34304
  ds_read_b64_tr_b16 v[118:119], v44 offset:38528
  ds_read_b64_tr_b16 v[120:121], v44 offset:32
  ds_read_b64_tr_b16 v[122:123], v44 offset:4256
  ds_read_b64_tr_b16 v[124:125], v44 offset:34336
  ds_read_b64_tr_b16 v[126:127], v44 offset:38560
  ds_read_b64_tr_b16 v[128:129], v44 offset:64
  ds_read_b64_tr_b16 v[130:131], v44 offset:4288
  ds_read_b64_tr_b16 v[132:133], v44 offset:34368
  ds_read_b64_tr_b16 v[134:135], v44 offset:38592
  s_waitcnt lgkmcnt(4)
  ds_read_b64_tr_b16 v[136:137], v44 offset:96
  ds_read_b64_tr_b16 v[138:139], v44 offset:4320
  ds_read_b64_tr_b16 v[140:141], v44 offset:34400
  ds_read_b64_tr_b16 v[142:143], v44 offset:38624
  s_waitcnt lgkmcnt(0)
  s_barrier
  s_mov_b64 s[60:61], -1
  s_waitcnt vmcnt(0)
  s_mov_b32 s100, 0
  s_branch L_gc_6
L_g_4:
  s_add_u32 s100, s100, 1
  s_cmp_gt_u32 s100, 1000000
  s_cbranch_scc1 L_abort
  s_sleep 2
L_gf_5:
  s_mov_b64 exec, s[60:61]
  buffer_load_dwordx4 v[20:23], v38, s[32:35], s82 offen offset:0 sc1
  buffer_load_dwordx4 v[24:27], v38, s[32:35], s83 offen offset:0 sc1
  s_waitcnt vmcnt(0)
L_gc_6:
  s_mov_b64 exec, s[60:61]
  v_perm_b32 v92, v21, v20, s56
  v_perm_b32 v92, v22, v92, s57
  v_perm_b32 v92, v23, v92, s58
  v_cmp_ne_u32 s[60:61], s48, v92
  v_perm_b32 v92, v25, v24, s56
  v_perm_b32 v92, v26, v92, s57
  v_perm_b32 v92, v27, v92, s58
  v_cmp_ne_u32 vcc, s48, v92
  s_nop 0
  s_or_b64 s[60:61], s[60:61], vcc
  s_cmp_lg_u64 s[60:61], 0
  s_cbranch_scc1 L_g_4
  s_mov_b64 exec, -1
  v_permlane32_swap_b32 v20, v22
  v_permlane32_swap_b32 v21, v23
  v_permlane32_swap_b32 v24, v26
  v_permlane32_swap_b32 v25, v27
  v_add_f32 v20, v20, v22
  v_add_f32 v21, v21, v23
  v_add_f32 v24, v24, v26
  v_add_f32 v25, v25, v27
  v_permlane16_swap_b32 v20, v21
  s_nop 0
  v_permlane16_swap_b32 v24, v25
  v_add_f32 v20, v20, v21
  v_add_f32 v24, v24, v25
  v_cvt_pk_bf16_f32 v25, v24, v24
  v_and_b32 v24, 0xffff0000, v25
  v_cvt_pk_bf16_f32 v21, v20, v20
  v_and_b32 v20, 0xffff0000, v21
  v_add_f32 v24, 1.0, v24
  v_cvt_pk_bf16_f32 v25, v24, v24
  v_and_b32 v24, 0xffff0000, v25
  v_mul_f32 v24, v103, v24
  v_cvt_pk_bf16_f32 v25, v24, v24
  v_and_b32 v24, 0xffff0000, v25
  v_add_f32 v24, v24, v20
  v_cvt_pk_bf16_f32 v24, v24, v24
  ds_write_b16 v40, v24
  ds_read_b128 v[28:31], v41
  ds_read_b128 v[32:35], v41 offset:64
  s_waitcnt lgkmcnt(1)
  v_mfma_f32_16x16x32_bf16 v[80:83], v[112:115], v[28:31], 0
  v_mfma_f32_16x16x32_bf16 v[84:87], v[120:123], v[28:31], 0
  v_mfma_f32_16x16x32_bf16 v[88:91], v[128:131], v[28:31], 0
  v_mfma_f32_16x16x32_bf16 v[92:95], v[136:139], v[28:31], 0
  s_waitcnt lgkmcnt(0)
  v_mfma_f32_16x16x32_bf16 v[80:83], v[116:119], v[32:35], v[80:83]
  v_mfma_f32_16x16x32_bf16 v[84:87], v[124:127], v[32:35], v[84:87]
  v_mfma_f32_16x16x32_bf16 v[88:91], v[132:135], v[32:35], v[88:91]
  v_mfma_f32_16x16x32_bf16 v[92:95], v[140:143], v[32:35], v[92:95]
  s_nop 4
  v_cvt_pk_bf16_f32 v20, v80, v81
  v_cvt_pk_bf16_f32 v21, v82, v83
  v_cvt_pk_bf16_f32 v22, v84, v85
  v_cvt_pk_bf16_f32 v23, v86, v87
  v_cvt_pk_bf16_f32 v24, v88, v89
  v_cvt_pk_bf16_f32 v25, v90, v91
  v_cvt_pk_bf16_f32 v26, v92, v93
  v_cvt_pk_bf16_f32 v27, v94, v95
  v_permlane16_swap_b32 v20, v22
  v_permlane16_swap_b32 v21, v23
  v_permlane16_swap_b32 v24, v26
  v_permlane16_swap_b32 v25, v27
  v_cndmask_b32 v20, v20, v24, s[74:75]
  v_cndmask_b32 v21, v21, v25, s[74:75]
  v_cndmask_b32 v22, v22, v26, s[74:75]
  v_cndmask_b32 v23, v23, v27, s[74:75]
  v_bfi_b32 v20, s53, v68, v20
  v_bfi_b32 v21, s53, v69, v21
  v_bfi_b32 v22, s53, v70, v22
  v_bfi_b32 v23, s53, v71, v23
  s_mov_b32 exec_lo, 0x30003
  s_mov_b32 exec_hi, 0x30003
  buffer_store_dwordx4 v[20:23], v39, s[32:35], s85 offen sc1
  s_mov_b64 exec, -1
  s_barrier
  s_lshr_b32 s92, s3, 2
  s_lshl_b32 s93, s92, 12
  s_xor_b32 s93, s93, 0
  s_xor_b32 m0, s91, s93
  s_lshl_b32 s93, s92, 14
  s_xor_b32 s93, s93, 0
  s_xor_b32 s101, s90, s93
  buffer_load_dwordx4 v244, s[36:39], s101 offen offset:0 nt lds
  buffer_load_dwordx4 v245, s[36:39], s101 offen offset:1024 nt lds
  buffer_load_dwordx4 v246, s[36:39], s101 offen offset:2048 nt lds
  buffer_load_dwordx4 v247, s[36:39], s101 offen offset:3072 nt lds
  s_lshr_b32 s92, s3, 2
  s_lshl_b32 s93, s92, 12
  s_xor_b32 s93, s93, 32768
  s_xor_b32 m0, s91, s93
  s_lshl_b32 s93, s92, 14
  s_xor_b32 s93, s93, 256
  s_xor_b32 s101, s90, s93
  buffer_load_dwordx4 v244, s[36:39], s101 offen offset:0 nt lds
  buffer_load_dwordx4 v245, s[36:39], s101 offen offset:1024 nt lds
  buffer_load_dwordx4 v246, s[36:39], s101 offen offset:2048 nt lds
  buffer_load_dwordx4 v247, s[36:39], s101 offen offset:3072 nt lds
  s_lshr_b32 s92, s3, 2
  s_lshl_b32 s93, s92, 12
  s_xor_b32 s93, s93, 65536
  s_xor_b32 m0, s91, s93
  s_lshl_b32 s93, s92, 14
  s_xor_b32 s93, s93, 512
  s_xor_b32 s101, s90, s93
  buffer_load_dwordx4 v244, s[36:39], s101 offen offset:0 nt lds
  buffer_load_dwordx4 v245, s[36:39], s101 offen offset:1024 nt lds
  buffer_load_dwordx4 v246, s[36:39], s101 offen offset:2048 nt lds
  buffer_load_dwordx4 v247, s[36:39], s101 offen offset:3072 nt lds
  s_lshr_b32 s92, s3, 2
  s_lshl_b32 s93, s92, 12
  s_xor_b32 s93, s93, 98304
  s_xor_b32 m0, s91, s93
  s_lshl_b32 s93, s92, 14
  s_xor_b32 s93, s93, 768
  s_xor_b32 s101, s90, s93
  buffer_load_dwordx4 v244, s[36:39], s101 offen offset:0 nt lds
  buffer_load_dwordx4 v245, s[36:39], s101 offen offset:1024 nt lds
  buffer_load_dwordx4 v246, s[36:39], s101 offen offset:2048 nt lds
  buffer_load_dwordx4 v247, s[36:39], s101 offen offset:3072 nt lds
  s_cmp_ge_u32 s3, 4
  s_cbranch_scc1 L_back
  s_barrier
  s_branch L_setup
L_K2:
  s_mov_b32 s54, 0x05040100
  s_mov_b32 s55, 0x07060302
  s_mov_b32 s56, 0x0c0c0400
  s_mov_b32 s57, 0x0c040100
  s_mov_b32 s58, 0x04020100
  s_mov_b32 s53, 0x10001
  v_mov_b32 v2, 0xffffff00
  s_lshr_b32 s77, s2, 5
  s_and_b32 s78, s2, 127
  s_and_b32 s76, s2, 7
  s_lshl_b32 s76, s76, 2
  s_bfe_u32 s97, s2, 0x20003
  s_add_u32 s76, s76, s97
  s_and_b32 s79, s2, 7
  s_lshl_b32 s79, s79, 1
  s_bfe_u32 s97, s2, 0x10003
  s_add_u32 s79, s79, s97
  s_bfe_u32 s80, s2, 0x30004
  s_bfe_u32 s17, s2, 0x20003
  s_bfe_u32 s59, s2, 0x10004
  s_lshl_b32 s59, s59, 14
  v_lshrrev_b32 v245, 4, v1
  v_and_b32 v246, 15, v1
  v_lshlrev_b32 v247, 2, v245
  v_xor_b32 v246, v246, v247
  v_lshlrev_b32 v246, 4, v246
  v_lshl_add_u32 v244, v245, 10, v246
  v_xor_b32 v245, 16, v244
  v_xor_b32 v246, 32, v244
  v_xor_b32 v247, 48, v244
  v_add_u32 v245, 3072, v245
  v_add_u32 v246, 6144, v246
  v_add_u32 v247, 9216, v247
  s_and_b32 s91, s3, 3
  s_lshl_b32 s90, s91, 15
  s_lshl_b32 s91, s91, 13
  s_lshl_b32 s92, s2, 17
  s_add_u32 s90, s90, s92
  s_bfe_u32 s93, s2, 0x20003
  s_lshl_b32 s92, s93, 15
  s_add_u32 s91, s91, s92
  s_lshl_b32 s92, s93, 8
  s_add_u32 s90, s90, s92
  s_mov_b64 s[36:37], s[6:7]
  s_mov_b32 s38, 0x2000000
  s_mov_b32 s39, 0x20000
  s_barrier
  s_lshr_b32 s92, s3, 2
  s_lshl_b32 s93, s92, 12
  s_xor_b32 s93, s93, 0
  s_xor_b32 m0, s91, s93
  s_lshl_b32 s93, s92, 14
  s_xor_b32 s93, s93, 0
  s_xor_b32 s101, s90, s93
  buffer_load_dwordx4 v244, s[36:39], s101 offen offset:0 nt lds
  buffer_load_dwordx4 v245, s[36:39], s101 offen offset:1024 nt lds
  buffer_load_dwordx4 v246, s[36:39], s101 offen offset:2048 nt lds
  buffer_load_dwordx4 v247, s[36:39], s101 offen offset:3072 nt lds
  s_lshr_b32 s92, s3, 2
  s_lshl_b32 s93, s92, 12
  s_xor_b32 s93, s93, 32768
  s_xor_b32 m0, s91, s93
  s_lshl_b32 s93, s92, 14
  s_xor_b32 s93, s93, 256
  s_xor_b32 s101, s90, s93
  buffer_load_dwordx4 v244, s[36:39], s101 offen offset:0 nt lds
  buffer_load_dwordx4 v245, s[36:39], s101 offen offset:1024 nt lds
  buffer_load_dwordx4 v246, s[36:39], s101 offen offset:2048 nt lds
  buffer_load_dwordx4 v247, s[36:39], s101 offen offset:3072 nt lds
  s_and_b32 s92, s3, 1
  s_lshl_b32 s92, s92, 15
  s_lshr_b32 s97, s3, 1
  s_lshl_b32 s97, s97, 8
  s_add_u32 s92, s92, s97
  s_add_u32 s92, s92, s81
  v_and_b32 v45, 15, v1
  v_mul_u32_u24 v45, 1040, v45
  v_add_u32 v45, s92, v45
  v_lshrrev_b32 v34, 4, v1
  v_lshlrev_b32 v34, 4, v34
  v_xor_b32 v45, v45, v34
  v_lshrrev_b32 v37, 3, v1
  v_lshlrev_b32 v37, 10, v37
  v_and_b32 v3, 7, v1
  v_lshl_add_u32 v37, v3, 4, v37
  s_and_b32 s83, s2, 7
  s_lshl_b32 s83, s83, 13
  s_lshl_b32 s97, s3, 7
  s_add_u32 s83, s83, s97
  s_add_u32 s83, s83, 0x80000
  s_lshl_b32 s92, s3, 7
  s_add_u32 s92, s92, 0x21000
  v_and_b32 v47, 7, v1
  v_lshlrev_b32 v47, 4, v47
  v_lshrrev_b32 v3, 4, v1
  v_lshl_add_u32 v47, v3, 2, v47
  v_add_u32 v47, s92, v47
  s_lshr_b32 s92, s3, 1
  s_lshl_b32 s92, s92, 8
  s_add_u32 s92, s92, 0x21000
  v_lshrrev_b32 v35, 4, v1
  v_lshlrev_b32 v35, 4, v35
  v_add_u32 v35, s92, v35
  v_mov_b32 v50, 0x3f80
  v_mov_b32 v51, 0x3f800000
  v_bfe_u32 v39, v1, 4, 1
  v_lshlrev_b32 v39, 5, v39
  v_lshrrev_b32 v3, 5, v1
  v_lshl_add_u32 v39, v3, 4, v39
  s_and_b32 s84, s2, 7
  s_lshl_b32 s84, s84, 12
  s_lshr_b32 s97, s3, 1
  s_lshl_b32 s97, s97, 10
  s_add_u32 s84, s84, s97
  s_bfe_u32 s97, s2, 0x30003
  s_lshl_b32 s97, s97, 7
  s_add_u32 s84, s84, s97
  s_and_b32 s97, s3, 1
  s_lshl_b32 s97, s97, 6
  s_add_u32 s84, s84, s97
  s_add_u32 s84, s84, 0x10000
  v_mov_b32 v72, 0
  v_mov_b32 v73, 0
  v_mov_b32 v74, 0
  v_mov_b32 v75, 0
  v_mov_b32 v76, 0
  v_mov_b32 v77, 0
  v_mov_b32 v78, 0
  v_mov_b32 v79, 0
  s_waitcnt vmcnt(8)
  s_barrier
  v_xor_b32 v32, 0, v45
  ds_read_b128 v[112:115], v32 offset:0
  v_xor_b32 v33, 64, v45
  ds_read_b128 v[116:119], v33 offset:0
  v_xor_b32 v32, 128, v45
  ds_read_b128 v[120:123], v32 offset:0
  v_xor_b32 v33, 192, v45
  ds_read_b128 v[124:127], v33 offset:0
  v_xor_b32 v32, 0, v45
  ds_read_b128 v[128:131], v32 offset:16384
  v_xor_b32 v33, 64, v45
  ds_read_b128 v[132:135], v33 offset:16384
  v_xor_b32 v32, 128, v45
  ds_read_b128 v[136:139], v32 offset:16384
  v_xor_b32 v33, 192, v45
  ds_read_b128 v[140:143], v33 offset:16384
  s_waitcnt lgkmcnt(0)
  s_barrier
  s_mov_b32 s100, 0
  v_mov_b32 v253, 0
L_ep_8:
  global_load_dword v252, v253, s[30:31] sc1
  s_add_u32 s100, s100, 1
  s_cmp_gt_u32 s100, 1000000
  s_cbranch_scc1 L_abort
  s_waitcnt vmcnt(0)
L_epc_9:
  v_readfirstlane_b32 s48, v252
  s_nop 0
  s_cmp_eq_u32 s48, 0
  s_nop 1
  s_cbranch_scc1 L_ep_8
  s_mul_i32 s48, s48, 0x9e3779b1
  s_and_b32 s49, s48, 0xff
  s_bfe_u32 s50, s48, 0x80008
  s_bfe_u32 s51, s48, 0x80010
  s_lshr_b32 s52, s48, 24
  s_lshr_b32 s97, s48, 15
  s_xor_b32 s97, s97, s48
  s_mul_i32 s97, s97, 0x85ebca6b
  v_mov_b32 v4, s48
  v_mov_b32 v5, s97
  v_mov_b32 v249, s48
  v_mov_b32 v250, s97
  v_and_b32 v6, 4, v1
  v_cmp_eq_u32 vcc, 0, v6
  v_and_b32 v7, 3, v1
  v_lshlrev_b32 v7, 2, v7
  v_cndmask_b32 v4, v5, v4, vcc
  v_lshrrev_b32 v4, v7, v4
  v_lshrrev_b32 v5, 1, v4
  v_lshrrev_b32 v6, 2, v4
  v_lshrrev_b32 v7, 3, v4
  s_and_b32 s92, s3, 1
  s_sub_u32 s74, 0, s92
  s_mov_b32 s75, s74
  v_bfe_u32 v28, v1, 4, 1
  v_lshlrev_b32 v28, 3, v28
  v_lshrrev_b32 v3, 5, v1
  v_lshl_add_u32 v28, v3, 2, v28
  v_mov_b32 v68, s48
  v_mov_b32 v69, s97
  v_cndmask_b32 v68, v68, v69, s[74:75]
  v_lshrrev_b32 v68, v28, v68
  v_lshrrev_b32 v69, 1, v68
  v_lshrrev_b32 v70, 2, v68
  v_lshrrev_b32 v71, 3, v68
  s_mov_b64 s[60:61], -1
  s_mov_b32 s100, 0
  s_branch L_gf_11
L_g_10:
  s_add_u32 s100, s100, 1
  s_cmp_gt_u32 s100, 1000000
  s_cbranch_scc1 L_abort
  s_sleep 2
L_gf_11:
  s_mov_b64 exec, s[60:61]
  buffer_load_dwordx4 v[20:23], v37, s[32:35], s83 offen offset:0 sc1
  s_waitcnt vmcnt(0)
L_gc_12:
  s_mov_b64 exec, s[60:61]
  v_xor_b32 v92, v20, v4
  v_bitop3_b32 v92, v21, v5, v92 bitop3:0xbe
  v_bitop3_b32 v92, v22, v6, v92 bitop3:0xbe
  v_bitop3_b32 v92, v23, v7, v92 bitop3:0xbe
  v_and_b32 v92, s53, v92
  v_cmp_ne_u32 s[60:61], 0, v92
  s_nop 0
  s_cmp_lg_u64 s[60:61], 0
  s_cselect_b64 s[60:61], -1, 0
  s_cmp_lg_u64 s[60:61], 0
  s_cbranch_scc1 L_g_10
  s_mov_b64 exec, -1
  v_dot2c_f32_bf16 v72, v50, v20
  v_dot2c_f32_bf16 v73, v51, v20
  v_dot2c_f32_bf16 v74, v50, v21
  v_dot2c_f32_bf16 v75, v51, v21
  v_dot2c_f32_bf16 v76, v50, v22
  v_dot2c_f32_bf16 v77, v51, v22
  v_dot2c_f32_bf16 v78, v50, v23
  v_dot2c_f32_bf16 v79, v51, v23
  v_permlane32_swap_b32 v72, v76
  v_permlane32_swap_b32 v73, v77
  v_permlane32_swap_b32 v74, v78
  v_permlane32_swap_b32 v75, v79
  v_add_f32 v72, v72, v76
  v_add_f32 v73, v73, v77
  v_add_f32 v74, v74, v78
  v_add_f32 v75, v75, v79
  s_nop 0
  v_permlane16_swap_b32 v72, v74
  v_permlane16_swap_b32 v73, v75
  v_add_f32 v72, v72, v74
  v_add_f32 v73, v73, v75
  s_nop 0
  v_add_f32_dpp v72, v72, v72 row_ror:8 row_mask:0xf bank_mask:0xf
  v_add_f32_dpp v73, v73, v73 row_ror:8 row_mask:0xf bank_mask:0xf
  v_cvt_pk_bf16_f32 v72, v72, v73
  ds_write_b32 v47, v72
  s_waitcnt lgkmcnt(0)
  s_barrier
  ds_read_b128 v[52:55], v35 offset:0
  ds_read_b128 v[56:59], v35 offset:64
  ds_read_b128 v[60:63], v35 offset:128
  ds_read_b128 v[64:67], v35 offset:192
  s_waitcnt lgkmcnt(3)
  v_mfma_f32_16x16x32_bf16 v[80:83], v[112:115], v[52:55], 0
  v_mfma_f32_16x16x32_bf16 v[84:87], v[128:131], v[52:55], 0
  s_waitcnt lgkmcnt(2)
  v_mfma_f32_16x16x32_bf16 v[80:83], v[116:119], v[56:59], v[80:83]
  v_mfma_f32_16x16x32_bf16 v[84:87], v[132:135], v[56:59], v[84:87]
  s_waitcnt lgkmcnt(1)
  v_mfma_f32_16x16x32_bf16 v[80:83], v[120:123], v[60:63], v[80:83]
  v_mfma_f32_16x16x32_bf16 v[84:87], v[136:139], v[60:63], v[84:87]
  s_waitcnt lgkmcnt(0)
  v_mfma_f32_16x16x32_bf16 v[80:83], v[124:127], v[64:67], v[80:83]
  v_mfma_f32_16x16x32_bf16 v[84:87], v[140:143], v[64:67], v[84:87]
  s_nop 6
  v_mul_f32 v80, 0x3e0293ee, v80
  v_mul_f32 v81, 0x3e0293ee, v81
  v_mul_f32 v82, 0x3e0293ee, v82
  v_mul_f32 v83, 0x3e0293ee, v83
  v_mul_f32 v84, 0x3e0293ee, v84
  v_mul_f32 v85, 0x3e0293ee, v85
  v_mul_f32 v86, 0x3e0293ee, v86
  v_mul_f32 v87, 0x3e0293ee, v87
  v_cvt_pk_bf16_f32 v20, v80, v81
  v_cvt_pk_bf16_f32 v21, v82, v83
  v_cvt_pk_bf16_f32 v22, v84, v85
  v_cvt_pk_bf16_f32 v23, v86, v87
  s_nop 0
  v_permlane16_swap_b32 v20, v22
  v_permlane16_swap_b32 v21, v23
  v_bfi_b32 v20, s53, v68, v20
  v_bfi_b32 v21, s53, v69, v21
  v_bfi_b32 v22, s53, v70, v22
  v_bfi_b32 v23, s53, v71, v23
  s_mov_b32 exec_lo, 0x10001
  s_mov_b32 exec_hi, 0x10001
  buffer_store_dwordx4 v[20:23], v39, s[32:35], s84 offen sc1
  s_mov_b64 exec, -1
  s_barrier
  s_lshr_b32 s92, s3, 2
  s_lshl_b32 s93, s92, 12
  s_xor_b32 s93, s93, 65536
  s_xor_b32 m0, s91, s93
  s_lshl_b32 s93, s92, 14
  s_xor_b32 s93, s93, 512
  s_xor_b32 s101, s90, s93
  buffer_load_dwordx4 v244, s[36:39], s101 offen offset:0 nt lds
  buffer_load_dwordx4 v245, s[36:39], s101 offen offset:1024 nt lds
  buffer_load_dwordx4 v246, s[36:39], s101 offen offset:2048 nt lds
  buffer_load_dwordx4 v247, s[36:39], s101 offen offset:3072 nt lds
  s_lshr_b32 s92, s3, 2
  s_lshl_b32 s93, s92, 12
  s_xor_b32 s93, s93, 98304
  s_xor_b32 m0, s91, s93
  s_lshl_b32 s93, s92, 14
  s_xor_b32 s93, s93, 768
  s_xor_b32 s101, s90, s93
  buffer_load_dwordx4 v244, s[36:39], s101 offen offset:0 nt lds
  buffer_load_dwordx4 v245, s[36:39], s101 offen offset:1024 nt lds
  buffer_load_dwordx4 v246, s[36:39], s101 offen offset:2048 nt lds
  buffer_load_dwordx4 v247, s[36:39], s101 offen offset:3072 nt lds
  s_cmp_ge_u32 s3, 4
  s_cbranch_scc0 L_kf
  s_branch L_back
L_kf:
  s_barrier
  s_branch L_setup
L_Bback2:
  s_mov_b32 s54, 0x05040100
  s_mov_b32 s55, 0x07060302
  s_mov_b32 s56, 0x0c0c0400
  s_mov_b32 s57, 0x0c040100
  s_mov_b32 s58, 0x04020100
  s_mov_b32 s53, 0x10001
  v_mov_b32 v2, 0xffffff00
  s_lshr_b32 s77, s2, 5
  s_and_b32 s78, s2, 127
  s_and_b32 s76, s2, 7
  s_lshl_b32 s76, s76, 2
  s_bfe_u32 s97, s2, 0x20003
  s_add_u32 s76, s76, s97
  s_and_b32 s79, s2, 7
  s_lshl_b32 s79, s79, 1
  s_bfe_u32 s97, s2, 0x10003
  s_add_u32 s79, s79, s97
  s_bfe_u32 s80, s2, 0x30004
  s_bfe_u32 s17, s2, 0x20003
  s_bfe_u32 s59, s2, 0x10004
  s_lshl_b32 s59, s59, 14
  s_lshl_b32 s81, s95, 2
  s_add_u32 s81, s81, s94
  s_lshl_b32 s81, s81, 8
  s_add_u32 s81, s81, 0
  v_and_b32 v8, 7, v1
  v_lshlrev_b32 v8, 2, v8
  v_lshrrev_b32 v9, 4, v1
  v_add_u32 v8, v8, v9
  v_lshlrev_b32 v8, 5, v8
  s_lshl_b32 s92, s3, 2
  s_add_u32 s92, s92, 139248
  v_add_u32 v8, s92, v8
  v_lshlrev_b32 v9, 6, v1
  v_add_u32 v9, 139264, v9
  v_lshlrev_b32 v10, 4, v1
  s_bitcmp1_b32 s2, 6
  s_cbranch_scc1 L_nou0b
  s_waitcnt vmcnt(4)
  v_mov_b32 v253, 0
  global_load_dword v252, v253, s[30:31] sc1
  v_lshlrev_b32 v120, 16, v112
  v_and_b32 v121, 0xffff0000, v112
  v_lshlrev_b32 v122, 16, v113
  v_and_b32 v123, 0xffff0000, v113
  v_mul_f32 v116, 0xbfb8aa3b, v120
  v_mul_f32 v117, 0xbfb8aa3b, v121
  v_mul_f32 v118, 0xbfb8aa3b, v122
  v_mul_f32 v119, 0xbfb8aa3b, v123
  v_exp_f32 v116, v116
  v_exp_f32 v117, v117
  v_exp_f32 v118, v118
  v_exp_f32 v119, v119
  v_add_f32 v116, 1.0, v116
  v_add_f32 v117, 1.0, v117
  v_add_f32 v118, 1.0, v118
  v_add_f32 v119, 1.0, v119
  v_rcp_f32 v116, v116
  v_rcp_f32 v117, v117
  v_rcp_f32 v118, v118
  v_rcp_f32 v119, v119
  v_mul_f32 v120, v120, v116
  v_mul_f32 v121, v121, v117
  v_mul_f32 v122, v122, v118
  v_mul_f32 v123, v123, v119
  v_cvt_pk_bf16_f32 v120, v120, v120
  v_cvt_pk_bf16_f32 v121, v121, v121
  v_cvt_pk_bf16_f32 v122, v122, v122
  v_cvt_pk_bf16_f32 v123, v123, v123
  v_lshrrev_b32 v116, 16, v120
  v_lshrrev_b32 v117, 16, v121
  v_lshrrev_b32 v118, 16, v122
  v_lshrrev_b32 v119, 16, v123
  v_and_b32 v120, 0xffff0000, v120
  v_and_b32 v121, 0xffff0000, v121
  v_and_b32 v122, 0xffff0000, v122
  v_and_b32 v123, 0xffff0000, v123
  v_mov_b32 v96, 0
  v_mov_b32 v97, 0
  v_mov_b32 v98, 0
  v_mov_b32 v99, 0
  v_mov_b32 v100, 0
  v_mov_b32 v101, 0
  v_mov_b32 v102, 0
  v_mov_b32 v103, 0
  s_waitcnt vmcnt(4)
  v_dot2c_f32_bf16 v96, v116, v124
  v_dot2c_f32_bf16 v97, v120, v124
  v_dot2c_f32_bf16 v98, v116, v125
  v_dot2c_f32_bf16 v99, v120, v125
  v_dot2c_f32_bf16 v100, v116, v126
  v_dot2c_f32_bf16 v101, v120, v126
  v_dot2c_f32_bf16 v102, v116, v127
  v_dot2c_f32_bf16 v103, v120, v127
  s_waitcnt vmcnt(3)
  v_dot2c_f32_bf16 v96, v117, v128
  v_dot2c_f32_bf16 v97, v121, v128
  v_dot2c_f32_bf16 v98, v117, v129
  v_dot2c_f32_bf16 v99, v121, v129
  v_dot2c_f32_bf16 v100, v117, v130
  v_dot2c_f32_bf16 v101, v121, v130
  v_dot2c_f32_bf16 v102, v117, v131
  v_dot2c_f32_bf16 v103, v121, v131
  s_waitcnt vmcnt(2)
  v_dot2c_f32_bf16 v96, v118, v132
  v_dot2c_f32_bf16 v97, v122, v132
  v_dot2c_f32_bf16 v98, v118, v133
  v_dot2c_f32_bf16 v99, v122, v133
  v_dot2c_f32_bf16 v100, v118, v134
  v_dot2c_f32_bf16 v101, v122, v134
  v_dot2c_f32_bf16 v102, v118, v135
  v_dot2c_f32_bf16 v103, v122, v135
  s_waitcnt vmcnt(1)
  v_dot2c_f32_bf16 v96, v119, v136
  v_dot2c_f32_bf16 v97, v123, v136
  v_dot2c_f32_bf16 v98, v119, v137
  v_dot2c_f32_bf16 v99, v123, v137
  v_dot2c_f32_bf16 v100, v119, v138
  v_dot2c_f32_bf16 v101, v123, v138
  v_dot2c_f32_bf16 v102, v119, v139
  v_dot2c_f32_bf16 v103, v123, v139
  v_permlane32_swap_b32 v96, v100
  v_permlane32_swap_b32 v97, v101
  v_permlane32_swap_b32 v98, v102
  v_permlane32_swap_b32 v99, v103
  v_add_f32 v96, v96, v100
  v_add_f32 v97, v97, v101
  v_add_f32 v98, v98, v102
  v_add_f32 v99, v99, v103
  s_nop 0
  v_permlane16_swap_b32 v96, v98
  v_permlane16_swap_b32 v97, v99
  v_add_f32 v96, v96, v98
  v_add_f32 v97, v97, v99
  s_nop 0
  v_add_f32_dpp v96, v96, v96 row_ror:8 row_mask:0xf bank_mask:0xf
  v_add_f32_dpp v97, v97, v97 row_ror:8 row_mask:0xf bank_mask:0xf
  s_mov_b32 s100, 0
  s_waitcnt vmcnt(0)
  s_branch L_epc_15
L_ep_14:
  global_load_dword v252, v253, s[30:31] sc1
  s_add_u32 s100, s100, 1
  s_cmp_gt_u32 s100, 1000000
  s_cbranch_scc1 L_abort
  s_waitcnt vmcnt(0)
L_epc_15:
  v_readfirstlane_b32 s48, v252
  s_nop 0
  s_cmp_eq_u32 s48, 0
  s_nop 1
  s_cbranch_scc1 L_ep_14
  s_mul_i32 s48, s48, 0x9e3779b1
  s_and_b32 s49, s48, 0xff
  s_bfe_u32 s50, s48, 0x80008
  s_bfe_u32 s51, s48, 0x80010
  s_lshr_b32 s52, s48, 24
  ds_write2_b32 v8, v96, v97 offset0:0 offset1:4
  s_waitcnt lgkmcnt(0)
  s_barrier
  s_cmp_lg_u32 s3, 4
  s_cbranch_scc1 L_nopub_16
  s_mov_b64 exec, 0xffff
  ds_read_b128 v[124:127], v9 offset:0
  ds_read_b128 v[128:131], v9 offset:16
  ds_read_b128 v[132:135], v9 offset:32
  ds_read_b128 v[136:139], v9 offset:48
  s_waitcnt lgkmcnt(3)
  v_add_f32 v124, v124, v125
  v_add_f32 v126, v126, v127
  v_add_f32 v124, v124, v126
  s_waitcnt lgkmcnt(2)
  v_add_f32 v128, v128, v129
  v_add_f32 v130, v130, v131
  v_add_f32 v128, v128, v130
  s_waitcnt lgkmcnt(1)
  v_add_f32 v132, v132, v133
  v_add_f32 v134, v134, v135
  v_add_f32 v132, v132, v134
  s_waitcnt lgkmcnt(0)
  v_add_f32 v136, v136, v137
  v_add_f32 v138, v138, v139
  v_add_f32 v136, v136, v138
  v_and_or_b32 v100, v124, v2, s49
  v_and_or_b32 v101, v128, v2, s50
  v_and_or_b32 v102, v132, v2, s51
  v_and_or_b32 v103, v136, v2, s52
  buffer_store_dwordx4 v[100:103], v10, s[32:35], s81 offen sc1
L_nopub_16:
  s_mov_b64 exec, -1
  s_barrier
  s_branch L_nou0c
L_nou0b:
  v_lshlrev_b32 v12, 7, v1
  v_lshlrev_b32 v14, 9, v1
  s_bfe_u32 s93, s2, 0x30003
  s_and_b32 s94, s2, 7
  s_cmp_lg_u32 s3, 4
  s_cbranch_scc1 L_ew5
  s_mov_b32 exec_hi, 0
  s_lshl_b32 s92, s93, 12
  s_add_u32 s92, s92, 0x10000
  buffer_load_dword v254, v12, s[32:35], s92 offen sc1
  s_lshl_b32 s92, s93, 14
  s_lshr_b32 s97, s94, 1
  s_lshl_b32 s97, s97, 7
  s_add_u32 s92, s92, s97
  s_add_u32 s92, s92, 0x20000
  buffer_load_dword v254, v14, s[32:35], s92 offen sc1
  s_mov_b32 exec_lo, 0xff
  s_lshl_b32 s92, s94, 13
  s_lshl_b32 s97, s93, 10
  s_add_u32 s92, s92, s97
  s_add_u32 s92, s92, 0x80000
  buffer_load_dword v254, v12, s[32:35], s92 offen sc1
  s_mov_b32 exec_lo, 0xffff
  s_lshl_b32 s92, s93, 11
  s_add_u32 s92, s92, 0x18000
  buffer_load_dword v254, v12, s[32:35], s92 offen sc1
  s_branch L_ewx
L_ew5:
  s_cmp_lg_u32 s3, 7
  s_cbranch_scc0 L_ew7
  s_mov_b32 exec_hi, 0
  s_lshl_b32 s95, s93, 4
  s_lshl_b32 s97, s3, 3
  s_add_u32 s95, s95, s97
  s_add_u32 s95, s95, s94
  s_add_u32 s95, s95, 0xffffffd8
  s_sub_u32 s96, s95, 56
  s_cmp_ge_u32 s95, 56
  s_cselect_b32 s95, s96, s95
  s_lshl_b32 s92, s95, 12
  s_add_u32 s92, s92, 0xd0000
  buffer_load_dword v254, v12, s[32:35], s92 offen sc1
  s_branch L_ewx
L_ew7:
  s_cmp_ge_u32 s93, 4
  s_cbranch_scc1 L_ew7b
  s_mov_b32 exec_hi, 0
  s_lshl_b32 s92, s94, 14
  s_lshl_b32 s97, s93, 12
  s_add_u32 s92, s92, s97
  s_add_u32 s92, s92, 0x40000
  buffer_load_dword v254, v12, s[32:35], s92 offen sc1
  s_branch L_ewx
L_ew7b:
  s_bitcmp1_b32 s93, 1
  s_cbranch_scc1 L_ew7c
  s_mov_b32 exec_hi, 0
  s_mul_i32 s92, s94, 8448
  s_and_b32 s97, s93, 1
  s_mul_i32 s97, s97, 4224
  s_add_u32 s92, s92, s97
  s_add_u32 s92, s92, 0x60000
  buffer_load_dword v254, v12, s[32:35], s92 offen sc1
  s_branch L_ewx
L_ew7c:
  s_mul_i32 s92, s94, 16896
  s_and_b32 s97, s93, 1
  s_mul_i32 s97, s97, 8448
  s_add_u32 s92, s92, s97
  s_add_u32 s92, s92, 0xa0000
  buffer_load_dword v254, v12, s[32:35], s92 offen sc1
L_ewx:
  s_mov_b64 exec, -1
  s_barrier
  s_barrier
  s_mov_b32 s100, 0
  v_mov_b32 v253, 0
L_ep_17:
  global_load_dword v252, v253, s[30:31] sc1
  s_add_u32 s100, s100, 1
  s_cmp_gt_u32 s100, 1000000
  s_cbranch_scc1 L_abort
  s_waitcnt vmcnt(0)
L_epc_18:
  v_readfirstlane_b32 s48, v252
  s_nop 0
  s_cmp_eq_u32 s48, 0
  s_nop 1
  s_cbranch_scc1 L_ep_17
  s_mul_i32 s48, s48, 0x9e3779b1
  s_and_b32 s49, s48, 0xff
  s_bfe_u32 s50, s48, 0x80008
  s_bfe_u32 s51, s48, 0x80010
  s_lshr_b32 s52, s48, 24
L_nou0c:
  s_lshr_b32 s97, s48, 15
  s_xor_b32 s97, s97, s48
  s_mul_i32 s97, s97, 0x85ebca6b
  v_mov_b32 v4, s48
  v_mov_b32 v5, s97
  v_mov_b32 v249, s48
  v_mov_b32 v250, s97
  v_and_b32 v6, 4, v1
  v_cmp_eq_u32 vcc, 0, v6
  v_and_b32 v7, 3, v1
  v_lshlrev_b32 v7, 2, v7
  v_cndmask_b32 v4, v5, v4, vcc
  v_lshrrev_b32 v4, v7, v4
  v_lshrrev_b32 v5, 1, v4
  v_lshrrev_b32 v6, 2, v4
  v_lshrrev_b32 v7, 3, v4
  v_lshrrev_b32 v245, 4, v1
  v_and_b32 v246, 15, v1
  v_lshlrev_b32 v247, 2, v245
  v_xor_b32 v246, v246, v247
  v_lshlrev_b32 v246, 4, v246
  v_lshl_add_u32 v244, v245, 10, v246
  v_xor_b32 v245, 16, v244
  v_xor_b32 v246, 32, v244
  v_xor_b32 v247, 48, v244
  v_add_u32 v245, 3072, v245
  v_add_u32 v246, 6144, v246
  v_add_u32 v247, 9216, v247
  s_and_b32 s91, s3, 3
  s_lshl_b32 s90, s91, 15
  s_lshl_b32 s91, s91, 13
  s_lshl_b32 s92, s2, 17
  s_add_u32 s90, s90, s92
  s_bfe_u32 s93, s2, 0x20003
  s_lshl_b32 s92, s93, 15
  s_add_u32 s91, s91, s92
  s_lshl_b32 s92, s93, 8
  s_add_u32 s90, s90, s92
  s_mov_b64 s[36:37], s[6:7]
  s_mov_b32 s38, 0x2000000
  s_mov_b32 s39, 0x20000
  v_lshlrev_b32 v12, 21, v1
  v_add_u32 v12, 0xf000, v12
  s_mov_b64 exec, 0x3f
  buffer_load_dword v254, v12, s[32:35], 0 offen
  s_mov_b64 exec, -1
  s_and_b32 s81, s3, 3
  s_lshl_b32 s81, s81, 13
  s_add_u32 s81, s81, 0x10000
  v_lshlrev_b32 v8, 4, v1
  s_add_u32 s82, s81, 4096
  v_lshrrev_b32 v9, 4, v1
  v_lshlrev_b32 v9, 13, v9
  v_and_b32 v3, 15, v1
  v_lshl_add_u32 v9, v3, 4, v9
  s_and_b32 s93, s3, 3
  s_lshl_b32 s93, s93, 11
  s_and_b32 s97, s3, 1
  s_lshl_b32 s97, s97, 5
  s_add_u32 s93, s93, s97
  s_add_u32 s93, s93, 0x20000
  v_xor_b32 v9, s93, v9
  s_xor_b32 m0, s91, 4096
  s_xor_b32 s101, s90, 16384
  buffer_load_dwordx4 v244, s[36:39], s101 offen offset:0 nt lds
  s_waitcnt vmcnt(0)
  buffer_load_dwordx4 v245, s[36:39], s101 offen offset:1024 nt lds
  s_waitcnt vmcnt(2)
  buffer_load_dwordx4 v246, s[36:39], s101 offen offset:2048 nt lds
  s_waitcnt vmcnt(2)
  buffer_load_dwordx4 v247, s[36:39], s101 offen offset:3072 nt lds
  s_waitcnt vmcnt(2)
  s_xor_b32 m0, s91, 36864
  s_xor_b32 s101, s90, 16640
  buffer_load_dwordx4 v244, s[36:39], s101 offen offset:0 nt lds
  s_waitcnt vmcnt(2)
  buffer_load_dwordx4 v245, s[36:39], s101 offen offset:1024 nt lds
  s_waitcnt vmcnt(2)
  buffer_load_dwordx4 v246, s[36:39], s101 offen offset:2048 nt lds
  s_waitcnt vmcnt(2)
  buffer_load_dwordx4 v247, s[36:39], s101 offen offset:3072 nt lds
  s_waitcnt vmcnt(2)
  s_xor_b32 m0, s91, 69632
  s_xor_b32 s101, s90, 16896
  buffer_load_dwordx4 v244, s[36:39], s101 offen offset:0 nt lds
  buffer_load_dwordx4 v245, s[36:39], s101 offen offset:1024 nt lds
  buffer_load_dwordx4 v246, s[36:39], s101 offen offset:2048 nt lds
  buffer_load_dwordx4 v247, s[36:39], s101 offen offset:3072 nt lds
  s_xor_b32 m0, s91, 102400
  s_xor_b32 s101, s90, 17152
  buffer_load_dwordx4 v244, s[36:39], s101 offen offset:0 nt lds
  buffer_load_dwordx4 v245, s[36:39], s101 offen offset:1024 nt lds
  buffer_load_dwordx4 v246, s[36:39], s101 offen offset:2048 nt lds
  buffer_load_dwordx4 v247, s[36:39], s101 offen offset:3072 nt lds
  s_mov_b64 s[40:41], s[26:27]
  s_mov_b32 s42, 0x300000
  s_mov_b32 s43, 0x20000
  v_lshrrev_b32 v13, 3, v1
  v_mul_u32_u24 v13, 24576, v13
  v_and_b32 v3, 7, v1
  v_lshl_add_u32 v13, v3, 4, v13
  s_lshr_b32 s94, s78, 5
  s_lshl_b32 s94, s94, 2
  s_and_b32 s97, s3, 3
  s_add_u32 s94, s94, s97
  s_lshl_b32 s95, s94, 6
  v_lshrrev_b32 v14, 3, v1
  v_lshlrev_b32 v14, 3, v14
  v_add_u32 v14, s95, v14
  s_mul_i32 s92, s94, 196608
  s_and_b32 s97, s2, 31
  s_lshl_b32 s97, s97, 7
  s_add_u32 s92, s92, s97
  s_add_u32 s92, s92, 0x800
  global_load_dwordx2 v[144:145], v14, s[24:25]
  buffer_load_dwordx4 v[128:131], v13, s[40:43], s92 offen nt
  s_add_u32 s92, s92, 6144
  buffer_load_dwordx4 v[132:135], v13, s[40:43], s92 offen nt
  s_add_u32 s92, s92, 6144
  buffer_load_dwordx4 v[136:139], v13, s[40:43], s92 offen nt
  s_add_u32 s92, s92, 6144
  buffer_load_dwordx4 v[140:143], v13, s[40:43], s92 offen nt
  v_lshrrev_b32 v253, 4, v1
  v_lshlrev_b32 v253, 13, v253
  v_and_b32 v3, 15, v1
  v_lshl_add_u32 v253, v3, 4, v253
  s_lshl_b32 s88, s77, 19
  s_bfe_u32 s97, s3, 0x10001
  s_lshl_b32 s97, s97, 18
  s_add_u32 s88, s88, s97
  s_and_b32 s97, s3, 1
  s_lshl_b32 s97, s97, 15
  s_add_u32 s88, s88, s97
  s_lshl_b32 s97, s76, 8
  s_add_u32 s88, s88, s97
  v_lshrrev_b32 v251, 5, v1
  v_mul_u32_u24 v251, 3584, v251
  v_and_b32 v3, 31, v1
  v_lshl_add_u32 v251, v3, 4, v251
  s_mul_i32 s89, s79, 114688
  s_and_b32 s97, s3, 3
  s_mul_i32 s97, s97, 28672
  s_add_u32 s89, s89, s97
  s_mul_i32 s97, s80, 448
  s_add_u32 s89, s89, s97
  s_barrier
  s_branch L_back1
L_back:
  v_lshlrev_b32 v12, 21, v1
  v_add_u32 v12, 0xf000, v12
  s_mov_b64 exec, 0x3f
  buffer_load_dword v254, v12, s[32:35], 0 offen
  s_mov_b64 exec, -1
  s_and_b32 s81, s3, 3
  s_lshl_b32 s81, s81, 13
  s_add_u32 s81, s81, 0x10000
  v_lshlrev_b32 v8, 4, v1
  s_add_u32 s82, s81, 4096
  v_lshrrev_b32 v9, 4, v1
  v_lshlrev_b32 v9, 13, v9
  v_and_b32 v3, 15, v1
  v_lshl_add_u32 v9, v3, 4, v9
  s_and_b32 s93, s3, 3
  s_lshl_b32 s93, s93, 11
  s_and_b32 s97, s3, 1
  s_lshl_b32 s97, s97, 5
  s_add_u32 s93, s93, s97
  s_add_u32 s93, s93, 0x20000
  v_xor_b32 v9, s93, v9
  v_lshrrev_b32 v253, 4, v1
  v_lshlrev_b32 v253, 13, v253
  v_and_b32 v3, 15, v1
  v_lshl_add_u32 v253, v3, 4, v253
  s_lshl_b32 s88, s77, 19
  s_bfe_u32 s97, s3, 0x10001
  s_lshl_b32 s97, s97, 18
  s_add_u32 s88, s88, s97
  s_and_b32 s97, s3, 1
  s_lshl_b32 s97, s97, 15
  s_add_u32 s88, s88, s97
  s_lshl_b32 s97, s76, 8
  s_add_u32 s88, s88, s97
  v_lshrrev_b32 v251, 4, v1
  v_lshlrev_b32 v251, 10, v251
  v_and_b32 v3, 15, v1
  v_lshl_add_u32 v251, v3, 4, v251
  s_lshl_b32 s89, s76, 17
  s_and_b32 s97, s3, 3
  s_lshl_b32 s97, s97, 15
  s_add_u32 s89, s89, s97
  s_lshl_b32 s97, s77, 8
  s_add_u32 s89, s89, s97
  s_barrier
L_back1:
  buffer_load_dwordx4 v[48:51], v8, s[32:35], s81 offen offset:0 sc1
  buffer_load_dwordx4 v[52:55], v8, s[32:35], s81 offen offset:1024 sc1
  buffer_load_dwordx4 v[56:59], v8, s[32:35], s81 offen offset:2048 sc1
  buffer_load_dwordx4 v[60:63], v8, s[32:35], s81 offen offset:3072 sc1
  buffer_load_dwordx4 v[64:67], v8, s[32:35], s82 offen offset:0 sc1
  buffer_load_dwordx4 v[68:71], v8, s[32:35], s82 offen offset:1024 sc1
  buffer_load_dwordx4 v[72:75], v8, s[32:35], s82 offen offset:2048 sc1
  buffer_load_dwordx4 v[76:79], v8, s[32:35], s82 offen offset:3072 sc1
  s_branch L_setup
L_back2:
  s_mov_b64 s[60:61], -1
  s_mov_b64 s[62:63], -1
  s_mov_b64 s[64:65], -1
  s_mov_b64 s[66:67], -1
  s_mov_b64 s[68:69], -1
  s_mov_b64 s[70:71], -1
  s_mov_b64 s[72:73], -1
  s_mov_b64 s[74:75], -1
  s_waitcnt vmcnt(0)
  s_mov_b32 s100, 0
  s_branch L_gc_21
L_g_19:
  s_add_u32 s100, s100, 1
  s_cmp_gt_u32 s100, 1000000
  s_cbranch_scc1 L_abort
  s_mov_b32 s92, 0
  s_cmp_lg_u32 s74, 0
  s_cselect_b32 s92, 7168, s92
  s_cmp_lg_u32 s72, 0
  s_cselect_b32 s92, 6144, s92
  s_cmp_lg_u32 s70, 0
  s_cselect_b32 s92, 5120, s92
  s_cmp_lg_u32 s68, 0
  s_cselect_b32 s92, 4096, s92
  s_cmp_lg_u32 s66, 0
  s_cselect_b32 s92, 3072, s92
  s_cmp_lg_u32 s64, 0
  s_cselect_b32 s92, 2048, s92
  s_cmp_lg_u32 s62, 0
  s_cselect_b32 s92, 1024, s92
  s_cmp_lg_u32 s60, 0
  s_cselect_b32 s92, 0, s92
  s_add_u32 s92, s92, s81
  s_mov_b64 exec, -1
L_qg_22:
  buffer_load_dwordx4 v[16:19], v8, s[32:35], s92 offen sc1
  s_add_u32 s100, s100, 1
  s_cmp_gt_u32 s100, 1000000
  s_cbranch_scc1 L_abort
  s_waitcnt vmcnt(0)
  v_xor_b32 v16, v16, v4
  v_bitop3_b32 v16, v17, v5, v16 bitop3:0xbe
  v_bitop3_b32 v16, v18, v6, v16 bitop3:0xbe
  v_bitop3_b32 v16, v19, v7, v16 bitop3:0xbe
  v_and_b32 v16, s53, v16
  v_cmp_ne_u32 vcc, 0, v16
  s_nop 0
  s_cbranch_vccz L_qg_22x
  s_sleep 4
  s_branch L_qg_22
L_qg_22x:
L_gf_20:
  s_mov_b64 exec, s[60:61]
  s_cbranch_execz L_gs_23
  buffer_load_dwordx4 v[48:51], v8, s[32:35], s81 offen offset:0 sc1
L_gs_23:
  s_mov_b64 exec, s[62:63]
  s_cbranch_execz L_gs_24
  buffer_load_dwordx4 v[52:55], v8, s[32:35], s81 offen offset:1024 sc1
L_gs_24:
  s_mov_b64 exec, s[64:65]
  s_cbranch_execz L_gs_25
  buffer_load_dwordx4 v[56:59], v8, s[32:35], s81 offen offset:2048 sc1
L_gs_25:
  s_mov_b64 exec, s[66:67]
  s_cbranch_execz L_gs_26
  buffer_load_dwordx4 v[60:63], v8, s[32:35], s81 offen offset:3072 sc1
L_gs_26:
  s_mov_b64 exec, s[68:69]
  s_cbranch_execz L_gs_27
  buffer_load_dwordx4 v[64:67], v8, s[32:35], s82 offen offset:0 sc1
L_gs_27:
  s_mov_b64 exec, s[70:71]
  s_cbranch_execz L_gs_28
  buffer_load_dwordx4 v[68:71], v8, s[32:35], s82 offen offset:1024 sc1
L_gs_28:
  s_mov_b64 exec, s[72:73]
  s_cbranch_execz L_gs_29
  buffer_load_dwordx4 v[72:75], v8, s[32:35], s82 offen offset:2048 sc1
L_gs_29:
  s_mov_b64 exec, s[74:75]
  s_cbranch_execz L_gs_30
  buffer_load_dwordx4 v[76:79], v8, s[32:35], s82 offen offset:3072 sc1
L_gs_30:
  s_waitcnt vmcnt(0)
L_gc_21:
  s_mov_b64 exec, s[60:61]
  v_xor_b32 v44, v48, v4
  v_bitop3_b32 v44, v49, v5, v44 bitop3:0xbe
  v_bitop3_b32 v44, v50, v6, v44 bitop3:0xbe
  v_bitop3_b32 v44, v51, v7, v44 bitop3:0xbe
  v_and_b32 v44, s53, v44
  v_cmp_ne_u32 s[60:61], 0, v44
  s_nop 0
  s_cmp_lg_u64 s[60:61], 0
  s_cselect_b64 s[60:61], -1, 0
  s_mov_b64 exec, s[62:63]
  v_xor_b32 v44, v52, v4
  v_bitop3_b32 v44, v53, v5, v44 bitop3:0xbe
  v_bitop3_b32 v44, v54, v6, v44 bitop3:0xbe
  v_bitop3_b32 v44, v55, v7, v44 bitop3:0xbe
  v_and_b32 v44, s53, v44
  v_cmp_ne_u32 s[62:63], 0, v44
  s_nop 0
  s_cmp_lg_u64 s[62:63], 0
  s_cselect_b64 s[62:63], -1, 0
  s_mov_b64 exec, s[64:65]
  v_xor_b32 v44, v56, v4
  v_bitop3_b32 v44, v57, v5, v44 bitop3:0xbe
  v_bitop3_b32 v44, v58, v6, v44 bitop3:0xbe
  v_bitop3_b32 v44, v59, v7, v44 bitop3:0xbe
  v_and_b32 v44, s53, v44
  v_cmp_ne_u32 s[64:65], 0, v44
  s_nop 0
  s_cmp_lg_u64 s[64:65], 0
  s_cselect_b64 s[64:65], -1, 0
  s_mov_b64 exec, s[66:67]
  v_xor_b32 v44, v60, v4
  v_bitop3_b32 v44, v61, v5, v44 bitop3:0xbe
  v_bitop3_b32 v44, v62, v6, v44 bitop3:0xbe
  v_bitop3_b32 v44, v63, v7, v44 bitop3:0xbe
  v_and_b32 v44, s53, v44
  v_cmp_ne_u32 s[66:67], 0, v44
  s_nop 0
  s_cmp_lg_u64 s[66:67], 0
  s_cselect_b64 s[66:67], -1, 0
  s_mov_b64 exec, s[68:69]
  v_xor_b32 v44, v64, v4
  v_bitop3_b32 v44, v65, v5, v44 bitop3:0xbe
  v_bitop3_b32 v44, v66, v6, v44 bitop3:0xbe
  v_bitop3_b32 v44, v67, v7, v44 bitop3:0xbe
  v_and_b32 v44, s53, v44
  v_cmp_ne_u32 s[68:69], 0, v44
  s_nop 0
  s_cmp_lg_u64 s[68:69], 0
  s_cselect_b64 s[68:69], -1, 0
  s_mov_b64 exec, s[70:71]
  v_xor_b32 v44, v68, v4
  v_bitop3_b32 v44, v69, v5, v44 bitop3:0xbe
  v_bitop3_b32 v44, v70, v6, v44 bitop3:0xbe
  v_bitop3_b32 v44, v71, v7, v44 bitop3:0xbe
  v_and_b32 v44, s53, v44
  v_cmp_ne_u32 s[70:71], 0, v44
  s_nop 0
  s_cmp_lg_u64 s[70:71], 0
  s_cselect_b64 s[70:71], -1, 0
  s_mov_b64 exec, s[72:73]
  v_xor_b32 v44, v72, v4
  v_bitop3_b32 v44, v73, v5, v44 bitop3:0xbe
  v_bitop3_b32 v44, v74, v6, v44 bitop3:0xbe
  v_bitop3_b32 v44, v75, v7, v44 bitop3:0xbe
  v_and_b32 v44, s53, v44
  v_cmp_ne_u32 s[72:73], 0, v44
  s_nop 0
  s_cmp_lg_u64 s[72:73], 0
  s_cselect_b64 s[72:73], -1, 0
  s_mov_b64 exec, s[74:75]
  v_xor_b32 v44, v76, v4
  v_bitop3_b32 v44, v77, v5, v44 bitop3:0xbe
  v_bitop3_b32 v44, v78, v6, v44 bitop3:0xbe
  v_bitop3_b32 v44, v79, v7, v44 bitop3:0xbe
  v_and_b32 v44, s53, v44
  v_cmp_ne_u32 s[74:75], 0, v44
  s_nop 0
  s_cmp_lg_u64 s[74:75], 0
  s_cselect_b64 s[74:75], -1, 0
  s_or_b64 s[96:97], s[60:61], s[62:63]
  s_or_b64 s[96:97], s[96:97], s[64:65]
  s_or_b64 s[96:97], s[96:97], s[66:67]
  s_or_b64 s[96:97], s[96:97], s[68:69]
  s_or_b64 s[96:97], s[96:97], s[70:71]
  s_or_b64 s[96:97], s[96:97], s[72:73]
  s_or_b64 s[96:97], s[96:97], s[74:75]
  s_cbranch_scc1 L_g_19
  s_mov_b64 exec, -1
  s_cmp_le_u32 s100, 0
  s_cselect_b32 s101, 0, 0
  v_xor_b32 v10, 0, v9
  ds_write_b128 v10, v[48:51] offset:0
  v_xor_b32 v11, 64, v9
  ds_write_b128 v11, v[52:55] offset:256
  v_xor_b32 v10, 128, v9
  ds_write_b128 v10, v[56:59] offset:512
  v_xor_b32 v11, 192, v9
  ds_write_b128 v11, v[60:63] offset:768
  v_xor_b32 v10, 16, v9
  ds_write_b128 v10, v[64:67] offset:1024
  v_xor_b32 v11, 80, v9
  ds_write_b128 v11, v[68:71] offset:1280
  v_xor_b32 v10, 144, v9
  ds_write_b128 v10, v[72:75] offset:1536
  v_xor_b32 v11, 208, v9
  ds_write_b128 v11, v[76:79] offset:1792
  s_mov_b64 s[40:41], s[14:15]
  s_mov_b32 s42, 0x400000
  s_mov_b32 s43, 0x20000
  s_mov_b64 s[44:45], s[12:13]
  s_mov_b32 s46, 0x400000
  s_mov_b32 s47, 0x20000
  s_waitcnt lgkmcnt(0)
  s_setprio 3
  s_barrier
  s_cmp_lt_u32 s2, 128
  s_cbranch_scc0 L_lwB
  s_cmp_lg_u32 s101, 0
  s_cbranch_scc1 L_lwX
  buffer_load_dwordx4 v[176:179], v253, s[44:47], s88 offen nt
  s_add_u32 s88, s88, 65536
  buffer_load_dwordx4 v[180:183], v253, s[44:47], s88 offen nt
  s_add_u32 s88, s88, 65536
  buffer_load_dwordx4 v[184:187], v253, s[44:47], s88 offen nt
  s_add_u32 s88, s88, 65536
  buffer_load_dwordx4 v[188:191], v253, s[44:47], s88 offen nt
  buffer_load_dwordx4 v[208:211], v251, s[40:43], s89 offen nt
  s_add_u32 s89, s89, 4096
  buffer_load_dwordx4 v[212:215], v251, s[40:43], s89 offen nt
  s_add_u32 s89, s89, 4096
  buffer_load_dwordx4 v[216:219], v251, s[40:43], s89 offen nt
  s_add_u32 s89, s89, 4096
  buffer_load_dwordx4 v[220:223], v251, s[40:43], s89 offen nt
  s_add_u32 s89, s89, 4096
  buffer_load_dwordx4 v[224:227], v251, s[40:43], s89 offen nt
  s_add_u32 s89, s89, 4096
  buffer_load_dwordx4 v[228:231], v251, s[40:43], s89 offen nt
  s_add_u32 s89, s89, 4096
  buffer_load_dwordx4 v[232:235], v251, s[40:43], s89 offen nt
  s_add_u32 s89, s89, 4096
  buffer_load_dwordx4 v[236:239], v251, s[40:43], s89 offen nt
L_lwX:
  s_barrier
  s_barrier
  s_barrier
  s_branch L_pv
L_lwB:
  s_cmp_lg_u32 s101, 0
  s_cbranch_scc1 L_lwB2
  buffer_load_dwordx4 v[176:179], v253, s[44:47], s88 offen nt
  s_add_u32 s88, s88, 65536
  buffer_load_dwordx4 v[180:183], v253, s[44:47], s88 offen nt
  s_add_u32 s88, s88, 65536
  buffer_load_dwordx4 v[184:187], v253, s[44:47], s88 offen nt
  s_add_u32 s88, s88, 65536
  buffer_load_dwordx4 v[188:191], v253, s[44:47], s88 offen nt
  s_mov_b64 s[40:41], s[18:19]
  s_mov_b32 s42, 0x1c0000
  s_mov_b32 s43, 0x20000
  s_mov_b64 s[44:45], s[20:21]
  s_mov_b32 s46, 0x1c0000
  s_mov_b32 s47, 0x20000
  s_mov_b32 exec_lo, 0xfffffff
  s_mov_b32 exec_hi, 0xfffffff
  buffer_load_dwordx4 v[208:211], v251, s[40:43], s89 offen nt
  buffer_load_dwordx4 v[212:215], v251, s[44:47], s89 offen nt
  s_add_u32 s89, s89, 7168
  buffer_load_dwordx4 v[216:219], v251, s[40:43], s89 offen nt
  buffer_load_dwordx4 v[220:223], v251, s[44:47], s89 offen nt
  s_add_u32 s89, s89, 7168
  buffer_load_dwordx4 v[224:227], v251, s[40:43], s89 offen nt
  buffer_load_dwordx4 v[228:231], v251, s[44:47], s89 offen nt
  s_add_u32 s89, s89, 7168
  buffer_load_dwordx4 v[232:235], v251, s[40:43], s89 offen nt
  buffer_load_dwordx4 v[236:239], v251, s[44:47], s89 offen nt
  s_mov_b64 exec, -1
L_lwB2:
  s_and_b32 s74, s2, 31
  s_lshl_b32 s74, s74, 10
  s_lshr_b32 s97, s78, 5
  s_lshl_b32 s97, s97, 8
  s_add_u32 s74, s74, s97
  s_add_u32 s74, s74, 0x4000
  v_and_b32 v13, 7, v1
  v_lshlrev_b32 v13, 2, v13
  v_lshrrev_b32 v14, 4, v1
  v_add_u32 v13, v13, v14
  v_lshlrev_b32 v13, 5, v13
  s_lshl_b32 s92, s3, 2
  s_add_u32 s92, s92, 141296
  v_add_u32 v13, s92, v13
  v_lshlrev_b32 v14, 6, v1
  v_add_u32 v14, 141312, v14
  v_lshlrev_b32 v15, 4, v1
  v_xor_b32 v13, s59, v13
  v_xor_b32 v14, s59, v14
  s_waitcnt vmcnt(63)
  v_lshlrev_b32 v116, 16, v144
  v_and_b32 v117, 0xffff0000, v144
  v_lshlrev_b32 v118, 16, v145
  v_and_b32 v119, 0xffff0000, v145
  v_mul_f32 v112, 0xbfb8aa3b, v116
  v_mul_f32 v113, 0xbfb8aa3b, v117
  v_mul_f32 v114, 0xbfb8aa3b, v118
  v_mul_f32 v115, 0xbfb8aa3b, v119
  v_exp_f32 v112, v112
  v_exp_f32 v113, v113
  v_exp_f32 v114, v114
  v_exp_f32 v115, v115
  v_add_f32 v112, 1.0, v112
  v_add_f32 v113, 1.0, v113
  v_add_f32 v114, 1.0, v114
  v_add_f32 v115, 1.0, v115
  v_rcp_f32 v112, v112
  v_rcp_f32 v113, v113
  v_rcp_f32 v114, v114
  v_rcp_f32 v115, v115
  v_mul_f32 v116, v116, v112
  v_mul_f32 v117, v117, v113
  v_mul_f32 v118, v118, v114
  v_mul_f32 v119, v119, v115
  v_cvt_pk_bf16_f32 v116, v116, v116
  v_cvt_pk_bf16_f32 v117, v117, v117
  v_cvt_pk_bf16_f32 v118, v118, v118
  v_cvt_pk_bf16_f32 v119, v119, v119
  v_lshrrev_b32 v112, 16, v116
  v_lshrrev_b32 v113, 16, v117
  v_lshrrev_b32 v114, 16, v118
  v_lshrrev_b32 v115, 16, v119
  v_and_b32 v116, 0xffff0000, v116
  v_and_b32 v117, 0xffff0000, v117
  v_and_b32 v118, 0xffff0000, v118
  v_and_b32 v119, 0xffff0000, v119
  v_mov_b32 v96, 0
  v_mov_b32 v97, 0
  v_mov_b32 v98, 0
  v_mov_b32 v99, 0
  v_mov_b32 v100, 0
  v_mov_b32 v101, 0
  v_mov_b32 v102, 0
  v_mov_b32 v103, 0
  s_waitcnt vmcnt(63)
  v_dot2c_f32_bf16 v96, v112, v128
  v_dot2c_f32_bf16 v97, v116, v128
  v_dot2c_f32_bf16 v98, v112, v129
  v_dot2c_f32_bf16 v99, v116, v129
  v_dot2c_f32_bf16 v100, v112, v130
  v_dot2c_f32_bf16 v101, v116, v130
  v_dot2c_f32_bf16 v102, v112, v131
  v_dot2c_f32_bf16 v103, v116, v131
  s_waitcnt vmcnt(62)
  v_dot2c_f32_bf16 v96, v113, v132
  v_dot2c_f32_bf16 v97, v117, v132
  v_dot2c_f32_bf16 v98, v113, v133
  v_dot2c_f32_bf16 v99, v117, v133
  v_dot2c_f32_bf16 v100, v113, v134
  v_dot2c_f32_bf16 v101, v117, v134
  v_dot2c_f32_bf16 v102, v113, v135
  v_dot2c_f32_bf16 v103, v117, v135
  s_waitcnt vmcnt(61)
  v_dot2c_f32_bf16 v96, v114, v136
  v_dot2c_f32_bf16 v97, v118, v136
  v_dot2c_f32_bf16 v98, v114, v137
  v_dot2c_f32_bf16 v99, v118, v137
  v_dot2c_f32_bf16 v100, v114, v138
  v_dot2c_f32_bf16 v101, v118, v138
  v_dot2c_f32_bf16 v102, v114, v139
  v_dot2c_f32_bf16 v103, v118, v139
  s_waitcnt vmcnt(60)
  v_dot2c_f32_bf16 v96, v115, v140
  v_dot2c_f32_bf16 v97, v119, v140
  v_dot2c_f32_bf16 v98, v115, v141
  v_dot2c_f32_bf16 v99, v119, v141
  v_dot2c_f32_bf16 v100, v115, v142
  v_dot2c_f32_bf16 v101, v119, v142
  v_dot2c_f32_bf16 v102, v115, v143
  v_dot2c_f32_bf16 v103, v119, v143
  v_permlane32_swap_b32 v96, v100
  v_permlane32_swap_b32 v97, v101
  v_permlane32_swap_b32 v98, v102
  v_permlane32_swap_b32 v99, v103
  v_add_f32 v96, v96, v100
  v_add_f32 v97, v97, v101
  v_add_f32 v98, v98, v102
  v_add_f32 v99, v99, v103
  s_nop 0
  v_permlane16_swap_b32 v96, v98
  v_permlane16_swap_b32 v97, v99
  v_add_f32 v96, v96, v98
  v_add_f32 v97, v97, v99
  s_nop 0
  v_add_f32_dpp v96, v96, v96 row_ror:8 row_mask:0xf bank_mask:0xf
  v_add_f32_dpp v97, v97, v97 row_ror:8 row_mask:0xf bank_mask:0xf
  s_barrier
  ds_write2_b32 v13, v96, v97 offset0:0 offset1:4
  s_waitcnt lgkmcnt(0)
  s_barrier
  s_cmp_lg_u32 s3, 4
  s_cbranch_scc1 L_nopub_31
  s_mov_b64 exec, 0xffff
  ds_read_b128 v[128:131], v14 offset:0
  ds_read_b128 v[132:135], v14 offset:16
  ds_read_b128 v[136:139], v14 offset:32
  ds_read_b128 v[140:143], v14 offset:48
  s_waitcnt lgkmcnt(3)
  v_add_f32 v128, v128, v129
  v_add_f32 v130, v130, v131
  v_add_f32 v128, v128, v130
  s_waitcnt lgkmcnt(2)
  v_add_f32 v132, v132, v133
  v_add_f32 v134, v134, v135
  v_add_f32 v132, v132, v134
  s_waitcnt lgkmcnt(1)
  v_add_f32 v136, v136, v137
  v_add_f32 v138, v138, v139
  v_add_f32 v136, v136, v138
  s_waitcnt lgkmcnt(0)
  v_add_f32 v140, v140, v141
  v_add_f32 v142, v142, v143
  v_add_f32 v140, v140, v142
  v_and_or_b32 v100, v128, v2, s49
  v_and_or_b32 v101, v132, v2, s50
  v_and_or_b32 v102, v136, v2, s51
  v_and_or_b32 v103, v140, v2, s52
  buffer_store_dwordx4 v[100:103], v15, s[32:35], s74 offen sc1
L_nopub_31:
  s_mov_b64 exec, -1
  s_barrier
  s_branch L_pv
L_front:
  s_mov_b32 s100, 0
  s_waitcnt vmcnt(4)
  s_branch L_epc_33
L_ep_32:
  global_load_dword v252, v253, s[30:31] sc1
  s_add_u32 s100, s100, 1
  s_cmp_gt_u32 s100, 1000000
  s_cbranch_scc1 L_abort
  s_waitcnt vmcnt(0)
L_epc_33:
  v_readfirstlane_b32 s48, v252
  s_nop 0
  s_cmp_eq_u32 s48, 0
  s_nop 1
  s_cbranch_scc1 L_ep_32
  s_mul_i32 s48, s48, 0x9e3779b1
  s_and_b32 s49, s48, 0xff
  s_bfe_u32 s50, s48, 0x80008
  s_bfe_u32 s51, s48, 0x80010
  s_lshr_b32 s52, s48, 24
  s_lshr_b32 s97, s48, 15
  s_xor_b32 s97, s97, s48
  s_mul_i32 s97, s97, 0x85ebca6b
  v_mov_b32 v4, s48
  v_mov_b32 v5, s97
  v_mov_b32 v249, s48
  v_mov_b32 v250, s97
  v_and_b32 v6, 4, v1
  v_cmp_eq_u32 vcc, 0, v6
  v_and_b32 v7, 3, v1
  v_lshlrev_b32 v7, 2, v7
  v_cndmask_b32 v4, v5, v4, vcc
  v_lshrrev_b32 v4, v7, v4
  v_lshrrev_b32 v5, 1, v4
  v_lshrrev_b32 v6, 2, v4
  v_lshrrev_b32 v7, 3, v4
L_setup:
  s_lshr_b32 s92, s3, 1
  s_lshl_b32 s92, s92, 15
  s_and_b32 s93, s3, 1
  v_lshlrev_b32 v34, 4, v1
  v_bfe_u32 v44, v1, 2, 2
  v_lshrrev_b32 v45, 5, v1
  v_lshl_add_u32 v46, v45, 2, v44
  v_lshlrev_b32 v46, 8, v46
  v_add_u32 v46, s92, v46
  v_and_b32 v47, 1, v1
  v_lshl_add_u32 v46, v47, 3, v46
  v_lshl_or_b32 v44, v44, 2, v45
  v_bfe_u32 v47, v1, 4, 1
  v_lshlrev_b32 v47, 1, v47
  v_xor_b32 v44, v44, v47
  v_bfe_u32 v47, v1, 1, 1
  v_xor_b32 v44, v44, v47
  s_lshl_b32 s94, s93, 3
  v_xor_b32 v44, s94, v44
  v_xor_b32 v47, 0, v44
  v_lshl_add_u32 v24, v47, 4, v46
  v_xor_b32 v47, 2, v44
  v_lshl_add_u32 v25, v47, 4, v46
  v_add_u32 v25, 2048, v25
  v_xor_b32 v47, 4, v44
  v_lshl_add_u32 v26, v47, 4, v46
  v_xor_b32 v47, 6, v44
  v_lshl_add_u32 v27, v47, 4, v46
  v_add_u32 v27, 2048, v27
  v_add_u32 v28, 132096, v34
  v_and_b32 v44, 31, v1
  v_lshlrev_b32 v29, 5, v44
  v_add_u32 v29, 131072, v29
  v_xor_b32 v28, s59, v28
  v_xor_b32 v29, s59, v29
  s_lshl_b32 s94, s93, 7
  s_add_u32 s94, s94, s92
  v_and_b32 v46, 3, v44
  v_lshlrev_b32 v46, 6, v46
  v_lshl_add_u32 v46, v44, 8, v46
  v_bfe_u32 v47, v44, 1, 2
  v_lshlrev_b32 v45, 1, v45
  v_xor_b32 v47, v47, v45
  v_lshl_add_u32 v46, v47, 4, v46
  v_xor_b32 v244, s94, v46
  v_xor_b32 v245, 16, v244
  v_xor_b32 v246, 64, v244
  v_xor_b32 v247, 0x50, v244
  v_lshrrev_b32 v44, 2, v1
  v_and_b32 v46, 3, v44
  v_lshlrev_b32 v46, 6, v46
  v_lshl_add_u32 v46, v44, 8, v46
  v_bfe_u32 v47, v44, 1, 2
  v_and_b32 v45, 3, v1
  v_xor_b32 v47, v47, v45
  v_lshl_add_u32 v46, v47, 4, v46
  v_xor_b32 v32, s94, v46
  v_xor_b32 v33, 64, v32
  v_lshrrev_b32 v44, 3, v1
  v_bfe_u32 v45, v1, 2, 1
  v_and_b32 v46, 3, v44
  v_xor_b32 v46, v46, v45
  v_lshlrev_b32 v46, 6, v46
  v_lshl_add_u32 v46, v44, 8, v46
  v_lshrrev_b32 v47, 1, v44
  v_and_b32 v45, 3, v1
  v_xor_b32 v47, v47, v45
  v_lshl_add_u32 v46, v47, 4, v46
  v_xor_b32 v32, s94, v46
  s_mul_i32 s87, s2, 32896
  s_lshl_b32 s97, s3, 12
  s_add_u32 s87, s87, s97
  s_add_u32 s87, s87, 0x200000
  s_lshl_b32 s94, s76, 4
  s_lshl_b32 s97, s3, 9
  s_add_u32 s94, s94, s97
  s_add_u32 s94, s94, 0x20000
  v_lshrrev_b32 v35, 3, v1
  v_lshlrev_b32 v35, 12, v35
  v_add_u32 v35, s94, v35
  v_lshlrev_b32 v248, 4, v1
  v_lshrrev_b32 v36, 3, v1
  v_mul_u32_u24 v36, 263168, v36
  v_and_b32 v3, 7, v1
  v_lshl_add_u32 v36, v3, 4, v36
  s_mul_i32 s94, s3, 32896
  s_lshl_b32 s97, s77, 12
  s_add_u32 s94, s94, s97
  s_lshl_b32 s97, s76, 7
  s_add_u32 s94, s94, s97
  s_add_u32 s83, s94, 6307840
  s_add_u32 s84, s94, 8413184
  s_add_u32 s85, s94, 2097152
  s_add_u32 s86, s94, 4202496
  s_mul_i32 s94, s3, 144
  s_add_u32 s94, s94, 0x14000
  v_and_b32 v37, 7, v1
  v_lshlrev_b32 v37, 4, v37
  v_lshrrev_b32 v3, 4, v1
  v_lshl_add_u32 v37, v3, 2, v37
  v_add_u32 v37, s94, v37
  v_and_b32 v38, 7, v1
  v_mul_u32_u24 v38, 144, v38
  v_lshrrev_b32 v3, 4, v1
  v_lshl_add_u32 v38, v3, 4, v38
  v_add_u32 v38, 81920, v38
  s_lshl_b32 s94, s3, 7
  s_add_u32 s94, s94, 0x16c00
  v_lshrrev_b32 v41, 4, v1
  v_lshlrev_b32 v41, 4, v41
  v_add_u32 v41, s94, v41
  v_and_b32 v40, 7, v1
  v_mul_u32_u24 v40, 272, v40
  v_lshrrev_b32 v3, 4, v1
  v_lshl_add_u32 v40, v3, 4, v40
  v_add_u32 v40, 94208, v40
  s_lshl_b32 s94, s76, 12
  s_lshl_b32 s97, s3, 6
  s_add_u32 s94, s94, s97
  s_add_u32 s94, s94, 0x40000
  v_bfe_u32 v39, v1, 2, 3
  v_lshlrev_b32 v39, 9, v39
  v_and_b32 v3, 3, v1
  v_lshl_add_u32 v39, v3, 4, v39
  v_add_u32 v39, s94, v39
  s_lshl_b32 s95, s77, 9
  s_add_u32 s16, s94, s95
  s_and_b32 s94, s3, 3
  s_mul_i32 s94, s94, 4864
  v_lshrrev_b32 v240, 4, v1
  v_mul_u32_u24 v240, 288, v240
  v_and_b32 v3, 15, v1
  v_lshl_add_u32 v240, v3, 4, v240
  v_add_u32 v240, s94, v240
  s_and_b32 s94, s3, 3
  s_mul_i32 s94, s94, 9728
  s_add_u32 s94, s94, 0x5000
  v_lshrrev_b32 v241, 4, v1
  v_mul_u32_u24 v241, 288, v241
  v_and_b32 v3, 15, v1
  v_lshl_add_u32 v241, v3, 4, v241
  v_add_u32 v241, s94, v241
  s_lshl_b32 s94, s3, 5
  v_lshrrev_b32 v242, 4, v1
  v_mul_u32_u24 v242, 2432, v242
  v_bfe_u32 v3, v1, 2, 2
  v_mul_u32_u24 v3, 288, v3
  v_add_u32 v242, v3, v242
  v_and_b32 v3, 3, v1
  v_lshl_add_u32 v242, v3, 3, v242
  v_add_u32 v242, s94, v242
  v_lshrrev_b32 v243, 4, v1
  v_mul_u32_u24 v243, 2432, v243
  v_bfe_u32 v3, v1, 2, 2
  v_mul_u32_u24 v3, 288, v3
  v_add_u32 v243, v3, v243
  v_and_b32 v3, 3, v1
  v_lshl_add_u32 v243, v3, 3, v243
  v_add_u32 v243, 20480, v243
  v_add_u32 v243, s94, v243
  v_bfe_u32 v43, v1, 2, 3
  v_mul_u32_u24 v43, 272, v43
  v_and_b32 v3, 3, v1
  v_lshl_add_u32 v43, v3, 3, v43
  v_add_u32 v43, 94208, v43
  v_add_u32 v43, s94, v43
  s_cmp_ge_u32 s3, 4
  s_cbranch_scc1 L_back2
  v_and_b32 v44, 31, v1
  v_and_b32 v46, 3, v44
  v_lshlrev_b32 v46, 2, v46
  v_bfe_u32 v47, v44, 2, 2
  v_or_b32 v46, v46, v47
  v_lshrrev_b32 v47, 5, v1
  v_xor_b32 v46, v46, v47
  v_lshlrev_b32 v45, 8, v44
  v_xor_b32 v47, 0, v46
  v_lshl_add_u32 v16, v47, 4, v45
  v_xor_b32 v47, 2, v46
  v_lshl_add_u32 v17, v47, 4, v45
  v_xor_b32 v47, 4, v46
  v_lshl_add_u32 v18, v47, 4, v45
  v_xor_b32 v47, 6, v46
  v_lshl_add_u32 v19, v47, 4, v45
  v_xor_b32 v47, 8, v46
  v_lshl_add_u32 v20, v47, 4, v45
  v_xor_b32 v47, 10, v46
  v_lshl_add_u32 v21, v47, 4, v45
  v_xor_b32 v47, 12, v46
  v_lshl_add_u32 v22, v47, 4, v45
  v_xor_b32 v47, 14, v46
  v_lshl_add_u32 v23, v47, 4, v45
  s_lshl_b32 s92, s17, 13
  s_add_u32 s92, s92, 131072
  v_add_u32 v8, s91, v16
  v_add_u32 v16, s92, v16
  v_add_u32 v9, s91, v17
  v_add_u32 v17, s92, v17
  v_add_u32 v10, s91, v18
  v_add_u32 v18, s92, v18
  v_add_u32 v11, s91, v19
  v_add_u32 v19, s92, v19
  v_add_u32 v12, s91, v20
  v_add_u32 v20, s92, v20
  v_add_u32 v13, s91, v21
  v_add_u32 v21, s92, v21
  v_add_u32 v14, s91, v22
  v_add_u32 v22, s92, v22
  v_add_u32 v15, s91, v23
  v_add_u32 v23, s92, v23
  s_lshl_b32 s92, s3, 2
  v_lshrrev_b32 v47, 5, v1
  v_lshl_add_u32 v30, v47, 4, v29
  v_add_u32 v30, s92, v30
  s_lshl_b32 s92, s3, 11
  v_add_u32 v31, s92, v28
  s_setprio 2
  s_mov_b32 s101, 1
  s_waitcnt vmcnt(4)
  s_barrier
  ds_read_b128 v[112:115], v8
  ds_read_b128 v[116:119], v16
  ds_read_b128 v[120:123], v9
  ds_read_b128 v[124:127], v17
  ds_read_b128 v[128:131], v10
  ds_read_b128 v[132:135], v18
  ds_read_b128 v[136:139], v11
  ds_read_b128 v[140:143], v19
  ds_read_b128 v[144:147], v12
  ds_read_b128 v[148:151], v20
  ds_read_b128 v[152:155], v13
  ds_read_b128 v[156:159], v21
  v_xor_b32 v8, 0x8000, v8
  v_xor_b32 v16, 0x2000, v16
  v_xor_b32 v9, 0x8000, v9
  v_xor_b32 v17, 0x2000, v17
  v_xor_b32 v10, 0x8000, v10
  v_xor_b32 v18, 0x2000, v18
  v_xor_b32 v11, 0x8000, v11
  v_xor_b32 v19, 0x2000, v19
  v_xor_b32 v12, 0x8000, v12
  v_xor_b32 v20, 0x2000, v20
  v_xor_b32 v13, 0x8000, v13
  v_xor_b32 v21, 0x2000, v21
  s_waitcnt lgkmcnt(10)
  v_mfma_f32_32x32x16_bf16 v[96:111], v[112:115], v[116:119], 0
  ds_read_b128 v[160:163], v14
  ds_read_b128 v[164:167], v22
  v_xor_b32 v14, 0x8000, v14
  v_xor_b32 v22, 0x2000, v22
  s_waitcnt lgkmcnt(10)
  v_mfma_f32_32x32x16_bf16 v[96:111], v[120:123], v[124:127], v[96:111]
  ds_read_b128 v[168:171], v15
  ds_read_b128 v[172:175], v23
  v_xor_b32 v15, 0x8000, v15
  v_xor_b32 v23, 0x2000, v23
  s_waitcnt lgkmcnt(10)
  v_mfma_f32_32x32x16_bf16 v[96:111], v[128:131], v[132:135], v[96:111]
  ds_read_b128 v[112:115], v8
  ds_read_b128 v[116:119], v16
  v_xor_b32 v8, 0x18000, v8
  v_xor_b32 v16, 0x6000, v16
  s_waitcnt lgkmcnt(10)
  v_mfma_f32_32x32x16_bf16 v[96:111], v[136:139], v[140:143], v[96:111]
  ds_read_b128 v[120:123], v9
  ds_read_b128 v[124:127], v17
  v_xor_b32 v9, 0x18000, v9
  v_xor_b32 v17, 0x6000, v17
  s_waitcnt lgkmcnt(10)
  v_mfma_f32_32x32x16_bf16 v[96:111], v[144:147], v[148:151], v[96:111]
  ds_read_b128 v[128:131], v10
  ds_read_b128 v[132:135], v18
  v_xor_b32 v10, 0x18000, v10
  v_xor_b32 v18, 0x6000, v18
  s_waitcnt lgkmcnt(10)
  v_mfma_f32_32x32x16_bf16 v[96:111], v[152:155], v[156:159], v[96:111]
  ds_read_b128 v[136:139], v11
  ds_read_b128 v[140:143], v19
  v_xor_b32 v11, 0x18000, v11
  v_xor_b32 v19, 0x6000, v19
  s_waitcnt lgkmcnt(10)
  v_mfma_f32_32x32x16_bf16 v[96:111], v[160:163], v[164:167], v[96:111]
  ds_read_b128 v[144:147], v12
  ds_read_b128 v[148:151], v20
  v_xor_b32 v12, 0x18000, v12
  v_xor_b32 v20, 0x6000, v20
  s_waitcnt lgkmcnt(10)
  v_mfma_f32_32x32x16_bf16 v[96:111], v[168:171], v[172:175], v[96:111]
  ds_read_b128 v[152:155], v13
  ds_read_b128 v[156:159], v21
  v_xor_b32 v13, 0x18000, v13
  v_xor_b32 v21, 0x6000, v21
  s_waitcnt lgkmcnt(10)
  v_mfma_f32_32x32x16_bf16 v[96:111], v[112:115], v[116:119], v[96:111]
  ds_read_b128 v[160:163], v14
  ds_read_b128 v[164:167], v22
  v_xor_b32 v14, 0x18000, v14
  v_xor_b32 v22, 0x6000, v22
  s_waitcnt lgkmcnt(10)
  v_mfma_f32_32x32x16_bf16 v[96:111], v[120:123], v[124:127], v[96:111]
  ds_read_b128 v[168:171], v15
  ds_read_b128 v[172:175], v23
  v_xor_b32 v15, 0x18000, v15
  v_xor_b32 v23, 0x6000, v23
  s_waitcnt lgkmcnt(10)
  v_mfma_f32_32x32x16_bf16 v[96:111], v[128:131], v[132:135], v[96:111]
  ds_read_b128 v[112:115], v8
  ds_read_b128 v[116:119], v16
  v_xor_b32 v8, 0x8000, v8
  v_xor_b32 v16, 0x2000, v16
  s_waitcnt lgkmcnt(10)
  v_mfma_f32_32x32x16_bf16 v[96:111], v[136:139], v[140:143], v[96:111]
  ds_read_b128 v[120:123], v9
  ds_read_b128 v[124:127], v17
  v_xor_b32 v9, 0x8000, v9
  v_xor_b32 v17, 0x2000, v17
  s_waitcnt lgkmcnt(10)
  v_mfma_f32_32x32x16_bf16 v[96:111], v[144:147], v[148:151], v[96:111]
  ds_read_b128 v[128:131], v10
  ds_read_b128 v[132:135], v18
  v_xor_b32 v10, 0x8000, v10
  v_xor_b32 v18, 0x2000, v18
  s_waitcnt lgkmcnt(10)
  v_mfma_f32_32x32x16_bf16 v[96:111], v[152:155], v[156:159], v[96:111]
  ds_read_b128 v[136:139], v11
  ds_read_b128 v[140:143], v19
  v_xor_b32 v11, 0x8000, v11
  v_xor_b32 v19, 0x2000, v19
  s_waitcnt lgkmcnt(10)
  v_mfma_f32_32x32x16_bf16 v[96:111], v[160:163], v[164:167], v[96:111]
  ds_read_b128 v[144:147], v12
  ds_read_b128 v[148:151], v20
  v_xor_b32 v12, 0x8000, v12
  v_xor_b32 v20, 0x2000, v20
  s_waitcnt lgkmcnt(10)
  v_mfma_f32_32x32x16_bf16 v[96:111], v[168:171], v[172:175], v[96:111]
  ds_read_b128 v[152:155], v13
  ds_read_b128 v[156:159], v21
  v_xor_b32 v13, 0x8000, v13
  v_xor_b32 v21, 0x2000, v21
  s_barrier
  s_waitcnt lgkmcnt(10)
  v_mfma_f32_32x32x16_bf16 v[96:111], v[112:115], v[116:119], v[96:111]
  ds_read_b128 v[160:163], v14
  ds_read_b128 v[164:167], v22
  v_xor_b32 v14, 0x8000, v14
  v_xor_b32 v22, 0x2000, v22
  s_waitcnt lgkmcnt(10)
  v_mfma_f32_32x32x16_bf16 v[96:111], v[120:123], v[124:127], v[96:111]
  ds_read_b128 v[168:171], v15
  ds_read_b128 v[172:175], v23
  v_xor_b32 v15, 0x8000, v15
  v_xor_b32 v23, 0x2000, v23
  s_waitcnt lgkmcnt(10)
  v_mfma_f32_32x32x16_bf16 v[96:111], v[128:131], v[132:135], v[96:111]
  s_waitcnt vmcnt(0)
  ds_read_b128 v[112:115], v8
  ds_read_b128 v[116:119], v16
  s_waitcnt lgkmcnt(10)
  v_mfma_f32_32x32x16_bf16 v[96:111], v[136:139], v[140:143], v[96:111]
  ds_read_b128 v[120:123], v9
  ds_read_b128 v[124:127], v17
  s_waitcnt lgkmcnt(10)
  v_mfma_f32_32x32x16_bf16 v[96:111], v[144:147], v[148:151], v[96:111]
  ds_read_b128 v[128:131], v10
  ds_read_b128 v[132:135], v18
  s_waitcnt lgkmcnt(10)
  v_mfma_f32_32x32x16_bf16 v[96:111], v[152:155], v[156:159], v[96:111]
  ds_read_b128 v[136:139], v11
  ds_read_b128 v[140:143], v19
  s_waitcnt lgkmcnt(10)
  v_mfma_f32_32x32x16_bf16 v[96:111], v[160:163], v[164:167], v[96:111]
  ds_read_b128 v[144:147], v12
  ds_read_b128 v[148:151], v20
  s_waitcnt lgkmcnt(10)
  v_mfma_f32_32x32x16_bf16 v[96:111], v[168:171], v[172:175], v[96:111]
  ds_read_b128 v[152:155], v13
  ds_read_b128 v[156:159], v21
  s_waitcnt lgkmcnt(10)
  v_mfma_f32_32x32x16_bf16 v[96:111], v[112:115], v[116:119], v[96:111]
  ds_read_b128 v[160:163], v14
  ds_read_b128 v[164:167], v22
  s_waitcnt lgkmcnt(10)
  v_mfma_f32_32x32x16_bf16 v[96:111], v[120:123], v[124:127], v[96:111]
  ds_read_b128 v[168:171], v15
  ds_read_b128 v[172:175], v23
  s_waitcnt lgkmcnt(10)
  v_mfma_f32_32x32x16_bf16 v[96:111], v[128:131], v[132:135], v[96:111]
  s_waitcnt lgkmcnt(8)
  v_mfma_f32_32x32x16_bf16 v[96:111], v[136:139], v[140:143], v[96:111]
  s_waitcnt lgkmcnt(6)
  v_mfma_f32_32x32x16_bf16 v[96:111], v[144:147], v[148:151], v[96:111]
  s_waitcnt lgkmcnt(4)
  v_mfma_f32_32x32x16_bf16 v[96:111], v[152:155], v[156:159], v[96:111]
  s_waitcnt lgkmcnt(2)
  v_mfma_f32_32x32x16_bf16 v[96:111], v[160:163], v[164:167], v[96:111]
  s_waitcnt lgkmcnt(0)
  v_mfma_f32_32x32x16_bf16 v[96:111], v[168:171], v[172:175], v[96:111]
  s_nop 11
  v_max3_f32 v44, v96, v97, v98
  v_max3_f32 v45, v99, v100, v101
  v_max3_f32 v46, v102, v103, v104
  v_max3_f32 v47, v105, v106, v107
  v_max3_f32 v44, v44, v108, v109
  v_max3_f32 v45, v45, v110, v111
  v_max3_f32 v44, v44, v46, v47
  v_max_f32 v44, v44, v45
  ds_write_b32 v30, v44
  v_sub_f32 v96, v96, v44
  v_sub_f32 v97, v97, v44
  v_sub_f32 v98, v98, v44
  v_sub_f32 v99, v99, v44
  v_sub_f32 v100, v100, v44
  v_sub_f32 v101, v101, v44
  v_sub_f32 v102, v102, v44
  v_sub_f32 v103, v103, v44
  s_waitcnt lgkmcnt(0)
  s_barrier
  ds_read_b128 v[48:51], v29
  ds_read_b128 v[52:55], v29 offset:16
  v_exp_f32 v96, v96
  v_sub_f32 v104, v104, v44
  v_exp_f32 v97, v97
  v_sub_f32 v105, v105, v44
  v_exp_f32 v98, v98
  v_sub_f32 v106, v106, v44
  v_exp_f32 v99, v99
  v_sub_f32 v107, v107, v44
  v_exp_f32 v100, v100
  v_sub_f32 v108, v108, v44
  v_exp_f32 v101, v101
  v_sub_f32 v109, v109, v44
  v_exp_f32 v102, v102
  v_sub_f32 v110, v110, v44
  v_exp_f32 v103, v103
  v_sub_f32 v111, v111, v44
  s_waitcnt lgkmcnt(0)
  v_max3_f32 v45, v48, v49, v50
  v_max3_f32 v46, v51, v52, v53
  v_exp_f32 v104, v104
  v_max3_f32 v45, v45, v54, v55
  v_exp_f32 v105, v105
  v_max_f32 v45, v45, v46
  v_exp_f32 v106, v106
  v_sub_f32 v45, v44, v45
  v_exp_f32 v107, v107
  v_exp_f32 v45, v45
  v_exp_f32 v108, v108
  v_exp_f32 v109, v109
  v_exp_f32 v110, v110
  v_exp_f32 v111, v111
  v_mul_f32 v96, v96, v45
  v_mul_f32 v97, v97, v45
  v_mul_f32 v98, v98, v45
  v_mul_f32 v99, v99, v45
  v_mul_f32 v100, v100, v45
  v_mul_f32 v101, v101, v45
  v_mul_f32 v102, v102, v45
  v_mul_f32 v103, v103, v45
  v_cvt_pk_bf16_f32 v48, v96, v97
  v_cvt_pk_bf16_f32 v49, v98, v99
  v_cvt_pk_bf16_f32 v50, v100, v101
  v_cvt_pk_bf16_f32 v51, v102, v103
  ds_write_b128 v31, v[48:51] offset:0
  v_mul_f32 v104, v104, v45
  v_mul_f32 v105, v105, v45
  v_mul_f32 v106, v106, v45
  v_mul_f32 v107, v107, v45
  v_mul_f32 v108, v108, v45
  v_mul_f32 v109, v109, v45
  v_mul_f32 v110, v110, v45
  v_mul_f32 v111, v111, v45
  v_cvt_pk_bf16_f32 v52, v104, v105
  v_cvt_pk_bf16_f32 v53, v106, v107
  v_cvt_pk_bf16_f32 v54, v108, v109
  v_cvt_pk_bf16_f32 v55, v110, v111
  ds_write_b128 v31, v[52:55] offset:1024
  v_add_f32 v96, v96, v97
  v_add_f32 v98, v98, v99
  v_add_f32 v100, v100, v101
  v_add_f32 v102, v102, v103
  v_add_f32 v104, v104, v105
  v_add_f32 v106, v106, v107
  v_add_f32 v108, v108, v109
  v_add_f32 v110, v110, v111
  v_add_f32 v96, v96, v98
  v_add_f32 v100, v100, v102
  v_add_f32 v104, v104, v106
  v_add_f32 v108, v108, v110
  v_add_f32 v96, v96, v100
  v_add_f32 v104, v104, v108
  v_add_f32 v96, v96, v104
  ds_write_b32 v30, v96 offset:9216
  s_waitcnt lgkmcnt(0)
  s_barrier
L_pv:
  s_setprio 2
  ds_read_b128 v[48:51], v28 offset:0
  ds_read_b64_tr_b16 v[112:113], v24 offset:0
  ds_read_b64_tr_b16 v[114:115], v25 offset:0
  ds_read_b128 v[52:55], v28 offset:1024
  ds_read_b64_tr_b16 v[116:117], v24 offset:4096
  ds_read_b64_tr_b16 v[118:119], v25 offset:4096
  ds_read_b128 v[56:59], v28 offset:2048
  ds_read_b64_tr_b16 v[120:121], v24 offset:8192
  ds_read_b64_tr_b16 v[122:123], v25 offset:8192
  ds_read_b128 v[60:63], v28 offset:3072
  ds_read_b64_tr_b16 v[124:125], v24 offset:12288
  ds_read_b64_tr_b16 v[126:127], v25 offset:12288
  s_lshl_b32 s74, s2, 9
  s_add_u32 s74, s74, 0x20000
  s_mov_b32 s70, 0x10000
  s_mov_b32 s71, 0x18000
  s_mov_b32 s72, 0x8000
  s_cmp_lg_u32 s3, 7
  s_cbranch_scc1 L_nolse
  ds_read_b128 v[144:147], v29
  ds_read_b128 v[148:151], v29 offset:16
  s_waitcnt lgkmcnt(6)
  ds_read_b128 v[152:155], v29 offset:9216
  ds_read_b128 v[156:159], v29 offset:9232
  s_andn2_b32 s92, s48, 1
  v_mov_b32 v23, s92
  s_waitcnt lgkmcnt(2)
  v_max3_f32 v20, v144, v145, v146
  v_max3_f32 v21, v147, v148, v149
  v_max3_f32 v20, v20, v150, v151
  v_max_f32 v20, v20, v21
  s_waitcnt lgkmcnt(0)
  v_add_f32 v152, v152, v153
  v_add_f32 v154, v154, v155
  v_add_f32 v156, v156, v157
  v_add_f32 v158, v158, v159
  v_add_f32 v152, v152, v154
  v_add_f32 v156, v156, v158
  v_add_f32 v152, v152, v156
  v_mov_b32 v21, v152
  s_mov_b32 exec_hi, 0
  buffer_store_dwordx4 v[20:23], v248, s[32:35], s74 offen sc1
  s_mov_b32 exec_hi, -1
L_nolse:
  s_waitcnt lgkmcnt(9)
  v_mfma_f32_32x32x16_bf16 v[144:159], v[112:115], v[48:51], 0
  ds_read_b128 v[64:67], v28 offset:4096
  ds_read_b64_tr_b16 v[128:129], v24 offset:16384
  ds_read_b64_tr_b16 v[130:131], v25 offset:16384
  s_waitcnt lgkmcnt(9)
  v_mfma_f32_32x32x16_bf16 v[144:159], v[116:119], v[52:55], v[144:159]
  ds_read_b128 v[68:71], v28 offset:5120
  ds_read_b64_tr_b16 v[132:133], v24 offset:20480
  ds_read_b64_tr_b16 v[134:135], v25 offset:20480
  v_lshrrev_b32 v44, 5, v1
  v_lshlrev_b32 v44, 3, v44
  v_lshrrev_b32 v96, v44, v249
  v_lshrrev_b32 v104, v44, v250
  s_waitcnt lgkmcnt(9)
  v_mfma_f32_32x32x16_bf16 v[144:159], v[120:123], v[56:59], v[144:159]
  ds_read_b128 v[72:75], v28 offset:6144
  ds_read_b64_tr_b16 v[136:137], v24 offset:24576
  ds_read_b64_tr_b16 v[138:139], v25 offset:24576
  v_lshrrev_b32 v97, 1, v96
  v_lshrrev_b32 v98, 2, v96
  v_lshrrev_b32 v99, 3, v96
  s_waitcnt lgkmcnt(9)
  v_mfma_f32_32x32x16_bf16 v[144:159], v[124:127], v[60:63], v[144:159]
  ds_read_b128 v[76:79], v28 offset:7168
  ds_read_b64_tr_b16 v[140:141], v24 offset:28672
  ds_read_b64_tr_b16 v[142:143], v25 offset:28672
  v_lshrrev_b32 v100, 4, v96
  v_lshrrev_b32 v101, 5, v96
  v_lshrrev_b32 v102, 6, v96
  v_lshrrev_b32 v103, 7, v96
  s_waitcnt lgkmcnt(9)
  v_mfma_f32_32x32x16_bf16 v[144:159], v[128:131], v[64:67], v[144:159]
  ds_read_b64_tr_b16 v[112:113], v26 offset:0
  ds_read_b64_tr_b16 v[114:115], v27 offset:0
  v_lshrrev_b32 v105, 1, v104
  v_lshrrev_b32 v106, 2, v104
  v_lshrrev_b32 v107, 3, v104
  s_waitcnt lgkmcnt(8)
  v_mfma_f32_32x32x16_bf16 v[144:159], v[132:135], v[68:71], v[144:159]
  ds_read_b64_tr_b16 v[116:117], v26 offset:4096
  ds_read_b64_tr_b16 v[118:119], v27 offset:4096
  v_lshrrev_b32 v108, 4, v104
  v_lshrrev_b32 v109, 5, v104
  v_lshrrev_b32 v110, 6, v104
  v_lshrrev_b32 v111, 7, v104
  s_waitcnt lgkmcnt(7)
  v_mfma_f32_32x32x16_bf16 v[144:159], v[136:139], v[72:75], v[144:159]
  ds_read_b64_tr_b16 v[120:121], v26 offset:8192
  ds_read_b64_tr_b16 v[122:123], v27 offset:8192
  s_waitcnt lgkmcnt(6)
  v_mfma_f32_32x32x16_bf16 v[144:159], v[140:143], v[76:79], v[144:159]
  ds_read_b64_tr_b16 v[124:125], v26 offset:12288
  ds_read_b64_tr_b16 v[126:127], v27 offset:12288
  s_waitcnt lgkmcnt(6)
  v_mfma_f32_32x32x16_bf16 v[160:175], v[112:115], v[48:51], 0
  ds_read_b64_tr_b16 v[128:129], v26 offset:16384
  ds_read_b64_tr_b16 v[130:131], v27 offset:16384
  s_waitcnt lgkmcnt(6)
  v_mfma_f32_32x32x16_bf16 v[160:175], v[116:119], v[52:55], v[160:175]
  ds_read_b64_tr_b16 v[132:133], v26 offset:20480
  ds_read_b64_tr_b16 v[134:135], v27 offset:20480
  s_waitcnt lgkmcnt(6)
  v_mfma_f32_32x32x16_bf16 v[160:175], v[120:123], v[56:59], v[160:175]
  ds_read_b64_tr_b16 v[136:137], v26 offset:24576
  ds_read_b64_tr_b16 v[138:139], v27 offset:24576
  v_cvt_pk_bf16_f32 v80, v144, v145
  v_cvt_pk_bf16_f32 v81, v146, v147
  v_cvt_pk_bf16_f32 v82, v148, v149
  v_cvt_pk_bf16_f32 v83, v150, v151
  v_bfi_b32 v80, s53, v96, v80
  v_bfi_b32 v81, s53, v97, v81
  v_bfi_b32 v82, s53, v98, v82
  v_bfi_b32 v83, s53, v99, v83
  ds_write_b128 v244, v[80:83]
  s_waitcnt lgkmcnt(7)
  v_mfma_f32_32x32x16_bf16 v[160:175], v[124:127], v[60:63], v[160:175]
  ds_read_b64_tr_b16 v[140:141], v26 offset:28672
  ds_read_b64_tr_b16 v[142:143], v27 offset:28672
  v_cvt_pk_bf16_f32 v84, v152, v153
  v_cvt_pk_bf16_f32 v85, v154, v155
  v_cvt_pk_bf16_f32 v86, v156, v157
  v_cvt_pk_bf16_f32 v87, v158, v159
  v_bfi_b32 v84, s53, v100, v84
  v_bfi_b32 v85, s53, v101, v85
  v_bfi_b32 v86, s53, v102, v86
  v_bfi_b32 v87, s53, v103, v87
  ds_write_b128 v245, v[84:87]
  s_waitcnt lgkmcnt(8)
  v_mfma_f32_32x32x16_bf16 v[160:175], v[128:131], v[64:67], v[160:175]
  s_waitcnt lgkmcnt(6)
  v_mfma_f32_32x32x16_bf16 v[160:175], v[132:135], v[68:71], v[160:175]
  s_waitcnt lgkmcnt(4)
  v_mfma_f32_32x32x16_bf16 v[160:175], v[136:139], v[72:75], v[160:175]
  s_waitcnt lgkmcnt(1)
  v_mfma_f32_32x32x16_bf16 v[160:175], v[140:143], v[76:79], v[160:175]
  s_setprio 2
  s_nop 10
  v_cvt_pk_bf16_f32 v88, v160, v161
  v_cvt_pk_bf16_f32 v89, v162, v163
  v_cvt_pk_bf16_f32 v90, v164, v165
  v_cvt_pk_bf16_f32 v91, v166, v167
  v_bfi_b32 v88, s53, v104, v88
  v_bfi_b32 v89, s53, v105, v89
  v_bfi_b32 v90, s53, v106, v90
  v_bfi_b32 v91, s53, v107, v91
  ds_write_b128 v246, v[88:91]
  v_cvt_pk_bf16_f32 v92, v168, v169
  v_cvt_pk_bf16_f32 v93, v170, v171
  v_cvt_pk_bf16_f32 v94, v172, v173
  v_cvt_pk_bf16_f32 v95, v174, v175
  v_bfi_b32 v92, s53, v108, v92
  v_bfi_b32 v93, s53, v109, v93
  v_bfi_b32 v94, s53, v110, v94
  v_bfi_b32 v95, s53, v111, v95
  ds_write_b128 v247, v[92:95]
  ds_read_b128 v[112:115], v32 offset:0
  ds_read_b128 v[116:119], v32 offset:2048
  ds_read_b128 v[120:123], v32 offset:4096
  ds_read_b128 v[124:127], v32 offset:6144
  s_waitcnt lgkmcnt(3)
  buffer_store_dwordx4 v[112:115], v34, s[32:35], s87 offen offset:0 sc1
  s_waitcnt lgkmcnt(2)
  buffer_store_dwordx4 v[116:119], v34, s[32:35], s87 offen offset:1024 sc1
  s_waitcnt lgkmcnt(1)
  buffer_store_dwordx4 v[120:123], v34, s[32:35], s87 offen offset:2048 sc1
  s_waitcnt lgkmcnt(0)
  buffer_store_dwordx4 v[124:127], v34, s[32:35], s87 offen offset:3072 sc1
  s_setprio 0
  s_barrier
  s_cmp_lg_u32 s3, 7
  s_cbranch_scc1 L_nolse2
  v_or_b32 v23, 1, v23
  s_mov_b32 exec_hi, 0
  buffer_store_dwordx4 v[20:23], v248, s[32:35], s74 offen sc1
  s_mov_b32 exec_hi, -1
L_nolse2:
  s_mov_b32 s73, 0
  s_or_b32 s69, s48, 1
  buffer_load_dwordx4 v[8:11], v35, s[32:35], s70 offen offset:0 sc1
  buffer_load_dwordx4 v[12:15], v35, s[32:35], s71 offen offset:0 sc1
  buffer_load_dwordx4 v[16:19], v35, s[32:35], 0 offen offset:0 sc1
  buffer_load_dwordx4 v[20:23], v35, s[32:35], s72 offen offset:0 sc1
  s_cmp_lt_u32 s2, 128
  s_cbranch_scc1 L_prepA
  s_and_b32 s92, s3, 3
  s_mul_i32 s92, s92, 7552
  s_add_u32 s92, s92, 0x5000
  v_lshrrev_b32 v62, 5, v1
  v_mul_u32_u24 v62, 928, v62
  v_and_b32 v3, 31, v1
  v_lshl_add_u32 v62, v3, 4, v62
  v_add_u32 v62, s92, v62
  s_lshl_b32 s92, s3, 6
  v_lshrrev_b32 v63, 4, v1
  v_mul_u32_u24 v63, 7552, v63
  v_bfe_u32 v3, v1, 2, 2
  v_mul_u32_u24 v3, 928, v3
  v_add_u32 v63, v3, v63
  v_and_b32 v3, 3, v1
  v_lshl_add_u32 v63, v3, 3, v63
  v_add_u32 v63, 20480, v63
  v_add_u32 v63, s92, v63
  s_mul_i32 s82, s80, 28672
  s_lshl_b32 s97, s3, 12
  s_add_u32 s82, s82, s97
  s_lshl_b32 s97, s79, 8
  s_add_u32 s82, s82, s97
  s_lshr_b32 s92, s79, 1
  s_lshl_b32 s92, s92, 10
  s_and_b32 s97, s79, 1
  s_lshl_b32 s97, s97, 7
  s_add_u32 s92, s92, s97
  s_add_u32 s92, s92, 0x4000
  v_bfe_u32 v56, v1, 3, 1
  v_lshlrev_b32 v56, 13, v56
  v_lshrrev_b32 v3, 4, v1
  v_lshl_add_u32 v56, v3, 8, v56
  v_and_b32 v3, 7, v1
  v_lshl_add_u32 v56, v3, 4, v56
  v_add_u32 v56, s92, v56
  v_and_b32 v60, 31, v1
  v_lshlrev_b32 v60, 5, v60
  v_add_u32 v60, 90112, v60
  s_lshl_b32 s92, s3, 2
  s_add_u32 s92, s92, 0x16000
  v_and_b32 v59, 7, v1
  v_lshlrev_b32 v59, 7, v59
  v_lshrrev_b32 v3, 4, v1
  v_lshl_add_u32 v59, v3, 5, v59
  v_add_u32 v59, s92, v59
  s_lshl_b32 s92, s3, 7
  s_add_u32 s92, s92, 0x16c00
  v_and_b32 v57, 31, v1
  v_lshlrev_b32 v57, 1, v57
  v_add_u32 v57, s92, v57
  s_mul_i32 s90, s79, 4224
  s_lshl_b32 s97, s3, 9
  s_add_u32 s90, s90, s97
  s_add_u32 s90, s90, 0x60000
  v_and_b32 v61, 31, v1
  v_lshlrev_b32 v61, 4, v61
  v_and_b32 v58, 3, v1
  v_lshlrev_b32 v58, 6, v58
  v_lshrrev_b32 v3, 4, v1
  v_lshl_add_u32 v58, v3, 4, v58
  s_lshl_b32 s92, s79, 6
  v_and_b32 v44, 31, v1
  v_lshlrev_b32 v44, 1, v44
  v_add_u32 v44, s92, v44
  global_load_ushort v66, v44, s[4:5]
  s_movk_i32 s68, 0x4000
  buffer_load_dwordx4 v[68:71], v56, s[32:35], 0 offen offset:0 sc1
  buffer_load_dwordx4 v[72:75], v56, s[32:35], s68 offen offset:0 sc1
  s_branch L_prep2
L_prepA:
  s_sub_u32 s92, s2, 56
  s_cmp_ge_u32 s2, 56
  s_cselect_b32 s81, s92, s2
  s_cselect_b32 s93, 1, 0
  s_lshl_b32 s91, s81, 15
  s_lshl_b32 s97, s3, 12
  s_add_u32 s91, s91, s97
  s_lshl_b32 s97, s93, 9
  s_add_u32 s91, s91, s97
  s_mul_i32 s75, s77, 16896
  s_lshr_b32 s97, s3, 1
  s_mul_i32 s97, s97, 4224
  s_add_u32 s75, s75, s97
  s_lshl_b32 s97, s76, 7
  s_add_u32 s75, s75, s97
  s_and_b32 s97, s3, 1
  s_lshl_b32 s97, s97, 6
  s_add_u32 s75, s75, s97
  s_add_u32 s75, s75, 0x60000
  s_mul_i32 s90, s93, 67584
  s_mul_i32 s97, s3, 8448
  s_add_u32 s90, s90, s97
  s_lshl_b32 s97, s81, 7
  s_add_u32 s90, s90, s97
  s_add_u32 s90, s90, 0xa0000
  s_mul_i32 s92, s3, 2176
  s_lshr_b32 s97, s3, 1
  s_lshl_b32 s97, s97, 7
  s_add_u32 s92, s92, s97
  s_add_u32 s92, s92, 0xe800
  v_lshrrev_b32 v62, 5, v1
  v_mul_u32_u24 v62, 544, v62
  v_and_b32 v3, 31, v1
  v_lshl_add_u32 v62, v3, 4, v62
  v_add_u32 v62, s92, v62
  s_lshl_b32 s92, s3, 6
  v_lshrrev_b32 v63, 4, v1
  v_mul_u32_u24 v63, 4480, v63
  v_bfe_u32 v3, v1, 2, 2
  v_mul_u32_u24 v3, 544, v3
  v_add_u32 v63, v3, v63
  v_and_b32 v3, 3, v1
  v_lshl_add_u32 v63, v3, 3, v63
  v_add_u32 v63, 59392, v63
  v_add_u32 v63, s92, v63
  s_lshl_b32 s82, s81, 12
  s_lshl_b32 s97, s3, 9
  s_add_u32 s82, s82, s97
  s_add_u32 s82, s82, 0xd0000
  s_lshl_b32 s92, s3, 7
  s_add_u32 s92, s92, 0x16c00
  v_and_b32 v57, 7, v1
  v_lshlrev_b32 v57, 3, v57
  v_lshrrev_b32 v3, 4, v1
  v_lshl_add_u32 v57, v3, 1, v57
  v_add_u32 v57, s92, v57
  v_and_b32 v61, 31, v1
  v_lshlrev_b32 v61, 4, v61
  v_and_b32 v58, 1, v1
  v_lshlrev_b32 v58, 6, v58
  v_lshrrev_b32 v3, 4, v1
  v_lshl_add_u32 v58, v3, 4, v58
  s_mul_i32 s92, s81, 37
  s_lshr_b32 s92, s92, 8
  s_lshl_b32 s92, s92, 11
  v_and_b32 v56, 15, v1
  v_lshlrev_b32 v56, 7, v56
  v_add_u32 v56, 98304, v56
  v_add_u32 v56, s92, v56
  s_lshl_b32 s92, s3, 2
  s_add_u32 s92, s92, 0x14800
  v_lshlrev_b32 v59, 5, v1
  v_add_u32 v59, s92, v59
  s_bfe_u32 s92, s3, 0x10002
  s_lshl_b32 s92, s92, 10
  s_and_b32 s97, s3, 3
  s_lshl_b32 s97, s97, 2
  s_add_u32 s92, s92, s97
  s_add_u32 s92, s92, 0x15800
  v_lshlrev_b32 v60, 4, v1
  v_add_u32 v60, s92, v60
L_prep2:
  s_cmp_lg_u32 s101, 0
  s_cbranch_scc1 L_nsg
  s_waitcnt vmcnt(8)
  ds_write_b128 v240, v[176:179] offset:0
  ds_write_b128 v240, v[180:183] offset:1152
  ds_write_b128 v240, v[184:187] offset:2432
  ds_write_b128 v240, v[188:191] offset:3584
  s_cmp_lt_u32 s2, 128
  s_cbranch_scc1 L_sf_34a
  s_mov_b32 exec_lo, 0xfffffff
  s_mov_b32 exec_hi, 0xfffffff
  ds_write_b128 v62, v[208:211] offset:0
  ds_write_b128 v62, v[212:215] offset:448
  ds_write_b128 v62, v[216:219] offset:1856
  ds_write_b128 v62, v[220:223] offset:2304
  ds_write_b128 v62, v[224:227] offset:3712
  ds_write_b128 v62, v[228:231] offset:4160
  ds_write_b128 v62, v[232:235] offset:5568
  ds_write_b128 v62, v[236:239] offset:6016
  s_mov_b64 exec, -1
  s_branch L_sf_34x
L_sf_34a:
  ds_write_b128 v241, v[208:211] offset:0
  ds_write_b128 v241, v[212:215] offset:1152
  ds_write_b128 v241, v[216:219] offset:2432
  ds_write_b128 v241, v[220:223] offset:3584
  ds_write_b128 v241, v[224:227] offset:4864
  ds_write_b128 v241, v[228:231] offset:6016
  ds_write_b128 v241, v[232:235] offset:7296
  ds_write_b128 v241, v[236:239] offset:8448
L_sf_34x:
L_nsg:
  s_waitcnt vmcnt(0)
  s_mov_b32 s100, 0
L_p1:
  v_cmp_ne_u32 s[60:61], s69, v11
  v_cmp_ne_u32 s[62:63], s69, v15
  v_cmp_ne_u32 s[64:65], s69, v19
  v_cmp_ne_u32 s[66:67], s69, v23
  v_xor_b32 v44, s69, v11
  v_bitop3_b32 v44, v15, s69, v44 bitop3:0xbe
  v_bitop3_b32 v44, v19, s69, v44 bitop3:0xbe
  v_bitop3_b32 v44, v23, s69, v44 bitop3:0xbe
  v_cmp_lt_u32 s[92:93], 1, v44
  s_mov_b32 s94, 0
  s_cmp_eq_u64 s[92:93], 0
  s_cbranch_scc1 L_p1d
  s_add_u32 s100, s100, 1
  s_cmp_gt_u32 s100, 1000000
  s_cbranch_scc1 L_abort
  s_mov_b64 exec, s[60:61]
  s_cbranch_execz L_ll_35
  buffer_load_dwordx4 v[8:11], v35, s[32:35], s70 offen offset:0 sc1
L_ll_35:
  s_mov_b64 exec, s[62:63]
  s_cbranch_execz L_ll_36
  buffer_load_dwordx4 v[12:15], v35, s[32:35], s71 offen offset:0 sc1
L_ll_36:
  s_mov_b64 exec, s[64:65]
  s_cbranch_execz L_ll_37
  buffer_load_dwordx4 v[16:19], v35, s[32:35], 0 offen offset:0 sc1
L_ll_37:
  s_mov_b64 exec, s[66:67]
  s_cbranch_execz L_ll_38
  buffer_load_dwordx4 v[20:23], v35, s[32:35], s72 offen offset:0 sc1
L_ll_38:
  s_mov_b64 exec, -1
L_p1d:
  s_bitcmp1_b32 s73, 0
  s_cbranch_scc1 L_lp_39
  s_cmp_lg_u64 s[60:61], 0
  s_cbranch_scc1 L_lp_39
  s_bitset1_b32 s73, 0
  s_add_u32 s94, s94, 1
  buffer_load_dwordx4 v[128:131], v36, s[32:35], s83 offen offset:0 sc1
L_lp_39:
  s_bitcmp1_b32 s73, 1
  s_cbranch_scc1 L_lp_40
  s_cmp_lg_u64 s[62:63], 0
  s_cbranch_scc1 L_lp_40
  s_bitset1_b32 s73, 1
  s_add_u32 s94, s94, 1
  buffer_load_dwordx4 v[132:135], v36, s[32:35], s84 offen offset:0 sc1
L_lp_40:
  s_bitcmp1_b32 s73, 2
  s_cbranch_scc1 L_lp_41
  s_cmp_lg_u64 s[64:65], 0
  s_cbranch_scc1 L_lp_41
  s_bitset1_b32 s73, 2
  s_add_u32 s94, s94, 1
  buffer_load_dwordx4 v[136:139], v36, s[32:35], s85 offen offset:0 sc1
L_lp_41:
  s_bitcmp1_b32 s73, 3
  s_cbranch_scc1 L_lp_42
  s_cmp_lg_u64 s[66:67], 0
  s_cbranch_scc1 L_lp_42
  s_bitset1_b32 s73, 3
  s_add_u32 s94, s94, 1
  buffer_load_dwordx4 v[140:143], v36, s[32:35], s86 offen offset:0 sc1
L_lp_42:
  s_cmp_eq_u64 s[92:93], 0
  s_cbranch_scc1 L_p1x
  s_cmp_eq_u32 s94, 0
  s_cbranch_scc0 L_pw0
  s_waitcnt vmcnt(0)
  s_branch L_p1
L_pw0:
  s_cmp_eq_u32 s94, 1
  s_cbranch_scc0 L_pw1
  s_waitcnt vmcnt(1)
  s_branch L_p1
L_pw1:
  s_cmp_eq_u32 s94, 2
  s_cbranch_scc0 L_pw2
  s_waitcnt vmcnt(2)
  s_branch L_p1
L_pw2:
  s_cmp_eq_u32 s94, 3
  s_cbranch_scc0 L_pw3
  s_waitcnt vmcnt(3)
  s_branch L_p1
L_pw3:
  s_waitcnt vmcnt(4)
  s_branch L_p1
L_p1x:
  v_max3_f32 v44, v8, v12, v16
  v_max_f32 v44, v44, v20
  s_nop 1
  v_max_f32_dpp v44, v44, v44 row_ror:8 row_mask:0xf bank_mask:0xf
  v_mov_b32 v45, v44
  s_nop 1
  v_permlane16_swap_b32 v44, v45
  v_max_f32 v44, v44, v45
  v_mov_b32 v45, v44
  s_nop 1
  v_permlane32_swap_b32 v44, v45
  v_max_f32 v44, v44, v45
  s_lshl_b32 s92, s3, 2
  s_add_u32 s92, s92, 92160
  v_mov_b32 v47, s92
  v_mov_b32 v46, 92160
  ds_write_b32 v47, v44
  s_waitcnt lgkmcnt(0)
  s_barrier
  ds_read_b128 v[144:147], v46
  ds_read_b128 v[148:151], v46 offset:16
  ds_read_b64_tr_b16 v[48:49], v242 offset:0
  ds_read_b64_tr_b16 v[50:51], v242 offset:1152
  ds_read_b64_tr_b16 v[52:53], v242 offset:9728
  ds_read_b64_tr_b16 v[54:55], v242 offset:10880
  s_waitcnt lgkmcnt(4)
  v_max3_f32 v44, v144, v145, v146
  v_max3_f32 v45, v147, v148, v149
  v_max3_f32 v44, v44, v150, v151
  v_max_f32 v44, v44, v45
  v_sub_f32 v152, v8, v44
  v_sub_f32 v153, v12, v44
  v_sub_f32 v154, v16, v44
  v_sub_f32 v155, v20, v44
  v_exp_f32 v152, v152
  v_exp_f32 v153, v153
  v_exp_f32 v154, v154
  v_exp_f32 v155, v155
  v_cvt_pk_bf16_f32 v152, v152, v152
  v_cvt_pk_bf16_f32 v153, v153, v153
  v_cvt_pk_bf16_f32 v154, v154, v154
  v_cvt_pk_bf16_f32 v155, v155, v155
  v_lshrrev_b32 v156, 16, v152
  v_lshrrev_b32 v157, 16, v153
  v_lshrrev_b32 v158, 16, v154
  v_lshrrev_b32 v159, 16, v155
  v_and_b32 v152, 0xffff0000, v152
  v_and_b32 v153, 0xffff0000, v153
  v_and_b32 v154, 0xffff0000, v154
  v_and_b32 v155, 0xffff0000, v155
  v_mul_f32 v44, v152, v9
  v_fmac_f32 v44, v153, v13
  v_fmac_f32 v44, v154, v17
  v_fmac_f32 v44, v155, v21
  s_nop 1
  v_add_f32_dpp v44, v44, v44 row_ror:8 row_mask:0xf bank_mask:0xf
  v_mov_b32 v45, v44
  s_nop 1
  v_permlane16_swap_b32 v44, v45
  v_add_f32 v44, v44, v45
  v_mov_b32 v45, v44
  s_nop 1
  v_permlane32_swap_b32 v44, v45
  v_add_f32 v44, v44, v45
  ds_write_b32 v47, v44 offset:32
  s_cmp_lt_u32 s2, 128
  s_cbranch_scc1 L_fgA
  ds_read_b64_tr_b16 v[80:81], v63 offset:0
  ds_read_b64_tr_b16 v[82:83], v63 offset:3712
  ds_read_b64_tr_b16 v[84:85], v63 offset:32
  ds_read_b64_tr_b16 v[86:87], v63 offset:3744
  ds_read_b64_tr_b16 v[88:89], v63 offset:448
  ds_read_b64_tr_b16 v[90:91], v63 offset:4160
  ds_read_b64_tr_b16 v[92:93], v63 offset:480
  ds_read_b64_tr_b16 v[94:95], v63 offset:4192
  s_branch L_fgx
L_fgA:
  ds_read_b64_tr_b16 v[80:81], v243 offset:0
  ds_read_b64_tr_b16 v[82:83], v243 offset:1152
  ds_read_b64_tr_b16 v[84:85], v243 offset:9728
  ds_read_b64_tr_b16 v[86:87], v243 offset:10880
  ds_read_b64_tr_b16 v[88:89], v243 offset:19456
  ds_read_b64_tr_b16 v[90:91], v243 offset:20608
  ds_read_b64_tr_b16 v[92:93], v243 offset:29184
  ds_read_b64_tr_b16 v[94:95], v243 offset:30336
L_fgx:
  s_waitcnt lgkmcnt(0)
  s_barrier
  ds_read_b128 v[160:163], v46 offset:32
  ds_read_b128 v[164:167], v46 offset:48
  v_mov_b32 v144, 0
  v_mov_b32 v145, 0
  v_mov_b32 v146, 0
  v_mov_b32 v147, 0
  v_mov_b32 v148, 0
  v_mov_b32 v149, 0
  v_mov_b32 v150, 0
  v_mov_b32 v151, 0
  s_waitcnt lgkmcnt(0)
  v_add_f32 v160, v160, v161
  v_add_f32 v162, v162, v163
  v_add_f32 v164, v164, v165
  v_add_f32 v166, v166, v167
  v_add_f32 v160, v160, v162
  v_add_f32 v164, v164, v166
  v_add_f32 v160, v160, v164
  v_rcp_f32 v168, v160
  s_bitcmp1_b32 s73, 0
  s_cbranch_scc1 L_ir_43
  buffer_load_dwordx4 v[128:131], v36, s[32:35], s83 offen offset:0 sc1
L_ir_43:
  s_bitcmp1_b32 s73, 1
  s_cbranch_scc1 L_ir_44
  buffer_load_dwordx4 v[132:135], v36, s[32:35], s84 offen offset:0 sc1
L_ir_44:
  s_bitcmp1_b32 s73, 2
  s_cbranch_scc1 L_ir_45
  buffer_load_dwordx4 v[136:139], v36, s[32:35], s85 offen offset:0 sc1
L_ir_45:
  s_bitcmp1_b32 s73, 3
  s_cbranch_scc1 L_ir_46
  buffer_load_dwordx4 v[140:143], v36, s[32:35], s86 offen offset:0 sc1
L_ir_46:
  s_or_b32 s73, s73, 15
  s_mov_b32 s100, 0
L_p2:
  s_mov_b32 s95, s73
  s_waitcnt vmcnt(0)
  s_bitcmp1_b32 s95, 0
  s_cbranch_scc0 L_dc_47
  s_bitcmp1_b32 s95, 4
  s_cbranch_scc1 L_dc_47
  v_xor_b32 v44, v128, v4
  v_bitop3_b32 v44, v129, v5, v44 bitop3:0xbe
  v_bitop3_b32 v44, v130, v6, v44 bitop3:0xbe
  v_bitop3_b32 v44, v131, v7, v44 bitop3:0xbe
  v_and_b32 v44, s53, v44
  v_cmp_ne_u32 vcc, 0, v44
  s_nop 0
  s_cbranch_vccz L_dc_47k
  s_sleep 1
  buffer_load_dwordx4 v[128:131], v36, s[32:35], s83 offen offset:0 sc1
  s_branch L_dc_47
L_dc_47k:
  s_bitset1_b32 s73, 4
  v_dot2c_f32_bf16 v144, v156, v128
  v_dot2c_f32_bf16 v145, v152, v128
  v_dot2c_f32_bf16 v146, v156, v129
  v_dot2c_f32_bf16 v147, v152, v129
  v_dot2c_f32_bf16 v148, v156, v130
  v_dot2c_f32_bf16 v149, v152, v130
  v_dot2c_f32_bf16 v150, v156, v131
  v_dot2c_f32_bf16 v151, v152, v131
L_dc_47:
  s_bitcmp1_b32 s95, 1
  s_nop 0
  s_cbranch_scc0 L_dc_48
  s_bitcmp1_b32 s95, 5
  s_cbranch_scc1 L_dc_48
  v_xor_b32 v44, v132, v4
  v_bitop3_b32 v44, v133, v5, v44 bitop3:0xbe
  v_bitop3_b32 v44, v134, v6, v44 bitop3:0xbe
  v_bitop3_b32 v44, v135, v7, v44 bitop3:0xbe
  v_and_b32 v44, s53, v44
  v_cmp_ne_u32 vcc, 0, v44
  s_nop 0
  s_cbranch_vccz L_dc_48k
  s_sleep 1
  buffer_load_dwordx4 v[132:135], v36, s[32:35], s84 offen offset:0 sc1
  s_branch L_dc_48
L_dc_48k:
  s_bitset1_b32 s73, 5
  v_dot2c_f32_bf16 v144, v157, v132
  v_dot2c_f32_bf16 v145, v153, v132
  v_dot2c_f32_bf16 v146, v157, v133
  v_dot2c_f32_bf16 v147, v153, v133
  v_dot2c_f32_bf16 v148, v157, v134
  v_dot2c_f32_bf16 v149, v153, v134
  v_dot2c_f32_bf16 v150, v157, v135
  v_dot2c_f32_bf16 v151, v153, v135
L_dc_48:
  s_bitcmp1_b32 s95, 2
  s_nop 0
  s_cbranch_scc0 L_dc_49
  s_bitcmp1_b32 s95, 6
  s_cbranch_scc1 L_dc_49
  v_xor_b32 v44, v136, v4
  v_bitop3_b32 v44, v137, v5, v44 bitop3:0xbe
  v_bitop3_b32 v44, v138, v6, v44 bitop3:0xbe
  v_bitop3_b32 v44, v139, v7, v44 bitop3:0xbe
  v_and_b32 v44, s53, v44
  v_cmp_ne_u32 vcc, 0, v44
  s_nop 0
  s_cbranch_vccz L_dc_49k
  s_sleep 1
  buffer_load_dwordx4 v[136:139], v36, s[32:35], s85 offen offset:0 sc1
  s_branch L_dc_49
L_dc_49k:
  s_bitset1_b32 s73, 6
  v_dot2c_f32_bf16 v144, v158, v136
  v_dot2c_f32_bf16 v145, v154, v136
  v_dot2c_f32_bf16 v146, v158, v137
  v_dot2c_f32_bf16 v147, v154, v137
  v_dot2c_f32_bf16 v148, v158, v138
  v_dot2c_f32_bf16 v149, v154, v138
  v_dot2c_f32_bf16 v150, v158, v139
  v_dot2c_f32_bf16 v151, v154, v139
L_dc_49:
  s_bitcmp1_b32 s95, 3
  s_nop 0
  s_cbranch_scc0 L_dc_50
  s_bitcmp1_b32 s95, 7
  s_cbranch_scc1 L_dc_50
  v_xor_b32 v44, v140, v4
  v_bitop3_b32 v44, v141, v5, v44 bitop3:0xbe
  v_bitop3_b32 v44, v142, v6, v44 bitop3:0xbe
  v_bitop3_b32 v44, v143, v7, v44 bitop3:0xbe
  v_and_b32 v44, s53, v44
  v_cmp_ne_u32 vcc, 0, v44
  s_nop 0
  s_cbranch_vccz L_dc_50k
  s_sleep 1
  buffer_load_dwordx4 v[140:143], v36, s[32:35], s86 offen offset:0 sc1
  s_branch L_dc_50
L_dc_50k:
  s_bitset1_b32 s73, 7
  v_dot2c_f32_bf16 v144, v159, v140
  v_dot2c_f32_bf16 v145, v155, v140
  v_dot2c_f32_bf16 v146, v159, v141
  v_dot2c_f32_bf16 v147, v155, v141
  v_dot2c_f32_bf16 v148, v159, v142
  v_dot2c_f32_bf16 v149, v155, v142
  v_dot2c_f32_bf16 v150, v159, v143
  v_dot2c_f32_bf16 v151, v155, v143
L_dc_50:
  s_cmp_eq_u32 s73, 0xff
  s_nop 0
  s_cbranch_scc1 L_p2x
  s_add_u32 s100, s100, 1
  s_cmp_gt_u32 s100, 1000000
  s_cbranch_scc1 L_abort
  s_branch L_p2
L_p2x:
  v_permlane32_swap_b32 v144, v148
  v_permlane32_swap_b32 v145, v149
  v_permlane32_swap_b32 v146, v150
  v_permlane32_swap_b32 v147, v151
  v_add_f32 v144, v144, v148
  v_add_f32 v145, v145, v149
  v_add_f32 v146, v146, v150
  v_add_f32 v147, v147, v151
  s_nop 0
  v_permlane16_swap_b32 v144, v146
  v_permlane16_swap_b32 v145, v147
  v_add_f32 v144, v144, v146
  v_add_f32 v145, v145, v147
  s_nop 0
  v_add_f32_dpp v144, v144, v144 row_ror:8 row_mask:0xf bank_mask:0xf
  v_add_f32_dpp v145, v145, v145 row_ror:8 row_mask:0xf bank_mask:0xf
  v_mul_f32 v144, v144, v168
  v_mul_f32 v145, v145, v168
  v_cvt_pk_bf16_f32 v44, v144, v145
  ds_write_b32 v37, v44
  s_waitcnt lgkmcnt(0)
  s_barrier
  ds_read_b128 v[160:163], v38
  ds_read_b128 v[164:167], v38 offset:64
  s_waitcnt lgkmcnt(1)
  v_mfma_f32_16x16x32_bf16 v[144:147], v[48:51], v[160:163], 0
  s_waitcnt lgkmcnt(0)
  v_mfma_f32_16x16x32_bf16 v[144:147], v[52:55], v[164:167], v[144:147]
  s_nop 7
  v_add_f32_dpp v144, v144, v144 quad_perm:[1,0,3,2] row_mask:0xf bank_mask:0xf
  v_add_f32_dpp v145, v145, v145 quad_perm:[1,0,3,2] row_mask:0xf bank_mask:0xf
  v_add_f32_dpp v146, v146, v146 quad_perm:[1,0,3,2] row_mask:0xf bank_mask:0xf
  v_add_f32_dpp v147, v147, v147 quad_perm:[1,0,3,2] row_mask:0xf bank_mask:0xf
  v_add_f32_dpp v144, v144, v144 quad_perm:[2,3,0,1] row_mask:0xf bank_mask:0xf
  v_add_f32_dpp v145, v145, v145 quad_perm:[2,3,0,1] row_mask:0xf bank_mask:0xf
  v_add_f32_dpp v146, v146, v146 quad_perm:[2,3,0,1] row_mask:0xf bank_mask:0xf
  v_add_f32_dpp v147, v147, v147 quad_perm:[2,3,0,1] row_mask:0xf bank_mask:0xf
  v_add_f32_dpp v144, v144, v144 row_half_mirror row_mask:0xf bank_mask:0xf
  v_add_f32_dpp v145, v145, v145 row_half_mirror row_mask:0xf bank_mask:0xf
  v_add_f32_dpp v146, v146, v146 row_half_mirror row_mask:0xf bank_mask:0xf
  v_add_f32_dpp v147, v147, v147 row_half_mirror row_mask:0xf bank_mask:0xf
  s_mov_b32 exec_lo, 0x10001
  s_mov_b32 exec_hi, 0x10001
  v_and_or_b32 v144, v144, v2, s49
  v_and_or_b32 v145, v145, v2, s50
  v_and_or_b32 v146, v146, v2, s51
  v_and_or_b32 v147, v147, v2, s52
  buffer_store_dwordx4 v[144:147], v1, s[32:35], s16 offen sc1
  s_mov_b64 exec, -1
  s_cmp_lt_u32 s2, 128
  s_cbranch_scc0 L_X
  s_mov_b32 s60, 0xffffffff
  s_mov_b32 s61, 0x0
  s_mov_b32 s100, 0
  s_branch L_gf_52
L_g_51:
  s_add_u32 s100, s100, 1
  s_cmp_gt_u32 s100, 1000000
  s_cbranch_scc1 L_abort
  s_sleep 1
L_gf_52:
  s_mov_b64 exec, s[60:61]
  buffer_load_dwordx4 v[128:131], v39, s[32:35], 0 offen offset:0 sc1
  s_waitcnt vmcnt(0)
L_gc_53:
  s_mov_b64 exec, s[60:61]
  v_perm_b32 v44, v129, v128, s56
  v_perm_b32 v44, v130, v44, s57
  v_perm_b32 v44, v131, v44, s58
  v_cmp_ne_u32 s[60:61], s48, v44
  s_nop 0
  s_cmp_lg_u64 s[60:61], 0
  s_cbranch_scc1 L_g_51
  s_mov_b64 exec, -1
  v_cvt_pk_bf16_f32 v44, v128, v129
  v_cvt_pk_bf16_f32 v45, v130, v131
  s_mov_b32 exec_hi, 0
  ds_write_b64 v43, v[44:45]
  s_mov_b32 exec_hi, -1
  s_waitcnt lgkmcnt(0)
  s_barrier
  ds_read_b128 v[128:131], v40 offset:0
  ds_read_b128 v[132:135], v40 offset:64
  ds_read_b128 v[136:139], v40 offset:128
  ds_read_b128 v[140:143], v40 offset:192
  s_waitcnt lgkmcnt(3)
  v_mfma_f32_16x16x32_bf16 v[144:147], v[80:83], v[128:131], 0
  s_waitcnt lgkmcnt(2)
  v_mfma_f32_16x16x32_bf16 v[144:147], v[84:87], v[132:135], v[144:147]
  s_waitcnt lgkmcnt(1)
  v_mfma_f32_16x16x32_bf16 v[144:147], v[88:91], v[136:139], v[144:147]
  s_waitcnt lgkmcnt(0)
  v_mfma_f32_16x16x32_bf16 v[144:147], v[92:95], v[140:143], v[144:147]
  s_nop 7
  v_add_f32_dpp v144, v144, v144 quad_perm:[1,0,3,2] row_mask:0xf bank_mask:0xf
  v_add_f32_dpp v145, v145, v145 quad_perm:[1,0,3,2] row_mask:0xf bank_mask:0xf
  v_add_f32_dpp v146, v146, v146 quad_perm:[1,0,3,2] row_mask:0xf bank_mask:0xf
  v_add_f32_dpp v147, v147, v147 quad_perm:[1,0,3,2] row_mask:0xf bank_mask:0xf
  v_add_f32_dpp v144, v144, v144 quad_perm:[2,3,0,1] row_mask:0xf bank_mask:0xf
  v_add_f32_dpp v145, v145, v145 quad_perm:[2,3,0,1] row_mask:0xf bank_mask:0xf
  v_add_f32_dpp v146, v146, v146 quad_perm:[2,3,0,1] row_mask:0xf bank_mask:0xf
  v_add_f32_dpp v147, v147, v147 quad_perm:[2,3,0,1] row_mask:0xf bank_mask:0xf
  v_add_f32_dpp v144, v144, v144 row_half_mirror row_mask:0xf bank_mask:0xf
  v_add_f32_dpp v145, v145, v145 row_half_mirror row_mask:0xf bank_mask:0xf
  v_add_f32_dpp v146, v146, v146 row_half_mirror row_mask:0xf bank_mask:0xf
  v_add_f32_dpp v147, v147, v147 row_half_mirror row_mask:0xf bank_mask:0xf
  s_mov_b32 exec_lo, 0x10001
  s_mov_b32 exec_hi, 0x10001
  v_and_or_b32 v144, v144, v2, s49
  v_and_or_b32 v145, v145, v2, s50
  v_and_or_b32 v146, v146, v2, s51
  v_and_or_b32 v147, v147, v2, s52
  buffer_store_dwordx4 v[144:147], v1, s[32:35], s75 offen sc1
  s_mov_b64 exec, -1
  s_branch L_Y
L_X:
  s_mov_b64 s[60:61], -1
  s_waitcnt vmcnt(63)
  s_mov_b32 s100, 0
  s_branch L_gc_58
L_g_56:
  s_add_u32 s100, s100, 1
  s_cmp_gt_u32 s100, 1000000
  s_cbranch_scc1 L_abort
  s_sleep 2
L_gf_57:
  s_mov_b64 exec, s[60:61]
  buffer_load_dwordx4 v[68:71], v56, s[32:35], 0 offen offset:0 sc1
  buffer_load_dwordx4 v[72:75], v56, s[32:35], s68 offen offset:0 sc1
  s_waitcnt vmcnt(0)
L_gc_58:
  s_mov_b64 exec, s[60:61]
  v_perm_b32 v44, v69, v68, s56
  v_perm_b32 v44, v70, v44, s57
  v_perm_b32 v44, v71, v44, s58
  v_cmp_ne_u32 s[60:61], s48, v44
  v_perm_b32 v44, v73, v72, s56
  v_perm_b32 v44, v74, v44, s57
  v_perm_b32 v44, v75, v44, s58
  v_cmp_ne_u32 vcc, s48, v44
  s_nop 0
  s_or_b64 s[60:61], s[60:61], vcc
  s_cmp_lg_u64 s[60:61], 0
  s_cbranch_scc1 L_g_56
  s_mov_b64 exec, -1
  v_permlane32_swap_b32 v68, v70
  v_permlane32_swap_b32 v69, v71
  v_add_f32 v68, v68, v70
  v_add_f32 v69, v69, v71
  s_nop 1
  v_permlane16_swap_b32 v68, v69
  v_add_f32 v68, v68, v69
  v_permlane32_swap_b32 v72, v74
  v_permlane32_swap_b32 v73, v75
  v_add_f32 v72, v72, v74
  v_add_f32 v73, v73, v75
  s_nop 1
  v_permlane16_swap_b32 v72, v73
  v_add_f32 v72, v72, v73
  v_cvt_pk_bf16_f32 v44, v68, v68
  v_and_b32 v68, 0xffff0000, v44
  v_cvt_pk_bf16_f32 v45, v72, v72
  v_and_b32 v72, 0xffff0000, v45
  v_and_b32 v44, 3, v1
  v_lshlrev_b32 v44, 6, v44
  v_bfe_u32 v3, v1, 2, 3
  v_lshl_add_u32 v44, v3, 2, v44
  ds_bpermute_b32 v76, v44, v68 offset:0
  ds_bpermute_b32 v77, v44, v68 offset:32
  ds_bpermute_b32 v78, v44, v72 offset:0
  ds_bpermute_b32 v79, v44, v72 offset:32
  s_lshr_b32 s92, s82, 12
  s_lshl_b32 s92, s92, 12
  s_add_u32 s94, s82, s92
  s_add_u32 s94, s94, 1114112
  s_add_u32 s82, s82, 851968
  v_bfe_u32 v45, v1, 2, 1
  v_lshlrev_b32 v45, 6, v45
  v_add_u32 v45, v45, v41
  v_bfe_u32 v69, v1, 2, 1
  v_lshlrev_b32 v69, 12, v69
  v_and_b32 v3, 3, v1
  v_lshl_add_u32 v69, v3, 6, v69
  v_lshrrev_b32 v3, 4, v1
  v_lshl_add_u32 v69, v3, 4, v69
  s_waitcnt lgkmcnt(0)
  v_add_f32 v78, 1.0, v78
  v_lshlrev_b32 v66, 16, v66
  v_cvt_pk_bf16_f32 v44, v78, v78
  v_and_b32 v78, 0xffff0000, v44
  s_cmp_eq_u32 s3, 7
  s_cbranch_scc1 L_ab_55
  ds_write_b16_d16_hi v57, v78
  ds_write_b16_d16_hi v57, v77 offset:64
  ds_read_b128 v[72:75], v45
  s_waitcnt lgkmcnt(0)
  v_mfma_f32_16x16x32_bf16 v[208:211], v[80:83], v[72:75], 0
  v_mfma_f32_16x16x32_bf16 v[212:215], v[84:87], v[72:75], 0
  v_mfma_f32_16x16x32_bf16 v[216:219], v[88:91], v[72:75], 0
  v_mfma_f32_16x16x32_bf16 v[220:223], v[92:95], v[72:75], 0
  s_mov_b32 exec_lo, 0x220022
  s_mov_b32 exec_hi, 0x220022
  s_nop 3
  v_mov_b32 v208, v212
  v_mov_b32 v209, v213
  v_mov_b32 v210, v214
  v_mov_b32 v211, v215
  s_mov_b32 exec_lo, 0x440044
  s_mov_b32 exec_hi, 0x440044
  v_mov_b32 v208, v216
  v_mov_b32 v209, v217
  v_mov_b32 v210, v218
  v_mov_b32 v211, v219
  s_mov_b32 exec_lo, 0x880088
  s_mov_b32 exec_hi, 0x880088
  v_mov_b32 v208, v220
  v_mov_b32 v209, v221
  v_mov_b32 v210, v222
  v_mov_b32 v211, v223
  s_mov_b32 exec_lo, 0xff00ff
  s_mov_b32 exec_hi, 0xff00ff
  v_and_or_b32 v208, v208, v2, s49
  v_and_or_b32 v209, v209, v2, s50
  v_and_or_b32 v210, v210, v2, s51
  v_and_or_b32 v211, v211, v2, s52
  buffer_store_dwordx4 v[208:211], v69, s[32:35], s94 offen sc1
  s_mov_b64 exec, -1
L_ab_55:
  v_mov_b32 v112, 0
  v_mov_b32 v113, 0
  v_mov_b32 v114, 0
  v_mov_b32 v115, 0
  s_mov_b32 s60, 0xffffffff
  s_mov_b32 s61, 0x0
  s_mov_b32 s100, 0
  s_branch L_gf_61
L_g_60:
  s_add_u32 s100, s100, 1
  s_cmp_gt_u32 s100, 1000000
  s_cbranch_scc1 L_abort
  s_sleep 1
L_gf_61:
  s_mov_b64 exec, s[60:61]
  buffer_load_dwordx4 v[112:115], v61, s[32:35], s90 offen offset:0 sc1
  s_waitcnt vmcnt(0)
L_gc_62:
  s_mov_b64 exec, s[60:61]
  v_perm_b32 v44, v113, v112, s56
  v_perm_b32 v44, v114, v44, s57
  v_perm_b32 v44, v115, v44, s58
  v_cmp_ne_u32 s[60:61], s48, v44
  s_nop 0
  s_cmp_lg_u64 s[60:61], 0
  s_cbranch_scc1 L_g_60
  s_mov_b64 exec, -1
  v_permlane32_swap_b32 v112, v114
  v_permlane32_swap_b32 v113, v115
  v_add_f32 v112, v112, v114
  v_add_f32 v113, v113, v115
  s_nop 1
  v_permlane16_swap_b32 v112, v113
  v_add_f32 v112, v112, v113
  s_nop 1
  v_add_f32_dpp v112, v112, v112 row_ror:8 row_mask:0xf bank_mask:0xf
  ds_write_b32 v59, v112
  s_waitcnt lgkmcnt(0)
  s_barrier
  ds_read_b128 v[112:115], v60
  ds_read_b128 v[116:119], v60 offset:16
  s_waitcnt lgkmcnt(0)
  v_add_f32 v112, v112, v113
  v_add_f32 v114, v114, v115
  v_add_f32 v116, v116, v117
  v_add_f32 v118, v118, v119
  v_add_f32 v112, v112, v114
  v_add_f32 v116, v116, v118
  v_add_f32 v112, v112, v116
  v_cvt_pk_bf16_f32 v44, v112, v112
  v_and_b32 v112, 0xffff0000, v44
  v_mul_f32 v67, v76, v112
  v_cvt_pk_bf16_f32 v44, v67, v67
  v_and_b32 v67, 0xffff0000, v44
  v_add_f32 v67, v66, v67
  v_cvt_pk_bf16_f32 v44, v67, v67
  v_and_b32 v67, 0xffff0000, v44
  s_cmp_eq_u32 s3, 7
  s_cbranch_scc1 L_stat
  v_mul_f32 v44, v67, v78
  v_cvt_pk_bf16_f32 v44, v44, v44
  ds_write_b16 v57, v44
  ds_read_b128 v[160:163], v41
  s_waitcnt lgkmcnt(0)
  v_mfma_f32_16x16x32_bf16 v[128:131], v[80:83], v[160:163], 0
  v_mfma_f32_16x16x32_bf16 v[132:135], v[84:87], v[160:163], 0
  v_mfma_f32_16x16x32_bf16 v[136:139], v[88:91], v[160:163], 0
  v_mfma_f32_16x16x32_bf16 v[140:143], v[92:95], v[160:163], 0
  s_mov_b32 exec_lo, 0x20002
  s_mov_b32 exec_hi, 0x20002
  s_nop 3
  v_mov_b32 v128, v132
  v_mov_b32 v129, v133
  v_mov_b32 v130, v134
  v_mov_b32 v131, v135
  s_mov_b32 exec_lo, 0x40004
  s_mov_b32 exec_hi, 0x40004
  v_mov_b32 v128, v136
  v_mov_b32 v129, v137
  v_mov_b32 v130, v138
  v_mov_b32 v131, v139
  s_mov_b32 exec_lo, 0x80008
  s_mov_b32 exec_hi, 0x80008
  v_mov_b32 v128, v140
  v_mov_b32 v129, v141
  v_mov_b32 v130, v142
  v_mov_b32 v131, v143
  s_mov_b32 exec_lo, 0xf000f
  s_mov_b32 exec_hi, 0xf000f
  v_and_or_b32 v128, v128, v2, s49
  v_and_or_b32 v129, v129, v2, s50
  v_and_or_b32 v130, v130, v2, s51
  v_and_or_b32 v131, v131, v2, s52
  buffer_store_dwordx4 v[128:131], v58, s[32:35], s82 offen sc1
  s_mov_b64 exec, -1
  s_branch L_xdone
L_stat:
  v_mov_b32 v130, v67
  v_mul_f32 v131, v67, v67
  s_nop 0
  v_add_f32_dpp v130, v130, v130 row_ror:8 row_mask:0xf bank_mask:0xf
  v_add_f32_dpp v131, v131, v131 row_ror:8 row_mask:0xf bank_mask:0xf
  s_nop 0
  v_add_f32_dpp v130, v130, v130 row_ror:4 row_mask:0xf bank_mask:0xf
  v_add_f32_dpp v131, v131, v131 row_ror:4 row_mask:0xf bank_mask:0xf
  s_nop 0
  v_add_f32_dpp v130, v130, v130 row_ror:2 row_mask:0xf bank_mask:0xf
  v_add_f32_dpp v131, v131, v131 row_ror:2 row_mask:0xf bank_mask:0xf
  s_nop 0
  v_add_f32_dpp v130, v130, v130 row_ror:1 row_mask:0xf bank_mask:0xf
  v_add_f32_dpp v131, v131, v131 row_ror:1 row_mask:0xf bank_mask:0xf
  v_mov_b32 v128, v130
  v_mov_b32 v129, v131
  s_nop 0
  v_permlane16_swap_b32 v130, v128
  v_permlane16_swap_b32 v131, v129
  v_add_f32 v130, v130, v128
  v_add_f32 v131, v131, v129
  v_and_b32 v128, v2, v130
  v_and_b32 v129, v2, v131
  v_sub_f32 v130, v130, v128
  v_sub_f32 v131, v131, v129
  v_and_or_b32 v128, v128, v2, s49
  v_and_or_b32 v129, v129, v2, s50
  v_and_or_b32 v130, v130, v2, s51
  v_and_or_b32 v131, v131, v2, s52
  s_lshl_b32 s92, s80, 11
  s_lshl_b32 s97, s79, 7
  s_add_u32 s92, s92, s97
  s_add_u32 s92, s92, 0x18000
  s_mov_b64 exec, 1
  buffer_store_dwordx4 v[128:131], v1, s[32:35], s92 offen sc1
  s_mov_b64 exec, -1
  v_mov_b32 v112, 0
L_xdone:
  s_cmp_lg_u32 s80, 0
  s_cbranch_scc1 L_fin
  s_mul_i32 s90, s79, 8448
  s_lshl_b32 s97, s3, 10
  s_add_u32 s90, s90, s97
  s_add_u32 s90, s90, 0xa0000
  s_lshl_b32 s92, s79, 6
  v_and_b32 v46, 31, v1
  v_lshlrev_b32 v46, 1, v46
  v_add_u32 v46, s92, v46
  s_cmp_eq_u32 s3, 7
  s_cbranch_scc1 L_nof
  s_mov_b64 s[60:61], -1
  s_mov_b32 s100, 0
  s_branch L_gf_65
L_g_64:
  s_add_u32 s100, s100, 1
  s_cmp_gt_u32 s100, 1000000
  s_cbranch_scc1 L_abort
  s_sleep 1
L_gf_65:
  s_mov_b64 exec, s[60:61]
  buffer_load_dwordx4 v[112:115], v34, s[32:35], s90 offen offset:0 sc1
  s_waitcnt vmcnt(0)
L_gc_66:
  s_mov_b64 exec, s[60:61]
  v_perm_b32 v44, v113, v112, s56
  v_perm_b32 v44, v114, v44, s57
  v_perm_b32 v44, v115, v44, s58
  v_cmp_ne_u32 s[60:61], s48, v44
  s_nop 0
  s_cmp_lg_u64 s[60:61], 0
  s_cbranch_scc1 L_g_64
  s_mov_b64 exec, -1
  v_permlane32_swap_b32 v112, v114
  v_permlane32_swap_b32 v113, v115
  v_add_f32 v112, v112, v114
  v_add_f32 v113, v113, v115
  s_nop 1
  v_permlane16_swap_b32 v112, v113
  v_add_f32 v112, v112, v113
  s_nop 1
  v_add_f32_dpp v112, v112, v112 row_ror:8 row_mask:0xf bank_mask:0xf
L_nof:
  ds_write_b32 v59, v112 offset:1024
  s_waitcnt lgkmcnt(0)
  s_barrier
  s_cmp_lg_u32 s3, 0
  s_cbranch_scc1 L_fin
  ds_read_b128 v[112:115], v60 offset:1024
  ds_read_b128 v[116:119], v60 offset:1040
  s_waitcnt lgkmcnt(0)
  v_add_f32 v112, v112, v113
  v_add_f32 v114, v114, v115
  v_add_f32 v116, v116, v117
  v_add_f32 v118, v118, v119
  v_add_f32 v112, v112, v114
  v_add_f32 v116, v116, v118
  v_add_f32 v112, v112, v116
  v_cvt_pk_bf16_f32 v45, v112, v112
  v_and_b32 v112, 0xffff0000, v45
  v_mul_f32 v44, v79, v112
  v_cvt_pk_bf16_f32 v45, v44, v44
  v_and_b32 v44, 0xffff0000, v45
  v_add_f32 v44, v67, v44
  v_cvt_pk_bf16_f32 v44, v44, v44
  s_mov_b32 exec_hi, 0
  global_store_short v46, v44, s[28:29]
  s_cmp_lg_u32 s2, 128
  s_cbranch_scc1 L_noep
  s_mov_b64 exec, 1
  v_mov_b32 v45, 0
  global_store_dword v45, v45, s[30:31]
L_noep:
L_fin:
  s_endpgm
L_Y:
  s_cmp_ge_u32 s2, 112
  s_cbranch_scc1 L_fin
  s_lshl_b32 s94, s81, 13
  s_lshl_b32 s97, s3, 10
  s_add_u32 s94, s94, s97
  s_add_u32 s94, s94, 0x110000
  buffer_load_dwordx4 v[76:79], v34, s[32:35], s94 offen offset:0 sc1
  s_mov_b64 s[40:41], s[22:23]
  s_mov_b32 s42, 0x1c0000
  s_mov_b32 s43, 0x20000
  v_lshrrev_b32 v44, 5, v1
  v_lshlrev_b32 v44, 10, v44
  v_and_b32 v3, 31, v1
  v_lshl_add_u32 v44, v3, 4, v44
  buffer_load_dwordx4 v[176:179], v44, s[40:43], s91 offen offset:0 nt
  buffer_load_dwordx4 v[180:183], v44, s[40:43], s91 offen offset:2048 nt
  v_mov_b32 v112, 0
  v_mov_b32 v113, 0
  v_mov_b32 v114, 0
  v_mov_b32 v115, 0
  v_lshlrev_b32 v46, 4, v1
  v_add_u32 v46, 88064, v46
  v_lshlrev_b32 v47, 5, v1
  v_add_u32 v47, 83968, v47
  s_mov_b64 s[60:61], -1
  s_waitcnt vmcnt(2)
  s_mov_b32 s100, 0
  s_branch L_gc_70
L_g_68:
  s_add_u32 s100, s100, 1
  s_cmp_gt_u32 s100, 1000000
  s_cbranch_scc1 L_abort
  s_sleep 2
L_gf_69:
  s_mov_b64 exec, s[60:61]
  buffer_load_dwordx4 v[76:79], v34, s[32:35], s94 offen offset:0 sc1
  s_waitcnt vmcnt(0)
L_gc_70:
  s_mov_b64 exec, s[60:61]
  v_perm_b32 v44, v77, v76, s56
  v_perm_b32 v44, v78, v44, s57
  v_perm_b32 v44, v79, v44, s58
  v_cmp_ne_u32 s[60:61], s48, v44
  s_nop 0
  s_cmp_lg_u64 s[60:61], 0
  s_cbranch_scc1 L_g_68
  s_mov_b64 exec, -1
  v_permlane32_swap_b32 v76, v78
  v_permlane32_swap_b32 v77, v79
  v_add_f32 v76, v76, v78
  v_add_f32 v77, v77, v79
  s_nop 1
  v_permlane16_swap_b32 v76, v77
  v_add_f32 v76, v76, v77
  s_waitcnt vmcnt(0)
  ds_write_b128 v62, v[176:179] offset:0
  ds_write_b128 v62, v[180:183] offset:1088
  ds_write_b32 v60, v76
  s_waitcnt lgkmcnt(0)
  s_barrier
  ds_read_b128 v[128:131], v46
  ds_read_b128 v[132:135], v46 offset:1024
  ds_read_b64_tr_b16 v[68:69], v63 offset:0
  ds_read_b64_tr_b16 v[70:71], v63 offset:2176
  ds_read_b64_tr_b16 v[72:73], v63 offset:32
  ds_read_b64_tr_b16 v[74:75], v63 offset:2208
  s_waitcnt lgkmcnt(4)
  v_add_f32 v128, v128, v129
  v_add_f32 v130, v130, v131
  v_add_f32 v128, v128, v130
  v_add_f32 v132, v132, v133
  v_add_f32 v134, v134, v135
  v_add_f32 v132, v132, v134
  s_mov_b32 s60, 0xffffffff
  s_mov_b32 s61, 0x0
  s_mov_b32 s62, 0xffff
  s_mov_b32 s63, 0x0
  s_mov_b32 s100, 0
  s_branch L_gf_73
L_g_72:
  s_add_u32 s100, s100, 1
  s_cmp_gt_u32 s100, 1000000
  s_cbranch_scc1 L_abort
  s_sleep 1
L_gf_73:
  s_mov_b64 exec, s[60:61]
  s_cbranch_execz L_gs_75
  buffer_load_dwordx4 v[112:115], v61, s[32:35], s82 offen offset:0 sc1
L_gs_75:
  s_mov_b64 exec, s[62:63]
  s_cbranch_execz L_gs_76
  buffer_load_dwordx4 v[136:139], v56, s[32:35], 0 offen offset:0 sc1
L_gs_76:
  s_waitcnt vmcnt(0)
L_gc_74:
  s_mov_b64 exec, s[60:61]
  v_perm_b32 v44, v113, v112, s56
  v_perm_b32 v44, v114, v44, s57
  v_perm_b32 v44, v115, v44, s58
  v_cmp_ne_u32 s[60:61], s48, v44
  s_mov_b64 exec, s[62:63]
  v_perm_b32 v44, v137, v136, s56
  v_perm_b32 v44, v138, v44, s57
  v_perm_b32 v44, v139, v44, s58
  v_cmp_ne_u32 s[62:63], s48, v44
  s_nop 0
  s_or_b64 s[96:97], s[60:61], s[62:63]
  s_cbranch_scc1 L_g_72
  s_mov_b64 exec, -1
  v_permlane32_swap_b32 v112, v114
  v_permlane32_swap_b32 v113, v115
  v_add_f32 v112, v112, v114
  v_add_f32 v113, v113, v115
  s_nop 1
  v_permlane16_swap_b32 v112, v113
  v_add_f32 v112, v112, v113
  ds_write_b32 v59, v112
  v_add_f32 v136, v136, v138
  v_add_f32 v137, v137, v139
  s_nop 0
  v_add_f32_dpp v136, v136, v136 quad_perm:[1,0,3,2] row_mask:0xf bank_mask:0xf
  v_add_f32_dpp v137, v137, v137 quad_perm:[1,0,3,2] row_mask:0xf bank_mask:0xf
  s_nop 0
  v_add_f32_dpp v136, v136, v136 quad_perm:[2,3,0,1] row_mask:0xf bank_mask:0xf
  v_add_f32_dpp v137, v137, v137 quad_perm:[2,3,0,1] row_mask:0xf bank_mask:0xf
  s_nop 0
  v_add_f32_dpp v136, v136, v136 row_half_mirror row_mask:0xf bank_mask:0xf
  v_add_f32_dpp v137, v137, v137 row_half_mirror row_mask:0xf bank_mask:0xf
  s_nop 0
  v_add_f32_dpp v136, v136, v136 row_ror:8 row_mask:0xf bank_mask:0xf
  v_add_f32_dpp v137, v137, v137 row_ror:8 row_mask:0xf bank_mask:0xf
  s_waitcnt lgkmcnt(0)
  s_barrier
  ds_read_b128 v[112:115], v47
  ds_read_b128 v[116:119], v47 offset:16
  v_readfirstlane_b32 s92, v136
  v_readfirstlane_b32 s93, v137
  v_mov_b32 v44, 0x3b000000
  v_mul_f32 v136, s92, v44
  v_mul_f32 v137, s93, v44
  v_fma_f32 v137, -v136, v136, v137
  v_max_f32 v137, 0, v137
  v_cvt_pk_bf16_f32 v45, v137, v137
  v_and_b32 v137, 0xffff0000, v45
  v_cvt_pk_bf16_f32 v44, v136, v136
  v_and_b32 v136, 0xffff0000, v44
  v_add_f32 v137, 0x3727c5ac, v137
  v_mul_f32 v128, v136, v128
  v_cvt_pk_bf16_f32 v45, v137, v137
  v_and_b32 v137, 0xffff0000, v45
  v_sqrt_f32 v137, v137
  s_nop 0
  v_cvt_pk_bf16_f32 v45, v137, v137
  v_and_b32 v137, 0xffff0000, v45
  v_rcp_f32 v137, v137
  s_waitcnt lgkmcnt(0)
  v_add_f32 v112, v112, v113
  v_add_f32 v114, v114, v115
  v_add_f32 v116, v116, v117
  v_add_f32 v118, v118, v119
  v_add_f32 v112, v112, v114
  v_add_f32 v116, v116, v118
  v_add_f32 v112, v112, v116
  v_sub_f32 v112, v112, v128
  v_fma_f32 v112, v112, v137, v132
  v_cvt_pk_bf16_f32 v44, v112, v112
  v_and_b32 v112, 0xffff0000, v44
  v_mul_f32 v44, v112, v112
  v_mov_b32 v45, 0xc0135761
  v_mov_b32_dpp v113, v112 row_ror:8 row_mask:0xf bank_mask:0xf
  v_fmac_f32 v45, 0xbdd2d3e8, v44
  v_mul_f32 v44, v45, v112
  v_exp_f32 v44, v44
  s_nop 0
  v_add_f32 v44, 1.0, v44
  v_rcp_f32 v44, v44
  s_nop 0
  v_mul_f32 v112, v112, v44
  v_cvt_pk_bf16_f32 v44, v112, v112
  v_and_b32 v112, 0xffff0000, v44
  v_mul_f32 v112, v112, v113
  v_cvt_pk_bf16_f32 v44, v112, v112
  s_mov_b32 exec_lo, 0xff00ff
  s_mov_b32 exec_hi, 0xff00ff
  ds_write_b16 v57, v44
  s_mov_b64 exec, -1
  ds_read_b128 v[160:163], v41
  s_waitcnt lgkmcnt(0)
  v_mfma_f32_16x16x32_bf16 v[144:147], v[68:71], v[160:163], 0
  v_mfma_f32_16x16x32_bf16 v[148:151], v[72:75], v[160:163], 0
  s_mov_b32 exec_lo, 0x20002
  s_mov_b32 exec_hi, 0x20002
  s_nop 5
  v_mov_b32 v144, v148
  v_mov_b32 v145, v149
  v_mov_b32 v146, v150
  v_mov_b32 v147, v151
  s_mov_b32 exec_lo, 0x30003
  s_mov_b32 exec_hi, 0x30003
  v_and_or_b32 v144, v144, v2, s49
  v_and_or_b32 v145, v145, v2, s50
  v_and_or_b32 v146, v146, v2, s51
  v_and_or_b32 v147, v147, v2, s52
  buffer_store_dwordx4 v[144:147], v58, s[32:35], s90 offen sc1
  s_endpgm
L_abort:
  s_endpgm
L_end:
  s_endpgm
L_codeend:
.section .rodata,"a"
.p2align 6
.amdhsa_kernel adaLN_cond__compressed_kv_cla__glu_gated_geglu__decode_kernel
  .amdhsa_next_free_vgpr 256
  .amdhsa_next_free_sgpr 102
  .amdhsa_accum_offset 256
  .amdhsa_group_segment_fixed_size 0
  .amdhsa_kernarg_size 120
  .amdhsa_user_sgpr_count 2
  .amdhsa_user_sgpr_kernarg_segment_ptr 1
  .amdhsa_system_sgpr_workgroup_id_x 1
.end_amdhsa_kernel
```

```asm
; @launch grid=(256,1,1) block=(512,1,1) lds=163840
.amdgcn_target "amdgcn-amd-amdhsa--gfx950"
.text
.globl adaLN_cond__compressed_kv_cla__glu_gated_geglu__decode_kernel
.p2align 8
.type adaLN_cond__compressed_kv_cla__glu_gated_geglu__decode_kernel,@function
adaLN_cond__compressed_kv_cla__glu_gated_geglu__decode_kernel:
  s_cmp_ge_u32 s2, 256
  s_cbranch_scc1 L_end
  s_load_dwordx16 s[4:19], s[0:1], 0
  s_load_dwordx8 s[20:27], s[0:1], 64
  s_load_dwordx4 s[28:31], s[0:1], 96
  s_load_dwordx2 s[32:33], s[0:1], 112
  v_lshrrev_b32 v1, 6, v0
  s_mov_b32 s34, 0x10000000
  s_mov_b32 s35, 0x20000
  v_readfirstlane_b32 s3, v1
  v_and_b32 v1, 63, v0
  v_mov_b32 v8, 0
  v_mov_b32 v20, 0
  v_mov_b32 v251, 0
  v_mov_b32 v253, 0
  s_cmp_lt_u32 s2, 128
  s_cbranch_scc0 L_B
  v_lshlrev_b32 v38, 4, v1
  s_bfe_u32 s82, s2, 0x30003
  s_lshl_b32 s82, s82, 19
  s_lshl_b32 s97, s3, 16
  s_add_u32 s82, s82, s97
  s_and_b32 s97, s2, 7
  s_lshl_b32 s97, s97, 10
  s_add_u32 s82, s82, s97
  s_mov_b32 s42, 0x400000
  s_mov_b32 s43, 0x20000
  s_bitcmp1_b32 s2, 6
  s_cbranch_scc1 L_K
  v_and_b32 v8, 15, v1
  v_lshlrev_b32 v8, 3, v8
  v_lshrrev_b32 v3, 4, v1
  v_lshl_add_u32 v8, v3, 1, v8
  s_bfe_u32 s92, s2, 0x30003
  s_lshl_b32 s92, s92, 7
  v_add_u32 v17, s92, v8
  s_mul_i32 s83, s3, 8576
  s_lshl_b32 s92, s2, 17
  v_mov_b32 v18, s92
  v_mov_b32 v19, 0xf000
  s_waitcnt lgkmcnt(0)
  s_mov_b64 s[40:41], s[8:9]
  global_load_dwordx4 v[12:15], v38, s[4:5]
  global_load_ushort v16, v17, s[4:5]
  s_add_u32 m0, s83, 0
  s_add_u32 s92, s82, 0
  buffer_load_dwordx4 v38, s[40:43], s92 offen nt lds
  s_add_u32 m0, s83, 1056
  s_add_u32 s92, s82, 8192
  buffer_load_dwordx4 v38, s[40:43], s92 offen nt lds
  s_add_u32 m0, s83, 2112
  s_add_u32 s92, s82, 16384
  buffer_load_dwordx4 v38, s[40:43], s92 offen nt lds
  s_add_u32 m0, s83, 3168
  s_add_u32 s92, s82, 24576
  buffer_load_dwordx4 v38, s[40:43], s92 offen nt lds
  s_add_u32 m0, s83, 4224
  s_add_u32 s92, s82, 32768
  buffer_load_dwordx4 v38, s[40:43], s92 offen nt lds
  s_add_u32 m0, s83, 5280
  s_add_u32 s92, s82, 40960
  buffer_load_dwordx4 v38, s[40:43], s92 offen nt lds
  s_add_u32 m0, s83, 6336
  s_add_u32 s92, s82, 49152
  buffer_load_dwordx4 v38, s[40:43], s92 offen nt lds
  s_add_u32 m0, s83, 7392
  s_add_u32 s92, s82, 57344
  buffer_load_dwordx4 v38, s[40:43], s92 offen nt lds
  s_cmp_lg_u32 s3, 7
  s_cbranch_scc1 L_nt_1
  s_mov_b64 exec, 1
  global_load_dword v20, v18, s[6:7] nt
  global_load_dword v21, v19, s[32:33]
  global_load_dword v22, v38, s[30:31] offset:128
  s_mov_b64 exec, -1
L_nt_1:
  s_branch L_Q2
L_K:
  s_bfe_u32 s81, s2, 0x10004
  s_xor_b32 s81, s81, 1
  s_lshl_b32 s81, s81, 16
  s_and_b32 s92, s3, 1
  s_lshl_b32 s92, s92, 7
  v_xor_b32 v39, s92, v38
  s_lshl_b32 s83, s3, 13
  s_add_u32 s83, s83, s81
  v_mov_b32 v19, 0xf000
  s_waitcnt lgkmcnt(0)
  s_mov_b64 s[40:41], s[10:11]
  s_mov_b64 exec, 1
  global_load_dword v21, v19, s[32:33]
  s_mov_b64 exec, -1
  v_xor_b32 v40, 0, v39
  s_add_u32 m0, s83, 0
  s_add_u32 s92, s82, 0
  buffer_load_dwordx4 v40, s[40:43], s92 offen nt lds
  v_xor_b32 v41, 16, v39
  s_add_u32 m0, s83, 1024
  s_add_u32 s92, s82, 8192
  buffer_load_dwordx4 v41, s[40:43], s92 offen nt lds
  v_xor_b32 v40, 32, v39
  s_add_u32 m0, s83, 2048
  s_add_u32 s92, s82, 16384
  buffer_load_dwordx4 v40, s[40:43], s92 offen nt lds
  v_xor_b32 v41, 48, v39
  s_add_u32 m0, s83, 3072
  s_add_u32 s92, s82, 24576
  buffer_load_dwordx4 v41, s[40:43], s92 offen nt lds
  v_xor_b32 v40, 64, v39
  s_add_u32 m0, s83, 4096
  s_add_u32 s92, s82, 32768
  buffer_load_dwordx4 v40, s[40:43], s92 offen nt lds
  v_xor_b32 v41, 80, v39
  s_add_u32 m0, s83, 5120
  s_add_u32 s92, s82, 40960
  buffer_load_dwordx4 v41, s[40:43], s92 offen nt lds
  v_xor_b32 v40, 96, v39
  s_add_u32 m0, s83, 6144
  s_add_u32 s92, s82, 49152
  buffer_load_dwordx4 v40, s[40:43], s92 offen nt lds
  v_xor_b32 v41, 112, v39
  s_add_u32 m0, s83, 7168
  s_add_u32 s92, s82, 57344
  buffer_load_dwordx4 v41, s[40:43], s92 offen nt lds
  s_branch L_K2
L_B:
  s_cmp_ge_u32 s3, 4
  s_cbranch_scc0 L_Bfront
  v_lshrrev_b32 v10, 3, v1
  v_mul_u32_u24 v5, 24576, v10
  v_lshlrev_b32 v10, 3, v10
  v_and_b32 v11, 7, v1
  v_lshl_add_u32 v5, v11, 4, v5
  s_bfe_u32 s94, s2, 0x20004
  s_and_b32 s95, s2, 15
  s_lshl_b32 s92, s94, 2
  s_add_u32 s92, s92, s3
  s_sub_u32 s92, s92, 4
  s_lshl_b32 s93, s92, 6
  v_add_u32 v10, s93, v10
  s_mul_i32 s92, s92, 196608
  s_lshl_b32 s93, s95, 7
  s_add_u32 s92, s92, s93
  s_mov_b32 s42, 0x300000
  s_mov_b32 s43, 0x20000
  v_mov_b32 v253, 0
  s_waitcnt lgkmcnt(0)
  s_mov_b64 s[40:41], s[26:27]
  s_bitcmp1_b32 s2, 6
  s_cbranch_scc1 L_nou0
  global_load_dwordx2 v[112:113], v10, s[24:25]
  buffer_load_dwordx4 v[124:127], v5, s[40:43], s92 offen nt
  s_add_u32 s92, s92, 6144
  buffer_load_dwordx4 v[128:131], v5, s[40:43], s92 offen nt
  s_add_u32 s92, s92, 6144
  buffer_load_dwordx4 v[132:135], v5, s[40:43], s92 offen nt
  s_add_u32 s92, s92, 6144
  buffer_load_dwordx4 v[136:139], v5, s[40:43], s92 offen nt
L_nou0:
  s_branch L_Bback2
L_Bfront:
  s_memrealtime s[62:63]
  s_bfe_u32 s64, s2, 0x40003
  s_xor_b32 s64, s64, 8
  s_or_b32 s64, s64, s3
  s_cbranch_scc1 L_nononce
  v_mov_b32 v18, 0
  v_mov_b32 v21, 0
  s_waitcnt lgkmcnt(0)
  s_or_b32 s62, s62, 1
  v_mov_b32 v20, s62
  s_mov_b64 exec, 1
  global_atomic_cmpswap v18, v[20:21], s[30:31] sc1
  s_mov_b64 exec, -1
L_nononce:
  v_lshrrev_b32 v245, 4, v1
  v_and_b32 v246, 15, v1
  v_lshlrev_b32 v247, 2, v245
  v_xor_b32 v246, v246, v247
  v_lshlrev_b32 v246, 4, v246
  v_lshl_add_u32 v244, v245, 10, v246
  v_xor_b32 v245, 16, v244
  v_xor_b32 v246, 32, v244
  v_xor_b32 v247, 48, v244
  v_add_u32 v245, 3072, v245
  v_add_u32 v246, 6144, v246
  v_add_u32 v247, 9216, v247
  s_and_b32 s91, s3, 3
  s_lshl_b32 s90, s91, 15
  s_lshl_b32 s91, s91, 13
  s_lshl_b32 s92, s2, 17
  s_add_u32 s90, s90, s92
  s_bfe_u32 s93, s2, 0x20003
  s_lshl_b32 s92, s93, 15
  s_add_u32 s91, s91, s92
  s_lshl_b32 s92, s93, 8
  s_add_u32 s90, s90, s92
  s_getpc_b64 s[94:95]
L_pc:
  s_sub_u32 s94, s94, L_pc-adaLN_cond__compressed_kv_cla__glu_gated_geglu__decode_kernel
  s_subb_u32 s95, s95, 0
  s_bfe_u32 s92, s2, 0x40003
  s_lshl_b32 s92, s92, 2
  s_add_u32 s92, s92, s3
  s_lshl_b32 s92, s92, 10
  v_lshlrev_b32 v11, 4, v1
  v_add_u32 v11, s92, v11
  s_mov_b32 s38, 0x2000000
  s_mov_b32 s39, 0x20000
  s_cmp_ge_u32 s92, L_codeend-adaLN_cond__compressed_kv_cla__glu_gated_geglu__decode_kernel
  s_cbranch_scc1 L_nopf
  v_min_u32 v11, L_codeend-adaLN_cond__compressed_kv_cla__glu_gated_geglu__decode_kernel-16, v11
  global_load_dwordx4 v[12:15], v11, s[94:95]
L_nopf:
  s_waitcnt lgkmcnt(0)
  s_mov_b64 s[36:37], s[6:7]
  s_barrier
  s_barrier
  s_mov_b32 s54, 0x05040100
  s_mov_b32 s55, 0x07060302
  s_mov_b32 s56, 0x0c0c0400
  s_mov_b32 s57, 0x0c040100
  s_mov_b32 s58, 0x04020100
  s_mov_b32 s53, 0x10001
  v_mov_b32 v2, 0xffffff00
  s_lshr_b32 s77, s2, 5
  s_and_b32 s78, s2, 127
  s_and_b32 s76, s2, 7
  s_lshl_b32 s76, s76, 2
  s_bfe_u32 s97, s2, 0x20003
  s_add_u32 s76, s76, s97
  s_bfe_u32 s79, s2, 0x40003
  s_and_b32 s80, s2, 7
  s_bfe_u32 s17, s2, 0x20003
  s_bfe_u32 s59, s2, 0x10004
  s_lshl_b32 s59, s59, 14
  s_xor_b32 m0, s91, 0
  s_xor_b32 s101, s90, 0
  buffer_load_dwordx4 v244, s[36:39], s101 offen offset:0 nt lds
  s_waitcnt vmcnt(0)
  buffer_load_dwordx4 v245, s[36:39], s101 offen offset:1024 nt lds
  s_waitcnt vmcnt(0)
  buffer_load_dwordx4 v246, s[36:39], s101 offen offset:2048 nt lds
  s_waitcnt vmcnt(2)
  buffer_load_dwordx4 v247, s[36:39], s101 offen offset:3072 nt lds
  s_waitcnt vmcnt(2)
  s_xor_b32 m0, s91, 32768
  s_xor_b32 s101, s90, 256
  buffer_load_dwordx4 v244, s[36:39], s101 offen offset:0 nt lds
  s_waitcnt vmcnt(2)
  buffer_load_dwordx4 v245, s[36:39], s101 offen offset:1024 nt lds
  s_waitcnt vmcnt(2)
  buffer_load_dwordx4 v246, s[36:39], s101 offen offset:2048 nt lds
  s_waitcnt vmcnt(2)
  buffer_load_dwordx4 v247, s[36:39], s101 offen offset:3072 nt lds
  s_waitcnt vmcnt(2)
  s_xor_b32 m0, s91, 65536
  s_xor_b32 s101, s90, 512
  buffer_load_dwordx4 v244, s[36:39], s101 offen offset:0 nt lds
  buffer_load_dwordx4 v245, s[36:39], s101 offen offset:1024 nt lds
  buffer_load_dwordx4 v246, s[36:39], s101 offen offset:2048 nt lds
  buffer_load_dwordx4 v247, s[36:39], s101 offen offset:3072 nt lds
  v_mov_b32 v253, 0
  global_load_dword v252, v253, s[30:31] sc1
  s_xor_b32 m0, s91, 98304
  s_xor_b32 s101, s90, 768
  buffer_load_dwordx4 v244, s[36:39], s101 offen offset:0 nt lds
  buffer_load_dwordx4 v245, s[36:39], s101 offen offset:1024 nt lds
  buffer_load_dwordx4 v246, s[36:39], s101 offen offset:2048 nt lds
  buffer_load_dwordx4 v247, s[36:39], s101 offen offset:3072 nt lds
  s_barrier
  s_branch L_front
L_Q2:
  s_mov_b32 s54, 0x05040100
  s_mov_b32 s55, 0x07060302
  s_mov_b32 s56, 0x0c0c0400
  s_mov_b32 s57, 0x0c040100
  s_mov_b32 s58, 0x04020100
  s_mov_b32 s53, 0x10001
  v_mov_b32 v2, 0xffffff00
  s_lshr_b32 s77, s2, 5
  s_and_b32 s78, s2, 127
  s_and_b32 s76, s2, 7
  s_lshl_b32 s76, s76, 2
  s_bfe_u32 s97, s2, 0x20003
  s_add_u32 s76, s76, s97
  s_bfe_u32 s79, s2, 0x40003
  s_and_b32 s80, s2, 7
  s_bfe_u32 s17, s2, 0x20003
  s_bfe_u32 s59, s2, 0x10004
  s_lshl_b32 s59, s59, 14
  v_lshrrev_b32 v245, 4, v1
  v_and_b32 v246, 15, v1
  v_lshlrev_b32 v247, 2, v245
  v_xor_b32 v246, v246, v247
  v_lshlrev_b32 v246, 4, v246
  v_lshl_add_u32 v244, v245, 10, v246
  v_xor_b32 v245, 16, v244
  v_xor_b32 v246, 32, v244
  v_xor_b32 v247, 48, v244
  v_add_u32 v245, 3072, v245
  v_add_u32 v246, 6144, v246
  v_add_u32 v247, 9216, v247
  s_and_b32 s91, s3, 3
  s_lshl_b32 s90, s91, 15
  s_lshl_b32 s91, s91, 13
  s_lshl_b32 s92, s2, 17
  s_add_u32 s90, s90, s92
  s_bfe_u32 s93, s2, 0x20003
  s_lshl_b32 s92, s93, 15
  s_add_u32 s91, s91, s92
  s_lshl_b32 s92, s93, 8
  s_add_u32 s90, s90, s92
  s_mov_b64 s[36:37], s[6:7]
  s_mov_b32 s38, 0x2000000
  s_mov_b32 s39, 0x20000
  s_bfe_u32 s82, s2, 0x30003
  s_lshl_b32 s82, s82, 10
  s_add_u32 s83, s82, 8192
  s_lshl_b32 s92, s3, 7
  s_add_u32 s92, s92, 0x20000
  v_add_u32 v40, s92, v8
  v_lshrrev_b32 v41, 4, v1
  v_lshlrev_b32 v41, 4, v41
  v_add_u32 v41, s92, v41
  s_lshl_b32 s92, s3, 7
  v_lshrrev_b32 v44, 4, v1
  v_mul_u32_u24 v44, 8576, v44
  v_bfe_u32 v3, v1, 2, 2
  v_mul_u32_u24 v3, 1056, v3
  v_add_u32 v44, v3, v44
  v_and_b32 v3, 3, v1
  v_lshl_add_u32 v44, v3, 3, v44
  v_add_u32 v44, s92, v44
  v_and_b32 v39, 3, v1
  v_lshlrev_b32 v39, 6, v39
  v_lshrrev_b32 v3, 4, v1
  v_lshl_add_u32 v39, v3, 4, v39
  s_and_b32 s85, s2, 7
  s_lshl_b32 s85, s85, 14
  s_bfe_u32 s97, s2, 0x30003
  s_lshl_b32 s97, s97, 11
  s_add_u32 s85, s85, s97
  s_lshl_b32 s97, s3, 8
  s_add_u32 s85, s85, s97
  s_add_u32 s85, s85, 0x80000
  s_mov_b32 s70, 0x20002
  s_mov_b32 s71, 0x20002
  s_mov_b32 s72, 0x40004
  s_mov_b32 s73, 0x40004
  s_mov_b32 s74, 0x80008
  s_mov_b32 s75, 0x80008
  s_waitcnt vmcnt(8)
  v_lshlrev_b32 v92, 16, v12
  v_and_b32 v93, 0xffff0000, v12
  v_lshlrev_b32 v94, 16, v13
  v_and_b32 v95, 0xffff0000, v13
  v_lshlrev_b32 v96, 16, v14
  v_and_b32 v97, 0xffff0000, v14
  v_lshlrev_b32 v98, 16, v15
  v_and_b32 v99, 0xffff0000, v15
  v_add_f32 v100, v92, v93
  v_add_f32 v100, v100, v94
  v_add_f32 v100, v100, v95
  v_add_f32 v100, v100, v96
  v_add_f32 v100, v100, v97
  v_add_f32 v100, v100, v98
  v_add_f32 v100, v100, v99
  s_nop 1
  v_add_f32_dpp v100, v100, v100 row_ror:8 row_mask:0xf bank_mask:0xf
  s_nop 1
  v_add_f32_dpp v100, v100, v100 row_ror:4 row_mask:0xf bank_mask:0xf
  s_nop 1
  v_add_f32_dpp v100, v100, v100 row_ror:2 row_mask:0xf bank_mask:0xf
  s_nop 1
  v_add_f32_dpp v100, v100, v100 row_ror:1 row_mask:0xf bank_mask:0xf
  v_mov_b32 v101, v100
  s_nop 1
  v_permlane16_swap_b32 v100, v101
  v_add_f32 v100, v100, v101
  v_mov_b32 v101, v100
  s_nop 1
  v_permlane32_swap_b32 v100, v101
  v_add_f32 v100, v100, v101
  v_mul_f32 v100, 0x3b000000, v100
  v_sub_f32 v92, v92, v100
  v_sub_f32 v93, v93, v100
  v_sub_f32 v94, v94, v100
  v_sub_f32 v95, v95, v100
  v_sub_f32 v96, v96, v100
  v_sub_f32 v97, v97, v100
  v_sub_f32 v98, v98, v100
  v_sub_f32 v99, v99, v100
  v_mul_f32 v102, v92, v92
  v_fmac_f32 v102, v93, v93
  v_fmac_f32 v102, v94, v94
  v_fmac_f32 v102, v95, v95
  v_fmac_f32 v102, v96, v96
  v_fmac_f32 v102, v97, v97
  v_fmac_f32 v102, v98, v98
  v_fmac_f32 v102, v99, v99
  s_nop 1
  v_add_f32_dpp v102, v102, v102 row_ror:8 row_mask:0xf bank_mask:0xf
  s_nop 1
  v_add_f32_dpp v102, v102, v102 row_ror:4 row_mask:0xf bank_mask:0xf
  s_nop 1
  v_add_f32_dpp v102, v102, v102 row_ror:2 row_mask:0xf bank_mask:0xf
  s_nop 1
  v_add_f32_dpp v102, v102, v102 row_ror:1 row_mask:0xf bank_mask:0xf
  v_mov_b32 v101, v102
  s_nop 1
  v_permlane16_swap_b32 v102, v101
  v_add_f32 v102, v102, v101
  v_mov_b32 v101, v102
  s_nop 1
  v_permlane32_swap_b32 v102, v101
  v_add_f32 v102, v102, v101
  v_mov_b32 v253, 0
  global_load_dword v252, v253, s[30:31] sc1
  v_mul_f32 v102, 0x3b000000, v102
  v_cvt_pk_bf16_f32 v101, v100, v100
  v_and_b32 v100, 0xffff0000, v101
  v_cvt_pk_bf16_f32 v101, v102, v102
  v_and_b32 v102, 0xffff0000, v101
  v_add_f32 v102, 0x3727c5ac, v102
  v_cvt_pk_bf16_f32 v101, v102, v102
  v_and_b32 v102, 0xffff0000, v101
  v_sqrt_f32 v102, v102
  s_nop 0
  v_cvt_pk_bf16_f32 v101, v102, v102
  v_and_b32 v102, 0xffff0000, v101
  v_rcp_f32 v102, v102
  v_lshlrev_b32 v103, 16, v16
  v_sub_f32 v103, v103, v100
  v_cvt_pk_bf16_f32 v101, v103, v103
  v_and_b32 v103, 0xffff0000, v101
  v_mul_f32 v103, v103, v102
  v_cvt_pk_bf16_f32 v101, v103, v103
  v_and_b32 v103, 0xffff0000, v101
  s_mov_b32 s100, 0
  s_waitcnt vmcnt(0)
  s_branch L_epc_3
L_ep_2:
  global_load_dword v252, v253, s[30:31] sc1
  s_add_u32 s100, s100, 1
  s_cmp_gt_u32 s100, 1000000
  s_cbranch_scc1 L_abort
  s_waitcnt vmcnt(0)
L_epc_3:
  v_readfirstlane_b32 s48, v252
  s_nop 0
  s_cmp_eq_u32 s48, 0
  s_nop 1
  s_cbranch_scc1 L_ep_2
  s_mul_i32 s48, s48, 0x9e3779b1
  s_and_b32 s49, s48, 0xff
  s_bfe_u32 s50, s48, 0x80008
  s_bfe_u32 s51, s48, 0x80010
  s_lshr_b32 s52, s48, 24
  s_lshr_b32 s97, s48, 15
  s_xor_b32 s97, s97, s48
  s_mul_i32 s97, s97, 0x85ebca6b
  v_mov_b32 v4, s48
  v_mov_b32 v5, s97
  v_mov_b32 v249, s48
  v_mov_b32 v250, s97
  v_and_b32 v6, 4, v1
  v_cmp_eq_u32 vcc, 0, v6
  v_and_b32 v7, 3, v1
  v_lshlrev_b32 v7, 2, v7
  v_cndmask_b32 v4, v5, v4, vcc
  v_lshrrev_b32 v4, v7, v4
  v_lshrrev_b32 v5, 1, v4
  v_lshrrev_b32 v6, 2, v4
  v_lshrrev_b32 v7, 3, v4
  s_barrier
  buffer_load_dwordx4 v[20:23], v38, s[32:35], s82 offen offset:0 sc1
  buffer_load_dwordx4 v[24:27], v38, s[32:35], s83 offen offset:0 sc1
  ds_read_b64_tr_b16 v[112:113], v44 offset:0
  ds_read_b64_tr_b16 v[114:115], v44 offset:4224
  ds_read_b64_tr_b16 v[116:117], v44 offset:34304
  ds_read_b64_tr_b16 v[118:119], v44 offset:38528
  ds_read_b64_tr_b16 v[120:121], v44 offset:32
  ds_read_b64_tr_b16 v[122:123], v44 offset:4256
  ds_read_b64_tr_b16 v[124:125], v44 offset:34336
  ds_read_b64_tr_b16 v[126:127], v44 offset:38560
  ds_read_b64_tr_b16 v[128:129], v44 offset:64
  ds_read_b64_tr_b16 v[130:131], v44 offset:4288
  ds_read_b64_tr_b16 v[132:133], v44 offset:34368
  ds_read_b64_tr_b16 v[134:135], v44 offset:38592
  s_waitcnt lgkmcnt(4)
  ds_read_b64_tr_b16 v[136:137], v44 offset:96
  ds_read_b64_tr_b16 v[138:139], v44 offset:4320
  ds_read_b64_tr_b16 v[140:141], v44 offset:34400
  ds_read_b64_tr_b16 v[142:143], v44 offset:38624
  s_waitcnt lgkmcnt(0)
  s_barrier
  s_mov_b64 s[60:61], -1
  s_waitcnt vmcnt(0)
  s_mov_b32 s100, 0
  s_branch L_gc_6
L_g_4:
  s_add_u32 s100, s100, 1
  s_cmp_gt_u32 s100, 1000000
  s_cbranch_scc1 L_abort
  s_sleep 2
L_gf_5:
  s_mov_b64 exec, s[60:61]
  buffer_load_dwordx4 v[20:23], v38, s[32:35], s82 offen offset:0 sc1
  buffer_load_dwordx4 v[24:27], v38, s[32:35], s83 offen offset:0 sc1
  s_waitcnt vmcnt(0)
L_gc_6:
  s_mov_b64 exec, s[60:61]
  v_perm_b32 v92, v21, v20, s56
  v_perm_b32 v92, v22, v92, s57
  v_perm_b32 v92, v23, v92, s58
  v_cmp_ne_u32 s[60:61], s48, v92
  v_perm_b32 v92, v25, v24, s56
  v_perm_b32 v92, v26, v92, s57
  v_perm_b32 v92, v27, v92, s58
  v_cmp_ne_u32 vcc, s48, v92
  s_nop 0
  s_or_b64 s[60:61], s[60:61], vcc
  s_cmp_lg_u64 s[60:61], 0
  s_cbranch_scc1 L_g_4
  s_mov_b64 exec, -1
  v_permlane32_swap_b32 v20, v22
  v_permlane32_swap_b32 v21, v23
  v_permlane32_swap_b32 v24, v26
  v_permlane32_swap_b32 v25, v27
  v_add_f32 v20, v20, v22
  v_add_f32 v21, v21, v23
  v_add_f32 v24, v24, v26
  v_add_f32 v25, v25, v27
  v_permlane16_swap_b32 v20, v21
  s_nop 0
  v_permlane16_swap_b32 v24, v25
  v_add_f32 v20, v20, v21
  v_add_f32 v24, v24, v25
  v_cvt_pk_bf16_f32 v25, v24, v24
  v_and_b32 v24, 0xffff0000, v25
  v_cvt_pk_bf16_f32 v21, v20, v20
  v_and_b32 v20, 0xffff0000, v21
  v_add_f32 v24, 1.0, v24
  v_cvt_pk_bf16_f32 v25, v24, v24
  v_and_b32 v24, 0xffff0000, v25
  v_mul_f32 v24, v103, v24
  v_cvt_pk_bf16_f32 v25, v24, v24
  v_and_b32 v24, 0xffff0000, v25
  v_add_f32 v24, v24, v20
  v_cvt_pk_bf16_f32 v24, v24, v24
  ds_write_b16 v40, v24
  ds_read_b128 v[28:31], v41
  ds_read_b128 v[32:35], v41 offset:64
  s_waitcnt lgkmcnt(1)
  v_mfma_f32_16x16x32_bf16 v[80:83], v[112:115], v[28:31], 0
  v_mfma_f32_16x16x32_bf16 v[84:87], v[120:123], v[28:31], 0
  v_mfma_f32_16x16x32_bf16 v[88:91], v[128:131], v[28:31], 0
  v_mfma_f32_16x16x32_bf16 v[92:95], v[136:139], v[28:31], 0
  s_waitcnt lgkmcnt(0)
  v_mfma_f32_16x16x32_bf16 v[80:83], v[116:119], v[32:35], v[80:83]
  v_mfma_f32_16x16x32_bf16 v[84:87], v[124:127], v[32:35], v[84:87]
  v_mfma_f32_16x16x32_bf16 v[88:91], v[132:135], v[32:35], v[88:91]
  v_mfma_f32_16x16x32_bf16 v[92:95], v[140:143], v[32:35], v[92:95]
  s_nop 5
  v_cndmask_b32 v80, v80, v84, s[70:71]
  v_cndmask_b32 v81, v81, v85, s[70:71]
  v_cndmask_b32 v82, v82, v86, s[70:71]
  v_cndmask_b32 v83, v83, v87, s[70:71]
  v_cndmask_b32 v80, v80, v88, s[72:73]
  v_cndmask_b32 v81, v81, v89, s[72:73]
  v_cndmask_b32 v82, v82, v90, s[72:73]
  v_cndmask_b32 v83, v83, v91, s[72:73]
  v_cndmask_b32 v80, v80, v92, s[74:75]
  v_cndmask_b32 v81, v81, v93, s[74:75]
  v_cndmask_b32 v82, v82, v94, s[74:75]
  v_cndmask_b32 v83, v83, v95, s[74:75]
  v_and_or_b32 v80, v80, v2, s49
  v_and_or_b32 v81, v81, v2, s50
  v_and_or_b32 v82, v82, v2, s51
  v_and_or_b32 v83, v83, v2, s52
  s_mov_b32 exec_lo, 0xf000f
  s_mov_b32 exec_hi, 0xf000f
  buffer_store_dwordx4 v[80:83], v39, s[32:35], s85 offen
  s_add_u32 s97, s85, 0x100000
  buffer_store_dwordx4 v[80:83], v39, s[32:35], s97 offen sc1
  s_mov_b64 exec, -1
  s_barrier
  s_lshr_b32 s92, s3, 2
  s_lshl_b32 s93, s92, 12
  s_xor_b32 s93, s93, 0
  s_xor_b32 m0, s91, s93
  s_lshl_b32 s93, s92, 14
  s_xor_b32 s93, s93, 0
  s_xor_b32 s101, s90, s93
  buffer_load_dwordx4 v244, s[36:39], s101 offen offset:0 nt lds
  buffer_load_dwordx4 v245, s[36:39], s101 offen offset:1024 nt lds
  buffer_load_dwordx4 v246, s[36:39], s101 offen offset:2048 nt lds
  buffer_load_dwordx4 v247, s[36:39], s101 offen offset:3072 nt lds
  s_lshr_b32 s92, s3, 2
  s_lshl_b32 s93, s92, 12
  s_xor_b32 s93, s93, 32768
  s_xor_b32 m0, s91, s93
  s_lshl_b32 s93, s92, 14
  s_xor_b32 s93, s93, 256
  s_xor_b32 s101, s90, s93
  buffer_load_dwordx4 v244, s[36:39], s101 offen offset:0 nt lds
  buffer_load_dwordx4 v245, s[36:39], s101 offen offset:1024 nt lds
  buffer_load_dwordx4 v246, s[36:39], s101 offen offset:2048 nt lds
  buffer_load_dwordx4 v247, s[36:39], s101 offen offset:3072 nt lds
  s_lshr_b32 s92, s3, 2
  s_lshl_b32 s93, s92, 12
  s_xor_b32 s93, s93, 65536
  s_xor_b32 m0, s91, s93
  s_lshl_b32 s93, s92, 14
  s_xor_b32 s93, s93, 512
  s_xor_b32 s101, s90, s93
  buffer_load_dwordx4 v244, s[36:39], s101 offen offset:0 nt lds
  buffer_load_dwordx4 v245, s[36:39], s101 offen offset:1024 nt lds
  buffer_load_dwordx4 v246, s[36:39], s101 offen offset:2048 nt lds
  buffer_load_dwordx4 v247, s[36:39], s101 offen offset:3072 nt lds
  s_lshr_b32 s92, s3, 2
  s_lshl_b32 s93, s92, 12
  s_xor_b32 s93, s93, 98304
  s_xor_b32 m0, s91, s93
  s_lshl_b32 s93, s92, 14
  s_xor_b32 s93, s93, 768
  s_xor_b32 s101, s90, s93
  buffer_load_dwordx4 v244, s[36:39], s101 offen offset:0 nt lds
  buffer_load_dwordx4 v245, s[36:39], s101 offen offset:1024 nt lds
  buffer_load_dwordx4 v246, s[36:39], s101 offen offset:2048 nt lds
  buffer_load_dwordx4 v247, s[36:39], s101 offen offset:3072 nt lds
  s_cmp_ge_u32 s3, 4
  s_cbranch_scc1 L_back
  s_barrier
  s_branch L_setup
L_K2:
  s_mov_b32 s54, 0x05040100
  s_mov_b32 s55, 0x07060302
  s_mov_b32 s56, 0x0c0c0400
  s_mov_b32 s57, 0x0c040100
  s_mov_b32 s58, 0x04020100
  s_mov_b32 s53, 0x10001
  v_mov_b32 v2, 0xffffff00
  s_lshr_b32 s77, s2, 5
  s_and_b32 s78, s2, 127
  s_and_b32 s76, s2, 7
  s_lshl_b32 s76, s76, 2
  s_bfe_u32 s97, s2, 0x20003
  s_add_u32 s76, s76, s97
  s_bfe_u32 s79, s2, 0x40003
  s_and_b32 s80, s2, 7
  s_bfe_u32 s17, s2, 0x20003
  s_bfe_u32 s59, s2, 0x10004
  s_lshl_b32 s59, s59, 14
  v_lshrrev_b32 v245, 4, v1
  v_and_b32 v246, 15, v1
  v_lshlrev_b32 v247, 2, v245
  v_xor_b32 v246, v246, v247
  v_lshlrev_b32 v246, 4, v246
  v_lshl_add_u32 v244, v245, 10, v246
  v_xor_b32 v245, 16, v244
  v_xor_b32 v246, 32, v244
  v_xor_b32 v247, 48, v244
  v_add_u32 v245, 3072, v245
  v_add_u32 v246, 6144, v246
  v_add_u32 v247, 9216, v247
  s_and_b32 s91, s3, 3
  s_lshl_b32 s90, s91, 15
  s_lshl_b32 s91, s91, 13
  s_lshl_b32 s92, s2, 17
  s_add_u32 s90, s90, s92
  s_bfe_u32 s93, s2, 0x20003
  s_lshl_b32 s92, s93, 15
  s_add_u32 s91, s91, s92
  s_lshl_b32 s92, s93, 8
  s_add_u32 s90, s90, s92
  s_mov_b64 s[36:37], s[6:7]
  s_mov_b32 s38, 0x2000000
  s_mov_b32 s39, 0x20000
  s_barrier
  s_lshr_b32 s92, s3, 2
  s_lshl_b32 s93, s92, 12
  s_xor_b32 s93, s93, 0
  s_xor_b32 m0, s91, s93
  s_lshl_b32 s93, s92, 14
  s_xor_b32 s93, s93, 0
  s_xor_b32 s101, s90, s93
  buffer_load_dwordx4 v244, s[36:39], s101 offen offset:0 nt lds
  buffer_load_dwordx4 v245, s[36:39], s101 offen offset:1024 nt lds
  buffer_load_dwordx4 v246, s[36:39], s101 offen offset:2048 nt lds
  buffer_load_dwordx4 v247, s[36:39], s101 offen offset:3072 nt lds
  s_lshr_b32 s92, s3, 2
  s_lshl_b32 s93, s92, 12
  s_xor_b32 s93, s93, 32768
  s_xor_b32 m0, s91, s93
  s_lshl_b32 s93, s92, 14
  s_xor_b32 s93, s93, 256
  s_xor_b32 s101, s90, s93
  buffer_load_dwordx4 v244, s[36:39], s101 offen offset:0 nt lds
  buffer_load_dwordx4 v245, s[36:39], s101 offen offset:1024 nt lds
  buffer_load_dwordx4 v246, s[36:39], s101 offen offset:2048 nt lds
  buffer_load_dwordx4 v247, s[36:39], s101 offen offset:3072 nt lds
  s_and_b32 s92, s3, 1
  s_lshl_b32 s92, s92, 15
  s_lshr_b32 s97, s3, 1
  s_lshl_b32 s97, s97, 8
  s_add_u32 s92, s92, s97
  s_add_u32 s92, s92, s81
  v_and_b32 v45, 15, v1
  v_mul_u32_u24 v45, 1040, v45
  v_add_u32 v45, s92, v45
  v_lshrrev_b32 v34, 4, v1
  v_lshlrev_b32 v34, 4, v34
  v_xor_b32 v45, v45, v34
  v_lshrrev_b32 v37, 4, v1
  v_lshlrev_b32 v37, 11, v37
  v_and_b32 v3, 15, v1
  v_lshl_add_u32 v37, v3, 4, v37
  s_and_b32 s83, s2, 7
  s_lshl_b32 s83, s83, 14
  s_lshl_b32 s97, s3, 8
  s_add_u32 s83, s83, s97
  s_add_u32 s83, s83, 0x80000
  s_add_u32 s85, s83, 8192
  s_lshl_b32 s92, s3, 7
  s_add_u32 s92, s92, 0x21000
  v_and_b32 v47, 15, v1
  v_lshlrev_b32 v47, 3, v47
  v_lshrrev_b32 v3, 4, v1
  v_lshl_add_u32 v47, v3, 1, v47
  v_add_u32 v47, s92, v47
  s_lshr_b32 s92, s3, 1
  s_lshl_b32 s92, s92, 8
  s_add_u32 s92, s92, 0x21000
  v_lshrrev_b32 v35, 4, v1
  v_lshlrev_b32 v35, 4, v35
  v_add_u32 v35, s92, v35
  v_bfe_u32 v39, v1, 4, 1
  v_lshlrev_b32 v39, 5, v39
  v_lshrrev_b32 v3, 5, v1
  v_lshl_add_u32 v39, v3, 4, v39
  s_and_b32 s84, s2, 7
  s_lshl_b32 s84, s84, 12
  s_lshr_b32 s97, s3, 1
  s_lshl_b32 s97, s97, 10
  s_add_u32 s84, s84, s97
  s_bfe_u32 s97, s2, 0x30003
  s_lshl_b32 s97, s97, 7
  s_add_u32 s84, s84, s97
  s_and_b32 s97, s3, 1
  s_lshl_b32 s97, s97, 6
  s_add_u32 s84, s84, s97
  s_add_u32 s84, s84, 0x10000
  s_waitcnt vmcnt(8)
  s_barrier
  v_xor_b32 v32, 0, v45
  ds_read_b128 v[112:115], v32 offset:0
  v_xor_b32 v33, 64, v45
  ds_read_b128 v[116:119], v33 offset:0
  v_xor_b32 v32, 128, v45
  ds_read_b128 v[120:123], v32 offset:0
  v_xor_b32 v33, 192, v45
  ds_read_b128 v[124:127], v33 offset:0
  v_xor_b32 v32, 0, v45
  ds_read_b128 v[128:131], v32 offset:16384
  v_xor_b32 v33, 64, v45
  ds_read_b128 v[132:135], v33 offset:16384
  v_xor_b32 v32, 128, v45
  ds_read_b128 v[136:139], v32 offset:16384
  v_xor_b32 v33, 192, v45
  ds_read_b128 v[140:143], v33 offset:16384
  s_waitcnt lgkmcnt(0)
  s_barrier
  s_mov_b32 s100, 0
  v_mov_b32 v253, 0
L_ep_8:
  global_load_dword v252, v253, s[30:31] sc1
  s_add_u32 s100, s100, 1
  s_cmp_gt_u32 s100, 1000000
  s_cbranch_scc1 L_abort
  s_waitcnt vmcnt(0)
L_epc_9:
  v_readfirstlane_b32 s48, v252
  s_nop 0
  s_cmp_eq_u32 s48, 0
  s_nop 1
  s_cbranch_scc1 L_ep_8
  s_mul_i32 s48, s48, 0x9e3779b1
  s_and_b32 s49, s48, 0xff
  s_bfe_u32 s50, s48, 0x80008
  s_bfe_u32 s51, s48, 0x80010
  s_lshr_b32 s52, s48, 24
  s_lshr_b32 s97, s48, 15
  s_xor_b32 s97, s97, s48
  s_mul_i32 s97, s97, 0x85ebca6b
  v_mov_b32 v4, s48
  v_mov_b32 v5, s97
  v_mov_b32 v249, s48
  v_mov_b32 v250, s97
  v_and_b32 v6, 4, v1
  v_cmp_eq_u32 vcc, 0, v6
  v_and_b32 v7, 3, v1
  v_lshlrev_b32 v7, 2, v7
  v_cndmask_b32 v4, v5, v4, vcc
  v_lshrrev_b32 v4, v7, v4
  v_lshrrev_b32 v5, 1, v4
  v_lshrrev_b32 v6, 2, v4
  v_lshrrev_b32 v7, 3, v4
  s_and_b32 s92, s3, 1
  s_sub_u32 s74, 0, s92
  s_mov_b32 s75, s74
  v_bfe_u32 v28, v1, 4, 1
  v_lshlrev_b32 v28, 3, v28
  v_lshrrev_b32 v3, 5, v1
  v_lshl_add_u32 v28, v3, 2, v28
  v_mov_b32 v68, s48
  v_mov_b32 v69, s97
  v_cndmask_b32 v68, v68, v69, s[74:75]
  v_lshrrev_b32 v68, v28, v68
  v_lshrrev_b32 v69, 1, v68
  v_lshrrev_b32 v70, 2, v68
  v_lshrrev_b32 v71, 3, v68
  s_mov_b64 s[60:61], -1
  s_mov_b64 s[62:63], -1
  s_mov_b32 s100, 0
  s_branch L_gf_11
L_g_10:
  s_add_u32 s100, s100, 1
  s_cmp_gt_u32 s100, 1000000
  s_cbranch_scc1 L_abort
  s_sleep 1
  s_cmp_lg_u32 s100, 40
  s_cbranch_scc1 L_alt_13
  s_add_u32 s83, s83, 0x100000
  s_add_u32 s85, s85, 0x100000
L_alt_13:
L_gf_11:
  s_mov_b64 exec, s[60:61]
  s_cbranch_execz L_gs_14
  buffer_load_dwordx4 v[20:23], v37, s[32:35], s83 offen offset:0 sc1
L_gs_14:
  s_mov_b64 exec, s[62:63]
  s_cbranch_execz L_gs_15
  buffer_load_dwordx4 v[24:27], v37, s[32:35], s85 offen offset:0 sc1
L_gs_15:
  s_waitcnt vmcnt(0)
L_gc_12:
  s_mov_b64 exec, s[60:61]
  v_perm_b32 v92, v21, v20, s56
  v_perm_b32 v92, v22, v92, s57
  v_perm_b32 v92, v23, v92, s58
  v_cmp_ne_u32 s[60:61], s48, v92
  s_mov_b64 exec, s[62:63]
  v_perm_b32 v92, v25, v24, s56
  v_perm_b32 v92, v26, v92, s57
  v_perm_b32 v92, v27, v92, s58
  v_cmp_ne_u32 s[62:63], s48, v92
  s_nop 0
  s_or_b64 s[96:97], s[60:61], s[62:63]
  s_cbranch_scc1 L_g_10
  s_mov_b64 exec, -1
  v_add_f32 v20, v20, v24
  v_add_f32 v21, v21, v25
  v_add_f32 v22, v22, v26
  v_add_f32 v23, v23, v27
  s_nop 0
  v_permlane32_swap_b32 v20, v22
  v_permlane32_swap_b32 v21, v23
  v_add_f32 v20, v20, v22
  v_add_f32 v21, v21, v23
  s_nop 1
  v_permlane16_swap_b32 v20, v21
  v_add_f32 v20, v20, v21
  v_cvt_pk_bf16_f32 v20, v20, v20
  ds_write_b16 v47, v20
  s_waitcnt lgkmcnt(0)
  s_barrier
  ds_read_b128 v[52:55], v35 offset:0
  ds_read_b128 v[56:59], v35 offset:64
  ds_read_b128 v[60:63], v35 offset:128
  ds_read_b128 v[64:67], v35 offset:192
  s_waitcnt lgkmcnt(3)
  v_mfma_f32_16x16x32_bf16 v[80:83], v[112:115], v[52:55], 0
  v_mfma_f32_16x16x32_bf16 v[84:87], v[128:131], v[52:55], 0
  s_waitcnt lgkmcnt(2)
  v_mfma_f32_16x16x32_bf16 v[80:83], v[116:119], v[56:59], v[80:83]
  v_mfma_f32_16x16x32_bf16 v[84:87], v[132:135], v[56:59], v[84:87]
  s_waitcnt lgkmcnt(1)
  v_mfma_f32_16x16x32_bf16 v[80:83], v[120:123], v[60:63], v[80:83]
  v_mfma_f32_16x16x32_bf16 v[84:87], v[136:139], v[60:63], v[84:87]
  s_waitcnt lgkmcnt(0)
  v_mfma_f32_16x16x32_bf16 v[80:83], v[124:127], v[64:67], v[80:83]
  v_mfma_f32_16x16x32_bf16 v[84:87], v[140:143], v[64:67], v[84:87]
  s_nop 6
  v_mul_f32 v80, 0x3e0293ee, v80
  v_mul_f32 v81, 0x3e0293ee, v81
  v_mul_f32 v82, 0x3e0293ee, v82
  v_mul_f32 v83, 0x3e0293ee, v83
  v_mul_f32 v84, 0x3e0293ee, v84
  v_mul_f32 v85, 0x3e0293ee, v85
  v_mul_f32 v86, 0x3e0293ee, v86
  v_mul_f32 v87, 0x3e0293ee, v87
  v_cvt_pk_bf16_f32 v20, v80, v81
  v_cvt_pk_bf16_f32 v21, v82, v83
  v_cvt_pk_bf16_f32 v22, v84, v85
  v_cvt_pk_bf16_f32 v23, v86, v87
  s_nop 0
  v_permlane16_swap_b32 v20, v22
  v_permlane16_swap_b32 v21, v23
  v_bfi_b32 v20, s53, v68, v20
  v_bfi_b32 v21, s53, v69, v21
  v_bfi_b32 v22, s53, v70, v22
  v_bfi_b32 v23, s53, v71, v23
  s_mov_b32 exec_lo, 0x10001
  s_mov_b32 exec_hi, 0x10001
  buffer_store_dwordx4 v[20:23], v39, s[32:35], s84 offen sc1
  s_mov_b64 exec, -1
  s_barrier
  s_lshr_b32 s92, s3, 2
  s_lshl_b32 s93, s92, 12
  s_xor_b32 s93, s93, 65536
  s_xor_b32 m0, s91, s93
  s_lshl_b32 s93, s92, 14
  s_xor_b32 s93, s93, 512
  s_xor_b32 s101, s90, s93
  buffer_load_dwordx4 v244, s[36:39], s101 offen offset:0 nt lds
  buffer_load_dwordx4 v245, s[36:39], s101 offen offset:1024 nt lds
  buffer_load_dwordx4 v246, s[36:39], s101 offen offset:2048 nt lds
  buffer_load_dwordx4 v247, s[36:39], s101 offen offset:3072 nt lds
  s_lshr_b32 s92, s3, 2
  s_lshl_b32 s93, s92, 12
  s_xor_b32 s93, s93, 98304
  s_xor_b32 m0, s91, s93
  s_lshl_b32 s93, s92, 14
  s_xor_b32 s93, s93, 768
  s_xor_b32 s101, s90, s93
  buffer_load_dwordx4 v244, s[36:39], s101 offen offset:0 nt lds
  buffer_load_dwordx4 v245, s[36:39], s101 offen offset:1024 nt lds
  buffer_load_dwordx4 v246, s[36:39], s101 offen offset:2048 nt lds
  buffer_load_dwordx4 v247, s[36:39], s101 offen offset:3072 nt lds
  s_cmp_ge_u32 s3, 4
  s_cbranch_scc0 L_kf
  s_branch L_back
L_kf:
  s_barrier
  s_branch L_setup
L_Bback2:
  s_mov_b32 s54, 0x05040100
  s_mov_b32 s55, 0x07060302
  s_mov_b32 s56, 0x0c0c0400
  s_mov_b32 s57, 0x0c040100
  s_mov_b32 s58, 0x04020100
  s_mov_b32 s53, 0x10001
  v_mov_b32 v2, 0xffffff00
  s_lshr_b32 s77, s2, 5
  s_and_b32 s78, s2, 127
  s_and_b32 s76, s2, 7
  s_lshl_b32 s76, s76, 2
  s_bfe_u32 s97, s2, 0x20003
  s_add_u32 s76, s76, s97
  s_bfe_u32 s79, s2, 0x40003
  s_and_b32 s80, s2, 7
  s_bfe_u32 s17, s2, 0x20003
  s_bfe_u32 s59, s2, 0x10004
  s_lshl_b32 s59, s59, 14
  s_lshl_b32 s81, s95, 2
  s_add_u32 s81, s81, s94
  s_lshl_b32 s81, s81, 8
  s_add_u32 s81, s81, 0
  v_and_b32 v8, 7, v1
  v_lshlrev_b32 v8, 2, v8
  v_lshrrev_b32 v9, 4, v1
  v_add_u32 v8, v8, v9
  v_lshlrev_b32 v8, 5, v8
  s_lshl_b32 s92, s3, 2
  s_add_u32 s92, s92, 139248
  v_add_u32 v8, s92, v8
  v_lshlrev_b32 v9, 6, v1
  v_add_u32 v9, 139264, v9
  v_lshlrev_b32 v10, 4, v1
  s_bitcmp1_b32 s2, 6
  s_cbranch_scc1 L_nou0b
  s_waitcnt vmcnt(4)
  v_mov_b32 v253, 0
  global_load_dword v252, v253, s[30:31] sc1
  v_lshlrev_b32 v120, 16, v112
  v_and_b32 v121, 0xffff0000, v112
  v_lshlrev_b32 v122, 16, v113
  v_and_b32 v123, 0xffff0000, v113
  v_mul_f32 v116, 0xbfb8aa3b, v120
  v_mul_f32 v117, 0xbfb8aa3b, v121
  v_mul_f32 v118, 0xbfb8aa3b, v122
  v_mul_f32 v119, 0xbfb8aa3b, v123
  v_exp_f32 v116, v116
  v_exp_f32 v117, v117
  v_exp_f32 v118, v118
  v_exp_f32 v119, v119
  v_add_f32 v116, 1.0, v116
  v_add_f32 v117, 1.0, v117
  v_add_f32 v118, 1.0, v118
  v_add_f32 v119, 1.0, v119
  v_rcp_f32 v116, v116
  v_rcp_f32 v117, v117
  v_rcp_f32 v118, v118
  v_rcp_f32 v119, v119
  v_mul_f32 v120, v120, v116
  v_mul_f32 v121, v121, v117
  v_mul_f32 v122, v122, v118
  v_mul_f32 v123, v123, v119
  v_cvt_pk_bf16_f32 v120, v120, v120
  v_cvt_pk_bf16_f32 v121, v121, v121
  v_cvt_pk_bf16_f32 v122, v122, v122
  v_cvt_pk_bf16_f32 v123, v123, v123
  v_lshrrev_b32 v116, 16, v120
  v_lshrrev_b32 v117, 16, v121
  v_lshrrev_b32 v118, 16, v122
  v_lshrrev_b32 v119, 16, v123
  v_and_b32 v120, 0xffff0000, v120
  v_and_b32 v121, 0xffff0000, v121
  v_and_b32 v122, 0xffff0000, v122
  v_and_b32 v123, 0xffff0000, v123
  v_mov_b32 v96, 0
  v_mov_b32 v97, 0
  v_mov_b32 v98, 0
  v_mov_b32 v99, 0
  v_mov_b32 v100, 0
  v_mov_b32 v101, 0
  v_mov_b32 v102, 0
  v_mov_b32 v103, 0
  s_waitcnt vmcnt(4)
  v_dot2c_f32_bf16 v96, v116, v124
  v_dot2c_f32_bf16 v97, v120, v124
  v_dot2c_f32_bf16 v98, v116, v125
  v_dot2c_f32_bf16 v99, v120, v125
  v_dot2c_f32_bf16 v100, v116, v126
  v_dot2c_f32_bf16 v101, v120, v126
  v_dot2c_f32_bf16 v102, v116, v127
  v_dot2c_f32_bf16 v103, v120, v127
  s_waitcnt vmcnt(3)
  v_dot2c_f32_bf16 v96, v117, v128
  v_dot2c_f32_bf16 v97, v121, v128
  v_dot2c_f32_bf16 v98, v117, v129
  v_dot2c_f32_bf16 v99, v121, v129
  v_dot2c_f32_bf16 v100, v117, v130
  v_dot2c_f32_bf16 v101, v121, v130
  v_dot2c_f32_bf16 v102, v117, v131
  v_dot2c_f32_bf16 v103, v121, v131
  s_waitcnt vmcnt(2)
  v_dot2c_f32_bf16 v96, v118, v132
  v_dot2c_f32_bf16 v97, v122, v132
  v_dot2c_f32_bf16 v98, v118, v133
  v_dot2c_f32_bf16 v99, v122, v133
  v_dot2c_f32_bf16 v100, v118, v134
  v_dot2c_f32_bf16 v101, v122, v134
  v_dot2c_f32_bf16 v102, v118, v135
  v_dot2c_f32_bf16 v103, v122, v135
  s_waitcnt vmcnt(1)
  v_dot2c_f32_bf16 v96, v119, v136
  v_dot2c_f32_bf16 v97, v123, v136
  v_dot2c_f32_bf16 v98, v119, v137
  v_dot2c_f32_bf16 v99, v123, v137
  v_dot2c_f32_bf16 v100, v119, v138
  v_dot2c_f32_bf16 v101, v123, v138
  v_dot2c_f32_bf16 v102, v119, v139
  v_dot2c_f32_bf16 v103, v123, v139
  v_permlane32_swap_b32 v96, v100
  v_permlane32_swap_b32 v97, v101
  v_permlane32_swap_b32 v98, v102
  v_permlane32_swap_b32 v99, v103
  v_add_f32 v96, v96, v100
  v_add_f32 v97, v97, v101
  v_add_f32 v98, v98, v102
  v_add_f32 v99, v99, v103
  s_nop 0
  v_permlane16_swap_b32 v96, v98
  v_permlane16_swap_b32 v97, v99
  v_add_f32 v96, v96, v98
  v_add_f32 v97, v97, v99
  s_nop 0
  v_add_f32_dpp v96, v96, v96 row_ror:8 row_mask:0xf bank_mask:0xf
  v_add_f32_dpp v97, v97, v97 row_ror:8 row_mask:0xf bank_mask:0xf
  s_mov_b32 s100, 0
  s_waitcnt vmcnt(0)
  s_branch L_epc_17
L_ep_16:
  global_load_dword v252, v253, s[30:31] sc1
  s_add_u32 s100, s100, 1
  s_cmp_gt_u32 s100, 1000000
  s_cbranch_scc1 L_abort
  s_waitcnt vmcnt(0)
L_epc_17:
  v_readfirstlane_b32 s48, v252
  s_nop 0
  s_cmp_eq_u32 s48, 0
  s_nop 1
  s_cbranch_scc1 L_ep_16
  s_mul_i32 s48, s48, 0x9e3779b1
  s_and_b32 s49, s48, 0xff
  s_bfe_u32 s50, s48, 0x80008
  s_bfe_u32 s51, s48, 0x80010
  s_lshr_b32 s52, s48, 24
  ds_write2_b32 v8, v96, v97 offset0:0 offset1:4
  s_waitcnt lgkmcnt(0)
  s_barrier
  s_cmp_lg_u32 s3, 4
  s_cbranch_scc1 L_nopub_18
  s_mov_b64 exec, 0xffff
  ds_read_b128 v[124:127], v9 offset:0
  ds_read_b128 v[128:131], v9 offset:16
  ds_read_b128 v[132:135], v9 offset:32
  ds_read_b128 v[136:139], v9 offset:48
  s_waitcnt lgkmcnt(3)
  v_add_f32 v124, v124, v125
  v_add_f32 v126, v126, v127
  v_add_f32 v124, v124, v126
  s_waitcnt lgkmcnt(2)
  v_add_f32 v128, v128, v129
  v_add_f32 v130, v130, v131
  v_add_f32 v128, v128, v130
  s_waitcnt lgkmcnt(1)
  v_add_f32 v132, v132, v133
  v_add_f32 v134, v134, v135
  v_add_f32 v132, v132, v134
  s_waitcnt lgkmcnt(0)
  v_add_f32 v136, v136, v137
  v_add_f32 v138, v138, v139
  v_add_f32 v136, v136, v138
  v_and_or_b32 v100, v124, v2, s49
  v_and_or_b32 v101, v128, v2, s50
  v_and_or_b32 v102, v132, v2, s51
  v_and_or_b32 v103, v136, v2, s52
  buffer_store_dwordx4 v[100:103], v10, s[32:35], s81 offen sc1
L_nopub_18:
  s_mov_b64 exec, -1
  s_barrier
  s_branch L_nou0c
L_nou0b:
  v_lshlrev_b32 v12, 7, v1
  v_lshlrev_b32 v14, 9, v1
  s_bfe_u32 s93, s2, 0x30003
  s_and_b32 s94, s2, 7
  s_cmp_lg_u32 s3, 4
  s_cbranch_scc1 L_ew5
  s_mov_b32 exec_hi, 0
  s_lshl_b32 s92, s93, 12
  s_add_u32 s92, s92, 0x10000
  buffer_load_dword v254, v12, s[32:35], s92 offen sc1
  s_lshl_b32 s92, s93, 14
  s_lshr_b32 s97, s94, 1
  s_lshl_b32 s97, s97, 7
  s_add_u32 s92, s92, s97
  s_add_u32 s92, s92, 0x20000
  buffer_load_dword v254, v14, s[32:35], s92 offen sc1
  s_mov_b32 exec_lo, 0xffff
  s_lshl_b32 s92, s94, 14
  s_lshl_b32 s97, s93, 11
  s_add_u32 s92, s92, s97
  s_add_u32 s92, s92, 0x80000
  buffer_load_dword v254, v12, s[32:35], s92 offen sc1
  s_lshl_b32 s92, s94, 11
  s_add_u32 s92, s92, 0x18000
  buffer_load_dword v254, v12, s[32:35], s92 offen sc1
  s_branch L_ewx
L_ew5:
  s_cmp_lg_u32 s3, 5
  s_cbranch_scc1 L_ew6
  s_mov_b32 exec_hi, 0
  s_min_u32 s95, s93, 6
  s_mul_i32 s92, s94, 28672
  s_lshl_b32 s97, s95, 12
  s_add_u32 s92, s92, s97
  s_add_u32 s92, s92, 0xd0000
  buffer_load_dword v254, v12, s[32:35], s92 offen sc1
  s_branch L_ewx
L_ew6:
  s_cmp_lg_u32 s3, 6
  s_cbranch_scc1 L_ew7
  s_mov_b32 exec_hi, 0
  s_cmp_lg_u32 s94, 0
  s_cbranch_scc1 L_ewx
  s_mul_i32 s92, s93, 8448
  s_add_u32 s92, s92, 0x60000
  buffer_load_dword v254, v12, s[32:35], s92 offen sc1
  s_add_u32 s92, s92, 4224
  buffer_load_dword v254, v12, s[32:35], s92 offen sc1
  s_branch L_ewx
L_ew7:
  s_cmp_ge_u32 s93, 4
  s_cbranch_scc1 L_ew7b
  s_mov_b32 exec_hi, 0
  s_lshl_b32 s92, s94, 14
  s_lshl_b32 s97, s93, 12
  s_add_u32 s92, s92, s97
  s_add_u32 s92, s92, 0x40000
  buffer_load_dword v254, v12, s[32:35], s92 offen sc1
  s_branch L_ewx
L_ew7b:
  s_mul_i32 s92, s94, 8448
  s_and_b32 s97, s93, 1
  s_mul_i32 s97, s97, 67584
  s_add_u32 s92, s92, s97
  s_add_u32 s92, s92, 0xa0000
  buffer_load_dword v254, v12, s[32:35], s92 offen sc1
L_ewx:
  s_mov_b64 exec, -1
  s_barrier
  s_barrier
  s_mov_b32 s100, 0
  v_mov_b32 v253, 0
L_ep_19:
  global_load_dword v252, v253, s[30:31] sc1
  s_add_u32 s100, s100, 1
  s_cmp_gt_u32 s100, 1000000
  s_cbranch_scc1 L_abort
  s_waitcnt vmcnt(0)
L_epc_20:
  v_readfirstlane_b32 s48, v252
  s_nop 0
  s_cmp_eq_u32 s48, 0
  s_nop 1
  s_cbranch_scc1 L_ep_19
  s_mul_i32 s48, s48, 0x9e3779b1
  s_and_b32 s49, s48, 0xff
  s_bfe_u32 s50, s48, 0x80008
  s_bfe_u32 s51, s48, 0x80010
  s_lshr_b32 s52, s48, 24
L_nou0c:
  s_lshr_b32 s97, s48, 15
  s_xor_b32 s97, s97, s48
  s_mul_i32 s97, s97, 0x85ebca6b
  v_mov_b32 v4, s48
  v_mov_b32 v5, s97
  v_mov_b32 v249, s48
  v_mov_b32 v250, s97
  v_and_b32 v6, 4, v1
  v_cmp_eq_u32 vcc, 0, v6
  v_and_b32 v7, 3, v1
  v_lshlrev_b32 v7, 2, v7
  v_cndmask_b32 v4, v5, v4, vcc
  v_lshrrev_b32 v4, v7, v4
  v_lshrrev_b32 v5, 1, v4
  v_lshrrev_b32 v6, 2, v4
  v_lshrrev_b32 v7, 3, v4
  v_lshrrev_b32 v245, 4, v1
  v_and_b32 v246, 15, v1
  v_lshlrev_b32 v247, 2, v245
  v_xor_b32 v246, v246, v247
  v_lshlrev_b32 v246, 4, v246
  v_lshl_add_u32 v244, v245, 10, v246
  v_xor_b32 v245, 16, v244
  v_xor_b32 v246, 32, v244
  v_xor_b32 v247, 48, v244
  v_add_u32 v245, 3072, v245
  v_add_u32 v246, 6144, v246
  v_add_u32 v247, 9216, v247
  s_and_b32 s91, s3, 3
  s_lshl_b32 s90, s91, 15
  s_lshl_b32 s91, s91, 13
  s_lshl_b32 s92, s2, 17
  s_add_u32 s90, s90, s92
  s_bfe_u32 s93, s2, 0x20003
  s_lshl_b32 s92, s93, 15
  s_add_u32 s91, s91, s92
  s_lshl_b32 s92, s93, 8
  s_add_u32 s90, s90, s92
  s_mov_b64 s[36:37], s[6:7]
  s_mov_b32 s38, 0x2000000
  s_mov_b32 s39, 0x20000
  v_lshlrev_b32 v12, 21, v1
  v_add_u32 v12, 0xf000, v12
  s_mov_b64 exec, 0x3f
  buffer_load_dword v254, v12, s[32:35], 0 offen
  s_mov_b64 exec, -1
  s_and_b32 s81, s3, 3
  s_lshl_b32 s81, s81, 13
  s_add_u32 s81, s81, 0x10000
  v_lshlrev_b32 v8, 4, v1
  s_add_u32 s82, s81, 4096
  v_lshrrev_b32 v9, 4, v1
  v_lshlrev_b32 v9, 13, v9
  v_and_b32 v3, 15, v1
  v_lshl_add_u32 v9, v3, 4, v9
  s_and_b32 s93, s3, 3
  s_lshl_b32 s93, s93, 11
  s_and_b32 s97, s3, 1
  s_lshl_b32 s97, s97, 5
  s_add_u32 s93, s93, s97
  s_add_u32 s93, s93, 0x20000
  v_xor_b32 v9, s93, v9
  s_xor_b32 m0, s91, 4096
  s_xor_b32 s101, s90, 16384
  buffer_load_dwordx4 v244, s[36:39], s101 offen offset:0 nt lds
  s_waitcnt vmcnt(0)
  buffer_load_dwordx4 v245, s[36:39], s101 offen offset:1024 nt lds
  s_waitcnt vmcnt(2)
  buffer_load_dwordx4 v246, s[36:39], s101 offen offset:2048 nt lds
  s_waitcnt vmcnt(2)
  buffer_load_dwordx4 v247, s[36:39], s101 offen offset:3072 nt lds
  s_waitcnt vmcnt(2)
  s_xor_b32 m0, s91, 36864
  s_xor_b32 s101, s90, 16640
  buffer_load_dwordx4 v244, s[36:39], s101 offen offset:0 nt lds
  s_waitcnt vmcnt(2)
  buffer_load_dwordx4 v245, s[36:39], s101 offen offset:1024 nt lds
  s_waitcnt vmcnt(2)
  buffer_load_dwordx4 v246, s[36:39], s101 offen offset:2048 nt lds
  s_waitcnt vmcnt(2)
  buffer_load_dwordx4 v247, s[36:39], s101 offen offset:3072 nt lds
  s_waitcnt vmcnt(2)
  s_xor_b32 m0, s91, 69632
  s_xor_b32 s101, s90, 16896
  buffer_load_dwordx4 v244, s[36:39], s101 offen offset:0 nt lds
  buffer_load_dwordx4 v245, s[36:39], s101 offen offset:1024 nt lds
  buffer_load_dwordx4 v246, s[36:39], s101 offen offset:2048 nt lds
  buffer_load_dwordx4 v247, s[36:39], s101 offen offset:3072 nt lds
  s_xor_b32 m0, s91, 102400
  s_xor_b32 s101, s90, 17152
  buffer_load_dwordx4 v244, s[36:39], s101 offen offset:0 nt lds
  buffer_load_dwordx4 v245, s[36:39], s101 offen offset:1024 nt lds
  buffer_load_dwordx4 v246, s[36:39], s101 offen offset:2048 nt lds
  buffer_load_dwordx4 v247, s[36:39], s101 offen offset:3072 nt lds
  s_mov_b64 s[40:41], s[26:27]
  s_mov_b32 s42, 0x300000
  s_mov_b32 s43, 0x20000
  v_lshrrev_b32 v13, 3, v1
  v_mul_u32_u24 v13, 24576, v13
  v_and_b32 v3, 7, v1
  v_lshl_add_u32 v13, v3, 4, v13
  s_lshr_b32 s94, s78, 5
  s_lshl_b32 s94, s94, 2
  s_and_b32 s97, s3, 3
  s_add_u32 s94, s94, s97
  s_lshl_b32 s95, s94, 6
  v_lshrrev_b32 v14, 3, v1
  v_lshlrev_b32 v14, 3, v14
  v_add_u32 v14, s95, v14
  s_mul_i32 s92, s94, 196608
  s_and_b32 s97, s2, 31
  s_lshl_b32 s97, s97, 7
  s_add_u32 s92, s92, s97
  s_add_u32 s92, s92, 0x800
  global_load_dwordx2 v[144:145], v14, s[24:25]
  buffer_load_dwordx4 v[128:131], v13, s[40:43], s92 offen nt
  s_add_u32 s92, s92, 6144
  buffer_load_dwordx4 v[132:135], v13, s[40:43], s92 offen nt
  s_add_u32 s92, s92, 6144
  buffer_load_dwordx4 v[136:139], v13, s[40:43], s92 offen nt
  s_add_u32 s92, s92, 6144
  buffer_load_dwordx4 v[140:143], v13, s[40:43], s92 offen nt
  v_lshrrev_b32 v253, 4, v1
  v_lshlrev_b32 v253, 13, v253
  v_and_b32 v3, 15, v1
  v_lshl_add_u32 v253, v3, 4, v253
  s_lshl_b32 s88, s77, 19
  s_bfe_u32 s97, s3, 0x10001
  s_lshl_b32 s97, s97, 18
  s_add_u32 s88, s88, s97
  s_and_b32 s97, s3, 1
  s_lshl_b32 s97, s97, 15
  s_add_u32 s88, s88, s97
  s_lshl_b32 s97, s76, 8
  s_add_u32 s88, s88, s97
  v_lshrrev_b32 v251, 5, v1
  v_mul_u32_u24 v251, 3584, v251
  v_and_b32 v3, 31, v1
  v_lshl_add_u32 v251, v3, 4, v251
  s_mul_i32 s89, s79, 114688
  s_and_b32 s97, s3, 3
  s_mul_i32 s97, s97, 28672
  s_add_u32 s89, s89, s97
  s_mul_i32 s97, s80, 448
  s_add_u32 s89, s89, s97
  s_barrier
  s_branch L_back1
L_back:
  v_lshlrev_b32 v12, 21, v1
  v_add_u32 v12, 0xf000, v12
  s_mov_b64 exec, 0x3f
  buffer_load_dword v254, v12, s[32:35], 0 offen
  s_mov_b64 exec, -1
  s_and_b32 s81, s3, 3
  s_lshl_b32 s81, s81, 13
  s_add_u32 s81, s81, 0x10000
  v_lshlrev_b32 v8, 4, v1
  s_add_u32 s82, s81, 4096
  v_lshrrev_b32 v9, 4, v1
  v_lshlrev_b32 v9, 13, v9
  v_and_b32 v3, 15, v1
  v_lshl_add_u32 v9, v3, 4, v9
  s_and_b32 s93, s3, 3
  s_lshl_b32 s93, s93, 11
  s_and_b32 s97, s3, 1
  s_lshl_b32 s97, s97, 5
  s_add_u32 s93, s93, s97
  s_add_u32 s93, s93, 0x20000
  v_xor_b32 v9, s93, v9
  v_lshrrev_b32 v253, 4, v1
  v_lshlrev_b32 v253, 13, v253
  v_and_b32 v3, 15, v1
  v_lshl_add_u32 v253, v3, 4, v253
  s_lshl_b32 s88, s77, 19
  s_bfe_u32 s97, s3, 0x10001
  s_lshl_b32 s97, s97, 18
  s_add_u32 s88, s88, s97
  s_and_b32 s97, s3, 1
  s_lshl_b32 s97, s97, 15
  s_add_u32 s88, s88, s97
  s_lshl_b32 s97, s76, 8
  s_add_u32 s88, s88, s97
  v_lshrrev_b32 v251, 4, v1
  v_lshlrev_b32 v251, 10, v251
  v_and_b32 v3, 15, v1
  v_lshl_add_u32 v251, v3, 4, v251
  s_lshl_b32 s89, s76, 17
  s_and_b32 s97, s3, 3
  s_lshl_b32 s97, s97, 15
  s_add_u32 s89, s89, s97
  s_lshl_b32 s97, s77, 8
  s_add_u32 s89, s89, s97
  s_barrier
L_back1:
  buffer_load_dwordx4 v[48:51], v8, s[32:35], s81 offen offset:0 sc1
  buffer_load_dwordx4 v[52:55], v8, s[32:35], s81 offen offset:1024 sc1
  buffer_load_dwordx4 v[56:59], v8, s[32:35], s81 offen offset:2048 sc1
  buffer_load_dwordx4 v[60:63], v8, s[32:35], s81 offen offset:3072 sc1
  buffer_load_dwordx4 v[64:67], v8, s[32:35], s82 offen offset:0 sc1
  buffer_load_dwordx4 v[68:71], v8, s[32:35], s82 offen offset:1024 sc1
  buffer_load_dwordx4 v[72:75], v8, s[32:35], s82 offen offset:2048 sc1
  buffer_load_dwordx4 v[76:79], v8, s[32:35], s82 offen offset:3072 sc1
  s_branch L_setup
L_back2:
  s_mov_b64 s[60:61], -1
  s_mov_b64 s[62:63], -1
  s_mov_b64 s[64:65], -1
  s_mov_b64 s[66:67], -1
  s_mov_b64 s[68:69], -1
  s_mov_b64 s[70:71], -1
  s_mov_b64 s[72:73], -1
  s_mov_b64 s[74:75], -1
  s_waitcnt vmcnt(0)
  s_mov_b32 s100, 0
  s_branch L_gc_23
L_g_21:
  s_add_u32 s100, s100, 1
  s_cmp_gt_u32 s100, 1000000
  s_cbranch_scc1 L_abort
  s_mov_b32 s92, 0
  s_cmp_lg_u32 s74, 0
  s_cselect_b32 s92, 7168, s92
  s_cmp_lg_u32 s72, 0
  s_cselect_b32 s92, 6144, s92
  s_cmp_lg_u32 s70, 0
  s_cselect_b32 s92, 5120, s92
  s_cmp_lg_u32 s68, 0
  s_cselect_b32 s92, 4096, s92
  s_cmp_lg_u32 s66, 0
  s_cselect_b32 s92, 3072, s92
  s_cmp_lg_u32 s64, 0
  s_cselect_b32 s92, 2048, s92
  s_cmp_lg_u32 s62, 0
  s_cselect_b32 s92, 1024, s92
  s_cmp_lg_u32 s60, 0
  s_cselect_b32 s92, 0, s92
  s_add_u32 s92, s92, s81
  s_mov_b64 exec, -1
L_qg_24:
  buffer_load_dwordx4 v[16:19], v8, s[32:35], s92 offen sc1
  s_add_u32 s100, s100, 1
  s_cmp_gt_u32 s100, 1000000
  s_cbranch_scc1 L_abort
  s_waitcnt vmcnt(0)
  v_xor_b32 v16, v16, v4
  v_bitop3_b32 v16, v17, v5, v16 bitop3:0xbe
  v_bitop3_b32 v16, v18, v6, v16 bitop3:0xbe
  v_bitop3_b32 v16, v19, v7, v16 bitop3:0xbe
  v_and_b32 v16, s53, v16
  v_cmp_ne_u32 vcc, 0, v16
  s_nop 0
  s_cbranch_vccz L_qg_24x
  s_sleep 4
  s_branch L_qg_24
L_qg_24x:
L_gf_22:
  s_mov_b64 exec, s[60:61]
  s_cbranch_execz L_gs_25
  buffer_load_dwordx4 v[48:51], v8, s[32:35], s81 offen offset:0 sc1
L_gs_25:
  s_mov_b64 exec, s[62:63]
  s_cbranch_execz L_gs_26
  buffer_load_dwordx4 v[52:55], v8, s[32:35], s81 offen offset:1024 sc1
L_gs_26:
  s_mov_b64 exec, s[64:65]
  s_cbranch_execz L_gs_27
  buffer_load_dwordx4 v[56:59], v8, s[32:35], s81 offen offset:2048 sc1
L_gs_27:
  s_mov_b64 exec, s[66:67]
  s_cbranch_execz L_gs_28
  buffer_load_dwordx4 v[60:63], v8, s[32:35], s81 offen offset:3072 sc1
L_gs_28:
  s_mov_b64 exec, s[68:69]
  s_cbranch_execz L_gs_29
  buffer_load_dwordx4 v[64:67], v8, s[32:35], s82 offen offset:0 sc1
L_gs_29:
  s_mov_b64 exec, s[70:71]
  s_cbranch_execz L_gs_30
  buffer_load_dwordx4 v[68:71], v8, s[32:35], s82 offen offset:1024 sc1
L_gs_30:
  s_mov_b64 exec, s[72:73]
  s_cbranch_execz L_gs_31
  buffer_load_dwordx4 v[72:75], v8, s[32:35], s82 offen offset:2048 sc1
L_gs_31:
  s_mov_b64 exec, s[74:75]
  s_cbranch_execz L_gs_32
  buffer_load_dwordx4 v[76:79], v8, s[32:35], s82 offen offset:3072 sc1
L_gs_32:
  s_waitcnt vmcnt(0)
L_gc_23:
  s_mov_b64 exec, s[60:61]
  v_xor_b32 v44, v48, v4
  v_bitop3_b32 v44, v49, v5, v44 bitop3:0xbe
  v_bitop3_b32 v44, v50, v6, v44 bitop3:0xbe
  v_bitop3_b32 v44, v51, v7, v44 bitop3:0xbe
  v_and_b32 v44, s53, v44
  v_cmp_ne_u32 s[60:61], 0, v44
  s_nop 0
  s_cmp_lg_u64 s[60:61], 0
  s_cselect_b64 s[60:61], -1, 0
  s_mov_b64 exec, s[62:63]
  v_xor_b32 v44, v52, v4
  v_bitop3_b32 v44, v53, v5, v44 bitop3:0xbe
  v_bitop3_b32 v44, v54, v6, v44 bitop3:0xbe
  v_bitop3_b32 v44, v55, v7, v44 bitop3:0xbe
  v_and_b32 v44, s53, v44
  v_cmp_ne_u32 s[62:63], 0, v44
  s_nop 0
  s_cmp_lg_u64 s[62:63], 0
  s_cselect_b64 s[62:63], -1, 0
  s_mov_b64 exec, s[64:65]
  v_xor_b32 v44, v56, v4
  v_bitop3_b32 v44, v57, v5, v44 bitop3:0xbe
  v_bitop3_b32 v44, v58, v6, v44 bitop3:0xbe
  v_bitop3_b32 v44, v59, v7, v44 bitop3:0xbe
  v_and_b32 v44, s53, v44
  v_cmp_ne_u32 s[64:65], 0, v44
  s_nop 0
  s_cmp_lg_u64 s[64:65], 0
  s_cselect_b64 s[64:65], -1, 0
  s_mov_b64 exec, s[66:67]
  v_xor_b32 v44, v60, v4
  v_bitop3_b32 v44, v61, v5, v44 bitop3:0xbe
  v_bitop3_b32 v44, v62, v6, v44 bitop3:0xbe
  v_bitop3_b32 v44, v63, v7, v44 bitop3:0xbe
  v_and_b32 v44, s53, v44
  v_cmp_ne_u32 s[66:67], 0, v44
  s_nop 0
  s_cmp_lg_u64 s[66:67], 0
  s_cselect_b64 s[66:67], -1, 0
  s_mov_b64 exec, s[68:69]
  v_xor_b32 v44, v64, v4
  v_bitop3_b32 v44, v65, v5, v44 bitop3:0xbe
  v_bitop3_b32 v44, v66, v6, v44 bitop3:0xbe
  v_bitop3_b32 v44, v67, v7, v44 bitop3:0xbe
  v_and_b32 v44, s53, v44
  v_cmp_ne_u32 s[68:69], 0, v44
  s_nop 0
  s_cmp_lg_u64 s[68:69], 0
  s_cselect_b64 s[68:69], -1, 0
  s_mov_b64 exec, s[70:71]
  v_xor_b32 v44, v68, v4
  v_bitop3_b32 v44, v69, v5, v44 bitop3:0xbe
  v_bitop3_b32 v44, v70, v6, v44 bitop3:0xbe
  v_bitop3_b32 v44, v71, v7, v44 bitop3:0xbe
  v_and_b32 v44, s53, v44
  v_cmp_ne_u32 s[70:71], 0, v44
  s_nop 0
  s_cmp_lg_u64 s[70:71], 0
  s_cselect_b64 s[70:71], -1, 0
  s_mov_b64 exec, s[72:73]
  v_xor_b32 v44, v72, v4
  v_bitop3_b32 v44, v73, v5, v44 bitop3:0xbe
  v_bitop3_b32 v44, v74, v6, v44 bitop3:0xbe
  v_bitop3_b32 v44, v75, v7, v44 bitop3:0xbe
  v_and_b32 v44, s53, v44
  v_cmp_ne_u32 s[72:73], 0, v44
  s_nop 0
  s_cmp_lg_u64 s[72:73], 0
  s_cselect_b64 s[72:73], -1, 0
  s_mov_b64 exec, s[74:75]
  v_xor_b32 v44, v76, v4
  v_bitop3_b32 v44, v77, v5, v44 bitop3:0xbe
  v_bitop3_b32 v44, v78, v6, v44 bitop3:0xbe
  v_bitop3_b32 v44, v79, v7, v44 bitop3:0xbe
  v_and_b32 v44, s53, v44
  v_cmp_ne_u32 s[74:75], 0, v44
  s_nop 0
  s_cmp_lg_u64 s[74:75], 0
  s_cselect_b64 s[74:75], -1, 0
  s_or_b64 s[96:97], s[60:61], s[62:63]
  s_or_b64 s[96:97], s[96:97], s[64:65]
  s_or_b64 s[96:97], s[96:97], s[66:67]
  s_or_b64 s[96:97], s[96:97], s[68:69]
  s_or_b64 s[96:97], s[96:97], s[70:71]
  s_or_b64 s[96:97], s[96:97], s[72:73]
  s_or_b64 s[96:97], s[96:97], s[74:75]
  s_cbranch_scc1 L_g_21
  s_mov_b64 exec, -1
  s_cmp_le_u32 s100, 0
  s_cselect_b32 s101, 0, 0
  v_xor_b32 v10, 0, v9
  ds_write_b128 v10, v[48:51] offset:0
  v_xor_b32 v11, 64, v9
  ds_write_b128 v11, v[52:55] offset:256
  v_xor_b32 v10, 128, v9
  ds_write_b128 v10, v[56:59] offset:512
  v_xor_b32 v11, 192, v9
  ds_write_b128 v11, v[60:63] offset:768
  v_xor_b32 v10, 16, v9
  ds_write_b128 v10, v[64:67] offset:1024
  v_xor_b32 v11, 80, v9
  ds_write_b128 v11, v[68:71] offset:1280
  v_xor_b32 v10, 144, v9
  ds_write_b128 v10, v[72:75] offset:1536
  v_xor_b32 v11, 208, v9
  ds_write_b128 v11, v[76:79] offset:1792
  s_mov_b64 s[40:41], s[14:15]
  s_mov_b32 s42, 0x400000
  s_mov_b32 s43, 0x20000
  s_mov_b64 s[44:45], s[12:13]
  s_mov_b32 s46, 0x400000
  s_mov_b32 s47, 0x20000
  s_waitcnt lgkmcnt(0)
  s_setprio 3
  s_barrier
  s_cmp_lt_u32 s2, 128
  s_cbranch_scc0 L_lwB
  s_cmp_lg_u32 s101, 0
  s_cbranch_scc1 L_lwX
  buffer_load_dwordx4 v[176:179], v253, s[44:47], s88 offen nt
  s_add_u32 s88, s88, 65536
  buffer_load_dwordx4 v[180:183], v253, s[44:47], s88 offen nt
  s_add_u32 s88, s88, 65536
  buffer_load_dwordx4 v[184:187], v253, s[44:47], s88 offen nt
  s_add_u32 s88, s88, 65536
  buffer_load_dwordx4 v[188:191], v253, s[44:47], s88 offen nt
  buffer_load_dwordx4 v[208:211], v251, s[40:43], s89 offen nt
  s_add_u32 s89, s89, 4096
  buffer_load_dwordx4 v[212:215], v251, s[40:43], s89 offen nt
  s_add_u32 s89, s89, 4096
  buffer_load_dwordx4 v[216:219], v251, s[40:43], s89 offen nt
  s_add_u32 s89, s89, 4096
  buffer_load_dwordx4 v[220:223], v251, s[40:43], s89 offen nt
  s_add_u32 s89, s89, 4096
  buffer_load_dwordx4 v[224:227], v251, s[40:43], s89 offen nt
  s_add_u32 s89, s89, 4096
  buffer_load_dwordx4 v[228:231], v251, s[40:43], s89 offen nt
  s_add_u32 s89, s89, 4096
  buffer_load_dwordx4 v[232:235], v251, s[40:43], s89 offen nt
  s_add_u32 s89, s89, 4096
  buffer_load_dwordx4 v[236:239], v251, s[40:43], s89 offen nt
L_lwX:
  s_barrier
  s_barrier
  s_barrier
  s_branch L_pv
L_lwB:
  s_cmp_lg_u32 s101, 0
  s_cbranch_scc1 L_lwB2
  buffer_load_dwordx4 v[176:179], v253, s[44:47], s88 offen nt
  s_add_u32 s88, s88, 65536
  buffer_load_dwordx4 v[180:183], v253, s[44:47], s88 offen nt
  s_add_u32 s88, s88, 65536
  buffer_load_dwordx4 v[184:187], v253, s[44:47], s88 offen nt
  s_add_u32 s88, s88, 65536
  buffer_load_dwordx4 v[188:191], v253, s[44:47], s88 offen nt
  s_mov_b64 s[40:41], s[18:19]
  s_mov_b32 s42, 0x1c0000
  s_mov_b32 s43, 0x20000
  s_mov_b64 s[44:45], s[20:21]
  s_mov_b32 s46, 0x1c0000
  s_mov_b32 s47, 0x20000
  s_mov_b32 exec_lo, 0xfffffff
  s_mov_b32 exec_hi, 0xfffffff
  buffer_load_dwordx4 v[208:211], v251, s[40:43], s89 offen nt
  buffer_load_dwordx4 v[212:215], v251, s[44:47], s89 offen nt
  s_add_u32 s89, s89, 7168
  buffer_load_dwordx4 v[216:219], v251, s[40:43], s89 offen nt
  buffer_load_dwordx4 v[220:223], v251, s[44:47], s89 offen nt
  s_add_u32 s89, s89, 7168
  buffer_load_dwordx4 v[224:227], v251, s[40:43], s89 offen nt
  buffer_load_dwordx4 v[228:231], v251, s[44:47], s89 offen nt
  s_add_u32 s89, s89, 7168
  buffer_load_dwordx4 v[232:235], v251, s[40:43], s89 offen nt
  buffer_load_dwordx4 v[236:239], v251, s[44:47], s89 offen nt
  s_mov_b64 exec, -1
L_lwB2:
  s_and_b32 s74, s2, 31
  s_lshl_b32 s74, s74, 10
  s_lshr_b32 s97, s78, 5
  s_lshl_b32 s97, s97, 8
  s_add_u32 s74, s74, s97
  s_add_u32 s74, s74, 0x4000
  v_and_b32 v13, 7, v1
  v_lshlrev_b32 v13, 2, v13
  v_lshrrev_b32 v14, 4, v1
  v_add_u32 v13, v13, v14
  v_lshlrev_b32 v13, 5, v13
  s_lshl_b32 s92, s3, 2
  s_add_u32 s92, s92, 141296
  v_add_u32 v13, s92, v13
  v_lshlrev_b32 v14, 6, v1
  v_add_u32 v14, 141312, v14
  v_lshlrev_b32 v15, 4, v1
  v_xor_b32 v13, s59, v13
  v_xor_b32 v14, s59, v14
  s_waitcnt vmcnt(63)
  v_lshlrev_b32 v116, 16, v144
  v_and_b32 v117, 0xffff0000, v144
  v_lshlrev_b32 v118, 16, v145
  v_and_b32 v119, 0xffff0000, v145
  v_mul_f32 v112, 0xbfb8aa3b, v116
  v_mul_f32 v113, 0xbfb8aa3b, v117
  v_mul_f32 v114, 0xbfb8aa3b, v118
  v_mul_f32 v115, 0xbfb8aa3b, v119
  v_exp_f32 v112, v112
  v_exp_f32 v113, v113
  v_exp_f32 v114, v114
  v_exp_f32 v115, v115
  v_add_f32 v112, 1.0, v112
  v_add_f32 v113, 1.0, v113
  v_add_f32 v114, 1.0, v114
  v_add_f32 v115, 1.0, v115
  v_rcp_f32 v112, v112
  v_rcp_f32 v113, v113
  v_rcp_f32 v114, v114
  v_rcp_f32 v115, v115
  v_mul_f32 v116, v116, v112
  v_mul_f32 v117, v117, v113
  v_mul_f32 v118, v118, v114
  v_mul_f32 v119, v119, v115
  v_cvt_pk_bf16_f32 v116, v116, v116
  v_cvt_pk_bf16_f32 v117, v117, v117
  v_cvt_pk_bf16_f32 v118, v118, v118
  v_cvt_pk_bf16_f32 v119, v119, v119
  v_lshrrev_b32 v112, 16, v116
  v_lshrrev_b32 v113, 16, v117
  v_lshrrev_b32 v114, 16, v118
  v_lshrrev_b32 v115, 16, v119
  v_and_b32 v116, 0xffff0000, v116
  v_and_b32 v117, 0xffff0000, v117
  v_and_b32 v118, 0xffff0000, v118
  v_and_b32 v119, 0xffff0000, v119
  v_mov_b32 v96, 0
  v_mov_b32 v97, 0
  v_mov_b32 v98, 0
  v_mov_b32 v99, 0
  v_mov_b32 v100, 0
  v_mov_b32 v101, 0
  v_mov_b32 v102, 0
  v_mov_b32 v103, 0
  s_waitcnt vmcnt(63)
  v_dot2c_f32_bf16 v96, v112, v128
  v_dot2c_f32_bf16 v97, v116, v128
  v_dot2c_f32_bf16 v98, v112, v129
  v_dot2c_f32_bf16 v99, v116, v129
  v_dot2c_f32_bf16 v100, v112, v130
  v_dot2c_f32_bf16 v101, v116, v130
  v_dot2c_f32_bf16 v102, v112, v131
  v_dot2c_f32_bf16 v103, v116, v131
  s_waitcnt vmcnt(62)
  v_dot2c_f32_bf16 v96, v113, v132
  v_dot2c_f32_bf16 v97, v117, v132
  v_dot2c_f32_bf16 v98, v113, v133
  v_dot2c_f32_bf16 v99, v117, v133
  v_dot2c_f32_bf16 v100, v113, v134
  v_dot2c_f32_bf16 v101, v117, v134
  v_dot2c_f32_bf16 v102, v113, v135
  v_dot2c_f32_bf16 v103, v117, v135
  s_waitcnt vmcnt(61)
  v_dot2c_f32_bf16 v96, v114, v136
  v_dot2c_f32_bf16 v97, v118, v136
  v_dot2c_f32_bf16 v98, v114, v137
  v_dot2c_f32_bf16 v99, v118, v137
  v_dot2c_f32_bf16 v100, v114, v138
  v_dot2c_f32_bf16 v101, v118, v138
  v_dot2c_f32_bf16 v102, v114, v139
  v_dot2c_f32_bf16 v103, v118, v139
  s_waitcnt vmcnt(60)
  v_dot2c_f32_bf16 v96, v115, v140
  v_dot2c_f32_bf16 v97, v119, v140
  v_dot2c_f32_bf16 v98, v115, v141
  v_dot2c_f32_bf16 v99, v119, v141
  v_dot2c_f32_bf16 v100, v115, v142
  v_dot2c_f32_bf16 v101, v119, v142
  v_dot2c_f32_bf16 v102, v115, v143
  v_dot2c_f32_bf16 v103, v119, v143
  v_permlane32_swap_b32 v96, v100
  v_permlane32_swap_b32 v97, v101
  v_permlane32_swap_b32 v98, v102
  v_permlane32_swap_b32 v99, v103
  v_add_f32 v96, v96, v100
  v_add_f32 v97, v97, v101
  v_add_f32 v98, v98, v102
  v_add_f32 v99, v99, v103
  s_nop 0
  v_permlane16_swap_b32 v96, v98
  v_permlane16_swap_b32 v97, v99
  v_add_f32 v96, v96, v98
  v_add_f32 v97, v97, v99
  s_nop 0
  v_add_f32_dpp v96, v96, v96 row_ror:8 row_mask:0xf bank_mask:0xf
  v_add_f32_dpp v97, v97, v97 row_ror:8 row_mask:0xf bank_mask:0xf
  s_barrier
  ds_write2_b32 v13, v96, v97 offset0:0 offset1:4
  s_waitcnt lgkmcnt(0)
  s_barrier
  s_cmp_lg_u32 s3, 4
  s_cbranch_scc1 L_nopub_33
  s_mov_b64 exec, 0xffff
  ds_read_b128 v[128:131], v14 offset:0
  ds_read_b128 v[132:135], v14 offset:16
  ds_read_b128 v[136:139], v14 offset:32
  ds_read_b128 v[140:143], v14 offset:48
  s_waitcnt lgkmcnt(3)
  v_add_f32 v128, v128, v129
  v_add_f32 v130, v130, v131
  v_add_f32 v128, v128, v130
  s_waitcnt lgkmcnt(2)
  v_add_f32 v132, v132, v133
  v_add_f32 v134, v134, v135
  v_add_f32 v132, v132, v134
  s_waitcnt lgkmcnt(1)
  v_add_f32 v136, v136, v137
  v_add_f32 v138, v138, v139
  v_add_f32 v136, v136, v138
  s_waitcnt lgkmcnt(0)
  v_add_f32 v140, v140, v141
  v_add_f32 v142, v142, v143
  v_add_f32 v140, v140, v142
  v_and_or_b32 v100, v128, v2, s49
  v_and_or_b32 v101, v132, v2, s50
  v_and_or_b32 v102, v136, v2, s51
  v_and_or_b32 v103, v140, v2, s52
  buffer_store_dwordx4 v[100:103], v15, s[32:35], s74 offen sc1
L_nopub_33:
  s_mov_b64 exec, -1
  s_barrier
  s_branch L_pv
L_front:
  s_mov_b32 s100, 0
  s_waitcnt vmcnt(4)
  s_branch L_epc_35
L_ep_34:
  global_load_dword v252, v253, s[30:31] sc1
  s_add_u32 s100, s100, 1
  s_cmp_gt_u32 s100, 1000000
  s_cbranch_scc1 L_abort
  s_waitcnt vmcnt(0)
L_epc_35:
  v_readfirstlane_b32 s48, v252
  s_nop 0
  s_cmp_eq_u32 s48, 0
  s_nop 1
  s_cbranch_scc1 L_ep_34
  s_mul_i32 s48, s48, 0x9e3779b1
  s_and_b32 s49, s48, 0xff
  s_bfe_u32 s50, s48, 0x80008
  s_bfe_u32 s51, s48, 0x80010
  s_lshr_b32 s52, s48, 24
  s_lshr_b32 s97, s48, 15
  s_xor_b32 s97, s97, s48
  s_mul_i32 s97, s97, 0x85ebca6b
  v_mov_b32 v4, s48
  v_mov_b32 v5, s97
  v_mov_b32 v249, s48
  v_mov_b32 v250, s97
  v_and_b32 v6, 4, v1
  v_cmp_eq_u32 vcc, 0, v6
  v_and_b32 v7, 3, v1
  v_lshlrev_b32 v7, 2, v7
  v_cndmask_b32 v4, v5, v4, vcc
  v_lshrrev_b32 v4, v7, v4
  v_lshrrev_b32 v5, 1, v4
  v_lshrrev_b32 v6, 2, v4
  v_lshrrev_b32 v7, 3, v4
L_setup:
  s_lshr_b32 s92, s3, 1
  s_lshl_b32 s92, s92, 15
  s_and_b32 s93, s3, 1
  v_lshlrev_b32 v34, 4, v1
  v_bfe_u32 v44, v1, 2, 2
  v_lshrrev_b32 v45, 5, v1
  v_lshl_add_u32 v46, v45, 2, v44
  v_lshlrev_b32 v46, 8, v46
  v_add_u32 v46, s92, v46
  v_and_b32 v47, 1, v1
  v_lshl_add_u32 v46, v47, 3, v46
  v_lshl_or_b32 v44, v44, 2, v45
  v_bfe_u32 v47, v1, 4, 1
  v_lshlrev_b32 v47, 1, v47
  v_xor_b32 v44, v44, v47
  v_bfe_u32 v47, v1, 1, 1
  v_xor_b32 v44, v44, v47
  s_lshl_b32 s94, s93, 3
  v_xor_b32 v44, s94, v44
  v_xor_b32 v47, 0, v44
  v_lshl_add_u32 v24, v47, 4, v46
  v_xor_b32 v47, 2, v44
  v_lshl_add_u32 v25, v47, 4, v46
  v_add_u32 v25, 2048, v25
  v_xor_b32 v47, 4, v44
  v_lshl_add_u32 v26, v47, 4, v46
  v_xor_b32 v47, 6, v44
  v_lshl_add_u32 v27, v47, 4, v46
  v_add_u32 v27, 2048, v27
  v_add_u32 v28, 132096, v34
  v_and_b32 v44, 31, v1
  v_lshlrev_b32 v29, 5, v44
  v_add_u32 v29, 131072, v29
  v_xor_b32 v28, s59, v28
  v_xor_b32 v29, s59, v29
  s_lshl_b32 s94, s93, 7
  s_add_u32 s94, s94, s92
  v_and_b32 v46, 3, v44
  v_lshlrev_b32 v46, 6, v46
  v_lshl_add_u32 v46, v44, 8, v46
  v_bfe_u32 v47, v44, 1, 2
  v_lshlrev_b32 v45, 1, v45
  v_xor_b32 v47, v47, v45
  v_lshl_add_u32 v46, v47, 4, v46
  v_xor_b32 v244, s94, v46
  v_xor_b32 v245, 16, v244
  v_xor_b32 v246, 64, v244
  v_xor_b32 v247, 0x50, v244
  v_lshrrev_b32 v44, 2, v1
  v_and_b32 v46, 3, v44
  v_lshlrev_b32 v46, 6, v46
  v_lshl_add_u32 v46, v44, 8, v46
  v_bfe_u32 v47, v44, 1, 2
  v_and_b32 v45, 3, v1
  v_xor_b32 v47, v47, v45
  v_lshl_add_u32 v46, v47, 4, v46
  v_xor_b32 v32, s94, v46
  v_xor_b32 v33, 64, v32
  v_lshrrev_b32 v44, 3, v1
  v_bfe_u32 v45, v1, 2, 1
  v_and_b32 v46, 3, v44
  v_xor_b32 v46, v46, v45
  v_lshlrev_b32 v46, 6, v46
  v_lshl_add_u32 v46, v44, 8, v46
  v_lshrrev_b32 v47, 1, v44
  v_and_b32 v45, 3, v1
  v_xor_b32 v47, v47, v45
  v_lshl_add_u32 v46, v47, 4, v46
  v_xor_b32 v32, s94, v46
  s_mul_i32 s87, s2, 32896
  s_lshl_b32 s97, s3, 12
  s_add_u32 s87, s87, s97
  s_add_u32 s87, s87, 0x200000
  s_lshl_b32 s94, s76, 4
  s_lshl_b32 s97, s3, 9
  s_add_u32 s94, s94, s97
  s_add_u32 s94, s94, 0x20000
  v_lshrrev_b32 v35, 3, v1
  v_lshlrev_b32 v35, 12, v35
  v_add_u32 v35, s94, v35
  v_lshlrev_b32 v248, 4, v1
  v_lshrrev_b32 v36, 3, v1
  v_mul_u32_u24 v36, 263168, v36
  v_and_b32 v3, 7, v1
  v_lshl_add_u32 v36, v3, 4, v36
  s_mul_i32 s94, s3, 32896
  s_lshl_b32 s97, s77, 12
  s_add_u32 s94, s94, s97
  s_lshl_b32 s97, s76, 7
  s_add_u32 s94, s94, s97
  s_add_u32 s83, s94, 6307840
  s_add_u32 s84, s94, 8413184
  s_add_u32 s85, s94, 2097152
  s_add_u32 s86, s94, 4202496
  s_mul_i32 s94, s3, 144
  s_add_u32 s94, s94, 0x14000
  v_and_b32 v37, 7, v1
  v_lshlrev_b32 v37, 4, v37
  v_lshrrev_b32 v3, 4, v1
  v_lshl_add_u32 v37, v3, 2, v37
  v_add_u32 v37, s94, v37
  v_and_b32 v38, 7, v1
  v_mul_u32_u24 v38, 144, v38
  v_lshrrev_b32 v3, 4, v1
  v_lshl_add_u32 v38, v3, 4, v38
  v_add_u32 v38, 81920, v38
  s_lshl_b32 s94, s3, 7
  s_add_u32 s94, s94, 0x16c00
  v_lshrrev_b32 v41, 4, v1
  v_lshlrev_b32 v41, 4, v41
  v_add_u32 v41, s94, v41
  v_and_b32 v40, 7, v1
  v_mul_u32_u24 v40, 272, v40
  v_lshrrev_b32 v3, 4, v1
  v_lshl_add_u32 v40, v3, 4, v40
  v_add_u32 v40, 94208, v40
  s_lshl_b32 s94, s76, 12
  s_lshl_b32 s97, s3, 6
  s_add_u32 s94, s94, s97
  s_add_u32 s94, s94, 0x40000
  v_bfe_u32 v39, v1, 2, 3
  v_lshlrev_b32 v39, 9, v39
  v_and_b32 v3, 3, v1
  v_lshl_add_u32 v39, v3, 4, v39
  v_add_u32 v39, s94, v39
  s_lshl_b32 s95, s77, 9
  s_add_u32 s16, s94, s95
  s_and_b32 s94, s3, 3
  s_mul_i32 s94, s94, 4864
  v_lshrrev_b32 v240, 4, v1
  v_mul_u32_u24 v240, 288, v240
  v_and_b32 v3, 15, v1
  v_lshl_add_u32 v240, v3, 4, v240
  v_add_u32 v240, s94, v240
  s_and_b32 s94, s3, 3
  s_mul_i32 s94, s94, 9728
  s_add_u32 s94, s94, 0x5000
  v_lshrrev_b32 v241, 4, v1
  v_mul_u32_u24 v241, 288, v241
  v_and_b32 v3, 15, v1
  v_lshl_add_u32 v241, v3, 4, v241
  v_add_u32 v241, s94, v241
  s_lshl_b32 s94, s3, 5
  v_lshrrev_b32 v242, 4, v1
  v_mul_u32_u24 v242, 2432, v242
  v_bfe_u32 v3, v1, 2, 2
  v_mul_u32_u24 v3, 288, v3
  v_add_u32 v242, v3, v242
  v_and_b32 v3, 3, v1
  v_lshl_add_u32 v242, v3, 3, v242
  v_add_u32 v242, s94, v242
  v_lshrrev_b32 v243, 4, v1
  v_mul_u32_u24 v243, 2432, v243
  v_bfe_u32 v3, v1, 2, 2
  v_mul_u32_u24 v3, 288, v3
  v_add_u32 v243, v3, v243
  v_and_b32 v3, 3, v1
  v_lshl_add_u32 v243, v3, 3, v243
  v_add_u32 v243, 20480, v243
  v_add_u32 v243, s94, v243
  v_bfe_u32 v43, v1, 2, 3
  v_mul_u32_u24 v43, 272, v43
  v_and_b32 v3, 3, v1
  v_lshl_add_u32 v43, v3, 3, v43
  v_add_u32 v43, 94208, v43
  v_add_u32 v43, s94, v43
  s_cmp_ge_u32 s3, 4
  s_cbranch_scc1 L_back2
  v_and_b32 v44, 31, v1
  v_and_b32 v46, 3, v44
  v_lshlrev_b32 v46, 2, v46
  v_bfe_u32 v47, v44, 2, 2
  v_or_b32 v46, v46, v47
  v_lshrrev_b32 v47, 5, v1
  v_xor_b32 v46, v46, v47
  v_lshlrev_b32 v45, 8, v44
  v_xor_b32 v47, 0, v46
  v_lshl_add_u32 v16, v47, 4, v45
  v_xor_b32 v47, 2, v46
  v_lshl_add_u32 v17, v47, 4, v45
  v_xor_b32 v47, 4, v46
  v_lshl_add_u32 v18, v47, 4, v45
  v_xor_b32 v47, 6, v46
  v_lshl_add_u32 v19, v47, 4, v45
  v_xor_b32 v47, 8, v46
  v_lshl_add_u32 v20, v47, 4, v45
  v_xor_b32 v47, 10, v46
  v_lshl_add_u32 v21, v47, 4, v45
  v_xor_b32 v47, 12, v46
  v_lshl_add_u32 v22, v47, 4, v45
  v_xor_b32 v47, 14, v46
  v_lshl_add_u32 v23, v47, 4, v45
  s_lshl_b32 s92, s17, 13
  s_add_u32 s92, s92, 131072
  v_add_u32 v8, s91, v16
  v_add_u32 v16, s92, v16
  v_add_u32 v9, s91, v17
  v_add_u32 v17, s92, v17
  v_add_u32 v10, s91, v18
  v_add_u32 v18, s92, v18
  v_add_u32 v11, s91, v19
  v_add_u32 v19, s92, v19
  v_add_u32 v12, s91, v20
  v_add_u32 v20, s92, v20
  v_add_u32 v13, s91, v21
  v_add_u32 v21, s92, v21
  v_add_u32 v14, s91, v22
  v_add_u32 v22, s92, v22
  v_add_u32 v15, s91, v23
  v_add_u32 v23, s92, v23
  s_lshl_b32 s92, s3, 2
  v_lshrrev_b32 v47, 5, v1
  v_lshl_add_u32 v30, v47, 4, v29
  v_add_u32 v30, s92, v30
  s_lshl_b32 s92, s3, 11
  v_add_u32 v31, s92, v28
  s_setprio 2
  s_mov_b32 s101, 1
  s_waitcnt vmcnt(4)
  s_barrier
  ds_read_b128 v[112:115], v8
  ds_read_b128 v[116:119], v16
  ds_read_b128 v[120:123], v9
  ds_read_b128 v[124:127], v17
  ds_read_b128 v[128:131], v10
  ds_read_b128 v[132:135], v18
  ds_read_b128 v[136:139], v11
  ds_read_b128 v[140:143], v19
  ds_read_b128 v[144:147], v12
  ds_read_b128 v[148:151], v20
  ds_read_b128 v[152:155], v13
  ds_read_b128 v[156:159], v21
  v_xor_b32 v8, 0x8000, v8
  v_xor_b32 v16, 0x2000, v16
  v_xor_b32 v9, 0x8000, v9
  v_xor_b32 v17, 0x2000, v17
  v_xor_b32 v10, 0x8000, v10
  v_xor_b32 v18, 0x2000, v18
  v_xor_b32 v11, 0x8000, v11
  v_xor_b32 v19, 0x2000, v19
  v_xor_b32 v12, 0x8000, v12
  v_xor_b32 v20, 0x2000, v20
  v_xor_b32 v13, 0x8000, v13
  v_xor_b32 v21, 0x2000, v21
  s_waitcnt lgkmcnt(10)
  v_mfma_f32_32x32x16_bf16 v[96:111], v[112:115], v[116:119], 0
  ds_read_b128 v[160:163], v14
  ds_read_b128 v[164:167], v22
  v_xor_b32 v14, 0x8000, v14
  v_xor_b32 v22, 0x2000, v22
  s_waitcnt lgkmcnt(10)
  v_mfma_f32_32x32x16_bf16 v[96:111], v[120:123], v[124:127], v[96:111]
  ds_read_b128 v[168:171], v15
  ds_read_b128 v[172:175], v23
  v_xor_b32 v15, 0x8000, v15
  v_xor_b32 v23, 0x2000, v23
  s_waitcnt lgkmcnt(10)
  v_mfma_f32_32x32x16_bf16 v[96:111], v[128:131], v[132:135], v[96:111]
  ds_read_b128 v[112:115], v8
  ds_read_b128 v[116:119], v16
  v_xor_b32 v8, 0x18000, v8
  v_xor_b32 v16, 0x6000, v16
  s_waitcnt lgkmcnt(10)
  v_mfma_f32_32x32x16_bf16 v[96:111], v[136:139], v[140:143], v[96:111]
  ds_read_b128 v[120:123], v9
  ds_read_b128 v[124:127], v17
  v_xor_b32 v9, 0x18000, v9
  v_xor_b32 v17, 0x6000, v17
  s_waitcnt lgkmcnt(10)
  v_mfma_f32_32x32x16_bf16 v[96:111], v[144:147], v[148:151], v[96:111]
  ds_read_b128 v[128:131], v10
  ds_read_b128 v[132:135], v18
  v_xor_b32 v10, 0x18000, v10
  v_xor_b32 v18, 0x6000, v18
  s_waitcnt lgkmcnt(10)
  v_mfma_f32_32x32x16_bf16 v[96:111], v[152:155], v[156:159], v[96:111]
  ds_read_b128 v[136:139], v11
  ds_read_b128 v[140:143], v19
  v_xor_b32 v11, 0x18000, v11
  v_xor_b32 v19, 0x6000, v19
  s_waitcnt lgkmcnt(10)
  v_mfma_f32_32x32x16_bf16 v[96:111], v[160:163], v[164:167], v[96:111]
  ds_read_b128 v[144:147], v12
  ds_read_b128 v[148:151], v20
  v_xor_b32 v12, 0x18000, v12
  v_xor_b32 v20, 0x6000, v20
  s_waitcnt lgkmcnt(10)
  v_mfma_f32_32x32x16_bf16 v[96:111], v[168:171], v[172:175], v[96:111]
  ds_read_b128 v[152:155], v13
  ds_read_b128 v[156:159], v21
  v_xor_b32 v13, 0x18000, v13
  v_xor_b32 v21, 0x6000, v21
  s_waitcnt lgkmcnt(10)
  v_mfma_f32_32x32x16_bf16 v[96:111], v[112:115], v[116:119], v[96:111]
  ds_read_b128 v[160:163], v14
  ds_read_b128 v[164:167], v22
  v_xor_b32 v14, 0x18000, v14
  v_xor_b32 v22, 0x6000, v22
  s_waitcnt lgkmcnt(10)
  v_mfma_f32_32x32x16_bf16 v[96:111], v[120:123], v[124:127], v[96:111]
  ds_read_b128 v[168:171], v15
  ds_read_b128 v[172:175], v23
  v_xor_b32 v15, 0x18000, v15
  v_xor_b32 v23, 0x6000, v23
  s_waitcnt lgkmcnt(10)
  v_mfma_f32_32x32x16_bf16 v[96:111], v[128:131], v[132:135], v[96:111]
  ds_read_b128 v[112:115], v8
  ds_read_b128 v[116:119], v16
  v_xor_b32 v8, 0x8000, v8
  v_xor_b32 v16, 0x2000, v16
  s_waitcnt lgkmcnt(10)
  v_mfma_f32_32x32x16_bf16 v[96:111], v[136:139], v[140:143], v[96:111]
  ds_read_b128 v[120:123], v9
  ds_read_b128 v[124:127], v17
  v_xor_b32 v9, 0x8000, v9
  v_xor_b32 v17, 0x2000, v17
  s_waitcnt lgkmcnt(10)
  v_mfma_f32_32x32x16_bf16 v[96:111], v[144:147], v[148:151], v[96:111]
  ds_read_b128 v[128:131], v10
  ds_read_b128 v[132:135], v18
  v_xor_b32 v10, 0x8000, v10
  v_xor_b32 v18, 0x2000, v18
  s_waitcnt lgkmcnt(10)
  v_mfma_f32_32x32x16_bf16 v[96:111], v[152:155], v[156:159], v[96:111]
  ds_read_b128 v[136:139], v11
  ds_read_b128 v[140:143], v19
  v_xor_b32 v11, 0x8000, v11
  v_xor_b32 v19, 0x2000, v19
  s_waitcnt lgkmcnt(10)
  v_mfma_f32_32x32x16_bf16 v[96:111], v[160:163], v[164:167], v[96:111]
  ds_read_b128 v[144:147], v12
  ds_read_b128 v[148:151], v20
  v_xor_b32 v12, 0x8000, v12
  v_xor_b32 v20, 0x2000, v20
  s_waitcnt lgkmcnt(10)
  v_mfma_f32_32x32x16_bf16 v[96:111], v[168:171], v[172:175], v[96:111]
  ds_read_b128 v[152:155], v13
  ds_read_b128 v[156:159], v21
  v_xor_b32 v13, 0x8000, v13
  v_xor_b32 v21, 0x2000, v21
  s_barrier
  s_waitcnt lgkmcnt(10)
  v_mfma_f32_32x32x16_bf16 v[96:111], v[112:115], v[116:119], v[96:111]
  ds_read_b128 v[160:163], v14
  ds_read_b128 v[164:167], v22
  v_xor_b32 v14, 0x8000, v14
  v_xor_b32 v22, 0x2000, v22
  s_waitcnt lgkmcnt(10)
  v_mfma_f32_32x32x16_bf16 v[96:111], v[120:123], v[124:127], v[96:111]
  ds_read_b128 v[168:171], v15
  ds_read_b128 v[172:175], v23
  v_xor_b32 v15, 0x8000, v15
  v_xor_b32 v23, 0x2000, v23
  s_waitcnt lgkmcnt(10)
  v_mfma_f32_32x32x16_bf16 v[96:111], v[128:131], v[132:135], v[96:111]
  s_waitcnt vmcnt(0)
  ds_read_b128 v[112:115], v8
  ds_read_b128 v[116:119], v16
  s_waitcnt lgkmcnt(10)
  v_mfma_f32_32x32x16_bf16 v[96:111], v[136:139], v[140:143], v[96:111]
  ds_read_b128 v[120:123], v9
  ds_read_b128 v[124:127], v17
  s_waitcnt lgkmcnt(10)
  v_mfma_f32_32x32x16_bf16 v[96:111], v[144:147], v[148:151], v[96:111]
  ds_read_b128 v[128:131], v10
  ds_read_b128 v[132:135], v18
  s_waitcnt lgkmcnt(10)
  v_mfma_f32_32x32x16_bf16 v[96:111], v[152:155], v[156:159], v[96:111]
  ds_read_b128 v[136:139], v11
  ds_read_b128 v[140:143], v19
  s_waitcnt lgkmcnt(10)
  v_mfma_f32_32x32x16_bf16 v[96:111], v[160:163], v[164:167], v[96:111]
  ds_read_b128 v[144:147], v12
  ds_read_b128 v[148:151], v20
  s_waitcnt lgkmcnt(10)
  v_mfma_f32_32x32x16_bf16 v[96:111], v[168:171], v[172:175], v[96:111]
  ds_read_b128 v[152:155], v13
  ds_read_b128 v[156:159], v21
  s_waitcnt lgkmcnt(10)
  v_mfma_f32_32x32x16_bf16 v[96:111], v[112:115], v[116:119], v[96:111]
  ds_read_b128 v[160:163], v14
  ds_read_b128 v[164:167], v22
  s_waitcnt lgkmcnt(10)
  v_mfma_f32_32x32x16_bf16 v[96:111], v[120:123], v[124:127], v[96:111]
  ds_read_b128 v[168:171], v15
  ds_read_b128 v[172:175], v23
  s_waitcnt lgkmcnt(10)
  v_mfma_f32_32x32x16_bf16 v[96:111], v[128:131], v[132:135], v[96:111]
  s_waitcnt lgkmcnt(8)
  v_mfma_f32_32x32x16_bf16 v[96:111], v[136:139], v[140:143], v[96:111]
  s_waitcnt lgkmcnt(6)
  v_mfma_f32_32x32x16_bf16 v[96:111], v[144:147], v[148:151], v[96:111]
  s_waitcnt lgkmcnt(4)
  v_mfma_f32_32x32x16_bf16 v[96:111], v[152:155], v[156:159], v[96:111]
  s_waitcnt lgkmcnt(2)
  v_mfma_f32_32x32x16_bf16 v[96:111], v[160:163], v[164:167], v[96:111]
  s_waitcnt lgkmcnt(0)
  v_mfma_f32_32x32x16_bf16 v[96:111], v[168:171], v[172:175], v[96:111]
  s_nop 11
  v_max3_f32 v44, v96, v97, v98
  v_max3_f32 v45, v99, v100, v101
  v_max3_f32 v46, v102, v103, v104
  v_max3_f32 v47, v105, v106, v107
  v_max3_f32 v44, v44, v108, v109
  v_max3_f32 v45, v45, v110, v111
  v_max3_f32 v44, v44, v46, v47
  v_max_f32 v44, v44, v45
  ds_write_b32 v30, v44
  v_sub_f32 v96, v96, v44
  v_sub_f32 v97, v97, v44
  v_sub_f32 v98, v98, v44
  v_sub_f32 v99, v99, v44
  v_sub_f32 v100, v100, v44
  v_sub_f32 v101, v101, v44
  v_sub_f32 v102, v102, v44
  v_sub_f32 v103, v103, v44
  s_waitcnt lgkmcnt(0)
  s_barrier
  ds_read_b128 v[48:51], v29
  ds_read_b128 v[52:55], v29 offset:16
  v_exp_f32 v96, v96
  v_sub_f32 v104, v104, v44
  v_exp_f32 v97, v97
  v_sub_f32 v105, v105, v44
  v_exp_f32 v98, v98
  v_sub_f32 v106, v106, v44
  v_exp_f32 v99, v99
  v_sub_f32 v107, v107, v44
  v_exp_f32 v100, v100
  v_sub_f32 v108, v108, v44
  v_exp_f32 v101, v101
  v_sub_f32 v109, v109, v44
  v_exp_f32 v102, v102
  v_sub_f32 v110, v110, v44
  v_exp_f32 v103, v103
  v_sub_f32 v111, v111, v44
  s_waitcnt lgkmcnt(0)
  v_max3_f32 v45, v48, v49, v50
  v_max3_f32 v46, v51, v52, v53
  v_exp_f32 v104, v104
  v_max3_f32 v45, v45, v54, v55
  v_exp_f32 v105, v105
  v_max_f32 v45, v45, v46
  v_exp_f32 v106, v106
  v_sub_f32 v45, v44, v45
  v_exp_f32 v107, v107
  v_exp_f32 v45, v45
  v_exp_f32 v108, v108
  v_exp_f32 v109, v109
  v_exp_f32 v110, v110
  v_exp_f32 v111, v111
  v_mul_f32 v96, v96, v45
  v_mul_f32 v97, v97, v45
  v_mul_f32 v98, v98, v45
  v_mul_f32 v99, v99, v45
  v_mul_f32 v100, v100, v45
  v_mul_f32 v101, v101, v45
  v_mul_f32 v102, v102, v45
  v_mul_f32 v103, v103, v45
  v_cvt_pk_bf16_f32 v48, v96, v97
  v_cvt_pk_bf16_f32 v49, v98, v99
  v_cvt_pk_bf16_f32 v50, v100, v101
  v_cvt_pk_bf16_f32 v51, v102, v103
  ds_write_b128 v31, v[48:51] offset:0
  v_mul_f32 v104, v104, v45
  v_mul_f32 v105, v105, v45
  v_mul_f32 v106, v106, v45
  v_mul_f32 v107, v107, v45
  v_mul_f32 v108, v108, v45
  v_mul_f32 v109, v109, v45
  v_mul_f32 v110, v110, v45
  v_mul_f32 v111, v111, v45
  v_cvt_pk_bf16_f32 v52, v104, v105
  v_cvt_pk_bf16_f32 v53, v106, v107
  v_cvt_pk_bf16_f32 v54, v108, v109
  v_cvt_pk_bf16_f32 v55, v110, v111
  ds_write_b128 v31, v[52:55] offset:1024
  v_add_f32 v96, v96, v97
  v_add_f32 v98, v98, v99
  v_add_f32 v100, v100, v101
  v_add_f32 v102, v102, v103
  v_add_f32 v104, v104, v105
  v_add_f32 v106, v106, v107
  v_add_f32 v108, v108, v109
  v_add_f32 v110, v110, v111
  v_add_f32 v96, v96, v98
  v_add_f32 v100, v100, v102
  v_add_f32 v104, v104, v106
  v_add_f32 v108, v108, v110
  v_add_f32 v96, v96, v100
  v_add_f32 v104, v104, v108
  v_add_f32 v96, v96, v104
  ds_write_b32 v30, v96 offset:9216
  s_waitcnt lgkmcnt(0)
  s_barrier
L_pv:
  s_setprio 2
  ds_read_b128 v[48:51], v28 offset:0
  ds_read_b64_tr_b16 v[112:113], v24 offset:0
  ds_read_b64_tr_b16 v[114:115], v25 offset:0
  ds_read_b128 v[52:55], v28 offset:1024
  ds_read_b64_tr_b16 v[116:117], v24 offset:4096
  ds_read_b64_tr_b16 v[118:119], v25 offset:4096
  ds_read_b128 v[56:59], v28 offset:2048
  ds_read_b64_tr_b16 v[120:121], v24 offset:8192
  ds_read_b64_tr_b16 v[122:123], v25 offset:8192
  ds_read_b128 v[60:63], v28 offset:3072
  ds_read_b64_tr_b16 v[124:125], v24 offset:12288
  ds_read_b64_tr_b16 v[126:127], v25 offset:12288
  s_lshl_b32 s74, s2, 9
  s_add_u32 s74, s74, 0x20000
  s_mov_b32 s70, 0x10000
  s_mov_b32 s71, 0x18000
  s_mov_b32 s72, 0x8000
  s_cmp_lg_u32 s3, 7
  s_cbranch_scc1 L_nolse
  ds_read_b128 v[144:147], v29
  ds_read_b128 v[148:151], v29 offset:16
  s_waitcnt lgkmcnt(6)
  ds_read_b128 v[152:155], v29 offset:9216
  ds_read_b128 v[156:159], v29 offset:9232
  s_andn2_b32 s92, s48, 1
  v_mov_b32 v23, s92
  s_waitcnt lgkmcnt(2)
  v_max3_f32 v20, v144, v145, v146
  v_max3_f32 v21, v147, v148, v149
  v_max3_f32 v20, v20, v150, v151
  v_max_f32 v20, v20, v21
  s_waitcnt lgkmcnt(0)
  v_add_f32 v152, v152, v153
  v_add_f32 v154, v154, v155
  v_add_f32 v156, v156, v157
  v_add_f32 v158, v158, v159
  v_add_f32 v152, v152, v154
  v_add_f32 v156, v156, v158
  v_add_f32 v152, v152, v156
  v_mov_b32 v21, v152
  s_mov_b32 exec_hi, 0
  buffer_store_dwordx4 v[20:23], v248, s[32:35], s74 offen sc1
  s_mov_b32 exec_hi, -1
L_nolse:
  s_waitcnt lgkmcnt(9)
  v_mfma_f32_32x32x16_bf16 v[144:159], v[112:115], v[48:51], 0
  ds_read_b128 v[64:67], v28 offset:4096
  ds_read_b64_tr_b16 v[128:129], v24 offset:16384
  ds_read_b64_tr_b16 v[130:131], v25 offset:16384
  s_waitcnt lgkmcnt(9)
  v_mfma_f32_32x32x16_bf16 v[144:159], v[116:119], v[52:55], v[144:159]
  ds_read_b128 v[68:71], v28 offset:5120
  ds_read_b64_tr_b16 v[132:133], v24 offset:20480
  ds_read_b64_tr_b16 v[134:135], v25 offset:20480
  v_lshrrev_b32 v44, 5, v1
  v_lshlrev_b32 v44, 3, v44
  v_lshrrev_b32 v96, v44, v249
  v_lshrrev_b32 v104, v44, v250
  s_waitcnt lgkmcnt(9)
  v_mfma_f32_32x32x16_bf16 v[144:159], v[120:123], v[56:59], v[144:159]
  ds_read_b128 v[72:75], v28 offset:6144
  ds_read_b64_tr_b16 v[136:137], v24 offset:24576
  ds_read_b64_tr_b16 v[138:139], v25 offset:24576
  v_lshrrev_b32 v97, 1, v96
  v_lshrrev_b32 v98, 2, v96
  v_lshrrev_b32 v99, 3, v96
  s_waitcnt lgkmcnt(9)
  v_mfma_f32_32x32x16_bf16 v[144:159], v[124:127], v[60:63], v[144:159]
  ds_read_b128 v[76:79], v28 offset:7168
  ds_read_b64_tr_b16 v[140:141], v24 offset:28672
  ds_read_b64_tr_b16 v[142:143], v25 offset:28672
  v_lshrrev_b32 v100, 4, v96
  v_lshrrev_b32 v101, 5, v96
  v_lshrrev_b32 v102, 6, v96
  v_lshrrev_b32 v103, 7, v96
  s_waitcnt lgkmcnt(9)
  v_mfma_f32_32x32x16_bf16 v[144:159], v[128:131], v[64:67], v[144:159]
  ds_read_b64_tr_b16 v[112:113], v26 offset:0
  ds_read_b64_tr_b16 v[114:115], v27 offset:0
  v_lshrrev_b32 v105, 1, v104
  v_lshrrev_b32 v106, 2, v104
  v_lshrrev_b32 v107, 3, v104
  s_waitcnt lgkmcnt(8)
  v_mfma_f32_32x32x16_bf16 v[144:159], v[132:135], v[68:71], v[144:159]
  ds_read_b64_tr_b16 v[116:117], v26 offset:4096
  ds_read_b64_tr_b16 v[118:119], v27 offset:4096
  v_lshrrev_b32 v108, 4, v104
  v_lshrrev_b32 v109, 5, v104
  v_lshrrev_b32 v110, 6, v104
  v_lshrrev_b32 v111, 7, v104
  s_waitcnt lgkmcnt(7)
  v_mfma_f32_32x32x16_bf16 v[144:159], v[136:139], v[72:75], v[144:159]
  ds_read_b64_tr_b16 v[120:121], v26 offset:8192
  ds_read_b64_tr_b16 v[122:123], v27 offset:8192
  s_waitcnt lgkmcnt(6)
  v_mfma_f32_32x32x16_bf16 v[144:159], v[140:143], v[76:79], v[144:159]
  ds_read_b64_tr_b16 v[124:125], v26 offset:12288
  ds_read_b64_tr_b16 v[126:127], v27 offset:12288
  s_waitcnt lgkmcnt(6)
  v_mfma_f32_32x32x16_bf16 v[160:175], v[112:115], v[48:51], 0
  ds_read_b64_tr_b16 v[128:129], v26 offset:16384
  ds_read_b64_tr_b16 v[130:131], v27 offset:16384
  s_waitcnt lgkmcnt(6)
  v_mfma_f32_32x32x16_bf16 v[160:175], v[116:119], v[52:55], v[160:175]
  ds_read_b64_tr_b16 v[132:133], v26 offset:20480
  ds_read_b64_tr_b16 v[134:135], v27 offset:20480
  s_waitcnt lgkmcnt(6)
  v_mfma_f32_32x32x16_bf16 v[160:175], v[120:123], v[56:59], v[160:175]
  ds_read_b64_tr_b16 v[136:137], v26 offset:24576
  ds_read_b64_tr_b16 v[138:139], v27 offset:24576
  v_cvt_pk_bf16_f32 v80, v144, v145
  v_cvt_pk_bf16_f32 v81, v146, v147
  v_cvt_pk_bf16_f32 v82, v148, v149
  v_cvt_pk_bf16_f32 v83, v150, v151
  v_bfi_b32 v80, s53, v96, v80
  v_bfi_b32 v81, s53, v97, v81
  v_bfi_b32 v82, s53, v98, v82
  v_bfi_b32 v83, s53, v99, v83
  ds_write_b128 v244, v[80:83]
  s_waitcnt lgkmcnt(7)
  v_mfma_f32_32x32x16_bf16 v[160:175], v[124:127], v[60:63], v[160:175]
  ds_read_b64_tr_b16 v[140:141], v26 offset:28672
  ds_read_b64_tr_b16 v[142:143], v27 offset:28672
  v_cvt_pk_bf16_f32 v84, v152, v153
  v_cvt_pk_bf16_f32 v85, v154, v155
  v_cvt_pk_bf16_f32 v86, v156, v157
  v_cvt_pk_bf16_f32 v87, v158, v159
  v_bfi_b32 v84, s53, v100, v84
  v_bfi_b32 v85, s53, v101, v85
  v_bfi_b32 v86, s53, v102, v86
  v_bfi_b32 v87, s53, v103, v87
  ds_write_b128 v245, v[84:87]
  s_waitcnt lgkmcnt(8)
  v_mfma_f32_32x32x16_bf16 v[160:175], v[128:131], v[64:67], v[160:175]
  s_waitcnt lgkmcnt(6)
  v_mfma_f32_32x32x16_bf16 v[160:175], v[132:135], v[68:71], v[160:175]
  s_waitcnt lgkmcnt(4)
  v_mfma_f32_32x32x16_bf16 v[160:175], v[136:139], v[72:75], v[160:175]
  s_waitcnt lgkmcnt(1)
  v_mfma_f32_32x32x16_bf16 v[160:175], v[140:143], v[76:79], v[160:175]
  s_setprio 2
  s_nop 10
  v_cvt_pk_bf16_f32 v88, v160, v161
  v_cvt_pk_bf16_f32 v89, v162, v163
  v_cvt_pk_bf16_f32 v90, v164, v165
  v_cvt_pk_bf16_f32 v91, v166, v167
  v_bfi_b32 v88, s53, v104, v88
  v_bfi_b32 v89, s53, v105, v89
  v_bfi_b32 v90, s53, v106, v90
  v_bfi_b32 v91, s53, v107, v91
  ds_write_b128 v246, v[88:91]
  v_cvt_pk_bf16_f32 v92, v168, v169
  v_cvt_pk_bf16_f32 v93, v170, v171
  v_cvt_pk_bf16_f32 v94, v172, v173
  v_cvt_pk_bf16_f32 v95, v174, v175
  v_bfi_b32 v92, s53, v108, v92
  v_bfi_b32 v93, s53, v109, v93
  v_bfi_b32 v94, s53, v110, v94
  v_bfi_b32 v95, s53, v111, v95
  ds_write_b128 v247, v[92:95]
  ds_read_b128 v[112:115], v32 offset:0
  ds_read_b128 v[116:119], v32 offset:2048
  ds_read_b128 v[120:123], v32 offset:4096
  ds_read_b128 v[124:127], v32 offset:6144
  s_waitcnt lgkmcnt(3)
  buffer_store_dwordx4 v[112:115], v34, s[32:35], s87 offen offset:0 sc1
  s_waitcnt lgkmcnt(2)
  buffer_store_dwordx4 v[116:119], v34, s[32:35], s87 offen offset:1024 sc1
  s_waitcnt lgkmcnt(1)
  buffer_store_dwordx4 v[120:123], v34, s[32:35], s87 offen offset:2048 sc1
  s_waitcnt lgkmcnt(0)
  buffer_store_dwordx4 v[124:127], v34, s[32:35], s87 offen offset:3072 sc1
  s_setprio 0
  s_barrier
  s_cmp_lg_u32 s3, 7
  s_cbranch_scc1 L_nolse2
  v_or_b32 v23, 1, v23
  s_mov_b32 exec_hi, 0
  buffer_store_dwordx4 v[20:23], v248, s[32:35], s74 offen sc1
  s_mov_b32 exec_hi, -1
L_nolse2:
  s_mov_b32 s73, 0
  s_or_b32 s69, s48, 1
  buffer_load_dwordx4 v[8:11], v35, s[32:35], s70 offen offset:0 sc1
  buffer_load_dwordx4 v[12:15], v35, s[32:35], s71 offen offset:0 sc1
  buffer_load_dwordx4 v[16:19], v35, s[32:35], 0 offen offset:0 sc1
  buffer_load_dwordx4 v[20:23], v35, s[32:35], s72 offen offset:0 sc1
  s_cmp_lt_u32 s2, 128
  s_cbranch_scc1 L_prepA
  s_and_b32 s92, s3, 3
  s_mul_i32 s92, s92, 7552
  s_add_u32 s92, s92, 0x5000
  v_lshrrev_b32 v62, 5, v1
  v_mul_u32_u24 v62, 928, v62
  v_and_b32 v3, 31, v1
  v_lshl_add_u32 v62, v3, 4, v62
  v_add_u32 v62, s92, v62
  s_lshl_b32 s92, s3, 6
  v_lshrrev_b32 v63, 4, v1
  v_mul_u32_u24 v63, 7552, v63
  v_bfe_u32 v3, v1, 2, 2
  v_mul_u32_u24 v3, 928, v3
  v_add_u32 v63, v3, v63
  v_and_b32 v3, 3, v1
  v_lshl_add_u32 v63, v3, 3, v63
  v_add_u32 v63, 20480, v63
  v_add_u32 v63, s92, v63
  s_mul_i32 s82, s80, 28672
  s_lshl_b32 s97, s3, 12
  s_add_u32 s82, s82, s97
  s_lshl_b32 s97, s79, 8
  s_add_u32 s82, s82, s97
  s_lshr_b32 s92, s79, 1
  s_lshl_b32 s92, s92, 10
  s_and_b32 s97, s79, 1
  s_lshl_b32 s97, s97, 7
  s_add_u32 s92, s92, s97
  s_add_u32 s92, s92, 0x4000
  v_bfe_u32 v56, v1, 3, 1
  v_lshlrev_b32 v56, 13, v56
  v_lshrrev_b32 v3, 4, v1
  v_lshl_add_u32 v56, v3, 8, v56
  v_and_b32 v3, 7, v1
  v_lshl_add_u32 v56, v3, 4, v56
  v_add_u32 v56, s92, v56
  v_and_b32 v60, 31, v1
  v_lshlrev_b32 v60, 5, v60
  v_add_u32 v60, 90112, v60
  s_lshl_b32 s92, s3, 2
  s_add_u32 s92, s92, 0x16000
  v_and_b32 v59, 7, v1
  v_lshlrev_b32 v59, 7, v59
  v_lshrrev_b32 v3, 4, v1
  v_lshl_add_u32 v59, v3, 5, v59
  v_add_u32 v59, s92, v59
  s_lshl_b32 s92, s3, 7
  s_add_u32 s92, s92, 0x16c00
  v_and_b32 v57, 31, v1
  v_lshlrev_b32 v57, 1, v57
  v_add_u32 v57, s92, v57
  s_mul_i32 s90, s79, 4224
  s_lshl_b32 s97, s3, 9
  s_add_u32 s90, s90, s97
  s_add_u32 s90, s90, 0x60000
  v_and_b32 v61, 31, v1
  v_lshlrev_b32 v61, 4, v61
  v_and_b32 v58, 3, v1
  v_lshlrev_b32 v58, 6, v58
  v_lshrrev_b32 v3, 4, v1
  v_lshl_add_u32 v58, v3, 4, v58
  s_nop 0
  s_branch L_prep2
L_prepA:
  s_sub_u32 s92, s79, 7
  s_cmp_ge_u32 s79, 7
  s_cselect_b32 s92, s92, s79
  s_cselect_b32 s93, 1, 0
  s_mul_i32 s81, s80, 7
  s_add_u32 s81, s81, s92
  s_lshl_b32 s91, s81, 15
  s_lshl_b32 s97, s3, 12
  s_add_u32 s91, s91, s97
  s_lshl_b32 s97, s93, 9
  s_add_u32 s91, s91, s97
  s_mul_i32 s75, s77, 16896
  s_lshr_b32 s97, s3, 1
  s_mul_i32 s97, s97, 4224
  s_add_u32 s75, s75, s97
  s_lshl_b32 s97, s76, 7
  s_add_u32 s75, s75, s97
  s_and_b32 s97, s3, 1
  s_lshl_b32 s97, s97, 6
  s_add_u32 s75, s75, s97
  s_add_u32 s75, s75, 0x60000
  s_mul_i32 s90, s93, 67584
  s_mul_i32 s97, s3, 8448
  s_add_u32 s90, s90, s97
  s_lshl_b32 s97, s81, 7
  s_add_u32 s90, s90, s97
  s_add_u32 s90, s90, 0xa0000
  s_mul_i32 s92, s3, 2176
  s_lshr_b32 s97, s3, 1
  s_lshl_b32 s97, s97, 7
  s_add_u32 s92, s92, s97
  s_add_u32 s92, s92, 0xe800
  v_lshrrev_b32 v62, 5, v1
  v_mul_u32_u24 v62, 544, v62
  v_and_b32 v3, 31, v1
  v_lshl_add_u32 v62, v3, 4, v62
  v_add_u32 v62, s92, v62
  s_lshl_b32 s92, s3, 6
  v_lshrrev_b32 v63, 4, v1
  v_mul_u32_u24 v63, 4480, v63
  v_bfe_u32 v3, v1, 2, 2
  v_mul_u32_u24 v3, 544, v3
  v_add_u32 v63, v3, v63
  v_and_b32 v3, 3, v1
  v_lshl_add_u32 v63, v3, 3, v63
  v_add_u32 v63, 59392, v63
  v_add_u32 v63, s92, v63
  s_lshl_b32 s82, s81, 12
  s_lshl_b32 s97, s3, 9
  s_add_u32 s82, s82, s97
  s_add_u32 s82, s82, 0xd0000
  s_lshl_b32 s92, s3, 7
  s_add_u32 s92, s92, 0x16c00
  v_and_b32 v57, 7, v1
  v_lshlrev_b32 v57, 3, v57
  v_lshrrev_b32 v3, 4, v1
  v_lshl_add_u32 v57, v3, 1, v57
  v_add_u32 v57, s92, v57
  v_and_b32 v61, 31, v1
  v_lshlrev_b32 v61, 4, v61
  v_and_b32 v58, 1, v1
  v_lshlrev_b32 v58, 6, v58
  v_lshrrev_b32 v3, 4, v1
  v_lshl_add_u32 v58, v3, 4, v58
  s_lshl_b32 s92, s80, 11
  v_and_b32 v56, 15, v1
  v_lshlrev_b32 v56, 7, v56
  v_add_u32 v56, 98304, v56
  v_add_u32 v56, s92, v56
  s_lshl_b32 s92, s3, 2
  s_add_u32 s92, s92, 0x14800
  v_lshlrev_b32 v59, 5, v1
  v_add_u32 v59, s92, v59
  s_bfe_u32 s92, s3, 0x10002
  s_lshl_b32 s92, s92, 10
  s_and_b32 s97, s3, 3
  s_lshl_b32 s97, s97, 2
  s_add_u32 s92, s92, s97
  s_add_u32 s92, s92, 0x15800
  v_lshlrev_b32 v60, 4, v1
  v_add_u32 v60, s92, v60
L_prep2:
  s_cmp_lg_u32 s101, 0
  s_cbranch_scc1 L_nsg
  s_waitcnt vmcnt(8)
  ds_write_b128 v240, v[176:179] offset:0
  ds_write_b128 v240, v[180:183] offset:1152
  ds_write_b128 v240, v[184:187] offset:2432
  ds_write_b128 v240, v[188:191] offset:3584
  s_cmp_lt_u32 s2, 128
  s_cbranch_scc1 L_sf_36a
  s_mov_b32 exec_lo, 0xfffffff
  s_mov_b32 exec_hi, 0xfffffff
  ds_write_b128 v62, v[208:211] offset:0
  ds_write_b128 v62, v[212:215] offset:448
  ds_write_b128 v62, v[216:219] offset:1856
  ds_write_b128 v62, v[220:223] offset:2304
  ds_write_b128 v62, v[224:227] offset:3712
  ds_write_b128 v62, v[228:231] offset:4160
  ds_write_b128 v62, v[232:235] offset:5568
  ds_write_b128 v62, v[236:239] offset:6016
  s_mov_b64 exec, -1
  s_branch L_sf_36x
L_sf_36a:
  ds_write_b128 v241, v[208:211] offset:0
  ds_write_b128 v241, v[212:215] offset:1152
  ds_write_b128 v241, v[216:219] offset:2432
  ds_write_b128 v241, v[220:223] offset:3584
  ds_write_b128 v241, v[224:227] offset:4864
  ds_write_b128 v241, v[228:231] offset:6016
  ds_write_b128 v241, v[232:235] offset:7296
  ds_write_b128 v241, v[236:239] offset:8448
L_sf_36x:
L_nsg:
  s_waitcnt vmcnt(0)
  s_mov_b32 s100, 0
L_p1:
  v_cmp_ne_u32 s[60:61], s69, v11
  v_cmp_ne_u32 s[62:63], s69, v15
  v_cmp_ne_u32 s[64:65], s69, v19
  v_cmp_ne_u32 s[66:67], s69, v23
  v_xor_b32 v44, s69, v11
  v_bitop3_b32 v44, v15, s69, v44 bitop3:0xbe
  v_bitop3_b32 v44, v19, s69, v44 bitop3:0xbe
  v_bitop3_b32 v44, v23, s69, v44 bitop3:0xbe
  v_cmp_lt_u32 s[92:93], 1, v44
  s_mov_b32 s94, 0
  s_cmp_eq_u64 s[92:93], 0
  s_cbranch_scc1 L_p1d
  s_add_u32 s100, s100, 1
  s_cmp_gt_u32 s100, 1000000
  s_cbranch_scc1 L_abort
  s_mov_b64 exec, s[60:61]
  s_cbranch_execz L_ll_37
  buffer_load_dwordx4 v[8:11], v35, s[32:35], s70 offen offset:0 sc1
L_ll_37:
  s_mov_b64 exec, s[62:63]
  s_cbranch_execz L_ll_38
  buffer_load_dwordx4 v[12:15], v35, s[32:35], s71 offen offset:0 sc1
L_ll_38:
  s_mov_b64 exec, s[64:65]
  s_cbranch_execz L_ll_39
  buffer_load_dwordx4 v[16:19], v35, s[32:35], 0 offen offset:0 sc1
L_ll_39:
  s_mov_b64 exec, s[66:67]
  s_cbranch_execz L_ll_40
  buffer_load_dwordx4 v[20:23], v35, s[32:35], s72 offen offset:0 sc1
L_ll_40:
  s_mov_b64 exec, -1
L_p1d:
  s_bitcmp1_b32 s73, 0
  s_cbranch_scc1 L_lp_41
  s_cmp_lg_u64 s[60:61], 0
  s_cbranch_scc1 L_lp_41
  s_bitset1_b32 s73, 0
  s_add_u32 s94, s94, 1
  buffer_load_dwordx4 v[128:131], v36, s[32:35], s83 offen offset:0 sc1
L_lp_41:
  s_bitcmp1_b32 s73, 1
  s_cbranch_scc1 L_lp_42
  s_cmp_lg_u64 s[62:63], 0
  s_cbranch_scc1 L_lp_42
  s_bitset1_b32 s73, 1
  s_add_u32 s94, s94, 1
  buffer_load_dwordx4 v[132:135], v36, s[32:35], s84 offen offset:0 sc1
L_lp_42:
  s_bitcmp1_b32 s73, 2
  s_cbranch_scc1 L_lp_43
  s_cmp_lg_u64 s[64:65], 0
  s_cbranch_scc1 L_lp_43
  s_bitset1_b32 s73, 2
  s_add_u32 s94, s94, 1
  buffer_load_dwordx4 v[136:139], v36, s[32:35], s85 offen offset:0 sc1
L_lp_43:
  s_bitcmp1_b32 s73, 3
  s_cbranch_scc1 L_lp_44
  s_cmp_lg_u64 s[66:67], 0
  s_cbranch_scc1 L_lp_44
  s_bitset1_b32 s73, 3
  s_add_u32 s94, s94, 1
  buffer_load_dwordx4 v[140:143], v36, s[32:35], s86 offen offset:0 sc1
L_lp_44:
  s_cmp_eq_u64 s[92:93], 0
  s_cbranch_scc1 L_p1x
  s_cmp_eq_u32 s94, 0
  s_cbranch_scc0 L_pw0
  s_waitcnt vmcnt(0)
  s_branch L_p1
L_pw0:
  s_cmp_eq_u32 s94, 1
  s_cbranch_scc0 L_pw1
  s_waitcnt vmcnt(1)
  s_branch L_p1
L_pw1:
  s_cmp_eq_u32 s94, 2
  s_cbranch_scc0 L_pw2
  s_waitcnt vmcnt(2)
  s_branch L_p1
L_pw2:
  s_cmp_eq_u32 s94, 3
  s_cbranch_scc0 L_pw3
  s_waitcnt vmcnt(3)
  s_branch L_p1
L_pw3:
  s_waitcnt vmcnt(4)
  s_branch L_p1
L_p1x:
  v_max3_f32 v44, v8, v12, v16
  v_max_f32 v44, v44, v20
  s_nop 1
  v_max_f32_dpp v44, v44, v44 row_ror:8 row_mask:0xf bank_mask:0xf
  v_mov_b32 v45, v44
  s_nop 1
  v_permlane16_swap_b32 v44, v45
  v_max_f32 v44, v44, v45
  v_mov_b32 v45, v44
  s_nop 1
  v_permlane32_swap_b32 v44, v45
  v_max_f32 v44, v44, v45
  s_lshl_b32 s92, s3, 2
  s_add_u32 s92, s92, 92160
  v_mov_b32 v47, s92
  v_mov_b32 v46, 92160
  ds_write_b32 v47, v44
  s_waitcnt lgkmcnt(0)
  s_barrier
  ds_read_b128 v[144:147], v46
  ds_read_b128 v[148:151], v46 offset:16
  ds_read_b64_tr_b16 v[48:49], v242 offset:0
  ds_read_b64_tr_b16 v[50:51], v242 offset:1152
  ds_read_b64_tr_b16 v[52:53], v242 offset:9728
  ds_read_b64_tr_b16 v[54:55], v242 offset:10880
  s_waitcnt lgkmcnt(4)
  v_max3_f32 v44, v144, v145, v146
  v_max3_f32 v45, v147, v148, v149
  v_max3_f32 v44, v44, v150, v151
  v_max_f32 v44, v44, v45
  v_sub_f32 v152, v8, v44
  v_sub_f32 v153, v12, v44
  v_sub_f32 v154, v16, v44
  v_sub_f32 v155, v20, v44
  v_exp_f32 v152, v152
  v_exp_f32 v153, v153
  v_exp_f32 v154, v154
  v_exp_f32 v155, v155
  v_cvt_pk_bf16_f32 v152, v152, v152
  v_cvt_pk_bf16_f32 v153, v153, v153
  v_cvt_pk_bf16_f32 v154, v154, v154
  v_cvt_pk_bf16_f32 v155, v155, v155
  v_lshrrev_b32 v156, 16, v152
  v_lshrrev_b32 v157, 16, v153
  v_lshrrev_b32 v158, 16, v154
  v_lshrrev_b32 v159, 16, v155
  v_and_b32 v152, 0xffff0000, v152
  v_and_b32 v153, 0xffff0000, v153
  v_and_b32 v154, 0xffff0000, v154
  v_and_b32 v155, 0xffff0000, v155
  v_mul_f32 v44, v152, v9
  v_fmac_f32 v44, v153, v13
  v_fmac_f32 v44, v154, v17
  v_fmac_f32 v44, v155, v21
  s_nop 1
  v_add_f32_dpp v44, v44, v44 row_ror:8 row_mask:0xf bank_mask:0xf
  v_mov_b32 v45, v44
  s_nop 1
  v_permlane16_swap_b32 v44, v45
  v_add_f32 v44, v44, v45
  v_mov_b32 v45, v44
  s_nop 1
  v_permlane32_swap_b32 v44, v45
  v_add_f32 v44, v44, v45
  ds_write_b32 v47, v44 offset:32
  s_cmp_lt_u32 s2, 128
  s_cbranch_scc1 L_fgA
  ds_read_b64_tr_b16 v[80:81], v63 offset:0
  ds_read_b64_tr_b16 v[82:83], v63 offset:3712
  ds_read_b64_tr_b16 v[84:85], v63 offset:32
  ds_read_b64_tr_b16 v[86:87], v63 offset:3744
  ds_read_b64_tr_b16 v[88:89], v63 offset:448
  ds_read_b64_tr_b16 v[90:91], v63 offset:4160
  ds_read_b64_tr_b16 v[92:93], v63 offset:480
  ds_read_b64_tr_b16 v[94:95], v63 offset:4192
  s_branch L_fgx
L_fgA:
  ds_read_b64_tr_b16 v[80:81], v243 offset:0
  ds_read_b64_tr_b16 v[82:83], v243 offset:1152
  ds_read_b64_tr_b16 v[84:85], v243 offset:9728
  ds_read_b64_tr_b16 v[86:87], v243 offset:10880
  ds_read_b64_tr_b16 v[88:89], v243 offset:19456
  ds_read_b64_tr_b16 v[90:91], v243 offset:20608
  ds_read_b64_tr_b16 v[92:93], v243 offset:29184
  ds_read_b64_tr_b16 v[94:95], v243 offset:30336
L_fgx:
  s_waitcnt lgkmcnt(0)
  s_barrier
  ds_read_b128 v[160:163], v46 offset:32
  ds_read_b128 v[164:167], v46 offset:48
  v_mov_b32 v144, 0
  v_mov_b32 v145, 0
  v_mov_b32 v146, 0
  v_mov_b32 v147, 0
  v_mov_b32 v148, 0
  v_mov_b32 v149, 0
  v_mov_b32 v150, 0
  v_mov_b32 v151, 0
  s_waitcnt lgkmcnt(0)
  v_add_f32 v160, v160, v161
  v_add_f32 v162, v162, v163
  v_add_f32 v164, v164, v165
  v_add_f32 v166, v166, v167
  v_add_f32 v160, v160, v162
  v_add_f32 v164, v164, v166
  v_add_f32 v160, v160, v164
  v_rcp_f32 v168, v160
  s_bitcmp1_b32 s73, 0
  s_cbranch_scc1 L_ir_45
  buffer_load_dwordx4 v[128:131], v36, s[32:35], s83 offen offset:0 sc1
L_ir_45:
  s_bitcmp1_b32 s73, 1
  s_cbranch_scc1 L_ir_46
  buffer_load_dwordx4 v[132:135], v36, s[32:35], s84 offen offset:0 sc1
L_ir_46:
  s_bitcmp1_b32 s73, 2
  s_cbranch_scc1 L_ir_47
  buffer_load_dwordx4 v[136:139], v36, s[32:35], s85 offen offset:0 sc1
L_ir_47:
  s_bitcmp1_b32 s73, 3
  s_cbranch_scc1 L_ir_48
  buffer_load_dwordx4 v[140:143], v36, s[32:35], s86 offen offset:0 sc1
L_ir_48:
  s_or_b32 s73, s73, 15
  s_mov_b32 s100, 0
L_p2:
  s_mov_b32 s95, s73
  s_waitcnt vmcnt(0)
  s_bitcmp1_b32 s95, 0
  s_cbranch_scc0 L_dc_49
  s_bitcmp1_b32 s95, 4
  s_cbranch_scc1 L_dc_49
  v_xor_b32 v44, v128, v4
  v_bitop3_b32 v44, v129, v5, v44 bitop3:0xbe
  v_bitop3_b32 v44, v130, v6, v44 bitop3:0xbe
  v_bitop3_b32 v44, v131, v7, v44 bitop3:0xbe
  v_and_b32 v44, s53, v44
  v_cmp_ne_u32 vcc, 0, v44
  s_nop 0
  s_cbranch_vccz L_dc_49k
  s_sleep 1
  buffer_load_dwordx4 v[128:131], v36, s[32:35], s83 offen offset:0 sc1
  s_branch L_dc_49
L_dc_49k:
  s_bitset1_b32 s73, 4
  v_dot2c_f32_bf16 v144, v156, v128
  v_dot2c_f32_bf16 v145, v152, v128
  v_dot2c_f32_bf16 v146, v156, v129
  v_dot2c_f32_bf16 v147, v152, v129
  v_dot2c_f32_bf16 v148, v156, v130
  v_dot2c_f32_bf16 v149, v152, v130
  v_dot2c_f32_bf16 v150, v156, v131
  v_dot2c_f32_bf16 v151, v152, v131
L_dc_49:
  s_bitcmp1_b32 s95, 1
  s_nop 0
  s_cbranch_scc0 L_dc_50
  s_bitcmp1_b32 s95, 5
  s_cbranch_scc1 L_dc_50
  v_xor_b32 v44, v132, v4
  v_bitop3_b32 v44, v133, v5, v44 bitop3:0xbe
  v_bitop3_b32 v44, v134, v6, v44 bitop3:0xbe
  v_bitop3_b32 v44, v135, v7, v44 bitop3:0xbe
  v_and_b32 v44, s53, v44
  v_cmp_ne_u32 vcc, 0, v44
  s_nop 0
  s_cbranch_vccz L_dc_50k
  s_sleep 1
  buffer_load_dwordx4 v[132:135], v36, s[32:35], s84 offen offset:0 sc1
  s_branch L_dc_50
L_dc_50k:
  s_bitset1_b32 s73, 5
  v_dot2c_f32_bf16 v144, v157, v132
  v_dot2c_f32_bf16 v145, v153, v132
  v_dot2c_f32_bf16 v146, v157, v133
  v_dot2c_f32_bf16 v147, v153, v133
  v_dot2c_f32_bf16 v148, v157, v134
  v_dot2c_f32_bf16 v149, v153, v134
  v_dot2c_f32_bf16 v150, v157, v135
  v_dot2c_f32_bf16 v151, v153, v135
L_dc_50:
  s_bitcmp1_b32 s95, 2
  s_nop 0
  s_cbranch_scc0 L_dc_51
  s_bitcmp1_b32 s95, 6
  s_cbranch_scc1 L_dc_51
  v_xor_b32 v44, v136, v4
  v_bitop3_b32 v44, v137, v5, v44 bitop3:0xbe
  v_bitop3_b32 v44, v138, v6, v44 bitop3:0xbe
  v_bitop3_b32 v44, v139, v7, v44 bitop3:0xbe
  v_and_b32 v44, s53, v44
  v_cmp_ne_u32 vcc, 0, v44
  s_nop 0
  s_cbranch_vccz L_dc_51k
  s_sleep 1
  buffer_load_dwordx4 v[136:139], v36, s[32:35], s85 offen offset:0 sc1
  s_branch L_dc_51
L_dc_51k:
  s_bitset1_b32 s73, 6
  v_dot2c_f32_bf16 v144, v158, v136
  v_dot2c_f32_bf16 v145, v154, v136
  v_dot2c_f32_bf16 v146, v158, v137
  v_dot2c_f32_bf16 v147, v154, v137
  v_dot2c_f32_bf16 v148, v158, v138
  v_dot2c_f32_bf16 v149, v154, v138
  v_dot2c_f32_bf16 v150, v158, v139
  v_dot2c_f32_bf16 v151, v154, v139
L_dc_51:
  s_bitcmp1_b32 s95, 3
  s_nop 0
  s_cbranch_scc0 L_dc_52
  s_bitcmp1_b32 s95, 7
  s_cbranch_scc1 L_dc_52
  v_xor_b32 v44, v140, v4
  v_bitop3_b32 v44, v141, v5, v44 bitop3:0xbe
  v_bitop3_b32 v44, v142, v6, v44 bitop3:0xbe
  v_bitop3_b32 v44, v143, v7, v44 bitop3:0xbe
  v_and_b32 v44, s53, v44
  v_cmp_ne_u32 vcc, 0, v44
  s_nop 0
  s_cbranch_vccz L_dc_52k
  s_sleep 1
  buffer_load_dwordx4 v[140:143], v36, s[32:35], s86 offen offset:0 sc1
  s_branch L_dc_52
L_dc_52k:
  s_bitset1_b32 s73, 7
  v_dot2c_f32_bf16 v144, v159, v140
  v_dot2c_f32_bf16 v145, v155, v140
  v_dot2c_f32_bf16 v146, v159, v141
  v_dot2c_f32_bf16 v147, v155, v141
  v_dot2c_f32_bf16 v148, v159, v142
  v_dot2c_f32_bf16 v149, v155, v142
  v_dot2c_f32_bf16 v150, v159, v143
  v_dot2c_f32_bf16 v151, v155, v143
L_dc_52:
  s_cmp_eq_u32 s73, 0xff
  s_nop 0
  s_cbranch_scc1 L_p2x
  s_add_u32 s100, s100, 1
  s_cmp_gt_u32 s100, 1000000
  s_cbranch_scc1 L_abort
  s_branch L_p2
L_p2x:
  v_permlane32_swap_b32 v144, v148
  v_permlane32_swap_b32 v145, v149
  v_permlane32_swap_b32 v146, v150
  v_permlane32_swap_b32 v147, v151
  v_add_f32 v144, v144, v148
  v_add_f32 v145, v145, v149
  v_add_f32 v146, v146, v150
  v_add_f32 v147, v147, v151
  s_nop 0
  v_permlane16_swap_b32 v144, v146
  v_permlane16_swap_b32 v145, v147
  v_add_f32 v144, v144, v146
  v_add_f32 v145, v145, v147
  s_nop 0
  v_add_f32_dpp v144, v144, v144 row_ror:8 row_mask:0xf bank_mask:0xf
  v_add_f32_dpp v145, v145, v145 row_ror:8 row_mask:0xf bank_mask:0xf
  v_mul_f32 v144, v144, v168
  v_mul_f32 v145, v145, v168
  v_cvt_pk_bf16_f32 v44, v144, v145
  ds_write_b32 v37, v44
  s_waitcnt lgkmcnt(0)
  s_barrier
  ds_read_b128 v[160:163], v38
  ds_read_b128 v[164:167], v38 offset:64
  s_waitcnt lgkmcnt(1)
  v_mfma_f32_16x16x32_bf16 v[144:147], v[48:51], v[160:163], 0
  s_waitcnt lgkmcnt(0)
  v_mfma_f32_16x16x32_bf16 v[144:147], v[52:55], v[164:167], v[144:147]
  s_nop 7
  v_add_f32_dpp v144, v144, v144 quad_perm:[1,0,3,2] row_mask:0xf bank_mask:0xf
  v_add_f32_dpp v145, v145, v145 quad_perm:[1,0,3,2] row_mask:0xf bank_mask:0xf
  v_add_f32_dpp v146, v146, v146 quad_perm:[1,0,3,2] row_mask:0xf bank_mask:0xf
  v_add_f32_dpp v147, v147, v147 quad_perm:[1,0,3,2] row_mask:0xf bank_mask:0xf
  v_add_f32_dpp v144, v144, v144 quad_perm:[2,3,0,1] row_mask:0xf bank_mask:0xf
  v_add_f32_dpp v145, v145, v145 quad_perm:[2,3,0,1] row_mask:0xf bank_mask:0xf
  v_add_f32_dpp v146, v146, v146 quad_perm:[2,3,0,1] row_mask:0xf bank_mask:0xf
  v_add_f32_dpp v147, v147, v147 quad_perm:[2,3,0,1] row_mask:0xf bank_mask:0xf
  v_add_f32_dpp v144, v144, v144 row_half_mirror row_mask:0xf bank_mask:0xf
  v_add_f32_dpp v145, v145, v145 row_half_mirror row_mask:0xf bank_mask:0xf
  v_add_f32_dpp v146, v146, v146 row_half_mirror row_mask:0xf bank_mask:0xf
  v_add_f32_dpp v147, v147, v147 row_half_mirror row_mask:0xf bank_mask:0xf
  s_mov_b32 exec_lo, 0x10001
  s_mov_b32 exec_hi, 0x10001
  v_and_or_b32 v144, v144, v2, s49
  v_and_or_b32 v145, v145, v2, s50
  v_and_or_b32 v146, v146, v2, s51
  v_and_or_b32 v147, v147, v2, s52
  buffer_store_dwordx4 v[144:147], v1, s[32:35], s16 offen
  v_mov_b32 v8, v144
  v_mov_b32 v9, v145
  v_mov_b32 v10, v146
  v_mov_b32 v11, v147
  s_mov_b64 exec, -1
  s_mov_b32 s69, 0
  s_mov_b32 s66, 0
  s_cmp_lt_u32 s2, 128
  s_cbranch_scc0 L_X
  s_mov_b32 s60, 0xffffffff
  s_mov_b32 s61, 0x0
  s_mov_b32 s100, 0
  s_branch L_gf_54
L_g_53:
  s_add_u32 s100, s100, 1
  s_cmp_gt_u32 s100, 1000000
  s_cbranch_scc1 L_abort
  s_sleep 1
  s_cmp_lg_u32 s100, 30
  s_cbranch_scc1 L_alt_56
  s_cmp_lg_u32 s69, 0
  s_cbranch_scc1 L_cg_57
  s_mov_b32 exec_lo, 0x10001
  s_mov_b32 exec_hi, 0x10001
  s_add_u32 s97, s16, 0x160000
  buffer_store_dwordx4 v[8:11], v1, s[32:35], s97 offen sc1
  s_mov_b32 s69, 1
  s_mov_b64 exec, -1
L_cg_57:
  s_add_u32 s66, s66, 0x160000
L_alt_56:
L_gf_54:
  s_mov_b64 exec, s[60:61]
  buffer_load_dwordx4 v[128:131], v39, s[32:35], s66 offen offset:0 sc1
  s_waitcnt vmcnt(0)
L_gc_55:
  s_mov_b64 exec, s[60:61]
  v_perm_b32 v44, v129, v128, s56
  v_perm_b32 v44, v130, v44, s57
  v_perm_b32 v44, v131, v44, s58
  v_cmp_ne_u32 s[60:61], s48, v44
  s_nop 0
  s_cmp_lg_u64 s[60:61], 0
  s_cbranch_scc1 L_g_53
  s_mov_b64 exec, -1
  v_cvt_pk_bf16_f32 v44, v128, v129
  v_cvt_pk_bf16_f32 v45, v130, v131
  s_mov_b32 exec_hi, 0
  ds_write_b64 v43, v[44:45]
  s_mov_b32 exec_hi, -1
  s_waitcnt lgkmcnt(0)
  s_barrier
  ds_read_b128 v[128:131], v40 offset:0
  ds_read_b128 v[132:135], v40 offset:64
  ds_read_b128 v[136:139], v40 offset:128
  ds_read_b128 v[140:143], v40 offset:192
  s_waitcnt lgkmcnt(3)
  v_mfma_f32_16x16x32_bf16 v[144:147], v[80:83], v[128:131], 0
  s_waitcnt lgkmcnt(2)
  v_mfma_f32_16x16x32_bf16 v[144:147], v[84:87], v[132:135], v[144:147]
  s_waitcnt lgkmcnt(1)
  v_mfma_f32_16x16x32_bf16 v[144:147], v[88:91], v[136:139], v[144:147]
  s_waitcnt lgkmcnt(0)
  v_mfma_f32_16x16x32_bf16 v[144:147], v[92:95], v[140:143], v[144:147]
  s_nop 7
  v_add_f32_dpp v144, v144, v144 quad_perm:[1,0,3,2] row_mask:0xf bank_mask:0xf
  v_add_f32_dpp v145, v145, v145 quad_perm:[1,0,3,2] row_mask:0xf bank_mask:0xf
  v_add_f32_dpp v146, v146, v146 quad_perm:[1,0,3,2] row_mask:0xf bank_mask:0xf
  v_add_f32_dpp v147, v147, v147 quad_perm:[1,0,3,2] row_mask:0xf bank_mask:0xf
  v_add_f32_dpp v144, v144, v144 quad_perm:[2,3,0,1] row_mask:0xf bank_mask:0xf
  v_add_f32_dpp v145, v145, v145 quad_perm:[2,3,0,1] row_mask:0xf bank_mask:0xf
  v_add_f32_dpp v146, v146, v146 quad_perm:[2,3,0,1] row_mask:0xf bank_mask:0xf
  v_add_f32_dpp v147, v147, v147 quad_perm:[2,3,0,1] row_mask:0xf bank_mask:0xf
  v_add_f32_dpp v144, v144, v144 row_half_mirror row_mask:0xf bank_mask:0xf
  v_add_f32_dpp v145, v145, v145 row_half_mirror row_mask:0xf bank_mask:0xf
  v_add_f32_dpp v146, v146, v146 row_half_mirror row_mask:0xf bank_mask:0xf
  v_add_f32_dpp v147, v147, v147 row_half_mirror row_mask:0xf bank_mask:0xf
  s_mov_b32 exec_lo, 0x10001
  s_mov_b32 exec_hi, 0x10001
  v_and_or_b32 v144, v144, v2, s49
  v_and_or_b32 v145, v145, v2, s50
  v_and_or_b32 v146, v146, v2, s51
  v_and_or_b32 v147, v147, v2, s52
  buffer_store_dwordx4 v[144:147], v1, s[32:35], s75 offen sc1
  s_mov_b64 exec, -1
  s_branch L_Y
L_X:
  s_lshl_b32 s92, s79, 6
  v_and_b32 v44, 31, v1
  v_lshlrev_b32 v44, 1, v44
  v_add_u32 v44, s92, v44
  global_load_ushort v66, v44, s[4:5]
  s_movk_i32 s68, 0x4000
  buffer_load_dwordx4 v[68:71], v56, s[32:35], 0 offen offset:0 sc1
  buffer_load_dwordx4 v[72:75], v56, s[32:35], s68 offen offset:0 sc1
  s_waitcnt vmcnt(0)
  s_mov_b64 s[60:61], -1
  s_waitcnt vmcnt(63)
  s_mov_b32 s100, 0
  s_branch L_gc_62
L_g_60:
  s_add_u32 s100, s100, 1
  s_cmp_gt_u32 s100, 1000000
  s_cbranch_scc1 L_abort
  s_sleep 2
  s_cmp_lg_u32 s100, 30
  s_cbranch_scc1 L_alt_63
  s_cmp_lg_u32 s69, 0
  s_cbranch_scc1 L_cg_64
  s_mov_b32 exec_lo, 0x10001
  s_mov_b32 exec_hi, 0x10001
  s_add_u32 s97, s16, 0x160000
  buffer_store_dwordx4 v[8:11], v1, s[32:35], s97 offen sc1
  s_mov_b32 s69, 1
  s_mov_b64 exec, -1
L_cg_64:
L_alt_63:
L_gf_61:
  s_mov_b64 exec, s[60:61]
  buffer_load_dwordx4 v[68:71], v56, s[32:35], 0 offen offset:0 sc1
  buffer_load_dwordx4 v[72:75], v56, s[32:35], s68 offen offset:0 sc1
  s_waitcnt vmcnt(0)
L_gc_62:
  s_mov_b64 exec, s[60:61]
  v_perm_b32 v44, v69, v68, s56
  v_perm_b32 v44, v70, v44, s57
  v_perm_b32 v44, v71, v44, s58
  v_cmp_ne_u32 s[60:61], s48, v44
  v_perm_b32 v44, v73, v72, s56
  v_perm_b32 v44, v74, v44, s57
  v_perm_b32 v44, v75, v44, s58
  v_cmp_ne_u32 vcc, s48, v44
  s_nop 0
  s_or_b64 s[60:61], s[60:61], vcc
  s_cmp_lg_u64 s[60:61], 0
  s_cbranch_scc1 L_g_60
  s_mov_b64 exec, -1
  v_permlane32_swap_b32 v68, v70
  v_permlane32_swap_b32 v69, v71
  v_add_f32 v68, v68, v70
  v_add_f32 v69, v69, v71
  s_nop 1
  v_permlane16_swap_b32 v68, v69
  v_add_f32 v68, v68, v69
  v_permlane32_swap_b32 v72, v74
  v_permlane32_swap_b32 v73, v75
  v_add_f32 v72, v72, v74
  v_add_f32 v73, v73, v75
  s_nop 1
  v_permlane16_swap_b32 v72, v73
  v_add_f32 v72, v72, v73
  v_cvt_pk_bf16_f32 v44, v68, v68
  v_and_b32 v68, 0xffff0000, v44
  v_cvt_pk_bf16_f32 v45, v72, v72
  v_and_b32 v72, 0xffff0000, v45
  v_and_b32 v44, 3, v1
  v_lshlrev_b32 v44, 6, v44
  v_bfe_u32 v3, v1, 2, 3
  v_lshl_add_u32 v44, v3, 2, v44
  ds_bpermute_b32 v76, v44, v68 offset:0
  ds_bpermute_b32 v77, v44, v68 offset:32
  ds_bpermute_b32 v78, v44, v72 offset:0
  ds_bpermute_b32 v79, v44, v72 offset:32
  s_lshr_b32 s92, s82, 12
  s_lshl_b32 s92, s92, 12
  s_add_u32 s94, s82, s92
  s_add_u32 s94, s94, 1114112
  s_add_u32 s82, s82, 851968
  v_bfe_u32 v45, v1, 2, 1
  v_lshlrev_b32 v45, 6, v45
  v_add_u32 v45, v45, v41
  v_bfe_u32 v69, v1, 2, 1
  v_lshlrev_b32 v69, 12, v69
  v_and_b32 v3, 3, v1
  v_lshl_add_u32 v69, v3, 6, v69
  v_lshrrev_b32 v3, 4, v1
  v_lshl_add_u32 v69, v3, 4, v69
  s_waitcnt lgkmcnt(0)
  v_add_f32 v78, 1.0, v78
  v_lshlrev_b32 v66, 16, v66
  v_cvt_pk_bf16_f32 v44, v78, v78
  v_and_b32 v78, 0xffff0000, v44
  s_cmp_eq_u32 s3, 7
  s_cbranch_scc1 L_ab_59
  ds_write_b16_d16_hi v57, v78
  ds_write_b16_d16_hi v57, v77 offset:64
  ds_read_b128 v[72:75], v45
  s_waitcnt lgkmcnt(0)
  v_mfma_f32_16x16x32_bf16 v[208:211], v[80:83], v[72:75], 0
  v_mfma_f32_16x16x32_bf16 v[212:215], v[84:87], v[72:75], 0
  v_mfma_f32_16x16x32_bf16 v[216:219], v[88:91], v[72:75], 0
  v_mfma_f32_16x16x32_bf16 v[220:223], v[92:95], v[72:75], 0
  s_mov_b32 exec_lo, 0x220022
  s_mov_b32 exec_hi, 0x220022
  s_nop 3
  v_mov_b32 v208, v212
  v_mov_b32 v209, v213
  v_mov_b32 v210, v214
  v_mov_b32 v211, v215
  s_mov_b32 exec_lo, 0x440044
  s_mov_b32 exec_hi, 0x440044
  v_mov_b32 v208, v216
  v_mov_b32 v209, v217
  v_mov_b32 v210, v218
  v_mov_b32 v211, v219
  s_mov_b32 exec_lo, 0x880088
  s_mov_b32 exec_hi, 0x880088
  v_mov_b32 v208, v220
  v_mov_b32 v209, v221
  v_mov_b32 v210, v222
  v_mov_b32 v211, v223
  s_mov_b32 exec_lo, 0xff00ff
  s_mov_b32 exec_hi, 0xff00ff
  v_and_or_b32 v208, v208, v2, s49
  v_and_or_b32 v209, v209, v2, s50
  v_and_or_b32 v210, v210, v2, s51
  v_and_or_b32 v211, v211, v2, s52
  buffer_store_dwordx4 v[208:211], v69, s[32:35], s94 offen sc1
  s_mov_b64 exec, -1
L_ab_59:
  v_mov_b32 v112, 0
  v_mov_b32 v113, 0
  v_mov_b32 v114, 0
  v_mov_b32 v115, 0
  s_mov_b32 s60, 0xffffffff
  s_mov_b32 s61, 0x0
  s_mov_b32 s100, 0
  s_branch L_gf_67
L_g_66:
  s_add_u32 s100, s100, 1
  s_cmp_gt_u32 s100, 1000000
  s_cbranch_scc1 L_abort
  s_sleep 4
  s_cmp_lg_u32 s100, 30
  s_cbranch_scc1 L_alt_69
  s_cmp_lg_u32 s69, 0
  s_cbranch_scc1 L_cg_70
  s_mov_b32 exec_lo, 0x10001
  s_mov_b32 exec_hi, 0x10001
  s_add_u32 s97, s16, 0x160000
  buffer_store_dwordx4 v[8:11], v1, s[32:35], s97 offen sc1
  s_mov_b32 s69, 1
  s_mov_b64 exec, -1
L_cg_70:
L_alt_69:
L_gf_67:
  s_mov_b64 exec, s[60:61]
  buffer_load_dwordx4 v[112:115], v61, s[32:35], s90 offen offset:0 sc1
  s_waitcnt vmcnt(0)
L_gc_68:
  s_mov_b64 exec, s[60:61]
  v_perm_b32 v44, v113, v112, s56
  v_perm_b32 v44, v114, v44, s57
  v_perm_b32 v44, v115, v44, s58
  v_cmp_ne_u32 s[60:61], s48, v44
  s_nop 0
  s_cmp_lg_u64 s[60:61], 0
  s_cbranch_scc1 L_g_66
  s_mov_b64 exec, -1
  v_permlane32_swap_b32 v112, v114
  v_permlane32_swap_b32 v113, v115
  v_add_f32 v112, v112, v114
  v_add_f32 v113, v113, v115
  s_nop 1
  v_permlane16_swap_b32 v112, v113
  v_add_f32 v112, v112, v113
  s_nop 1
  v_add_f32_dpp v112, v112, v112 row_ror:8 row_mask:0xf bank_mask:0xf
  ds_write_b32 v59, v112
  s_waitcnt lgkmcnt(0)
  s_barrier
  ds_read_b128 v[112:115], v60
  ds_read_b128 v[116:119], v60 offset:16
  s_waitcnt lgkmcnt(0)
  v_add_f32 v112, v112, v113
  v_add_f32 v114, v114, v115
  v_add_f32 v116, v116, v117
  v_add_f32 v118, v118, v119
  v_add_f32 v112, v112, v114
  v_add_f32 v116, v116, v118
  v_add_f32 v112, v112, v116
  v_cvt_pk_bf16_f32 v44, v112, v112
  v_and_b32 v112, 0xffff0000, v44
  v_mul_f32 v67, v76, v112
  v_cvt_pk_bf16_f32 v44, v67, v67
  v_and_b32 v67, 0xffff0000, v44
  v_add_f32 v67, v66, v67
  v_cvt_pk_bf16_f32 v44, v67, v67
  v_and_b32 v67, 0xffff0000, v44
  s_cmp_eq_u32 s3, 7
  s_cbranch_scc1 L_stat
  v_mul_f32 v44, v67, v78
  v_cvt_pk_bf16_f32 v44, v44, v44
  ds_write_b16 v57, v44
  ds_read_b128 v[160:163], v41
  s_mov_b32 s70, 0x20002
  s_mov_b32 s71, 0x20002
  s_mov_b32 s72, 0x40004
  s_mov_b32 s73, 0x40004
  s_mov_b32 s74, 0x80008
  s_mov_b32 s75, 0x80008
  s_waitcnt lgkmcnt(0)
  v_mfma_f32_16x16x32_bf16 v[128:131], v[80:83], v[160:163], 0
  v_mfma_f32_16x16x32_bf16 v[132:135], v[84:87], v[160:163], 0
  v_mfma_f32_16x16x32_bf16 v[136:139], v[88:91], v[160:163], 0
  v_mfma_f32_16x16x32_bf16 v[140:143], v[92:95], v[160:163], 0
  s_nop 5
  v_cndmask_b32 v128, v128, v132, s[70:71]
  v_cndmask_b32 v129, v129, v133, s[70:71]
  v_cndmask_b32 v130, v130, v134, s[70:71]
  v_cndmask_b32 v131, v131, v135, s[70:71]
  v_cndmask_b32 v128, v128, v136, s[72:73]
  v_cndmask_b32 v129, v129, v137, s[72:73]
  v_cndmask_b32 v130, v130, v138, s[72:73]
  v_cndmask_b32 v131, v131, v139, s[72:73]
  v_cndmask_b32 v128, v128, v140, s[74:75]
  v_cndmask_b32 v129, v129, v141, s[74:75]
  v_cndmask_b32 v130, v130, v142, s[74:75]
  v_cndmask_b32 v131, v131, v143, s[74:75]
  v_and_or_b32 v128, v128, v2, s49
  v_and_or_b32 v129, v129, v2, s50
  v_and_or_b32 v130, v130, v2, s51
  v_and_or_b32 v131, v131, v2, s52
  s_mov_b32 exec_lo, 0xf000f
  s_mov_b32 exec_hi, 0xf000f
  buffer_store_dwordx4 v[128:131], v58, s[32:35], s82 offen
  s_add_u32 s97, s82, 0xf0000
  buffer_store_dwordx4 v[128:131], v58, s[32:35], s97 offen sc1
  s_mov_b64 exec, -1
  s_branch L_xdone
L_stat:
  v_mov_b32 v130, v67
  v_mul_f32 v131, v67, v67
  s_nop 0
  v_add_f32_dpp v130, v130, v130 row_ror:8 row_mask:0xf bank_mask:0xf
  v_add_f32_dpp v131, v131, v131 row_ror:8 row_mask:0xf bank_mask:0xf
  s_nop 0
  v_add_f32_dpp v130, v130, v130 row_ror:4 row_mask:0xf bank_mask:0xf
  v_add_f32_dpp v131, v131, v131 row_ror:4 row_mask:0xf bank_mask:0xf
  s_nop 0
  v_add_f32_dpp v130, v130, v130 row_ror:2 row_mask:0xf bank_mask:0xf
  v_add_f32_dpp v131, v131, v131 row_ror:2 row_mask:0xf bank_mask:0xf
  s_nop 0
  v_add_f32_dpp v130, v130, v130 row_ror:1 row_mask:0xf bank_mask:0xf
  v_add_f32_dpp v131, v131, v131 row_ror:1 row_mask:0xf bank_mask:0xf
  v_mov_b32 v128, v130
  v_mov_b32 v129, v131
  s_nop 0
  v_permlane16_swap_b32 v130, v128
  v_permlane16_swap_b32 v131, v129
  v_add_f32 v130, v130, v128
  v_add_f32 v131, v131, v129
  v_and_b32 v128, v2, v130
  v_and_b32 v129, v2, v131
  v_sub_f32 v130, v130, v128
  v_sub_f32 v131, v131, v129
  v_and_or_b32 v128, v128, v2, s49
  v_and_or_b32 v129, v129, v2, s50
  v_and_or_b32 v130, v130, v2, s51
  v_and_or_b32 v131, v131, v2, s52
  s_lshl_b32 s92, s80, 11
  s_lshl_b32 s97, s79, 7
  s_add_u32 s92, s92, s97
  s_add_u32 s92, s92, 0x18000
  s_mov_b64 exec, 1
  buffer_store_dwordx4 v[128:131], v1, s[32:35], s92 offen
  s_add_u32 s97, s92, 0x1e0000
  buffer_store_dwordx4 v[128:131], v1, s[32:35], s97 offen sc1
  s_mov_b64 exec, -1
  v_mov_b32 v112, 0
L_xdone:
  s_cmp_lg_u32 s69, 0
  s_cbranch_scc1 L_cg_72
  s_mov_b32 exec_lo, 0x10001
  s_mov_b32 exec_hi, 0x10001
  s_add_u32 s97, s16, 0x160000
  buffer_store_dwordx4 v[8:11], v1, s[32:35], s97 offen sc1
  s_mov_b32 s69, 1
  s_mov_b64 exec, -1
L_cg_72:
  s_and_b32 s92, s79, 7
  s_cmp_lg_u32 s80, s92
  s_cbranch_scc1 L_fin
  s_mul_i32 s90, s79, 8448
  s_lshl_b32 s97, s3, 10
  s_add_u32 s90, s90, s97
  s_add_u32 s90, s90, 0xa0000
  s_lshl_b32 s92, s79, 6
  v_and_b32 v46, 31, v1
  v_lshlrev_b32 v46, 1, v46
  v_add_u32 v46, s92, v46
  s_cmp_eq_u32 s3, 7
  s_cbranch_scc1 L_nof
  s_mov_b64 s[60:61], -1
  s_mov_b32 s100, 0
  s_branch L_gf_74
L_g_73:
  s_add_u32 s100, s100, 1
  s_cmp_gt_u32 s100, 1000000
  s_cbranch_scc1 L_abort
  s_sleep 1
L_gf_74:
  s_mov_b64 exec, s[60:61]
  buffer_load_dwordx4 v[112:115], v34, s[32:35], s90 offen offset:0 sc1
  s_waitcnt vmcnt(0)
L_gc_75:
  s_mov_b64 exec, s[60:61]
  v_perm_b32 v44, v113, v112, s56
  v_perm_b32 v44, v114, v44, s57
  v_perm_b32 v44, v115, v44, s58
  v_cmp_ne_u32 s[60:61], s48, v44
  s_nop 0
  s_cmp_lg_u64 s[60:61], 0
  s_cbranch_scc1 L_g_73
  s_mov_b64 exec, -1
  v_permlane32_swap_b32 v112, v114
  v_permlane32_swap_b32 v113, v115
  v_add_f32 v112, v112, v114
  v_add_f32 v113, v113, v115
  s_nop 1
  v_permlane16_swap_b32 v112, v113
  v_add_f32 v112, v112, v113
  s_nop 1
  v_add_f32_dpp v112, v112, v112 row_ror:8 row_mask:0xf bank_mask:0xf
L_nof:
  ds_write_b32 v59, v112 offset:1024
  s_waitcnt lgkmcnt(0)
  s_barrier
  s_cmp_lg_u32 s3, 0
  s_cbranch_scc1 L_fin
  ds_read_b128 v[112:115], v60 offset:1024
  ds_read_b128 v[116:119], v60 offset:1040
  s_waitcnt lgkmcnt(0)
  v_add_f32 v112, v112, v113
  v_add_f32 v114, v114, v115
  v_add_f32 v116, v116, v117
  v_add_f32 v118, v118, v119
  v_add_f32 v112, v112, v114
  v_add_f32 v116, v116, v118
  v_add_f32 v112, v112, v116
  v_cvt_pk_bf16_f32 v45, v112, v112
  v_and_b32 v112, 0xffff0000, v45
  v_mul_f32 v44, v79, v112
  v_cvt_pk_bf16_f32 v45, v44, v44
  v_and_b32 v44, 0xffff0000, v45
  v_add_f32 v44, v67, v44
  v_cvt_pk_bf16_f32 v44, v44, v44
  s_mov_b32 exec_hi, 0
  global_store_short v46, v44, s[28:29]
  s_cmp_lg_u32 s2, 128
  s_cbranch_scc1 L_noep
  s_mov_b64 exec, 1
  v_mov_b32 v45, 0
  global_store_dword v45, v45, s[30:31]
L_noep:
L_fin:
  s_endpgm
L_Y:
  s_cmp_ge_u32 s2, 112
  s_cbranch_scc1 L_finA
  s_lshl_b32 s94, s81, 13
  s_lshl_b32 s97, s3, 10
  s_add_u32 s94, s94, s97
  s_add_u32 s94, s94, 0x110000
  s_mov_b64 s[40:41], s[22:23]
  s_mov_b32 s42, 0x1c0000
  s_mov_b32 s43, 0x20000
  v_lshrrev_b32 v44, 5, v1
  v_lshlrev_b32 v44, 10, v44
  v_and_b32 v3, 31, v1
  v_lshl_add_u32 v44, v3, 4, v44
  buffer_load_dwordx4 v[176:179], v44, s[40:43], s91 offen offset:0 nt
  buffer_load_dwordx4 v[180:183], v44, s[40:43], s91 offen offset:2048 nt
  v_mov_b32 v112, 0
  v_mov_b32 v113, 0
  v_mov_b32 v114, 0
  v_mov_b32 v115, 0
  v_lshlrev_b32 v46, 4, v1
  v_add_u32 v46, 88064, v46
  v_lshlrev_b32 v47, 5, v1
  v_add_u32 v47, 83968, v47
  s_waitcnt vmcnt(0)
  s_mov_b64 s[60:61], -1
  s_mov_b32 s100, 0
  s_branch L_gf_78
L_g_77:
  s_add_u32 s100, s100, 1
  s_cmp_gt_u32 s100, 1000000
  s_cbranch_scc1 L_abort
  s_sleep 2
  s_cmp_lg_u32 s100, 30
  s_cbranch_scc1 L_alt_80
  s_cmp_lg_u32 s69, 0
  s_cbranch_scc1 L_cg_81
  s_mov_b32 exec_lo, 0x10001
  s_mov_b32 exec_hi, 0x10001
  s_add_u32 s97, s16, 0x160000
  buffer_store_dwordx4 v[8:11], v1, s[32:35], s97 offen sc1
  s_mov_b32 s69, 1
  s_mov_b64 exec, -1
L_cg_81:
L_alt_80:
L_gf_78:
  s_mov_b64 exec, s[60:61]
  buffer_load_dwordx4 v[76:79], v34, s[32:35], s94 offen offset:0 sc1
  s_waitcnt vmcnt(0)
L_gc_79:
  s_mov_b64 exec, s[60:61]
  v_perm_b32 v44, v77, v76, s56
  v_perm_b32 v44, v78, v44, s57
  v_perm_b32 v44, v79, v44, s58
  v_cmp_ne_u32 s[60:61], s48, v44
  s_nop 0
  s_cmp_lg_u64 s[60:61], 0
  s_cbranch_scc1 L_g_77
  s_mov_b64 exec, -1
  v_permlane32_swap_b32 v76, v78
  v_permlane32_swap_b32 v77, v79
  v_add_f32 v76, v76, v78
  v_add_f32 v77, v77, v79
  s_nop 1
  v_permlane16_swap_b32 v76, v77
  v_add_f32 v76, v76, v77
  s_waitcnt vmcnt(0)
  ds_write_b128 v62, v[176:179] offset:0
  ds_write_b128 v62, v[180:183] offset:1088
  ds_write_b32 v60, v76
  s_waitcnt lgkmcnt(0)
  s_barrier
  ds_read_b128 v[128:131], v46
  ds_read_b128 v[132:135], v46 offset:1024
  ds_read_b64_tr_b16 v[68:69], v63 offset:0
  ds_read_b64_tr_b16 v[70:71], v63 offset:2176
  ds_read_b64_tr_b16 v[72:73], v63 offset:32
  ds_read_b64_tr_b16 v[74:75], v63 offset:2208
  s_waitcnt lgkmcnt(4)
  v_add_f32 v128, v128, v129
  v_add_f32 v130, v130, v131
  v_add_f32 v128, v128, v130
  v_add_f32 v132, v132, v133
  v_add_f32 v134, v134, v135
  v_add_f32 v132, v132, v134
  s_mov_b32 s66, 0
  s_mov_b32 s60, 0xffffffff
  s_mov_b32 s61, 0x0
  s_mov_b32 s62, 0xffff
  s_mov_b32 s63, 0x0
  s_mov_b32 s100, 0
  s_branch L_gf_84
L_g_83:
  s_add_u32 s100, s100, 1
  s_cmp_gt_u32 s100, 1000000
  s_cbranch_scc1 L_abort
  s_sleep 1
  s_cmp_lg_u32 s100, 30
  s_cbranch_scc1 L_alt_86
  s_cmp_lg_u32 s69, 0
  s_cbranch_scc1 L_cg_87
  s_mov_b32 exec_lo, 0x10001
  s_mov_b32 exec_hi, 0x10001
  s_add_u32 s97, s16, 0x160000
  buffer_store_dwordx4 v[8:11], v1, s[32:35], s97 offen sc1
  s_mov_b32 s69, 1
  s_mov_b64 exec, -1
L_cg_87:
  s_add_u32 s82, s82, 0xf0000
  s_add_u32 s66, s66, 0x1e0000
L_alt_86:
L_gf_84:
  s_mov_b64 exec, s[60:61]
  s_cbranch_execz L_gs_88
  buffer_load_dwordx4 v[112:115], v61, s[32:35], s82 offen offset:0 sc1
L_gs_88:
  s_mov_b64 exec, s[62:63]
  s_cbranch_execz L_gs_89
  buffer_load_dwordx4 v[136:139], v56, s[32:35], s66 offen offset:0 sc1
L_gs_89:
  s_waitcnt vmcnt(0)
L_gc_85:
  s_mov_b64 exec, s[60:61]
  v_perm_b32 v44, v113, v112, s56
  v_perm_b32 v44, v114, v44, s57
  v_perm_b32 v44, v115, v44, s58
  v_cmp_ne_u32 s[60:61], s48, v44
  s_mov_b64 exec, s[62:63]
  v_perm_b32 v44, v137, v136, s56
  v_perm_b32 v44, v138, v44, s57
  v_perm_b32 v44, v139, v44, s58
  v_cmp_ne_u32 s[62:63], s48, v44
  s_nop 0
  s_or_b64 s[96:97], s[60:61], s[62:63]
  s_cbranch_scc1 L_g_83
  s_mov_b64 exec, -1
  v_permlane32_swap_b32 v112, v114
  v_permlane32_swap_b32 v113, v115
  v_add_f32 v112, v112, v114
  v_add_f32 v113, v113, v115
  s_nop 1
  v_permlane16_swap_b32 v112, v113
  v_add_f32 v112, v112, v113
  ds_write_b32 v59, v112
  v_add_f32 v136, v136, v138
  v_add_f32 v137, v137, v139
  s_nop 0
  v_add_f32_dpp v136, v136, v136 quad_perm:[1,0,3,2] row_mask:0xf bank_mask:0xf
  v_add_f32_dpp v137, v137, v137 quad_perm:[1,0,3,2] row_mask:0xf bank_mask:0xf
  s_nop 0
  v_add_f32_dpp v136, v136, v136 quad_perm:[2,3,0,1] row_mask:0xf bank_mask:0xf
  v_add_f32_dpp v137, v137, v137 quad_perm:[2,3,0,1] row_mask:0xf bank_mask:0xf
  s_nop 0
  v_add_f32_dpp v136, v136, v136 row_half_mirror row_mask:0xf bank_mask:0xf
  v_add_f32_dpp v137, v137, v137 row_half_mirror row_mask:0xf bank_mask:0xf
  s_nop 0
  v_add_f32_dpp v136, v136, v136 row_ror:8 row_mask:0xf bank_mask:0xf
  v_add_f32_dpp v137, v137, v137 row_ror:8 row_mask:0xf bank_mask:0xf
  s_waitcnt lgkmcnt(0)
  s_barrier
  ds_read_b128 v[112:115], v47
  ds_read_b128 v[116:119], v47 offset:16
  v_readfirstlane_b32 s92, v136
  v_readfirstlane_b32 s93, v137
  v_mov_b32 v44, 0x3b000000
  v_mul_f32 v136, s92, v44
  v_mul_f32 v137, s93, v44
  v_fma_f32 v137, -v136, v136, v137
  v_max_f32 v137, 0, v137
  v_cvt_pk_bf16_f32 v45, v137, v137
  v_and_b32 v137, 0xffff0000, v45
  v_cvt_pk_bf16_f32 v44, v136, v136
  v_and_b32 v136, 0xffff0000, v44
  v_add_f32 v137, 0x3727c5ac, v137
  v_mul_f32 v128, v136, v128
  v_cvt_pk_bf16_f32 v45, v137, v137
  v_and_b32 v137, 0xffff0000, v45
  v_sqrt_f32 v137, v137
  s_nop 0
  v_cvt_pk_bf16_f32 v45, v137, v137
  v_and_b32 v137, 0xffff0000, v45
  v_rcp_f32 v137, v137
  s_waitcnt lgkmcnt(0)
  v_add_f32 v112, v112, v113
  v_add_f32 v114, v114, v115
  v_add_f32 v116, v116, v117
  v_add_f32 v118, v118, v119
  v_add_f32 v112, v112, v114
  v_add_f32 v116, v116, v118
  v_add_f32 v112, v112, v116
  v_sub_f32 v112, v112, v128
  v_fma_f32 v112, v112, v137, v132
  v_cvt_pk_bf16_f32 v44, v112, v112
  v_and_b32 v112, 0xffff0000, v44
  v_mul_f32 v44, v112, v112
  v_mov_b32 v45, 0xc0135761
  v_mov_b32_dpp v113, v112 row_ror:8 row_mask:0xf bank_mask:0xf
  v_fmac_f32 v45, 0xbdd2d3e8, v44
  v_mul_f32 v44, v45, v112
  v_exp_f32 v44, v44
  s_nop 0
  v_add_f32 v44, 1.0, v44
  v_rcp_f32 v44, v44
  s_nop 0
  v_mul_f32 v112, v112, v44
  v_cvt_pk_bf16_f32 v44, v112, v112
  v_and_b32 v112, 0xffff0000, v44
  v_mul_f32 v112, v112, v113
  v_cvt_pk_bf16_f32 v44, v112, v112
  s_mov_b32 exec_lo, 0xff00ff
  s_mov_b32 exec_hi, 0xff00ff
  ds_write_b16 v57, v44
  s_mov_b64 exec, -1
  ds_read_b128 v[160:163], v41
  s_mov_b32 s70, 0x20002
  s_mov_b32 s71, 0x20002
  s_waitcnt lgkmcnt(0)
  v_mfma_f32_16x16x32_bf16 v[144:147], v[68:71], v[160:163], 0
  v_mfma_f32_16x16x32_bf16 v[148:151], v[72:75], v[160:163], 0
  s_nop 7
  v_cndmask_b32 v144, v144, v148, s[70:71]
  v_cndmask_b32 v145, v145, v149, s[70:71]
  v_cndmask_b32 v146, v146, v150, s[70:71]
  v_cndmask_b32 v147, v147, v151, s[70:71]
  v_and_or_b32 v144, v144, v2, s49
  v_and_or_b32 v145, v145, v2, s50
  v_and_or_b32 v146, v146, v2, s51
  v_and_or_b32 v147, v147, v2, s52
  s_mov_b32 exec_lo, 0x30003
  s_mov_b32 exec_hi, 0x30003
  buffer_store_dwordx4 v[144:147], v58, s[32:35], s90 offen sc1
L_finA:
  s_mov_b64 exec, -1
  s_cmp_lg_u32 s69, 0
  s_cbranch_scc1 L_cg_90
  s_mov_b32 exec_lo, 0x10001
  s_mov_b32 exec_hi, 0x10001
  s_add_u32 s97, s16, 0x160000
  buffer_store_dwordx4 v[8:11], v1, s[32:35], s97 offen sc1
  s_mov_b32 s69, 1
  s_mov_b64 exec, -1
L_cg_90:
  s_endpgm
L_abort:
  s_endpgm
L_end:
  s_endpgm
L_codeend:
.section .rodata,"a"
.p2align 6
.amdhsa_kernel adaLN_cond__compressed_kv_cla__glu_gated_geglu__decode_kernel
  .amdhsa_next_free_vgpr 256
  .amdhsa_next_free_sgpr 102
  .amdhsa_accum_offset 256
  .amdhsa_group_segment_fixed_size 0
  .amdhsa_kernarg_size 120
  .amdhsa_user_sgpr_count 2
  .amdhsa_user_sgpr_kernarg_segment_ptr 1
  .amdhsa_system_sgpr_workgroup_id_x 1
.end_amdhsa_kernel
```

```asm
; @launch grid=(256,1,1) block=(512,1,1) lds=163840
.amdgcn_target "amdgcn-amd-amdhsa--gfx950"
.text
.globl adaLN_cond__compressed_kv_cla__glu_gated_geglu__decode_kernel
.p2align 8
.type adaLN_cond__compressed_kv_cla__glu_gated_geglu__decode_kernel,@function
adaLN_cond__compressed_kv_cla__glu_gated_geglu__decode_kernel:
  s_cmp_ge_u32 s2, 256
  s_cbranch_scc1 L_end
  s_load_dwordx16 s[4:19], s[0:1], 0
  s_load_dwordx8 s[20:27], s[0:1], 64
  s_load_dwordx4 s[28:31], s[0:1], 96
  s_load_dwordx2 s[32:33], s[0:1], 112
  v_lshrrev_b32 v1, 6, v0
  s_mov_b32 s34, 0x10000000
  s_mov_b32 s35, 0x20000
  v_readfirstlane_b32 s3, v1
  v_and_b32 v1, 63, v0
  v_mov_b32 v8, 0
  v_mov_b32 v20, 0
  v_mov_b32 v251, 0
  v_mov_b32 v253, 0
  s_cmp_lt_u32 s2, 128
  s_cbranch_scc0 L_B
  v_lshlrev_b32 v38, 4, v1
  s_bfe_u32 s82, s2, 0x30003
  s_lshl_b32 s82, s82, 19
  s_lshl_b32 s97, s3, 16
  s_add_u32 s82, s82, s97
  s_and_b32 s97, s2, 7
  s_lshl_b32 s97, s97, 10
  s_add_u32 s82, s82, s97
  s_mov_b32 s42, 0x400000
  s_mov_b32 s43, 0x20000
  s_bitcmp1_b32 s2, 6
  s_cbranch_scc1 L_K
  v_and_b32 v8, 15, v1
  v_lshlrev_b32 v8, 3, v8
  v_lshrrev_b32 v3, 4, v1
  v_lshl_add_u32 v8, v3, 1, v8
  s_bfe_u32 s92, s2, 0x30003
  s_lshl_b32 s92, s92, 7
  v_add_u32 v17, s92, v8
  s_mul_i32 s83, s3, 8576
  s_lshl_b32 s92, s2, 17
  v_mov_b32 v18, s92
  v_mov_b32 v19, 0xf000
  s_waitcnt lgkmcnt(0)
  s_mov_b64 s[40:41], s[8:9]
  global_load_dwordx4 v[12:15], v38, s[4:5]
  global_load_ushort v16, v17, s[4:5]
  s_add_u32 m0, s83, 0
  s_add_u32 s92, s82, 0
  buffer_load_dwordx4 v38, s[40:43], s92 offen nt lds
  s_add_u32 m0, s83, 1056
  s_add_u32 s92, s82, 8192
  buffer_load_dwordx4 v38, s[40:43], s92 offen nt lds
  s_add_u32 m0, s83, 2112
  s_add_u32 s92, s82, 16384
  buffer_load_dwordx4 v38, s[40:43], s92 offen nt lds
  s_add_u32 m0, s83, 3168
  s_add_u32 s92, s82, 24576
  buffer_load_dwordx4 v38, s[40:43], s92 offen nt lds
  s_add_u32 m0, s83, 4224
  s_add_u32 s92, s82, 32768
  buffer_load_dwordx4 v38, s[40:43], s92 offen nt lds
  s_add_u32 m0, s83, 5280
  s_add_u32 s92, s82, 40960
  buffer_load_dwordx4 v38, s[40:43], s92 offen nt lds
  s_add_u32 m0, s83, 6336
  s_add_u32 s92, s82, 49152
  buffer_load_dwordx4 v38, s[40:43], s92 offen nt lds
  s_add_u32 m0, s83, 7392
  s_add_u32 s92, s82, 57344
  buffer_load_dwordx4 v38, s[40:43], s92 offen nt lds
  s_cmp_lg_u32 s3, 7
  s_cbranch_scc1 L_nt_1
  s_mov_b64 exec, 1
  global_load_dword v20, v18, s[6:7] nt
  global_load_dword v21, v19, s[32:33]
  global_load_dword v22, v38, s[30:31] offset:128
  s_mov_b64 exec, -1
L_nt_1:
  s_branch L_Q2
L_K:
  s_bfe_u32 s81, s2, 0x10004
  s_xor_b32 s81, s81, 1
  s_lshl_b32 s81, s81, 16
  s_and_b32 s92, s3, 1
  s_lshl_b32 s92, s92, 7
  v_xor_b32 v39, s92, v38
  s_lshl_b32 s83, s3, 13
  s_add_u32 s83, s83, s81
  v_mov_b32 v19, 0xf000
  s_waitcnt lgkmcnt(0)
  s_mov_b64 s[40:41], s[10:11]
  s_mov_b64 exec, 1
  global_load_dword v21, v19, s[32:33]
  s_mov_b64 exec, -1
  v_xor_b32 v40, 0, v39
  s_add_u32 m0, s83, 0
  s_add_u32 s92, s82, 0
  buffer_load_dwordx4 v40, s[40:43], s92 offen nt lds
  v_xor_b32 v41, 16, v39
  s_add_u32 m0, s83, 1024
  s_add_u32 s92, s82, 8192
  buffer_load_dwordx4 v41, s[40:43], s92 offen nt lds
  v_xor_b32 v40, 32, v39
  s_add_u32 m0, s83, 2048
  s_add_u32 s92, s82, 16384
  buffer_load_dwordx4 v40, s[40:43], s92 offen nt lds
  v_xor_b32 v41, 48, v39
  s_add_u32 m0, s83, 3072
  s_add_u32 s92, s82, 24576
  buffer_load_dwordx4 v41, s[40:43], s92 offen nt lds
  v_xor_b32 v40, 64, v39
  s_add_u32 m0, s83, 4096
  s_add_u32 s92, s82, 32768
  buffer_load_dwordx4 v40, s[40:43], s92 offen nt lds
  v_xor_b32 v41, 80, v39
  s_add_u32 m0, s83, 5120
  s_add_u32 s92, s82, 40960
  buffer_load_dwordx4 v41, s[40:43], s92 offen nt lds
  v_xor_b32 v40, 96, v39
  s_add_u32 m0, s83, 6144
  s_add_u32 s92, s82, 49152
  buffer_load_dwordx4 v40, s[40:43], s92 offen nt lds
  v_xor_b32 v41, 112, v39
  s_add_u32 m0, s83, 7168
  s_add_u32 s92, s82, 57344
  buffer_load_dwordx4 v41, s[40:43], s92 offen nt lds
  s_branch L_K2
L_B:
  s_cmp_ge_u32 s3, 4
  s_cbranch_scc0 L_Bfront
  v_lshrrev_b32 v10, 3, v1
  v_mul_u32_u24 v5, 24576, v10
  v_lshlrev_b32 v10, 3, v10
  v_and_b32 v11, 7, v1
  v_lshl_add_u32 v5, v11, 4, v5
  s_bfe_u32 s94, s2, 0x20004
  s_and_b32 s95, s2, 15
  s_lshl_b32 s92, s94, 2
  s_add_u32 s92, s92, s3
  s_sub_u32 s92, s92, 4
  s_lshl_b32 s93, s92, 6
  v_add_u32 v10, s93, v10
  s_mul_i32 s92, s92, 196608
  s_lshl_b32 s93, s95, 7
  s_add_u32 s92, s92, s93
  s_mov_b32 s42, 0x300000
  s_mov_b32 s43, 0x20000
  v_mov_b32 v253, 0
  s_waitcnt lgkmcnt(0)
  s_mov_b64 s[40:41], s[26:27]
  s_bitcmp1_b32 s2, 6
  s_cbranch_scc1 L_nou0
  global_load_dwordx2 v[112:113], v10, s[24:25]
  buffer_load_dwordx4 v[124:127], v5, s[40:43], s92 offen nt
  s_add_u32 s92, s92, 6144
  buffer_load_dwordx4 v[128:131], v5, s[40:43], s92 offen nt
  s_add_u32 s92, s92, 6144
  buffer_load_dwordx4 v[132:135], v5, s[40:43], s92 offen nt
  s_add_u32 s92, s92, 6144
  buffer_load_dwordx4 v[136:139], v5, s[40:43], s92 offen nt
L_nou0:
  s_branch L_Bback2
L_Bfront:
  s_memrealtime s[62:63]
  s_bfe_u32 s64, s2, 0x40003
  s_xor_b32 s64, s64, 8
  s_or_b32 s64, s64, s3
  s_cbranch_scc1 L_nononce
  v_mov_b32 v18, 0
  v_mov_b32 v21, 0
  s_waitcnt lgkmcnt(0)
  s_or_b32 s62, s62, 1
  v_mov_b32 v20, s62
  s_mov_b64 exec, 1
  global_atomic_cmpswap v18, v[20:21], s[30:31] sc1
  s_mov_b64 exec, -1
L_nononce:
  v_lshrrev_b32 v245, 4, v1
  v_and_b32 v246, 15, v1
  v_lshlrev_b32 v247, 2, v245
  v_xor_b32 v246, v246, v247
  v_lshlrev_b32 v246, 4, v246
  v_lshl_add_u32 v244, v245, 10, v246
  v_xor_b32 v245, 16, v244
  v_xor_b32 v246, 32, v244
  v_xor_b32 v247, 48, v244
  v_add_u32 v245, 3072, v245
  v_add_u32 v246, 6144, v246
  v_add_u32 v247, 9216, v247
  s_and_b32 s91, s3, 3
  s_lshl_b32 s90, s91, 15
  s_lshl_b32 s91, s91, 13
  s_lshl_b32 s92, s2, 17
  s_add_u32 s90, s90, s92
  s_bfe_u32 s93, s2, 0x20003
  s_lshl_b32 s92, s93, 15
  s_add_u32 s91, s91, s92
  s_lshl_b32 s92, s93, 8
  s_add_u32 s90, s90, s92
  s_getpc_b64 s[94:95]
L_pc:
  s_sub_u32 s94, s94, L_pc-adaLN_cond__compressed_kv_cla__glu_gated_geglu__decode_kernel
  s_subb_u32 s95, s95, 0
  s_bfe_u32 s92, s2, 0x40003
  s_lshl_b32 s92, s92, 2
  s_add_u32 s92, s92, s3
  s_lshl_b32 s92, s92, 10
  v_lshlrev_b32 v11, 4, v1
  v_add_u32 v11, s92, v11
  s_mov_b32 s38, 0x2000000
  s_mov_b32 s39, 0x20000
  s_cmp_ge_u32 s92, L_codeend-adaLN_cond__compressed_kv_cla__glu_gated_geglu__decode_kernel
  s_cbranch_scc1 L_nopf
  v_min_u32 v11, L_codeend-adaLN_cond__compressed_kv_cla__glu_gated_geglu__decode_kernel-16, v11
  global_load_dwordx4 v[12:15], v11, s[94:95]
L_nopf:
  s_waitcnt lgkmcnt(0)
  s_mov_b64 s[36:37], s[6:7]
  s_barrier
  s_barrier
  s_mov_b32 s54, 0x05040100
  s_mov_b32 s55, 0x07060302
  s_mov_b32 s56, 0x0c0c0400
  s_mov_b32 s57, 0x0c040100
  s_mov_b32 s58, 0x04020100
  s_mov_b32 s53, 0x10001
  v_mov_b32 v2, 0xffffff00
  s_lshr_b32 s77, s2, 5
  s_and_b32 s78, s2, 127
  s_and_b32 s76, s2, 7
  s_lshl_b32 s76, s76, 2
  s_bfe_u32 s97, s2, 0x20003
  s_add_u32 s76, s76, s97
  s_and_b32 s79, s2, 7
  s_lshl_b32 s79, s79, 1
  s_bfe_u32 s97, s2, 0x10003
  s_add_u32 s79, s79, s97
  s_bfe_u32 s80, s2, 0x30004
  s_bfe_u32 s17, s2, 0x20003
  s_bfe_u32 s59, s2, 0x10004
  s_lshl_b32 s59, s59, 14
  s_xor_b32 m0, s91, 0
  s_xor_b32 s101, s90, 0
  buffer_load_dwordx4 v244, s[36:39], s101 offen offset:0 nt lds
  s_waitcnt vmcnt(0)
  buffer_load_dwordx4 v245, s[36:39], s101 offen offset:1024 nt lds
  s_waitcnt vmcnt(0)
  buffer_load_dwordx4 v246, s[36:39], s101 offen offset:2048 nt lds
  s_waitcnt vmcnt(2)
  buffer_load_dwordx4 v247, s[36:39], s101 offen offset:3072 nt lds
  s_waitcnt vmcnt(2)
  s_xor_b32 m0, s91, 32768
  s_xor_b32 s101, s90, 256
  buffer_load_dwordx4 v244, s[36:39], s101 offen offset:0 nt lds
  s_waitcnt vmcnt(2)
  buffer_load_dwordx4 v245, s[36:39], s101 offen offset:1024 nt lds
  s_waitcnt vmcnt(2)
  buffer_load_dwordx4 v246, s[36:39], s101 offen offset:2048 nt lds
  s_waitcnt vmcnt(2)
  buffer_load_dwordx4 v247, s[36:39], s101 offen offset:3072 nt lds
  s_waitcnt vmcnt(2)
  s_xor_b32 m0, s91, 65536
  s_xor_b32 s101, s90, 512
  buffer_load_dwordx4 v244, s[36:39], s101 offen offset:0 nt lds
  buffer_load_dwordx4 v245, s[36:39], s101 offen offset:1024 nt lds
  buffer_load_dwordx4 v246, s[36:39], s101 offen offset:2048 nt lds
  buffer_load_dwordx4 v247, s[36:39], s101 offen offset:3072 nt lds
  v_mov_b32 v253, 0
  global_load_dword v252, v253, s[30:31] sc1
  s_xor_b32 m0, s91, 98304
  s_xor_b32 s101, s90, 768
  buffer_load_dwordx4 v244, s[36:39], s101 offen offset:0 nt lds
  buffer_load_dwordx4 v245, s[36:39], s101 offen offset:1024 nt lds
  buffer_load_dwordx4 v246, s[36:39], s101 offen offset:2048 nt lds
  buffer_load_dwordx4 v247, s[36:39], s101 offen offset:3072 nt lds
  s_barrier
  s_branch L_front
L_Q2:
  s_mov_b32 s54, 0x05040100
  s_mov_b32 s55, 0x07060302
  s_mov_b32 s56, 0x0c0c0400
  s_mov_b32 s57, 0x0c040100
  s_mov_b32 s58, 0x04020100
  s_mov_b32 s53, 0x10001
  v_mov_b32 v2, 0xffffff00
  s_lshr_b32 s77, s2, 5
  s_and_b32 s78, s2, 127
  s_and_b32 s76, s2, 7
  s_lshl_b32 s76, s76, 2
  s_bfe_u32 s97, s2, 0x20003
  s_add_u32 s76, s76, s97
  s_and_b32 s79, s2, 7
  s_lshl_b32 s79, s79, 1
  s_bfe_u32 s97, s2, 0x10003
  s_add_u32 s79, s79, s97
  s_bfe_u32 s80, s2, 0x30004
  s_bfe_u32 s17, s2, 0x20003
  s_bfe_u32 s59, s2, 0x10004
  s_lshl_b32 s59, s59, 14
  v_lshrrev_b32 v245, 4, v1
  v_and_b32 v246, 15, v1
  v_lshlrev_b32 v247, 2, v245
  v_xor_b32 v246, v246, v247
  v_lshlrev_b32 v246, 4, v246
  v_lshl_add_u32 v244, v245, 10, v246
  v_xor_b32 v245, 16, v244
  v_xor_b32 v246, 32, v244
  v_xor_b32 v247, 48, v244
  v_add_u32 v245, 3072, v245
  v_add_u32 v246, 6144, v246
  v_add_u32 v247, 9216, v247
  s_and_b32 s91, s3, 3
  s_lshl_b32 s90, s91, 15
  s_lshl_b32 s91, s91, 13
  s_lshl_b32 s92, s2, 17
  s_add_u32 s90, s90, s92
  s_bfe_u32 s93, s2, 0x20003
  s_lshl_b32 s92, s93, 15
  s_add_u32 s91, s91, s92
  s_lshl_b32 s92, s93, 8
  s_add_u32 s90, s90, s92
  s_mov_b64 s[36:37], s[6:7]
  s_mov_b32 s38, 0x2000000
  s_mov_b32 s39, 0x20000
  s_bfe_u32 s82, s2, 0x30003
  s_lshl_b32 s82, s82, 10
  s_add_u32 s83, s82, 8192
  s_lshl_b32 s92, s3, 7
  s_add_u32 s92, s92, 0x20000
  v_add_u32 v40, s92, v8
  v_lshrrev_b32 v41, 4, v1
  v_lshlrev_b32 v41, 4, v41
  v_add_u32 v41, s92, v41
  s_lshl_b32 s92, s3, 7
  v_lshrrev_b32 v44, 4, v1
  v_mul_u32_u24 v44, 8576, v44
  v_bfe_u32 v3, v1, 2, 2
  v_mul_u32_u24 v3, 1056, v3
  v_add_u32 v44, v3, v44
  v_and_b32 v3, 3, v1
  v_lshl_add_u32 v44, v3, 3, v44
  v_add_u32 v44, s92, v44
  v_and_b32 v39, 3, v1
  v_lshlrev_b32 v39, 6, v39
  v_lshrrev_b32 v3, 4, v1
  v_lshl_add_u32 v39, v3, 4, v39
  s_and_b32 s85, s2, 7
  s_lshl_b32 s85, s85, 14
  s_bfe_u32 s97, s2, 0x30003
  s_lshl_b32 s97, s97, 11
  s_add_u32 s85, s85, s97
  s_lshl_b32 s97, s3, 8
  s_add_u32 s85, s85, s97
  s_add_u32 s85, s85, 0x80000
  s_mov_b32 s70, 0x20002
  s_mov_b32 s71, 0x20002
  s_mov_b32 s72, 0x40004
  s_mov_b32 s73, 0x40004
  s_mov_b32 s74, 0x80008
  s_mov_b32 s75, 0x80008
  s_waitcnt vmcnt(8)
  v_lshlrev_b32 v92, 16, v12
  v_and_b32 v93, 0xffff0000, v12
  v_lshlrev_b32 v94, 16, v13
  v_and_b32 v95, 0xffff0000, v13
  v_lshlrev_b32 v96, 16, v14
  v_and_b32 v97, 0xffff0000, v14
  v_lshlrev_b32 v98, 16, v15
  v_and_b32 v99, 0xffff0000, v15
  v_add_f32 v100, v92, v93
  v_add_f32 v100, v100, v94
  v_add_f32 v100, v100, v95
  v_add_f32 v100, v100, v96
  v_add_f32 v100, v100, v97
  v_add_f32 v100, v100, v98
  v_add_f32 v100, v100, v99
  s_nop 1
  v_add_f32_dpp v100, v100, v100 row_ror:8 row_mask:0xf bank_mask:0xf
  s_nop 1
  v_add_f32_dpp v100, v100, v100 row_ror:4 row_mask:0xf bank_mask:0xf
  s_nop 1
  v_add_f32_dpp v100, v100, v100 row_ror:2 row_mask:0xf bank_mask:0xf
  s_nop 1
  v_add_f32_dpp v100, v100, v100 row_ror:1 row_mask:0xf bank_mask:0xf
  v_mov_b32 v101, v100
  s_nop 1
  v_permlane16_swap_b32 v100, v101
  v_add_f32 v100, v100, v101
  v_mov_b32 v101, v100
  s_nop 1
  v_permlane32_swap_b32 v100, v101
  v_add_f32 v100, v100, v101
  v_mul_f32 v100, 0x3b000000, v100
  v_sub_f32 v92, v92, v100
  v_sub_f32 v93, v93, v100
  v_sub_f32 v94, v94, v100
  v_sub_f32 v95, v95, v100
  v_sub_f32 v96, v96, v100
  v_sub_f32 v97, v97, v100
  v_sub_f32 v98, v98, v100
  v_sub_f32 v99, v99, v100
  v_mul_f32 v102, v92, v92
  v_fmac_f32 v102, v93, v93
  v_fmac_f32 v102, v94, v94
  v_fmac_f32 v102, v95, v95
  v_fmac_f32 v102, v96, v96
  v_fmac_f32 v102, v97, v97
  v_fmac_f32 v102, v98, v98
  v_fmac_f32 v102, v99, v99
  s_nop 1
  v_add_f32_dpp v102, v102, v102 row_ror:8 row_mask:0xf bank_mask:0xf
  s_nop 1
  v_add_f32_dpp v102, v102, v102 row_ror:4 row_mask:0xf bank_mask:0xf
  s_nop 1
  v_add_f32_dpp v102, v102, v102 row_ror:2 row_mask:0xf bank_mask:0xf
  s_nop 1
  v_add_f32_dpp v102, v102, v102 row_ror:1 row_mask:0xf bank_mask:0xf
  v_mov_b32 v101, v102
  s_nop 1
  v_permlane16_swap_b32 v102, v101
  v_add_f32 v102, v102, v101
  v_mov_b32 v101, v102
  s_nop 1
  v_permlane32_swap_b32 v102, v101
  v_add_f32 v102, v102, v101
  v_mov_b32 v253, 0
  global_load_dword v252, v253, s[30:31] sc1
  v_mul_f32 v102, 0x3b000000, v102
  v_cvt_pk_bf16_f32 v101, v100, v100
  v_and_b32 v100, 0xffff0000, v101
  v_cvt_pk_bf16_f32 v101, v102, v102
  v_and_b32 v102, 0xffff0000, v101
  v_add_f32 v102, 0x3727c5ac, v102
  v_cvt_pk_bf16_f32 v101, v102, v102
  v_and_b32 v102, 0xffff0000, v101
  v_sqrt_f32 v102, v102
  s_nop 0
  v_cvt_pk_bf16_f32 v101, v102, v102
  v_and_b32 v102, 0xffff0000, v101
  v_rcp_f32 v102, v102
  v_lshlrev_b32 v103, 16, v16
  v_sub_f32 v103, v103, v100
  v_cvt_pk_bf16_f32 v101, v103, v103
  v_and_b32 v103, 0xffff0000, v101
  v_mul_f32 v103, v103, v102
  v_cvt_pk_bf16_f32 v101, v103, v103
  v_and_b32 v103, 0xffff0000, v101
  s_mov_b32 s100, 0
  s_waitcnt vmcnt(0)
  s_branch L_epc_3
L_ep_2:
  global_load_dword v252, v253, s[30:31] sc1
  s_add_u32 s100, s100, 1
  s_cmp_gt_u32 s100, 1000000
  s_cbranch_scc1 L_abort
  s_waitcnt vmcnt(0)
L_epc_3:
  v_readfirstlane_b32 s48, v252
  s_nop 0
  s_cmp_eq_u32 s48, 0
  s_nop 1
  s_cbranch_scc1 L_ep_2
  s_mul_i32 s48, s48, 0x9e3779b1
  s_and_b32 s49, s48, 0xff
  s_bfe_u32 s50, s48, 0x80008
  s_bfe_u32 s51, s48, 0x80010
  s_lshr_b32 s52, s48, 24
  s_lshr_b32 s97, s48, 15
  s_xor_b32 s97, s97, s48
  s_mul_i32 s97, s97, 0x85ebca6b
  v_mov_b32 v4, s48
  v_mov_b32 v5, s97
  v_mov_b32 v249, s48
  v_mov_b32 v250, s97
  v_and_b32 v6, 4, v1
  v_cmp_eq_u32 vcc, 0, v6
  v_and_b32 v7, 3, v1
  v_lshlrev_b32 v7, 2, v7
  v_cndmask_b32 v4, v5, v4, vcc
  v_lshrrev_b32 v4, v7, v4
  v_lshrrev_b32 v5, 1, v4
  v_lshrrev_b32 v6, 2, v4
  v_lshrrev_b32 v7, 3, v4
  s_barrier
  buffer_load_dwordx4 v[20:23], v38, s[32:35], s82 offen offset:0 sc1
  buffer_load_dwordx4 v[24:27], v38, s[32:35], s83 offen offset:0 sc1
  ds_read_b64_tr_b16 v[112:113], v44 offset:0
  ds_read_b64_tr_b16 v[114:115], v44 offset:4224
  ds_read_b64_tr_b16 v[116:117], v44 offset:34304
  ds_read_b64_tr_b16 v[118:119], v44 offset:38528
  ds_read_b64_tr_b16 v[120:121], v44 offset:32
  ds_read_b64_tr_b16 v[122:123], v44 offset:4256
  ds_read_b64_tr_b16 v[124:125], v44 offset:34336
  ds_read_b64_tr_b16 v[126:127], v44 offset:38560
  ds_read_b64_tr_b16 v[128:129], v44 offset:64
  ds_read_b64_tr_b16 v[130:131], v44 offset:4288
  ds_read_b64_tr_b16 v[132:133], v44 offset:34368
  ds_read_b64_tr_b16 v[134:135], v44 offset:38592
  s_waitcnt lgkmcnt(4)
  ds_read_b64_tr_b16 v[136:137], v44 offset:96
  ds_read_b64_tr_b16 v[138:139], v44 offset:4320
  ds_read_b64_tr_b16 v[140:141], v44 offset:34400
  ds_read_b64_tr_b16 v[142:143], v44 offset:38624
  s_waitcnt lgkmcnt(0)
  s_barrier
  s_mov_b64 s[60:61], -1
  s_waitcnt vmcnt(0)
  s_mov_b32 s100, 0
  s_branch L_gc_6
L_g_4:
  s_add_u32 s100, s100, 1
  s_cmp_gt_u32 s100, 1000000
  s_cbranch_scc1 L_abort
  s_sleep 2
L_gf_5:
  s_mov_b64 exec, s[60:61]
  buffer_load_dwordx4 v[20:23], v38, s[32:35], s82 offen offset:0 sc1
  buffer_load_dwordx4 v[24:27], v38, s[32:35], s83 offen offset:0 sc1
  s_waitcnt vmcnt(0)
L_gc_6:
  s_mov_b64 exec, s[60:61]
  v_perm_b32 v92, v21, v20, s56
  v_perm_b32 v92, v22, v92, s57
  v_perm_b32 v92, v23, v92, s58
  v_cmp_ne_u32 s[60:61], s48, v92
  v_perm_b32 v92, v25, v24, s56
  v_perm_b32 v92, v26, v92, s57
  v_perm_b32 v92, v27, v92, s58
  v_cmp_ne_u32 vcc, s48, v92
  s_nop 0
  s_or_b64 s[60:61], s[60:61], vcc
  s_cmp_lg_u64 s[60:61], 0
  s_cbranch_scc1 L_g_4
  s_mov_b64 exec, -1
  v_permlane32_swap_b32 v20, v22
  v_permlane32_swap_b32 v21, v23
  v_permlane32_swap_b32 v24, v26
  v_permlane32_swap_b32 v25, v27
  v_add_f32 v20, v20, v22
  v_add_f32 v21, v21, v23
  v_add_f32 v24, v24, v26
  v_add_f32 v25, v25, v27
  v_permlane16_swap_b32 v20, v21
  s_nop 0
  v_permlane16_swap_b32 v24, v25
  v_add_f32 v20, v20, v21
  v_add_f32 v24, v24, v25
  v_cvt_pk_bf16_f32 v25, v24, v24
  v_and_b32 v24, 0xffff0000, v25
  v_cvt_pk_bf16_f32 v21, v20, v20
  v_and_b32 v20, 0xffff0000, v21
  v_add_f32 v24, 1.0, v24
  v_cvt_pk_bf16_f32 v25, v24, v24
  v_and_b32 v24, 0xffff0000, v25
  v_mul_f32 v24, v103, v24
  v_cvt_pk_bf16_f32 v25, v24, v24
  v_and_b32 v24, 0xffff0000, v25
  v_add_f32 v24, v24, v20
  v_cvt_pk_bf16_f32 v24, v24, v24
  ds_write_b16 v40, v24
  ds_read_b128 v[28:31], v41
  ds_read_b128 v[32:35], v41 offset:64
  s_waitcnt lgkmcnt(1)
  v_mfma_f32_16x16x32_bf16 v[80:83], v[112:115], v[28:31], 0
  v_mfma_f32_16x16x32_bf16 v[84:87], v[120:123], v[28:31], 0
  v_mfma_f32_16x16x32_bf16 v[88:91], v[128:131], v[28:31], 0
  v_mfma_f32_16x16x32_bf16 v[92:95], v[136:139], v[28:31], 0
  s_waitcnt lgkmcnt(0)
  v_mfma_f32_16x16x32_bf16 v[80:83], v[116:119], v[32:35], v[80:83]
  v_mfma_f32_16x16x32_bf16 v[84:87], v[124:127], v[32:35], v[84:87]
  v_mfma_f32_16x16x32_bf16 v[88:91], v[132:135], v[32:35], v[88:91]
  v_mfma_f32_16x16x32_bf16 v[92:95], v[140:143], v[32:35], v[92:95]
  s_nop 5
  v_cndmask_b32 v80, v80, v84, s[70:71]
  v_cndmask_b32 v81, v81, v85, s[70:71]
  v_cndmask_b32 v82, v82, v86, s[70:71]
  v_cndmask_b32 v83, v83, v87, s[70:71]
  v_cndmask_b32 v80, v80, v88, s[72:73]
  v_cndmask_b32 v81, v81, v89, s[72:73]
  v_cndmask_b32 v82, v82, v90, s[72:73]
  v_cndmask_b32 v83, v83, v91, s[72:73]
  v_cndmask_b32 v80, v80, v92, s[74:75]
  v_cndmask_b32 v81, v81, v93, s[74:75]
  v_cndmask_b32 v82, v82, v94, s[74:75]
  v_cndmask_b32 v83, v83, v95, s[74:75]
  v_and_or_b32 v80, v80, v2, s49
  v_and_or_b32 v81, v81, v2, s50
  v_and_or_b32 v82, v82, v2, s51
  v_and_or_b32 v83, v83, v2, s52
  s_mov_b32 exec_lo, 0xf000f
  s_mov_b32 exec_hi, 0xf000f
  buffer_store_dwordx4 v[80:83], v39, s[32:35], s85 offen sc1
  s_mov_b64 exec, -1
  s_barrier
  s_lshr_b32 s92, s3, 2
  s_lshl_b32 s93, s92, 12
  s_xor_b32 s93, s93, 0
  s_xor_b32 m0, s91, s93
  s_lshl_b32 s93, s92, 14
  s_xor_b32 s93, s93, 0
  s_xor_b32 s101, s90, s93
  buffer_load_dwordx4 v244, s[36:39], s101 offen offset:0 nt lds
  buffer_load_dwordx4 v245, s[36:39], s101 offen offset:1024 nt lds
  buffer_load_dwordx4 v246, s[36:39], s101 offen offset:2048 nt lds
  buffer_load_dwordx4 v247, s[36:39], s101 offen offset:3072 nt lds
  s_lshr_b32 s92, s3, 2
  s_lshl_b32 s93, s92, 12
  s_xor_b32 s93, s93, 32768
  s_xor_b32 m0, s91, s93
  s_lshl_b32 s93, s92, 14
  s_xor_b32 s93, s93, 256
  s_xor_b32 s101, s90, s93
  buffer_load_dwordx4 v244, s[36:39], s101 offen offset:0 nt lds
  buffer_load_dwordx4 v245, s[36:39], s101 offen offset:1024 nt lds
  buffer_load_dwordx4 v246, s[36:39], s101 offen offset:2048 nt lds
  buffer_load_dwordx4 v247, s[36:39], s101 offen offset:3072 nt lds
  s_lshr_b32 s92, s3, 2
  s_lshl_b32 s93, s92, 12
  s_xor_b32 s93, s93, 65536
  s_xor_b32 m0, s91, s93
  s_lshl_b32 s93, s92, 14
  s_xor_b32 s93, s93, 512
  s_xor_b32 s101, s90, s93
  buffer_load_dwordx4 v244, s[36:39], s101 offen offset:0 nt lds
  buffer_load_dwordx4 v245, s[36:39], s101 offen offset:1024 nt lds
  buffer_load_dwordx4 v246, s[36:39], s101 offen offset:2048 nt lds
  buffer_load_dwordx4 v247, s[36:39], s101 offen offset:3072 nt lds
  s_lshr_b32 s92, s3, 2
  s_lshl_b32 s93, s92, 12
  s_xor_b32 s93, s93, 98304
  s_xor_b32 m0, s91, s93
  s_lshl_b32 s93, s92, 14
  s_xor_b32 s93, s93, 768
  s_xor_b32 s101, s90, s93
  buffer_load_dwordx4 v244, s[36:39], s101 offen offset:0 nt lds
  buffer_load_dwordx4 v245, s[36:39], s101 offen offset:1024 nt lds
  buffer_load_dwordx4 v246, s[36:39], s101 offen offset:2048 nt lds
  buffer_load_dwordx4 v247, s[36:39], s101 offen offset:3072 nt lds
  s_cmp_ge_u32 s3, 4
  s_cbranch_scc1 L_back
  s_barrier
  s_branch L_setup
L_K2:
  s_mov_b32 s54, 0x05040100
  s_mov_b32 s55, 0x07060302
  s_mov_b32 s56, 0x0c0c0400
  s_mov_b32 s57, 0x0c040100
  s_mov_b32 s58, 0x04020100
  s_mov_b32 s53, 0x10001
  v_mov_b32 v2, 0xffffff00
  s_lshr_b32 s77, s2, 5
  s_and_b32 s78, s2, 127
  s_and_b32 s76, s2, 7
  s_lshl_b32 s76, s76, 2
  s_bfe_u32 s97, s2, 0x20003
  s_add_u32 s76, s76, s97
  s_and_b32 s79, s2, 7
  s_lshl_b32 s79, s79, 1
  s_bfe_u32 s97, s2, 0x10003
  s_add_u32 s79, s79, s97
  s_bfe_u32 s80, s2, 0x30004
  s_bfe_u32 s17, s2, 0x20003
  s_bfe_u32 s59, s2, 0x10004
  s_lshl_b32 s59, s59, 14
  v_lshrrev_b32 v245, 4, v1
  v_and_b32 v246, 15, v1
  v_lshlrev_b32 v247, 2, v245
  v_xor_b32 v246, v246, v247
  v_lshlrev_b32 v246, 4, v246
  v_lshl_add_u32 v244, v245, 10, v246
  v_xor_b32 v245, 16, v244
  v_xor_b32 v246, 32, v244
  v_xor_b32 v247, 48, v244
  v_add_u32 v245, 3072, v245
  v_add_u32 v246, 6144, v246
  v_add_u32 v247, 9216, v247
  s_and_b32 s91, s3, 3
  s_lshl_b32 s90, s91, 15
  s_lshl_b32 s91, s91, 13
  s_lshl_b32 s92, s2, 17
  s_add_u32 s90, s90, s92
  s_bfe_u32 s93, s2, 0x20003
  s_lshl_b32 s92, s93, 15
  s_add_u32 s91, s91, s92
  s_lshl_b32 s92, s93, 8
  s_add_u32 s90, s90, s92
  s_mov_b64 s[36:37], s[6:7]
  s_mov_b32 s38, 0x2000000
  s_mov_b32 s39, 0x20000
  s_barrier
  s_lshr_b32 s92, s3, 2
  s_lshl_b32 s93, s92, 12
  s_xor_b32 s93, s93, 0
  s_xor_b32 m0, s91, s93
  s_lshl_b32 s93, s92, 14
  s_xor_b32 s93, s93, 0
  s_xor_b32 s101, s90, s93
  buffer_load_dwordx4 v244, s[36:39], s101 offen offset:0 nt lds
  buffer_load_dwordx4 v245, s[36:39], s101 offen offset:1024 nt lds
  buffer_load_dwordx4 v246, s[36:39], s101 offen offset:2048 nt lds
  buffer_load_dwordx4 v247, s[36:39], s101 offen offset:3072 nt lds
  s_lshr_b32 s92, s3, 2
  s_lshl_b32 s93, s92, 12
  s_xor_b32 s93, s93, 32768
  s_xor_b32 m0, s91, s93
  s_lshl_b32 s93, s92, 14
  s_xor_b32 s93, s93, 256
  s_xor_b32 s101, s90, s93
  buffer_load_dwordx4 v244, s[36:39], s101 offen offset:0 nt lds
  buffer_load_dwordx4 v245, s[36:39], s101 offen offset:1024 nt lds
  buffer_load_dwordx4 v246, s[36:39], s101 offen offset:2048 nt lds
  buffer_load_dwordx4 v247, s[36:39], s101 offen offset:3072 nt lds
  s_and_b32 s92, s3, 1
  s_lshl_b32 s92, s92, 15
  s_lshr_b32 s97, s3, 1
  s_lshl_b32 s97, s97, 8
  s_add_u32 s92, s92, s97
  s_add_u32 s92, s92, s81
  v_and_b32 v45, 15, v1
  v_mul_u32_u24 v45, 1040, v45
  v_add_u32 v45, s92, v45
  v_lshrrev_b32 v34, 4, v1
  v_lshlrev_b32 v34, 4, v34
  v_xor_b32 v45, v45, v34
  v_lshrrev_b32 v37, 4, v1
  v_lshlrev_b32 v37, 11, v37
  v_and_b32 v3, 15, v1
  v_lshl_add_u32 v37, v3, 4, v37
  s_and_b32 s83, s2, 7
  s_lshl_b32 s83, s83, 14
  s_lshl_b32 s97, s3, 8
  s_add_u32 s83, s83, s97
  s_add_u32 s83, s83, 0x80000
  s_add_u32 s85, s83, 8192
  s_lshl_b32 s92, s3, 7
  s_add_u32 s92, s92, 0x21000
  v_and_b32 v47, 15, v1
  v_lshlrev_b32 v47, 3, v47
  v_lshrrev_b32 v3, 4, v1
  v_lshl_add_u32 v47, v3, 1, v47
  v_add_u32 v47, s92, v47
  s_lshr_b32 s92, s3, 1
  s_lshl_b32 s92, s92, 8
  s_add_u32 s92, s92, 0x21000
  v_lshrrev_b32 v35, 4, v1
  v_lshlrev_b32 v35, 4, v35
  v_add_u32 v35, s92, v35
  v_bfe_u32 v39, v1, 4, 1
  v_lshlrev_b32 v39, 5, v39
  v_lshrrev_b32 v3, 5, v1
  v_lshl_add_u32 v39, v3, 4, v39
  s_and_b32 s84, s2, 7
  s_lshl_b32 s84, s84, 12
  s_lshr_b32 s97, s3, 1
  s_lshl_b32 s97, s97, 10
  s_add_u32 s84, s84, s97
  s_bfe_u32 s97, s2, 0x30003
  s_lshl_b32 s97, s97, 7
  s_add_u32 s84, s84, s97
  s_and_b32 s97, s3, 1
  s_lshl_b32 s97, s97, 6
  s_add_u32 s84, s84, s97
  s_add_u32 s84, s84, 0x10000
  s_waitcnt vmcnt(8)
  s_barrier
  v_xor_b32 v32, 0, v45
  ds_read_b128 v[112:115], v32 offset:0
  v_xor_b32 v33, 64, v45
  ds_read_b128 v[116:119], v33 offset:0
  v_xor_b32 v32, 128, v45
  ds_read_b128 v[120:123], v32 offset:0
  v_xor_b32 v33, 192, v45
  ds_read_b128 v[124:127], v33 offset:0
  v_xor_b32 v32, 0, v45
  ds_read_b128 v[128:131], v32 offset:16384
  v_xor_b32 v33, 64, v45
  ds_read_b128 v[132:135], v33 offset:16384
  v_xor_b32 v32, 128, v45
  ds_read_b128 v[136:139], v32 offset:16384
  v_xor_b32 v33, 192, v45
  ds_read_b128 v[140:143], v33 offset:16384
  s_waitcnt lgkmcnt(0)
  s_barrier
  s_mov_b32 s100, 0
  v_mov_b32 v253, 0
L_ep_8:
  global_load_dword v252, v253, s[30:31] sc1
  s_add_u32 s100, s100, 1
  s_cmp_gt_u32 s100, 1000000
  s_cbranch_scc1 L_abort
  s_waitcnt vmcnt(0)
L_epc_9:
  v_readfirstlane_b32 s48, v252
  s_nop 0
  s_cmp_eq_u32 s48, 0
  s_nop 1
  s_cbranch_scc1 L_ep_8
  s_mul_i32 s48, s48, 0x9e3779b1
  s_and_b32 s49, s48, 0xff
  s_bfe_u32 s50, s48, 0x80008
  s_bfe_u32 s51, s48, 0x80010
  s_lshr_b32 s52, s48, 24
  s_lshr_b32 s97, s48, 15
  s_xor_b32 s97, s97, s48
  s_mul_i32 s97, s97, 0x85ebca6b
  v_mov_b32 v4, s48
  v_mov_b32 v5, s97
  v_mov_b32 v249, s48
  v_mov_b32 v250, s97
  v_and_b32 v6, 4, v1
  v_cmp_eq_u32 vcc, 0, v6
  v_and_b32 v7, 3, v1
  v_lshlrev_b32 v7, 2, v7
  v_cndmask_b32 v4, v5, v4, vcc
  v_lshrrev_b32 v4, v7, v4
  v_lshrrev_b32 v5, 1, v4
  v_lshrrev_b32 v6, 2, v4
  v_lshrrev_b32 v7, 3, v4
  s_and_b32 s92, s3, 1
  s_sub_u32 s74, 0, s92
  s_mov_b32 s75, s74
  v_bfe_u32 v28, v1, 4, 1
  v_lshlrev_b32 v28, 3, v28
  v_lshrrev_b32 v3, 5, v1
  v_lshl_add_u32 v28, v3, 2, v28
  v_mov_b32 v68, s48
  v_mov_b32 v69, s97
  v_cndmask_b32 v68, v68, v69, s[74:75]
  v_lshrrev_b32 v68, v28, v68
  v_lshrrev_b32 v69, 1, v68
  v_lshrrev_b32 v70, 2, v68
  v_lshrrev_b32 v71, 3, v68
  s_mov_b64 s[60:61], -1
  s_mov_b64 s[62:63], -1
  s_mov_b32 s100, 0
  s_branch L_gf_11
L_g_10:
  s_add_u32 s100, s100, 1
  s_cmp_gt_u32 s100, 1000000
  s_cbranch_scc1 L_abort
  s_sleep 2
L_gf_11:
  s_mov_b64 exec, s[60:61]
  s_cbranch_execz L_gs_13
  buffer_load_dwordx4 v[20:23], v37, s[32:35], s83 offen offset:0 sc1
L_gs_13:
  s_mov_b64 exec, s[62:63]
  s_cbranch_execz L_gs_14
  buffer_load_dwordx4 v[24:27], v37, s[32:35], s85 offen offset:0 sc1
L_gs_14:
  s_waitcnt vmcnt(0)
L_gc_12:
  s_mov_b64 exec, s[60:61]
  v_perm_b32 v92, v21, v20, s56
  v_perm_b32 v92, v22, v92, s57
  v_perm_b32 v92, v23, v92, s58
  v_cmp_ne_u32 s[60:61], s48, v92
  s_mov_b64 exec, s[62:63]
  v_perm_b32 v92, v25, v24, s56
  v_perm_b32 v92, v26, v92, s57
  v_perm_b32 v92, v27, v92, s58
  v_cmp_ne_u32 s[62:63], s48, v92
  s_nop 0
  s_or_b64 s[96:97], s[60:61], s[62:63]
  s_cbranch_scc1 L_g_10
  s_mov_b64 exec, -1
  v_add_f32 v20, v20, v24
  v_add_f32 v21, v21, v25
  v_add_f32 v22, v22, v26
  v_add_f32 v23, v23, v27
  s_nop 0
  v_permlane32_swap_b32 v20, v22
  v_permlane32_swap_b32 v21, v23
  v_add_f32 v20, v20, v22
  v_add_f32 v21, v21, v23
  s_nop 1
  v_permlane16_swap_b32 v20, v21
  v_add_f32 v20, v20, v21
  v_cvt_pk_bf16_f32 v20, v20, v20
  ds_write_b16 v47, v20
  s_waitcnt lgkmcnt(0)
  s_barrier
  ds_read_b128 v[52:55], v35 offset:0
  ds_read_b128 v[56:59], v35 offset:64
  ds_read_b128 v[60:63], v35 offset:128
  ds_read_b128 v[64:67], v35 offset:192
  s_waitcnt lgkmcnt(3)
  v_mfma_f32_16x16x32_bf16 v[80:83], v[112:115], v[52:55], 0
  v_mfma_f32_16x16x32_bf16 v[84:87], v[128:131], v[52:55], 0
  s_waitcnt lgkmcnt(2)
  v_mfma_f32_16x16x32_bf16 v[80:83], v[116:119], v[56:59], v[80:83]
  v_mfma_f32_16x16x32_bf16 v[84:87], v[132:135], v[56:59], v[84:87]
  s_waitcnt lgkmcnt(1)
  v_mfma_f32_16x16x32_bf16 v[80:83], v[120:123], v[60:63], v[80:83]
  v_mfma_f32_16x16x32_bf16 v[84:87], v[136:139], v[60:63], v[84:87]
  s_waitcnt lgkmcnt(0)
  v_mfma_f32_16x16x32_bf16 v[80:83], v[124:127], v[64:67], v[80:83]
  v_mfma_f32_16x16x32_bf16 v[84:87], v[140:143], v[64:67], v[84:87]
  s_nop 6
  v_mul_f32 v80, 0x3e0293ee, v80
  v_mul_f32 v81, 0x3e0293ee, v81
  v_mul_f32 v82, 0x3e0293ee, v82
  v_mul_f32 v83, 0x3e0293ee, v83
  v_mul_f32 v84, 0x3e0293ee, v84
  v_mul_f32 v85, 0x3e0293ee, v85
  v_mul_f32 v86, 0x3e0293ee, v86
  v_mul_f32 v87, 0x3e0293ee, v87
  v_cvt_pk_bf16_f32 v20, v80, v81
  v_cvt_pk_bf16_f32 v21, v82, v83
  v_cvt_pk_bf16_f32 v22, v84, v85
  v_cvt_pk_bf16_f32 v23, v86, v87
  s_nop 0
  v_permlane16_swap_b32 v20, v22
  v_permlane16_swap_b32 v21, v23
  v_bfi_b32 v20, s53, v68, v20
  v_bfi_b32 v21, s53, v69, v21
  v_bfi_b32 v22, s53, v70, v22
  v_bfi_b32 v23, s53, v71, v23
  s_mov_b32 exec_lo, 0x10001
  s_mov_b32 exec_hi, 0x10001
  buffer_store_dwordx4 v[20:23], v39, s[32:35], s84 offen sc1
  s_mov_b64 exec, -1
  s_barrier
  s_lshr_b32 s92, s3, 2
  s_lshl_b32 s93, s92, 12
  s_xor_b32 s93, s93, 65536
  s_xor_b32 m0, s91, s93
  s_lshl_b32 s93, s92, 14
  s_xor_b32 s93, s93, 512
  s_xor_b32 s101, s90, s93
  buffer_load_dwordx4 v244, s[36:39], s101 offen offset:0 nt lds
  buffer_load_dwordx4 v245, s[36:39], s101 offen offset:1024 nt lds
  buffer_load_dwordx4 v246, s[36:39], s101 offen offset:2048 nt lds
  buffer_load_dwordx4 v247, s[36:39], s101 offen offset:3072 nt lds
  s_lshr_b32 s92, s3, 2
  s_lshl_b32 s93, s92, 12
  s_xor_b32 s93, s93, 98304
  s_xor_b32 m0, s91, s93
  s_lshl_b32 s93, s92, 14
  s_xor_b32 s93, s93, 768
  s_xor_b32 s101, s90, s93
  buffer_load_dwordx4 v244, s[36:39], s101 offen offset:0 nt lds
  buffer_load_dwordx4 v245, s[36:39], s101 offen offset:1024 nt lds
  buffer_load_dwordx4 v246, s[36:39], s101 offen offset:2048 nt lds
  buffer_load_dwordx4 v247, s[36:39], s101 offen offset:3072 nt lds
  s_cmp_ge_u32 s3, 4
  s_cbranch_scc0 L_kf
  s_branch L_back
L_kf:
  s_barrier
  s_branch L_setup
L_Bback2:
  s_mov_b32 s54, 0x05040100
  s_mov_b32 s55, 0x07060302
  s_mov_b32 s56, 0x0c0c0400
  s_mov_b32 s57, 0x0c040100
  s_mov_b32 s58, 0x04020100
  s_mov_b32 s53, 0x10001
  v_mov_b32 v2, 0xffffff00
  s_lshr_b32 s77, s2, 5
  s_and_b32 s78, s2, 127
  s_and_b32 s76, s2, 7
  s_lshl_b32 s76, s76, 2
  s_bfe_u32 s97, s2, 0x20003
  s_add_u32 s76, s76, s97
  s_and_b32 s79, s2, 7
  s_lshl_b32 s79, s79, 1
  s_bfe_u32 s97, s2, 0x10003
  s_add_u32 s79, s79, s97
  s_bfe_u32 s80, s2, 0x30004
  s_bfe_u32 s17, s2, 0x20003
  s_bfe_u32 s59, s2, 0x10004
  s_lshl_b32 s59, s59, 14
  s_lshl_b32 s81, s95, 2
  s_add_u32 s81, s81, s94
  s_lshl_b32 s81, s81, 8
  s_add_u32 s81, s81, 0
  v_and_b32 v8, 7, v1
  v_lshlrev_b32 v8, 2, v8
  v_lshrrev_b32 v9, 4, v1
  v_add_u32 v8, v8, v9
  v_lshlrev_b32 v8, 5, v8
  s_lshl_b32 s92, s3, 2
  s_add_u32 s92, s92, 139248
  v_add_u32 v8, s92, v8
  v_lshlrev_b32 v9, 6, v1
  v_add_u32 v9, 139264, v9
  v_lshlrev_b32 v10, 4, v1
  s_bitcmp1_b32 s2, 6
  s_cbranch_scc1 L_nou0b
  s_waitcnt vmcnt(4)
  v_mov_b32 v253, 0
  global_load_dword v252, v253, s[30:31] sc1
  v_lshlrev_b32 v120, 16, v112
  v_and_b32 v121, 0xffff0000, v112
  v_lshlrev_b32 v122, 16, v113
  v_and_b32 v123, 0xffff0000, v113
  v_mul_f32 v116, 0xbfb8aa3b, v120
  v_mul_f32 v117, 0xbfb8aa3b, v121
  v_mul_f32 v118, 0xbfb8aa3b, v122
  v_mul_f32 v119, 0xbfb8aa3b, v123
  v_exp_f32 v116, v116
  v_exp_f32 v117, v117
  v_exp_f32 v118, v118
  v_exp_f32 v119, v119
  v_add_f32 v116, 1.0, v116
  v_add_f32 v117, 1.0, v117
  v_add_f32 v118, 1.0, v118
  v_add_f32 v119, 1.0, v119
  v_rcp_f32 v116, v116
  v_rcp_f32 v117, v117
  v_rcp_f32 v118, v118
  v_rcp_f32 v119, v119
  v_mul_f32 v120, v120, v116
  v_mul_f32 v121, v121, v117
  v_mul_f32 v122, v122, v118
  v_mul_f32 v123, v123, v119
  v_cvt_pk_bf16_f32 v120, v120, v120
  v_cvt_pk_bf16_f32 v121, v121, v121
  v_cvt_pk_bf16_f32 v122, v122, v122
  v_cvt_pk_bf16_f32 v123, v123, v123
  v_lshrrev_b32 v116, 16, v120
  v_lshrrev_b32 v117, 16, v121
  v_lshrrev_b32 v118, 16, v122
  v_lshrrev_b32 v119, 16, v123
  v_and_b32 v120, 0xffff0000, v120
  v_and_b32 v121, 0xffff0000, v121
  v_and_b32 v122, 0xffff0000, v122
  v_and_b32 v123, 0xffff0000, v123
  v_mov_b32 v96, 0
  v_mov_b32 v97, 0
  v_mov_b32 v98, 0
  v_mov_b32 v99, 0
  v_mov_b32 v100, 0
  v_mov_b32 v101, 0
  v_mov_b32 v102, 0
  v_mov_b32 v103, 0
  s_waitcnt vmcnt(4)
  v_dot2c_f32_bf16 v96, v116, v124
  v_dot2c_f32_bf16 v97, v120, v124
  v_dot2c_f32_bf16 v98, v116, v125
  v_dot2c_f32_bf16 v99, v120, v125
  v_dot2c_f32_bf16 v100, v116, v126
  v_dot2c_f32_bf16 v101, v120, v126
  v_dot2c_f32_bf16 v102, v116, v127
  v_dot2c_f32_bf16 v103, v120, v127
  s_waitcnt vmcnt(3)
  v_dot2c_f32_bf16 v96, v117, v128
  v_dot2c_f32_bf16 v97, v121, v128
  v_dot2c_f32_bf16 v98, v117, v129
  v_dot2c_f32_bf16 v99, v121, v129
  v_dot2c_f32_bf16 v100, v117, v130
  v_dot2c_f32_bf16 v101, v121, v130
  v_dot2c_f32_bf16 v102, v117, v131
  v_dot2c_f32_bf16 v103, v121, v131
  s_waitcnt vmcnt(2)
  v_dot2c_f32_bf16 v96, v118, v132
  v_dot2c_f32_bf16 v97, v122, v132
  v_dot2c_f32_bf16 v98, v118, v133
  v_dot2c_f32_bf16 v99, v122, v133
  v_dot2c_f32_bf16 v100, v118, v134
  v_dot2c_f32_bf16 v101, v122, v134
  v_dot2c_f32_bf16 v102, v118, v135
  v_dot2c_f32_bf16 v103, v122, v135
  s_waitcnt vmcnt(1)
  v_dot2c_f32_bf16 v96, v119, v136
  v_dot2c_f32_bf16 v97, v123, v136
  v_dot2c_f32_bf16 v98, v119, v137
  v_dot2c_f32_bf16 v99, v123, v137
  v_dot2c_f32_bf16 v100, v119, v138
  v_dot2c_f32_bf16 v101, v123, v138
  v_dot2c_f32_bf16 v102, v119, v139
  v_dot2c_f32_bf16 v103, v123, v139
  v_permlane32_swap_b32 v96, v100
  v_permlane32_swap_b32 v97, v101
  v_permlane32_swap_b32 v98, v102
  v_permlane32_swap_b32 v99, v103
  v_add_f32 v96, v96, v100
  v_add_f32 v97, v97, v101
  v_add_f32 v98, v98, v102
  v_add_f32 v99, v99, v103
  s_nop 0
  v_permlane16_swap_b32 v96, v98
  v_permlane16_swap_b32 v97, v99
  v_add_f32 v96, v96, v98
  v_add_f32 v97, v97, v99
  s_nop 0
  v_add_f32_dpp v96, v96, v96 row_ror:8 row_mask:0xf bank_mask:0xf
  v_add_f32_dpp v97, v97, v97 row_ror:8 row_mask:0xf bank_mask:0xf
  s_mov_b32 s100, 0
  s_waitcnt vmcnt(0)
  s_branch L_epc_16
L_ep_15:
  global_load_dword v252, v253, s[30:31] sc1
  s_add_u32 s100, s100, 1
  s_cmp_gt_u32 s100, 1000000
  s_cbranch_scc1 L_abort
  s_waitcnt vmcnt(0)
L_epc_16:
  v_readfirstlane_b32 s48, v252
  s_nop 0
  s_cmp_eq_u32 s48, 0
  s_nop 1
  s_cbranch_scc1 L_ep_15
  s_mul_i32 s48, s48, 0x9e3779b1
  s_and_b32 s49, s48, 0xff
  s_bfe_u32 s50, s48, 0x80008
  s_bfe_u32 s51, s48, 0x80010
  s_lshr_b32 s52, s48, 24
  ds_write2_b32 v8, v96, v97 offset0:0 offset1:4
  s_waitcnt lgkmcnt(0)
  s_barrier
  s_cmp_lg_u32 s3, 4
  s_cbranch_scc1 L_nopub_17
  s_mov_b64 exec, 0xffff
  ds_read_b128 v[124:127], v9 offset:0
  ds_read_b128 v[128:131], v9 offset:16
  ds_read_b128 v[132:135], v9 offset:32
  ds_read_b128 v[136:139], v9 offset:48
  s_waitcnt lgkmcnt(3)
  v_add_f32 v124, v124, v125
  v_add_f32 v126, v126, v127
  v_add_f32 v124, v124, v126
  s_waitcnt lgkmcnt(2)
  v_add_f32 v128, v128, v129
  v_add_f32 v130, v130, v131
  v_add_f32 v128, v128, v130
  s_waitcnt lgkmcnt(1)
  v_add_f32 v132, v132, v133
  v_add_f32 v134, v134, v135
  v_add_f32 v132, v132, v134
  s_waitcnt lgkmcnt(0)
  v_add_f32 v136, v136, v137
  v_add_f32 v138, v138, v139
  v_add_f32 v136, v136, v138
  v_and_or_b32 v100, v124, v2, s49
  v_and_or_b32 v101, v128, v2, s50
  v_and_or_b32 v102, v132, v2, s51
  v_and_or_b32 v103, v136, v2, s52
  buffer_store_dwordx4 v[100:103], v10, s[32:35], s81 offen sc1
L_nopub_17:
  s_mov_b64 exec, -1
  s_barrier
  s_branch L_nou0c
L_nou0b:
  v_lshlrev_b32 v12, 7, v1
  v_lshlrev_b32 v14, 9, v1
  s_bfe_u32 s93, s2, 0x30003
  s_and_b32 s94, s2, 7
  s_cmp_lg_u32 s3, 4
  s_cbranch_scc1 L_ew5
  s_mov_b32 exec_hi, 0
  s_lshl_b32 s92, s93, 12
  s_add_u32 s92, s92, 0x10000
  buffer_load_dword v254, v12, s[32:35], s92 offen sc1
  s_lshl_b32 s92, s93, 14
  s_lshr_b32 s97, s94, 1
  s_lshl_b32 s97, s97, 7
  s_add_u32 s92, s92, s97
  s_add_u32 s92, s92, 0x20000
  buffer_load_dword v254, v14, s[32:35], s92 offen sc1
  s_mov_b32 exec_lo, 0xffff
  s_lshl_b32 s92, s94, 14
  s_lshl_b32 s97, s93, 11
  s_add_u32 s92, s92, s97
  s_add_u32 s92, s92, 0x80000
  buffer_load_dword v254, v12, s[32:35], s92 offen sc1
  s_lshl_b32 s92, s93, 11
  s_add_u32 s92, s92, 0x18000
  buffer_load_dword v254, v12, s[32:35], s92 offen sc1
  s_branch L_ewx
L_ew5:
  s_cmp_lg_u32 s3, 7
  s_cbranch_scc0 L_ew7
  s_mov_b32 exec_hi, 0
  s_lshl_b32 s95, s93, 4
  s_lshl_b32 s97, s3, 3
  s_add_u32 s95, s95, s97
  s_add_u32 s95, s95, s94
  s_add_u32 s95, s95, 0xffffffd8
  s_sub_u32 s96, s95, 56
  s_cmp_ge_u32 s95, 56
  s_cselect_b32 s95, s96, s95
  s_lshl_b32 s92, s95, 12
  s_add_u32 s92, s92, 0xd0000
  buffer_load_dword v254, v12, s[32:35], s92 offen sc1
  s_branch L_ewx
L_ew7:
  s_cmp_ge_u32 s93, 4
  s_cbranch_scc1 L_ew7b
  s_mov_b32 exec_hi, 0
  s_lshl_b32 s92, s94, 14
  s_lshl_b32 s97, s93, 12
  s_add_u32 s92, s92, s97
  s_add_u32 s92, s92, 0x40000
  buffer_load_dword v254, v12, s[32:35], s92 offen sc1
  s_branch L_ewx
L_ew7b:
  s_bitcmp1_b32 s93, 1
  s_cbranch_scc1 L_ew7c
  s_mov_b32 exec_hi, 0
  s_mul_i32 s92, s94, 8448
  s_and_b32 s97, s93, 1
  s_mul_i32 s97, s97, 4224
  s_add_u32 s92, s92, s97
  s_add_u32 s92, s92, 0x60000
  buffer_load_dword v254, v12, s[32:35], s92 offen sc1
  s_branch L_ewx
L_ew7c:
  s_mul_i32 s92, s94, 16896
  s_and_b32 s97, s93, 1
  s_mul_i32 s97, s97, 8448
  s_add_u32 s92, s92, s97
  s_add_u32 s92, s92, 0xa0000
  buffer_load_dword v254, v12, s[32:35], s92 offen sc1
L_ewx:
  s_mov_b64 exec, -1
  s_barrier
  s_barrier
  s_mov_b32 s100, 0
  v_mov_b32 v253, 0
L_ep_18:
  global_load_dword v252, v253, s[30:31] sc1
  s_add_u32 s100, s100, 1
  s_cmp_gt_u32 s100, 1000000
  s_cbranch_scc1 L_abort
  s_waitcnt vmcnt(0)
L_epc_19:
  v_readfirstlane_b32 s48, v252
  s_nop 0
  s_cmp_eq_u32 s48, 0
  s_nop 1
  s_cbranch_scc1 L_ep_18
  s_mul_i32 s48, s48, 0x9e3779b1
  s_and_b32 s49, s48, 0xff
  s_bfe_u32 s50, s48, 0x80008
  s_bfe_u32 s51, s48, 0x80010
  s_lshr_b32 s52, s48, 24
L_nou0c:
  s_lshr_b32 s97, s48, 15
  s_xor_b32 s97, s97, s48
  s_mul_i32 s97, s97, 0x85ebca6b
  v_mov_b32 v4, s48
  v_mov_b32 v5, s97
  v_mov_b32 v249, s48
  v_mov_b32 v250, s97
  v_and_b32 v6, 4, v1
  v_cmp_eq_u32 vcc, 0, v6
  v_and_b32 v7, 3, v1
  v_lshlrev_b32 v7, 2, v7
  v_cndmask_b32 v4, v5, v4, vcc
  v_lshrrev_b32 v4, v7, v4
  v_lshrrev_b32 v5, 1, v4
  v_lshrrev_b32 v6, 2, v4
  v_lshrrev_b32 v7, 3, v4
  v_lshrrev_b32 v245, 4, v1
  v_and_b32 v246, 15, v1
  v_lshlrev_b32 v247, 2, v245
  v_xor_b32 v246, v246, v247
  v_lshlrev_b32 v246, 4, v246
  v_lshl_add_u32 v244, v245, 10, v246
  v_xor_b32 v245, 16, v244
  v_xor_b32 v246, 32, v244
  v_xor_b32 v247, 48, v244
  v_add_u32 v245, 3072, v245
  v_add_u32 v246, 6144, v246
  v_add_u32 v247, 9216, v247
  s_and_b32 s91, s3, 3
  s_lshl_b32 s90, s91, 15
  s_lshl_b32 s91, s91, 13
  s_lshl_b32 s92, s2, 17
  s_add_u32 s90, s90, s92
  s_bfe_u32 s93, s2, 0x20003
  s_lshl_b32 s92, s93, 15
  s_add_u32 s91, s91, s92
  s_lshl_b32 s92, s93, 8
  s_add_u32 s90, s90, s92
  s_mov_b64 s[36:37], s[6:7]
  s_mov_b32 s38, 0x2000000
  s_mov_b32 s39, 0x20000
  v_lshlrev_b32 v12, 21, v1
  v_add_u32 v12, 0xf000, v12
  s_mov_b64 exec, 0x3f
  buffer_load_dword v254, v12, s[32:35], 0 offen
  s_mov_b64 exec, -1
  s_and_b32 s81, s3, 3
  s_lshl_b32 s81, s81, 13
  s_add_u32 s81, s81, 0x10000
  v_lshlrev_b32 v8, 4, v1
  s_add_u32 s82, s81, 4096
  v_lshrrev_b32 v9, 4, v1
  v_lshlrev_b32 v9, 13, v9
  v_and_b32 v3, 15, v1
  v_lshl_add_u32 v9, v3, 4, v9
  s_and_b32 s93, s3, 3
  s_lshl_b32 s93, s93, 11
  s_and_b32 s97, s3, 1
  s_lshl_b32 s97, s97, 5
  s_add_u32 s93, s93, s97
  s_add_u32 s93, s93, 0x20000
  v_xor_b32 v9, s93, v9
  s_xor_b32 m0, s91, 4096
  s_xor_b32 s101, s90, 16384
  buffer_load_dwordx4 v244, s[36:39], s101 offen offset:0 nt lds
  s_waitcnt vmcnt(0)
  buffer_load_dwordx4 v245, s[36:39], s101 offen offset:1024 nt lds
  s_waitcnt vmcnt(2)
  buffer_load_dwordx4 v246, s[36:39], s101 offen offset:2048 nt lds
  s_waitcnt vmcnt(2)
  buffer_load_dwordx4 v247, s[36:39], s101 offen offset:3072 nt lds
  s_waitcnt vmcnt(2)
  s_xor_b32 m0, s91, 36864
  s_xor_b32 s101, s90, 16640
  buffer_load_dwordx4 v244, s[36:39], s101 offen offset:0 nt lds
  s_waitcnt vmcnt(2)
  buffer_load_dwordx4 v245, s[36:39], s101 offen offset:1024 nt lds
  s_waitcnt vmcnt(2)
  buffer_load_dwordx4 v246, s[36:39], s101 offen offset:2048 nt lds
  s_waitcnt vmcnt(2)
  buffer_load_dwordx4 v247, s[36:39], s101 offen offset:3072 nt lds
  s_waitcnt vmcnt(2)
  s_xor_b32 m0, s91, 69632
  s_xor_b32 s101, s90, 16896
  buffer_load_dwordx4 v244, s[36:39], s101 offen offset:0 nt lds
  buffer_load_dwordx4 v245, s[36:39], s101 offen offset:1024 nt lds
  buffer_load_dwordx4 v246, s[36:39], s101 offen offset:2048 nt lds
  buffer_load_dwordx4 v247, s[36:39], s101 offen offset:3072 nt lds
  s_xor_b32 m0, s91, 102400
  s_xor_b32 s101, s90, 17152
  buffer_load_dwordx4 v244, s[36:39], s101 offen offset:0 nt lds
  buffer_load_dwordx4 v245, s[36:39], s101 offen offset:1024 nt lds
  buffer_load_dwordx4 v246, s[36:39], s101 offen offset:2048 nt lds
  buffer_load_dwordx4 v247, s[36:39], s101 offen offset:3072 nt lds
  s_mov_b64 s[40:41], s[26:27]
  s_mov_b32 s42, 0x300000
  s_mov_b32 s43, 0x20000
  v_lshrrev_b32 v13, 3, v1
  v_mul_u32_u24 v13, 24576, v13
  v_and_b32 v3, 7, v1
  v_lshl_add_u32 v13, v3, 4, v13
  s_lshr_b32 s94, s78, 5
  s_lshl_b32 s94, s94, 2
  s_and_b32 s97, s3, 3
  s_add_u32 s94, s94, s97
  s_lshl_b32 s95, s94, 6
  v_lshrrev_b32 v14, 3, v1
  v_lshlrev_b32 v14, 3, v14
  v_add_u32 v14, s95, v14
  s_mul_i32 s92, s94, 196608
  s_and_b32 s97, s2, 31
  s_lshl_b32 s97, s97, 7
  s_add_u32 s92, s92, s97
  s_add_u32 s92, s92, 0x800
  global_load_dwordx2 v[144:145], v14, s[24:25]
  buffer_load_dwordx4 v[128:131], v13, s[40:43], s92 offen nt
  s_add_u32 s92, s92, 6144
  buffer_load_dwordx4 v[132:135], v13, s[40:43], s92 offen nt
  s_add_u32 s92, s92, 6144
  buffer_load_dwordx4 v[136:139], v13, s[40:43], s92 offen nt
  s_add_u32 s92, s92, 6144
  buffer_load_dwordx4 v[140:143], v13, s[40:43], s92 offen nt
  v_lshrrev_b32 v253, 4, v1
  v_lshlrev_b32 v253, 13, v253
  v_and_b32 v3, 15, v1
  v_lshl_add_u32 v253, v3, 4, v253
  s_lshl_b32 s88, s77, 19
  s_bfe_u32 s97, s3, 0x10001
  s_lshl_b32 s97, s97, 18
  s_add_u32 s88, s88, s97
  s_and_b32 s97, s3, 1
  s_lshl_b32 s97, s97, 15
  s_add_u32 s88, s88, s97
  s_lshl_b32 s97, s76, 8
  s_add_u32 s88, s88, s97
  v_lshrrev_b32 v251, 5, v1
  v_mul_u32_u24 v251, 3584, v251
  v_and_b32 v3, 31, v1
  v_lshl_add_u32 v251, v3, 4, v251
  s_mul_i32 s89, s79, 114688
  s_and_b32 s97, s3, 3
  s_mul_i32 s97, s97, 28672
  s_add_u32 s89, s89, s97
  s_mul_i32 s97, s80, 448
  s_add_u32 s89, s89, s97
  s_barrier
  s_branch L_back1
L_back:
  v_lshlrev_b32 v12, 21, v1
  v_add_u32 v12, 0xf000, v12
  s_mov_b64 exec, 0x3f
  buffer_load_dword v254, v12, s[32:35], 0 offen
  s_mov_b64 exec, -1
  s_and_b32 s81, s3, 3
  s_lshl_b32 s81, s81, 13
  s_add_u32 s81, s81, 0x10000
  v_lshlrev_b32 v8, 4, v1
  s_add_u32 s82, s81, 4096
  v_lshrrev_b32 v9, 4, v1
  v_lshlrev_b32 v9, 13, v9
  v_and_b32 v3, 15, v1
  v_lshl_add_u32 v9, v3, 4, v9
  s_and_b32 s93, s3, 3
  s_lshl_b32 s93, s93, 11
  s_and_b32 s97, s3, 1
  s_lshl_b32 s97, s97, 5
  s_add_u32 s93, s93, s97
  s_add_u32 s93, s93, 0x20000
  v_xor_b32 v9, s93, v9
  v_lshrrev_b32 v253, 4, v1
  v_lshlrev_b32 v253, 13, v253
  v_and_b32 v3, 15, v1
  v_lshl_add_u32 v253, v3, 4, v253
  s_lshl_b32 s88, s77, 19
  s_bfe_u32 s97, s3, 0x10001
  s_lshl_b32 s97, s97, 18
  s_add_u32 s88, s88, s97
  s_and_b32 s97, s3, 1
  s_lshl_b32 s97, s97, 15
  s_add_u32 s88, s88, s97
  s_lshl_b32 s97, s76, 8
  s_add_u32 s88, s88, s97
  v_lshrrev_b32 v251, 4, v1
  v_lshlrev_b32 v251, 10, v251
  v_and_b32 v3, 15, v1
  v_lshl_add_u32 v251, v3, 4, v251
  s_lshl_b32 s89, s76, 17
  s_and_b32 s97, s3, 3
  s_lshl_b32 s97, s97, 15
  s_add_u32 s89, s89, s97
  s_lshl_b32 s97, s77, 8
  s_add_u32 s89, s89, s97
  s_barrier
L_back1:
  buffer_load_dwordx4 v[48:51], v8, s[32:35], s81 offen offset:0 sc1
  buffer_load_dwordx4 v[52:55], v8, s[32:35], s81 offen offset:1024 sc1
  buffer_load_dwordx4 v[56:59], v8, s[32:35], s81 offen offset:2048 sc1
  buffer_load_dwordx4 v[60:63], v8, s[32:35], s81 offen offset:3072 sc1
  buffer_load_dwordx4 v[64:67], v8, s[32:35], s82 offen offset:0 sc1
  buffer_load_dwordx4 v[68:71], v8, s[32:35], s82 offen offset:1024 sc1
  buffer_load_dwordx4 v[72:75], v8, s[32:35], s82 offen offset:2048 sc1
  buffer_load_dwordx4 v[76:79], v8, s[32:35], s82 offen offset:3072 sc1
  s_branch L_setup
L_back2:
  s_mov_b64 s[60:61], -1
  s_mov_b64 s[62:63], -1
  s_mov_b64 s[64:65], -1
  s_mov_b64 s[66:67], -1
  s_mov_b64 s[68:69], -1
  s_mov_b64 s[70:71], -1
  s_mov_b64 s[72:73], -1
  s_mov_b64 s[74:75], -1
  s_waitcnt vmcnt(0)
  s_mov_b32 s100, 0
  s_branch L_gc_22
L_g_20:
  s_add_u32 s100, s100, 1
  s_cmp_gt_u32 s100, 1000000
  s_cbranch_scc1 L_abort
  s_mov_b32 s92, 0
  s_cmp_lg_u32 s74, 0
  s_cselect_b32 s92, 7168, s92
  s_cmp_lg_u32 s72, 0
  s_cselect_b32 s92, 6144, s92
  s_cmp_lg_u32 s70, 0
  s_cselect_b32 s92, 5120, s92
  s_cmp_lg_u32 s68, 0
  s_cselect_b32 s92, 4096, s92
  s_cmp_lg_u32 s66, 0
  s_cselect_b32 s92, 3072, s92
  s_cmp_lg_u32 s64, 0
  s_cselect_b32 s92, 2048, s92
  s_cmp_lg_u32 s62, 0
  s_cselect_b32 s92, 1024, s92
  s_cmp_lg_u32 s60, 0
  s_cselect_b32 s92, 0, s92
  s_add_u32 s92, s92, s81
  s_mov_b64 exec, -1
L_qg_23:
  buffer_load_dwordx4 v[16:19], v8, s[32:35], s92 offen sc1
  s_add_u32 s100, s100, 1
  s_cmp_gt_u32 s100, 1000000
  s_cbranch_scc1 L_abort
  s_waitcnt vmcnt(0)
  v_xor_b32 v16, v16, v4
  v_bitop3_b32 v16, v17, v5, v16 bitop3:0xbe
  v_bitop3_b32 v16, v18, v6, v16 bitop3:0xbe
  v_bitop3_b32 v16, v19, v7, v16 bitop3:0xbe
  v_and_b32 v16, s53, v16
  v_cmp_ne_u32 vcc, 0, v16
  s_nop 0
  s_cbranch_vccz L_qg_23x
  s_sleep 4
  s_branch L_qg_23
L_qg_23x:
L_gf_21:
  s_mov_b64 exec, s[60:61]
  s_cbranch_execz L_gs_24
  buffer_load_dwordx4 v[48:51], v8, s[32:35], s81 offen offset:0 sc1
L_gs_24:
  s_mov_b64 exec, s[62:63]
  s_cbranch_execz L_gs_25
  buffer_load_dwordx4 v[52:55], v8, s[32:35], s81 offen offset:1024 sc1
L_gs_25:
  s_mov_b64 exec, s[64:65]
  s_cbranch_execz L_gs_26
  buffer_load_dwordx4 v[56:59], v8, s[32:35], s81 offen offset:2048 sc1
L_gs_26:
  s_mov_b64 exec, s[66:67]
  s_cbranch_execz L_gs_27
  buffer_load_dwordx4 v[60:63], v8, s[32:35], s81 offen offset:3072 sc1
L_gs_27:
  s_mov_b64 exec, s[68:69]
  s_cbranch_execz L_gs_28
  buffer_load_dwordx4 v[64:67], v8, s[32:35], s82 offen offset:0 sc1
L_gs_28:
  s_mov_b64 exec, s[70:71]
  s_cbranch_execz L_gs_29
  buffer_load_dwordx4 v[68:71], v8, s[32:35], s82 offen offset:1024 sc1
L_gs_29:
  s_mov_b64 exec, s[72:73]
  s_cbranch_execz L_gs_30
  buffer_load_dwordx4 v[72:75], v8, s[32:35], s82 offen offset:2048 sc1
L_gs_30:
  s_mov_b64 exec, s[74:75]
  s_cbranch_execz L_gs_31
  buffer_load_dwordx4 v[76:79], v8, s[32:35], s82 offen offset:3072 sc1
L_gs_31:
  s_waitcnt vmcnt(0)
L_gc_22:
  s_mov_b64 exec, s[60:61]
  v_xor_b32 v44, v48, v4
  v_bitop3_b32 v44, v49, v5, v44 bitop3:0xbe
  v_bitop3_b32 v44, v50, v6, v44 bitop3:0xbe
  v_bitop3_b32 v44, v51, v7, v44 bitop3:0xbe
  v_and_b32 v44, s53, v44
  v_cmp_ne_u32 s[60:61], 0, v44
  s_nop 0
  s_cmp_lg_u64 s[60:61], 0
  s_cselect_b64 s[60:61], -1, 0
  s_mov_b64 exec, s[62:63]
  v_xor_b32 v44, v52, v4
  v_bitop3_b32 v44, v53, v5, v44 bitop3:0xbe
  v_bitop3_b32 v44, v54, v6, v44 bitop3:0xbe
  v_bitop3_b32 v44, v55, v7, v44 bitop3:0xbe
  v_and_b32 v44, s53, v44
  v_cmp_ne_u32 s[62:63], 0, v44
  s_nop 0
  s_cmp_lg_u64 s[62:63], 0
  s_cselect_b64 s[62:63], -1, 0
  s_mov_b64 exec, s[64:65]
  v_xor_b32 v44, v56, v4
  v_bitop3_b32 v44, v57, v5, v44 bitop3:0xbe
  v_bitop3_b32 v44, v58, v6, v44 bitop3:0xbe
  v_bitop3_b32 v44, v59, v7, v44 bitop3:0xbe
  v_and_b32 v44, s53, v44
  v_cmp_ne_u32 s[64:65], 0, v44
  s_nop 0
  s_cmp_lg_u64 s[64:65], 0
  s_cselect_b64 s[64:65], -1, 0
  s_mov_b64 exec, s[66:67]
  v_xor_b32 v44, v60, v4
  v_bitop3_b32 v44, v61, v5, v44 bitop3:0xbe
  v_bitop3_b32 v44, v62, v6, v44 bitop3:0xbe
  v_bitop3_b32 v44, v63, v7, v44 bitop3:0xbe
  v_and_b32 v44, s53, v44
  v_cmp_ne_u32 s[66:67], 0, v44
  s_nop 0
  s_cmp_lg_u64 s[66:67], 0
  s_cselect_b64 s[66:67], -1, 0
  s_mov_b64 exec, s[68:69]
  v_xor_b32 v44, v64, v4
  v_bitop3_b32 v44, v65, v5, v44 bitop3:0xbe
  v_bitop3_b32 v44, v66, v6, v44 bitop3:0xbe
  v_bitop3_b32 v44, v67, v7, v44 bitop3:0xbe
  v_and_b32 v44, s53, v44
  v_cmp_ne_u32 s[68:69], 0, v44
  s_nop 0
  s_cmp_lg_u64 s[68:69], 0
  s_cselect_b64 s[68:69], -1, 0
  s_mov_b64 exec, s[70:71]
  v_xor_b32 v44, v68, v4
  v_bitop3_b32 v44, v69, v5, v44 bitop3:0xbe
  v_bitop3_b32 v44, v70, v6, v44 bitop3:0xbe
  v_bitop3_b32 v44, v71, v7, v44 bitop3:0xbe
  v_and_b32 v44, s53, v44
  v_cmp_ne_u32 s[70:71], 0, v44
  s_nop 0
  s_cmp_lg_u64 s[70:71], 0
  s_cselect_b64 s[70:71], -1, 0
  s_mov_b64 exec, s[72:73]
  v_xor_b32 v44, v72, v4
  v_bitop3_b32 v44, v73, v5, v44 bitop3:0xbe
  v_bitop3_b32 v44, v74, v6, v44 bitop3:0xbe
  v_bitop3_b32 v44, v75, v7, v44 bitop3:0xbe
  v_and_b32 v44, s53, v44
  v_cmp_ne_u32 s[72:73], 0, v44
  s_nop 0
  s_cmp_lg_u64 s[72:73], 0
  s_cselect_b64 s[72:73], -1, 0
  s_mov_b64 exec, s[74:75]
  v_xor_b32 v44, v76, v4
  v_bitop3_b32 v44, v77, v5, v44 bitop3:0xbe
  v_bitop3_b32 v44, v78, v6, v44 bitop3:0xbe
  v_bitop3_b32 v44, v79, v7, v44 bitop3:0xbe
  v_and_b32 v44, s53, v44
  v_cmp_ne_u32 s[74:75], 0, v44
  s_nop 0
  s_cmp_lg_u64 s[74:75], 0
  s_cselect_b64 s[74:75], -1, 0
  s_or_b64 s[96:97], s[60:61], s[62:63]
  s_or_b64 s[96:97], s[96:97], s[64:65]
  s_or_b64 s[96:97], s[96:97], s[66:67]
  s_or_b64 s[96:97], s[96:97], s[68:69]
  s_or_b64 s[96:97], s[96:97], s[70:71]
  s_or_b64 s[96:97], s[96:97], s[72:73]
  s_or_b64 s[96:97], s[96:97], s[74:75]
  s_cbranch_scc1 L_g_20
  s_mov_b64 exec, -1
  s_cmp_le_u32 s100, 0
  s_cselect_b32 s101, 0, 0
  v_xor_b32 v10, 0, v9
  ds_write_b128 v10, v[48:51] offset:0
  v_xor_b32 v11, 64, v9
  ds_write_b128 v11, v[52:55] offset:256
  v_xor_b32 v10, 128, v9
  ds_write_b128 v10, v[56:59] offset:512
  v_xor_b32 v11, 192, v9
  ds_write_b128 v11, v[60:63] offset:768
  v_xor_b32 v10, 16, v9
  ds_write_b128 v10, v[64:67] offset:1024
  v_xor_b32 v11, 80, v9
  ds_write_b128 v11, v[68:71] offset:1280
  v_xor_b32 v10, 144, v9
  ds_write_b128 v10, v[72:75] offset:1536
  v_xor_b32 v11, 208, v9
  ds_write_b128 v11, v[76:79] offset:1792
  s_mov_b64 s[40:41], s[14:15]
  s_mov_b32 s42, 0x400000
  s_mov_b32 s43, 0x20000
  s_mov_b64 s[44:45], s[12:13]
  s_mov_b32 s46, 0x400000
  s_mov_b32 s47, 0x20000
  s_waitcnt lgkmcnt(0)
  s_setprio 3
  s_barrier
  s_cmp_lt_u32 s2, 128
  s_cbranch_scc0 L_lwB
  s_cmp_lg_u32 s101, 0
  s_cbranch_scc1 L_lwX
  buffer_load_dwordx4 v[176:179], v253, s[44:47], s88 offen nt
  s_add_u32 s88, s88, 65536
  buffer_load_dwordx4 v[180:183], v253, s[44:47], s88 offen nt
  s_add_u32 s88, s88, 65536
  buffer_load_dwordx4 v[184:187], v253, s[44:47], s88 offen nt
  s_add_u32 s88, s88, 65536
  buffer_load_dwordx4 v[188:191], v253, s[44:47], s88 offen nt
  buffer_load_dwordx4 v[208:211], v251, s[40:43], s89 offen nt
  s_add_u32 s89, s89, 4096
  buffer_load_dwordx4 v[212:215], v251, s[40:43], s89 offen nt
  s_add_u32 s89, s89, 4096
  buffer_load_dwordx4 v[216:219], v251, s[40:43], s89 offen nt
  s_add_u32 s89, s89, 4096
  buffer_load_dwordx4 v[220:223], v251, s[40:43], s89 offen nt
  s_add_u32 s89, s89, 4096
  buffer_load_dwordx4 v[224:227], v251, s[40:43], s89 offen nt
  s_add_u32 s89, s89, 4096
  buffer_load_dwordx4 v[228:231], v251, s[40:43], s89 offen nt
  s_add_u32 s89, s89, 4096
  buffer_load_dwordx4 v[232:235], v251, s[40:43], s89 offen nt
  s_add_u32 s89, s89, 4096
  buffer_load_dwordx4 v[236:239], v251, s[40:43], s89 offen nt
L_lwX:
  s_barrier
  s_barrier
  s_barrier
  s_branch L_pv
L_lwB:
  s_cmp_lg_u32 s101, 0
  s_cbranch_scc1 L_lwB2
  buffer_load_dwordx4 v[176:179], v253, s[44:47], s88 offen nt
  s_add_u32 s88, s88, 65536
  buffer_load_dwordx4 v[180:183], v253, s[44:47], s88 offen nt
  s_add_u32 s88, s88, 65536
  buffer_load_dwordx4 v[184:187], v253, s[44:47], s88 offen nt
  s_add_u32 s88, s88, 65536
  buffer_load_dwordx4 v[188:191], v253, s[44:47], s88 offen nt
  s_mov_b64 s[40:41], s[18:19]
  s_mov_b32 s42, 0x1c0000
  s_mov_b32 s43, 0x20000
  s_mov_b64 s[44:45], s[20:21]
  s_mov_b32 s46, 0x1c0000
  s_mov_b32 s47, 0x20000
  s_mov_b32 exec_lo, 0xfffffff
  s_mov_b32 exec_hi, 0xfffffff
  buffer_load_dwordx4 v[208:211], v251, s[40:43], s89 offen nt
  buffer_load_dwordx4 v[212:215], v251, s[44:47], s89 offen nt
  s_add_u32 s89, s89, 7168
  buffer_load_dwordx4 v[216:219], v251, s[40:43], s89 offen nt
  buffer_load_dwordx4 v[220:223], v251, s[44:47], s89 offen nt
  s_add_u32 s89, s89, 7168
  buffer_load_dwordx4 v[224:227], v251, s[40:43], s89 offen nt
  buffer_load_dwordx4 v[228:231], v251, s[44:47], s89 offen nt
  s_add_u32 s89, s89, 7168
  buffer_load_dwordx4 v[232:235], v251, s[40:43], s89 offen nt
  buffer_load_dwordx4 v[236:239], v251, s[44:47], s89 offen nt
  s_mov_b64 exec, -1
L_lwB2:
  s_and_b32 s74, s2, 31
  s_lshl_b32 s74, s74, 10
  s_lshr_b32 s97, s78, 5
  s_lshl_b32 s97, s97, 8
  s_add_u32 s74, s74, s97
  s_add_u32 s74, s74, 0x4000
  v_and_b32 v13, 7, v1
  v_lshlrev_b32 v13, 2, v13
  v_lshrrev_b32 v14, 4, v1
  v_add_u32 v13, v13, v14
  v_lshlrev_b32 v13, 5, v13
  s_lshl_b32 s92, s3, 2
  s_add_u32 s92, s92, 141296
  v_add_u32 v13, s92, v13
  v_lshlrev_b32 v14, 6, v1
  v_add_u32 v14, 141312, v14
  v_lshlrev_b32 v15, 4, v1
  v_xor_b32 v13, s59, v13
  v_xor_b32 v14, s59, v14
  s_waitcnt vmcnt(63)
  v_lshlrev_b32 v116, 16, v144
  v_and_b32 v117, 0xffff0000, v144
  v_lshlrev_b32 v118, 16, v145
  v_and_b32 v119, 0xffff0000, v145
  v_mul_f32 v112, 0xbfb8aa3b, v116
  v_mul_f32 v113, 0xbfb8aa3b, v117
  v_mul_f32 v114, 0xbfb8aa3b, v118
  v_mul_f32 v115, 0xbfb8aa3b, v119
  v_exp_f32 v112, v112
  v_exp_f32 v113, v113
  v_exp_f32 v114, v114
  v_exp_f32 v115, v115
  v_add_f32 v112, 1.0, v112
  v_add_f32 v113, 1.0, v113
  v_add_f32 v114, 1.0, v114
  v_add_f32 v115, 1.0, v115
  v_rcp_f32 v112, v112
  v_rcp_f32 v113, v113
  v_rcp_f32 v114, v114
  v_rcp_f32 v115, v115
  v_mul_f32 v116, v116, v112
  v_mul_f32 v117, v117, v113
  v_mul_f32 v118, v118, v114
  v_mul_f32 v119, v119, v115
  v_cvt_pk_bf16_f32 v116, v116, v116
  v_cvt_pk_bf16_f32 v117, v117, v117
  v_cvt_pk_bf16_f32 v118, v118, v118
  v_cvt_pk_bf16_f32 v119, v119, v119
  v_lshrrev_b32 v112, 16, v116
  v_lshrrev_b32 v113, 16, v117
  v_lshrrev_b32 v114, 16, v118
  v_lshrrev_b32 v115, 16, v119
  v_and_b32 v116, 0xffff0000, v116
  v_and_b32 v117, 0xffff0000, v117
  v_and_b32 v118, 0xffff0000, v118
  v_and_b32 v119, 0xffff0000, v119
  v_mov_b32 v96, 0
  v_mov_b32 v97, 0
  v_mov_b32 v98, 0
  v_mov_b32 v99, 0
  v_mov_b32 v100, 0
  v_mov_b32 v101, 0
  v_mov_b32 v102, 0
  v_mov_b32 v103, 0
  s_waitcnt vmcnt(63)
  v_dot2c_f32_bf16 v96, v112, v128
  v_dot2c_f32_bf16 v97, v116, v128
  v_dot2c_f32_bf16 v98, v112, v129
  v_dot2c_f32_bf16 v99, v116, v129
  v_dot2c_f32_bf16 v100, v112, v130
  v_dot2c_f32_bf16 v101, v116, v130
  v_dot2c_f32_bf16 v102, v112, v131
  v_dot2c_f32_bf16 v103, v116, v131
  s_waitcnt vmcnt(62)
  v_dot2c_f32_bf16 v96, v113, v132
  v_dot2c_f32_bf16 v97, v117, v132
  v_dot2c_f32_bf16 v98, v113, v133
  v_dot2c_f32_bf16 v99, v117, v133
  v_dot2c_f32_bf16 v100, v113, v134
  v_dot2c_f32_bf16 v101, v117, v134
  v_dot2c_f32_bf16 v102, v113, v135
  v_dot2c_f32_bf16 v103, v117, v135
  s_waitcnt vmcnt(61)
  v_dot2c_f32_bf16 v96, v114, v136
  v_dot2c_f32_bf16 v97, v118, v136
  v_dot2c_f32_bf16 v98, v114, v137
  v_dot2c_f32_bf16 v99, v118, v137
  v_dot2c_f32_bf16 v100, v114, v138
  v_dot2c_f32_bf16 v101, v118, v138
  v_dot2c_f32_bf16 v102, v114, v139
  v_dot2c_f32_bf16 v103, v118, v139
  s_waitcnt vmcnt(60)
  v_dot2c_f32_bf16 v96, v115, v140
  v_dot2c_f32_bf16 v97, v119, v140
  v_dot2c_f32_bf16 v98, v115, v141
  v_dot2c_f32_bf16 v99, v119, v141
  v_dot2c_f32_bf16 v100, v115, v142
  v_dot2c_f32_bf16 v101, v119, v142
  v_dot2c_f32_bf16 v102, v115, v143
  v_dot2c_f32_bf16 v103, v119, v143
  v_permlane32_swap_b32 v96, v100
  v_permlane32_swap_b32 v97, v101
  v_permlane32_swap_b32 v98, v102
  v_permlane32_swap_b32 v99, v103
  v_add_f32 v96, v96, v100
  v_add_f32 v97, v97, v101
  v_add_f32 v98, v98, v102
  v_add_f32 v99, v99, v103
  s_nop 0
  v_permlane16_swap_b32 v96, v98
  v_permlane16_swap_b32 v97, v99
  v_add_f32 v96, v96, v98
  v_add_f32 v97, v97, v99
  s_nop 0
  v_add_f32_dpp v96, v96, v96 row_ror:8 row_mask:0xf bank_mask:0xf
  v_add_f32_dpp v97, v97, v97 row_ror:8 row_mask:0xf bank_mask:0xf
  s_barrier
  ds_write2_b32 v13, v96, v97 offset0:0 offset1:4
  s_waitcnt lgkmcnt(0)
  s_barrier
  s_cmp_lg_u32 s3, 4
  s_cbranch_scc1 L_nopub_32
  s_mov_b64 exec, 0xffff
  ds_read_b128 v[128:131], v14 offset:0
  ds_read_b128 v[132:135], v14 offset:16
  ds_read_b128 v[136:139], v14 offset:32
  ds_read_b128 v[140:143], v14 offset:48
  s_waitcnt lgkmcnt(3)
  v_add_f32 v128, v128, v129
  v_add_f32 v130, v130, v131
  v_add_f32 v128, v128, v130
  s_waitcnt lgkmcnt(2)
  v_add_f32 v132, v132, v133
  v_add_f32 v134, v134, v135
  v_add_f32 v132, v132, v134
  s_waitcnt lgkmcnt(1)
  v_add_f32 v136, v136, v137
  v_add_f32 v138, v138, v139
  v_add_f32 v136, v136, v138
  s_waitcnt lgkmcnt(0)
  v_add_f32 v140, v140, v141
  v_add_f32 v142, v142, v143
  v_add_f32 v140, v140, v142
  v_and_or_b32 v100, v128, v2, s49
  v_and_or_b32 v101, v132, v2, s50
  v_and_or_b32 v102, v136, v2, s51
  v_and_or_b32 v103, v140, v2, s52
  buffer_store_dwordx4 v[100:103], v15, s[32:35], s74 offen sc1
L_nopub_32:
  s_mov_b64 exec, -1
  s_barrier
  s_branch L_pv
L_front:
  s_mov_b32 s100, 0
  s_waitcnt vmcnt(4)
  s_branch L_epc_34
L_ep_33:
  global_load_dword v252, v253, s[30:31] sc1
  s_add_u32 s100, s100, 1
  s_cmp_gt_u32 s100, 1000000
  s_cbranch_scc1 L_abort
  s_waitcnt vmcnt(0)
L_epc_34:
  v_readfirstlane_b32 s48, v252
  s_nop 0
  s_cmp_eq_u32 s48, 0
  s_nop 1
  s_cbranch_scc1 L_ep_33
  s_mul_i32 s48, s48, 0x9e3779b1
  s_and_b32 s49, s48, 0xff
  s_bfe_u32 s50, s48, 0x80008
  s_bfe_u32 s51, s48, 0x80010
  s_lshr_b32 s52, s48, 24
  s_lshr_b32 s97, s48, 15
  s_xor_b32 s97, s97, s48
  s_mul_i32 s97, s97, 0x85ebca6b
  v_mov_b32 v4, s48
  v_mov_b32 v5, s97
  v_mov_b32 v249, s48
  v_mov_b32 v250, s97
  v_and_b32 v6, 4, v1
  v_cmp_eq_u32 vcc, 0, v6
  v_and_b32 v7, 3, v1
  v_lshlrev_b32 v7, 2, v7
  v_cndmask_b32 v4, v5, v4, vcc
  v_lshrrev_b32 v4, v7, v4
  v_lshrrev_b32 v5, 1, v4
  v_lshrrev_b32 v6, 2, v4
  v_lshrrev_b32 v7, 3, v4
L_setup:
  s_lshr_b32 s92, s3, 1
  s_lshl_b32 s92, s92, 15
  s_and_b32 s93, s3, 1
  v_lshlrev_b32 v34, 4, v1
  v_bfe_u32 v44, v1, 2, 2
  v_lshrrev_b32 v45, 5, v1
  v_lshl_add_u32 v46, v45, 2, v44
  v_lshlrev_b32 v46, 8, v46
  v_add_u32 v46, s92, v46
  v_and_b32 v47, 1, v1
  v_lshl_add_u32 v46, v47, 3, v46
  v_lshl_or_b32 v44, v44, 2, v45
  v_bfe_u32 v47, v1, 4, 1
  v_lshlrev_b32 v47, 1, v47
  v_xor_b32 v44, v44, v47
  v_bfe_u32 v47, v1, 1, 1
  v_xor_b32 v44, v44, v47
  s_lshl_b32 s94, s93, 3
  v_xor_b32 v44, s94, v44
  v_xor_b32 v47, 0, v44
  v_lshl_add_u32 v24, v47, 4, v46
  v_xor_b32 v47, 2, v44
  v_lshl_add_u32 v25, v47, 4, v46
  v_add_u32 v25, 2048, v25
  v_xor_b32 v47, 4, v44
  v_lshl_add_u32 v26, v47, 4, v46
  v_xor_b32 v47, 6, v44
  v_lshl_add_u32 v27, v47, 4, v46
  v_add_u32 v27, 2048, v27
  v_add_u32 v28, 132096, v34
  v_and_b32 v44, 31, v1
  v_lshlrev_b32 v29, 5, v44
  v_add_u32 v29, 131072, v29
  v_xor_b32 v28, s59, v28
  v_xor_b32 v29, s59, v29
  s_lshl_b32 s94, s93, 7
  s_add_u32 s94, s94, s92
  v_and_b32 v46, 3, v44
  v_lshlrev_b32 v46, 6, v46
  v_lshl_add_u32 v46, v44, 8, v46
  v_bfe_u32 v47, v44, 1, 2
  v_lshlrev_b32 v45, 1, v45
  v_xor_b32 v47, v47, v45
  v_lshl_add_u32 v46, v47, 4, v46
  v_xor_b32 v244, s94, v46
  v_xor_b32 v245, 16, v244
  v_xor_b32 v246, 64, v244
  v_xor_b32 v247, 0x50, v244
  v_lshrrev_b32 v44, 2, v1
  v_and_b32 v46, 3, v44
  v_lshlrev_b32 v46, 6, v46
  v_lshl_add_u32 v46, v44, 8, v46
  v_bfe_u32 v47, v44, 1, 2
  v_and_b32 v45, 3, v1
  v_xor_b32 v47, v47, v45
  v_lshl_add_u32 v46, v47, 4, v46
  v_xor_b32 v32, s94, v46
  v_xor_b32 v33, 64, v32
  v_lshrrev_b32 v44, 3, v1
  v_bfe_u32 v45, v1, 2, 1
  v_and_b32 v46, 3, v44
  v_xor_b32 v46, v46, v45
  v_lshlrev_b32 v46, 6, v46
  v_lshl_add_u32 v46, v44, 8, v46
  v_lshrrev_b32 v47, 1, v44
  v_and_b32 v45, 3, v1
  v_xor_b32 v47, v47, v45
  v_lshl_add_u32 v46, v47, 4, v46
  v_xor_b32 v32, s94, v46
  s_mul_i32 s87, s2, 32896
  s_lshl_b32 s97, s3, 12
  s_add_u32 s87, s87, s97
  s_add_u32 s87, s87, 0x200000
  s_lshl_b32 s94, s76, 4
  s_lshl_b32 s97, s3, 9
  s_add_u32 s94, s94, s97
  s_add_u32 s94, s94, 0x20000
  v_lshrrev_b32 v35, 3, v1
  v_lshlrev_b32 v35, 12, v35
  v_add_u32 v35, s94, v35
  v_lshlrev_b32 v248, 4, v1
  v_lshrrev_b32 v36, 3, v1
  v_mul_u32_u24 v36, 263168, v36
  v_and_b32 v3, 7, v1
  v_lshl_add_u32 v36, v3, 4, v36
  s_mul_i32 s94, s3, 32896
  s_lshl_b32 s97, s77, 12
  s_add_u32 s94, s94, s97
  s_lshl_b32 s97, s76, 7
  s_add_u32 s94, s94, s97
  s_add_u32 s83, s94, 6307840
  s_add_u32 s84, s94, 8413184
  s_add_u32 s85, s94, 2097152
  s_add_u32 s86, s94, 4202496
  s_mul_i32 s94, s3, 144
  s_add_u32 s94, s94, 0x14000
  v_and_b32 v37, 7, v1
  v_lshlrev_b32 v37, 4, v37
  v_lshrrev_b32 v3, 4, v1
  v_lshl_add_u32 v37, v3, 2, v37
  v_add_u32 v37, s94, v37
  v_and_b32 v38, 7, v1
  v_mul_u32_u24 v38, 144, v38
  v_lshrrev_b32 v3, 4, v1
  v_lshl_add_u32 v38, v3, 4, v38
  v_add_u32 v38, 81920, v38
  s_lshl_b32 s94, s3, 7
  s_add_u32 s94, s94, 0x16c00
  v_lshrrev_b32 v41, 4, v1
  v_lshlrev_b32 v41, 4, v41
  v_add_u32 v41, s94, v41
  v_and_b32 v40, 7, v1
  v_mul_u32_u24 v40, 272, v40
  v_lshrrev_b32 v3, 4, v1
  v_lshl_add_u32 v40, v3, 4, v40
  v_add_u32 v40, 94208, v40
  s_lshl_b32 s94, s76, 12
  s_lshl_b32 s97, s3, 6
  s_add_u32 s94, s94, s97
  s_add_u32 s94, s94, 0x40000
  v_bfe_u32 v39, v1, 2, 3
  v_lshlrev_b32 v39, 9, v39
  v_and_b32 v3, 3, v1
  v_lshl_add_u32 v39, v3, 4, v39
  v_add_u32 v39, s94, v39
  s_lshl_b32 s95, s77, 9
  s_add_u32 s16, s94, s95
  s_and_b32 s94, s3, 3
  s_mul_i32 s94, s94, 4864
  v_lshrrev_b32 v240, 4, v1
  v_mul_u32_u24 v240, 288, v240
  v_and_b32 v3, 15, v1
  v_lshl_add_u32 v240, v3, 4, v240
  v_add_u32 v240, s94, v240
  s_and_b32 s94, s3, 3
  s_mul_i32 s94, s94, 9728
  s_add_u32 s94, s94, 0x5000
  v_lshrrev_b32 v241, 4, v1
  v_mul_u32_u24 v241, 288, v241
  v_and_b32 v3, 15, v1
  v_lshl_add_u32 v241, v3, 4, v241
  v_add_u32 v241, s94, v241
  s_lshl_b32 s94, s3, 5
  v_lshrrev_b32 v242, 4, v1
  v_mul_u32_u24 v242, 2432, v242
  v_bfe_u32 v3, v1, 2, 2
  v_mul_u32_u24 v3, 288, v3
  v_add_u32 v242, v3, v242
  v_and_b32 v3, 3, v1
  v_lshl_add_u32 v242, v3, 3, v242
  v_add_u32 v242, s94, v242
  v_lshrrev_b32 v243, 4, v1
  v_mul_u32_u24 v243, 2432, v243
  v_bfe_u32 v3, v1, 2, 2
  v_mul_u32_u24 v3, 288, v3
  v_add_u32 v243, v3, v243
  v_and_b32 v3, 3, v1
  v_lshl_add_u32 v243, v3, 3, v243
  v_add_u32 v243, 20480, v243
  v_add_u32 v243, s94, v243
  v_bfe_u32 v43, v1, 2, 3
  v_mul_u32_u24 v43, 272, v43
  v_and_b32 v3, 3, v1
  v_lshl_add_u32 v43, v3, 3, v43
  v_add_u32 v43, 94208, v43
  v_add_u32 v43, s94, v43
  s_cmp_ge_u32 s3, 4
  s_cbranch_scc1 L_back2
  v_and_b32 v44, 31, v1
  v_and_b32 v46, 3, v44
  v_lshlrev_b32 v46, 2, v46
  v_bfe_u32 v47, v44, 2, 2
  v_or_b32 v46, v46, v47
  v_lshrrev_b32 v47, 5, v1
  v_xor_b32 v46, v46, v47
  v_lshlrev_b32 v45, 8, v44
  v_xor_b32 v47, 0, v46
  v_lshl_add_u32 v16, v47, 4, v45
  v_xor_b32 v47, 2, v46
  v_lshl_add_u32 v17, v47, 4, v45
  v_xor_b32 v47, 4, v46
  v_lshl_add_u32 v18, v47, 4, v45
  v_xor_b32 v47, 6, v46
  v_lshl_add_u32 v19, v47, 4, v45
  v_xor_b32 v47, 8, v46
  v_lshl_add_u32 v20, v47, 4, v45
  v_xor_b32 v47, 10, v46
  v_lshl_add_u32 v21, v47, 4, v45
  v_xor_b32 v47, 12, v46
  v_lshl_add_u32 v22, v47, 4, v45
  v_xor_b32 v47, 14, v46
  v_lshl_add_u32 v23, v47, 4, v45
  s_lshl_b32 s92, s17, 13
  s_add_u32 s92, s92, 131072
  v_add_u32 v8, s91, v16
  v_add_u32 v16, s92, v16
  v_add_u32 v9, s91, v17
  v_add_u32 v17, s92, v17
  v_add_u32 v10, s91, v18
  v_add_u32 v18, s92, v18
  v_add_u32 v11, s91, v19
  v_add_u32 v19, s92, v19
  v_add_u32 v12, s91, v20
  v_add_u32 v20, s92, v20
  v_add_u32 v13, s91, v21
  v_add_u32 v21, s92, v21
  v_add_u32 v14, s91, v22
  v_add_u32 v22, s92, v22
  v_add_u32 v15, s91, v23
  v_add_u32 v23, s92, v23
  s_lshl_b32 s92, s3, 2
  v_lshrrev_b32 v47, 5, v1
  v_lshl_add_u32 v30, v47, 4, v29
  v_add_u32 v30, s92, v30
  s_lshl_b32 s92, s3, 11
  v_add_u32 v31, s92, v28
  s_setprio 2
  s_mov_b32 s101, 1
  s_waitcnt vmcnt(4)
  s_barrier
  ds_read_b128 v[112:115], v8
  ds_read_b128 v[116:119], v16
  ds_read_b128 v[120:123], v9
  ds_read_b128 v[124:127], v17
  ds_read_b128 v[128:131], v10
  ds_read_b128 v[132:135], v18
  ds_read_b128 v[136:139], v11
  ds_read_b128 v[140:143], v19
  ds_read_b128 v[144:147], v12
  ds_read_b128 v[148:151], v20
  ds_read_b128 v[152:155], v13
  ds_read_b128 v[156:159], v21
  v_xor_b32 v8, 0x8000, v8
  v_xor_b32 v16, 0x2000, v16
  v_xor_b32 v9, 0x8000, v9
  v_xor_b32 v17, 0x2000, v17
  v_xor_b32 v10, 0x8000, v10
  v_xor_b32 v18, 0x2000, v18
  v_xor_b32 v11, 0x8000, v11
  v_xor_b32 v19, 0x2000, v19
  v_xor_b32 v12, 0x8000, v12
  v_xor_b32 v20, 0x2000, v20
  v_xor_b32 v13, 0x8000, v13
  v_xor_b32 v21, 0x2000, v21
  s_waitcnt lgkmcnt(10)
  v_mfma_f32_32x32x16_bf16 v[96:111], v[112:115], v[116:119], 0
  ds_read_b128 v[160:163], v14
  ds_read_b128 v[164:167], v22
  v_xor_b32 v14, 0x8000, v14
  v_xor_b32 v22, 0x2000, v22
  s_waitcnt lgkmcnt(10)
  v_mfma_f32_32x32x16_bf16 v[96:111], v[120:123], v[124:127], v[96:111]
  ds_read_b128 v[168:171], v15
  ds_read_b128 v[172:175], v23
  v_xor_b32 v15, 0x8000, v15
  v_xor_b32 v23, 0x2000, v23
  s_waitcnt lgkmcnt(10)
  v_mfma_f32_32x32x16_bf16 v[96:111], v[128:131], v[132:135], v[96:111]
  ds_read_b128 v[112:115], v8
  ds_read_b128 v[116:119], v16
  v_xor_b32 v8, 0x18000, v8
  v_xor_b32 v16, 0x6000, v16
  s_waitcnt lgkmcnt(10)
  v_mfma_f32_32x32x16_bf16 v[96:111], v[136:139], v[140:143], v[96:111]
  ds_read_b128 v[120:123], v9
  ds_read_b128 v[124:127], v17
  v_xor_b32 v9, 0x18000, v9
  v_xor_b32 v17, 0x6000, v17
  s_waitcnt lgkmcnt(10)
  v_mfma_f32_32x32x16_bf16 v[96:111], v[144:147], v[148:151], v[96:111]
  ds_read_b128 v[128:131], v10
  ds_read_b128 v[132:135], v18
  v_xor_b32 v10, 0x18000, v10
  v_xor_b32 v18, 0x6000, v18
  s_waitcnt lgkmcnt(10)
  v_mfma_f32_32x32x16_bf16 v[96:111], v[152:155], v[156:159], v[96:111]
  ds_read_b128 v[136:139], v11
  ds_read_b128 v[140:143], v19
  v_xor_b32 v11, 0x18000, v11
  v_xor_b32 v19, 0x6000, v19
  s_waitcnt lgkmcnt(10)
  v_mfma_f32_32x32x16_bf16 v[96:111], v[160:163], v[164:167], v[96:111]
  ds_read_b128 v[144:147], v12
  ds_read_b128 v[148:151], v20
  v_xor_b32 v12, 0x18000, v12
  v_xor_b32 v20, 0x6000, v20
  s_waitcnt lgkmcnt(10)
  v_mfma_f32_32x32x16_bf16 v[96:111], v[168:171], v[172:175], v[96:111]
  ds_read_b128 v[152:155], v13
  ds_read_b128 v[156:159], v21
  v_xor_b32 v13, 0x18000, v13
  v_xor_b32 v21, 0x6000, v21
  s_waitcnt lgkmcnt(10)
  v_mfma_f32_32x32x16_bf16 v[96:111], v[112:115], v[116:119], v[96:111]
  ds_read_b128 v[160:163], v14
  ds_read_b128 v[164:167], v22
  v_xor_b32 v14, 0x18000, v14
  v_xor_b32 v22, 0x6000, v22
  s_waitcnt lgkmcnt(10)
  v_mfma_f32_32x32x16_bf16 v[96:111], v[120:123], v[124:127], v[96:111]
  ds_read_b128 v[168:171], v15
  ds_read_b128 v[172:175], v23
  v_xor_b32 v15, 0x18000, v15
  v_xor_b32 v23, 0x6000, v23
  s_waitcnt lgkmcnt(10)
  v_mfma_f32_32x32x16_bf16 v[96:111], v[128:131], v[132:135], v[96:111]
  ds_read_b128 v[112:115], v8
  ds_read_b128 v[116:119], v16
  v_xor_b32 v8, 0x8000, v8
  v_xor_b32 v16, 0x2000, v16
  s_waitcnt lgkmcnt(10)
  v_mfma_f32_32x32x16_bf16 v[96:111], v[136:139], v[140:143], v[96:111]
  ds_read_b128 v[120:123], v9
  ds_read_b128 v[124:127], v17
  v_xor_b32 v9, 0x8000, v9
  v_xor_b32 v17, 0x2000, v17
  s_waitcnt lgkmcnt(10)
  v_mfma_f32_32x32x16_bf16 v[96:111], v[144:147], v[148:151], v[96:111]
  ds_read_b128 v[128:131], v10
  ds_read_b128 v[132:135], v18
  v_xor_b32 v10, 0x8000, v10
  v_xor_b32 v18, 0x2000, v18
  s_waitcnt lgkmcnt(10)
  v_mfma_f32_32x32x16_bf16 v[96:111], v[152:155], v[156:159], v[96:111]
  ds_read_b128 v[136:139], v11
  ds_read_b128 v[140:143], v19
  v_xor_b32 v11, 0x8000, v11
  v_xor_b32 v19, 0x2000, v19
  s_waitcnt lgkmcnt(10)
  v_mfma_f32_32x32x16_bf16 v[96:111], v[160:163], v[164:167], v[96:111]
  ds_read_b128 v[144:147], v12
  ds_read_b128 v[148:151], v20
  v_xor_b32 v12, 0x8000, v12
  v_xor_b32 v20, 0x2000, v20
  s_waitcnt lgkmcnt(10)
  v_mfma_f32_32x32x16_bf16 v[96:111], v[168:171], v[172:175], v[96:111]
  ds_read_b128 v[152:155], v13
  ds_read_b128 v[156:159], v21
  v_xor_b32 v13, 0x8000, v13
  v_xor_b32 v21, 0x2000, v21
  s_barrier
  s_waitcnt lgkmcnt(10)
  v_mfma_f32_32x32x16_bf16 v[96:111], v[112:115], v[116:119], v[96:111]
  ds_read_b128 v[160:163], v14
  ds_read_b128 v[164:167], v22
  v_xor_b32 v14, 0x8000, v14
  v_xor_b32 v22, 0x2000, v22
  s_waitcnt lgkmcnt(10)
  v_mfma_f32_32x32x16_bf16 v[96:111], v[120:123], v[124:127], v[96:111]
  ds_read_b128 v[168:171], v15
  ds_read_b128 v[172:175], v23
  v_xor_b32 v15, 0x8000, v15
  v_xor_b32 v23, 0x2000, v23
  s_waitcnt lgkmcnt(10)
  v_mfma_f32_32x32x16_bf16 v[96:111], v[128:131], v[132:135], v[96:111]
  s_waitcnt vmcnt(0)
  ds_read_b128 v[112:115], v8
  ds_read_b128 v[116:119], v16
  s_waitcnt lgkmcnt(10)
  v_mfma_f32_32x32x16_bf16 v[96:111], v[136:139], v[140:143], v[96:111]
  ds_read_b128 v[120:123], v9
  ds_read_b128 v[124:127], v17
  s_waitcnt lgkmcnt(10)
  v_mfma_f32_32x32x16_bf16 v[96:111], v[144:147], v[148:151], v[96:111]
  ds_read_b128 v[128:131], v10
  ds_read_b128 v[132:135], v18
  s_waitcnt lgkmcnt(10)
  v_mfma_f32_32x32x16_bf16 v[96:111], v[152:155], v[156:159], v[96:111]
  ds_read_b128 v[136:139], v11
  ds_read_b128 v[140:143], v19
  s_waitcnt lgkmcnt(10)
  v_mfma_f32_32x32x16_bf16 v[96:111], v[160:163], v[164:167], v[96:111]
  ds_read_b128 v[144:147], v12
  ds_read_b128 v[148:151], v20
  s_waitcnt lgkmcnt(10)
  v_mfma_f32_32x32x16_bf16 v[96:111], v[168:171], v[172:175], v[96:111]
  ds_read_b128 v[152:155], v13
  ds_read_b128 v[156:159], v21
  s_waitcnt lgkmcnt(10)
  v_mfma_f32_32x32x16_bf16 v[96:111], v[112:115], v[116:119], v[96:111]
  ds_read_b128 v[160:163], v14
  ds_read_b128 v[164:167], v22
  s_waitcnt lgkmcnt(10)
  v_mfma_f32_32x32x16_bf16 v[96:111], v[120:123], v[124:127], v[96:111]
  ds_read_b128 v[168:171], v15
  ds_read_b128 v[172:175], v23
  s_waitcnt lgkmcnt(10)
  v_mfma_f32_32x32x16_bf16 v[96:111], v[128:131], v[132:135], v[96:111]
  s_waitcnt lgkmcnt(8)
  v_mfma_f32_32x32x16_bf16 v[96:111], v[136:139], v[140:143], v[96:111]
  s_waitcnt lgkmcnt(6)
  v_mfma_f32_32x32x16_bf16 v[96:111], v[144:147], v[148:151], v[96:111]
  s_waitcnt lgkmcnt(4)
  v_mfma_f32_32x32x16_bf16 v[96:111], v[152:155], v[156:159], v[96:111]
  s_waitcnt lgkmcnt(2)
  v_mfma_f32_32x32x16_bf16 v[96:111], v[160:163], v[164:167], v[96:111]
  s_waitcnt lgkmcnt(0)
  v_mfma_f32_32x32x16_bf16 v[96:111], v[168:171], v[172:175], v[96:111]
  s_nop 11
  v_max3_f32 v44, v96, v97, v98
  v_max3_f32 v45, v99, v100, v101
  v_max3_f32 v46, v102, v103, v104
  v_max3_f32 v47, v105, v106, v107
  v_max3_f32 v44, v44, v108, v109
  v_max3_f32 v45, v45, v110, v111
  v_max3_f32 v44, v44, v46, v47
  v_max_f32 v44, v44, v45
  ds_write_b32 v30, v44
  v_sub_f32 v96, v96, v44
  v_sub_f32 v97, v97, v44
  v_sub_f32 v98, v98, v44
  v_sub_f32 v99, v99, v44
  v_sub_f32 v100, v100, v44
  v_sub_f32 v101, v101, v44
  v_sub_f32 v102, v102, v44
  v_sub_f32 v103, v103, v44
  s_waitcnt lgkmcnt(0)
  s_barrier
  ds_read_b128 v[48:51], v29
  ds_read_b128 v[52:55], v29 offset:16
  v_exp_f32 v96, v96
  v_sub_f32 v104, v104, v44
  v_exp_f32 v97, v97
  v_sub_f32 v105, v105, v44
  v_exp_f32 v98, v98
  v_sub_f32 v106, v106, v44
  v_exp_f32 v99, v99
  v_sub_f32 v107, v107, v44
  v_exp_f32 v100, v100
  v_sub_f32 v108, v108, v44
  v_exp_f32 v101, v101
  v_sub_f32 v109, v109, v44
  v_exp_f32 v102, v102
  v_sub_f32 v110, v110, v44
  v_exp_f32 v103, v103
  v_sub_f32 v111, v111, v44
  s_waitcnt lgkmcnt(0)
  v_max3_f32 v45, v48, v49, v50
  v_max3_f32 v46, v51, v52, v53
  v_exp_f32 v104, v104
  v_max3_f32 v45, v45, v54, v55
  v_exp_f32 v105, v105
  v_max_f32 v45, v45, v46
  v_exp_f32 v106, v106
  v_sub_f32 v45, v44, v45
  v_exp_f32 v107, v107
  v_exp_f32 v45, v45
  v_exp_f32 v108, v108
  v_exp_f32 v109, v109
  v_exp_f32 v110, v110
  v_exp_f32 v111, v111
  v_mul_f32 v96, v96, v45
  v_mul_f32 v97, v97, v45
  v_mul_f32 v98, v98, v45
  v_mul_f32 v99, v99, v45
  v_mul_f32 v100, v100, v45
  v_mul_f32 v101, v101, v45
  v_mul_f32 v102, v102, v45
  v_mul_f32 v103, v103, v45
  v_cvt_pk_bf16_f32 v48, v96, v97
  v_cvt_pk_bf16_f32 v49, v98, v99
  v_cvt_pk_bf16_f32 v50, v100, v101
  v_cvt_pk_bf16_f32 v51, v102, v103
  ds_write_b128 v31, v[48:51] offset:0
  v_mul_f32 v104, v104, v45
  v_mul_f32 v105, v105, v45
  v_mul_f32 v106, v106, v45
  v_mul_f32 v107, v107, v45
  v_mul_f32 v108, v108, v45
  v_mul_f32 v109, v109, v45
  v_mul_f32 v110, v110, v45
  v_mul_f32 v111, v111, v45
  v_cvt_pk_bf16_f32 v52, v104, v105
  v_cvt_pk_bf16_f32 v53, v106, v107
  v_cvt_pk_bf16_f32 v54, v108, v109
  v_cvt_pk_bf16_f32 v55, v110, v111
  ds_write_b128 v31, v[52:55] offset:1024
  v_add_f32 v96, v96, v97
  v_add_f32 v98, v98, v99
  v_add_f32 v100, v100, v101
  v_add_f32 v102, v102, v103
  v_add_f32 v104, v104, v105
  v_add_f32 v106, v106, v107
  v_add_f32 v108, v108, v109
  v_add_f32 v110, v110, v111
  v_add_f32 v96, v96, v98
  v_add_f32 v100, v100, v102
  v_add_f32 v104, v104, v106
  v_add_f32 v108, v108, v110
  v_add_f32 v96, v96, v100
  v_add_f32 v104, v104, v108
  v_add_f32 v96, v96, v104
  ds_write_b32 v30, v96 offset:9216
  s_waitcnt lgkmcnt(0)
  s_barrier
L_pv:
  s_setprio 2
  ds_read_b128 v[48:51], v28 offset:0
  ds_read_b64_tr_b16 v[112:113], v24 offset:0
  ds_read_b64_tr_b16 v[114:115], v25 offset:0
  ds_read_b128 v[52:55], v28 offset:1024
  ds_read_b64_tr_b16 v[116:117], v24 offset:4096
  ds_read_b64_tr_b16 v[118:119], v25 offset:4096
  ds_read_b128 v[56:59], v28 offset:2048
  ds_read_b64_tr_b16 v[120:121], v24 offset:8192
  ds_read_b64_tr_b16 v[122:123], v25 offset:8192
  ds_read_b128 v[60:63], v28 offset:3072
  ds_read_b64_tr_b16 v[124:125], v24 offset:12288
  ds_read_b64_tr_b16 v[126:127], v25 offset:12288
  s_lshl_b32 s74, s2, 9
  s_add_u32 s74, s74, 0x20000
  s_mov_b32 s70, 0x10000
  s_mov_b32 s71, 0x18000
  s_mov_b32 s72, 0x8000
  s_cmp_lg_u32 s3, 7
  s_cbranch_scc1 L_nolse
  ds_read_b128 v[144:147], v29
  ds_read_b128 v[148:151], v29 offset:16
  s_waitcnt lgkmcnt(6)
  ds_read_b128 v[152:155], v29 offset:9216
  ds_read_b128 v[156:159], v29 offset:9232
  s_andn2_b32 s92, s48, 1
  v_mov_b32 v23, s92
  s_waitcnt lgkmcnt(2)
  v_max3_f32 v20, v144, v145, v146
  v_max3_f32 v21, v147, v148, v149
  v_max3_f32 v20, v20, v150, v151
  v_max_f32 v20, v20, v21
  s_waitcnt lgkmcnt(0)
  v_add_f32 v152, v152, v153
  v_add_f32 v154, v154, v155
  v_add_f32 v156, v156, v157
  v_add_f32 v158, v158, v159
  v_add_f32 v152, v152, v154
  v_add_f32 v156, v156, v158
  v_add_f32 v152, v152, v156
  v_mov_b32 v21, v152
  s_mov_b32 exec_hi, 0
  buffer_store_dwordx4 v[20:23], v248, s[32:35], s74 offen sc1
  s_mov_b32 exec_hi, -1
L_nolse:
  s_waitcnt lgkmcnt(9)
  v_mfma_f32_32x32x16_bf16 v[144:159], v[112:115], v[48:51], 0
  ds_read_b128 v[64:67], v28 offset:4096
  ds_read_b64_tr_b16 v[128:129], v24 offset:16384
  ds_read_b64_tr_b16 v[130:131], v25 offset:16384
  s_waitcnt lgkmcnt(9)
  v_mfma_f32_32x32x16_bf16 v[144:159], v[116:119], v[52:55], v[144:159]
  ds_read_b128 v[68:71], v28 offset:5120
  ds_read_b64_tr_b16 v[132:133], v24 offset:20480
  ds_read_b64_tr_b16 v[134:135], v25 offset:20480
  v_lshrrev_b32 v44, 5, v1
  v_lshlrev_b32 v44, 3, v44
  v_lshrrev_b32 v96, v44, v249
  v_lshrrev_b32 v104, v44, v250
  s_waitcnt lgkmcnt(9)
  v_mfma_f32_32x32x16_bf16 v[144:159], v[120:123], v[56:59], v[144:159]
  ds_read_b128 v[72:75], v28 offset:6144
  ds_read_b64_tr_b16 v[136:137], v24 offset:24576
  ds_read_b64_tr_b16 v[138:139], v25 offset:24576
  v_lshrrev_b32 v97, 1, v96
  v_lshrrev_b32 v98, 2, v96
  v_lshrrev_b32 v99, 3, v96
  s_waitcnt lgkmcnt(9)
  v_mfma_f32_32x32x16_bf16 v[144:159], v[124:127], v[60:63], v[144:159]
  ds_read_b128 v[76:79], v28 offset:7168
  ds_read_b64_tr_b16 v[140:141], v24 offset:28672
  ds_read_b64_tr_b16 v[142:143], v25 offset:28672
  v_lshrrev_b32 v100, 4, v96
  v_lshrrev_b32 v101, 5, v96
  v_lshrrev_b32 v102, 6, v96
  v_lshrrev_b32 v103, 7, v96
  s_waitcnt lgkmcnt(9)
  v_mfma_f32_32x32x16_bf16 v[144:159], v[128:131], v[64:67], v[144:159]
  ds_read_b64_tr_b16 v[112:113], v26 offset:0
  ds_read_b64_tr_b16 v[114:115], v27 offset:0
  v_lshrrev_b32 v105, 1, v104
  v_lshrrev_b32 v106, 2, v104
  v_lshrrev_b32 v107, 3, v104
  s_waitcnt lgkmcnt(8)
  v_mfma_f32_32x32x16_bf16 v[144:159], v[132:135], v[68:71], v[144:159]
  ds_read_b64_tr_b16 v[116:117], v26 offset:4096
  ds_read_b64_tr_b16 v[118:119], v27 offset:4096
  v_lshrrev_b32 v108, 4, v104
  v_lshrrev_b32 v109, 5, v104
  v_lshrrev_b32 v110, 6, v104
  v_lshrrev_b32 v111, 7, v104
  s_waitcnt lgkmcnt(7)
  v_mfma_f32_32x32x16_bf16 v[144:159], v[136:139], v[72:75], v[144:159]
  ds_read_b64_tr_b16 v[120:121], v26 offset:8192
  ds_read_b64_tr_b16 v[122:123], v27 offset:8192
  s_waitcnt lgkmcnt(6)
  v_mfma_f32_32x32x16_bf16 v[144:159], v[140:143], v[76:79], v[144:159]
  ds_read_b64_tr_b16 v[124:125], v26 offset:12288
  ds_read_b64_tr_b16 v[126:127], v27 offset:12288
  s_waitcnt lgkmcnt(6)
  v_mfma_f32_32x32x16_bf16 v[160:175], v[112:115], v[48:51], 0
  ds_read_b64_tr_b16 v[128:129], v26 offset:16384
  ds_read_b64_tr_b16 v[130:131], v27 offset:16384
  s_waitcnt lgkmcnt(6)
  v_mfma_f32_32x32x16_bf16 v[160:175], v[116:119], v[52:55], v[160:175]
  ds_read_b64_tr_b16 v[132:133], v26 offset:20480
  ds_read_b64_tr_b16 v[134:135], v27 offset:20480
  s_waitcnt lgkmcnt(6)
  v_mfma_f32_32x32x16_bf16 v[160:175], v[120:123], v[56:59], v[160:175]
  ds_read_b64_tr_b16 v[136:137], v26 offset:24576
  ds_read_b64_tr_b16 v[138:139], v27 offset:24576
  v_cvt_pk_bf16_f32 v80, v144, v145
  v_cvt_pk_bf16_f32 v81, v146, v147
  v_cvt_pk_bf16_f32 v82, v148, v149
  v_cvt_pk_bf16_f32 v83, v150, v151
  v_bfi_b32 v80, s53, v96, v80
  v_bfi_b32 v81, s53, v97, v81
  v_bfi_b32 v82, s53, v98, v82
  v_bfi_b32 v83, s53, v99, v83
  ds_write_b128 v244, v[80:83]
  s_waitcnt lgkmcnt(7)
  v_mfma_f32_32x32x16_bf16 v[160:175], v[124:127], v[60:63], v[160:175]
  ds_read_b64_tr_b16 v[140:141], v26 offset:28672
  ds_read_b64_tr_b16 v[142:143], v27 offset:28672
  v_cvt_pk_bf16_f32 v84, v152, v153
  v_cvt_pk_bf16_f32 v85, v154, v155
  v_cvt_pk_bf16_f32 v86, v156, v157
  v_cvt_pk_bf16_f32 v87, v158, v159
  v_bfi_b32 v84, s53, v100, v84
  v_bfi_b32 v85, s53, v101, v85
  v_bfi_b32 v86, s53, v102, v86
  v_bfi_b32 v87, s53, v103, v87
  ds_write_b128 v245, v[84:87]
  s_waitcnt lgkmcnt(8)
  v_mfma_f32_32x32x16_bf16 v[160:175], v[128:131], v[64:67], v[160:175]
  s_waitcnt lgkmcnt(6)
  v_mfma_f32_32x32x16_bf16 v[160:175], v[132:135], v[68:71], v[160:175]
  s_waitcnt lgkmcnt(4)
  v_mfma_f32_32x32x16_bf16 v[160:175], v[136:139], v[72:75], v[160:175]
  s_waitcnt lgkmcnt(1)
  v_mfma_f32_32x32x16_bf16 v[160:175], v[140:143], v[76:79], v[160:175]
  s_setprio 2
  s_nop 10
  v_cvt_pk_bf16_f32 v88, v160, v161
  v_cvt_pk_bf16_f32 v89, v162, v163
  v_cvt_pk_bf16_f32 v90, v164, v165
  v_cvt_pk_bf16_f32 v91, v166, v167
  v_bfi_b32 v88, s53, v104, v88
  v_bfi_b32 v89, s53, v105, v89
  v_bfi_b32 v90, s53, v106, v90
  v_bfi_b32 v91, s53, v107, v91
  ds_write_b128 v246, v[88:91]
  v_cvt_pk_bf16_f32 v92, v168, v169
  v_cvt_pk_bf16_f32 v93, v170, v171
  v_cvt_pk_bf16_f32 v94, v172, v173
  v_cvt_pk_bf16_f32 v95, v174, v175
  v_bfi_b32 v92, s53, v108, v92
  v_bfi_b32 v93, s53, v109, v93
  v_bfi_b32 v94, s53, v110, v94
  v_bfi_b32 v95, s53, v111, v95
  ds_write_b128 v247, v[92:95]
  ds_read_b128 v[112:115], v32 offset:0
  ds_read_b128 v[116:119], v32 offset:2048
  ds_read_b128 v[120:123], v32 offset:4096
  ds_read_b128 v[124:127], v32 offset:6144
  s_waitcnt lgkmcnt(3)
  buffer_store_dwordx4 v[112:115], v34, s[32:35], s87 offen offset:0 sc1
  s_waitcnt lgkmcnt(2)
  buffer_store_dwordx4 v[116:119], v34, s[32:35], s87 offen offset:1024 sc1
  s_waitcnt lgkmcnt(1)
  buffer_store_dwordx4 v[120:123], v34, s[32:35], s87 offen offset:2048 sc1
  s_waitcnt lgkmcnt(0)
  buffer_store_dwordx4 v[124:127], v34, s[32:35], s87 offen offset:3072 sc1
  s_setprio 0
  s_barrier
  s_cmp_lg_u32 s3, 7
  s_cbranch_scc1 L_nolse2
  v_or_b32 v23, 1, v23
  s_mov_b32 exec_hi, 0
  buffer_store_dwordx4 v[20:23], v248, s[32:35], s74 offen sc1
  s_mov_b32 exec_hi, -1
L_nolse2:
  s_mov_b32 s73, 0
  s_or_b32 s69, s48, 1
  buffer_load_dwordx4 v[8:11], v35, s[32:35], s70 offen offset:0 sc1
  buffer_load_dwordx4 v[12:15], v35, s[32:35], s71 offen offset:0 sc1
  buffer_load_dwordx4 v[16:19], v35, s[32:35], 0 offen offset:0 sc1
  buffer_load_dwordx4 v[20:23], v35, s[32:35], s72 offen offset:0 sc1
  s_cmp_lt_u32 s2, 128
  s_cbranch_scc1 L_prepA
  s_and_b32 s92, s3, 3
  s_mul_i32 s92, s92, 7552
  s_add_u32 s92, s92, 0x5000
  v_lshrrev_b32 v62, 5, v1
  v_mul_u32_u24 v62, 928, v62
  v_and_b32 v3, 31, v1
  v_lshl_add_u32 v62, v3, 4, v62
  v_add_u32 v62, s92, v62
  s_lshl_b32 s92, s3, 6
  v_lshrrev_b32 v63, 4, v1
  v_mul_u32_u24 v63, 7552, v63
  v_bfe_u32 v3, v1, 2, 2
  v_mul_u32_u24 v3, 928, v3
  v_add_u32 v63, v3, v63
  v_and_b32 v3, 3, v1
  v_lshl_add_u32 v63, v3, 3, v63
  v_add_u32 v63, 20480, v63
  v_add_u32 v63, s92, v63
  s_mul_i32 s82, s80, 28672
  s_lshl_b32 s97, s3, 12
  s_add_u32 s82, s82, s97
  s_lshl_b32 s97, s79, 8
  s_add_u32 s82, s82, s97
  s_lshr_b32 s92, s79, 1
  s_lshl_b32 s92, s92, 10
  s_and_b32 s97, s79, 1
  s_lshl_b32 s97, s97, 7
  s_add_u32 s92, s92, s97
  s_add_u32 s92, s92, 0x4000
  v_bfe_u32 v56, v1, 3, 1
  v_lshlrev_b32 v56, 13, v56
  v_lshrrev_b32 v3, 4, v1
  v_lshl_add_u32 v56, v3, 8, v56
  v_and_b32 v3, 7, v1
  v_lshl_add_u32 v56, v3, 4, v56
  v_add_u32 v56, s92, v56
  v_and_b32 v60, 31, v1
  v_lshlrev_b32 v60, 5, v60
  v_add_u32 v60, 90112, v60
  s_lshl_b32 s92, s3, 2
  s_add_u32 s92, s92, 0x16000
  v_and_b32 v59, 7, v1
  v_lshlrev_b32 v59, 7, v59
  v_lshrrev_b32 v3, 4, v1
  v_lshl_add_u32 v59, v3, 5, v59
  v_add_u32 v59, s92, v59
  s_lshl_b32 s92, s3, 7
  s_add_u32 s92, s92, 0x16c00
  v_and_b32 v57, 31, v1
  v_lshlrev_b32 v57, 1, v57
  v_add_u32 v57, s92, v57
  s_mul_i32 s90, s79, 4224
  s_lshl_b32 s97, s3, 9
  s_add_u32 s90, s90, s97
  s_add_u32 s90, s90, 0x60000
  v_and_b32 v61, 31, v1
  v_lshlrev_b32 v61, 4, v61
  v_and_b32 v58, 3, v1
  v_lshlrev_b32 v58, 6, v58
  v_lshrrev_b32 v3, 4, v1
  v_lshl_add_u32 v58, v3, 4, v58
  s_nop 0
  s_branch L_prep2
L_prepA:
  s_sub_u32 s92, s2, 56
  s_cmp_ge_u32 s2, 56
  s_cselect_b32 s81, s92, s2
  s_cselect_b32 s93, 1, 0
  s_lshl_b32 s91, s81, 15
  s_lshl_b32 s97, s3, 12
  s_add_u32 s91, s91, s97
  s_lshl_b32 s97, s93, 9
  s_add_u32 s91, s91, s97
  s_mul_i32 s75, s77, 16896
  s_lshr_b32 s97, s3, 1
  s_mul_i32 s97, s97, 4224
  s_add_u32 s75, s75, s97
  s_lshl_b32 s97, s76, 7
  s_add_u32 s75, s75, s97
  s_and_b32 s97, s3, 1
  s_lshl_b32 s97, s97, 6
  s_add_u32 s75, s75, s97
  s_add_u32 s75, s75, 0x60000
  s_mul_i32 s90, s93, 67584
  s_mul_i32 s97, s3, 8448
  s_add_u32 s90, s90, s97
  s_lshl_b32 s97, s81, 7
  s_add_u32 s90, s90, s97
  s_add_u32 s90, s90, 0xa0000
  s_mul_i32 s92, s3, 2176
  s_lshr_b32 s97, s3, 1
  s_lshl_b32 s97, s97, 7
  s_add_u32 s92, s92, s97
  s_add_u32 s92, s92, 0xe800
  v_lshrrev_b32 v62, 5, v1
  v_mul_u32_u24 v62, 544, v62
  v_and_b32 v3, 31, v1
  v_lshl_add_u32 v62, v3, 4, v62
  v_add_u32 v62, s92, v62
  s_lshl_b32 s92, s3, 6
  v_lshrrev_b32 v63, 4, v1
  v_mul_u32_u24 v63, 4480, v63
  v_bfe_u32 v3, v1, 2, 2
  v_mul_u32_u24 v3, 544, v3
  v_add_u32 v63, v3, v63
  v_and_b32 v3, 3, v1
  v_lshl_add_u32 v63, v3, 3, v63
  v_add_u32 v63, 59392, v63
  v_add_u32 v63, s92, v63
  s_lshl_b32 s82, s81, 12
  s_lshl_b32 s97, s3, 9
  s_add_u32 s82, s82, s97
  s_add_u32 s82, s82, 0xd0000
  s_lshl_b32 s92, s3, 7
  s_add_u32 s92, s92, 0x16c00
  v_and_b32 v57, 7, v1
  v_lshlrev_b32 v57, 3, v57
  v_lshrrev_b32 v3, 4, v1
  v_lshl_add_u32 v57, v3, 1, v57
  v_add_u32 v57, s92, v57
  v_and_b32 v61, 31, v1
  v_lshlrev_b32 v61, 4, v61
  v_and_b32 v58, 1, v1
  v_lshlrev_b32 v58, 6, v58
  v_lshrrev_b32 v3, 4, v1
  v_lshl_add_u32 v58, v3, 4, v58
  s_mul_i32 s92, s81, 37
  s_lshr_b32 s92, s92, 8
  s_lshl_b32 s92, s92, 11
  v_and_b32 v56, 15, v1
  v_lshlrev_b32 v56, 7, v56
  v_add_u32 v56, 98304, v56
  v_add_u32 v56, s92, v56
  s_lshl_b32 s92, s3, 2
  s_add_u32 s92, s92, 0x14800
  v_lshlrev_b32 v59, 5, v1
  v_add_u32 v59, s92, v59
  s_bfe_u32 s92, s3, 0x10002
  s_lshl_b32 s92, s92, 10
  s_and_b32 s97, s3, 3
  s_lshl_b32 s97, s97, 2
  s_add_u32 s92, s92, s97
  s_add_u32 s92, s92, 0x15800
  v_lshlrev_b32 v60, 4, v1
  v_add_u32 v60, s92, v60
L_prep2:
  s_cmp_lg_u32 s101, 0
  s_cbranch_scc1 L_nsg
  s_waitcnt vmcnt(8)
  ds_write_b128 v240, v[176:179] offset:0
  ds_write_b128 v240, v[180:183] offset:1152
  ds_write_b128 v240, v[184:187] offset:2432
  ds_write_b128 v240, v[188:191] offset:3584
  s_cmp_lt_u32 s2, 128
  s_cbranch_scc1 L_sf_35a
  s_mov_b32 exec_lo, 0xfffffff
  s_mov_b32 exec_hi, 0xfffffff
  ds_write_b128 v62, v[208:211] offset:0
  ds_write_b128 v62, v[212:215] offset:448
  ds_write_b128 v62, v[216:219] offset:1856
  ds_write_b128 v62, v[220:223] offset:2304
  ds_write_b128 v62, v[224:227] offset:3712
  ds_write_b128 v62, v[228:231] offset:4160
  ds_write_b128 v62, v[232:235] offset:5568
  ds_write_b128 v62, v[236:239] offset:6016
  s_mov_b64 exec, -1
  s_branch L_sf_35x
L_sf_35a:
  ds_write_b128 v241, v[208:211] offset:0
  ds_write_b128 v241, v[212:215] offset:1152
  ds_write_b128 v241, v[216:219] offset:2432
  ds_write_b128 v241, v[220:223] offset:3584
  ds_write_b128 v241, v[224:227] offset:4864
  ds_write_b128 v241, v[228:231] offset:6016
  ds_write_b128 v241, v[232:235] offset:7296
  ds_write_b128 v241, v[236:239] offset:8448
L_sf_35x:
L_nsg:
  s_waitcnt vmcnt(0)
  s_mov_b32 s100, 0
L_p1:
  v_cmp_ne_u32 s[60:61], s69, v11
  v_cmp_ne_u32 s[62:63], s69, v15
  v_cmp_ne_u32 s[64:65], s69, v19
  v_cmp_ne_u32 s[66:67], s69, v23
  v_xor_b32 v44, s69, v11
  v_bitop3_b32 v44, v15, s69, v44 bitop3:0xbe
  v_bitop3_b32 v44, v19, s69, v44 bitop3:0xbe
  v_bitop3_b32 v44, v23, s69, v44 bitop3:0xbe
  v_cmp_lt_u32 s[92:93], 1, v44
  s_mov_b32 s94, 0
  s_cmp_eq_u64 s[92:93], 0
  s_cbranch_scc1 L_p1d
  s_add_u32 s100, s100, 1
  s_cmp_gt_u32 s100, 1000000
  s_cbranch_scc1 L_abort
  s_mov_b64 exec, s[60:61]
  s_cbranch_execz L_ll_36
  buffer_load_dwordx4 v[8:11], v35, s[32:35], s70 offen offset:0 sc1
L_ll_36:
  s_mov_b64 exec, s[62:63]
  s_cbranch_execz L_ll_37
  buffer_load_dwordx4 v[12:15], v35, s[32:35], s71 offen offset:0 sc1
L_ll_37:
  s_mov_b64 exec, s[64:65]
  s_cbranch_execz L_ll_38
  buffer_load_dwordx4 v[16:19], v35, s[32:35], 0 offen offset:0 sc1
L_ll_38:
  s_mov_b64 exec, s[66:67]
  s_cbranch_execz L_ll_39
  buffer_load_dwordx4 v[20:23], v35, s[32:35], s72 offen offset:0 sc1
L_ll_39:
  s_mov_b64 exec, -1
L_p1d:
  s_bitcmp1_b32 s73, 0
  s_cbranch_scc1 L_lp_40
  s_cmp_lg_u64 s[60:61], 0
  s_cbranch_scc1 L_lp_40
  s_bitset1_b32 s73, 0
  s_add_u32 s94, s94, 1
  buffer_load_dwordx4 v[128:131], v36, s[32:35], s83 offen offset:0 sc1
L_lp_40:
  s_bitcmp1_b32 s73, 1
  s_cbranch_scc1 L_lp_41
  s_cmp_lg_u64 s[62:63], 0
  s_cbranch_scc1 L_lp_41
  s_bitset1_b32 s73, 1
  s_add_u32 s94, s94, 1
  buffer_load_dwordx4 v[132:135], v36, s[32:35], s84 offen offset:0 sc1
L_lp_41:
  s_bitcmp1_b32 s73, 2
  s_cbranch_scc1 L_lp_42
  s_cmp_lg_u64 s[64:65], 0
  s_cbranch_scc1 L_lp_42
  s_bitset1_b32 s73, 2
  s_add_u32 s94, s94, 1
  buffer_load_dwordx4 v[136:139], v36, s[32:35], s85 offen offset:0 sc1
L_lp_42:
  s_bitcmp1_b32 s73, 3
  s_cbranch_scc1 L_lp_43
  s_cmp_lg_u64 s[66:67], 0
  s_cbranch_scc1 L_lp_43
  s_bitset1_b32 s73, 3
  s_add_u32 s94, s94, 1
  buffer_load_dwordx4 v[140:143], v36, s[32:35], s86 offen offset:0 sc1
L_lp_43:
  s_cmp_eq_u64 s[92:93], 0
  s_cbranch_scc1 L_p1x
  s_cmp_eq_u32 s94, 0
  s_cbranch_scc0 L_pw0
  s_waitcnt vmcnt(0)
  s_branch L_p1
L_pw0:
  s_cmp_eq_u32 s94, 1
  s_cbranch_scc0 L_pw1
  s_waitcnt vmcnt(1)
  s_branch L_p1
L_pw1:
  s_cmp_eq_u32 s94, 2
  s_cbranch_scc0 L_pw2
  s_waitcnt vmcnt(2)
  s_branch L_p1
L_pw2:
  s_cmp_eq_u32 s94, 3
  s_cbranch_scc0 L_pw3
  s_waitcnt vmcnt(3)
  s_branch L_p1
L_pw3:
  s_waitcnt vmcnt(4)
  s_branch L_p1
L_p1x:
  v_max3_f32 v44, v8, v12, v16
  v_max_f32 v44, v44, v20
  s_nop 1
  v_max_f32_dpp v44, v44, v44 row_ror:8 row_mask:0xf bank_mask:0xf
  v_mov_b32 v45, v44
  s_nop 1
  v_permlane16_swap_b32 v44, v45
  v_max_f32 v44, v44, v45
  v_mov_b32 v45, v44
  s_nop 1
  v_permlane32_swap_b32 v44, v45
  v_max_f32 v44, v44, v45
  s_lshl_b32 s92, s3, 2
  s_add_u32 s92, s92, 92160
  v_mov_b32 v47, s92
  v_mov_b32 v46, 92160
  ds_write_b32 v47, v44
  s_waitcnt lgkmcnt(0)
  s_barrier
  ds_read_b128 v[144:147], v46
  ds_read_b128 v[148:151], v46 offset:16
  ds_read_b64_tr_b16 v[48:49], v242 offset:0
  ds_read_b64_tr_b16 v[50:51], v242 offset:1152
  ds_read_b64_tr_b16 v[52:53], v242 offset:9728
  ds_read_b64_tr_b16 v[54:55], v242 offset:10880
  s_waitcnt lgkmcnt(4)
  v_max3_f32 v44, v144, v145, v146
  v_max3_f32 v45, v147, v148, v149
  v_max3_f32 v44, v44, v150, v151
  v_max_f32 v44, v44, v45
  v_sub_f32 v152, v8, v44
  v_sub_f32 v153, v12, v44
  v_sub_f32 v154, v16, v44
  v_sub_f32 v155, v20, v44
  v_exp_f32 v152, v152
  v_exp_f32 v153, v153
  v_exp_f32 v154, v154
  v_exp_f32 v155, v155
  v_cvt_pk_bf16_f32 v152, v152, v152
  v_cvt_pk_bf16_f32 v153, v153, v153
  v_cvt_pk_bf16_f32 v154, v154, v154
  v_cvt_pk_bf16_f32 v155, v155, v155
  v_lshrrev_b32 v156, 16, v152
  v_lshrrev_b32 v157, 16, v153
  v_lshrrev_b32 v158, 16, v154
  v_lshrrev_b32 v159, 16, v155
  v_and_b32 v152, 0xffff0000, v152
  v_and_b32 v153, 0xffff0000, v153
  v_and_b32 v154, 0xffff0000, v154
  v_and_b32 v155, 0xffff0000, v155
  v_mul_f32 v44, v152, v9
  v_fmac_f32 v44, v153, v13
  v_fmac_f32 v44, v154, v17
  v_fmac_f32 v44, v155, v21
  s_nop 1
  v_add_f32_dpp v44, v44, v44 row_ror:8 row_mask:0xf bank_mask:0xf
  v_mov_b32 v45, v44
  s_nop 1
  v_permlane16_swap_b32 v44, v45
  v_add_f32 v44, v44, v45
  v_mov_b32 v45, v44
  s_nop 1
  v_permlane32_swap_b32 v44, v45
  v_add_f32 v44, v44, v45
  ds_write_b32 v47, v44 offset:32
  s_cmp_lt_u32 s2, 128
  s_cbranch_scc1 L_fgA
  ds_read_b64_tr_b16 v[80:81], v63 offset:0
  ds_read_b64_tr_b16 v[82:83], v63 offset:3712
  ds_read_b64_tr_b16 v[84:85], v63 offset:32
  ds_read_b64_tr_b16 v[86:87], v63 offset:3744
  ds_read_b64_tr_b16 v[88:89], v63 offset:448
  ds_read_b64_tr_b16 v[90:91], v63 offset:4160
  ds_read_b64_tr_b16 v[92:93], v63 offset:480
  ds_read_b64_tr_b16 v[94:95], v63 offset:4192
  s_branch L_fgx
L_fgA:
  ds_read_b64_tr_b16 v[80:81], v243 offset:0
  ds_read_b64_tr_b16 v[82:83], v243 offset:1152
  ds_read_b64_tr_b16 v[84:85], v243 offset:9728
  ds_read_b64_tr_b16 v[86:87], v243 offset:10880
  ds_read_b64_tr_b16 v[88:89], v243 offset:19456
  ds_read_b64_tr_b16 v[90:91], v243 offset:20608
  ds_read_b64_tr_b16 v[92:93], v243 offset:29184
  ds_read_b64_tr_b16 v[94:95], v243 offset:30336
L_fgx:
  s_waitcnt lgkmcnt(0)
  s_barrier
  ds_read_b128 v[160:163], v46 offset:32
  ds_read_b128 v[164:167], v46 offset:48
  v_mov_b32 v144, 0
  v_mov_b32 v145, 0
  v_mov_b32 v146, 0
  v_mov_b32 v147, 0
  v_mov_b32 v148, 0
  v_mov_b32 v149, 0
  v_mov_b32 v150, 0
  v_mov_b32 v151, 0
  s_waitcnt lgkmcnt(0)
  v_add_f32 v160, v160, v161
  v_add_f32 v162, v162, v163
  v_add_f32 v164, v164, v165
  v_add_f32 v166, v166, v167
  v_add_f32 v160, v160, v162
  v_add_f32 v164, v164, v166
  v_add_f32 v160, v160, v164
  v_rcp_f32 v168, v160
  s_bitcmp1_b32 s73, 0
  s_cbranch_scc1 L_ir_44
  buffer_load_dwordx4 v[128:131], v36, s[32:35], s83 offen offset:0 sc1
L_ir_44:
  s_bitcmp1_b32 s73, 1
  s_cbranch_scc1 L_ir_45
  buffer_load_dwordx4 v[132:135], v36, s[32:35], s84 offen offset:0 sc1
L_ir_45:
  s_bitcmp1_b32 s73, 2
  s_cbranch_scc1 L_ir_46
  buffer_load_dwordx4 v[136:139], v36, s[32:35], s85 offen offset:0 sc1
L_ir_46:
  s_bitcmp1_b32 s73, 3
  s_cbranch_scc1 L_ir_47
  buffer_load_dwordx4 v[140:143], v36, s[32:35], s86 offen offset:0 sc1
L_ir_47:
  s_or_b32 s73, s73, 15
  s_mov_b32 s100, 0
L_p2:
  s_mov_b32 s95, s73
  s_waitcnt vmcnt(0)
  s_bitcmp1_b32 s95, 0
  s_cbranch_scc0 L_dc_48
  s_bitcmp1_b32 s95, 4
  s_cbranch_scc1 L_dc_48
  v_xor_b32 v44, v128, v4
  v_bitop3_b32 v44, v129, v5, v44 bitop3:0xbe
  v_bitop3_b32 v44, v130, v6, v44 bitop3:0xbe
  v_bitop3_b32 v44, v131, v7, v44 bitop3:0xbe
  v_and_b32 v44, s53, v44
  v_cmp_ne_u32 vcc, 0, v44
  s_nop 0
  s_cbranch_vccz L_dc_48k
  s_sleep 1
  buffer_load_dwordx4 v[128:131], v36, s[32:35], s83 offen offset:0 sc1
  s_branch L_dc_48
L_dc_48k:
  s_bitset1_b32 s73, 4
  v_dot2c_f32_bf16 v144, v156, v128
  v_dot2c_f32_bf16 v145, v152, v128
  v_dot2c_f32_bf16 v146, v156, v129
  v_dot2c_f32_bf16 v147, v152, v129
  v_dot2c_f32_bf16 v148, v156, v130
  v_dot2c_f32_bf16 v149, v152, v130
  v_dot2c_f32_bf16 v150, v156, v131
  v_dot2c_f32_bf16 v151, v152, v131
L_dc_48:
  s_bitcmp1_b32 s95, 1
  s_nop 0
  s_cbranch_scc0 L_dc_49
  s_bitcmp1_b32 s95, 5
  s_cbranch_scc1 L_dc_49
  v_xor_b32 v44, v132, v4
  v_bitop3_b32 v44, v133, v5, v44 bitop3:0xbe
  v_bitop3_b32 v44, v134, v6, v44 bitop3:0xbe
  v_bitop3_b32 v44, v135, v7, v44 bitop3:0xbe
  v_and_b32 v44, s53, v44
  v_cmp_ne_u32 vcc, 0, v44
  s_nop 0
  s_cbranch_vccz L_dc_49k
  s_sleep 1
  buffer_load_dwordx4 v[132:135], v36, s[32:35], s84 offen offset:0 sc1
  s_branch L_dc_49
L_dc_49k:
  s_bitset1_b32 s73, 5
  v_dot2c_f32_bf16 v144, v157, v132
  v_dot2c_f32_bf16 v145, v153, v132
  v_dot2c_f32_bf16 v146, v157, v133
  v_dot2c_f32_bf16 v147, v153, v133
  v_dot2c_f32_bf16 v148, v157, v134
  v_dot2c_f32_bf16 v149, v153, v134
  v_dot2c_f32_bf16 v150, v157, v135
  v_dot2c_f32_bf16 v151, v153, v135
L_dc_49:
  s_bitcmp1_b32 s95, 2
  s_nop 0
  s_cbranch_scc0 L_dc_50
  s_bitcmp1_b32 s95, 6
  s_cbranch_scc1 L_dc_50
  v_xor_b32 v44, v136, v4
  v_bitop3_b32 v44, v137, v5, v44 bitop3:0xbe
  v_bitop3_b32 v44, v138, v6, v44 bitop3:0xbe
  v_bitop3_b32 v44, v139, v7, v44 bitop3:0xbe
  v_and_b32 v44, s53, v44
  v_cmp_ne_u32 vcc, 0, v44
  s_nop 0
  s_cbranch_vccz L_dc_50k
  s_sleep 1
  buffer_load_dwordx4 v[136:139], v36, s[32:35], s85 offen offset:0 sc1
  s_branch L_dc_50
L_dc_50k:
  s_bitset1_b32 s73, 6
  v_dot2c_f32_bf16 v144, v158, v136
  v_dot2c_f32_bf16 v145, v154, v136
  v_dot2c_f32_bf16 v146, v158, v137
  v_dot2c_f32_bf16 v147, v154, v137
  v_dot2c_f32_bf16 v148, v158, v138
  v_dot2c_f32_bf16 v149, v154, v138
  v_dot2c_f32_bf16 v150, v158, v139
  v_dot2c_f32_bf16 v151, v154, v139
L_dc_50:
  s_bitcmp1_b32 s95, 3
  s_nop 0
  s_cbranch_scc0 L_dc_51
  s_bitcmp1_b32 s95, 7
  s_cbranch_scc1 L_dc_51
  v_xor_b32 v44, v140, v4
  v_bitop3_b32 v44, v141, v5, v44 bitop3:0xbe
  v_bitop3_b32 v44, v142, v6, v44 bitop3:0xbe
  v_bitop3_b32 v44, v143, v7, v44 bitop3:0xbe
  v_and_b32 v44, s53, v44
  v_cmp_ne_u32 vcc, 0, v44
  s_nop 0
  s_cbranch_vccz L_dc_51k
  s_sleep 1
  buffer_load_dwordx4 v[140:143], v36, s[32:35], s86 offen offset:0 sc1
  s_branch L_dc_51
L_dc_51k:
  s_bitset1_b32 s73, 7
  v_dot2c_f32_bf16 v144, v159, v140
  v_dot2c_f32_bf16 v145, v155, v140
  v_dot2c_f32_bf16 v146, v159, v141
  v_dot2c_f32_bf16 v147, v155, v141
  v_dot2c_f32_bf16 v148, v159, v142
  v_dot2c_f32_bf16 v149, v155, v142
  v_dot2c_f32_bf16 v150, v159, v143
  v_dot2c_f32_bf16 v151, v155, v143
L_dc_51:
  s_cmp_eq_u32 s73, 0xff
  s_nop 0
  s_cbranch_scc1 L_p2x
  s_add_u32 s100, s100, 1
  s_cmp_gt_u32 s100, 1000000
  s_cbranch_scc1 L_abort
  s_branch L_p2
L_p2x:
  v_permlane32_swap_b32 v144, v148
  v_permlane32_swap_b32 v145, v149
  v_permlane32_swap_b32 v146, v150
  v_permlane32_swap_b32 v147, v151
  v_add_f32 v144, v144, v148
  v_add_f32 v145, v145, v149
  v_add_f32 v146, v146, v150
  v_add_f32 v147, v147, v151
  s_nop 0
  v_permlane16_swap_b32 v144, v146
  v_permlane16_swap_b32 v145, v147
  v_add_f32 v144, v144, v146
  v_add_f32 v145, v145, v147
  s_nop 0
  v_add_f32_dpp v144, v144, v144 row_ror:8 row_mask:0xf bank_mask:0xf
  v_add_f32_dpp v145, v145, v145 row_ror:8 row_mask:0xf bank_mask:0xf
  v_mul_f32 v144, v144, v168
  v_mul_f32 v145, v145, v168
  v_cvt_pk_bf16_f32 v44, v144, v145
  ds_write_b32 v37, v44
  s_waitcnt lgkmcnt(0)
  s_barrier
  ds_read_b128 v[160:163], v38
  ds_read_b128 v[164:167], v38 offset:64
  s_waitcnt lgkmcnt(1)
  v_mfma_f32_16x16x32_bf16 v[144:147], v[48:51], v[160:163], 0
  s_waitcnt lgkmcnt(0)
  v_mfma_f32_16x16x32_bf16 v[144:147], v[52:55], v[164:167], v[144:147]
  s_nop 7
  v_add_f32_dpp v144, v144, v144 quad_perm:[1,0,3,2] row_mask:0xf bank_mask:0xf
  v_add_f32_dpp v145, v145, v145 quad_perm:[1,0,3,2] row_mask:0xf bank_mask:0xf
  v_add_f32_dpp v146, v146, v146 quad_perm:[1,0,3,2] row_mask:0xf bank_mask:0xf
  v_add_f32_dpp v147, v147, v147 quad_perm:[1,0,3,2] row_mask:0xf bank_mask:0xf
  v_add_f32_dpp v144, v144, v144 quad_perm:[2,3,0,1] row_mask:0xf bank_mask:0xf
  v_add_f32_dpp v145, v145, v145 quad_perm:[2,3,0,1] row_mask:0xf bank_mask:0xf
  v_add_f32_dpp v146, v146, v146 quad_perm:[2,3,0,1] row_mask:0xf bank_mask:0xf
  v_add_f32_dpp v147, v147, v147 quad_perm:[2,3,0,1] row_mask:0xf bank_mask:0xf
  v_add_f32_dpp v144, v144, v144 row_half_mirror row_mask:0xf bank_mask:0xf
  v_add_f32_dpp v145, v145, v145 row_half_mirror row_mask:0xf bank_mask:0xf
  v_add_f32_dpp v146, v146, v146 row_half_mirror row_mask:0xf bank_mask:0xf
  v_add_f32_dpp v147, v147, v147 row_half_mirror row_mask:0xf bank_mask:0xf
  s_mov_b32 exec_lo, 0x10001
  s_mov_b32 exec_hi, 0x10001
  v_and_or_b32 v144, v144, v2, s49
  v_and_or_b32 v145, v145, v2, s50
  v_and_or_b32 v146, v146, v2, s51
  v_and_or_b32 v147, v147, v2, s52
  buffer_store_dwordx4 v[144:147], v1, s[32:35], s16 offen sc1
  s_mov_b64 exec, -1
  s_cmp_lt_u32 s2, 128
  s_cbranch_scc0 L_X
  s_mov_b32 s60, 0xffffffff
  s_mov_b32 s61, 0x0
  s_mov_b32 s100, 0
  s_branch L_gf_53
L_g_52:
  s_add_u32 s100, s100, 1
  s_cmp_gt_u32 s100, 1000000
  s_cbranch_scc1 L_abort
  s_sleep 1
L_gf_53:
  s_mov_b64 exec, s[60:61]
  buffer_load_dwordx4 v[128:131], v39, s[32:35], 0 offen offset:0 sc1
  s_waitcnt vmcnt(0)
L_gc_54:
  s_mov_b64 exec, s[60:61]
  v_perm_b32 v44, v129, v128, s56
  v_perm_b32 v44, v130, v44, s57
  v_perm_b32 v44, v131, v44, s58
  v_cmp_ne_u32 s[60:61], s48, v44
  s_nop 0
  s_cmp_lg_u64 s[60:61], 0
  s_cbranch_scc1 L_g_52
  s_mov_b64 exec, -1
  v_cvt_pk_bf16_f32 v44, v128, v129
  v_cvt_pk_bf16_f32 v45, v130, v131
  s_mov_b32 exec_hi, 0
  ds_write_b64 v43, v[44:45]
  s_mov_b32 exec_hi, -1
  s_waitcnt lgkmcnt(0)
  s_barrier
  ds_read_b128 v[128:131], v40 offset:0
  ds_read_b128 v[132:135], v40 offset:64
  ds_read_b128 v[136:139], v40 offset:128
  ds_read_b128 v[140:143], v40 offset:192
  s_waitcnt lgkmcnt(3)
  v_mfma_f32_16x16x32_bf16 v[144:147], v[80:83], v[128:131], 0
  s_waitcnt lgkmcnt(2)
  v_mfma_f32_16x16x32_bf16 v[144:147], v[84:87], v[132:135], v[144:147]
  s_waitcnt lgkmcnt(1)
  v_mfma_f32_16x16x32_bf16 v[144:147], v[88:91], v[136:139], v[144:147]
  s_waitcnt lgkmcnt(0)
  v_mfma_f32_16x16x32_bf16 v[144:147], v[92:95], v[140:143], v[144:147]
  s_nop 7
  v_add_f32_dpp v144, v144, v144 quad_perm:[1,0,3,2] row_mask:0xf bank_mask:0xf
  v_add_f32_dpp v145, v145, v145 quad_perm:[1,0,3,2] row_mask:0xf bank_mask:0xf
  v_add_f32_dpp v146, v146, v146 quad_perm:[1,0,3,2] row_mask:0xf bank_mask:0xf
  v_add_f32_dpp v147, v147, v147 quad_perm:[1,0,3,2] row_mask:0xf bank_mask:0xf
  v_add_f32_dpp v144, v144, v144 quad_perm:[2,3,0,1] row_mask:0xf bank_mask:0xf
  v_add_f32_dpp v145, v145, v145 quad_perm:[2,3,0,1] row_mask:0xf bank_mask:0xf
  v_add_f32_dpp v146, v146, v146 quad_perm:[2,3,0,1] row_mask:0xf bank_mask:0xf
  v_add_f32_dpp v147, v147, v147 quad_perm:[2,3,0,1] row_mask:0xf bank_mask:0xf
  v_add_f32_dpp v144, v144, v144 row_half_mirror row_mask:0xf bank_mask:0xf
  v_add_f32_dpp v145, v145, v145 row_half_mirror row_mask:0xf bank_mask:0xf
  v_add_f32_dpp v146, v146, v146 row_half_mirror row_mask:0xf bank_mask:0xf
  v_add_f32_dpp v147, v147, v147 row_half_mirror row_mask:0xf bank_mask:0xf
  s_mov_b32 exec_lo, 0x10001
  s_mov_b32 exec_hi, 0x10001
  v_and_or_b32 v144, v144, v2, s49
  v_and_or_b32 v145, v145, v2, s50
  v_and_or_b32 v146, v146, v2, s51
  v_and_or_b32 v147, v147, v2, s52
  buffer_store_dwordx4 v[144:147], v1, s[32:35], s75 offen sc1
  s_mov_b64 exec, -1
  s_branch L_Y
L_X:
  s_lshl_b32 s92, s79, 6
  v_and_b32 v44, 31, v1
  v_lshlrev_b32 v44, 1, v44
  v_add_u32 v44, s92, v44
  global_load_ushort v66, v44, s[4:5]
  s_movk_i32 s68, 0x4000
  buffer_load_dwordx4 v[68:71], v56, s[32:35], 0 offen offset:0 sc1
  buffer_load_dwordx4 v[72:75], v56, s[32:35], s68 offen offset:0 sc1
  s_waitcnt vmcnt(0)
  s_mov_b64 s[60:61], -1
  s_waitcnt vmcnt(63)
  s_mov_b32 s100, 0
  s_branch L_gc_59
L_g_57:
  s_add_u32 s100, s100, 1
  s_cmp_gt_u32 s100, 1000000
  s_cbranch_scc1 L_abort
  s_sleep 2
L_gf_58:
  s_mov_b64 exec, s[60:61]
  buffer_load_dwordx4 v[68:71], v56, s[32:35], 0 offen offset:0 sc1
  buffer_load_dwordx4 v[72:75], v56, s[32:35], s68 offen offset:0 sc1
  s_waitcnt vmcnt(0)
L_gc_59:
  s_mov_b64 exec, s[60:61]
  v_perm_b32 v44, v69, v68, s56
  v_perm_b32 v44, v70, v44, s57
  v_perm_b32 v44, v71, v44, s58
  v_cmp_ne_u32 s[60:61], s48, v44
  v_perm_b32 v44, v73, v72, s56
  v_perm_b32 v44, v74, v44, s57
  v_perm_b32 v44, v75, v44, s58
  v_cmp_ne_u32 vcc, s48, v44
  s_nop 0
  s_or_b64 s[60:61], s[60:61], vcc
  s_cmp_lg_u64 s[60:61], 0
  s_cbranch_scc1 L_g_57
  s_mov_b64 exec, -1
  v_permlane32_swap_b32 v68, v70
  v_permlane32_swap_b32 v69, v71
  v_add_f32 v68, v68, v70
  v_add_f32 v69, v69, v71
  s_nop 1
  v_permlane16_swap_b32 v68, v69
  v_add_f32 v68, v68, v69
  v_permlane32_swap_b32 v72, v74
  v_permlane32_swap_b32 v73, v75
  v_add_f32 v72, v72, v74
  v_add_f32 v73, v73, v75
  s_nop 1
  v_permlane16_swap_b32 v72, v73
  v_add_f32 v72, v72, v73
  v_cvt_pk_bf16_f32 v44, v68, v68
  v_and_b32 v68, 0xffff0000, v44
  v_cvt_pk_bf16_f32 v45, v72, v72
  v_and_b32 v72, 0xffff0000, v45
  v_and_b32 v44, 3, v1
  v_lshlrev_b32 v44, 6, v44
  v_bfe_u32 v3, v1, 2, 3
  v_lshl_add_u32 v44, v3, 2, v44
  ds_bpermute_b32 v76, v44, v68 offset:0
  ds_bpermute_b32 v77, v44, v68 offset:32
  ds_bpermute_b32 v78, v44, v72 offset:0
  ds_bpermute_b32 v79, v44, v72 offset:32
  s_lshr_b32 s92, s82, 12
  s_lshl_b32 s92, s92, 12
  s_add_u32 s94, s82, s92
  s_add_u32 s94, s94, 1114112
  s_add_u32 s82, s82, 851968
  v_bfe_u32 v45, v1, 2, 1
  v_lshlrev_b32 v45, 6, v45
  v_add_u32 v45, v45, v41
  v_bfe_u32 v69, v1, 2, 1
  v_lshlrev_b32 v69, 12, v69
  v_and_b32 v3, 3, v1
  v_lshl_add_u32 v69, v3, 6, v69
  v_lshrrev_b32 v3, 4, v1
  v_lshl_add_u32 v69, v3, 4, v69
  s_waitcnt lgkmcnt(0)
  v_add_f32 v78, 1.0, v78
  v_lshlrev_b32 v66, 16, v66
  v_cvt_pk_bf16_f32 v44, v78, v78
  v_and_b32 v78, 0xffff0000, v44
  s_cmp_eq_u32 s3, 7
  s_cbranch_scc1 L_ab_56
  ds_write_b16_d16_hi v57, v78
  ds_write_b16_d16_hi v57, v77 offset:64
  ds_read_b128 v[72:75], v45
  s_waitcnt lgkmcnt(0)
  v_mfma_f32_16x16x32_bf16 v[208:211], v[80:83], v[72:75], 0
  v_mfma_f32_16x16x32_bf16 v[212:215], v[84:87], v[72:75], 0
  v_mfma_f32_16x16x32_bf16 v[216:219], v[88:91], v[72:75], 0
  v_mfma_f32_16x16x32_bf16 v[220:223], v[92:95], v[72:75], 0
  s_mov_b32 exec_lo, 0x220022
  s_mov_b32 exec_hi, 0x220022
  s_nop 3
  v_mov_b32 v208, v212
  v_mov_b32 v209, v213
  v_mov_b32 v210, v214
  v_mov_b32 v211, v215
  s_mov_b32 exec_lo, 0x440044
  s_mov_b32 exec_hi, 0x440044
  v_mov_b32 v208, v216
  v_mov_b32 v209, v217
  v_mov_b32 v210, v218
  v_mov_b32 v211, v219
  s_mov_b32 exec_lo, 0x880088
  s_mov_b32 exec_hi, 0x880088
  v_mov_b32 v208, v220
  v_mov_b32 v209, v221
  v_mov_b32 v210, v222
  v_mov_b32 v211, v223
  s_mov_b32 exec_lo, 0xff00ff
  s_mov_b32 exec_hi, 0xff00ff
  v_and_or_b32 v208, v208, v2, s49
  v_and_or_b32 v209, v209, v2, s50
  v_and_or_b32 v210, v210, v2, s51
  v_and_or_b32 v211, v211, v2, s52
  buffer_store_dwordx4 v[208:211], v69, s[32:35], s94 offen sc1
  s_mov_b64 exec, -1
L_ab_56:
  v_mov_b32 v112, 0
  v_mov_b32 v113, 0
  v_mov_b32 v114, 0
  v_mov_b32 v115, 0
  s_mov_b32 s60, 0xffffffff
  s_mov_b32 s61, 0x0
  s_mov_b32 s100, 0
  s_branch L_gf_62
L_g_61:
  s_add_u32 s100, s100, 1
  s_cmp_gt_u32 s100, 1000000
  s_cbranch_scc1 L_abort
  s_sleep 1
L_gf_62:
  s_mov_b64 exec, s[60:61]
  buffer_load_dwordx4 v[112:115], v61, s[32:35], s90 offen offset:0 sc1
  s_waitcnt vmcnt(0)
L_gc_63:
  s_mov_b64 exec, s[60:61]
  v_perm_b32 v44, v113, v112, s56
  v_perm_b32 v44, v114, v44, s57
  v_perm_b32 v44, v115, v44, s58
  v_cmp_ne_u32 s[60:61], s48, v44
  s_nop 0
  s_cmp_lg_u64 s[60:61], 0
  s_cbranch_scc1 L_g_61
  s_mov_b64 exec, -1
  v_permlane32_swap_b32 v112, v114
  v_permlane32_swap_b32 v113, v115
  v_add_f32 v112, v112, v114
  v_add_f32 v113, v113, v115
  s_nop 1
  v_permlane16_swap_b32 v112, v113
  v_add_f32 v112, v112, v113
  s_nop 1
  v_add_f32_dpp v112, v112, v112 row_ror:8 row_mask:0xf bank_mask:0xf
  ds_write_b32 v59, v112
  s_waitcnt lgkmcnt(0)
  s_barrier
  ds_read_b128 v[112:115], v60
  ds_read_b128 v[116:119], v60 offset:16
  s_waitcnt lgkmcnt(0)
  v_add_f32 v112, v112, v113
  v_add_f32 v114, v114, v115
  v_add_f32 v116, v116, v117
  v_add_f32 v118, v118, v119
  v_add_f32 v112, v112, v114
  v_add_f32 v116, v116, v118
  v_add_f32 v112, v112, v116
  v_cvt_pk_bf16_f32 v44, v112, v112
  v_and_b32 v112, 0xffff0000, v44
  v_mul_f32 v67, v76, v112
  v_cvt_pk_bf16_f32 v44, v67, v67
  v_and_b32 v67, 0xffff0000, v44
  v_add_f32 v67, v66, v67
  v_cvt_pk_bf16_f32 v44, v67, v67
  v_and_b32 v67, 0xffff0000, v44
  s_cmp_eq_u32 s3, 7
  s_cbranch_scc1 L_stat
  v_mul_f32 v44, v67, v78
  v_cvt_pk_bf16_f32 v44, v44, v44
  ds_write_b16 v57, v44
  ds_read_b128 v[160:163], v41
  s_mov_b32 s70, 0x20002
  s_mov_b32 s71, 0x20002
  s_mov_b32 s72, 0x40004
  s_mov_b32 s73, 0x40004
  s_mov_b32 s74, 0x80008
  s_mov_b32 s75, 0x80008
  s_waitcnt lgkmcnt(0)
  v_mfma_f32_16x16x32_bf16 v[128:131], v[80:83], v[160:163], 0
  v_mfma_f32_16x16x32_bf16 v[132:135], v[84:87], v[160:163], 0
  v_mfma_f32_16x16x32_bf16 v[136:139], v[88:91], v[160:163], 0
  v_mfma_f32_16x16x32_bf16 v[140:143], v[92:95], v[160:163], 0
  s_nop 5
  v_cndmask_b32 v128, v128, v132, s[70:71]
  v_cndmask_b32 v129, v129, v133, s[70:71]
  v_cndmask_b32 v130, v130, v134, s[70:71]
  v_cndmask_b32 v131, v131, v135, s[70:71]
  v_cndmask_b32 v128, v128, v136, s[72:73]
  v_cndmask_b32 v129, v129, v137, s[72:73]
  v_cndmask_b32 v130, v130, v138, s[72:73]
  v_cndmask_b32 v131, v131, v139, s[72:73]
  v_cndmask_b32 v128, v128, v140, s[74:75]
  v_cndmask_b32 v129, v129, v141, s[74:75]
  v_cndmask_b32 v130, v130, v142, s[74:75]
  v_cndmask_b32 v131, v131, v143, s[74:75]
  v_and_or_b32 v128, v128, v2, s49
  v_and_or_b32 v129, v129, v2, s50
  v_and_or_b32 v130, v130, v2, s51
  v_and_or_b32 v131, v131, v2, s52
  s_mov_b32 exec_lo, 0xf000f
  s_mov_b32 exec_hi, 0xf000f
  buffer_store_dwordx4 v[128:131], v58, s[32:35], s82 offen sc1
  s_mov_b64 exec, -1
  s_branch L_xdone
L_stat:
  v_mov_b32 v130, v67
  v_mul_f32 v131, v67, v67
  s_nop 0
  v_add_f32_dpp v130, v130, v130 row_ror:8 row_mask:0xf bank_mask:0xf
  v_add_f32_dpp v131, v131, v131 row_ror:8 row_mask:0xf bank_mask:0xf
  s_nop 0
  v_add_f32_dpp v130, v130, v130 row_ror:4 row_mask:0xf bank_mask:0xf
  v_add_f32_dpp v131, v131, v131 row_ror:4 row_mask:0xf bank_mask:0xf
  s_nop 0
  v_add_f32_dpp v130, v130, v130 row_ror:2 row_mask:0xf bank_mask:0xf
  v_add_f32_dpp v131, v131, v131 row_ror:2 row_mask:0xf bank_mask:0xf
  s_nop 0
  v_add_f32_dpp v130, v130, v130 row_ror:1 row_mask:0xf bank_mask:0xf
  v_add_f32_dpp v131, v131, v131 row_ror:1 row_mask:0xf bank_mask:0xf
  v_mov_b32 v128, v130
  v_mov_b32 v129, v131
  s_nop 0
  v_permlane16_swap_b32 v130, v128
  v_permlane16_swap_b32 v131, v129
  v_add_f32 v130, v130, v128
  v_add_f32 v131, v131, v129
  v_and_b32 v128, v2, v130
  v_and_b32 v129, v2, v131
  v_sub_f32 v130, v130, v128
  v_sub_f32 v131, v131, v129
  v_and_or_b32 v128, v128, v2, s49
  v_and_or_b32 v129, v129, v2, s50
  v_and_or_b32 v130, v130, v2, s51
  v_and_or_b32 v131, v131, v2, s52
  s_lshl_b32 s92, s80, 11
  s_lshl_b32 s97, s79, 7
  s_add_u32 s92, s92, s97
  s_add_u32 s92, s92, 0x18000
  s_mov_b64 exec, 1
  buffer_store_dwordx4 v[128:131], v1, s[32:35], s92 offen sc1
  s_mov_b64 exec, -1
  v_mov_b32 v112, 0
L_xdone:
  s_cmp_lg_u32 s80, 0
  s_cbranch_scc1 L_fin
  s_mul_i32 s90, s79, 8448
  s_lshl_b32 s97, s3, 10
  s_add_u32 s90, s90, s97
  s_add_u32 s90, s90, 0xa0000
  s_lshl_b32 s92, s79, 6
  v_and_b32 v46, 31, v1
  v_lshlrev_b32 v46, 1, v46
  v_add_u32 v46, s92, v46
  s_cmp_eq_u32 s3, 7
  s_cbranch_scc1 L_nof
  s_mov_b64 s[60:61], -1
  s_mov_b32 s100, 0
  s_branch L_gf_66
L_g_65:
  s_add_u32 s100, s100, 1
  s_cmp_gt_u32 s100, 1000000
  s_cbranch_scc1 L_abort
  s_sleep 1
L_gf_66:
  s_mov_b64 exec, s[60:61]
  buffer_load_dwordx4 v[112:115], v34, s[32:35], s90 offen offset:0 sc1
  s_waitcnt vmcnt(0)
L_gc_67:
  s_mov_b64 exec, s[60:61]
  v_perm_b32 v44, v113, v112, s56
  v_perm_b32 v44, v114, v44, s57
  v_perm_b32 v44, v115, v44, s58
  v_cmp_ne_u32 s[60:61], s48, v44
  s_nop 0
  s_cmp_lg_u64 s[60:61], 0
  s_cbranch_scc1 L_g_65
  s_mov_b64 exec, -1
  v_permlane32_swap_b32 v112, v114
  v_permlane32_swap_b32 v113, v115
  v_add_f32 v112, v112, v114
  v_add_f32 v113, v113, v115
  s_nop 1
  v_permlane16_swap_b32 v112, v113
  v_add_f32 v112, v112, v113
  s_nop 1
  v_add_f32_dpp v112, v112, v112 row_ror:8 row_mask:0xf bank_mask:0xf
L_nof:
  ds_write_b32 v59, v112 offset:1024
  s_waitcnt lgkmcnt(0)
  s_barrier
  s_cmp_lg_u32 s3, 0
  s_cbranch_scc1 L_fin
  ds_read_b128 v[112:115], v60 offset:1024
  ds_read_b128 v[116:119], v60 offset:1040
  s_waitcnt lgkmcnt(0)
  v_add_f32 v112, v112, v113
  v_add_f32 v114, v114, v115
  v_add_f32 v116, v116, v117
  v_add_f32 v118, v118, v119
  v_add_f32 v112, v112, v114
  v_add_f32 v116, v116, v118
  v_add_f32 v112, v112, v116
  v_cvt_pk_bf16_f32 v45, v112, v112
  v_and_b32 v112, 0xffff0000, v45
  v_mul_f32 v44, v79, v112
  v_cvt_pk_bf16_f32 v45, v44, v44
  v_and_b32 v44, 0xffff0000, v45
  v_add_f32 v44, v67, v44
  v_cvt_pk_bf16_f32 v44, v44, v44
  s_mov_b32 exec_hi, 0
  global_store_short v46, v44, s[28:29]
  s_cmp_lg_u32 s2, 128
  s_cbranch_scc1 L_noep
  s_mov_b64 exec, 1
  v_mov_b32 v45, 0
  global_store_dword v45, v45, s[30:31]
L_noep:
L_fin:
  s_endpgm
L_Y:
  s_cmp_ge_u32 s2, 112
  s_cbranch_scc1 L_fin
  s_lshl_b32 s94, s81, 13
  s_lshl_b32 s97, s3, 10
  s_add_u32 s94, s94, s97
  s_add_u32 s94, s94, 0x110000
  buffer_load_dwordx4 v[76:79], v34, s[32:35], s94 offen offset:0 sc1
  s_mov_b64 s[40:41], s[22:23]
  s_mov_b32 s42, 0x1c0000
  s_mov_b32 s43, 0x20000
  v_lshrrev_b32 v44, 5, v1
  v_lshlrev_b32 v44, 10, v44
  v_and_b32 v3, 31, v1
  v_lshl_add_u32 v44, v3, 4, v44
  buffer_load_dwordx4 v[176:179], v44, s[40:43], s91 offen offset:0 nt
  buffer_load_dwordx4 v[180:183], v44, s[40:43], s91 offen offset:2048 nt
  v_mov_b32 v112, 0
  v_mov_b32 v113, 0
  v_mov_b32 v114, 0
  v_mov_b32 v115, 0
  v_lshlrev_b32 v46, 4, v1
  v_add_u32 v46, 88064, v46
  v_lshlrev_b32 v47, 5, v1
  v_add_u32 v47, 83968, v47
  s_mov_b64 s[60:61], -1
  s_waitcnt vmcnt(2)
  s_mov_b32 s100, 0
  s_branch L_gc_71
L_g_69:
  s_add_u32 s100, s100, 1
  s_cmp_gt_u32 s100, 1000000
  s_cbranch_scc1 L_abort
  s_sleep 2
L_gf_70:
  s_mov_b64 exec, s[60:61]
  buffer_load_dwordx4 v[76:79], v34, s[32:35], s94 offen offset:0 sc1
  s_waitcnt vmcnt(0)
L_gc_71:
  s_mov_b64 exec, s[60:61]
  v_perm_b32 v44, v77, v76, s56
  v_perm_b32 v44, v78, v44, s57
  v_perm_b32 v44, v79, v44, s58
  v_cmp_ne_u32 s[60:61], s48, v44
  s_nop 0
  s_cmp_lg_u64 s[60:61], 0
  s_cbranch_scc1 L_g_69
  s_mov_b64 exec, -1
  v_permlane32_swap_b32 v76, v78
  v_permlane32_swap_b32 v77, v79
  v_add_f32 v76, v76, v78
  v_add_f32 v77, v77, v79
  s_nop 1
  v_permlane16_swap_b32 v76, v77
  v_add_f32 v76, v76, v77
  s_waitcnt vmcnt(0)
  ds_write_b128 v62, v[176:179] offset:0
  ds_write_b128 v62, v[180:183] offset:1088
  ds_write_b32 v60, v76
  s_waitcnt lgkmcnt(0)
  s_barrier
  ds_read_b128 v[128:131], v46
  ds_read_b128 v[132:135], v46 offset:1024
  ds_read_b64_tr_b16 v[68:69], v63 offset:0
  ds_read_b64_tr_b16 v[70:71], v63 offset:2176
  ds_read_b64_tr_b16 v[72:73], v63 offset:32
  ds_read_b64_tr_b16 v[74:75], v63 offset:2208
  s_waitcnt lgkmcnt(4)
  v_add_f32 v128, v128, v129
  v_add_f32 v130, v130, v131
  v_add_f32 v128, v128, v130
  v_add_f32 v132, v132, v133
  v_add_f32 v134, v134, v135
  v_add_f32 v132, v132, v134
  s_mov_b32 s60, 0xffffffff
  s_mov_b32 s61, 0x0
  s_mov_b32 s62, 0xffff
  s_mov_b32 s63, 0x0
  s_mov_b32 s100, 0
  s_branch L_gf_74
L_g_73:
  s_add_u32 s100, s100, 1
  s_cmp_gt_u32 s100, 1000000
  s_cbranch_scc1 L_abort
  s_sleep 1
L_gf_74:
  s_mov_b64 exec, s[60:61]
  s_cbranch_execz L_gs_76
  buffer_load_dwordx4 v[112:115], v61, s[32:35], s82 offen offset:0 sc1
L_gs_76:
  s_mov_b64 exec, s[62:63]
  s_cbranch_execz L_gs_77
  buffer_load_dwordx4 v[136:139], v56, s[32:35], 0 offen offset:0 sc1
L_gs_77:
  s_waitcnt vmcnt(0)
L_gc_75:
  s_mov_b64 exec, s[60:61]
  v_perm_b32 v44, v113, v112, s56
  v_perm_b32 v44, v114, v44, s57
  v_perm_b32 v44, v115, v44, s58
  v_cmp_ne_u32 s[60:61], s48, v44
  s_mov_b64 exec, s[62:63]
  v_perm_b32 v44, v137, v136, s56
  v_perm_b32 v44, v138, v44, s57
  v_perm_b32 v44, v139, v44, s58
  v_cmp_ne_u32 s[62:63], s48, v44
  s_nop 0
  s_or_b64 s[96:97], s[60:61], s[62:63]
  s_cbranch_scc1 L_g_73
  s_mov_b64 exec, -1
  v_permlane32_swap_b32 v112, v114
  v_permlane32_swap_b32 v113, v115
  v_add_f32 v112, v112, v114
  v_add_f32 v113, v113, v115
  s_nop 1
  v_permlane16_swap_b32 v112, v113
  v_add_f32 v112, v112, v113
  ds_write_b32 v59, v112
  v_add_f32 v136, v136, v138
  v_add_f32 v137, v137, v139
  s_nop 0
  v_add_f32_dpp v136, v136, v136 quad_perm:[1,0,3,2] row_mask:0xf bank_mask:0xf
  v_add_f32_dpp v137, v137, v137 quad_perm:[1,0,3,2] row_mask:0xf bank_mask:0xf
  s_nop 0
  v_add_f32_dpp v136, v136, v136 quad_perm:[2,3,0,1] row_mask:0xf bank_mask:0xf
  v_add_f32_dpp v137, v137, v137 quad_perm:[2,3,0,1] row_mask:0xf bank_mask:0xf
  s_nop 0
  v_add_f32_dpp v136, v136, v136 row_half_mirror row_mask:0xf bank_mask:0xf
  v_add_f32_dpp v137, v137, v137 row_half_mirror row_mask:0xf bank_mask:0xf
  s_nop 0
  v_add_f32_dpp v136, v136, v136 row_ror:8 row_mask:0xf bank_mask:0xf
  v_add_f32_dpp v137, v137, v137 row_ror:8 row_mask:0xf bank_mask:0xf
  s_waitcnt lgkmcnt(0)
  s_barrier
  ds_read_b128 v[112:115], v47
  ds_read_b128 v[116:119], v47 offset:16
  v_readfirstlane_b32 s92, v136
  v_readfirstlane_b32 s93, v137
  v_mov_b32 v44, 0x3b000000
  v_mul_f32 v136, s92, v44
  v_mul_f32 v137, s93, v44
  v_fma_f32 v137, -v136, v136, v137
  v_max_f32 v137, 0, v137
  v_cvt_pk_bf16_f32 v45, v137, v137
  v_and_b32 v137, 0xffff0000, v45
  v_cvt_pk_bf16_f32 v44, v136, v136
  v_and_b32 v136, 0xffff0000, v44
  v_add_f32 v137, 0x3727c5ac, v137
  v_mul_f32 v128, v136, v128
  v_cvt_pk_bf16_f32 v45, v137, v137
  v_and_b32 v137, 0xffff0000, v45
  v_sqrt_f32 v137, v137
  s_nop 0
  v_cvt_pk_bf16_f32 v45, v137, v137
  v_and_b32 v137, 0xffff0000, v45
  v_rcp_f32 v137, v137
  s_waitcnt lgkmcnt(0)
  v_add_f32 v112, v112, v113
  v_add_f32 v114, v114, v115
  v_add_f32 v116, v116, v117
  v_add_f32 v118, v118, v119
  v_add_f32 v112, v112, v114
  v_add_f32 v116, v116, v118
  v_add_f32 v112, v112, v116
  v_sub_f32 v112, v112, v128
  v_fma_f32 v112, v112, v137, v132
  v_cvt_pk_bf16_f32 v44, v112, v112
  v_and_b32 v112, 0xffff0000, v44
  v_mul_f32 v44, v112, v112
  v_mov_b32 v45, 0xc0135761
  v_mov_b32_dpp v113, v112 row_ror:8 row_mask:0xf bank_mask:0xf
  v_fmac_f32 v45, 0xbdd2d3e8, v44
  v_mul_f32 v44, v45, v112
  v_exp_f32 v44, v44
  s_nop 0
  v_add_f32 v44, 1.0, v44
  v_rcp_f32 v44, v44
  s_nop 0
  v_mul_f32 v112, v112, v44
  v_cvt_pk_bf16_f32 v44, v112, v112
  v_and_b32 v112, 0xffff0000, v44
  v_mul_f32 v112, v112, v113
  v_cvt_pk_bf16_f32 v44, v112, v112
  s_mov_b32 exec_lo, 0xff00ff
  s_mov_b32 exec_hi, 0xff00ff
  ds_write_b16 v57, v44
  s_mov_b64 exec, -1
  ds_read_b128 v[160:163], v41
  s_mov_b32 s70, 0x20002
  s_mov_b32 s71, 0x20002
  s_waitcnt lgkmcnt(0)
  v_mfma_f32_16x16x32_bf16 v[144:147], v[68:71], v[160:163], 0
  v_mfma_f32_16x16x32_bf16 v[148:151], v[72:75], v[160:163], 0
  s_nop 7
  v_cndmask_b32 v144, v144, v148, s[70:71]
  v_cndmask_b32 v145, v145, v149, s[70:71]
  v_cndmask_b32 v146, v146, v150, s[70:71]
  v_cndmask_b32 v147, v147, v151, s[70:71]
  v_and_or_b32 v144, v144, v2, s49
  v_and_or_b32 v145, v145, v2, s50
  v_and_or_b32 v146, v146, v2, s51
  v_and_or_b32 v147, v147, v2, s52
  s_mov_b32 exec_lo, 0x30003
  s_mov_b32 exec_hi, 0x30003
  buffer_store_dwordx4 v[144:147], v58, s[32:35], s90 offen sc1
  s_endpgm
L_abort:
  s_endpgm
L_end:
  s_endpgm
L_codeend:
.section .rodata,"a"
.p2align 6
.amdhsa_kernel adaLN_cond__compressed_kv_cla__glu_gated_geglu__decode_kernel
  .amdhsa_next_free_vgpr 256
  .amdhsa_next_free_sgpr 102
  .amdhsa_accum_offset 256
  .amdhsa_group_segment_fixed_size 0
  .amdhsa_kernarg_size 120
  .amdhsa_user_sgpr_count 2
  .amdhsa_user_sgpr_kernarg_segment_ptr 1
  .amdhsa_system_sgpr_workgroup_id_x 1
.end_amdhsa_kernel
```

```asm
; @launch grid=(256,1,1) block=(512,1,1) lds=163840
.amdgcn_target "amdgcn-amd-amdhsa--gfx950"
.text
.globl adaLN_cond__compressed_kv_cla__glu_gated_geglu__decode_kernel
.p2align 8
.type adaLN_cond__compressed_kv_cla__glu_gated_geglu__decode_kernel,@function
adaLN_cond__compressed_kv_cla__glu_gated_geglu__decode_kernel:
  s_cmp_ge_u32 s2, 256
  s_cbranch_scc1 L_end
  s_load_dwordx16 s[4:19], s[0:1], 0
  s_load_dwordx8 s[20:27], s[0:1], 64
  s_load_dwordx4 s[28:31], s[0:1], 96
  s_load_dwordx2 s[32:33], s[0:1], 112
  v_lshrrev_b32 v1, 6, v0
  s_mov_b32 s34, 0x10000000
  s_mov_b32 s35, 0x20000
  v_readfirstlane_b32 s3, v1
  v_and_b32 v1, 63, v0
  v_mov_b32 v8, 0
  v_mov_b32 v20, 0
  v_mov_b32 v251, 0
  v_mov_b32 v253, 0
  s_cmp_lt_u32 s2, 128
  s_cbranch_scc0 L_B
  v_lshlrev_b32 v38, 4, v1
  s_bfe_u32 s82, s2, 0x30003
  s_lshl_b32 s82, s82, 19
  s_lshl_b32 s97, s3, 16
  s_add_u32 s82, s82, s97
  s_and_b32 s97, s2, 7
  s_lshl_b32 s97, s97, 10
  s_add_u32 s82, s82, s97
  s_mov_b32 s42, 0x400000
  s_mov_b32 s43, 0x20000
  s_bitcmp1_b32 s2, 6
  s_cbranch_scc1 L_K
  v_and_b32 v8, 15, v1
  v_lshlrev_b32 v8, 3, v8
  v_lshrrev_b32 v3, 4, v1
  v_lshl_add_u32 v8, v3, 1, v8
  s_bfe_u32 s92, s2, 0x30003
  s_lshl_b32 s92, s92, 7
  v_add_u32 v17, s92, v8
  s_mul_i32 s83, s3, 8576
  s_lshl_b32 s92, s2, 17
  v_mov_b32 v18, s92
  v_mov_b32 v19, 0xf000
  s_waitcnt lgkmcnt(0)
  s_mov_b64 s[40:41], s[8:9]
  global_load_dwordx4 v[12:15], v38, s[4:5]
  global_load_ushort v16, v17, s[4:5]
  s_add_u32 m0, s83, 0
  s_add_u32 s92, s82, 0
  buffer_load_dwordx4 v38, s[40:43], s92 offen nt lds
  s_add_u32 m0, s83, 1056
  s_add_u32 s92, s82, 8192
  buffer_load_dwordx4 v38, s[40:43], s92 offen nt lds
  s_add_u32 m0, s83, 2112
  s_add_u32 s92, s82, 16384
  buffer_load_dwordx4 v38, s[40:43], s92 offen nt lds
  s_add_u32 m0, s83, 3168
  s_add_u32 s92, s82, 24576
  buffer_load_dwordx4 v38, s[40:43], s92 offen nt lds
  s_add_u32 m0, s83, 4224
  s_add_u32 s92, s82, 32768
  buffer_load_dwordx4 v38, s[40:43], s92 offen nt lds
  s_add_u32 m0, s83, 5280
  s_add_u32 s92, s82, 40960
  buffer_load_dwordx4 v38, s[40:43], s92 offen nt lds
  s_add_u32 m0, s83, 6336
  s_add_u32 s92, s82, 49152
  buffer_load_dwordx4 v38, s[40:43], s92 offen nt lds
  s_add_u32 m0, s83, 7392
  s_add_u32 s92, s82, 57344
  buffer_load_dwordx4 v38, s[40:43], s92 offen nt lds
  s_cmp_lg_u32 s3, 7
  s_cbranch_scc1 L_nt_1
  s_mov_b64 exec, 1
  global_load_dword v20, v18, s[6:7] nt
  global_load_dword v21, v19, s[32:33]
  global_load_dword v22, v38, s[30:31] offset:128
  s_mov_b64 exec, -1
L_nt_1:
  s_branch L_Q2
L_K:
  s_bfe_u32 s81, s2, 0x10004
  s_xor_b32 s81, s81, 1
  s_lshl_b32 s81, s81, 16
  s_and_b32 s92, s3, 1
  s_lshl_b32 s92, s92, 7
  v_xor_b32 v39, s92, v38
  s_lshl_b32 s83, s3, 13
  s_add_u32 s83, s83, s81
  v_mov_b32 v19, 0xf000
  s_waitcnt lgkmcnt(0)
  s_mov_b64 s[40:41], s[10:11]
  s_mov_b64 exec, 1
  global_load_dword v21, v19, s[32:33]
  s_mov_b64 exec, -1
  v_xor_b32 v40, 0, v39
  s_add_u32 m0, s83, 0
  s_add_u32 s92, s82, 0
  buffer_load_dwordx4 v40, s[40:43], s92 offen nt lds
  v_xor_b32 v41, 16, v39
  s_add_u32 m0, s83, 1024
  s_add_u32 s92, s82, 8192
  buffer_load_dwordx4 v41, s[40:43], s92 offen nt lds
  v_xor_b32 v40, 32, v39
  s_add_u32 m0, s83, 2048
  s_add_u32 s92, s82, 16384
  buffer_load_dwordx4 v40, s[40:43], s92 offen nt lds
  v_xor_b32 v41, 48, v39
  s_add_u32 m0, s83, 3072
  s_add_u32 s92, s82, 24576
  buffer_load_dwordx4 v41, s[40:43], s92 offen nt lds
  v_xor_b32 v40, 64, v39
  s_add_u32 m0, s83, 4096
  s_add_u32 s92, s82, 32768
  buffer_load_dwordx4 v40, s[40:43], s92 offen nt lds
  v_xor_b32 v41, 80, v39
  s_add_u32 m0, s83, 5120
  s_add_u32 s92, s82, 40960
  buffer_load_dwordx4 v41, s[40:43], s92 offen nt lds
  v_xor_b32 v40, 96, v39
  s_add_u32 m0, s83, 6144
  s_add_u32 s92, s82, 49152
  buffer_load_dwordx4 v40, s[40:43], s92 offen nt lds
  v_xor_b32 v41, 112, v39
  s_add_u32 m0, s83, 7168
  s_add_u32 s92, s82, 57344
  buffer_load_dwordx4 v41, s[40:43], s92 offen nt lds
  s_branch L_K2
L_B:
  s_cmp_ge_u32 s3, 4
  s_cbranch_scc0 L_Bfront
  v_lshrrev_b32 v10, 3, v1
  v_mul_u32_u24 v5, 24576, v10
  v_lshlrev_b32 v10, 3, v10
  v_and_b32 v11, 7, v1
  v_lshl_add_u32 v5, v11, 4, v5
  s_bfe_u32 s94, s2, 0x20004
  s_and_b32 s95, s2, 15
  s_lshl_b32 s92, s94, 2
  s_add_u32 s92, s92, s3
  s_sub_u32 s92, s92, 4
  s_lshl_b32 s93, s92, 6
  v_add_u32 v10, s93, v10
  s_mul_i32 s92, s92, 196608
  s_lshl_b32 s93, s95, 7
  s_add_u32 s92, s92, s93
  s_mov_b32 s42, 0x300000
  s_mov_b32 s43, 0x20000
  v_mov_b32 v253, 0
  s_waitcnt lgkmcnt(0)
  s_mov_b64 s[40:41], s[26:27]
  s_bitcmp1_b32 s2, 6
  s_cbranch_scc1 L_nou0
  global_load_dwordx2 v[112:113], v10, s[24:25]
  buffer_load_dwordx4 v[124:127], v5, s[40:43], s92 offen nt
  s_add_u32 s92, s92, 6144
  buffer_load_dwordx4 v[128:131], v5, s[40:43], s92 offen nt
  s_add_u32 s92, s92, 6144
  buffer_load_dwordx4 v[132:135], v5, s[40:43], s92 offen nt
  s_add_u32 s92, s92, 6144
  buffer_load_dwordx4 v[136:139], v5, s[40:43], s92 offen nt
L_nou0:
  s_branch L_Bback2
L_Bfront:
  s_memrealtime s[62:63]
  s_bfe_u32 s64, s2, 0x40003
  s_xor_b32 s64, s64, 8
  s_or_b32 s64, s64, s3
  s_cbranch_scc1 L_nononce
  v_mov_b32 v18, 0
  v_mov_b32 v21, 0
  s_waitcnt lgkmcnt(0)
  s_or_b32 s62, s62, 1
  v_mov_b32 v20, s62
  s_mov_b64 exec, 1
  global_atomic_cmpswap v18, v[20:21], s[30:31] sc1
  s_mov_b64 exec, -1
L_nononce:
  v_lshrrev_b32 v245, 4, v1
  v_and_b32 v246, 15, v1
  v_lshlrev_b32 v247, 2, v245
  v_xor_b32 v246, v246, v247
  v_lshlrev_b32 v246, 4, v246
  v_lshl_add_u32 v244, v245, 10, v246
  v_xor_b32 v245, 16, v244
  v_xor_b32 v246, 32, v244
  v_xor_b32 v247, 48, v244
  v_add_u32 v245, 3072, v245
  v_add_u32 v246, 6144, v246
  v_add_u32 v247, 9216, v247
  s_and_b32 s91, s3, 3
  s_lshl_b32 s90, s91, 15
  s_lshl_b32 s91, s91, 13
  s_lshl_b32 s92, s2, 17
  s_add_u32 s90, s90, s92
  s_bfe_u32 s93, s2, 0x20003
  s_lshl_b32 s92, s93, 15
  s_add_u32 s91, s91, s92
  s_lshl_b32 s92, s93, 8
  s_add_u32 s90, s90, s92
  s_getpc_b64 s[94:95]
L_pc:
  s_sub_u32 s94, s94, L_pc-adaLN_cond__compressed_kv_cla__glu_gated_geglu__decode_kernel
  s_subb_u32 s95, s95, 0
  s_bfe_u32 s92, s2, 0x40003
  s_lshl_b32 s92, s92, 2
  s_add_u32 s92, s92, s3
  s_lshl_b32 s92, s92, 10
  v_lshlrev_b32 v11, 4, v1
  v_add_u32 v11, s92, v11
  s_mov_b32 s38, 0x2000000
  s_mov_b32 s39, 0x20000
  s_cmp_ge_u32 s92, L_codeend-adaLN_cond__compressed_kv_cla__glu_gated_geglu__decode_kernel
  s_cbranch_scc1 L_nopf
  v_min_u32 v11, L_codeend-adaLN_cond__compressed_kv_cla__glu_gated_geglu__decode_kernel-16, v11
  global_load_dwordx4 v[12:15], v11, s[94:95]
L_nopf:
  s_waitcnt lgkmcnt(0)
  s_mov_b64 s[36:37], s[6:7]
  s_barrier
  s_barrier
  s_mov_b32 s54, 0x05040100
  s_mov_b32 s55, 0x07060302
  s_mov_b32 s56, 0x0c0c0400
  s_mov_b32 s57, 0x0c040100
  s_mov_b32 s58, 0x04020100
  s_mov_b32 s53, 0x10001
  v_mov_b32 v2, 0xffffff00
  s_lshr_b32 s77, s2, 5
  s_and_b32 s78, s2, 127
  s_and_b32 s76, s2, 7
  s_lshl_b32 s76, s76, 2
  s_bfe_u32 s97, s2, 0x20003
  s_add_u32 s76, s76, s97
  s_bfe_u32 s79, s2, 0x40003
  s_and_b32 s80, s2, 7
  s_bfe_u32 s17, s2, 0x20003
  s_bfe_u32 s59, s2, 0x10004
  s_lshl_b32 s59, s59, 14
  s_xor_b32 m0, s91, 0
  s_xor_b32 s101, s90, 0
  buffer_load_dwordx4 v244, s[36:39], s101 offen offset:0 nt lds
  s_waitcnt vmcnt(0)
  buffer_load_dwordx4 v245, s[36:39], s101 offen offset:1024 nt lds
  s_waitcnt vmcnt(0)
  buffer_load_dwordx4 v246, s[36:39], s101 offen offset:2048 nt lds
  s_waitcnt vmcnt(2)
  buffer_load_dwordx4 v247, s[36:39], s101 offen offset:3072 nt lds
  s_waitcnt vmcnt(2)
  s_xor_b32 m0, s91, 32768
  s_xor_b32 s101, s90, 256
  buffer_load_dwordx4 v244, s[36:39], s101 offen offset:0 nt lds
  s_waitcnt vmcnt(2)
  buffer_load_dwordx4 v245, s[36:39], s101 offen offset:1024 nt lds
  s_waitcnt vmcnt(2)
  buffer_load_dwordx4 v246, s[36:39], s101 offen offset:2048 nt lds
  s_waitcnt vmcnt(2)
  buffer_load_dwordx4 v247, s[36:39], s101 offen offset:3072 nt lds
  s_waitcnt vmcnt(2)
  s_xor_b32 m0, s91, 65536
  s_xor_b32 s101, s90, 512
  buffer_load_dwordx4 v244, s[36:39], s101 offen offset:0 nt lds
  buffer_load_dwordx4 v245, s[36:39], s101 offen offset:1024 nt lds
  buffer_load_dwordx4 v246, s[36:39], s101 offen offset:2048 nt lds
  buffer_load_dwordx4 v247, s[36:39], s101 offen offset:3072 nt lds
  v_mov_b32 v253, 0
  global_load_dword v252, v253, s[30:31] sc1
  s_xor_b32 m0, s91, 98304
  s_xor_b32 s101, s90, 768
  buffer_load_dwordx4 v244, s[36:39], s101 offen offset:0 nt lds
  buffer_load_dwordx4 v245, s[36:39], s101 offen offset:1024 nt lds
  buffer_load_dwordx4 v246, s[36:39], s101 offen offset:2048 nt lds
  buffer_load_dwordx4 v247, s[36:39], s101 offen offset:3072 nt lds
  s_barrier
  s_branch L_front
L_Q2:
  s_mov_b32 s54, 0x05040100
  s_mov_b32 s55, 0x07060302
  s_mov_b32 s56, 0x0c0c0400
  s_mov_b32 s57, 0x0c040100
  s_mov_b32 s58, 0x04020100
  s_mov_b32 s53, 0x10001
  v_mov_b32 v2, 0xffffff00
  s_lshr_b32 s77, s2, 5
  s_and_b32 s78, s2, 127
  s_and_b32 s76, s2, 7
  s_lshl_b32 s76, s76, 2
  s_bfe_u32 s97, s2, 0x20003
  s_add_u32 s76, s76, s97
  s_bfe_u32 s79, s2, 0x40003
  s_and_b32 s80, s2, 7
  s_bfe_u32 s17, s2, 0x20003
  s_bfe_u32 s59, s2, 0x10004
  s_lshl_b32 s59, s59, 14
  v_lshrrev_b32 v245, 4, v1
  v_and_b32 v246, 15, v1
  v_lshlrev_b32 v247, 2, v245
  v_xor_b32 v246, v246, v247
  v_lshlrev_b32 v246, 4, v246
  v_lshl_add_u32 v244, v245, 10, v246
  v_xor_b32 v245, 16, v244
  v_xor_b32 v246, 32, v244
  v_xor_b32 v247, 48, v244
  v_add_u32 v245, 3072, v245
  v_add_u32 v246, 6144, v246
  v_add_u32 v247, 9216, v247
  s_and_b32 s91, s3, 3
  s_lshl_b32 s90, s91, 15
  s_lshl_b32 s91, s91, 13
  s_lshl_b32 s92, s2, 17
  s_add_u32 s90, s90, s92
  s_bfe_u32 s93, s2, 0x20003
  s_lshl_b32 s92, s93, 15
  s_add_u32 s91, s91, s92
  s_lshl_b32 s92, s93, 8
  s_add_u32 s90, s90, s92
  s_mov_b64 s[36:37], s[6:7]
  s_mov_b32 s38, 0x2000000
  s_mov_b32 s39, 0x20000
  s_bfe_u32 s82, s2, 0x30003
  s_lshl_b32 s82, s82, 10
  s_add_u32 s83, s82, 8192
  s_lshl_b32 s92, s3, 7
  s_add_u32 s92, s92, 0x20000
  v_add_u32 v40, s92, v8
  v_lshrrev_b32 v41, 4, v1
  v_lshlrev_b32 v41, 4, v41
  v_add_u32 v41, s92, v41
  s_lshl_b32 s92, s3, 7
  v_lshrrev_b32 v44, 4, v1
  v_mul_u32_u24 v44, 8576, v44
  v_bfe_u32 v3, v1, 2, 2
  v_mul_u32_u24 v3, 1056, v3
  v_add_u32 v44, v3, v44
  v_and_b32 v3, 3, v1
  v_lshl_add_u32 v44, v3, 3, v44
  v_add_u32 v44, s92, v44
  v_and_b32 v39, 3, v1
  v_lshlrev_b32 v39, 6, v39
  v_lshrrev_b32 v3, 4, v1
  v_lshl_add_u32 v39, v3, 4, v39
  s_and_b32 s85, s2, 7
  s_lshl_b32 s85, s85, 14
  s_bfe_u32 s97, s2, 0x30003
  s_lshl_b32 s97, s97, 11
  s_add_u32 s85, s85, s97
  s_lshl_b32 s97, s3, 8
  s_add_u32 s85, s85, s97
  s_add_u32 s85, s85, 0x80000
  s_mov_b32 s70, 0x20002
  s_mov_b32 s71, 0x20002
  s_mov_b32 s72, 0x40004
  s_mov_b32 s73, 0x40004
  s_mov_b32 s74, 0x80008
  s_mov_b32 s75, 0x80008
  s_waitcnt vmcnt(8)
  v_lshlrev_b32 v92, 16, v12
  v_and_b32 v93, 0xffff0000, v12
  v_lshlrev_b32 v94, 16, v13
  v_and_b32 v95, 0xffff0000, v13
  v_lshlrev_b32 v96, 16, v14
  v_and_b32 v97, 0xffff0000, v14
  v_lshlrev_b32 v98, 16, v15
  v_and_b32 v99, 0xffff0000, v15
  v_add_f32 v100, v92, v93
  v_add_f32 v100, v100, v94
  v_add_f32 v100, v100, v95
  v_add_f32 v100, v100, v96
  v_add_f32 v100, v100, v97
  v_add_f32 v100, v100, v98
  v_add_f32 v100, v100, v99
  s_nop 1
  v_add_f32_dpp v100, v100, v100 row_ror:8 row_mask:0xf bank_mask:0xf
  s_nop 1
  v_add_f32_dpp v100, v100, v100 row_ror:4 row_mask:0xf bank_mask:0xf
  s_nop 1
  v_add_f32_dpp v100, v100, v100 row_ror:2 row_mask:0xf bank_mask:0xf
  s_nop 1
  v_add_f32_dpp v100, v100, v100 row_ror:1 row_mask:0xf bank_mask:0xf
  v_mov_b32 v101, v100
  s_nop 1
  v_permlane16_swap_b32 v100, v101
  v_add_f32 v100, v100, v101
  v_mov_b32 v101, v100
  s_nop 1
  v_permlane32_swap_b32 v100, v101
  v_add_f32 v100, v100, v101
  v_mul_f32 v100, 0x3b000000, v100
  v_sub_f32 v92, v92, v100
  v_sub_f32 v93, v93, v100
  v_sub_f32 v94, v94, v100
  v_sub_f32 v95, v95, v100
  v_sub_f32 v96, v96, v100
  v_sub_f32 v97, v97, v100
  v_sub_f32 v98, v98, v100
  v_sub_f32 v99, v99, v100
  v_mul_f32 v102, v92, v92
  v_fmac_f32 v102, v93, v93
  v_fmac_f32 v102, v94, v94
  v_fmac_f32 v102, v95, v95
  v_fmac_f32 v102, v96, v96
  v_fmac_f32 v102, v97, v97
  v_fmac_f32 v102, v98, v98
  v_fmac_f32 v102, v99, v99
  s_nop 1
  v_add_f32_dpp v102, v102, v102 row_ror:8 row_mask:0xf bank_mask:0xf
  s_nop 1
  v_add_f32_dpp v102, v102, v102 row_ror:4 row_mask:0xf bank_mask:0xf
  s_nop 1
  v_add_f32_dpp v102, v102, v102 row_ror:2 row_mask:0xf bank_mask:0xf
  s_nop 1
  v_add_f32_dpp v102, v102, v102 row_ror:1 row_mask:0xf bank_mask:0xf
  v_mov_b32 v101, v102
  s_nop 1
  v_permlane16_swap_b32 v102, v101
  v_add_f32 v102, v102, v101
  v_mov_b32 v101, v102
  s_nop 1
  v_permlane32_swap_b32 v102, v101
  v_add_f32 v102, v102, v101
  v_mov_b32 v253, 0
  global_load_dword v252, v253, s[30:31] sc1
  v_mul_f32 v102, 0x3b000000, v102
  v_cvt_pk_bf16_f32 v101, v100, v100
  v_and_b32 v100, 0xffff0000, v101
  v_cvt_pk_bf16_f32 v101, v102, v102
  v_and_b32 v102, 0xffff0000, v101
  v_add_f32 v102, 0x3727c5ac, v102
  v_cvt_pk_bf16_f32 v101, v102, v102
  v_and_b32 v102, 0xffff0000, v101
  v_sqrt_f32 v102, v102
  s_nop 0
  v_cvt_pk_bf16_f32 v101, v102, v102
  v_and_b32 v102, 0xffff0000, v101
  v_rcp_f32 v102, v102
  v_lshlrev_b32 v103, 16, v16
  v_sub_f32 v103, v103, v100
  v_cvt_pk_bf16_f32 v101, v103, v103
  v_and_b32 v103, 0xffff0000, v101
  v_mul_f32 v103, v103, v102
  v_cvt_pk_bf16_f32 v101, v103, v103
  v_and_b32 v103, 0xffff0000, v101
  s_mov_b32 s100, 0
  s_waitcnt vmcnt(0)
  s_branch L_epc_3
L_ep_2:
  global_load_dword v252, v253, s[30:31] sc1
  s_add_u32 s100, s100, 1
  s_cmp_gt_u32 s100, 100000
  s_cbranch_scc1 L_abort
  s_waitcnt vmcnt(0)
L_epc_3:
  v_readfirstlane_b32 s48, v252
  s_nop 0
  s_cmp_eq_u32 s48, 0
  s_nop 1
  s_cbranch_scc1 L_ep_2
  s_mul_i32 s48, s48, 0x9e3779b1
  s_and_b32 s49, s48, 0xff
  s_bfe_u32 s50, s48, 0x80008
  s_bfe_u32 s51, s48, 0x80010
  s_lshr_b32 s52, s48, 24
  s_lshr_b32 s97, s48, 15
  s_xor_b32 s97, s97, s48
  s_mul_i32 s97, s97, 0x85ebca6b
  v_mov_b32 v4, s48
  v_mov_b32 v5, s97
  v_mov_b32 v249, s48
  v_mov_b32 v250, s97
  v_and_b32 v6, 4, v1
  v_cmp_eq_u32 vcc, 0, v6
  v_and_b32 v7, 3, v1
  v_lshlrev_b32 v7, 2, v7
  v_cndmask_b32 v4, v5, v4, vcc
  v_lshrrev_b32 v4, v7, v4
  v_lshrrev_b32 v5, 1, v4
  v_lshrrev_b32 v6, 2, v4
  v_lshrrev_b32 v7, 3, v4
  s_barrier
  buffer_load_dwordx4 v[20:23], v38, s[32:35], s82 offen offset:0 sc1
  buffer_load_dwordx4 v[24:27], v38, s[32:35], s83 offen offset:0 sc1
  ds_read_b64_tr_b16 v[112:113], v44 offset:0
  ds_read_b64_tr_b16 v[114:115], v44 offset:4224
  ds_read_b64_tr_b16 v[116:117], v44 offset:34304
  ds_read_b64_tr_b16 v[118:119], v44 offset:38528
  ds_read_b64_tr_b16 v[120:121], v44 offset:32
  ds_read_b64_tr_b16 v[122:123], v44 offset:4256
  ds_read_b64_tr_b16 v[124:125], v44 offset:34336
  ds_read_b64_tr_b16 v[126:127], v44 offset:38560
  ds_read_b64_tr_b16 v[128:129], v44 offset:64
  ds_read_b64_tr_b16 v[130:131], v44 offset:4288
  ds_read_b64_tr_b16 v[132:133], v44 offset:34368
  ds_read_b64_tr_b16 v[134:135], v44 offset:38592
  s_waitcnt lgkmcnt(4)
  ds_read_b64_tr_b16 v[136:137], v44 offset:96
  ds_read_b64_tr_b16 v[138:139], v44 offset:4320
  ds_read_b64_tr_b16 v[140:141], v44 offset:34400
  ds_read_b64_tr_b16 v[142:143], v44 offset:38624
  s_waitcnt lgkmcnt(0)
  s_barrier
  s_mov_b64 s[60:61], -1
  s_waitcnt vmcnt(0)
  s_mov_b32 s100, 0
  s_branch L_gc_6
L_g_4:
  s_add_u32 s100, s100, 1
  s_cmp_gt_u32 s100, 100000
  s_cbranch_scc1 L_abort
  s_sleep 2
L_gf_5:
  s_mov_b64 exec, s[60:61]
  buffer_load_dwordx4 v[20:23], v38, s[32:35], s82 offen offset:0 sc1
  buffer_load_dwordx4 v[24:27], v38, s[32:35], s83 offen offset:0 sc1
  s_waitcnt vmcnt(0)
L_gc_6:
  s_mov_b64 exec, s[60:61]
  v_perm_b32 v92, v21, v20, s56
  v_perm_b32 v92, v22, v92, s57
  v_perm_b32 v92, v23, v92, s58
  v_cmp_ne_u32 s[60:61], s48, v92
  v_perm_b32 v92, v25, v24, s56
  v_perm_b32 v92, v26, v92, s57
  v_perm_b32 v92, v27, v92, s58
  v_cmp_ne_u32 vcc, s48, v92
  s_nop 0
  s_or_b64 s[60:61], s[60:61], vcc
  s_cmp_lg_u64 s[60:61], 0
  s_cbranch_scc1 L_g_4
  s_mov_b64 exec, -1
  v_permlane32_swap_b32 v20, v22
  v_permlane32_swap_b32 v21, v23
  v_permlane32_swap_b32 v24, v26
  v_permlane32_swap_b32 v25, v27
  v_add_f32 v20, v20, v22
  v_add_f32 v21, v21, v23
  v_add_f32 v24, v24, v26
  v_add_f32 v25, v25, v27
  v_permlane16_swap_b32 v20, v21
  s_nop 0
  v_permlane16_swap_b32 v24, v25
  v_add_f32 v20, v20, v21
  v_add_f32 v24, v24, v25
  v_cvt_pk_bf16_f32 v25, v24, v24
  v_and_b32 v24, 0xffff0000, v25
  v_cvt_pk_bf16_f32 v21, v20, v20
  v_and_b32 v20, 0xffff0000, v21
  v_add_f32 v24, 1.0, v24
  v_cvt_pk_bf16_f32 v25, v24, v24
  v_and_b32 v24, 0xffff0000, v25
  v_mul_f32 v24, v103, v24
  v_cvt_pk_bf16_f32 v25, v24, v24
  v_and_b32 v24, 0xffff0000, v25
  v_add_f32 v24, v24, v20
  v_cvt_pk_bf16_f32 v24, v24, v24
  ds_write_b16 v40, v24
  ds_read_b128 v[28:31], v41
  ds_read_b128 v[32:35], v41 offset:64
  s_waitcnt lgkmcnt(1)
  v_mfma_f32_16x16x32_bf16 v[80:83], v[112:115], v[28:31], 0
  v_mfma_f32_16x16x32_bf16 v[84:87], v[120:123], v[28:31], 0
  v_mfma_f32_16x16x32_bf16 v[88:91], v[128:131], v[28:31], 0
  v_mfma_f32_16x16x32_bf16 v[92:95], v[136:139], v[28:31], 0
  s_waitcnt lgkmcnt(0)
  v_mfma_f32_16x16x32_bf16 v[80:83], v[116:119], v[32:35], v[80:83]
  v_mfma_f32_16x16x32_bf16 v[84:87], v[124:127], v[32:35], v[84:87]
  v_mfma_f32_16x16x32_bf16 v[88:91], v[132:135], v[32:35], v[88:91]
  v_mfma_f32_16x16x32_bf16 v[92:95], v[140:143], v[32:35], v[92:95]
  s_nop 5
  v_cndmask_b32 v80, v80, v84, s[70:71]
  v_cndmask_b32 v81, v81, v85, s[70:71]
  v_cndmask_b32 v82, v82, v86, s[70:71]
  v_cndmask_b32 v83, v83, v87, s[70:71]
  v_cndmask_b32 v80, v80, v88, s[72:73]
  v_cndmask_b32 v81, v81, v89, s[72:73]
  v_cndmask_b32 v82, v82, v90, s[72:73]
  v_cndmask_b32 v83, v83, v91, s[72:73]
  v_cndmask_b32 v80, v80, v92, s[74:75]
  v_cndmask_b32 v81, v81, v93, s[74:75]
  v_cndmask_b32 v82, v82, v94, s[74:75]
  v_cndmask_b32 v83, v83, v95, s[74:75]
  v_and_or_b32 v80, v80, v2, s49
  v_and_or_b32 v81, v81, v2, s50
  v_and_or_b32 v82, v82, v2, s51
  v_and_or_b32 v83, v83, v2, s52
  s_mov_b32 exec_lo, 0xf000f
  s_mov_b32 exec_hi, 0xf000f
  buffer_store_dwordx4 v[80:83], v39, s[32:35], s85 offen
  s_add_u32 s97, s85, 0x100000
  buffer_store_dwordx4 v[80:83], v39, s[32:35], s97 offen sc1
  s_mov_b64 exec, -1
  s_barrier
  s_lshr_b32 s92, s3, 2
  s_lshl_b32 s93, s92, 12
  s_xor_b32 s93, s93, 0
  s_xor_b32 m0, s91, s93
  s_lshl_b32 s93, s92, 14
  s_xor_b32 s93, s93, 0
  s_xor_b32 s101, s90, s93
  buffer_load_dwordx4 v244, s[36:39], s101 offen offset:0 nt lds
  buffer_load_dwordx4 v245, s[36:39], s101 offen offset:1024 nt lds
  buffer_load_dwordx4 v246, s[36:39], s101 offen offset:2048 nt lds
  buffer_load_dwordx4 v247, s[36:39], s101 offen offset:3072 nt lds
  s_lshr_b32 s92, s3, 2
  s_lshl_b32 s93, s92, 12
  s_xor_b32 s93, s93, 32768
  s_xor_b32 m0, s91, s93
  s_lshl_b32 s93, s92, 14
  s_xor_b32 s93, s93, 256
  s_xor_b32 s101, s90, s93
  buffer_load_dwordx4 v244, s[36:39], s101 offen offset:0 nt lds
  buffer_load_dwordx4 v245, s[36:39], s101 offen offset:1024 nt lds
  buffer_load_dwordx4 v246, s[36:39], s101 offen offset:2048 nt lds
  buffer_load_dwordx4 v247, s[36:39], s101 offen offset:3072 nt lds
  s_lshr_b32 s92, s3, 2
  s_lshl_b32 s93, s92, 12
  s_xor_b32 s93, s93, 65536
  s_xor_b32 m0, s91, s93
  s_lshl_b32 s93, s92, 14
  s_xor_b32 s93, s93, 512
  s_xor_b32 s101, s90, s93
  buffer_load_dwordx4 v244, s[36:39], s101 offen offset:0 nt lds
  buffer_load_dwordx4 v245, s[36:39], s101 offen offset:1024 nt lds
  buffer_load_dwordx4 v246, s[36:39], s101 offen offset:2048 nt lds
  buffer_load_dwordx4 v247, s[36:39], s101 offen offset:3072 nt lds
  s_lshr_b32 s92, s3, 2
  s_lshl_b32 s93, s92, 12
  s_xor_b32 s93, s93, 98304
  s_xor_b32 m0, s91, s93
  s_lshl_b32 s93, s92, 14
  s_xor_b32 s93, s93, 768
  s_xor_b32 s101, s90, s93
  buffer_load_dwordx4 v244, s[36:39], s101 offen offset:0 nt lds
  buffer_load_dwordx4 v245, s[36:39], s101 offen offset:1024 nt lds
  buffer_load_dwordx4 v246, s[36:39], s101 offen offset:2048 nt lds
  buffer_load_dwordx4 v247, s[36:39], s101 offen offset:3072 nt lds
  s_cmp_ge_u32 s3, 4
  s_cbranch_scc1 L_back
  s_barrier
  s_branch L_setup
L_K2:
  s_mov_b32 s54, 0x05040100
  s_mov_b32 s55, 0x07060302
  s_mov_b32 s56, 0x0c0c0400
  s_mov_b32 s57, 0x0c040100
  s_mov_b32 s58, 0x04020100
  s_mov_b32 s53, 0x10001
  v_mov_b32 v2, 0xffffff00
  s_lshr_b32 s77, s2, 5
  s_and_b32 s78, s2, 127
  s_and_b32 s76, s2, 7
  s_lshl_b32 s76, s76, 2
  s_bfe_u32 s97, s2, 0x20003
  s_add_u32 s76, s76, s97
  s_bfe_u32 s79, s2, 0x40003
  s_and_b32 s80, s2, 7
  s_bfe_u32 s17, s2, 0x20003
  s_bfe_u32 s59, s2, 0x10004
  s_lshl_b32 s59, s59, 14
  v_lshrrev_b32 v245, 4, v1
  v_and_b32 v246, 15, v1
  v_lshlrev_b32 v247, 2, v245
  v_xor_b32 v246, v246, v247
  v_lshlrev_b32 v246, 4, v246
  v_lshl_add_u32 v244, v245, 10, v246
  v_xor_b32 v245, 16, v244
  v_xor_b32 v246, 32, v244
  v_xor_b32 v247, 48, v244
  v_add_u32 v245, 3072, v245
  v_add_u32 v246, 6144, v246
  v_add_u32 v247, 9216, v247
  s_and_b32 s91, s3, 3
  s_lshl_b32 s90, s91, 15
  s_lshl_b32 s91, s91, 13
  s_lshl_b32 s92, s2, 17
  s_add_u32 s90, s90, s92
  s_bfe_u32 s93, s2, 0x20003
  s_lshl_b32 s92, s93, 15
  s_add_u32 s91, s91, s92
  s_lshl_b32 s92, s93, 8
  s_add_u32 s90, s90, s92
  s_mov_b64 s[36:37], s[6:7]
  s_mov_b32 s38, 0x2000000
  s_mov_b32 s39, 0x20000
  s_barrier
  s_lshr_b32 s92, s3, 2
  s_lshl_b32 s93, s92, 12
  s_xor_b32 s93, s93, 0
  s_xor_b32 m0, s91, s93
  s_lshl_b32 s93, s92, 14
  s_xor_b32 s93, s93, 0
  s_xor_b32 s101, s90, s93
  buffer_load_dwordx4 v244, s[36:39], s101 offen offset:0 nt lds
  buffer_load_dwordx4 v245, s[36:39], s101 offen offset:1024 nt lds
  buffer_load_dwordx4 v246, s[36:39], s101 offen offset:2048 nt lds
  buffer_load_dwordx4 v247, s[36:39], s101 offen offset:3072 nt lds
  s_lshr_b32 s92, s3, 2
  s_lshl_b32 s93, s92, 12
  s_xor_b32 s93, s93, 32768
  s_xor_b32 m0, s91, s93
  s_lshl_b32 s93, s92, 14
  s_xor_b32 s93, s93, 256
  s_xor_b32 s101, s90, s93
  buffer_load_dwordx4 v244, s[36:39], s101 offen offset:0 nt lds
  buffer_load_dwordx4 v245, s[36:39], s101 offen offset:1024 nt lds
  buffer_load_dwordx4 v246, s[36:39], s101 offen offset:2048 nt lds
  buffer_load_dwordx4 v247, s[36:39], s101 offen offset:3072 nt lds
  s_and_b32 s92, s3, 1
  s_lshl_b32 s92, s92, 15
  s_lshr_b32 s97, s3, 1
  s_lshl_b32 s97, s97, 8
  s_add_u32 s92, s92, s97
  s_add_u32 s92, s92, s81
  v_and_b32 v45, 15, v1
  v_mul_u32_u24 v45, 1040, v45
  v_add_u32 v45, s92, v45
  v_lshrrev_b32 v34, 4, v1
  v_lshlrev_b32 v34, 4, v34
  v_xor_b32 v45, v45, v34
  v_lshrrev_b32 v37, 4, v1
  v_lshlrev_b32 v37, 11, v37
  v_and_b32 v3, 15, v1
  v_lshl_add_u32 v37, v3, 4, v37
  s_and_b32 s83, s2, 7
  s_lshl_b32 s83, s83, 14
  s_lshl_b32 s97, s3, 8
  s_add_u32 s83, s83, s97
  s_add_u32 s83, s83, 0x80000
  s_add_u32 s85, s83, 8192
  s_lshl_b32 s92, s3, 7
  s_add_u32 s92, s92, 0x21000
  v_and_b32 v47, 15, v1
  v_lshlrev_b32 v47, 3, v47
  v_lshrrev_b32 v3, 4, v1
  v_lshl_add_u32 v47, v3, 1, v47
  v_add_u32 v47, s92, v47
  s_lshr_b32 s92, s3, 1
  s_lshl_b32 s92, s92, 8
  s_add_u32 s92, s92, 0x21000
  v_lshrrev_b32 v35, 4, v1
  v_lshlrev_b32 v35, 4, v35
  v_add_u32 v35, s92, v35
  v_bfe_u32 v39, v1, 4, 1
  v_lshlrev_b32 v39, 5, v39
  v_lshrrev_b32 v3, 5, v1
  v_lshl_add_u32 v39, v3, 4, v39
  s_and_b32 s84, s2, 7
  s_lshl_b32 s84, s84, 12
  s_lshr_b32 s97, s3, 1
  s_lshl_b32 s97, s97, 10
  s_add_u32 s84, s84, s97
  s_bfe_u32 s97, s2, 0x30003
  s_lshl_b32 s97, s97, 7
  s_add_u32 s84, s84, s97
  s_and_b32 s97, s3, 1
  s_lshl_b32 s97, s97, 6
  s_add_u32 s84, s84, s97
  s_add_u32 s84, s84, 0x10000
  s_waitcnt vmcnt(8)
  s_barrier
  v_xor_b32 v32, 0, v45
  ds_read_b128 v[112:115], v32 offset:0
  v_xor_b32 v33, 64, v45
  ds_read_b128 v[116:119], v33 offset:0
  v_xor_b32 v32, 128, v45
  ds_read_b128 v[120:123], v32 offset:0
  v_xor_b32 v33, 192, v45
  ds_read_b128 v[124:127], v33 offset:0
  v_xor_b32 v32, 0, v45
  ds_read_b128 v[128:131], v32 offset:16384
  v_xor_b32 v33, 64, v45
  ds_read_b128 v[132:135], v33 offset:16384
  v_xor_b32 v32, 128, v45
  ds_read_b128 v[136:139], v32 offset:16384
  v_xor_b32 v33, 192, v45
  ds_read_b128 v[140:143], v33 offset:16384
  s_waitcnt lgkmcnt(0)
  s_barrier
  s_mov_b32 s100, 0
  v_mov_b32 v253, 0
L_ep_8:
  global_load_dword v252, v253, s[30:31] sc1
  s_add_u32 s100, s100, 1
  s_cmp_gt_u32 s100, 100000
  s_cbranch_scc1 L_abort
  s_waitcnt vmcnt(0)
L_epc_9:
  v_readfirstlane_b32 s48, v252
  s_nop 0
  s_cmp_eq_u32 s48, 0
  s_nop 1
  s_cbranch_scc1 L_ep_8
  s_mul_i32 s48, s48, 0x9e3779b1
  s_and_b32 s49, s48, 0xff
  s_bfe_u32 s50, s48, 0x80008
  s_bfe_u32 s51, s48, 0x80010
  s_lshr_b32 s52, s48, 24
  s_lshr_b32 s97, s48, 15
  s_xor_b32 s97, s97, s48
  s_mul_i32 s97, s97, 0x85ebca6b
  v_mov_b32 v4, s48
  v_mov_b32 v5, s97
  v_mov_b32 v249, s48
  v_mov_b32 v250, s97
  v_and_b32 v6, 4, v1
  v_cmp_eq_u32 vcc, 0, v6
  v_and_b32 v7, 3, v1
  v_lshlrev_b32 v7, 2, v7
  v_cndmask_b32 v4, v5, v4, vcc
  v_lshrrev_b32 v4, v7, v4
  v_lshrrev_b32 v5, 1, v4
  v_lshrrev_b32 v6, 2, v4
  v_lshrrev_b32 v7, 3, v4
  s_and_b32 s92, s3, 1
  s_sub_u32 s74, 0, s92
  s_mov_b32 s75, s74
  v_bfe_u32 v28, v1, 4, 1
  v_lshlrev_b32 v28, 3, v28
  v_lshrrev_b32 v3, 5, v1
  v_lshl_add_u32 v28, v3, 2, v28
  v_mov_b32 v68, s48
  v_mov_b32 v69, s97
  v_cndmask_b32 v68, v68, v69, s[74:75]
  v_lshrrev_b32 v68, v28, v68
  v_lshrrev_b32 v69, 1, v68
  v_lshrrev_b32 v70, 2, v68
  v_lshrrev_b32 v71, 3, v68
  s_mov_b64 s[60:61], -1
  s_mov_b64 s[62:63], -1
  s_mov_b32 s100, 0
  s_branch L_gf_11
L_g_10:
  s_add_u32 s100, s100, 1
  s_cmp_gt_u32 s100, 100000
  s_cbranch_scc1 L_abort
  s_sleep 1
  s_cmp_lg_u32 s100, 40
  s_cbranch_scc1 L_alt_13
  s_add_u32 s83, s83, 0x100000
  s_add_u32 s85, s85, 0x100000
L_alt_13:
L_gf_11:
  s_mov_b64 exec, s[60:61]
  s_cbranch_execz L_gs_14
  buffer_load_dwordx4 v[20:23], v37, s[32:35], s83 offen offset:0 sc1
L_gs_14:
  s_mov_b64 exec, s[62:63]
  s_cbranch_execz L_gs_15
  buffer_load_dwordx4 v[24:27], v37, s[32:35], s85 offen offset:0 sc1
L_gs_15:
  s_waitcnt vmcnt(0)
L_gc_12:
  s_mov_b64 exec, s[60:61]
  v_perm_b32 v92, v21, v20, s56
  v_perm_b32 v92, v22, v92, s57
  v_perm_b32 v92, v23, v92, s58
  v_cmp_ne_u32 s[60:61], s48, v92
  s_mov_b64 exec, s[62:63]
  v_perm_b32 v92, v25, v24, s56
  v_perm_b32 v92, v26, v92, s57
  v_perm_b32 v92, v27, v92, s58
  v_cmp_ne_u32 s[62:63], s48, v92
  s_nop 0
  s_or_b64 s[96:97], s[60:61], s[62:63]
  s_cbranch_scc1 L_g_10
  s_mov_b64 exec, -1
  v_add_f32 v20, v20, v24
  v_add_f32 v21, v21, v25
  v_add_f32 v22, v22, v26
  v_add_f32 v23, v23, v27
  s_nop 0
  v_permlane32_swap_b32 v20, v22
  v_permlane32_swap_b32 v21, v23
  v_add_f32 v20, v20, v22
  v_add_f32 v21, v21, v23
  s_nop 1
  v_permlane16_swap_b32 v20, v21
  v_add_f32 v20, v20, v21
  v_cvt_pk_bf16_f32 v20, v20, v20
  ds_write_b16 v47, v20
  s_waitcnt lgkmcnt(0)
  s_barrier
  ds_read_b128 v[52:55], v35 offset:0
  ds_read_b128 v[56:59], v35 offset:64
  ds_read_b128 v[60:63], v35 offset:128
  ds_read_b128 v[64:67], v35 offset:192
  s_waitcnt lgkmcnt(3)
  v_mfma_f32_16x16x32_bf16 v[80:83], v[112:115], v[52:55], 0
  v_mfma_f32_16x16x32_bf16 v[84:87], v[128:131], v[52:55], 0
  s_waitcnt lgkmcnt(2)
  v_mfma_f32_16x16x32_bf16 v[80:83], v[116:119], v[56:59], v[80:83]
  v_mfma_f32_16x16x32_bf16 v[84:87], v[132:135], v[56:59], v[84:87]
  s_waitcnt lgkmcnt(1)
  v_mfma_f32_16x16x32_bf16 v[80:83], v[120:123], v[60:63], v[80:83]
  v_mfma_f32_16x16x32_bf16 v[84:87], v[136:139], v[60:63], v[84:87]
  s_waitcnt lgkmcnt(0)
  v_mfma_f32_16x16x32_bf16 v[80:83], v[124:127], v[64:67], v[80:83]
  v_mfma_f32_16x16x32_bf16 v[84:87], v[140:143], v[64:67], v[84:87]
  s_nop 6
  v_mul_f32 v80, 0x3e0293ee, v80
  v_mul_f32 v81, 0x3e0293ee, v81
  v_mul_f32 v82, 0x3e0293ee, v82
  v_mul_f32 v83, 0x3e0293ee, v83
  v_mul_f32 v84, 0x3e0293ee, v84
  v_mul_f32 v85, 0x3e0293ee, v85
  v_mul_f32 v86, 0x3e0293ee, v86
  v_mul_f32 v87, 0x3e0293ee, v87
  v_cvt_pk_bf16_f32 v20, v80, v81
  v_cvt_pk_bf16_f32 v21, v82, v83
  v_cvt_pk_bf16_f32 v22, v84, v85
  v_cvt_pk_bf16_f32 v23, v86, v87
  s_nop 0
  v_permlane16_swap_b32 v20, v22
  v_permlane16_swap_b32 v21, v23
  v_bfi_b32 v20, s53, v68, v20
  v_bfi_b32 v21, s53, v69, v21
  v_bfi_b32 v22, s53, v70, v22
  v_bfi_b32 v23, s53, v71, v23
  s_mov_b32 exec_lo, 0x10001
  s_mov_b32 exec_hi, 0x10001
  buffer_store_dwordx4 v[20:23], v39, s[32:35], s84 offen sc1
  s_mov_b64 exec, -1
  s_barrier
  s_lshr_b32 s92, s3, 2
  s_lshl_b32 s93, s92, 12
  s_xor_b32 s93, s93, 65536
  s_xor_b32 m0, s91, s93
  s_lshl_b32 s93, s92, 14
  s_xor_b32 s93, s93, 512
  s_xor_b32 s101, s90, s93
  buffer_load_dwordx4 v244, s[36:39], s101 offen offset:0 nt lds
  buffer_load_dwordx4 v245, s[36:39], s101 offen offset:1024 nt lds
  buffer_load_dwordx4 v246, s[36:39], s101 offen offset:2048 nt lds
  buffer_load_dwordx4 v247, s[36:39], s101 offen offset:3072 nt lds
  s_lshr_b32 s92, s3, 2
  s_lshl_b32 s93, s92, 12
  s_xor_b32 s93, s93, 98304
  s_xor_b32 m0, s91, s93
  s_lshl_b32 s93, s92, 14
  s_xor_b32 s93, s93, 768
  s_xor_b32 s101, s90, s93
  buffer_load_dwordx4 v244, s[36:39], s101 offen offset:0 nt lds
  buffer_load_dwordx4 v245, s[36:39], s101 offen offset:1024 nt lds
  buffer_load_dwordx4 v246, s[36:39], s101 offen offset:2048 nt lds
  buffer_load_dwordx4 v247, s[36:39], s101 offen offset:3072 nt lds
  s_cmp_ge_u32 s3, 4
  s_cbranch_scc0 L_kf
  s_branch L_back
L_kf:
  s_barrier
  s_branch L_setup
L_Bback2:
  s_mov_b32 s54, 0x05040100
  s_mov_b32 s55, 0x07060302
  s_mov_b32 s56, 0x0c0c0400
  s_mov_b32 s57, 0x0c040100
  s_mov_b32 s58, 0x04020100
  s_mov_b32 s53, 0x10001
  v_mov_b32 v2, 0xffffff00
  s_lshr_b32 s77, s2, 5
  s_and_b32 s78, s2, 127
  s_and_b32 s76, s2, 7
  s_lshl_b32 s76, s76, 2
  s_bfe_u32 s97, s2, 0x20003
  s_add_u32 s76, s76, s97
  s_bfe_u32 s79, s2, 0x40003
  s_and_b32 s80, s2, 7
  s_bfe_u32 s17, s2, 0x20003
  s_bfe_u32 s59, s2, 0x10004
  s_lshl_b32 s59, s59, 14
  s_lshl_b32 s81, s95, 2
  s_add_u32 s81, s81, s94
  s_lshl_b32 s81, s81, 8
  s_add_u32 s81, s81, 0
  v_and_b32 v8, 7, v1
  v_lshlrev_b32 v8, 2, v8
  v_lshrrev_b32 v9, 4, v1
  v_add_u32 v8, v8, v9
  v_lshlrev_b32 v8, 5, v8
  s_lshl_b32 s92, s3, 2
  s_add_u32 s92, s92, 139248
  v_add_u32 v8, s92, v8
  v_lshlrev_b32 v9, 6, v1
  v_add_u32 v9, 139264, v9
  v_lshlrev_b32 v10, 4, v1
  s_bitcmp1_b32 s2, 6
  s_cbranch_scc1 L_nou0b
  s_waitcnt vmcnt(4)
  v_mov_b32 v253, 0
  global_load_dword v252, v253, s[30:31] sc1
  v_lshlrev_b32 v120, 16, v112
  v_and_b32 v121, 0xffff0000, v112
  v_lshlrev_b32 v122, 16, v113
  v_and_b32 v123, 0xffff0000, v113
  v_mul_f32 v116, 0xbfb8aa3b, v120
  v_mul_f32 v117, 0xbfb8aa3b, v121
  v_mul_f32 v118, 0xbfb8aa3b, v122
  v_mul_f32 v119, 0xbfb8aa3b, v123
  v_exp_f32 v116, v116
  v_exp_f32 v117, v117
  v_exp_f32 v118, v118
  v_exp_f32 v119, v119
  v_add_f32 v116, 1.0, v116
  v_add_f32 v117, 1.0, v117
  v_add_f32 v118, 1.0, v118
  v_add_f32 v119, 1.0, v119
  v_rcp_f32 v116, v116
  v_rcp_f32 v117, v117
  v_rcp_f32 v118, v118
  v_rcp_f32 v119, v119
  v_mul_f32 v120, v120, v116
  v_mul_f32 v121, v121, v117
  v_mul_f32 v122, v122, v118
  v_mul_f32 v123, v123, v119
  v_cvt_pk_bf16_f32 v120, v120, v120
  v_cvt_pk_bf16_f32 v121, v121, v121
  v_cvt_pk_bf16_f32 v122, v122, v122
  v_cvt_pk_bf16_f32 v123, v123, v123
  v_lshrrev_b32 v116, 16, v120
  v_lshrrev_b32 v117, 16, v121
  v_lshrrev_b32 v118, 16, v122
  v_lshrrev_b32 v119, 16, v123
  v_and_b32 v120, 0xffff0000, v120
  v_and_b32 v121, 0xffff0000, v121
  v_and_b32 v122, 0xffff0000, v122
  v_and_b32 v123, 0xffff0000, v123
  v_mov_b32 v96, 0
  v_mov_b32 v97, 0
  v_mov_b32 v98, 0
  v_mov_b32 v99, 0
  v_mov_b32 v100, 0
  v_mov_b32 v101, 0
  v_mov_b32 v102, 0
  v_mov_b32 v103, 0
  s_waitcnt vmcnt(4)
  v_dot2c_f32_bf16 v96, v116, v124
  v_dot2c_f32_bf16 v97, v120, v124
  v_dot2c_f32_bf16 v98, v116, v125
  v_dot2c_f32_bf16 v99, v120, v125
  v_dot2c_f32_bf16 v100, v116, v126
  v_dot2c_f32_bf16 v101, v120, v126
  v_dot2c_f32_bf16 v102, v116, v127
  v_dot2c_f32_bf16 v103, v120, v127
  s_waitcnt vmcnt(3)
  v_dot2c_f32_bf16 v96, v117, v128
  v_dot2c_f32_bf16 v97, v121, v128
  v_dot2c_f32_bf16 v98, v117, v129
  v_dot2c_f32_bf16 v99, v121, v129
  v_dot2c_f32_bf16 v100, v117, v130
  v_dot2c_f32_bf16 v101, v121, v130
  v_dot2c_f32_bf16 v102, v117, v131
  v_dot2c_f32_bf16 v103, v121, v131
  s_waitcnt vmcnt(2)
  v_dot2c_f32_bf16 v96, v118, v132
  v_dot2c_f32_bf16 v97, v122, v132
  v_dot2c_f32_bf16 v98, v118, v133
  v_dot2c_f32_bf16 v99, v122, v133
  v_dot2c_f32_bf16 v100, v118, v134
  v_dot2c_f32_bf16 v101, v122, v134
  v_dot2c_f32_bf16 v102, v118, v135
  v_dot2c_f32_bf16 v103, v122, v135
  s_waitcnt vmcnt(1)
  v_dot2c_f32_bf16 v96, v119, v136
  v_dot2c_f32_bf16 v97, v123, v136
  v_dot2c_f32_bf16 v98, v119, v137
  v_dot2c_f32_bf16 v99, v123, v137
  v_dot2c_f32_bf16 v100, v119, v138
  v_dot2c_f32_bf16 v101, v123, v138
  v_dot2c_f32_bf16 v102, v119, v139
  v_dot2c_f32_bf16 v103, v123, v139
  v_permlane32_swap_b32 v96, v100
  v_permlane32_swap_b32 v97, v101
  v_permlane32_swap_b32 v98, v102
  v_permlane32_swap_b32 v99, v103
  v_add_f32 v96, v96, v100
  v_add_f32 v97, v97, v101
  v_add_f32 v98, v98, v102
  v_add_f32 v99, v99, v103
  s_nop 0
  v_permlane16_swap_b32 v96, v98
  v_permlane16_swap_b32 v97, v99
  v_add_f32 v96, v96, v98
  v_add_f32 v97, v97, v99
  s_nop 0
  v_add_f32_dpp v96, v96, v96 row_ror:8 row_mask:0xf bank_mask:0xf
  v_add_f32_dpp v97, v97, v97 row_ror:8 row_mask:0xf bank_mask:0xf
  s_mov_b32 s100, 0
  s_waitcnt vmcnt(0)
  s_branch L_epc_17
L_ep_16:
  global_load_dword v252, v253, s[30:31] sc1
  s_add_u32 s100, s100, 1
  s_cmp_gt_u32 s100, 100000
  s_cbranch_scc1 L_abort
  s_waitcnt vmcnt(0)
L_epc_17:
  v_readfirstlane_b32 s48, v252
  s_nop 0
  s_cmp_eq_u32 s48, 0
  s_nop 1
  s_cbranch_scc1 L_ep_16
  s_mul_i32 s48, s48, 0x9e3779b1
  s_and_b32 s49, s48, 0xff
  s_bfe_u32 s50, s48, 0x80008
  s_bfe_u32 s51, s48, 0x80010
  s_lshr_b32 s52, s48, 24
  ds_write2_b32 v8, v96, v97 offset0:0 offset1:4
  s_waitcnt lgkmcnt(0)
  s_barrier
  s_cmp_lg_u32 s3, 4
  s_cbranch_scc1 L_nopub_18
  s_mov_b64 exec, 0xffff
  ds_read_b128 v[124:127], v9 offset:0
  ds_read_b128 v[128:131], v9 offset:16
  ds_read_b128 v[132:135], v9 offset:32
  ds_read_b128 v[136:139], v9 offset:48
  s_waitcnt lgkmcnt(3)
  v_add_f32 v124, v124, v125
  v_add_f32 v126, v126, v127
  v_add_f32 v124, v124, v126
  s_waitcnt lgkmcnt(2)
  v_add_f32 v128, v128, v129
  v_add_f32 v130, v130, v131
  v_add_f32 v128, v128, v130
  s_waitcnt lgkmcnt(1)
  v_add_f32 v132, v132, v133
  v_add_f32 v134, v134, v135
  v_add_f32 v132, v132, v134
  s_waitcnt lgkmcnt(0)
  v_add_f32 v136, v136, v137
  v_add_f32 v138, v138, v139
  v_add_f32 v136, v136, v138
  v_and_or_b32 v100, v124, v2, s49
  v_and_or_b32 v101, v128, v2, s50
  v_and_or_b32 v102, v132, v2, s51
  v_and_or_b32 v103, v136, v2, s52
  buffer_store_dwordx4 v[100:103], v10, s[32:35], s81 offen sc1
L_nopub_18:
  s_mov_b64 exec, -1
  s_barrier
  s_branch L_nou0c
L_nou0b:
  v_lshlrev_b32 v12, 7, v1
  v_lshlrev_b32 v14, 9, v1
  s_bfe_u32 s93, s2, 0x30003
  s_and_b32 s94, s2, 7
  s_cmp_lg_u32 s3, 4
  s_cbranch_scc1 L_ew5
  s_mov_b32 exec_hi, 0
  s_lshl_b32 s92, s93, 12
  s_add_u32 s92, s92, 0x10000
  buffer_load_dword v254, v12, s[32:35], s92 offen sc1
  s_lshl_b32 s92, s93, 14
  s_lshr_b32 s97, s94, 1
  s_lshl_b32 s97, s97, 7
  s_add_u32 s92, s92, s97
  s_add_u32 s92, s92, 0x20000
  buffer_load_dword v254, v14, s[32:35], s92 offen sc1
  s_mov_b32 exec_lo, 0xffff
  s_lshl_b32 s92, s94, 14
  s_lshl_b32 s97, s93, 11
  s_add_u32 s92, s92, s97
  s_add_u32 s92, s92, 0x80000
  buffer_load_dword v254, v12, s[32:35], s92 offen sc1
  s_lshl_b32 s92, s94, 11
  s_add_u32 s92, s92, 0x18000
  buffer_load_dword v254, v12, s[32:35], s92 offen sc1
  s_lshl_b32 s92, s93, 11
  buffer_load_dword v254, v12, s[32:35], s92 offen sc1
  s_branch L_ewx
L_ew5:
  s_cmp_lg_u32 s3, 5
  s_cbranch_scc1 L_ew6
  s_mov_b32 exec_hi, 0
  s_min_u32 s95, s93, 6
  s_mul_i32 s92, s94, 28672
  s_lshl_b32 s97, s95, 12
  s_add_u32 s92, s92, s97
  s_add_u32 s92, s92, 0xd0000
  buffer_load_dword v254, v12, s[32:35], s92 offen sc1
  s_branch L_ewx
L_ew6:
  s_cmp_lg_u32 s3, 6
  s_cbranch_scc1 L_ew7
  s_mov_b32 exec_hi, 0
  s_cmp_lg_u32 s94, 0
  s_cbranch_scc1 L_ewx
  s_mul_i32 s92, s93, 8448
  s_add_u32 s92, s92, 0x60000
  buffer_load_dword v254, v12, s[32:35], s92 offen sc1
  s_add_u32 s92, s92, 4224
  buffer_load_dword v254, v12, s[32:35], s92 offen sc1
  s_branch L_ewx
L_ew7:
  s_cmp_ge_u32 s93, 4
  s_cbranch_scc1 L_ew7b
  s_mov_b32 exec_hi, 0
  s_lshl_b32 s92, s94, 14
  s_lshl_b32 s97, s93, 12
  s_add_u32 s92, s92, s97
  s_add_u32 s92, s92, 0x40000
  buffer_load_dword v254, v12, s[32:35], s92 offen sc1
  s_branch L_ewx
L_ew7b:
  s_mul_i32 s92, s94, 8448
  s_and_b32 s97, s93, 1
  s_mul_i32 s97, s97, 67584
  s_add_u32 s92, s92, s97
  s_add_u32 s92, s92, 0xa0000
  buffer_load_dword v254, v12, s[32:35], s92 offen sc1
L_ewx:
  s_mov_b64 exec, -1
  s_barrier
  s_barrier
  s_mov_b32 s100, 0
  v_mov_b32 v253, 0
L_ep_19:
  global_load_dword v252, v253, s[30:31] sc1
  s_add_u32 s100, s100, 1
  s_cmp_gt_u32 s100, 100000
  s_cbranch_scc1 L_abort
  s_waitcnt vmcnt(0)
L_epc_20:
  v_readfirstlane_b32 s48, v252
  s_nop 0
  s_cmp_eq_u32 s48, 0
  s_nop 1
  s_cbranch_scc1 L_ep_19
  s_mul_i32 s48, s48, 0x9e3779b1
  s_and_b32 s49, s48, 0xff
  s_bfe_u32 s50, s48, 0x80008
  s_bfe_u32 s51, s48, 0x80010
  s_lshr_b32 s52, s48, 24
L_nou0c:
  s_lshr_b32 s97, s48, 15
  s_xor_b32 s97, s97, s48
  s_mul_i32 s97, s97, 0x85ebca6b
  v_mov_b32 v4, s48
  v_mov_b32 v5, s97
  v_mov_b32 v249, s48
  v_mov_b32 v250, s97
  v_and_b32 v6, 4, v1
  v_cmp_eq_u32 vcc, 0, v6
  v_and_b32 v7, 3, v1
  v_lshlrev_b32 v7, 2, v7
  v_cndmask_b32 v4, v5, v4, vcc
  v_lshrrev_b32 v4, v7, v4
  v_lshrrev_b32 v5, 1, v4
  v_lshrrev_b32 v6, 2, v4
  v_lshrrev_b32 v7, 3, v4
  v_lshrrev_b32 v245, 4, v1
  v_and_b32 v246, 15, v1
  v_lshlrev_b32 v247, 2, v245
  v_xor_b32 v246, v246, v247
  v_lshlrev_b32 v246, 4, v246
  v_lshl_add_u32 v244, v245, 10, v246
  v_xor_b32 v245, 16, v244
  v_xor_b32 v246, 32, v244
  v_xor_b32 v247, 48, v244
  v_add_u32 v245, 3072, v245
  v_add_u32 v246, 6144, v246
  v_add_u32 v247, 9216, v247
  s_and_b32 s91, s3, 3
  s_lshl_b32 s90, s91, 15
  s_lshl_b32 s91, s91, 13
  s_lshl_b32 s92, s2, 17
  s_add_u32 s90, s90, s92
  s_bfe_u32 s93, s2, 0x20003
  s_lshl_b32 s92, s93, 15
  s_add_u32 s91, s91, s92
  s_lshl_b32 s92, s93, 8
  s_add_u32 s90, s90, s92
  s_mov_b64 s[36:37], s[6:7]
  s_mov_b32 s38, 0x2000000
  s_mov_b32 s39, 0x20000
  v_lshlrev_b32 v12, 21, v1
  v_add_u32 v12, 0xf000, v12
  s_mov_b64 exec, 0x3f
  buffer_load_dword v254, v12, s[32:35], 0 offen
  s_mov_b64 exec, -1
  s_and_b32 s81, s3, 3
  s_lshl_b32 s81, s81, 13
  s_add_u32 s81, s81, 0x10000
  v_lshlrev_b32 v8, 4, v1
  s_add_u32 s82, s81, 4096
  v_lshrrev_b32 v9, 4, v1
  v_lshlrev_b32 v9, 13, v9
  v_and_b32 v3, 15, v1
  v_lshl_add_u32 v9, v3, 4, v9
  s_and_b32 s93, s3, 3
  s_lshl_b32 s93, s93, 11
  s_and_b32 s97, s3, 1
  s_lshl_b32 s97, s97, 5
  s_add_u32 s93, s93, s97
  s_add_u32 s93, s93, 0x20000
  v_xor_b32 v9, s93, v9
  s_xor_b32 m0, s91, 4096
  s_xor_b32 s101, s90, 16384
  buffer_load_dwordx4 v244, s[36:39], s101 offen offset:0 nt lds
  s_waitcnt vmcnt(0)
  buffer_load_dwordx4 v245, s[36:39], s101 offen offset:1024 nt lds
  s_waitcnt vmcnt(2)
  buffer_load_dwordx4 v246, s[36:39], s101 offen offset:2048 nt lds
  s_waitcnt vmcnt(2)
  buffer_load_dwordx4 v247, s[36:39], s101 offen offset:3072 nt lds
  s_waitcnt vmcnt(2)
  s_xor_b32 m0, s91, 36864
  s_xor_b32 s101, s90, 16640
  buffer_load_dwordx4 v244, s[36:39], s101 offen offset:0 nt lds
  s_waitcnt vmcnt(2)
  buffer_load_dwordx4 v245, s[36:39], s101 offen offset:1024 nt lds
  s_waitcnt vmcnt(2)
  buffer_load_dwordx4 v246, s[36:39], s101 offen offset:2048 nt lds
  s_waitcnt vmcnt(2)
  buffer_load_dwordx4 v247, s[36:39], s101 offen offset:3072 nt lds
  s_waitcnt vmcnt(2)
  s_xor_b32 m0, s91, 69632
  s_xor_b32 s101, s90, 16896
  buffer_load_dwordx4 v244, s[36:39], s101 offen offset:0 nt lds
  buffer_load_dwordx4 v245, s[36:39], s101 offen offset:1024 nt lds
  buffer_load_dwordx4 v246, s[36:39], s101 offen offset:2048 nt lds
  buffer_load_dwordx4 v247, s[36:39], s101 offen offset:3072 nt lds
  s_xor_b32 m0, s91, 102400
  s_xor_b32 s101, s90, 17152
  buffer_load_dwordx4 v244, s[36:39], s101 offen offset:0 nt lds
  buffer_load_dwordx4 v245, s[36:39], s101 offen offset:1024 nt lds
  buffer_load_dwordx4 v246, s[36:39], s101 offen offset:2048 nt lds
  buffer_load_dwordx4 v247, s[36:39], s101 offen offset:3072 nt lds
  s_mov_b64 s[40:41], s[26:27]
  s_mov_b32 s42, 0x300000
  s_mov_b32 s43, 0x20000
  v_lshrrev_b32 v13, 3, v1
  v_mul_u32_u24 v13, 24576, v13
  v_and_b32 v3, 7, v1
  v_lshl_add_u32 v13, v3, 4, v13
  s_lshr_b32 s94, s78, 5
  s_lshl_b32 s94, s94, 2
  s_and_b32 s97, s3, 3
  s_add_u32 s94, s94, s97
  s_lshl_b32 s95, s94, 6
  v_lshrrev_b32 v14, 3, v1
  v_lshlrev_b32 v14, 3, v14
  v_add_u32 v14, s95, v14
  s_mul_i32 s92, s94, 196608
  s_and_b32 s97, s2, 31
  s_lshl_b32 s97, s97, 7
  s_add_u32 s92, s92, s97
  s_add_u32 s92, s92, 0x800
  global_load_dwordx2 v[144:145], v14, s[24:25]
  buffer_load_dwordx4 v[128:131], v13, s[40:43], s92 offen nt
  s_add_u32 s92, s92, 6144
  buffer_load_dwordx4 v[132:135], v13, s[40:43], s92 offen nt
  s_add_u32 s92, s92, 6144
  buffer_load_dwordx4 v[136:139], v13, s[40:43], s92 offen nt
  s_add_u32 s92, s92, 6144
  buffer_load_dwordx4 v[140:143], v13, s[40:43], s92 offen nt
  v_lshrrev_b32 v253, 4, v1
  v_lshlrev_b32 v253, 13, v253
  v_and_b32 v3, 15, v1
  v_lshl_add_u32 v253, v3, 4, v253
  s_lshl_b32 s88, s77, 19
  s_bfe_u32 s97, s3, 0x10001
  s_lshl_b32 s97, s97, 18
  s_add_u32 s88, s88, s97
  s_and_b32 s97, s3, 1
  s_lshl_b32 s97, s97, 15
  s_add_u32 s88, s88, s97
  s_lshl_b32 s97, s76, 8
  s_add_u32 s88, s88, s97
  v_lshrrev_b32 v251, 5, v1
  v_mul_u32_u24 v251, 3584, v251
  v_and_b32 v3, 31, v1
  v_lshl_add_u32 v251, v3, 4, v251
  s_mul_i32 s89, s79, 114688
  s_and_b32 s97, s3, 3
  s_mul_i32 s97, s97, 28672
  s_add_u32 s89, s89, s97
  s_mul_i32 s97, s80, 448
  s_add_u32 s89, s89, s97
  s_barrier
  s_branch L_back1
L_back:
  v_lshlrev_b32 v12, 21, v1
  v_add_u32 v12, 0xf000, v12
  s_mov_b64 exec, 0x3f
  buffer_load_dword v254, v12, s[32:35], 0 offen
  s_mov_b64 exec, -1
  s_and_b32 s81, s3, 3
  s_lshl_b32 s81, s81, 13
  s_add_u32 s81, s81, 0x10000
  v_lshlrev_b32 v8, 4, v1
  s_add_u32 s82, s81, 4096
  v_lshrrev_b32 v9, 4, v1
  v_lshlrev_b32 v9, 13, v9
  v_and_b32 v3, 15, v1
  v_lshl_add_u32 v9, v3, 4, v9
  s_and_b32 s93, s3, 3
  s_lshl_b32 s93, s93, 11
  s_and_b32 s97, s3, 1
  s_lshl_b32 s97, s97, 5
  s_add_u32 s93, s93, s97
  s_add_u32 s93, s93, 0x20000
  v_xor_b32 v9, s93, v9
  v_lshrrev_b32 v253, 4, v1
  v_lshlrev_b32 v253, 13, v253
  v_and_b32 v3, 15, v1
  v_lshl_add_u32 v253, v3, 4, v253
  s_lshl_b32 s88, s77, 19
  s_bfe_u32 s97, s3, 0x10001
  s_lshl_b32 s97, s97, 18
  s_add_u32 s88, s88, s97
  s_and_b32 s97, s3, 1
  s_lshl_b32 s97, s97, 15
  s_add_u32 s88, s88, s97
  s_lshl_b32 s97, s76, 8
  s_add_u32 s88, s88, s97
  v_lshrrev_b32 v251, 4, v1
  v_lshlrev_b32 v251, 10, v251
  v_and_b32 v3, 15, v1
  v_lshl_add_u32 v251, v3, 4, v251
  s_lshl_b32 s89, s76, 17
  s_and_b32 s97, s3, 3
  s_lshl_b32 s97, s97, 15
  s_add_u32 s89, s89, s97
  s_lshl_b32 s97, s77, 8
  s_add_u32 s89, s89, s97
  s_barrier
L_back1:
  buffer_load_dwordx4 v[48:51], v8, s[32:35], s81 offen offset:0 sc1
  buffer_load_dwordx4 v[52:55], v8, s[32:35], s81 offen offset:1024 sc1
  buffer_load_dwordx4 v[56:59], v8, s[32:35], s81 offen offset:2048 sc1
  buffer_load_dwordx4 v[60:63], v8, s[32:35], s81 offen offset:3072 sc1
  buffer_load_dwordx4 v[64:67], v8, s[32:35], s82 offen offset:0 sc1
  buffer_load_dwordx4 v[68:71], v8, s[32:35], s82 offen offset:1024 sc1
  buffer_load_dwordx4 v[72:75], v8, s[32:35], s82 offen offset:2048 sc1
  buffer_load_dwordx4 v[76:79], v8, s[32:35], s82 offen offset:3072 sc1
  s_branch L_setup
L_back2:
  s_mov_b64 s[60:61], -1
  s_mov_b64 s[62:63], -1
  s_mov_b64 s[64:65], -1
  s_mov_b64 s[66:67], -1
  s_mov_b64 s[68:69], -1
  s_mov_b64 s[70:71], -1
  s_mov_b64 s[72:73], -1
  s_mov_b64 s[74:75], -1
  s_waitcnt vmcnt(0)
  s_mov_b32 s100, 0
  s_branch L_gc_23
L_g_21:
  s_add_u32 s100, s100, 1
  s_cmp_gt_u32 s100, 100000
  s_cbranch_scc1 L_abort
  s_mov_b32 s92, 0
  s_cmp_lg_u32 s74, 0
  s_cselect_b32 s92, 7168, s92
  s_cmp_lg_u32 s72, 0
  s_cselect_b32 s92, 6144, s92
  s_cmp_lg_u32 s70, 0
  s_cselect_b32 s92, 5120, s92
  s_cmp_lg_u32 s68, 0
  s_cselect_b32 s92, 4096, s92
  s_cmp_lg_u32 s66, 0
  s_cselect_b32 s92, 3072, s92
  s_cmp_lg_u32 s64, 0
  s_cselect_b32 s92, 2048, s92
  s_cmp_lg_u32 s62, 0
  s_cselect_b32 s92, 1024, s92
  s_cmp_lg_u32 s60, 0
  s_cselect_b32 s92, 0, s92
  s_add_u32 s92, s92, s81
  s_mov_b64 exec, -1
L_qg_24:
  buffer_load_dwordx4 v[16:19], v8, s[32:35], s92 offen sc1
  s_add_u32 s100, s100, 1
  s_cmp_gt_u32 s100, 100000
  s_cbranch_scc1 L_abort
  s_waitcnt vmcnt(0)
  v_xor_b32 v16, v16, v4
  v_bitop3_b32 v16, v17, v5, v16 bitop3:0xbe
  v_bitop3_b32 v16, v18, v6, v16 bitop3:0xbe
  v_bitop3_b32 v16, v19, v7, v16 bitop3:0xbe
  v_and_b32 v16, s53, v16
  v_cmp_ne_u32 vcc, 0, v16
  s_nop 0
  s_cbranch_vccz L_qg_24x
  s_sleep 4
  s_branch L_qg_24
L_qg_24x:
L_gf_22:
  s_mov_b64 exec, s[60:61]
  s_cbranch_execz L_gs_25
  buffer_load_dwordx4 v[48:51], v8, s[32:35], s81 offen offset:0 sc1
L_gs_25:
  s_mov_b64 exec, s[62:63]
  s_cbranch_execz L_gs_26
  buffer_load_dwordx4 v[52:55], v8, s[32:35], s81 offen offset:1024 sc1
L_gs_26:
  s_mov_b64 exec, s[64:65]
  s_cbranch_execz L_gs_27
  buffer_load_dwordx4 v[56:59], v8, s[32:35], s81 offen offset:2048 sc1
L_gs_27:
  s_mov_b64 exec, s[66:67]
  s_cbranch_execz L_gs_28
  buffer_load_dwordx4 v[60:63], v8, s[32:35], s81 offen offset:3072 sc1
L_gs_28:
  s_mov_b64 exec, s[68:69]
  s_cbranch_execz L_gs_29
  buffer_load_dwordx4 v[64:67], v8, s[32:35], s82 offen offset:0 sc1
L_gs_29:
  s_mov_b64 exec, s[70:71]
  s_cbranch_execz L_gs_30
  buffer_load_dwordx4 v[68:71], v8, s[32:35], s82 offen offset:1024 sc1
L_gs_30:
  s_mov_b64 exec, s[72:73]
  s_cbranch_execz L_gs_31
  buffer_load_dwordx4 v[72:75], v8, s[32:35], s82 offen offset:2048 sc1
L_gs_31:
  s_mov_b64 exec, s[74:75]
  s_cbranch_execz L_gs_32
  buffer_load_dwordx4 v[76:79], v8, s[32:35], s82 offen offset:3072 sc1
L_gs_32:
  s_waitcnt vmcnt(0)
L_gc_23:
  s_mov_b64 exec, s[60:61]
  v_xor_b32 v44, v48, v4
  v_bitop3_b32 v44, v49, v5, v44 bitop3:0xbe
  v_bitop3_b32 v44, v50, v6, v44 bitop3:0xbe
  v_bitop3_b32 v44, v51, v7, v44 bitop3:0xbe
  v_and_b32 v44, s53, v44
  v_cmp_ne_u32 s[60:61], 0, v44
  s_nop 0
  s_cmp_lg_u64 s[60:61], 0
  s_cselect_b64 s[60:61], -1, 0
  s_mov_b64 exec, s[62:63]
  v_xor_b32 v44, v52, v4
  v_bitop3_b32 v44, v53, v5, v44 bitop3:0xbe
  v_bitop3_b32 v44, v54, v6, v44 bitop3:0xbe
  v_bitop3_b32 v44, v55, v7, v44 bitop3:0xbe
  v_and_b32 v44, s53, v44
  v_cmp_ne_u32 s[62:63], 0, v44
  s_nop 0
  s_cmp_lg_u64 s[62:63], 0
  s_cselect_b64 s[62:63], -1, 0
  s_mov_b64 exec, s[64:65]
  v_xor_b32 v44, v56, v4
  v_bitop3_b32 v44, v57, v5, v44 bitop3:0xbe
  v_bitop3_b32 v44, v58, v6, v44 bitop3:0xbe
  v_bitop3_b32 v44, v59, v7, v44 bitop3:0xbe
  v_and_b32 v44, s53, v44
  v_cmp_ne_u32 s[64:65], 0, v44
  s_nop 0
  s_cmp_lg_u64 s[64:65], 0
  s_cselect_b64 s[64:65], -1, 0
  s_mov_b64 exec, s[66:67]
  v_xor_b32 v44, v60, v4
  v_bitop3_b32 v44, v61, v5, v44 bitop3:0xbe
  v_bitop3_b32 v44, v62, v6, v44 bitop3:0xbe
  v_bitop3_b32 v44, v63, v7, v44 bitop3:0xbe
  v_and_b32 v44, s53, v44
  v_cmp_ne_u32 s[66:67], 0, v44
  s_nop 0
  s_cmp_lg_u64 s[66:67], 0
  s_cselect_b64 s[66:67], -1, 0
  s_mov_b64 exec, s[68:69]
  v_xor_b32 v44, v64, v4
  v_bitop3_b32 v44, v65, v5, v44 bitop3:0xbe
  v_bitop3_b32 v44, v66, v6, v44 bitop3:0xbe
  v_bitop3_b32 v44, v67, v7, v44 bitop3:0xbe
  v_and_b32 v44, s53, v44
  v_cmp_ne_u32 s[68:69], 0, v44
  s_nop 0
  s_cmp_lg_u64 s[68:69], 0
  s_cselect_b64 s[68:69], -1, 0
  s_mov_b64 exec, s[70:71]
  v_xor_b32 v44, v68, v4
  v_bitop3_b32 v44, v69, v5, v44 bitop3:0xbe
  v_bitop3_b32 v44, v70, v6, v44 bitop3:0xbe
  v_bitop3_b32 v44, v71, v7, v44 bitop3:0xbe
  v_and_b32 v44, s53, v44
  v_cmp_ne_u32 s[70:71], 0, v44
  s_nop 0
  s_cmp_lg_u64 s[70:71], 0
  s_cselect_b64 s[70:71], -1, 0
  s_mov_b64 exec, s[72:73]
  v_xor_b32 v44, v72, v4
  v_bitop3_b32 v44, v73, v5, v44 bitop3:0xbe
  v_bitop3_b32 v44, v74, v6, v44 bitop3:0xbe
  v_bitop3_b32 v44, v75, v7, v44 bitop3:0xbe
  v_and_b32 v44, s53, v44
  v_cmp_ne_u32 s[72:73], 0, v44
  s_nop 0
  s_cmp_lg_u64 s[72:73], 0
  s_cselect_b64 s[72:73], -1, 0
  s_mov_b64 exec, s[74:75]
  v_xor_b32 v44, v76, v4
  v_bitop3_b32 v44, v77, v5, v44 bitop3:0xbe
  v_bitop3_b32 v44, v78, v6, v44 bitop3:0xbe
  v_bitop3_b32 v44, v79, v7, v44 bitop3:0xbe
  v_and_b32 v44, s53, v44
  v_cmp_ne_u32 s[74:75], 0, v44
  s_nop 0
  s_cmp_lg_u64 s[74:75], 0
  s_cselect_b64 s[74:75], -1, 0
  s_or_b64 s[96:97], s[60:61], s[62:63]
  s_or_b64 s[96:97], s[96:97], s[64:65]
  s_or_b64 s[96:97], s[96:97], s[66:67]
  s_or_b64 s[96:97], s[96:97], s[68:69]
  s_or_b64 s[96:97], s[96:97], s[70:71]
  s_or_b64 s[96:97], s[96:97], s[72:73]
  s_or_b64 s[96:97], s[96:97], s[74:75]
  s_cbranch_scc1 L_g_21
  s_mov_b64 exec, -1
  s_cmp_le_u32 s100, 0
  s_cselect_b32 s101, 0, 0
  v_xor_b32 v10, 0, v9
  ds_write_b128 v10, v[48:51] offset:0
  v_xor_b32 v11, 64, v9
  ds_write_b128 v11, v[52:55] offset:256
  v_xor_b32 v10, 128, v9
  ds_write_b128 v10, v[56:59] offset:512
  v_xor_b32 v11, 192, v9
  ds_write_b128 v11, v[60:63] offset:768
  v_xor_b32 v10, 16, v9
  ds_write_b128 v10, v[64:67] offset:1024
  v_xor_b32 v11, 80, v9
  ds_write_b128 v11, v[68:71] offset:1280
  v_xor_b32 v10, 144, v9
  ds_write_b128 v10, v[72:75] offset:1536
  v_xor_b32 v11, 208, v9
  ds_write_b128 v11, v[76:79] offset:1792
  s_mov_b64 s[40:41], s[14:15]
  s_mov_b32 s42, 0x400000
  s_mov_b32 s43, 0x20000
  s_mov_b64 s[44:45], s[12:13]
  s_mov_b32 s46, 0x400000
  s_mov_b32 s47, 0x20000
  s_waitcnt lgkmcnt(0)
  s_setprio 3
  s_barrier
  s_cmp_lt_u32 s2, 128
  s_cbranch_scc0 L_lwB
  s_cmp_lg_u32 s101, 0
  s_cbranch_scc1 L_lwX
  buffer_load_dwordx4 v[176:179], v253, s[44:47], s88 offen nt
  s_add_u32 s88, s88, 65536
  buffer_load_dwordx4 v[180:183], v253, s[44:47], s88 offen nt
  s_add_u32 s88, s88, 65536
  buffer_load_dwordx4 v[184:187], v253, s[44:47], s88 offen nt
  s_add_u32 s88, s88, 65536
  buffer_load_dwordx4 v[188:191], v253, s[44:47], s88 offen nt
  buffer_load_dwordx4 v[208:211], v251, s[40:43], s89 offen nt
  s_add_u32 s89, s89, 4096
  buffer_load_dwordx4 v[212:215], v251, s[40:43], s89 offen nt
  s_add_u32 s89, s89, 4096
  buffer_load_dwordx4 v[216:219], v251, s[40:43], s89 offen nt
  s_add_u32 s89, s89, 4096
  buffer_load_dwordx4 v[220:223], v251, s[40:43], s89 offen nt
  s_add_u32 s89, s89, 4096
  buffer_load_dwordx4 v[224:227], v251, s[40:43], s89 offen nt
  s_add_u32 s89, s89, 4096
  buffer_load_dwordx4 v[228:231], v251, s[40:43], s89 offen nt
  s_add_u32 s89, s89, 4096
  buffer_load_dwordx4 v[232:235], v251, s[40:43], s89 offen nt
  s_add_u32 s89, s89, 4096
  buffer_load_dwordx4 v[236:239], v251, s[40:43], s89 offen nt
L_lwX:
  s_barrier
  s_barrier
  s_barrier
  s_branch L_pv
L_lwB:
  s_cmp_lg_u32 s101, 0
  s_cbranch_scc1 L_lwB2
  buffer_load_dwordx4 v[176:179], v253, s[44:47], s88 offen nt
  s_add_u32 s88, s88, 65536
  buffer_load_dwordx4 v[180:183], v253, s[44:47], s88 offen nt
  s_add_u32 s88, s88, 65536
  buffer_load_dwordx4 v[184:187], v253, s[44:47], s88 offen nt
  s_add_u32 s88, s88, 65536
  buffer_load_dwordx4 v[188:191], v253, s[44:47], s88 offen nt
  s_mov_b64 s[40:41], s[18:19]
  s_mov_b32 s42, 0x1c0000
  s_mov_b32 s43, 0x20000
  s_mov_b64 s[44:45], s[20:21]
  s_mov_b32 s46, 0x1c0000
  s_mov_b32 s47, 0x20000
  s_mov_b32 exec_lo, 0xfffffff
  s_mov_b32 exec_hi, 0xfffffff
  buffer_load_dwordx4 v[208:211], v251, s[40:43], s89 offen nt
  buffer_load_dwordx4 v[212:215], v251, s[44:47], s89 offen nt
  s_add_u32 s89, s89, 7168
  buffer_load_dwordx4 v[216:219], v251, s[40:43], s89 offen nt
  buffer_load_dwordx4 v[220:223], v251, s[44:47], s89 offen nt
  s_add_u32 s89, s89, 7168
  buffer_load_dwordx4 v[224:227], v251, s[40:43], s89 offen nt
  buffer_load_dwordx4 v[228:231], v251, s[44:47], s89 offen nt
  s_add_u32 s89, s89, 7168
  buffer_load_dwordx4 v[232:235], v251, s[40:43], s89 offen nt
  buffer_load_dwordx4 v[236:239], v251, s[44:47], s89 offen nt
  s_mov_b64 exec, -1
L_lwB2:
  s_and_b32 s74, s2, 31
  s_lshl_b32 s74, s74, 10
  s_lshr_b32 s97, s78, 5
  s_lshl_b32 s97, s97, 8
  s_add_u32 s74, s74, s97
  s_add_u32 s74, s74, 0x4000
  v_and_b32 v13, 7, v1
  v_lshlrev_b32 v13, 2, v13
  v_lshrrev_b32 v14, 4, v1
  v_add_u32 v13, v13, v14
  v_lshlrev_b32 v13, 5, v13
  s_lshl_b32 s92, s3, 2
  s_add_u32 s92, s92, 141296
  v_add_u32 v13, s92, v13
  v_lshlrev_b32 v14, 6, v1
  v_add_u32 v14, 141312, v14
  v_lshlrev_b32 v15, 4, v1
  v_xor_b32 v13, s59, v13
  v_xor_b32 v14, s59, v14
  s_waitcnt vmcnt(63)
  v_lshlrev_b32 v116, 16, v144
  v_and_b32 v117, 0xffff0000, v144
  v_lshlrev_b32 v118, 16, v145
  v_and_b32 v119, 0xffff0000, v145
  v_mul_f32 v112, 0xbfb8aa3b, v116
  v_mul_f32 v113, 0xbfb8aa3b, v117
  v_mul_f32 v114, 0xbfb8aa3b, v118
  v_mul_f32 v115, 0xbfb8aa3b, v119
  v_exp_f32 v112, v112
  v_exp_f32 v113, v113
  v_exp_f32 v114, v114
  v_exp_f32 v115, v115
  v_add_f32 v112, 1.0, v112
  v_add_f32 v113, 1.0, v113
  v_add_f32 v114, 1.0, v114
  v_add_f32 v115, 1.0, v115
  v_rcp_f32 v112, v112
  v_rcp_f32 v113, v113
  v_rcp_f32 v114, v114
  v_rcp_f32 v115, v115
  v_mul_f32 v116, v116, v112
  v_mul_f32 v117, v117, v113
  v_mul_f32 v118, v118, v114
  v_mul_f32 v119, v119, v115
  v_cvt_pk_bf16_f32 v116, v116, v116
  v_cvt_pk_bf16_f32 v117, v117, v117
  v_cvt_pk_bf16_f32 v118, v118, v118
  v_cvt_pk_bf16_f32 v119, v119, v119
  v_lshrrev_b32 v112, 16, v116
  v_lshrrev_b32 v113, 16, v117
  v_lshrrev_b32 v114, 16, v118
  v_lshrrev_b32 v115, 16, v119
  v_and_b32 v116, 0xffff0000, v116
  v_and_b32 v117, 0xffff0000, v117
  v_and_b32 v118, 0xffff0000, v118
  v_and_b32 v119, 0xffff0000, v119
  v_mov_b32 v96, 0
  v_mov_b32 v97, 0
  v_mov_b32 v98, 0
  v_mov_b32 v99, 0
  v_mov_b32 v100, 0
  v_mov_b32 v101, 0
  v_mov_b32 v102, 0
  v_mov_b32 v103, 0
  s_waitcnt vmcnt(63)
  v_dot2c_f32_bf16 v96, v112, v128
  v_dot2c_f32_bf16 v97, v116, v128
  v_dot2c_f32_bf16 v98, v112, v129
  v_dot2c_f32_bf16 v99, v116, v129
  v_dot2c_f32_bf16 v100, v112, v130
  v_dot2c_f32_bf16 v101, v116, v130
  v_dot2c_f32_bf16 v102, v112, v131
  v_dot2c_f32_bf16 v103, v116, v131
  s_waitcnt vmcnt(62)
  v_dot2c_f32_bf16 v96, v113, v132
  v_dot2c_f32_bf16 v97, v117, v132
  v_dot2c_f32_bf16 v98, v113, v133
  v_dot2c_f32_bf16 v99, v117, v133
  v_dot2c_f32_bf16 v100, v113, v134
  v_dot2c_f32_bf16 v101, v117, v134
  v_dot2c_f32_bf16 v102, v113, v135
  v_dot2c_f32_bf16 v103, v117, v135
  s_waitcnt vmcnt(61)
  v_dot2c_f32_bf16 v96, v114, v136
  v_dot2c_f32_bf16 v97, v118, v136
  v_dot2c_f32_bf16 v98, v114, v137
  v_dot2c_f32_bf16 v99, v118, v137
  v_dot2c_f32_bf16 v100, v114, v138
  v_dot2c_f32_bf16 v101, v118, v138
  v_dot2c_f32_bf16 v102, v114, v139
  v_dot2c_f32_bf16 v103, v118, v139
  s_waitcnt vmcnt(60)
  v_dot2c_f32_bf16 v96, v115, v140
  v_dot2c_f32_bf16 v97, v119, v140
  v_dot2c_f32_bf16 v98, v115, v141
  v_dot2c_f32_bf16 v99, v119, v141
  v_dot2c_f32_bf16 v100, v115, v142
  v_dot2c_f32_bf16 v101, v119, v142
  v_dot2c_f32_bf16 v102, v115, v143
  v_dot2c_f32_bf16 v103, v119, v143
  v_permlane32_swap_b32 v96, v100
  v_permlane32_swap_b32 v97, v101
  v_permlane32_swap_b32 v98, v102
  v_permlane32_swap_b32 v99, v103
  v_add_f32 v96, v96, v100
  v_add_f32 v97, v97, v101
  v_add_f32 v98, v98, v102
  v_add_f32 v99, v99, v103
  s_nop 0
  v_permlane16_swap_b32 v96, v98
  v_permlane16_swap_b32 v97, v99
  v_add_f32 v96, v96, v98
  v_add_f32 v97, v97, v99
  s_nop 0
  v_add_f32_dpp v96, v96, v96 row_ror:8 row_mask:0xf bank_mask:0xf
  v_add_f32_dpp v97, v97, v97 row_ror:8 row_mask:0xf bank_mask:0xf
  s_barrier
  ds_write2_b32 v13, v96, v97 offset0:0 offset1:4
  s_waitcnt lgkmcnt(0)
  s_barrier
  s_cmp_lg_u32 s3, 4
  s_cbranch_scc1 L_nopub_33
  s_mov_b64 exec, 0xffff
  ds_read_b128 v[128:131], v14 offset:0
  ds_read_b128 v[132:135], v14 offset:16
  ds_read_b128 v[136:139], v14 offset:32
  ds_read_b128 v[140:143], v14 offset:48
  s_waitcnt lgkmcnt(3)
  v_add_f32 v128, v128, v129
  v_add_f32 v130, v130, v131
  v_add_f32 v128, v128, v130
  s_waitcnt lgkmcnt(2)
  v_add_f32 v132, v132, v133
  v_add_f32 v134, v134, v135
  v_add_f32 v132, v132, v134
  s_waitcnt lgkmcnt(1)
  v_add_f32 v136, v136, v137
  v_add_f32 v138, v138, v139
  v_add_f32 v136, v136, v138
  s_waitcnt lgkmcnt(0)
  v_add_f32 v140, v140, v141
  v_add_f32 v142, v142, v143
  v_add_f32 v140, v140, v142
  v_and_or_b32 v100, v128, v2, s49
  v_and_or_b32 v101, v132, v2, s50
  v_and_or_b32 v102, v136, v2, s51
  v_and_or_b32 v103, v140, v2, s52
  buffer_store_dwordx4 v[100:103], v15, s[32:35], s74 offen sc1
L_nopub_33:
  s_mov_b64 exec, -1
  s_barrier
  s_branch L_pv
L_front:
  s_mov_b32 s100, 0
  s_waitcnt vmcnt(4)
  s_branch L_epc_35
L_ep_34:
  global_load_dword v252, v253, s[30:31] sc1
  s_add_u32 s100, s100, 1
  s_cmp_gt_u32 s100, 100000
  s_cbranch_scc1 L_abort
  s_waitcnt vmcnt(0)
L_epc_35:
  v_readfirstlane_b32 s48, v252
  s_nop 0
  s_cmp_eq_u32 s48, 0
  s_nop 1
  s_cbranch_scc1 L_ep_34
  s_mul_i32 s48, s48, 0x9e3779b1
  s_and_b32 s49, s48, 0xff
  s_bfe_u32 s50, s48, 0x80008
  s_bfe_u32 s51, s48, 0x80010
  s_lshr_b32 s52, s48, 24
  s_lshr_b32 s97, s48, 15
  s_xor_b32 s97, s97, s48
  s_mul_i32 s97, s97, 0x85ebca6b
  v_mov_b32 v4, s48
  v_mov_b32 v5, s97
  v_mov_b32 v249, s48
  v_mov_b32 v250, s97
  v_and_b32 v6, 4, v1
  v_cmp_eq_u32 vcc, 0, v6
  v_and_b32 v7, 3, v1
  v_lshlrev_b32 v7, 2, v7
  v_cndmask_b32 v4, v5, v4, vcc
  v_lshrrev_b32 v4, v7, v4
  v_lshrrev_b32 v5, 1, v4
  v_lshrrev_b32 v6, 2, v4
  v_lshrrev_b32 v7, 3, v4
L_setup:
  s_lshr_b32 s92, s3, 1
  s_lshl_b32 s92, s92, 15
  s_and_b32 s93, s3, 1
  v_lshlrev_b32 v34, 4, v1
  v_bfe_u32 v44, v1, 2, 2
  v_lshrrev_b32 v45, 5, v1
  v_lshl_add_u32 v46, v45, 2, v44
  v_lshlrev_b32 v46, 8, v46
  v_add_u32 v46, s92, v46
  v_and_b32 v47, 1, v1
  v_lshl_add_u32 v46, v47, 3, v46
  v_lshl_or_b32 v44, v44, 2, v45
  v_bfe_u32 v47, v1, 4, 1
  v_lshlrev_b32 v47, 1, v47
  v_xor_b32 v44, v44, v47
  v_bfe_u32 v47, v1, 1, 1
  v_xor_b32 v44, v44, v47
  s_lshl_b32 s94, s93, 3
  v_xor_b32 v44, s94, v44
  v_xor_b32 v47, 0, v44
  v_lshl_add_u32 v24, v47, 4, v46
  v_xor_b32 v47, 2, v44
  v_lshl_add_u32 v25, v47, 4, v46
  v_add_u32 v25, 2048, v25
  v_xor_b32 v47, 4, v44
  v_lshl_add_u32 v26, v47, 4, v46
  v_xor_b32 v47, 6, v44
  v_lshl_add_u32 v27, v47, 4, v46
  v_add_u32 v27, 2048, v27
  v_add_u32 v28, 132096, v34
  v_and_b32 v44, 31, v1
  v_lshlrev_b32 v29, 5, v44
  v_add_u32 v29, 131072, v29
  v_xor_b32 v28, s59, v28
  v_xor_b32 v29, s59, v29
  s_lshl_b32 s94, s93, 7
  s_add_u32 s94, s94, s92
  v_and_b32 v46, 3, v44
  v_lshlrev_b32 v46, 6, v46
  v_lshl_add_u32 v46, v44, 8, v46
  v_bfe_u32 v47, v44, 1, 2
  v_lshlrev_b32 v45, 1, v45
  v_xor_b32 v47, v47, v45
  v_lshl_add_u32 v46, v47, 4, v46
  v_xor_b32 v244, s94, v46
  v_xor_b32 v245, 16, v244
  v_xor_b32 v246, 64, v244
  v_xor_b32 v247, 0x50, v244
  v_lshrrev_b32 v44, 2, v1
  v_and_b32 v46, 3, v44
  v_lshlrev_b32 v46, 6, v46
  v_lshl_add_u32 v46, v44, 8, v46
  v_bfe_u32 v47, v44, 1, 2
  v_and_b32 v45, 3, v1
  v_xor_b32 v47, v47, v45
  v_lshl_add_u32 v46, v47, 4, v46
  v_xor_b32 v32, s94, v46
  v_xor_b32 v33, 64, v32
  v_lshrrev_b32 v44, 3, v1
  v_bfe_u32 v45, v1, 2, 1
  v_and_b32 v46, 3, v44
  v_xor_b32 v46, v46, v45
  v_lshlrev_b32 v46, 6, v46
  v_lshl_add_u32 v46, v44, 8, v46
  v_lshrrev_b32 v47, 1, v44
  v_and_b32 v45, 3, v1
  v_xor_b32 v47, v47, v45
  v_lshl_add_u32 v46, v47, 4, v46
  v_xor_b32 v32, s94, v46
  s_mul_i32 s87, s2, 32896
  s_lshl_b32 s97, s3, 12
  s_add_u32 s87, s87, s97
  s_add_u32 s87, s87, 0x200000
  s_lshl_b32 s94, s76, 4
  s_lshl_b32 s97, s3, 9
  s_add_u32 s94, s94, s97
  s_add_u32 s94, s94, 0x20000
  v_lshrrev_b32 v35, 3, v1
  v_lshlrev_b32 v35, 12, v35
  v_add_u32 v35, s94, v35
  v_lshlrev_b32 v248, 4, v1
  v_lshrrev_b32 v36, 3, v1
  v_mul_u32_u24 v36, 263168, v36
  v_and_b32 v3, 7, v1
  v_lshl_add_u32 v36, v3, 4, v36
  s_mul_i32 s94, s3, 32896
  s_lshl_b32 s97, s77, 12
  s_add_u32 s94, s94, s97
  s_lshl_b32 s97, s76, 7
  s_add_u32 s94, s94, s97
  s_add_u32 s83, s94, 6307840
  s_add_u32 s84, s94, 8413184
  s_add_u32 s85, s94, 2097152
  s_add_u32 s86, s94, 4202496
  s_mul_i32 s94, s3, 144
  s_add_u32 s94, s94, 0x14000
  v_and_b32 v37, 7, v1
  v_lshlrev_b32 v37, 4, v37
  v_lshrrev_b32 v3, 4, v1
  v_lshl_add_u32 v37, v3, 2, v37
  v_add_u32 v37, s94, v37
  v_and_b32 v38, 7, v1
  v_mul_u32_u24 v38, 144, v38
  v_lshrrev_b32 v3, 4, v1
  v_lshl_add_u32 v38, v3, 4, v38
  v_add_u32 v38, 81920, v38
  s_lshl_b32 s94, s3, 7
  s_add_u32 s94, s94, 0x16c00
  v_lshrrev_b32 v41, 4, v1
  v_lshlrev_b32 v41, 4, v41
  v_add_u32 v41, s94, v41
  v_and_b32 v40, 7, v1
  v_mul_u32_u24 v40, 272, v40
  v_lshrrev_b32 v3, 4, v1
  v_lshl_add_u32 v40, v3, 4, v40
  v_add_u32 v40, 94208, v40
  s_lshl_b32 s94, s76, 12
  s_lshl_b32 s97, s3, 6
  s_add_u32 s94, s94, s97
  s_add_u32 s94, s94, 0x40000
  v_bfe_u32 v39, v1, 2, 3
  v_lshlrev_b32 v39, 9, v39
  v_and_b32 v3, 3, v1
  v_lshl_add_u32 v39, v3, 4, v39
  v_add_u32 v39, s94, v39
  s_lshl_b32 s95, s77, 9
  s_add_u32 s16, s94, s95
  s_and_b32 s94, s3, 3
  s_mul_i32 s94, s94, 4864
  v_lshrrev_b32 v240, 4, v1
  v_mul_u32_u24 v240, 288, v240
  v_and_b32 v3, 15, v1
  v_lshl_add_u32 v240, v3, 4, v240
  v_add_u32 v240, s94, v240
  s_and_b32 s94, s3, 3
  s_mul_i32 s94, s94, 9728
  s_add_u32 s94, s94, 0x5000
  v_lshrrev_b32 v241, 4, v1
  v_mul_u32_u24 v241, 288, v241
  v_and_b32 v3, 15, v1
  v_lshl_add_u32 v241, v3, 4, v241
  v_add_u32 v241, s94, v241
  s_lshl_b32 s94, s3, 5
  v_lshrrev_b32 v242, 4, v1
  v_mul_u32_u24 v242, 2432, v242
  v_bfe_u32 v3, v1, 2, 2
  v_mul_u32_u24 v3, 288, v3
  v_add_u32 v242, v3, v242
  v_and_b32 v3, 3, v1
  v_lshl_add_u32 v242, v3, 3, v242
  v_add_u32 v242, s94, v242
  v_lshrrev_b32 v243, 4, v1
  v_mul_u32_u24 v243, 2432, v243
  v_bfe_u32 v3, v1, 2, 2
  v_mul_u32_u24 v3, 288, v3
  v_add_u32 v243, v3, v243
  v_and_b32 v3, 3, v1
  v_lshl_add_u32 v243, v3, 3, v243
  v_add_u32 v243, 20480, v243
  v_add_u32 v243, s94, v243
  v_bfe_u32 v43, v1, 2, 3
  v_mul_u32_u24 v43, 272, v43
  v_and_b32 v3, 3, v1
  v_lshl_add_u32 v43, v3, 3, v43
  v_add_u32 v43, 94208, v43
  v_add_u32 v43, s94, v43
  s_cmp_ge_u32 s3, 4
  s_cbranch_scc1 L_back2
  v_and_b32 v44, 31, v1
  v_and_b32 v46, 3, v44
  v_lshlrev_b32 v46, 2, v46
  v_bfe_u32 v47, v44, 2, 2
  v_or_b32 v46, v46, v47
  v_lshrrev_b32 v47, 5, v1
  v_xor_b32 v46, v46, v47
  v_lshlrev_b32 v45, 8, v44
  v_xor_b32 v47, 0, v46
  v_lshl_add_u32 v16, v47, 4, v45
  v_xor_b32 v47, 2, v46
  v_lshl_add_u32 v17, v47, 4, v45
  v_xor_b32 v47, 4, v46
  v_lshl_add_u32 v18, v47, 4, v45
  v_xor_b32 v47, 6, v46
  v_lshl_add_u32 v19, v47, 4, v45
  v_xor_b32 v47, 8, v46
  v_lshl_add_u32 v20, v47, 4, v45
  v_xor_b32 v47, 10, v46
  v_lshl_add_u32 v21, v47, 4, v45
  v_xor_b32 v47, 12, v46
  v_lshl_add_u32 v22, v47, 4, v45
  v_xor_b32 v47, 14, v46
  v_lshl_add_u32 v23, v47, 4, v45
  s_lshl_b32 s92, s17, 13
  s_add_u32 s92, s92, 131072
  v_add_u32 v8, s91, v16
  v_add_u32 v16, s92, v16
  v_add_u32 v9, s91, v17
  v_add_u32 v17, s92, v17
  v_add_u32 v10, s91, v18
  v_add_u32 v18, s92, v18
  v_add_u32 v11, s91, v19
  v_add_u32 v19, s92, v19
  v_add_u32 v12, s91, v20
  v_add_u32 v20, s92, v20
  v_add_u32 v13, s91, v21
  v_add_u32 v21, s92, v21
  v_add_u32 v14, s91, v22
  v_add_u32 v22, s92, v22
  v_add_u32 v15, s91, v23
  v_add_u32 v23, s92, v23
  s_lshl_b32 s92, s3, 2
  v_lshrrev_b32 v47, 5, v1
  v_lshl_add_u32 v30, v47, 4, v29
  v_add_u32 v30, s92, v30
  s_lshl_b32 s92, s3, 11
  v_add_u32 v31, s92, v28
  s_setprio 2
  s_mov_b32 s101, 1
  s_waitcnt vmcnt(4)
  s_barrier
  ds_read_b128 v[112:115], v8
  ds_read_b128 v[116:119], v16
  ds_read_b128 v[120:123], v9
  ds_read_b128 v[124:127], v17
  ds_read_b128 v[128:131], v10
  ds_read_b128 v[132:135], v18
  ds_read_b128 v[136:139], v11
  ds_read_b128 v[140:143], v19
  ds_read_b128 v[144:147], v12
  ds_read_b128 v[148:151], v20
  ds_read_b128 v[152:155], v13
  ds_read_b128 v[156:159], v21
  v_xor_b32 v8, 0x8000, v8
  v_xor_b32 v16, 0x2000, v16
  v_xor_b32 v9, 0x8000, v9
  v_xor_b32 v17, 0x2000, v17
  v_xor_b32 v10, 0x8000, v10
  v_xor_b32 v18, 0x2000, v18
  v_xor_b32 v11, 0x8000, v11
  v_xor_b32 v19, 0x2000, v19
  v_xor_b32 v12, 0x8000, v12
  v_xor_b32 v20, 0x2000, v20
  v_xor_b32 v13, 0x8000, v13
  v_xor_b32 v21, 0x2000, v21
  s_waitcnt lgkmcnt(10)
  v_mfma_f32_32x32x16_bf16 v[96:111], v[112:115], v[116:119], 0
  ds_read_b128 v[160:163], v14
  ds_read_b128 v[164:167], v22
  v_xor_b32 v14, 0x8000, v14
  v_xor_b32 v22, 0x2000, v22
  s_waitcnt lgkmcnt(10)
  v_mfma_f32_32x32x16_bf16 v[96:111], v[120:123], v[124:127], v[96:111]
  ds_read_b128 v[168:171], v15
  ds_read_b128 v[172:175], v23
  v_xor_b32 v15, 0x8000, v15
  v_xor_b32 v23, 0x2000, v23
  s_waitcnt lgkmcnt(10)
  v_mfma_f32_32x32x16_bf16 v[96:111], v[128:131], v[132:135], v[96:111]
  ds_read_b128 v[112:115], v8
  ds_read_b128 v[116:119], v16
  v_xor_b32 v8, 0x18000, v8
  v_xor_b32 v16, 0x6000, v16
  s_waitcnt lgkmcnt(10)
  v_mfma_f32_32x32x16_bf16 v[96:111], v[136:139], v[140:143], v[96:111]
  ds_read_b128 v[120:123], v9
  ds_read_b128 v[124:127], v17
  v_xor_b32 v9, 0x18000, v9
  v_xor_b32 v17, 0x6000, v17
  s_waitcnt lgkmcnt(10)
  v_mfma_f32_32x32x16_bf16 v[96:111], v[144:147], v[148:151], v[96:111]
  ds_read_b128 v[128:131], v10
  ds_read_b128 v[132:135], v18
  v_xor_b32 v10, 0x18000, v10
  v_xor_b32 v18, 0x6000, v18
  s_waitcnt lgkmcnt(10)
  v_mfma_f32_32x32x16_bf16 v[96:111], v[152:155], v[156:159], v[96:111]
  ds_read_b128 v[136:139], v11
  ds_read_b128 v[140:143], v19
  v_xor_b32 v11, 0x18000, v11
  v_xor_b32 v19, 0x6000, v19
  s_waitcnt lgkmcnt(10)
  v_mfma_f32_32x32x16_bf16 v[96:111], v[160:163], v[164:167], v[96:111]
  ds_read_b128 v[144:147], v12
  ds_read_b128 v[148:151], v20
  v_xor_b32 v12, 0x18000, v12
  v_xor_b32 v20, 0x6000, v20
  s_waitcnt lgkmcnt(10)
  v_mfma_f32_32x32x16_bf16 v[96:111], v[168:171], v[172:175], v[96:111]
  ds_read_b128 v[152:155], v13
  ds_read_b128 v[156:159], v21
  v_xor_b32 v13, 0x18000, v13
  v_xor_b32 v21, 0x6000, v21
  s_waitcnt lgkmcnt(10)
  v_mfma_f32_32x32x16_bf16 v[96:111], v[112:115], v[116:119], v[96:111]
  ds_read_b128 v[160:163], v14
  ds_read_b128 v[164:167], v22
  v_xor_b32 v14, 0x18000, v14
  v_xor_b32 v22, 0x6000, v22
  s_waitcnt lgkmcnt(10)
  v_mfma_f32_32x32x16_bf16 v[96:111], v[120:123], v[124:127], v[96:111]
  ds_read_b128 v[168:171], v15
  ds_read_b128 v[172:175], v23
  v_xor_b32 v15, 0x18000, v15
  v_xor_b32 v23, 0x6000, v23
  s_waitcnt lgkmcnt(10)
  v_mfma_f32_32x32x16_bf16 v[96:111], v[128:131], v[132:135], v[96:111]
  ds_read_b128 v[112:115], v8
  ds_read_b128 v[116:119], v16
  v_xor_b32 v8, 0x8000, v8
  v_xor_b32 v16, 0x2000, v16
  s_waitcnt lgkmcnt(10)
  v_mfma_f32_32x32x16_bf16 v[96:111], v[136:139], v[140:143], v[96:111]
  ds_read_b128 v[120:123], v9
  ds_read_b128 v[124:127], v17
  v_xor_b32 v9, 0x8000, v9
  v_xor_b32 v17, 0x2000, v17
  s_waitcnt lgkmcnt(10)
  v_mfma_f32_32x32x16_bf16 v[96:111], v[144:147], v[148:151], v[96:111]
  ds_read_b128 v[128:131], v10
  ds_read_b128 v[132:135], v18
  v_xor_b32 v10, 0x8000, v10
  v_xor_b32 v18, 0x2000, v18
  s_waitcnt lgkmcnt(10)
  v_mfma_f32_32x32x16_bf16 v[96:111], v[152:155], v[156:159], v[96:111]
  ds_read_b128 v[136:139], v11
  ds_read_b128 v[140:143], v19
  v_xor_b32 v11, 0x8000, v11
  v_xor_b32 v19, 0x2000, v19
  s_waitcnt lgkmcnt(10)
  v_mfma_f32_32x32x16_bf16 v[96:111], v[160:163], v[164:167], v[96:111]
  ds_read_b128 v[144:147], v12
  ds_read_b128 v[148:151], v20
  v_xor_b32 v12, 0x8000, v12
  v_xor_b32 v20, 0x2000, v20
  s_waitcnt lgkmcnt(10)
  v_mfma_f32_32x32x16_bf16 v[96:111], v[168:171], v[172:175], v[96:111]
  ds_read_b128 v[152:155], v13
  ds_read_b128 v[156:159], v21
  v_xor_b32 v13, 0x8000, v13
  v_xor_b32 v21, 0x2000, v21
  s_barrier
  s_waitcnt lgkmcnt(10)
  v_mfma_f32_32x32x16_bf16 v[96:111], v[112:115], v[116:119], v[96:111]
  ds_read_b128 v[160:163], v14
  ds_read_b128 v[164:167], v22
  v_xor_b32 v14, 0x8000, v14
  v_xor_b32 v22, 0x2000, v22
  s_waitcnt lgkmcnt(10)
  v_mfma_f32_32x32x16_bf16 v[96:111], v[120:123], v[124:127], v[96:111]
  ds_read_b128 v[168:171], v15
  ds_read_b128 v[172:175], v23
  v_xor_b32 v15, 0x8000, v15
  v_xor_b32 v23, 0x2000, v23
  s_waitcnt lgkmcnt(10)
  v_mfma_f32_32x32x16_bf16 v[96:111], v[128:131], v[132:135], v[96:111]
  s_waitcnt vmcnt(0)
  ds_read_b128 v[112:115], v8
  ds_read_b128 v[116:119], v16
  s_waitcnt lgkmcnt(10)
  v_mfma_f32_32x32x16_bf16 v[96:111], v[136:139], v[140:143], v[96:111]
  ds_read_b128 v[120:123], v9
  ds_read_b128 v[124:127], v17
  s_waitcnt lgkmcnt(10)
  v_mfma_f32_32x32x16_bf16 v[96:111], v[144:147], v[148:151], v[96:111]
  ds_read_b128 v[128:131], v10
  ds_read_b128 v[132:135], v18
  s_waitcnt lgkmcnt(10)
  v_mfma_f32_32x32x16_bf16 v[96:111], v[152:155], v[156:159], v[96:111]
  ds_read_b128 v[136:139], v11
  ds_read_b128 v[140:143], v19
  s_waitcnt lgkmcnt(10)
  v_mfma_f32_32x32x16_bf16 v[96:111], v[160:163], v[164:167], v[96:111]
  ds_read_b128 v[144:147], v12
  ds_read_b128 v[148:151], v20
  s_waitcnt lgkmcnt(10)
  v_mfma_f32_32x32x16_bf16 v[96:111], v[168:171], v[172:175], v[96:111]
  ds_read_b128 v[152:155], v13
  ds_read_b128 v[156:159], v21
  s_waitcnt lgkmcnt(10)
  v_mfma_f32_32x32x16_bf16 v[96:111], v[112:115], v[116:119], v[96:111]
  ds_read_b128 v[160:163], v14
  ds_read_b128 v[164:167], v22
  s_waitcnt lgkmcnt(10)
  v_mfma_f32_32x32x16_bf16 v[96:111], v[120:123], v[124:127], v[96:111]
  ds_read_b128 v[168:171], v15
  ds_read_b128 v[172:175], v23
  s_waitcnt lgkmcnt(10)
  v_mfma_f32_32x32x16_bf16 v[96:111], v[128:131], v[132:135], v[96:111]
  s_waitcnt lgkmcnt(8)
  v_mfma_f32_32x32x16_bf16 v[96:111], v[136:139], v[140:143], v[96:111]
  s_waitcnt lgkmcnt(6)
  v_mfma_f32_32x32x16_bf16 v[96:111], v[144:147], v[148:151], v[96:111]
  s_waitcnt lgkmcnt(4)
  v_mfma_f32_32x32x16_bf16 v[96:111], v[152:155], v[156:159], v[96:111]
  s_waitcnt lgkmcnt(2)
  v_mfma_f32_32x32x16_bf16 v[96:111], v[160:163], v[164:167], v[96:111]
  s_waitcnt lgkmcnt(0)
  v_mfma_f32_32x32x16_bf16 v[96:111], v[168:171], v[172:175], v[96:111]
  s_nop 11
  v_max3_f32 v44, v96, v97, v98
  v_max3_f32 v45, v99, v100, v101
  v_max3_f32 v46, v102, v103, v104
  v_max3_f32 v47, v105, v106, v107
  v_max3_f32 v44, v44, v108, v109
  v_max3_f32 v45, v45, v110, v111
  v_max3_f32 v44, v44, v46, v47
  v_max_f32 v44, v44, v45
  ds_write_b32 v30, v44
  v_sub_f32 v96, v96, v44
  v_sub_f32 v97, v97, v44
  v_sub_f32 v98, v98, v44
  v_sub_f32 v99, v99, v44
  v_sub_f32 v100, v100, v44
  v_sub_f32 v101, v101, v44
  v_sub_f32 v102, v102, v44
  v_sub_f32 v103, v103, v44
  s_waitcnt lgkmcnt(0)
  s_barrier
  ds_read_b128 v[48:51], v29
  ds_read_b128 v[52:55], v29 offset:16
  v_exp_f32 v96, v96
  v_sub_f32 v104, v104, v44
  v_exp_f32 v97, v97
  v_sub_f32 v105, v105, v44
  v_exp_f32 v98, v98
  v_sub_f32 v106, v106, v44
  v_exp_f32 v99, v99
  v_sub_f32 v107, v107, v44
  v_exp_f32 v100, v100
  v_sub_f32 v108, v108, v44
  v_exp_f32 v101, v101
  v_sub_f32 v109, v109, v44
  v_exp_f32 v102, v102
  v_sub_f32 v110, v110, v44
  v_exp_f32 v103, v103
  v_sub_f32 v111, v111, v44
  s_waitcnt lgkmcnt(0)
  v_max3_f32 v45, v48, v49, v50
  v_max3_f32 v46, v51, v52, v53
  v_exp_f32 v104, v104
  v_max3_f32 v45, v45, v54, v55
  v_exp_f32 v105, v105
  v_max_f32 v45, v45, v46
  v_exp_f32 v106, v106
  v_sub_f32 v45, v44, v45
  v_exp_f32 v107, v107
  v_exp_f32 v45, v45
  v_exp_f32 v108, v108
  v_exp_f32 v109, v109
  v_exp_f32 v110, v110
  v_exp_f32 v111, v111
  v_mul_f32 v96, v96, v45
  v_mul_f32 v97, v97, v45
  v_mul_f32 v98, v98, v45
  v_mul_f32 v99, v99, v45
  v_mul_f32 v100, v100, v45
  v_mul_f32 v101, v101, v45
  v_mul_f32 v102, v102, v45
  v_mul_f32 v103, v103, v45
  v_cvt_pk_bf16_f32 v48, v96, v97
  v_cvt_pk_bf16_f32 v49, v98, v99
  v_cvt_pk_bf16_f32 v50, v100, v101
  v_cvt_pk_bf16_f32 v51, v102, v103
  ds_write_b128 v31, v[48:51] offset:0
  v_mul_f32 v104, v104, v45
  v_mul_f32 v105, v105, v45
  v_mul_f32 v106, v106, v45
  v_mul_f32 v107, v107, v45
  v_mul_f32 v108, v108, v45
  v_mul_f32 v109, v109, v45
  v_mul_f32 v110, v110, v45
  v_mul_f32 v111, v111, v45
  v_cvt_pk_bf16_f32 v52, v104, v105
  v_cvt_pk_bf16_f32 v53, v106, v107
  v_cvt_pk_bf16_f32 v54, v108, v109
  v_cvt_pk_bf16_f32 v55, v110, v111
  ds_write_b128 v31, v[52:55] offset:1024
  v_add_f32 v96, v96, v97
  v_add_f32 v98, v98, v99
  v_add_f32 v100, v100, v101
  v_add_f32 v102, v102, v103
  v_add_f32 v104, v104, v105
  v_add_f32 v106, v106, v107
  v_add_f32 v108, v108, v109
  v_add_f32 v110, v110, v111
  v_add_f32 v96, v96, v98
  v_add_f32 v100, v100, v102
  v_add_f32 v104, v104, v106
  v_add_f32 v108, v108, v110
  v_add_f32 v96, v96, v100
  v_add_f32 v104, v104, v108
  v_add_f32 v96, v96, v104
  ds_write_b32 v30, v96 offset:9216
  s_waitcnt lgkmcnt(0)
  s_barrier
L_pv:
  s_setprio 2
  ds_read_b128 v[48:51], v28 offset:0
  ds_read_b64_tr_b16 v[112:113], v24 offset:0
  ds_read_b64_tr_b16 v[114:115], v25 offset:0
  ds_read_b128 v[52:55], v28 offset:1024
  ds_read_b64_tr_b16 v[116:117], v24 offset:4096
  ds_read_b64_tr_b16 v[118:119], v25 offset:4096
  ds_read_b128 v[56:59], v28 offset:2048
  ds_read_b64_tr_b16 v[120:121], v24 offset:8192
  ds_read_b64_tr_b16 v[122:123], v25 offset:8192
  ds_read_b128 v[60:63], v28 offset:3072
  ds_read_b64_tr_b16 v[124:125], v24 offset:12288
  ds_read_b64_tr_b16 v[126:127], v25 offset:12288
  s_lshl_b32 s74, s2, 9
  s_add_u32 s74, s74, 0x20000
  s_mov_b32 s70, 0x10000
  s_mov_b32 s71, 0x18000
  s_mov_b32 s72, 0x8000
  s_cmp_lg_u32 s3, 7
  s_cbranch_scc1 L_nolse
  ds_read_b128 v[144:147], v29
  ds_read_b128 v[148:151], v29 offset:16
  s_waitcnt lgkmcnt(6)
  ds_read_b128 v[152:155], v29 offset:9216
  ds_read_b128 v[156:159], v29 offset:9232
  s_andn2_b32 s92, s48, 1
  v_mov_b32 v23, s92
  s_waitcnt lgkmcnt(2)
  v_max3_f32 v20, v144, v145, v146
  v_max3_f32 v21, v147, v148, v149
  v_max3_f32 v20, v20, v150, v151
  v_max_f32 v20, v20, v21
  s_waitcnt lgkmcnt(0)
  v_add_f32 v152, v152, v153
  v_add_f32 v154, v154, v155
  v_add_f32 v156, v156, v157
  v_add_f32 v158, v158, v159
  v_add_f32 v152, v152, v154
  v_add_f32 v156, v156, v158
  v_add_f32 v152, v152, v156
  v_mov_b32 v21, v152
  s_mov_b32 exec_hi, 0
  buffer_store_dwordx4 v[20:23], v248, s[32:35], s74 offen sc1
  s_mov_b32 exec_hi, -1
L_nolse:
  s_waitcnt lgkmcnt(9)
  v_mfma_f32_32x32x16_bf16 v[144:159], v[112:115], v[48:51], 0
  ds_read_b128 v[64:67], v28 offset:4096
  ds_read_b64_tr_b16 v[128:129], v24 offset:16384
  ds_read_b64_tr_b16 v[130:131], v25 offset:16384
  s_waitcnt lgkmcnt(9)
  v_mfma_f32_32x32x16_bf16 v[144:159], v[116:119], v[52:55], v[144:159]
  ds_read_b128 v[68:71], v28 offset:5120
  ds_read_b64_tr_b16 v[132:133], v24 offset:20480
  ds_read_b64_tr_b16 v[134:135], v25 offset:20480
  v_lshrrev_b32 v44, 5, v1
  v_lshlrev_b32 v44, 3, v44
  v_lshrrev_b32 v96, v44, v249
  v_lshrrev_b32 v104, v44, v250
  s_waitcnt lgkmcnt(9)
  v_mfma_f32_32x32x16_bf16 v[144:159], v[120:123], v[56:59], v[144:159]
  ds_read_b128 v[72:75], v28 offset:6144
  ds_read_b64_tr_b16 v[136:137], v24 offset:24576
  ds_read_b64_tr_b16 v[138:139], v25 offset:24576
  v_lshrrev_b32 v97, 1, v96
  v_lshrrev_b32 v98, 2, v96
  v_lshrrev_b32 v99, 3, v96
  s_waitcnt lgkmcnt(9)
  v_mfma_f32_32x32x16_bf16 v[144:159], v[124:127], v[60:63], v[144:159]
  ds_read_b128 v[76:79], v28 offset:7168
  ds_read_b64_tr_b16 v[140:141], v24 offset:28672
  ds_read_b64_tr_b16 v[142:143], v25 offset:28672
  v_lshrrev_b32 v100, 4, v96
  v_lshrrev_b32 v101, 5, v96
  v_lshrrev_b32 v102, 6, v96
  v_lshrrev_b32 v103, 7, v96
  s_waitcnt lgkmcnt(9)
  v_mfma_f32_32x32x16_bf16 v[144:159], v[128:131], v[64:67], v[144:159]
  ds_read_b64_tr_b16 v[112:113], v26 offset:0
  ds_read_b64_tr_b16 v[114:115], v27 offset:0
  v_lshrrev_b32 v105, 1, v104
  v_lshrrev_b32 v106, 2, v104
  v_lshrrev_b32 v107, 3, v104
  s_waitcnt lgkmcnt(8)
  v_mfma_f32_32x32x16_bf16 v[144:159], v[132:135], v[68:71], v[144:159]
  ds_read_b64_tr_b16 v[116:117], v26 offset:4096
  ds_read_b64_tr_b16 v[118:119], v27 offset:4096
  v_lshrrev_b32 v108, 4, v104
  v_lshrrev_b32 v109, 5, v104
  v_lshrrev_b32 v110, 6, v104
  v_lshrrev_b32 v111, 7, v104
  s_waitcnt lgkmcnt(7)
  v_mfma_f32_32x32x16_bf16 v[144:159], v[136:139], v[72:75], v[144:159]
  ds_read_b64_tr_b16 v[120:121], v26 offset:8192
  ds_read_b64_tr_b16 v[122:123], v27 offset:8192
  s_waitcnt lgkmcnt(6)
  v_mfma_f32_32x32x16_bf16 v[144:159], v[140:143], v[76:79], v[144:159]
  ds_read_b64_tr_b16 v[124:125], v26 offset:12288
  ds_read_b64_tr_b16 v[126:127], v27 offset:12288
  s_waitcnt lgkmcnt(6)
  v_mfma_f32_32x32x16_bf16 v[160:175], v[112:115], v[48:51], 0
  ds_read_b64_tr_b16 v[128:129], v26 offset:16384
  ds_read_b64_tr_b16 v[130:131], v27 offset:16384
  s_waitcnt lgkmcnt(6)
  v_mfma_f32_32x32x16_bf16 v[160:175], v[116:119], v[52:55], v[160:175]
  ds_read_b64_tr_b16 v[132:133], v26 offset:20480
  ds_read_b64_tr_b16 v[134:135], v27 offset:20480
  s_waitcnt lgkmcnt(6)
  v_mfma_f32_32x32x16_bf16 v[160:175], v[120:123], v[56:59], v[160:175]
  ds_read_b64_tr_b16 v[136:137], v26 offset:24576
  ds_read_b64_tr_b16 v[138:139], v27 offset:24576
  v_cvt_pk_bf16_f32 v80, v144, v145
  v_cvt_pk_bf16_f32 v81, v146, v147
  v_cvt_pk_bf16_f32 v82, v148, v149
  v_cvt_pk_bf16_f32 v83, v150, v151
  v_bfi_b32 v80, s53, v96, v80
  v_bfi_b32 v81, s53, v97, v81
  v_bfi_b32 v82, s53, v98, v82
  v_bfi_b32 v83, s53, v99, v83
  ds_write_b128 v244, v[80:83]
  s_waitcnt lgkmcnt(7)
  v_mfma_f32_32x32x16_bf16 v[160:175], v[124:127], v[60:63], v[160:175]
  ds_read_b64_tr_b16 v[140:141], v26 offset:28672
  ds_read_b64_tr_b16 v[142:143], v27 offset:28672
  v_cvt_pk_bf16_f32 v84, v152, v153
  v_cvt_pk_bf16_f32 v85, v154, v155
  v_cvt_pk_bf16_f32 v86, v156, v157
  v_cvt_pk_bf16_f32 v87, v158, v159
  v_bfi_b32 v84, s53, v100, v84
  v_bfi_b32 v85, s53, v101, v85
  v_bfi_b32 v86, s53, v102, v86
  v_bfi_b32 v87, s53, v103, v87
  ds_write_b128 v245, v[84:87]
  s_waitcnt lgkmcnt(8)
  v_mfma_f32_32x32x16_bf16 v[160:175], v[128:131], v[64:67], v[160:175]
  s_waitcnt lgkmcnt(6)
  v_mfma_f32_32x32x16_bf16 v[160:175], v[132:135], v[68:71], v[160:175]
  s_waitcnt lgkmcnt(4)
  v_mfma_f32_32x32x16_bf16 v[160:175], v[136:139], v[72:75], v[160:175]
  s_waitcnt lgkmcnt(1)
  v_mfma_f32_32x32x16_bf16 v[160:175], v[140:143], v[76:79], v[160:175]
  s_setprio 2
  s_nop 10
  v_cvt_pk_bf16_f32 v88, v160, v161
  v_cvt_pk_bf16_f32 v89, v162, v163
  v_cvt_pk_bf16_f32 v90, v164, v165
  v_cvt_pk_bf16_f32 v91, v166, v167
  v_bfi_b32 v88, s53, v104, v88
  v_bfi_b32 v89, s53, v105, v89
  v_bfi_b32 v90, s53, v106, v90
  v_bfi_b32 v91, s53, v107, v91
  ds_write_b128 v246, v[88:91]
  v_cvt_pk_bf16_f32 v92, v168, v169
  v_cvt_pk_bf16_f32 v93, v170, v171
  v_cvt_pk_bf16_f32 v94, v172, v173
  v_cvt_pk_bf16_f32 v95, v174, v175
  v_bfi_b32 v92, s53, v108, v92
  v_bfi_b32 v93, s53, v109, v93
  v_bfi_b32 v94, s53, v110, v94
  v_bfi_b32 v95, s53, v111, v95
  ds_write_b128 v247, v[92:95]
  ds_read_b128 v[112:115], v32 offset:0
  ds_read_b128 v[116:119], v32 offset:2048
  ds_read_b128 v[120:123], v32 offset:4096
  ds_read_b128 v[124:127], v32 offset:6144
  s_waitcnt lgkmcnt(3)
  buffer_store_dwordx4 v[112:115], v34, s[32:35], s87 offen offset:0 sc1
  s_waitcnt lgkmcnt(2)
  buffer_store_dwordx4 v[116:119], v34, s[32:35], s87 offen offset:1024 sc1
  s_waitcnt lgkmcnt(1)
  buffer_store_dwordx4 v[120:123], v34, s[32:35], s87 offen offset:2048 sc1
  s_waitcnt lgkmcnt(0)
  buffer_store_dwordx4 v[124:127], v34, s[32:35], s87 offen offset:3072 sc1
  s_setprio 0
  s_barrier
  s_cmp_lg_u32 s3, 7
  s_cbranch_scc1 L_nolse2
  v_or_b32 v23, 1, v23
  s_mov_b32 exec_hi, 0
  buffer_store_dwordx4 v[20:23], v248, s[32:35], s74 offen sc1
  s_mov_b32 exec_hi, -1
L_nolse2:
  s_mov_b32 s73, 0
  s_or_b32 s69, s48, 1
  buffer_load_dwordx4 v[8:11], v35, s[32:35], s70 offen offset:0 sc1
  buffer_load_dwordx4 v[12:15], v35, s[32:35], s71 offen offset:0 sc1
  buffer_load_dwordx4 v[16:19], v35, s[32:35], 0 offen offset:0 sc1
  buffer_load_dwordx4 v[20:23], v35, s[32:35], s72 offen offset:0 sc1
  s_cmp_lt_u32 s2, 128
  s_cbranch_scc1 L_prepA
  s_and_b32 s92, s3, 3
  s_mul_i32 s92, s92, 7552
  s_add_u32 s92, s92, 0x5000
  v_lshrrev_b32 v62, 5, v1
  v_mul_u32_u24 v62, 928, v62
  v_and_b32 v3, 31, v1
  v_lshl_add_u32 v62, v3, 4, v62
  v_add_u32 v62, s92, v62
  s_lshl_b32 s92, s3, 6
  v_lshrrev_b32 v63, 4, v1
  v_mul_u32_u24 v63, 7552, v63
  v_bfe_u32 v3, v1, 2, 2
  v_mul_u32_u24 v3, 928, v3
  v_add_u32 v63, v3, v63
  v_and_b32 v3, 3, v1
  v_lshl_add_u32 v63, v3, 3, v63
  v_add_u32 v63, 20480, v63
  v_add_u32 v63, s92, v63
  s_mul_i32 s82, s80, 28672
  s_lshl_b32 s97, s3, 12
  s_add_u32 s82, s82, s97
  s_lshl_b32 s97, s79, 8
  s_add_u32 s82, s82, s97
  s_lshr_b32 s92, s79, 1
  s_lshl_b32 s92, s92, 10
  s_and_b32 s97, s79, 1
  s_lshl_b32 s97, s97, 7
  s_add_u32 s92, s92, s97
  s_add_u32 s92, s92, 0x4000
  v_bfe_u32 v56, v1, 3, 1
  v_lshlrev_b32 v56, 13, v56
  v_lshrrev_b32 v3, 4, v1
  v_lshl_add_u32 v56, v3, 8, v56
  v_and_b32 v3, 7, v1
  v_lshl_add_u32 v56, v3, 4, v56
  v_add_u32 v56, s92, v56
  v_and_b32 v60, 31, v1
  v_lshlrev_b32 v60, 5, v60
  v_add_u32 v60, 90112, v60
  s_lshl_b32 s92, s3, 2
  s_add_u32 s92, s92, 0x16000
  v_and_b32 v59, 7, v1
  v_lshlrev_b32 v59, 7, v59
  v_lshrrev_b32 v3, 4, v1
  v_lshl_add_u32 v59, v3, 5, v59
  v_add_u32 v59, s92, v59
  s_lshl_b32 s92, s3, 7
  s_add_u32 s92, s92, 0x16c00
  v_and_b32 v57, 31, v1
  v_lshlrev_b32 v57, 1, v57
  v_add_u32 v57, s92, v57
  s_mul_i32 s90, s79, 4224
  s_lshl_b32 s97, s3, 9
  s_add_u32 s90, s90, s97
  s_add_u32 s90, s90, 0x60000
  v_and_b32 v61, 31, v1
  v_lshlrev_b32 v61, 4, v61
  v_and_b32 v58, 3, v1
  v_lshlrev_b32 v58, 6, v58
  v_lshrrev_b32 v3, 4, v1
  v_lshl_add_u32 v58, v3, 4, v58
  s_nop 0
  s_branch L_prep2
L_prepA:
  s_sub_u32 s92, s79, 7
  s_cmp_ge_u32 s79, 7
  s_cselect_b32 s92, s92, s79
  s_cselect_b32 s93, 1, 0
  s_mul_i32 s81, s80, 7
  s_add_u32 s81, s81, s92
  s_lshl_b32 s91, s81, 15
  s_lshl_b32 s97, s3, 12
  s_add_u32 s91, s91, s97
  s_lshl_b32 s97, s93, 9
  s_add_u32 s91, s91, s97
  s_mul_i32 s75, s77, 16896
  s_lshr_b32 s97, s3, 1
  s_mul_i32 s97, s97, 4224
  s_add_u32 s75, s75, s97
  s_lshl_b32 s97, s76, 7
  s_add_u32 s75, s75, s97
  s_and_b32 s97, s3, 1
  s_lshl_b32 s97, s97, 6
  s_add_u32 s75, s75, s97
  s_add_u32 s75, s75, 0x60000
  s_mul_i32 s90, s93, 67584
  s_mul_i32 s97, s3, 8448
  s_add_u32 s90, s90, s97
  s_lshl_b32 s97, s81, 7
  s_add_u32 s90, s90, s97
  s_add_u32 s90, s90, 0xa0000
  s_mul_i32 s92, s3, 2176
  s_lshr_b32 s97, s3, 1
  s_lshl_b32 s97, s97, 7
  s_add_u32 s92, s92, s97
  s_add_u32 s92, s92, 0xe800
  v_lshrrev_b32 v62, 5, v1
  v_mul_u32_u24 v62, 544, v62
  v_and_b32 v3, 31, v1
  v_lshl_add_u32 v62, v3, 4, v62
  v_add_u32 v62, s92, v62
  s_lshl_b32 s92, s3, 6
  v_lshrrev_b32 v63, 4, v1
  v_mul_u32_u24 v63, 4480, v63
  v_bfe_u32 v3, v1, 2, 2
  v_mul_u32_u24 v3, 544, v3
  v_add_u32 v63, v3, v63
  v_and_b32 v3, 3, v1
  v_lshl_add_u32 v63, v3, 3, v63
  v_add_u32 v63, 59392, v63
  v_add_u32 v63, s92, v63
  s_lshl_b32 s82, s81, 12
  s_lshl_b32 s97, s3, 9
  s_add_u32 s82, s82, s97
  s_add_u32 s82, s82, 0xd0000
  s_lshl_b32 s92, s3, 7
  s_add_u32 s92, s92, 0x16c00
  v_and_b32 v57, 7, v1
  v_lshlrev_b32 v57, 3, v57
  v_lshrrev_b32 v3, 4, v1
  v_lshl_add_u32 v57, v3, 1, v57
  v_add_u32 v57, s92, v57
  v_and_b32 v61, 31, v1
  v_lshlrev_b32 v61, 4, v61
  v_and_b32 v58, 1, v1
  v_lshlrev_b32 v58, 6, v58
  v_lshrrev_b32 v3, 4, v1
  v_lshl_add_u32 v58, v3, 4, v58
  s_lshl_b32 s92, s80, 11
  v_and_b32 v56, 15, v1
  v_lshlrev_b32 v56, 7, v56
  v_add_u32 v56, 98304, v56
  v_add_u32 v56, s92, v56
  s_lshl_b32 s92, s3, 2
  s_add_u32 s92, s92, 0x14800
  v_lshlrev_b32 v59, 5, v1
  v_add_u32 v59, s92, v59
  s_bfe_u32 s92, s3, 0x10002
  s_lshl_b32 s92, s92, 10
  s_and_b32 s97, s3, 3
  s_lshl_b32 s97, s97, 2
  s_add_u32 s92, s92, s97
  s_add_u32 s92, s92, 0x15800
  v_lshlrev_b32 v60, 4, v1
  v_add_u32 v60, s92, v60
L_prep2:
  s_cmp_lg_u32 s101, 0
  s_cbranch_scc1 L_nsg
  s_waitcnt vmcnt(8)
  ds_write_b128 v240, v[176:179] offset:0
  ds_write_b128 v240, v[180:183] offset:1152
  ds_write_b128 v240, v[184:187] offset:2432
  ds_write_b128 v240, v[188:191] offset:3584
  s_cmp_lt_u32 s2, 128
  s_cbranch_scc1 L_sf_36a
  s_mov_b32 exec_lo, 0xfffffff
  s_mov_b32 exec_hi, 0xfffffff
  ds_write_b128 v62, v[208:211] offset:0
  ds_write_b128 v62, v[212:215] offset:448
  ds_write_b128 v62, v[216:219] offset:1856
  ds_write_b128 v62, v[220:223] offset:2304
  ds_write_b128 v62, v[224:227] offset:3712
  ds_write_b128 v62, v[228:231] offset:4160
  ds_write_b128 v62, v[232:235] offset:5568
  ds_write_b128 v62, v[236:239] offset:6016
  s_mov_b64 exec, -1
  s_branch L_sf_36x
L_sf_36a:
  ds_write_b128 v241, v[208:211] offset:0
  ds_write_b128 v241, v[212:215] offset:1152
  ds_write_b128 v241, v[216:219] offset:2432
  ds_write_b128 v241, v[220:223] offset:3584
  ds_write_b128 v241, v[224:227] offset:4864
  ds_write_b128 v241, v[228:231] offset:6016
  ds_write_b128 v241, v[232:235] offset:7296
  ds_write_b128 v241, v[236:239] offset:8448
L_sf_36x:
L_nsg:
  s_waitcnt vmcnt(0)
  s_mov_b32 s100, 0
L_p1:
  v_cmp_ne_u32 s[60:61], s69, v11
  v_cmp_ne_u32 s[62:63], s69, v15
  v_cmp_ne_u32 s[64:65], s69, v19
  v_cmp_ne_u32 s[66:67], s69, v23
  v_xor_b32 v44, s69, v11
  v_bitop3_b32 v44, v15, s69, v44 bitop3:0xbe
  v_bitop3_b32 v44, v19, s69, v44 bitop3:0xbe
  v_bitop3_b32 v44, v23, s69, v44 bitop3:0xbe
  v_cmp_lt_u32 s[92:93], 1, v44
  s_mov_b32 s94, 0
  s_cmp_eq_u64 s[92:93], 0
  s_cbranch_scc1 L_p1d
  s_add_u32 s100, s100, 1
  s_cmp_gt_u32 s100, 100000
  s_cbranch_scc1 L_abort
  s_mov_b64 exec, s[60:61]
  s_cbranch_execz L_ll_37
  buffer_load_dwordx4 v[8:11], v35, s[32:35], s70 offen offset:0 sc1
L_ll_37:
  s_mov_b64 exec, s[62:63]
  s_cbranch_execz L_ll_38
  buffer_load_dwordx4 v[12:15], v35, s[32:35], s71 offen offset:0 sc1
L_ll_38:
  s_mov_b64 exec, s[64:65]
  s_cbranch_execz L_ll_39
  buffer_load_dwordx4 v[16:19], v35, s[32:35], 0 offen offset:0 sc1
L_ll_39:
  s_mov_b64 exec, s[66:67]
  s_cbranch_execz L_ll_40
  buffer_load_dwordx4 v[20:23], v35, s[32:35], s72 offen offset:0 sc1
L_ll_40:
  s_mov_b64 exec, -1
L_p1d:
  s_bitcmp1_b32 s73, 0
  s_cbranch_scc1 L_lp_41
  s_cmp_lg_u64 s[60:61], 0
  s_cbranch_scc1 L_lp_41
  s_bitset1_b32 s73, 0
  s_add_u32 s94, s94, 1
  buffer_load_dwordx4 v[128:131], v36, s[32:35], s83 offen offset:0 sc1
L_lp_41:
  s_bitcmp1_b32 s73, 1
  s_cbranch_scc1 L_lp_42
  s_cmp_lg_u64 s[62:63], 0
  s_cbranch_scc1 L_lp_42
  s_bitset1_b32 s73, 1
  s_add_u32 s94, s94, 1
  buffer_load_dwordx4 v[132:135], v36, s[32:35], s84 offen offset:0 sc1
L_lp_42:
  s_bitcmp1_b32 s73, 2
  s_cbranch_scc1 L_lp_43
  s_cmp_lg_u64 s[64:65], 0
  s_cbranch_scc1 L_lp_43
  s_bitset1_b32 s73, 2
  s_add_u32 s94, s94, 1
  buffer_load_dwordx4 v[136:139], v36, s[32:35], s85 offen offset:0 sc1
L_lp_43:
  s_bitcmp1_b32 s73, 3
  s_cbranch_scc1 L_lp_44
  s_cmp_lg_u64 s[66:67], 0
  s_cbranch_scc1 L_lp_44
  s_bitset1_b32 s73, 3
  s_add_u32 s94, s94, 1
  buffer_load_dwordx4 v[140:143], v36, s[32:35], s86 offen offset:0 sc1
L_lp_44:
  s_cmp_eq_u64 s[92:93], 0
  s_cbranch_scc1 L_p1x
  s_cmp_eq_u32 s94, 0
  s_cbranch_scc0 L_pw0
  s_waitcnt vmcnt(0)
  s_branch L_p1
L_pw0:
  s_cmp_eq_u32 s94, 1
  s_cbranch_scc0 L_pw1
  s_waitcnt vmcnt(1)
  s_branch L_p1
L_pw1:
  s_cmp_eq_u32 s94, 2
  s_cbranch_scc0 L_pw2
  s_waitcnt vmcnt(2)
  s_branch L_p1
L_pw2:
  s_cmp_eq_u32 s94, 3
  s_cbranch_scc0 L_pw3
  s_waitcnt vmcnt(3)
  s_branch L_p1
L_pw3:
  s_waitcnt vmcnt(4)
  s_branch L_p1
L_p1x:
  v_max3_f32 v44, v8, v12, v16
  v_max_f32 v44, v44, v20
  s_nop 1
  v_max_f32_dpp v44, v44, v44 row_ror:8 row_mask:0xf bank_mask:0xf
  v_mov_b32 v45, v44
  s_nop 1
  v_permlane16_swap_b32 v44, v45
  v_max_f32 v44, v44, v45
  v_mov_b32 v45, v44
  s_nop 1
  v_permlane32_swap_b32 v44, v45
  v_max_f32 v44, v44, v45
  s_lshl_b32 s92, s3, 2
  s_add_u32 s92, s92, 92160
  v_mov_b32 v47, s92
  v_mov_b32 v46, 92160
  ds_write_b32 v47, v44
  s_waitcnt lgkmcnt(0)
  s_barrier
  ds_read_b128 v[144:147], v46
  ds_read_b128 v[148:151], v46 offset:16
  ds_read_b64_tr_b16 v[48:49], v242 offset:0
  ds_read_b64_tr_b16 v[50:51], v242 offset:1152
  ds_read_b64_tr_b16 v[52:53], v242 offset:9728
  ds_read_b64_tr_b16 v[54:55], v242 offset:10880
  s_waitcnt lgkmcnt(4)
  v_max3_f32 v44, v144, v145, v146
  v_max3_f32 v45, v147, v148, v149
  v_max3_f32 v44, v44, v150, v151
  v_max_f32 v44, v44, v45
  v_sub_f32 v152, v8, v44
  v_sub_f32 v153, v12, v44
  v_sub_f32 v154, v16, v44
  v_sub_f32 v155, v20, v44
  v_exp_f32 v152, v152
  v_exp_f32 v153, v153
  v_exp_f32 v154, v154
  v_exp_f32 v155, v155
  v_cvt_pk_bf16_f32 v152, v152, v152
  v_cvt_pk_bf16_f32 v153, v153, v153
  v_cvt_pk_bf16_f32 v154, v154, v154
  v_cvt_pk_bf16_f32 v155, v155, v155
  v_lshrrev_b32 v156, 16, v152
  v_lshrrev_b32 v157, 16, v153
  v_lshrrev_b32 v158, 16, v154
  v_lshrrev_b32 v159, 16, v155
  v_and_b32 v152, 0xffff0000, v152
  v_and_b32 v153, 0xffff0000, v153
  v_and_b32 v154, 0xffff0000, v154
  v_and_b32 v155, 0xffff0000, v155
  v_mul_f32 v44, v152, v9
  v_fmac_f32 v44, v153, v13
  v_fmac_f32 v44, v154, v17
  v_fmac_f32 v44, v155, v21
  s_nop 1
  v_add_f32_dpp v44, v44, v44 row_ror:8 row_mask:0xf bank_mask:0xf
  v_mov_b32 v45, v44
  s_nop 1
  v_permlane16_swap_b32 v44, v45
  v_add_f32 v44, v44, v45
  v_mov_b32 v45, v44
  s_nop 1
  v_permlane32_swap_b32 v44, v45
  v_add_f32 v44, v44, v45
  ds_write_b32 v47, v44 offset:32
  s_cmp_lt_u32 s2, 128
  s_cbranch_scc1 L_fgA
  ds_read_b64_tr_b16 v[80:81], v63 offset:0
  ds_read_b64_tr_b16 v[82:83], v63 offset:3712
  ds_read_b64_tr_b16 v[84:85], v63 offset:32
  ds_read_b64_tr_b16 v[86:87], v63 offset:3744
  ds_read_b64_tr_b16 v[88:89], v63 offset:448
  ds_read_b64_tr_b16 v[90:91], v63 offset:4160
  ds_read_b64_tr_b16 v[92:93], v63 offset:480
  ds_read_b64_tr_b16 v[94:95], v63 offset:4192
  s_branch L_fgx
L_fgA:
  ds_read_b64_tr_b16 v[80:81], v243 offset:0
  ds_read_b64_tr_b16 v[82:83], v243 offset:1152
  ds_read_b64_tr_b16 v[84:85], v243 offset:9728
  ds_read_b64_tr_b16 v[86:87], v243 offset:10880
  ds_read_b64_tr_b16 v[88:89], v243 offset:19456
  ds_read_b64_tr_b16 v[90:91], v243 offset:20608
  ds_read_b64_tr_b16 v[92:93], v243 offset:29184
  ds_read_b64_tr_b16 v[94:95], v243 offset:30336
L_fgx:
  s_waitcnt lgkmcnt(0)
  s_barrier
  ds_read_b128 v[160:163], v46 offset:32
  ds_read_b128 v[164:167], v46 offset:48
  v_mov_b32 v144, 0
  v_mov_b32 v145, 0
  v_mov_b32 v146, 0
  v_mov_b32 v147, 0
  v_mov_b32 v148, 0
  v_mov_b32 v149, 0
  v_mov_b32 v150, 0
  v_mov_b32 v151, 0
  s_waitcnt lgkmcnt(0)
  v_add_f32 v160, v160, v161
  v_add_f32 v162, v162, v163
  v_add_f32 v164, v164, v165
  v_add_f32 v166, v166, v167
  v_add_f32 v160, v160, v162
  v_add_f32 v164, v164, v166
  v_add_f32 v160, v160, v164
  v_rcp_f32 v168, v160
  s_bitcmp1_b32 s73, 0
  s_cbranch_scc1 L_ir_45
  buffer_load_dwordx4 v[128:131], v36, s[32:35], s83 offen offset:0 sc1
L_ir_45:
  s_bitcmp1_b32 s73, 1
  s_cbranch_scc1 L_ir_46
  buffer_load_dwordx4 v[132:135], v36, s[32:35], s84 offen offset:0 sc1
L_ir_46:
  s_bitcmp1_b32 s73, 2
  s_cbranch_scc1 L_ir_47
  buffer_load_dwordx4 v[136:139], v36, s[32:35], s85 offen offset:0 sc1
L_ir_47:
  s_bitcmp1_b32 s73, 3
  s_cbranch_scc1 L_ir_48
  buffer_load_dwordx4 v[140:143], v36, s[32:35], s86 offen offset:0 sc1
L_ir_48:
  s_or_b32 s73, s73, 15
  s_mov_b32 s100, 0
L_p2:
  s_mov_b32 s95, s73
  s_waitcnt vmcnt(0)
  s_bitcmp1_b32 s95, 0
  s_cbranch_scc0 L_dc_49
  s_bitcmp1_b32 s95, 4
  s_cbranch_scc1 L_dc_49
  v_xor_b32 v44, v128, v4
  v_bitop3_b32 v44, v129, v5, v44 bitop3:0xbe
  v_bitop3_b32 v44, v130, v6, v44 bitop3:0xbe
  v_bitop3_b32 v44, v131, v7, v44 bitop3:0xbe
  v_and_b32 v44, s53, v44
  v_cmp_ne_u32 vcc, 0, v44
  s_nop 0
  s_cbranch_vccz L_dc_49k
  s_sleep 1
  buffer_load_dwordx4 v[128:131], v36, s[32:35], s83 offen offset:0 sc1
  s_branch L_dc_49
L_dc_49k:
  s_bitset1_b32 s73, 4
  v_dot2c_f32_bf16 v144, v156, v128
  v_dot2c_f32_bf16 v145, v152, v128
  v_dot2c_f32_bf16 v146, v156, v129
  v_dot2c_f32_bf16 v147, v152, v129
  v_dot2c_f32_bf16 v148, v156, v130
  v_dot2c_f32_bf16 v149, v152, v130
  v_dot2c_f32_bf16 v150, v156, v131
  v_dot2c_f32_bf16 v151, v152, v131
L_dc_49:
  s_bitcmp1_b32 s95, 1
  s_nop 0
  s_cbranch_scc0 L_dc_50
  s_bitcmp1_b32 s95, 5
  s_cbranch_scc1 L_dc_50
  v_xor_b32 v44, v132, v4
  v_bitop3_b32 v44, v133, v5, v44 bitop3:0xbe
  v_bitop3_b32 v44, v134, v6, v44 bitop3:0xbe
  v_bitop3_b32 v44, v135, v7, v44 bitop3:0xbe
  v_and_b32 v44, s53, v44
  v_cmp_ne_u32 vcc, 0, v44
  s_nop 0
  s_cbranch_vccz L_dc_50k
  s_sleep 1
  buffer_load_dwordx4 v[132:135], v36, s[32:35], s84 offen offset:0 sc1
  s_branch L_dc_50
L_dc_50k:
  s_bitset1_b32 s73, 5
  v_dot2c_f32_bf16 v144, v157, v132
  v_dot2c_f32_bf16 v145, v153, v132
  v_dot2c_f32_bf16 v146, v157, v133
  v_dot2c_f32_bf16 v147, v153, v133
  v_dot2c_f32_bf16 v148, v157, v134
  v_dot2c_f32_bf16 v149, v153, v134
  v_dot2c_f32_bf16 v150, v157, v135
  v_dot2c_f32_bf16 v151, v153, v135
L_dc_50:
  s_bitcmp1_b32 s95, 2
  s_nop 0
  s_cbranch_scc0 L_dc_51
  s_bitcmp1_b32 s95, 6
  s_cbranch_scc1 L_dc_51
  v_xor_b32 v44, v136, v4
  v_bitop3_b32 v44, v137, v5, v44 bitop3:0xbe
  v_bitop3_b32 v44, v138, v6, v44 bitop3:0xbe
  v_bitop3_b32 v44, v139, v7, v44 bitop3:0xbe
  v_and_b32 v44, s53, v44
  v_cmp_ne_u32 vcc, 0, v44
  s_nop 0
  s_cbranch_vccz L_dc_51k
  s_sleep 1
  buffer_load_dwordx4 v[136:139], v36, s[32:35], s85 offen offset:0 sc1
  s_branch L_dc_51
L_dc_51k:
  s_bitset1_b32 s73, 6
  v_dot2c_f32_bf16 v144, v158, v136
  v_dot2c_f32_bf16 v145, v154, v136
  v_dot2c_f32_bf16 v146, v158, v137
  v_dot2c_f32_bf16 v147, v154, v137
  v_dot2c_f32_bf16 v148, v158, v138
  v_dot2c_f32_bf16 v149, v154, v138
  v_dot2c_f32_bf16 v150, v158, v139
  v_dot2c_f32_bf16 v151, v154, v139
L_dc_51:
  s_bitcmp1_b32 s95, 3
  s_nop 0
  s_cbranch_scc0 L_dc_52
  s_bitcmp1_b32 s95, 7
  s_cbranch_scc1 L_dc_52
  v_xor_b32 v44, v140, v4
  v_bitop3_b32 v44, v141, v5, v44 bitop3:0xbe
  v_bitop3_b32 v44, v142, v6, v44 bitop3:0xbe
  v_bitop3_b32 v44, v143, v7, v44 bitop3:0xbe
  v_and_b32 v44, s53, v44
  v_cmp_ne_u32 vcc, 0, v44
  s_nop 0
  s_cbranch_vccz L_dc_52k
  s_sleep 1
  buffer_load_dwordx4 v[140:143], v36, s[32:35], s86 offen offset:0 sc1
  s_branch L_dc_52
L_dc_52k:
  s_bitset1_b32 s73, 7
  v_dot2c_f32_bf16 v144, v159, v140
  v_dot2c_f32_bf16 v145, v155, v140
  v_dot2c_f32_bf16 v146, v159, v141
  v_dot2c_f32_bf16 v147, v155, v141
  v_dot2c_f32_bf16 v148, v159, v142
  v_dot2c_f32_bf16 v149, v155, v142
  v_dot2c_f32_bf16 v150, v159, v143
  v_dot2c_f32_bf16 v151, v155, v143
L_dc_52:
  s_cmp_eq_u32 s73, 0xff
  s_nop 0
  s_cbranch_scc1 L_p2x
  s_add_u32 s100, s100, 1
  s_cmp_gt_u32 s100, 100000
  s_cbranch_scc1 L_abort
  s_branch L_p2
L_p2x:
  v_permlane32_swap_b32 v144, v148
  v_permlane32_swap_b32 v145, v149
  v_permlane32_swap_b32 v146, v150
  v_permlane32_swap_b32 v147, v151
  v_add_f32 v144, v144, v148
  v_add_f32 v145, v145, v149
  v_add_f32 v146, v146, v150
  v_add_f32 v147, v147, v151
  s_nop 0
  v_permlane16_swap_b32 v144, v146
  v_permlane16_swap_b32 v145, v147
  v_add_f32 v144, v144, v146
  v_add_f32 v145, v145, v147
  s_nop 0
  v_add_f32_dpp v144, v144, v144 row_ror:8 row_mask:0xf bank_mask:0xf
  v_add_f32_dpp v145, v145, v145 row_ror:8 row_mask:0xf bank_mask:0xf
  v_mul_f32 v144, v144, v168
  v_mul_f32 v145, v145, v168
  v_cvt_pk_bf16_f32 v44, v144, v145
  ds_write_b32 v37, v44
  s_waitcnt lgkmcnt(0)
  s_barrier
  ds_read_b128 v[160:163], v38
  ds_read_b128 v[164:167], v38 offset:64
  s_waitcnt lgkmcnt(1)
  v_mfma_f32_16x16x32_bf16 v[144:147], v[48:51], v[160:163], 0
  s_waitcnt lgkmcnt(0)
  v_mfma_f32_16x16x32_bf16 v[144:147], v[52:55], v[164:167], v[144:147]
  s_nop 7
  v_add_f32_dpp v144, v144, v144 quad_perm:[1,0,3,2] row_mask:0xf bank_mask:0xf
  v_add_f32_dpp v145, v145, v145 quad_perm:[1,0,3,2] row_mask:0xf bank_mask:0xf
  v_add_f32_dpp v146, v146, v146 quad_perm:[1,0,3,2] row_mask:0xf bank_mask:0xf
  v_add_f32_dpp v147, v147, v147 quad_perm:[1,0,3,2] row_mask:0xf bank_mask:0xf
  v_add_f32_dpp v144, v144, v144 quad_perm:[2,3,0,1] row_mask:0xf bank_mask:0xf
  v_add_f32_dpp v145, v145, v145 quad_perm:[2,3,0,1] row_mask:0xf bank_mask:0xf
  v_add_f32_dpp v146, v146, v146 quad_perm:[2,3,0,1] row_mask:0xf bank_mask:0xf
  v_add_f32_dpp v147, v147, v147 quad_perm:[2,3,0,1] row_mask:0xf bank_mask:0xf
  v_add_f32_dpp v144, v144, v144 row_half_mirror row_mask:0xf bank_mask:0xf
  v_add_f32_dpp v145, v145, v145 row_half_mirror row_mask:0xf bank_mask:0xf
  v_add_f32_dpp v146, v146, v146 row_half_mirror row_mask:0xf bank_mask:0xf
  v_add_f32_dpp v147, v147, v147 row_half_mirror row_mask:0xf bank_mask:0xf
  s_mov_b32 exec_lo, 0x10001
  s_mov_b32 exec_hi, 0x10001
  v_and_or_b32 v144, v144, v2, s49
  v_and_or_b32 v145, v145, v2, s50
  v_and_or_b32 v146, v146, v2, s51
  v_and_or_b32 v147, v147, v2, s52
  buffer_store_dwordx4 v[144:147], v1, s[32:35], s16 offen
  v_mov_b32 v8, v144
  v_mov_b32 v9, v145
  v_mov_b32 v10, v146
  v_mov_b32 v11, v147
  s_mov_b64 exec, -1
  s_mov_b32 s69, 0
  s_mov_b32 s66, 0
  s_cmp_lt_u32 s2, 128
  s_cbranch_scc0 L_X
  s_mov_b32 s60, 0xffffffff
  s_mov_b32 s61, 0x0
  s_mov_b32 s100, 0
  s_branch L_gf_54
L_g_53:
  s_add_u32 s100, s100, 1
  s_cmp_gt_u32 s100, 100000
  s_cbranch_scc1 L_abort
  s_sleep 1
  s_cmp_lg_u32 s100, 30
  s_cbranch_scc1 L_alt_56
  s_cmp_lg_u32 s69, 0
  s_cbranch_scc1 L_cg_57
  s_mov_b32 exec_lo, 0x10001
  s_mov_b32 exec_hi, 0x10001
  s_add_u32 s97, s16, 0x160000
  buffer_store_dwordx4 v[8:11], v1, s[32:35], s97 offen sc1
  s_mov_b32 s69, 1
  s_mov_b64 exec, -1
L_cg_57:
  s_add_u32 s66, s66, 0x160000
L_alt_56:
L_gf_54:
  s_mov_b64 exec, s[60:61]
  buffer_load_dwordx4 v[128:131], v39, s[32:35], s66 offen offset:0 sc1
  s_waitcnt vmcnt(0)
L_gc_55:
  s_mov_b64 exec, s[60:61]
  v_perm_b32 v44, v129, v128, s56
  v_perm_b32 v44, v130, v44, s57
  v_perm_b32 v44, v131, v44, s58
  v_cmp_ne_u32 s[60:61], s48, v44
  s_nop 0
  s_cmp_lg_u64 s[60:61], 0
  s_cbranch_scc1 L_g_53
  s_mov_b64 exec, -1
  v_cvt_pk_bf16_f32 v44, v128, v129
  v_cvt_pk_bf16_f32 v45, v130, v131
  s_mov_b32 exec_hi, 0
  ds_write_b64 v43, v[44:45]
  s_mov_b32 exec_hi, -1
  s_cmp_lg_u32 s69, 0
  s_cbranch_scc1 L_cg_59
  s_mov_b32 exec_lo, 0x10001
  s_mov_b32 exec_hi, 0x10001
  s_add_u32 s97, s16, 0x160000
  buffer_store_dwordx4 v[8:11], v1, s[32:35], s97 offen sc1
  s_mov_b32 s69, 1
  s_mov_b64 exec, -1
L_cg_59:
  s_waitcnt lgkmcnt(0)
  s_barrier
  ds_read_b128 v[128:131], v40 offset:0
  ds_read_b128 v[132:135], v40 offset:64
  ds_read_b128 v[136:139], v40 offset:128
  ds_read_b128 v[140:143], v40 offset:192
  s_waitcnt lgkmcnt(3)
  v_mfma_f32_16x16x32_bf16 v[144:147], v[80:83], v[128:131], 0
  s_waitcnt lgkmcnt(2)
  v_mfma_f32_16x16x32_bf16 v[144:147], v[84:87], v[132:135], v[144:147]
  s_waitcnt lgkmcnt(1)
  v_mfma_f32_16x16x32_bf16 v[144:147], v[88:91], v[136:139], v[144:147]
  s_waitcnt lgkmcnt(0)
  v_mfma_f32_16x16x32_bf16 v[144:147], v[92:95], v[140:143], v[144:147]
  s_nop 7
  v_add_f32_dpp v144, v144, v144 quad_perm:[1,0,3,2] row_mask:0xf bank_mask:0xf
  v_add_f32_dpp v145, v145, v145 quad_perm:[1,0,3,2] row_mask:0xf bank_mask:0xf
  v_add_f32_dpp v146, v146, v146 quad_perm:[1,0,3,2] row_mask:0xf bank_mask:0xf
  v_add_f32_dpp v147, v147, v147 quad_perm:[1,0,3,2] row_mask:0xf bank_mask:0xf
  v_add_f32_dpp v144, v144, v144 quad_perm:[2,3,0,1] row_mask:0xf bank_mask:0xf
  v_add_f32_dpp v145, v145, v145 quad_perm:[2,3,0,1] row_mask:0xf bank_mask:0xf
  v_add_f32_dpp v146, v146, v146 quad_perm:[2,3,0,1] row_mask:0xf bank_mask:0xf
  v_add_f32_dpp v147, v147, v147 quad_perm:[2,3,0,1] row_mask:0xf bank_mask:0xf
  v_add_f32_dpp v144, v144, v144 row_half_mirror row_mask:0xf bank_mask:0xf
  v_add_f32_dpp v145, v145, v145 row_half_mirror row_mask:0xf bank_mask:0xf
  v_add_f32_dpp v146, v146, v146 row_half_mirror row_mask:0xf bank_mask:0xf
  v_add_f32_dpp v147, v147, v147 row_half_mirror row_mask:0xf bank_mask:0xf
  s_mov_b32 exec_lo, 0x10001
  s_mov_b32 exec_hi, 0x10001
  v_and_or_b32 v144, v144, v2, s49
  v_and_or_b32 v145, v145, v2, s50
  v_and_or_b32 v146, v146, v2, s51
  v_and_or_b32 v147, v147, v2, s52
  buffer_store_dwordx4 v[144:147], v1, s[32:35], s75 offen sc1
  s_mov_b64 exec, -1
  s_branch L_Y
L_X:
  s_cmp_lg_u32 s69, 0
  s_cbranch_scc1 L_cg_60
  s_mov_b32 exec_lo, 0x10001
  s_mov_b32 exec_hi, 0x10001
  s_add_u32 s97, s16, 0x160000
  buffer_store_dwordx4 v[8:11], v1, s[32:35], s97 offen sc1
  s_mov_b32 s69, 1
  s_mov_b64 exec, -1
L_cg_60:
  s_lshl_b32 s92, s79, 6
  v_and_b32 v44, 31, v1
  v_lshlrev_b32 v44, 1, v44
  v_add_u32 v44, s92, v44
  global_load_ushort v66, v44, s[4:5]
  s_movk_i32 s68, 0x4000
  buffer_load_dwordx4 v[68:71], v56, s[32:35], 0 offen offset:0 sc1
  buffer_load_dwordx4 v[72:75], v56, s[32:35], s68 offen offset:0 sc1
  s_waitcnt vmcnt(0)
  s_mov_b64 s[60:61], -1
  s_waitcnt vmcnt(63)
  s_mov_b32 s100, 0
  s_branch L_gc_64
L_g_62:
  s_add_u32 s100, s100, 1
  s_cmp_gt_u32 s100, 100000
  s_cbranch_scc1 L_abort
  s_sleep 2
L_gf_63:
  s_mov_b64 exec, s[60:61]
  buffer_load_dwordx4 v[68:71], v56, s[32:35], 0 offen offset:0 sc1
  buffer_load_dwordx4 v[72:75], v56, s[32:35], s68 offen offset:0 sc1
  s_waitcnt vmcnt(0)
L_gc_64:
  s_mov_b64 exec, s[60:61]
  v_perm_b32 v44, v69, v68, s56
  v_perm_b32 v44, v70, v44, s57
  v_perm_b32 v44, v71, v44, s58
  v_cmp_ne_u32 s[60:61], s48, v44
  v_perm_b32 v44, v73, v72, s56
  v_perm_b32 v44, v74, v44, s57
  v_perm_b32 v44, v75, v44, s58
  v_cmp_ne_u32 vcc, s48, v44
  s_nop 0
  s_or_b64 s[60:61], s[60:61], vcc
  s_cmp_lg_u64 s[60:61], 0
  s_cbranch_scc1 L_g_62
  s_mov_b64 exec, -1
  v_permlane32_swap_b32 v68, v70
  v_permlane32_swap_b32 v69, v71
  v_add_f32 v68, v68, v70
  v_add_f32 v69, v69, v71
  s_nop 1
  v_permlane16_swap_b32 v68, v69
  v_add_f32 v68, v68, v69
  v_permlane32_swap_b32 v72, v74
  v_permlane32_swap_b32 v73, v75
  v_add_f32 v72, v72, v74
  v_add_f32 v73, v73, v75
  s_nop 1
  v_permlane16_swap_b32 v72, v73
  v_add_f32 v72, v72, v73
  v_cvt_pk_bf16_f32 v44, v68, v68
  v_and_b32 v68, 0xffff0000, v44
  v_cvt_pk_bf16_f32 v45, v72, v72
  v_and_b32 v72, 0xffff0000, v45
  v_and_b32 v44, 3, v1
  v_lshlrev_b32 v44, 6, v44
  v_bfe_u32 v3, v1, 2, 3
  v_lshl_add_u32 v44, v3, 2, v44
  ds_bpermute_b32 v76, v44, v68 offset:0
  ds_bpermute_b32 v77, v44, v68 offset:32
  ds_bpermute_b32 v78, v44, v72 offset:0
  ds_bpermute_b32 v79, v44, v72 offset:32
  s_lshr_b32 s92, s82, 12
  s_lshl_b32 s92, s92, 12
  s_add_u32 s94, s82, s92
  s_add_u32 s94, s94, 1114112
  s_add_u32 s82, s82, 851968
  v_bfe_u32 v45, v1, 2, 1
  v_lshlrev_b32 v45, 6, v45
  v_add_u32 v45, v45, v41
  v_bfe_u32 v69, v1, 2, 1
  v_lshlrev_b32 v69, 12, v69
  v_and_b32 v3, 3, v1
  v_lshl_add_u32 v69, v3, 6, v69
  v_lshrrev_b32 v3, 4, v1
  v_lshl_add_u32 v69, v3, 4, v69
  s_waitcnt lgkmcnt(0)
  v_add_f32 v78, 1.0, v78
  v_lshlrev_b32 v66, 16, v66
  v_cvt_pk_bf16_f32 v44, v78, v78
  v_and_b32 v78, 0xffff0000, v44
  s_cmp_eq_u32 s3, 7
  s_cbranch_scc1 L_ab_61
  ds_write_b16_d16_hi v57, v78
  ds_write_b16_d16_hi v57, v77 offset:64
  ds_read_b128 v[72:75], v45
  s_waitcnt lgkmcnt(0)
  v_mfma_f32_16x16x32_bf16 v[208:211], v[80:83], v[72:75], 0
  v_mfma_f32_16x16x32_bf16 v[212:215], v[84:87], v[72:75], 0
  v_mfma_f32_16x16x32_bf16 v[216:219], v[88:91], v[72:75], 0
  v_mfma_f32_16x16x32_bf16 v[220:223], v[92:95], v[72:75], 0
  s_mov_b32 exec_lo, 0x220022
  s_mov_b32 exec_hi, 0x220022
  s_nop 3
  v_mov_b32 v208, v212
  v_mov_b32 v209, v213
  v_mov_b32 v210, v214
  v_mov_b32 v211, v215
  s_mov_b32 exec_lo, 0x440044
  s_mov_b32 exec_hi, 0x440044
  v_mov_b32 v208, v216
  v_mov_b32 v209, v217
  v_mov_b32 v210, v218
  v_mov_b32 v211, v219
  s_mov_b32 exec_lo, 0x880088
  s_mov_b32 exec_hi, 0x880088
  v_mov_b32 v208, v220
  v_mov_b32 v209, v221
  v_mov_b32 v210, v222
  v_mov_b32 v211, v223
  s_mov_b32 exec_lo, 0xff00ff
  s_mov_b32 exec_hi, 0xff00ff
  v_and_or_b32 v208, v208, v2, s49
  v_and_or_b32 v209, v209, v2, s50
  v_and_or_b32 v210, v210, v2, s51
  v_and_or_b32 v211, v211, v2, s52
  buffer_store_dwordx4 v[208:211], v69, s[32:35], s94 offen sc1
  s_mov_b64 exec, -1
L_ab_61:
  v_mov_b32 v112, 0
  v_mov_b32 v113, 0
  v_mov_b32 v114, 0
  v_mov_b32 v115, 0
  s_mov_b32 s60, 0xffffffff
  s_mov_b32 s61, 0x0
  s_mov_b32 s100, 0
  s_branch L_gf_67
L_g_66:
  s_add_u32 s100, s100, 1
  s_cmp_gt_u32 s100, 100000
  s_cbranch_scc1 L_abort
  s_sleep 4
L_gf_67:
  s_mov_b64 exec, s[60:61]
  buffer_load_dwordx4 v[112:115], v61, s[32:35], s90 offen offset:0 sc1
  s_waitcnt vmcnt(0)
L_gc_68:
  s_mov_b64 exec, s[60:61]
  v_perm_b32 v44, v113, v112, s56
  v_perm_b32 v44, v114, v44, s57
  v_perm_b32 v44, v115, v44, s58
  v_cmp_ne_u32 s[60:61], s48, v44
  s_nop 0
  s_cmp_lg_u64 s[60:61], 0
  s_cbranch_scc1 L_g_66
  s_mov_b64 exec, -1
  v_permlane32_swap_b32 v112, v114
  v_permlane32_swap_b32 v113, v115
  v_add_f32 v112, v112, v114
  v_add_f32 v113, v113, v115
  s_nop 1
  v_permlane16_swap_b32 v112, v113
  v_add_f32 v112, v112, v113
  s_nop 1
  v_add_f32_dpp v112, v112, v112 row_ror:8 row_mask:0xf bank_mask:0xf
  ds_write_b32 v59, v112
  s_waitcnt lgkmcnt(0)
  s_barrier
  ds_read_b128 v[112:115], v60
  ds_read_b128 v[116:119], v60 offset:16
  s_waitcnt lgkmcnt(0)
  v_add_f32 v112, v112, v113
  v_add_f32 v114, v114, v115
  v_add_f32 v116, v116, v117
  v_add_f32 v118, v118, v119
  v_add_f32 v112, v112, v114
  v_add_f32 v116, v116, v118
  v_add_f32 v112, v112, v116
  v_cvt_pk_bf16_f32 v44, v112, v112
  v_and_b32 v112, 0xffff0000, v44
  v_mul_f32 v67, v76, v112
  v_cvt_pk_bf16_f32 v44, v67, v67
  v_and_b32 v67, 0xffff0000, v44
  v_add_f32 v67, v66, v67
  v_cvt_pk_bf16_f32 v44, v67, v67
  v_and_b32 v67, 0xffff0000, v44
  s_cmp_eq_u32 s3, 7
  s_cbranch_scc1 L_stat
  v_mul_f32 v44, v67, v78
  v_cvt_pk_bf16_f32 v44, v44, v44
  ds_write_b16 v57, v44
  ds_read_b128 v[160:163], v41
  s_mov_b32 s70, 0x20002
  s_mov_b32 s71, 0x20002
  s_mov_b32 s72, 0x40004
  s_mov_b32 s73, 0x40004
  s_mov_b32 s74, 0x80008
  s_mov_b32 s75, 0x80008
  s_waitcnt lgkmcnt(0)
  v_mfma_f32_16x16x32_bf16 v[128:131], v[80:83], v[160:163], 0
  v_mfma_f32_16x16x32_bf16 v[132:135], v[84:87], v[160:163], 0
  v_mfma_f32_16x16x32_bf16 v[136:139], v[88:91], v[160:163], 0
  v_mfma_f32_16x16x32_bf16 v[140:143], v[92:95], v[160:163], 0
  s_nop 5
  v_cndmask_b32 v128, v128, v132, s[70:71]
  v_cndmask_b32 v129, v129, v133, s[70:71]
  v_cndmask_b32 v130, v130, v134, s[70:71]
  v_cndmask_b32 v131, v131, v135, s[70:71]
  v_cndmask_b32 v128, v128, v136, s[72:73]
  v_cndmask_b32 v129, v129, v137, s[72:73]
  v_cndmask_b32 v130, v130, v138, s[72:73]
  v_cndmask_b32 v131, v131, v139, s[72:73]
  v_cndmask_b32 v128, v128, v140, s[74:75]
  v_cndmask_b32 v129, v129, v141, s[74:75]
  v_cndmask_b32 v130, v130, v142, s[74:75]
  v_cndmask_b32 v131, v131, v143, s[74:75]
  v_and_or_b32 v128, v128, v2, s49
  v_and_or_b32 v129, v129, v2, s50
  v_and_or_b32 v130, v130, v2, s51
  v_and_or_b32 v131, v131, v2, s52
  s_mov_b32 exec_lo, 0xf000f
  s_mov_b32 exec_hi, 0xf000f
  buffer_store_dwordx4 v[128:131], v58, s[32:35], s82 offen
  s_add_u32 s97, s82, 0xf0000
  buffer_store_dwordx4 v[128:131], v58, s[32:35], s97 offen sc1
  s_mov_b64 exec, -1
  s_branch L_xdone
L_stat:
  v_mov_b32 v130, v67
  v_mul_f32 v131, v67, v67
  s_nop 0
  v_add_f32_dpp v130, v130, v130 row_ror:8 row_mask:0xf bank_mask:0xf
  v_add_f32_dpp v131, v131, v131 row_ror:8 row_mask:0xf bank_mask:0xf
  s_nop 0
  v_add_f32_dpp v130, v130, v130 row_ror:4 row_mask:0xf bank_mask:0xf
  v_add_f32_dpp v131, v131, v131 row_ror:4 row_mask:0xf bank_mask:0xf
  s_nop 0
  v_add_f32_dpp v130, v130, v130 row_ror:2 row_mask:0xf bank_mask:0xf
  v_add_f32_dpp v131, v131, v131 row_ror:2 row_mask:0xf bank_mask:0xf
  s_nop 0
  v_add_f32_dpp v130, v130, v130 row_ror:1 row_mask:0xf bank_mask:0xf
  v_add_f32_dpp v131, v131, v131 row_ror:1 row_mask:0xf bank_mask:0xf
  v_mov_b32 v128, v130
  v_mov_b32 v129, v131
  s_nop 0
  v_permlane16_swap_b32 v130, v128
  v_permlane16_swap_b32 v131, v129
  v_add_f32 v130, v130, v128
  v_add_f32 v131, v131, v129
  v_and_b32 v128, v2, v130
  v_and_b32 v129, v2, v131
  v_sub_f32 v130, v130, v128
  v_sub_f32 v131, v131, v129
  v_and_or_b32 v128, v128, v2, s49
  v_and_or_b32 v129, v129, v2, s50
  v_and_or_b32 v130, v130, v2, s51
  v_and_or_b32 v131, v131, v2, s52
  s_lshl_b32 s92, s80, 11
  s_lshl_b32 s97, s79, 7
  s_add_u32 s92, s92, s97
  s_add_u32 s92, s92, 0x18000
  s_mov_b64 exec, 1
  buffer_store_dwordx4 v[128:131], v1, s[32:35], s92 offen
  s_add_u32 s97, s92, 0x1e0000
  buffer_store_dwordx4 v[128:131], v1, s[32:35], s97 offen sc1
  s_mov_b64 exec, -1
  v_mov_b32 v112, 0
L_xdone:
  s_and_b32 s92, s79, 7
  s_cmp_lg_u32 s80, s92
  s_cbranch_scc1 L_fin
  s_mul_i32 s90, s79, 8448
  s_lshl_b32 s97, s3, 10
  s_add_u32 s90, s90, s97
  s_add_u32 s90, s90, 0xa0000
  s_lshl_b32 s92, s79, 6
  v_and_b32 v46, 31, v1
  v_lshlrev_b32 v46, 1, v46
  v_add_u32 v46, s92, v46
  s_cmp_eq_u32 s3, 7
  s_cbranch_scc1 L_nof
  s_mov_b64 s[60:61], -1
  s_mov_b32 s100, 0
  s_branch L_gf_71
L_g_70:
  s_add_u32 s100, s100, 1
  s_cmp_gt_u32 s100, 100000
  s_cbranch_scc1 L_abort
  s_sleep 1
L_gf_71:
  s_mov_b64 exec, s[60:61]
  buffer_load_dwordx4 v[112:115], v34, s[32:35], s90 offen offset:0 sc1
  s_waitcnt vmcnt(0)
L_gc_72:
  s_mov_b64 exec, s[60:61]
  v_perm_b32 v44, v113, v112, s56
  v_perm_b32 v44, v114, v44, s57
  v_perm_b32 v44, v115, v44, s58
  v_cmp_ne_u32 s[60:61], s48, v44
  s_nop 0
  s_cmp_lg_u64 s[60:61], 0
  s_cbranch_scc1 L_g_70
  s_mov_b64 exec, -1
  v_permlane32_swap_b32 v112, v114
  v_permlane32_swap_b32 v113, v115
  v_add_f32 v112, v112, v114
  v_add_f32 v113, v113, v115
  s_nop 1
  v_permlane16_swap_b32 v112, v113
  v_add_f32 v112, v112, v113
  s_nop 1
  v_add_f32_dpp v112, v112, v112 row_ror:8 row_mask:0xf bank_mask:0xf
L_nof:
  ds_write_b32 v59, v112 offset:1024
  s_waitcnt lgkmcnt(0)
  s_barrier
  s_cmp_lg_u32 s3, 0
  s_cbranch_scc1 L_fin
  ds_read_b128 v[112:115], v60 offset:1024
  ds_read_b128 v[116:119], v60 offset:1040
  s_waitcnt lgkmcnt(0)
  v_add_f32 v112, v112, v113
  v_add_f32 v114, v114, v115
  v_add_f32 v116, v116, v117
  v_add_f32 v118, v118, v119
  v_add_f32 v112, v112, v114
  v_add_f32 v116, v116, v118
  v_add_f32 v112, v112, v116
  v_cvt_pk_bf16_f32 v45, v112, v112
  v_and_b32 v112, 0xffff0000, v45
  v_mul_f32 v44, v79, v112
  v_cvt_pk_bf16_f32 v45, v44, v44
  v_and_b32 v44, 0xffff0000, v45
  v_add_f32 v44, v67, v44
  v_cvt_pk_bf16_f32 v44, v44, v44
  s_mov_b32 exec_hi, 0
  global_store_short v46, v44, s[28:29]
  s_cmp_lg_u32 s2, 128
  s_cbranch_scc1 L_noep
  s_mov_b64 exec, 1
  v_mov_b32 v45, 0
  global_store_dword v45, v45, s[30:31]
L_noep:
L_fin:
  s_endpgm
L_Y:
  s_cmp_ge_u32 s2, 112
  s_cbranch_scc1 L_fin
  s_lshl_b32 s94, s81, 13
  s_lshl_b32 s97, s3, 10
  s_add_u32 s94, s94, s97
  s_add_u32 s94, s94, 0x110000
  s_mov_b64 s[40:41], s[22:23]
  s_mov_b32 s42, 0x1c0000
  s_mov_b32 s43, 0x20000
  v_lshrrev_b32 v44, 5, v1
  v_lshlrev_b32 v44, 10, v44
  v_and_b32 v3, 31, v1
  v_lshl_add_u32 v44, v3, 4, v44
  buffer_load_dwordx4 v[176:179], v44, s[40:43], s91 offen offset:0 nt
  buffer_load_dwordx4 v[180:183], v44, s[40:43], s91 offen offset:2048 nt
  v_mov_b32 v112, 0
  v_mov_b32 v113, 0
  v_mov_b32 v114, 0
  v_mov_b32 v115, 0
  v_lshlrev_b32 v46, 4, v1
  v_add_u32 v46, 88064, v46
  v_lshlrev_b32 v47, 5, v1
  v_add_u32 v47, 83968, v47
  s_waitcnt vmcnt(0)
  s_mov_b64 s[60:61], -1
  s_mov_b32 s100, 0
  s_branch L_gf_75
L_g_74:
  s_add_u32 s100, s100, 1
  s_cmp_gt_u32 s100, 100000
  s_cbranch_scc1 L_abort
  s_sleep 2
L_gf_75:
  s_mov_b64 exec, s[60:61]
  buffer_load_dwordx4 v[76:79], v34, s[32:35], s94 offen offset:0 sc1
  s_waitcnt vmcnt(0)
L_gc_76:
  s_mov_b64 exec, s[60:61]
  v_perm_b32 v44, v77, v76, s56
  v_perm_b32 v44, v78, v44, s57
  v_perm_b32 v44, v79, v44, s58
  v_cmp_ne_u32 s[60:61], s48, v44
  s_nop 0
  s_cmp_lg_u64 s[60:61], 0
  s_cbranch_scc1 L_g_74
  s_mov_b64 exec, -1
  v_permlane32_swap_b32 v76, v78
  v_permlane32_swap_b32 v77, v79
  v_add_f32 v76, v76, v78
  v_add_f32 v77, v77, v79
  s_nop 1
  v_permlane16_swap_b32 v76, v77
  v_add_f32 v76, v76, v77
  s_waitcnt vmcnt(0)
  ds_write_b128 v62, v[176:179] offset:0
  ds_write_b128 v62, v[180:183] offset:1088
  ds_write_b32 v60, v76
  s_waitcnt lgkmcnt(0)
  s_barrier
  ds_read_b128 v[128:131], v46
  ds_read_b128 v[132:135], v46 offset:1024
  ds_read_b64_tr_b16 v[68:69], v63 offset:0
  ds_read_b64_tr_b16 v[70:71], v63 offset:2176
  ds_read_b64_tr_b16 v[72:73], v63 offset:32
  ds_read_b64_tr_b16 v[74:75], v63 offset:2208
  s_waitcnt lgkmcnt(4)
  v_add_f32 v128, v128, v129
  v_add_f32 v130, v130, v131
  v_add_f32 v128, v128, v130
  v_add_f32 v132, v132, v133
  v_add_f32 v134, v134, v135
  v_add_f32 v132, v132, v134
  s_mov_b32 s66, 0
  s_mov_b32 s60, 0xffffffff
  s_mov_b32 s61, 0x0
  s_mov_b32 s62, 0xffff
  s_mov_b32 s63, 0x0
  s_mov_b32 s100, 0
  s_branch L_gf_79
L_g_78:
  s_add_u32 s100, s100, 1
  s_cmp_gt_u32 s100, 100000
  s_cbranch_scc1 L_abort
  s_sleep 1
  s_cmp_lg_u32 s100, 30
  s_cbranch_scc1 L_alt_81
  s_add_u32 s82, s82, 0xf0000
  s_add_u32 s66, s66, 0x1e0000
L_alt_81:
L_gf_79:
  s_mov_b64 exec, s[60:61]
  s_cbranch_execz L_gs_82
  buffer_load_dwordx4 v[112:115], v61, s[32:35], s82 offen offset:0 sc1
L_gs_82:
  s_mov_b64 exec, s[62:63]
  s_cbranch_execz L_gs_83
  buffer_load_dwordx4 v[136:139], v56, s[32:35], s66 offen offset:0 sc1
L_gs_83:
  s_waitcnt vmcnt(0)
L_gc_80:
  s_mov_b64 exec, s[60:61]
  v_perm_b32 v44, v113, v112, s56
  v_perm_b32 v44, v114, v44, s57
  v_perm_b32 v44, v115, v44, s58
  v_cmp_ne_u32 s[60:61], s48, v44
  s_mov_b64 exec, s[62:63]
  v_perm_b32 v44, v137, v136, s56
  v_perm_b32 v44, v138, v44, s57
  v_perm_b32 v44, v139, v44, s58
  v_cmp_ne_u32 s[62:63], s48, v44
  s_nop 0
  s_or_b64 s[96:97], s[60:61], s[62:63]
  s_cbranch_scc1 L_g_78
  s_mov_b64 exec, -1
  v_permlane32_swap_b32 v112, v114
  v_permlane32_swap_b32 v113, v115
  v_add_f32 v112, v112, v114
  v_add_f32 v113, v113, v115
  s_nop 1
  v_permlane16_swap_b32 v112, v113
  v_add_f32 v112, v112, v113
  ds_write_b32 v59, v112
  v_add_f32 v136, v136, v138
  v_add_f32 v137, v137, v139
  s_nop 0
  v_add_f32_dpp v136, v136, v136 quad_perm:[1,0,3,2] row_mask:0xf bank_mask:0xf
  v_add_f32_dpp v137, v137, v137 quad_perm:[1,0,3,2] row_mask:0xf bank_mask:0xf
  s_nop 0
  v_add_f32_dpp v136, v136, v136 quad_perm:[2,3,0,1] row_mask:0xf bank_mask:0xf
  v_add_f32_dpp v137, v137, v137 quad_perm:[2,3,0,1] row_mask:0xf bank_mask:0xf
  s_nop 0
  v_add_f32_dpp v136, v136, v136 row_half_mirror row_mask:0xf bank_mask:0xf
  v_add_f32_dpp v137, v137, v137 row_half_mirror row_mask:0xf bank_mask:0xf
  s_nop 0
  v_add_f32_dpp v136, v136, v136 row_ror:8 row_mask:0xf bank_mask:0xf
  v_add_f32_dpp v137, v137, v137 row_ror:8 row_mask:0xf bank_mask:0xf
  s_waitcnt lgkmcnt(0)
  s_barrier
  ds_read_b128 v[112:115], v47
  ds_read_b128 v[116:119], v47 offset:16
  v_readfirstlane_b32 s92, v136
  v_readfirstlane_b32 s93, v137
  v_mov_b32 v44, 0x3b000000
  v_mul_f32 v136, s92, v44
  v_mul_f32 v137, s93, v44
  v_fma_f32 v137, -v136, v136, v137
  v_max_f32 v137, 0, v137
  v_cvt_pk_bf16_f32 v45, v137, v137
  v_and_b32 v137, 0xffff0000, v45
  v_cvt_pk_bf16_f32 v44, v136, v136
  v_and_b32 v136, 0xffff0000, v44
  v_add_f32 v137, 0x3727c5ac, v137
  v_mul_f32 v128, v136, v128
  v_cvt_pk_bf16_f32 v45, v137, v137
  v_and_b32 v137, 0xffff0000, v45
  v_sqrt_f32 v137, v137
  s_nop 0
  v_cvt_pk_bf16_f32 v45, v137, v137
  v_and_b32 v137, 0xffff0000, v45
  v_rcp_f32 v137, v137
  s_waitcnt lgkmcnt(0)
  v_add_f32 v112, v112, v113
  v_add_f32 v114, v114, v115
  v_add_f32 v116, v116, v117
  v_add_f32 v118, v118, v119
  v_add_f32 v112, v112, v114
  v_add_f32 v116, v116, v118
  v_add_f32 v112, v112, v116
  v_sub_f32 v112, v112, v128
  v_fma_f32 v112, v112, v137, v132
  v_cvt_pk_bf16_f32 v44, v112, v112
  v_and_b32 v112, 0xffff0000, v44
  v_mul_f32 v44, v112, v112
  v_mov_b32 v45, 0xc0135761
  v_mov_b32_dpp v113, v112 row_ror:8 row_mask:0xf bank_mask:0xf
  v_fmac_f32 v45, 0xbdd2d3e8, v44
  v_mul_f32 v44, v45, v112
  v_exp_f32 v44, v44
  s_nop 0
  v_add_f32 v44, 1.0, v44
  v_rcp_f32 v44, v44
  s_nop 0
  v_mul_f32 v112, v112, v44
  v_cvt_pk_bf16_f32 v44, v112, v112
  v_and_b32 v112, 0xffff0000, v44
  v_mul_f32 v112, v112, v113
  v_cvt_pk_bf16_f32 v44, v112, v112
  s_mov_b32 exec_lo, 0xff00ff
  s_mov_b32 exec_hi, 0xff00ff
  ds_write_b16 v57, v44
  s_mov_b64 exec, -1
  ds_read_b128 v[160:163], v41
  s_mov_b32 s70, 0x20002
  s_mov_b32 s71, 0x20002
  s_waitcnt lgkmcnt(0)
  v_mfma_f32_16x16x32_bf16 v[144:147], v[68:71], v[160:163], 0
  v_mfma_f32_16x16x32_bf16 v[148:151], v[72:75], v[160:163], 0
  s_nop 7
  v_cndmask_b32 v144, v144, v148, s[70:71]
  v_cndmask_b32 v145, v145, v149, s[70:71]
  v_cndmask_b32 v146, v146, v150, s[70:71]
  v_cndmask_b32 v147, v147, v151, s[70:71]
  v_and_or_b32 v144, v144, v2, s49
  v_and_or_b32 v145, v145, v2, s50
  v_and_or_b32 v146, v146, v2, s51
  v_and_or_b32 v147, v147, v2, s52
  s_mov_b32 exec_lo, 0x30003
  s_mov_b32 exec_hi, 0x30003
  buffer_store_dwordx4 v[144:147], v58, s[32:35], s90 offen sc1
  s_endpgm
L_abort:
  s_endpgm
L_end:
  s_endpgm
L_codeend:
.section .rodata,"a"
.p2align 6
.amdhsa_kernel adaLN_cond__compressed_kv_cla__glu_gated_geglu__decode_kernel
  .amdhsa_next_free_vgpr 256
  .amdhsa_next_free_sgpr 102
  .amdhsa_accum_offset 256
  .amdhsa_group_segment_fixed_size 0
  .amdhsa_kernarg_size 120
  .amdhsa_user_sgpr_count 2
  .amdhsa_user_sgpr_kernarg_segment_ptr 1
  .amdhsa_system_sgpr_workgroup_id_x 1
.end_amdhsa_kernel
```

```asm
; @launch grid=(256,1,1) block=(512,1,1) lds=163840
.amdgcn_target "amdgcn-amd-amdhsa--gfx950"
.text
.globl adaLN_cond__compressed_kv_cla__glu_gated_geglu__decode_kernel
.p2align 8
.type adaLN_cond__compressed_kv_cla__glu_gated_geglu__decode_kernel,@function
adaLN_cond__compressed_kv_cla__glu_gated_geglu__decode_kernel:
  s_cmp_ge_u32 s2, 256
  s_cbranch_scc1 L_end
  s_load_dwordx16 s[4:19], s[0:1], 0
  s_load_dwordx8 s[20:27], s[0:1], 64
  s_load_dwordx4 s[28:31], s[0:1], 96
  s_load_dwordx2 s[32:33], s[0:1], 112
  v_lshrrev_b32 v1, 6, v0
  s_mov_b32 s34, 0x10000000
  s_mov_b32 s35, 0x20000
  v_readfirstlane_b32 s3, v1
  v_and_b32 v1, 63, v0
  v_mov_b32 v8, 0
  v_mov_b32 v20, 0
  v_mov_b32 v251, 0
  v_mov_b32 v253, 0
  s_cmp_lt_u32 s2, 128
  s_cbranch_scc0 L_B
  v_lshlrev_b32 v38, 4, v1
  s_bfe_u32 s82, s2, 0x30003
  s_lshl_b32 s82, s82, 19
  s_lshl_b32 s97, s3, 16
  s_add_u32 s82, s82, s97
  s_and_b32 s97, s2, 7
  s_lshl_b32 s97, s97, 10
  s_add_u32 s82, s82, s97
  s_mov_b32 s42, 0x400000
  s_mov_b32 s43, 0x20000
  s_bitcmp1_b32 s2, 6
  s_cbranch_scc1 L_K
  v_and_b32 v8, 15, v1
  v_lshlrev_b32 v8, 3, v8
  v_lshrrev_b32 v3, 4, v1
  v_lshl_add_u32 v8, v3, 1, v8
  s_bfe_u32 s92, s2, 0x30003
  s_lshl_b32 s92, s92, 7
  v_add_u32 v17, s92, v8
  s_mul_i32 s83, s3, 8576
  s_lshl_b32 s92, s2, 17
  v_mov_b32 v18, s92
  v_mov_b32 v19, 0xf000
  s_waitcnt lgkmcnt(0)
  s_mov_b64 s[40:41], s[8:9]
  global_load_dwordx4 v[12:15], v38, s[4:5]
  global_load_ushort v16, v17, s[4:5]
  s_add_u32 m0, s83, 0
  s_add_u32 s92, s82, 0
  buffer_load_dwordx4 v38, s[40:43], s92 offen nt lds
  s_add_u32 m0, s83, 1056
  s_add_u32 s92, s82, 8192
  buffer_load_dwordx4 v38, s[40:43], s92 offen nt lds
  s_add_u32 m0, s83, 2112
  s_add_u32 s92, s82, 16384
  buffer_load_dwordx4 v38, s[40:43], s92 offen nt lds
  s_add_u32 m0, s83, 3168
  s_add_u32 s92, s82, 24576
  buffer_load_dwordx4 v38, s[40:43], s92 offen nt lds
  s_add_u32 m0, s83, 4224
  s_add_u32 s92, s82, 32768
  buffer_load_dwordx4 v38, s[40:43], s92 offen nt lds
  s_add_u32 m0, s83, 5280
  s_add_u32 s92, s82, 40960
  buffer_load_dwordx4 v38, s[40:43], s92 offen nt lds
  s_add_u32 m0, s83, 6336
  s_add_u32 s92, s82, 49152
  buffer_load_dwordx4 v38, s[40:43], s92 offen nt lds
  s_add_u32 m0, s83, 7392
  s_add_u32 s92, s82, 57344
  buffer_load_dwordx4 v38, s[40:43], s92 offen nt lds
  s_cmp_lg_u32 s3, 7
  s_cbranch_scc1 L_nt_1
  s_mov_b64 exec, 1
  global_load_dword v20, v18, s[6:7] nt
  global_load_dword v21, v19, s[32:33]
  global_load_dword v22, v38, s[30:31] offset:128
  s_mov_b64 exec, -1
L_nt_1:
  s_branch L_Q2
L_K:
  s_bfe_u32 s81, s2, 0x10004
  s_xor_b32 s81, s81, 1
  s_lshl_b32 s81, s81, 16
  s_and_b32 s92, s3, 1
  s_lshl_b32 s92, s92, 7
  v_xor_b32 v39, s92, v38
  s_lshl_b32 s83, s3, 13
  s_add_u32 s83, s83, s81
  v_mov_b32 v19, 0xf000
  s_waitcnt lgkmcnt(0)
  s_mov_b64 s[40:41], s[10:11]
  s_mov_b64 exec, 1
  global_load_dword v21, v19, s[32:33]
  s_mov_b64 exec, -1
  v_xor_b32 v40, 0, v39
  s_add_u32 m0, s83, 0
  s_add_u32 s92, s82, 0
  buffer_load_dwordx4 v40, s[40:43], s92 offen nt lds
  v_xor_b32 v41, 16, v39
  s_add_u32 m0, s83, 1024
  s_add_u32 s92, s82, 8192
  buffer_load_dwordx4 v41, s[40:43], s92 offen nt lds
  v_xor_b32 v40, 32, v39
  s_add_u32 m0, s83, 2048
  s_add_u32 s92, s82, 16384
  buffer_load_dwordx4 v40, s[40:43], s92 offen nt lds
  v_xor_b32 v41, 48, v39
  s_add_u32 m0, s83, 3072
  s_add_u32 s92, s82, 24576
  buffer_load_dwordx4 v41, s[40:43], s92 offen nt lds
  v_xor_b32 v40, 64, v39
  s_add_u32 m0, s83, 4096
  s_add_u32 s92, s82, 32768
  buffer_load_dwordx4 v40, s[40:43], s92 offen nt lds
  v_xor_b32 v41, 80, v39
  s_add_u32 m0, s83, 5120
  s_add_u32 s92, s82, 40960
  buffer_load_dwordx4 v41, s[40:43], s92 offen nt lds
  v_xor_b32 v40, 96, v39
  s_add_u32 m0, s83, 6144
  s_add_u32 s92, s82, 49152
  buffer_load_dwordx4 v40, s[40:43], s92 offen nt lds
  v_xor_b32 v41, 112, v39
  s_add_u32 m0, s83, 7168
  s_add_u32 s92, s82, 57344
  buffer_load_dwordx4 v41, s[40:43], s92 offen nt lds
  s_branch L_K2
L_B:
  s_cmp_ge_u32 s3, 4
  s_cbranch_scc0 L_Bfront
  v_lshrrev_b32 v10, 3, v1
  v_mul_u32_u24 v5, 24576, v10
  v_lshlrev_b32 v10, 3, v10
  v_and_b32 v11, 7, v1
  v_lshl_add_u32 v5, v11, 4, v5
  s_bfe_u32 s94, s2, 0x20004
  s_and_b32 s95, s2, 15
  s_lshl_b32 s92, s94, 2
  s_add_u32 s92, s92, s3
  s_sub_u32 s92, s92, 4
  s_lshl_b32 s93, s92, 6
  v_add_u32 v10, s93, v10
  s_mul_i32 s92, s92, 196608
  s_lshl_b32 s93, s95, 7
  s_add_u32 s92, s92, s93
  s_mov_b32 s42, 0x300000
  s_mov_b32 s43, 0x20000
  v_mov_b32 v253, 0
  s_waitcnt lgkmcnt(0)
  s_mov_b64 s[40:41], s[26:27]
  s_bitcmp1_b32 s2, 6
  s_cbranch_scc1 L_nou0
  global_load_dwordx2 v[112:113], v10, s[24:25]
  buffer_load_dwordx4 v[124:127], v5, s[40:43], s92 offen nt
  s_add_u32 s92, s92, 6144
  buffer_load_dwordx4 v[128:131], v5, s[40:43], s92 offen nt
  s_add_u32 s92, s92, 6144
  buffer_load_dwordx4 v[132:135], v5, s[40:43], s92 offen nt
  s_add_u32 s92, s92, 6144
  buffer_load_dwordx4 v[136:139], v5, s[40:43], s92 offen nt
L_nou0:
  s_branch L_Bback2
L_Bfront:
  s_memrealtime s[62:63]
  s_bfe_u32 s64, s2, 0x40003
  s_xor_b32 s64, s64, 8
  s_or_b32 s64, s64, s3
  s_cbranch_scc1 L_nononce
  v_mov_b32 v18, 0
  v_mov_b32 v21, 0
  s_waitcnt lgkmcnt(0)
  s_or_b32 s62, s62, 1
  v_mov_b32 v20, s62
  s_mov_b64 exec, 1
  global_atomic_cmpswap v18, v[20:21], s[30:31] sc1
  s_mov_b64 exec, -1
L_nononce:
  v_lshrrev_b32 v245, 4, v1
  v_and_b32 v246, 15, v1
  v_lshlrev_b32 v247, 2, v245
  v_xor_b32 v246, v246, v247
  v_lshlrev_b32 v246, 4, v246
  v_lshl_add_u32 v244, v245, 10, v246
  v_xor_b32 v245, 16, v244
  v_xor_b32 v246, 32, v244
  v_xor_b32 v247, 48, v244
  v_add_u32 v245, 3072, v245
  v_add_u32 v246, 6144, v246
  v_add_u32 v247, 9216, v247
  s_and_b32 s91, s3, 3
  s_lshl_b32 s90, s91, 15
  s_lshl_b32 s91, s91, 13
  s_lshl_b32 s92, s2, 17
  s_add_u32 s90, s90, s92
  s_bfe_u32 s93, s2, 0x20003
  s_lshl_b32 s92, s93, 15
  s_add_u32 s91, s91, s92
  s_lshl_b32 s92, s93, 8
  s_add_u32 s90, s90, s92
  s_getpc_b64 s[94:95]
L_pc:
  s_sub_u32 s94, s94, L_pc-adaLN_cond__compressed_kv_cla__glu_gated_geglu__decode_kernel
  s_subb_u32 s95, s95, 0
  s_bfe_u32 s92, s2, 0x40003
  s_lshl_b32 s92, s92, 2
  s_add_u32 s92, s92, s3
  s_lshl_b32 s92, s92, 10
  v_lshlrev_b32 v11, 4, v1
  v_add_u32 v11, s92, v11
  s_mov_b32 s38, 0x2000000
  s_mov_b32 s39, 0x20000
  s_cmp_ge_u32 s92, L_codeend-adaLN_cond__compressed_kv_cla__glu_gated_geglu__decode_kernel
  s_cbranch_scc1 L_nopf
  v_min_u32 v11, L_codeend-adaLN_cond__compressed_kv_cla__glu_gated_geglu__decode_kernel-16, v11
  global_load_dwordx4 v[12:15], v11, s[94:95]
L_nopf:
  s_waitcnt lgkmcnt(0)
  s_mov_b64 s[36:37], s[6:7]
  s_barrier
  s_barrier
  s_mov_b32 s54, 0x05040100
  s_mov_b32 s55, 0x07060302
  s_mov_b32 s56, 0x0c0c0400
  s_mov_b32 s57, 0x0c040100
  s_mov_b32 s58, 0x04020100
  s_mov_b32 s53, 0x10001
  v_mov_b32 v2, 0xffffff00
  s_lshr_b32 s77, s2, 5
  s_and_b32 s78, s2, 127
  s_and_b32 s76, s2, 7
  s_lshl_b32 s76, s76, 2
  s_bfe_u32 s97, s2, 0x20003
  s_add_u32 s76, s76, s97
  s_bfe_u32 s79, s2, 0x40003
  s_and_b32 s80, s2, 7
  s_bfe_u32 s17, s2, 0x20003
  s_bfe_u32 s59, s2, 0x10004
  s_lshl_b32 s59, s59, 14
  s_xor_b32 m0, s91, 0
  s_xor_b32 s101, s90, 0
  buffer_load_dwordx4 v244, s[36:39], s101 offen offset:0 nt lds
  s_waitcnt vmcnt(0)
  buffer_load_dwordx4 v245, s[36:39], s101 offen offset:1024 nt lds
  s_waitcnt vmcnt(0)
  buffer_load_dwordx4 v246, s[36:39], s101 offen offset:2048 nt lds
  s_waitcnt vmcnt(2)
  buffer_load_dwordx4 v247, s[36:39], s101 offen offset:3072 nt lds
  s_waitcnt vmcnt(2)
  s_xor_b32 m0, s91, 32768
  s_xor_b32 s101, s90, 256
  buffer_load_dwordx4 v244, s[36:39], s101 offen offset:0 nt lds
  s_waitcnt vmcnt(2)
  buffer_load_dwordx4 v245, s[36:39], s101 offen offset:1024 nt lds
  s_waitcnt vmcnt(2)
  buffer_load_dwordx4 v246, s[36:39], s101 offen offset:2048 nt lds
  s_waitcnt vmcnt(2)
  buffer_load_dwordx4 v247, s[36:39], s101 offen offset:3072 nt lds
  s_waitcnt vmcnt(2)
  s_xor_b32 m0, s91, 65536
  s_xor_b32 s101, s90, 512
  buffer_load_dwordx4 v244, s[36:39], s101 offen offset:0 nt lds
  buffer_load_dwordx4 v245, s[36:39], s101 offen offset:1024 nt lds
  buffer_load_dwordx4 v246, s[36:39], s101 offen offset:2048 nt lds
  buffer_load_dwordx4 v247, s[36:39], s101 offen offset:3072 nt lds
  v_mov_b32 v253, 0
  global_load_dword v252, v253, s[30:31] sc1
  s_barrier
  s_xor_b32 m0, s91, 98304
  s_xor_b32 s101, s90, 768
  buffer_load_dwordx4 v244, s[36:39], s101 offen offset:0 nt lds
  buffer_load_dwordx4 v245, s[36:39], s101 offen offset:1024 nt lds
  buffer_load_dwordx4 v246, s[36:39], s101 offen offset:2048 nt lds
  buffer_load_dwordx4 v247, s[36:39], s101 offen offset:3072 nt lds
  s_branch L_front
L_Q2:
  s_mov_b32 s54, 0x05040100
  s_mov_b32 s55, 0x07060302
  s_mov_b32 s56, 0x0c0c0400
  s_mov_b32 s57, 0x0c040100
  s_mov_b32 s58, 0x04020100
  s_mov_b32 s53, 0x10001
  v_mov_b32 v2, 0xffffff00
  s_lshr_b32 s77, s2, 5
  s_and_b32 s78, s2, 127
  s_and_b32 s76, s2, 7
  s_lshl_b32 s76, s76, 2
  s_bfe_u32 s97, s2, 0x20003
  s_add_u32 s76, s76, s97
  s_bfe_u32 s79, s2, 0x40003
  s_and_b32 s80, s2, 7
  s_bfe_u32 s17, s2, 0x20003
  s_bfe_u32 s59, s2, 0x10004
  s_lshl_b32 s59, s59, 14
  v_lshrrev_b32 v245, 4, v1
  v_and_b32 v246, 15, v1
  v_lshlrev_b32 v247, 2, v245
  v_xor_b32 v246, v246, v247
  v_lshlrev_b32 v246, 4, v246
  v_lshl_add_u32 v244, v245, 10, v246
  v_xor_b32 v245, 16, v244
  v_xor_b32 v246, 32, v244
  v_xor_b32 v247, 48, v244
  v_add_u32 v245, 3072, v245
  v_add_u32 v246, 6144, v246
  v_add_u32 v247, 9216, v247
  s_and_b32 s91, s3, 3
  s_lshl_b32 s90, s91, 15
  s_lshl_b32 s91, s91, 13
  s_lshl_b32 s92, s2, 17
  s_add_u32 s90, s90, s92
  s_bfe_u32 s93, s2, 0x20003
  s_lshl_b32 s92, s93, 15
  s_add_u32 s91, s91, s92
  s_lshl_b32 s92, s93, 8
  s_add_u32 s90, s90, s92
  s_mov_b64 s[36:37], s[6:7]
  s_mov_b32 s38, 0x2000000
  s_mov_b32 s39, 0x20000
  s_bfe_u32 s82, s2, 0x30003
  s_lshl_b32 s82, s82, 10
  s_add_u32 s83, s82, 8192
  s_lshl_b32 s92, s3, 7
  s_add_u32 s92, s92, 0x20000
  v_add_u32 v40, s92, v8
  v_lshrrev_b32 v41, 4, v1
  v_lshlrev_b32 v41, 4, v41
  v_add_u32 v41, s92, v41
  s_lshl_b32 s92, s3, 7
  v_lshrrev_b32 v44, 4, v1
  v_mul_u32_u24 v44, 8576, v44
  v_bfe_u32 v3, v1, 2, 2
  v_mul_u32_u24 v3, 1056, v3
  v_add_u32 v44, v3, v44
  v_and_b32 v3, 3, v1
  v_lshl_add_u32 v44, v3, 3, v44
  v_add_u32 v44, s92, v44
  v_and_b32 v39, 3, v1
  v_lshlrev_b32 v39, 6, v39
  v_lshrrev_b32 v3, 4, v1
  v_lshl_add_u32 v39, v3, 4, v39
  s_and_b32 s85, s2, 7
  s_lshl_b32 s85, s85, 14
  s_bfe_u32 s97, s2, 0x30003
  s_lshl_b32 s97, s97, 11
  s_add_u32 s85, s85, s97
  s_lshl_b32 s97, s3, 8
  s_add_u32 s85, s85, s97
  s_add_u32 s85, s85, 0x80000
  s_mov_b32 s70, 0x20002
  s_mov_b32 s71, 0x20002
  s_mov_b32 s72, 0x40004
  s_mov_b32 s73, 0x40004
  s_mov_b32 s74, 0x80008
  s_mov_b32 s75, 0x80008
  s_waitcnt vmcnt(8)
  v_lshlrev_b32 v92, 16, v12
  v_and_b32 v93, 0xffff0000, v12
  v_lshlrev_b32 v94, 16, v13
  v_and_b32 v95, 0xffff0000, v13
  v_lshlrev_b32 v96, 16, v14
  v_and_b32 v97, 0xffff0000, v14
  v_lshlrev_b32 v98, 16, v15
  v_and_b32 v99, 0xffff0000, v15
  v_add_f32 v100, v92, v93
  v_add_f32 v100, v100, v94
  v_add_f32 v100, v100, v95
  v_add_f32 v100, v100, v96
  v_add_f32 v100, v100, v97
  v_add_f32 v100, v100, v98
  v_add_f32 v100, v100, v99
  s_nop 1
  v_add_f32_dpp v100, v100, v100 row_ror:8 row_mask:0xf bank_mask:0xf
  s_nop 1
  v_add_f32_dpp v100, v100, v100 row_ror:4 row_mask:0xf bank_mask:0xf
  s_nop 1
  v_add_f32_dpp v100, v100, v100 row_ror:2 row_mask:0xf bank_mask:0xf
  s_nop 1
  v_add_f32_dpp v100, v100, v100 row_ror:1 row_mask:0xf bank_mask:0xf
  v_mov_b32 v101, v100
  s_nop 1
  v_permlane16_swap_b32 v100, v101
  v_add_f32 v100, v100, v101
  v_mov_b32 v101, v100
  s_nop 1
  v_permlane32_swap_b32 v100, v101
  v_add_f32 v100, v100, v101
  v_mul_f32 v100, 0x3b000000, v100
  v_sub_f32 v92, v92, v100
  v_sub_f32 v93, v93, v100
  v_sub_f32 v94, v94, v100
  v_sub_f32 v95, v95, v100
  v_sub_f32 v96, v96, v100
  v_sub_f32 v97, v97, v100
  v_sub_f32 v98, v98, v100
  v_sub_f32 v99, v99, v100
  v_mul_f32 v102, v92, v92
  v_fmac_f32 v102, v93, v93
  v_fmac_f32 v102, v94, v94
  v_fmac_f32 v102, v95, v95
  v_fmac_f32 v102, v96, v96
  v_fmac_f32 v102, v97, v97
  v_fmac_f32 v102, v98, v98
  v_fmac_f32 v102, v99, v99
  s_nop 1
  v_add_f32_dpp v102, v102, v102 row_ror:8 row_mask:0xf bank_mask:0xf
  s_nop 1
  v_add_f32_dpp v102, v102, v102 row_ror:4 row_mask:0xf bank_mask:0xf
  s_nop 1
  v_add_f32_dpp v102, v102, v102 row_ror:2 row_mask:0xf bank_mask:0xf
  s_nop 1
  v_add_f32_dpp v102, v102, v102 row_ror:1 row_mask:0xf bank_mask:0xf
  v_mov_b32 v101, v102
  s_nop 1
  v_permlane16_swap_b32 v102, v101
  v_add_f32 v102, v102, v101
  v_mov_b32 v101, v102
  s_nop 1
  v_permlane32_swap_b32 v102, v101
  v_add_f32 v102, v102, v101
  v_mov_b32 v253, 0
  global_load_dword v252, v253, s[30:31] sc1
  v_mul_f32 v102, 0x3b000000, v102
  v_cvt_pk_bf16_f32 v101, v100, v100
  v_and_b32 v100, 0xffff0000, v101
  v_cvt_pk_bf16_f32 v101, v102, v102
  v_and_b32 v102, 0xffff0000, v101
  v_add_f32 v102, 0x3727c5ac, v102
  v_cvt_pk_bf16_f32 v101, v102, v102
  v_and_b32 v102, 0xffff0000, v101
  v_sqrt_f32 v102, v102
  s_nop 0
  v_cvt_pk_bf16_f32 v101, v102, v102
  v_and_b32 v102, 0xffff0000, v101
  v_rcp_f32 v102, v102
  v_lshlrev_b32 v103, 16, v16
  v_sub_f32 v103, v103, v100
  v_cvt_pk_bf16_f32 v101, v103, v103
  v_and_b32 v103, 0xffff0000, v101
  v_mul_f32 v103, v103, v102
  v_cvt_pk_bf16_f32 v101, v103, v103
  v_and_b32 v103, 0xffff0000, v101
  s_mov_b32 s100, 0
  s_waitcnt vmcnt(0)
  s_branch L_epc_3
L_ep_2:
  global_load_dword v252, v253, s[30:31] sc1
  s_add_u32 s100, s100, 1
  s_cmp_gt_u32 s100, 100000
  s_cbranch_scc1 L_abort
  s_waitcnt vmcnt(0)
L_epc_3:
  v_readfirstlane_b32 s48, v252
  s_nop 0
  s_cmp_eq_u32 s48, 0
  s_nop 1
  s_cbranch_scc1 L_ep_2
  s_mul_i32 s48, s48, 0x9e3779b1
  s_and_b32 s49, s48, 0xff
  s_bfe_u32 s50, s48, 0x80008
  s_bfe_u32 s51, s48, 0x80010
  s_lshr_b32 s52, s48, 24
  s_lshr_b32 s97, s48, 15
  s_xor_b32 s97, s97, s48
  s_mul_i32 s97, s97, 0x85ebca6b
  v_mov_b32 v4, s48
  v_mov_b32 v5, s97
  v_mov_b32 v249, s48
  v_mov_b32 v250, s97
  v_and_b32 v6, 4, v1
  v_cmp_eq_u32 vcc, 0, v6
  v_and_b32 v7, 3, v1
  v_lshlrev_b32 v7, 2, v7
  v_cndmask_b32 v4, v5, v4, vcc
  v_lshrrev_b32 v4, v7, v4
  v_lshrrev_b32 v5, 1, v4
  v_lshrrev_b32 v6, 2, v4
  v_lshrrev_b32 v7, 3, v4
  s_barrier
  buffer_load_dwordx4 v[20:23], v38, s[32:35], s82 offen offset:0 sc1
  buffer_load_dwordx4 v[24:27], v38, s[32:35], s83 offen offset:0 sc1
  ds_read_b64_tr_b16 v[112:113], v44 offset:0
  ds_read_b64_tr_b16 v[114:115], v44 offset:4224
  ds_read_b64_tr_b16 v[116:117], v44 offset:34304
  ds_read_b64_tr_b16 v[118:119], v44 offset:38528
  ds_read_b64_tr_b16 v[120:121], v44 offset:32
  ds_read_b64_tr_b16 v[122:123], v44 offset:4256
  ds_read_b64_tr_b16 v[124:125], v44 offset:34336
  ds_read_b64_tr_b16 v[126:127], v44 offset:38560
  ds_read_b64_tr_b16 v[128:129], v44 offset:64
  ds_read_b64_tr_b16 v[130:131], v44 offset:4288
  ds_read_b64_tr_b16 v[132:133], v44 offset:34368
  ds_read_b64_tr_b16 v[134:135], v44 offset:38592
  s_waitcnt lgkmcnt(4)
  ds_read_b64_tr_b16 v[136:137], v44 offset:96
  ds_read_b64_tr_b16 v[138:139], v44 offset:4320
  ds_read_b64_tr_b16 v[140:141], v44 offset:34400
  ds_read_b64_tr_b16 v[142:143], v44 offset:38624
  s_waitcnt lgkmcnt(0)
  s_barrier
  s_mov_b64 s[60:61], -1
  s_waitcnt vmcnt(0)
  s_mov_b32 s100, 0
  s_branch L_gc_6
L_g_4:
  s_add_u32 s100, s100, 1
  s_cmp_gt_u32 s100, 100000
  s_cbranch_scc1 L_abort
  s_sleep 2
L_gf_5:
  s_mov_b64 exec, s[60:61]
  buffer_load_dwordx4 v[20:23], v38, s[32:35], s82 offen offset:0 sc1
  buffer_load_dwordx4 v[24:27], v38, s[32:35], s83 offen offset:0 sc1
  s_waitcnt vmcnt(0)
L_gc_6:
  s_mov_b64 exec, s[60:61]
  v_perm_b32 v92, v21, v20, s56
  v_perm_b32 v92, v22, v92, s57
  v_perm_b32 v92, v23, v92, s58
  v_cmp_ne_u32 s[60:61], s48, v92
  v_perm_b32 v92, v25, v24, s56
  v_perm_b32 v92, v26, v92, s57
  v_perm_b32 v92, v27, v92, s58
  v_cmp_ne_u32 vcc, s48, v92
  s_nop 0
  s_or_b64 s[60:61], s[60:61], vcc
  s_cmp_lg_u64 s[60:61], 0
  s_cbranch_scc1 L_g_4
  s_mov_b64 exec, -1
  v_permlane32_swap_b32 v20, v22
  v_permlane32_swap_b32 v21, v23
  v_permlane32_swap_b32 v24, v26
  v_permlane32_swap_b32 v25, v27
  v_add_f32 v20, v20, v22
  v_add_f32 v21, v21, v23
  v_add_f32 v24, v24, v26
  v_add_f32 v25, v25, v27
  v_permlane16_swap_b32 v20, v21
  s_nop 0
  v_permlane16_swap_b32 v24, v25
  v_add_f32 v20, v20, v21
  v_add_f32 v24, v24, v25
  v_cvt_pk_bf16_f32 v25, v24, v24
  v_and_b32 v24, 0xffff0000, v25
  v_cvt_pk_bf16_f32 v21, v20, v20
  v_and_b32 v20, 0xffff0000, v21
  v_add_f32 v24, 1.0, v24
  v_cvt_pk_bf16_f32 v25, v24, v24
  v_and_b32 v24, 0xffff0000, v25
  v_mul_f32 v24, v103, v24
  v_cvt_pk_bf16_f32 v25, v24, v24
  v_and_b32 v24, 0xffff0000, v25
  v_add_f32 v24, v24, v20
  v_cvt_pk_bf16_f32 v24, v24, v24
  ds_write_b16 v40, v24
  ds_read_b128 v[28:31], v41
  ds_read_b128 v[32:35], v41 offset:64
  s_waitcnt lgkmcnt(1)
  v_mfma_f32_16x16x32_bf16 v[80:83], v[112:115], v[28:31], 0
  v_mfma_f32_16x16x32_bf16 v[84:87], v[120:123], v[28:31], 0
  v_mfma_f32_16x16x32_bf16 v[88:91], v[128:131], v[28:31], 0
  v_mfma_f32_16x16x32_bf16 v[92:95], v[136:139], v[28:31], 0
  s_waitcnt lgkmcnt(0)
  v_mfma_f32_16x16x32_bf16 v[80:83], v[116:119], v[32:35], v[80:83]
  v_mfma_f32_16x16x32_bf16 v[84:87], v[124:127], v[32:35], v[84:87]
  v_mfma_f32_16x16x32_bf16 v[88:91], v[132:135], v[32:35], v[88:91]
  v_mfma_f32_16x16x32_bf16 v[92:95], v[140:143], v[32:35], v[92:95]
  s_nop 5
  v_cndmask_b32 v80, v80, v84, s[70:71]
  v_cndmask_b32 v81, v81, v85, s[70:71]
  v_cndmask_b32 v82, v82, v86, s[70:71]
  v_cndmask_b32 v83, v83, v87, s[70:71]
  v_cndmask_b32 v80, v80, v88, s[72:73]
  v_cndmask_b32 v81, v81, v89, s[72:73]
  v_cndmask_b32 v82, v82, v90, s[72:73]
  v_cndmask_b32 v83, v83, v91, s[72:73]
  v_cndmask_b32 v80, v80, v92, s[74:75]
  v_cndmask_b32 v81, v81, v93, s[74:75]
  v_cndmask_b32 v82, v82, v94, s[74:75]
  v_cndmask_b32 v83, v83, v95, s[74:75]
  v_and_or_b32 v80, v80, v2, s49
  v_and_or_b32 v81, v81, v2, s50
  v_and_or_b32 v82, v82, v2, s51
  v_and_or_b32 v83, v83, v2, s52
  s_mov_b32 exec_lo, 0xf000f
  s_mov_b32 exec_hi, 0xf000f
  buffer_store_dwordx4 v[80:83], v39, s[32:35], s85 offen
  s_add_u32 s97, s85, 0x100000
  buffer_store_dwordx4 v[80:83], v39, s[32:35], s97 offen sc1
  s_mov_b64 exec, -1
  s_barrier
  s_lshr_b32 s92, s3, 2
  s_lshl_b32 s93, s92, 12
  s_xor_b32 s93, s93, 0
  s_xor_b32 m0, s91, s93
  s_lshl_b32 s93, s92, 14
  s_xor_b32 s93, s93, 0
  s_xor_b32 s101, s90, s93
  buffer_load_dwordx4 v244, s[36:39], s101 offen offset:0 nt lds
  buffer_load_dwordx4 v245, s[36:39], s101 offen offset:1024 nt lds
  buffer_load_dwordx4 v246, s[36:39], s101 offen offset:2048 nt lds
  buffer_load_dwordx4 v247, s[36:39], s101 offen offset:3072 nt lds
  s_lshr_b32 s92, s3, 2
  s_lshl_b32 s93, s92, 12
  s_xor_b32 s93, s93, 32768
  s_xor_b32 m0, s91, s93
  s_lshl_b32 s93, s92, 14
  s_xor_b32 s93, s93, 256
  s_xor_b32 s101, s90, s93
  buffer_load_dwordx4 v244, s[36:39], s101 offen offset:0 nt lds
  buffer_load_dwordx4 v245, s[36:39], s101 offen offset:1024 nt lds
  buffer_load_dwordx4 v246, s[36:39], s101 offen offset:2048 nt lds
  buffer_load_dwordx4 v247, s[36:39], s101 offen offset:3072 nt lds
  s_lshr_b32 s92, s3, 2
  s_lshl_b32 s93, s92, 12
  s_xor_b32 s93, s93, 65536
  s_xor_b32 m0, s91, s93
  s_lshl_b32 s93, s92, 14
  s_xor_b32 s93, s93, 512
  s_xor_b32 s101, s90, s93
  buffer_load_dwordx4 v244, s[36:39], s101 offen offset:0 nt lds
  buffer_load_dwordx4 v245, s[36:39], s101 offen offset:1024 nt lds
  buffer_load_dwordx4 v246, s[36:39], s101 offen offset:2048 nt lds
  buffer_load_dwordx4 v247, s[36:39], s101 offen offset:3072 nt lds
  s_cmp_ge_u32 s3, 4
  s_cbranch_scc1 L_back
  s_barrier
  s_xor_b32 m0, s91, 98304
  s_xor_b32 s101, s90, 768
  buffer_load_dwordx4 v244, s[36:39], s101 offen offset:0 nt lds
  buffer_load_dwordx4 v245, s[36:39], s101 offen offset:1024 nt lds
  buffer_load_dwordx4 v246, s[36:39], s101 offen offset:2048 nt lds
  buffer_load_dwordx4 v247, s[36:39], s101 offen offset:3072 nt lds
  s_branch L_setup
L_K2:
  s_mov_b32 s54, 0x05040100
  s_mov_b32 s55, 0x07060302
  s_mov_b32 s56, 0x0c0c0400
  s_mov_b32 s57, 0x0c040100
  s_mov_b32 s58, 0x04020100
  s_mov_b32 s53, 0x10001
  v_mov_b32 v2, 0xffffff00
  s_lshr_b32 s77, s2, 5
  s_and_b32 s78, s2, 127
  s_and_b32 s76, s2, 7
  s_lshl_b32 s76, s76, 2
  s_bfe_u32 s97, s2, 0x20003
  s_add_u32 s76, s76, s97
  s_bfe_u32 s79, s2, 0x40003
  s_and_b32 s80, s2, 7
  s_bfe_u32 s17, s2, 0x20003
  s_bfe_u32 s59, s2, 0x10004
  s_lshl_b32 s59, s59, 14
  v_lshrrev_b32 v245, 4, v1
  v_and_b32 v246, 15, v1
  v_lshlrev_b32 v247, 2, v245
  v_xor_b32 v246, v246, v247
  v_lshlrev_b32 v246, 4, v246
  v_lshl_add_u32 v244, v245, 10, v246
  v_xor_b32 v245, 16, v244
  v_xor_b32 v246, 32, v244
  v_xor_b32 v247, 48, v244
  v_add_u32 v245, 3072, v245
  v_add_u32 v246, 6144, v246
  v_add_u32 v247, 9216, v247
  s_and_b32 s91, s3, 3
  s_lshl_b32 s90, s91, 15
  s_lshl_b32 s91, s91, 13
  s_lshl_b32 s92, s2, 17
  s_add_u32 s90, s90, s92
  s_bfe_u32 s93, s2, 0x20003
  s_lshl_b32 s92, s93, 15
  s_add_u32 s91, s91, s92
  s_lshl_b32 s92, s93, 8
  s_add_u32 s90, s90, s92
  s_mov_b64 s[36:37], s[6:7]
  s_mov_b32 s38, 0x2000000
  s_mov_b32 s39, 0x20000
  s_barrier
  s_lshr_b32 s92, s3, 2
  s_lshl_b32 s93, s92, 12
  s_xor_b32 s93, s93, 0
  s_xor_b32 m0, s91, s93
  s_lshl_b32 s93, s92, 14
  s_xor_b32 s93, s93, 0
  s_xor_b32 s101, s90, s93
  buffer_load_dwordx4 v244, s[36:39], s101 offen offset:0 nt lds
  buffer_load_dwordx4 v245, s[36:39], s101 offen offset:1024 nt lds
  buffer_load_dwordx4 v246, s[36:39], s101 offen offset:2048 nt lds
  buffer_load_dwordx4 v247, s[36:39], s101 offen offset:3072 nt lds
  s_lshr_b32 s92, s3, 2
  s_lshl_b32 s93, s92, 12
  s_xor_b32 s93, s93, 32768
  s_xor_b32 m0, s91, s93
  s_lshl_b32 s93, s92, 14
  s_xor_b32 s93, s93, 256
  s_xor_b32 s101, s90, s93
  buffer_load_dwordx4 v244, s[36:39], s101 offen offset:0 nt lds
  buffer_load_dwordx4 v245, s[36:39], s101 offen offset:1024 nt lds
  buffer_load_dwordx4 v246, s[36:39], s101 offen offset:2048 nt lds
  buffer_load_dwordx4 v247, s[36:39], s101 offen offset:3072 nt lds
  s_and_b32 s92, s3, 1
  s_lshl_b32 s92, s92, 15
  s_lshr_b32 s97, s3, 1
  s_lshl_b32 s97, s97, 8
  s_add_u32 s92, s92, s97
  s_add_u32 s92, s92, s81
  v_and_b32 v45, 15, v1
  v_mul_u32_u24 v45, 1040, v45
  v_add_u32 v45, s92, v45
  v_lshrrev_b32 v34, 4, v1
  v_lshlrev_b32 v34, 4, v34
  v_xor_b32 v45, v45, v34
  v_lshrrev_b32 v37, 4, v1
  v_lshlrev_b32 v37, 11, v37
  v_and_b32 v3, 15, v1
  v_lshl_add_u32 v37, v3, 4, v37
  s_and_b32 s83, s2, 7
  s_lshl_b32 s83, s83, 14
  s_lshl_b32 s97, s3, 8
  s_add_u32 s83, s83, s97
  s_add_u32 s83, s83, 0x80000
  s_add_u32 s85, s83, 8192
  s_lshl_b32 s92, s3, 7
  s_add_u32 s92, s92, 0x21000
  v_and_b32 v47, 15, v1
  v_lshlrev_b32 v47, 3, v47
  v_lshrrev_b32 v3, 4, v1
  v_lshl_add_u32 v47, v3, 1, v47
  v_add_u32 v47, s92, v47
  s_lshr_b32 s92, s3, 1
  s_lshl_b32 s92, s92, 8
  s_add_u32 s92, s92, 0x21000
  v_lshrrev_b32 v35, 4, v1
  v_lshlrev_b32 v35, 4, v35
  v_add_u32 v35, s92, v35
  v_bfe_u32 v39, v1, 4, 1
  v_lshlrev_b32 v39, 5, v39
  v_lshrrev_b32 v3, 5, v1
  v_lshl_add_u32 v39, v3, 4, v39
  s_and_b32 s84, s2, 7
  s_lshl_b32 s84, s84, 12
  s_lshr_b32 s97, s3, 1
  s_lshl_b32 s97, s97, 10
  s_add_u32 s84, s84, s97
  s_bfe_u32 s97, s2, 0x30003
  s_lshl_b32 s97, s97, 7
  s_add_u32 s84, s84, s97
  s_and_b32 s97, s3, 1
  s_lshl_b32 s97, s97, 6
  s_add_u32 s84, s84, s97
  s_add_u32 s84, s84, 0x10000
  s_waitcnt vmcnt(8)
  s_barrier
  v_xor_b32 v32, 0, v45
  ds_read_b128 v[112:115], v32 offset:0
  v_xor_b32 v33, 64, v45
  ds_read_b128 v[116:119], v33 offset:0
  v_xor_b32 v32, 128, v45
  ds_read_b128 v[120:123], v32 offset:0
  v_xor_b32 v33, 192, v45
  ds_read_b128 v[124:127], v33 offset:0
  v_xor_b32 v32, 0, v45
  ds_read_b128 v[128:131], v32 offset:16384
  v_xor_b32 v33, 64, v45
  ds_read_b128 v[132:135], v33 offset:16384
  v_xor_b32 v32, 128, v45
  ds_read_b128 v[136:139], v32 offset:16384
  v_xor_b32 v33, 192, v45
  ds_read_b128 v[140:143], v33 offset:16384
  s_waitcnt lgkmcnt(0)
  s_barrier
  s_mov_b32 s100, 0
  v_mov_b32 v253, 0
L_ep_8:
  global_load_dword v252, v253, s[30:31] sc1
  s_add_u32 s100, s100, 1
  s_cmp_gt_u32 s100, 100000
  s_cbranch_scc1 L_abort
  s_waitcnt vmcnt(0)
L_epc_9:
  v_readfirstlane_b32 s48, v252
  s_nop 0
  s_cmp_eq_u32 s48, 0
  s_nop 1
  s_cbranch_scc1 L_ep_8
  s_mul_i32 s48, s48, 0x9e3779b1
  s_and_b32 s49, s48, 0xff
  s_bfe_u32 s50, s48, 0x80008
  s_bfe_u32 s51, s48, 0x80010
  s_lshr_b32 s52, s48, 24
  s_lshr_b32 s97, s48, 15
  s_xor_b32 s97, s97, s48
  s_mul_i32 s97, s97, 0x85ebca6b
  v_mov_b32 v4, s48
  v_mov_b32 v5, s97
  v_mov_b32 v249, s48
  v_mov_b32 v250, s97
  v_and_b32 v6, 4, v1
  v_cmp_eq_u32 vcc, 0, v6
  v_and_b32 v7, 3, v1
  v_lshlrev_b32 v7, 2, v7
  v_cndmask_b32 v4, v5, v4, vcc
  v_lshrrev_b32 v4, v7, v4
  v_lshrrev_b32 v5, 1, v4
  v_lshrrev_b32 v6, 2, v4
  v_lshrrev_b32 v7, 3, v4
  s_and_b32 s92, s3, 1
  s_sub_u32 s74, 0, s92
  s_mov_b32 s75, s74
  v_bfe_u32 v28, v1, 4, 1
  v_lshlrev_b32 v28, 3, v28
  v_lshrrev_b32 v3, 5, v1
  v_lshl_add_u32 v28, v3, 2, v28
  v_mov_b32 v68, s48
  v_mov_b32 v69, s97
  v_cndmask_b32 v68, v68, v69, s[74:75]
  v_lshrrev_b32 v68, v28, v68
  v_lshrrev_b32 v69, 1, v68
  v_lshrrev_b32 v70, 2, v68
  v_lshrrev_b32 v71, 3, v68
  s_mov_b64 s[60:61], -1
  s_mov_b64 s[62:63], -1
  s_mov_b32 s100, 0
  s_branch L_gf_11
L_g_10:
  s_add_u32 s100, s100, 1
  s_cmp_gt_u32 s100, 100000
  s_cbranch_scc1 L_abort
  s_sleep 1
  s_cmp_lg_u32 s100, 40
  s_cbranch_scc1 L_alt_13
  s_add_u32 s83, s83, 0x100000
  s_add_u32 s85, s85, 0x100000
L_alt_13:
L_gf_11:
  s_mov_b64 exec, s[60:61]
  s_cbranch_execz L_gs_14
  buffer_load_dwordx4 v[20:23], v37, s[32:35], s83 offen offset:0 sc1
L_gs_14:
  s_mov_b64 exec, s[62:63]
  s_cbranch_execz L_gs_15
  buffer_load_dwordx4 v[24:27], v37, s[32:35], s85 offen offset:0 sc1
L_gs_15:
  s_waitcnt vmcnt(0)
L_gc_12:
  s_mov_b64 exec, s[60:61]
  v_perm_b32 v92, v21, v20, s56
  v_perm_b32 v92, v22, v92, s57
  v_perm_b32 v92, v23, v92, s58
  v_cmp_ne_u32 s[60:61], s48, v92
  s_mov_b64 exec, s[62:63]
  v_perm_b32 v92, v25, v24, s56
  v_perm_b32 v92, v26, v92, s57
  v_perm_b32 v92, v27, v92, s58
  v_cmp_ne_u32 s[62:63], s48, v92
  s_nop 0
  s_or_b64 s[96:97], s[60:61], s[62:63]
  s_cbranch_scc1 L_g_10
  s_mov_b64 exec, -1
  v_add_f32 v20, v20, v24
  v_add_f32 v21, v21, v25
  v_add_f32 v22, v22, v26
  v_add_f32 v23, v23, v27
  s_nop 0
  v_permlane32_swap_b32 v20, v22
  v_permlane32_swap_b32 v21, v23
  v_add_f32 v20, v20, v22
  v_add_f32 v21, v21, v23
  s_nop 1
  v_permlane16_swap_b32 v20, v21
  v_add_f32 v20, v20, v21
  v_cvt_pk_bf16_f32 v20, v20, v20
  ds_write_b16 v47, v20
  s_waitcnt lgkmcnt(0)
  s_barrier
  ds_read_b128 v[52:55], v35 offset:0
  ds_read_b128 v[56:59], v35 offset:64
  ds_read_b128 v[60:63], v35 offset:128
  ds_read_b128 v[64:67], v35 offset:192
  s_waitcnt lgkmcnt(3)
  v_mfma_f32_16x16x32_bf16 v[80:83], v[112:115], v[52:55], 0
  v_mfma_f32_16x16x32_bf16 v[84:87], v[128:131], v[52:55], 0
  s_waitcnt lgkmcnt(2)
  v_mfma_f32_16x16x32_bf16 v[80:83], v[116:119], v[56:59], v[80:83]
  v_mfma_f32_16x16x32_bf16 v[84:87], v[132:135], v[56:59], v[84:87]
  s_waitcnt lgkmcnt(1)
  v_mfma_f32_16x16x32_bf16 v[80:83], v[120:123], v[60:63], v[80:83]
  v_mfma_f32_16x16x32_bf16 v[84:87], v[136:139], v[60:63], v[84:87]
  s_waitcnt lgkmcnt(0)
  v_mfma_f32_16x16x32_bf16 v[80:83], v[124:127], v[64:67], v[80:83]
  v_mfma_f32_16x16x32_bf16 v[84:87], v[140:143], v[64:67], v[84:87]
  s_nop 6
  v_mul_f32 v80, 0x3e0293ee, v80
  v_mul_f32 v81, 0x3e0293ee, v81
  v_mul_f32 v82, 0x3e0293ee, v82
  v_mul_f32 v83, 0x3e0293ee, v83
  v_mul_f32 v84, 0x3e0293ee, v84
  v_mul_f32 v85, 0x3e0293ee, v85
  v_mul_f32 v86, 0x3e0293ee, v86
  v_mul_f32 v87, 0x3e0293ee, v87
  v_cvt_pk_bf16_f32 v20, v80, v81
  v_cvt_pk_bf16_f32 v21, v82, v83
  v_cvt_pk_bf16_f32 v22, v84, v85
  v_cvt_pk_bf16_f32 v23, v86, v87
  s_nop 0
  v_permlane16_swap_b32 v20, v22
  v_permlane16_swap_b32 v21, v23
  v_bfi_b32 v20, s53, v68, v20
  v_bfi_b32 v21, s53, v69, v21
  v_bfi_b32 v22, s53, v70, v22
  v_bfi_b32 v23, s53, v71, v23
  s_mov_b32 exec_lo, 0x10001
  s_mov_b32 exec_hi, 0x10001
  buffer_store_dwordx4 v[20:23], v39, s[32:35], s84 offen sc1
  s_mov_b64 exec, -1
  s_barrier
  s_lshr_b32 s92, s3, 2
  s_lshl_b32 s93, s92, 12
  s_xor_b32 s93, s93, 65536
  s_xor_b32 m0, s91, s93
  s_lshl_b32 s93, s92, 14
  s_xor_b32 s93, s93, 512
  s_xor_b32 s101, s90, s93
  buffer_load_dwordx4 v244, s[36:39], s101 offen offset:0 nt lds
  buffer_load_dwordx4 v245, s[36:39], s101 offen offset:1024 nt lds
  buffer_load_dwordx4 v246, s[36:39], s101 offen offset:2048 nt lds
  buffer_load_dwordx4 v247, s[36:39], s101 offen offset:3072 nt lds
  s_cmp_ge_u32 s3, 4
  s_cbranch_scc0 L_kf
  s_branch L_back
L_kf:
  s_xor_b32 m0, s91, 98304
  s_xor_b32 s101, s90, 768
  buffer_load_dwordx4 v244, s[36:39], s101 offen offset:0 nt lds
  buffer_load_dwordx4 v245, s[36:39], s101 offen offset:1024 nt lds
  buffer_load_dwordx4 v246, s[36:39], s101 offen offset:2048 nt lds
  buffer_load_dwordx4 v247, s[36:39], s101 offen offset:3072 nt lds
  s_barrier
  s_branch L_setup
L_Bback2:
  s_mov_b32 s54, 0x05040100
  s_mov_b32 s55, 0x07060302
  s_mov_b32 s56, 0x0c0c0400
  s_mov_b32 s57, 0x0c040100
  s_mov_b32 s58, 0x04020100
  s_mov_b32 s53, 0x10001
  v_mov_b32 v2, 0xffffff00
  s_lshr_b32 s77, s2, 5
  s_and_b32 s78, s2, 127
  s_and_b32 s76, s2, 7
  s_lshl_b32 s76, s76, 2
  s_bfe_u32 s97, s2, 0x20003
  s_add_u32 s76, s76, s97
  s_bfe_u32 s79, s2, 0x40003
  s_and_b32 s80, s2, 7
  s_bfe_u32 s17, s2, 0x20003
  s_bfe_u32 s59, s2, 0x10004
  s_lshl_b32 s59, s59, 14
  s_lshl_b32 s81, s95, 2
  s_add_u32 s81, s81, s94
  s_lshl_b32 s81, s81, 8
  s_add_u32 s81, s81, 0
  v_and_b32 v8, 7, v1
  v_lshlrev_b32 v8, 2, v8
  v_lshrrev_b32 v9, 4, v1
  v_add_u32 v8, v8, v9
  v_lshlrev_b32 v8, 5, v8
  s_lshl_b32 s92, s3, 2
  s_add_u32 s92, s92, 139248
  v_add_u32 v8, s92, v8
  v_lshlrev_b32 v9, 6, v1
  v_add_u32 v9, 139264, v9
  v_lshlrev_b32 v10, 4, v1
  s_bitcmp1_b32 s2, 6
  s_cbranch_scc1 L_nou0b
  s_waitcnt vmcnt(4)
  v_mov_b32 v253, 0
  global_load_dword v252, v253, s[30:31] sc1
  v_lshlrev_b32 v120, 16, v112
  v_and_b32 v121, 0xffff0000, v112
  v_lshlrev_b32 v122, 16, v113
  v_and_b32 v123, 0xffff0000, v113
  v_mul_f32 v116, 0xbfb8aa3b, v120
  v_mul_f32 v117, 0xbfb8aa3b, v121
  v_mul_f32 v118, 0xbfb8aa3b, v122
  v_mul_f32 v119, 0xbfb8aa3b, v123
  v_exp_f32 v116, v116
  v_exp_f32 v117, v117
  v_exp_f32 v118, v118
  v_exp_f32 v119, v119
  v_add_f32 v116, 1.0, v116
  v_add_f32 v117, 1.0, v117
  v_add_f32 v118, 1.0, v118
  v_add_f32 v119, 1.0, v119
  v_rcp_f32 v116, v116
  v_rcp_f32 v117, v117
  v_rcp_f32 v118, v118
  v_rcp_f32 v119, v119
  v_mul_f32 v120, v120, v116
  v_mul_f32 v121, v121, v117
  v_mul_f32 v122, v122, v118
  v_mul_f32 v123, v123, v119
  v_cvt_pk_bf16_f32 v120, v120, v120
  v_cvt_pk_bf16_f32 v121, v121, v121
  v_cvt_pk_bf16_f32 v122, v122, v122
  v_cvt_pk_bf16_f32 v123, v123, v123
  v_lshrrev_b32 v116, 16, v120
  v_lshrrev_b32 v117, 16, v121
  v_lshrrev_b32 v118, 16, v122
  v_lshrrev_b32 v119, 16, v123
  v_and_b32 v120, 0xffff0000, v120
  v_and_b32 v121, 0xffff0000, v121
  v_and_b32 v122, 0xffff0000, v122
  v_and_b32 v123, 0xffff0000, v123
  v_mov_b32 v96, 0
  v_mov_b32 v97, 0
  v_mov_b32 v98, 0
  v_mov_b32 v99, 0
  v_mov_b32 v100, 0
  v_mov_b32 v101, 0
  v_mov_b32 v102, 0
  v_mov_b32 v103, 0
  s_waitcnt vmcnt(4)
  v_dot2c_f32_bf16 v96, v116, v124
  v_dot2c_f32_bf16 v97, v120, v124
  v_dot2c_f32_bf16 v98, v116, v125
  v_dot2c_f32_bf16 v99, v120, v125
  v_dot2c_f32_bf16 v100, v116, v126
  v_dot2c_f32_bf16 v101, v120, v126
  v_dot2c_f32_bf16 v102, v116, v127
  v_dot2c_f32_bf16 v103, v120, v127
  s_waitcnt vmcnt(3)
  v_dot2c_f32_bf16 v96, v117, v128
  v_dot2c_f32_bf16 v97, v121, v128
  v_dot2c_f32_bf16 v98, v117, v129
  v_dot2c_f32_bf16 v99, v121, v129
  v_dot2c_f32_bf16 v100, v117, v130
  v_dot2c_f32_bf16 v101, v121, v130
  v_dot2c_f32_bf16 v102, v117, v131
  v_dot2c_f32_bf16 v103, v121, v131
  s_waitcnt vmcnt(2)
  v_dot2c_f32_bf16 v96, v118, v132
  v_dot2c_f32_bf16 v97, v122, v132
  v_dot2c_f32_bf16 v98, v118, v133
  v_dot2c_f32_bf16 v99, v122, v133
  v_dot2c_f32_bf16 v100, v118, v134
  v_dot2c_f32_bf16 v101, v122, v134
  v_dot2c_f32_bf16 v102, v118, v135
  v_dot2c_f32_bf16 v103, v122, v135
  s_waitcnt vmcnt(1)
  v_dot2c_f32_bf16 v96, v119, v136
  v_dot2c_f32_bf16 v97, v123, v136
  v_dot2c_f32_bf16 v98, v119, v137
  v_dot2c_f32_bf16 v99, v123, v137
  v_dot2c_f32_bf16 v100, v119, v138
  v_dot2c_f32_bf16 v101, v123, v138
  v_dot2c_f32_bf16 v102, v119, v139
  v_dot2c_f32_bf16 v103, v123, v139
  v_permlane32_swap_b32 v96, v100
  v_permlane32_swap_b32 v97, v101
  v_permlane32_swap_b32 v98, v102
  v_permlane32_swap_b32 v99, v103
  v_add_f32 v96, v96, v100
  v_add_f32 v97, v97, v101
  v_add_f32 v98, v98, v102
  v_add_f32 v99, v99, v103
  s_nop 0
  v_permlane16_swap_b32 v96, v98
  v_permlane16_swap_b32 v97, v99
  v_add_f32 v96, v96, v98
  v_add_f32 v97, v97, v99
  s_nop 0
  v_add_f32_dpp v96, v96, v96 row_ror:8 row_mask:0xf bank_mask:0xf
  v_add_f32_dpp v97, v97, v97 row_ror:8 row_mask:0xf bank_mask:0xf
  s_mov_b32 s100, 0
  s_waitcnt vmcnt(0)
  s_branch L_epc_17
L_ep_16:
  global_load_dword v252, v253, s[30:31] sc1
  s_add_u32 s100, s100, 1
  s_cmp_gt_u32 s100, 100000
  s_cbranch_scc1 L_abort
  s_waitcnt vmcnt(0)
L_epc_17:
  v_readfirstlane_b32 s48, v252
  s_nop 0
  s_cmp_eq_u32 s48, 0
  s_nop 1
  s_cbranch_scc1 L_ep_16
  s_mul_i32 s48, s48, 0x9e3779b1
  s_and_b32 s49, s48, 0xff
  s_bfe_u32 s50, s48, 0x80008
  s_bfe_u32 s51, s48, 0x80010
  s_lshr_b32 s52, s48, 24
  ds_write2_b32 v8, v96, v97 offset0:0 offset1:4
  s_waitcnt lgkmcnt(0)
  s_barrier
  s_cmp_lg_u32 s3, 4
  s_cbranch_scc1 L_nopub_18
  s_mov_b64 exec, 0xffff
  ds_read_b128 v[124:127], v9 offset:0
  ds_read_b128 v[128:131], v9 offset:16
  ds_read_b128 v[132:135], v9 offset:32
  ds_read_b128 v[136:139], v9 offset:48
  s_waitcnt lgkmcnt(3)
  v_add_f32 v124, v124, v125
  v_add_f32 v126, v126, v127
  v_add_f32 v124, v124, v126
  s_waitcnt lgkmcnt(2)
  v_add_f32 v128, v128, v129
  v_add_f32 v130, v130, v131
  v_add_f32 v128, v128, v130
  s_waitcnt lgkmcnt(1)
  v_add_f32 v132, v132, v133
  v_add_f32 v134, v134, v135
  v_add_f32 v132, v132, v134
  s_waitcnt lgkmcnt(0)
  v_add_f32 v136, v136, v137
  v_add_f32 v138, v138, v139
  v_add_f32 v136, v136, v138
  v_and_or_b32 v100, v124, v2, s49
  v_and_or_b32 v101, v128, v2, s50
  v_and_or_b32 v102, v132, v2, s51
  v_and_or_b32 v103, v136, v2, s52
  buffer_store_dwordx4 v[100:103], v10, s[32:35], s81 offen sc1
L_nopub_18:
  s_mov_b64 exec, -1
  s_barrier
  s_branch L_nou0c
L_nou0b:
  v_lshlrev_b32 v12, 7, v1
  v_lshlrev_b32 v14, 9, v1
  s_bfe_u32 s93, s2, 0x30003
  s_and_b32 s94, s2, 7
  s_cmp_lg_u32 s3, 4
  s_cbranch_scc1 L_ew5
  s_mov_b32 exec_hi, 0
  s_lshl_b32 s92, s93, 12
  s_add_u32 s92, s92, 0x10000
  buffer_load_dword v254, v12, s[32:35], s92 offen sc1
  s_lshl_b32 s92, s93, 14
  s_lshr_b32 s97, s94, 1
  s_lshl_b32 s97, s97, 7
  s_add_u32 s92, s92, s97
  s_add_u32 s92, s92, 0x20000
  buffer_load_dword v254, v14, s[32:35], s92 offen sc1
  s_mov_b32 exec_lo, 0xffff
  s_lshl_b32 s92, s94, 14
  s_lshl_b32 s97, s93, 11
  s_add_u32 s92, s92, s97
  s_add_u32 s92, s92, 0x80000
  buffer_load_dword v254, v12, s[32:35], s92 offen sc1
  s_lshl_b32 s92, s94, 11
  s_add_u32 s92, s92, 0x18000
  buffer_load_dword v254, v12, s[32:35], s92 offen sc1
  s_lshl_b32 s92, s93, 11
  buffer_load_dword v254, v12, s[32:35], s92 offen sc1
  s_branch L_ewx
L_ew5:
  s_cmp_lg_u32 s3, 5
  s_cbranch_scc1 L_ew6
  s_mov_b32 exec_hi, 0
  s_min_u32 s95, s93, 6
  s_mul_i32 s92, s94, 28672
  s_lshl_b32 s97, s95, 12
  s_add_u32 s92, s92, s97
  s_add_u32 s92, s92, 0xd0000
  buffer_load_dword v254, v12, s[32:35], s92 offen sc1
  s_branch L_ewx
L_ew6:
  s_cmp_lg_u32 s3, 6
  s_cbranch_scc1 L_ew7
  s_mov_b32 exec_hi, 0
  s_cmp_lg_u32 s94, 0
  s_cbranch_scc1 L_ewx
  s_mul_i32 s92, s93, 8448
  s_add_u32 s92, s92, 0x60000
  buffer_load_dword v254, v12, s[32:35], s92 offen sc1
  s_add_u32 s92, s92, 4224
  buffer_load_dword v254, v12, s[32:35], s92 offen sc1
  s_branch L_ewx
L_ew7:
  s_cmp_ge_u32 s93, 4
  s_cbranch_scc1 L_ew7b
  s_mov_b32 exec_hi, 0
  s_lshl_b32 s92, s94, 14
  s_lshl_b32 s97, s93, 12
  s_add_u32 s92, s92, s97
  s_add_u32 s92, s92, 0x40000
  buffer_load_dword v254, v12, s[32:35], s92 offen sc1
  s_branch L_ewx
L_ew7b:
  s_mul_i32 s92, s94, 8448
  s_and_b32 s97, s93, 1
  s_mul_i32 s97, s97, 67584
  s_add_u32 s92, s92, s97
  s_add_u32 s92, s92, 0xa0000
  buffer_load_dword v254, v12, s[32:35], s92 offen sc1
L_ewx:
  s_mov_b64 exec, -1
  s_barrier
  s_barrier
  s_mov_b32 s100, 0
  v_mov_b32 v253, 0
L_ep_19:
  global_load_dword v252, v253, s[30:31] sc1
  s_add_u32 s100, s100, 1
  s_cmp_gt_u32 s100, 100000
  s_cbranch_scc1 L_abort
  s_waitcnt vmcnt(0)
L_epc_20:
  v_readfirstlane_b32 s48, v252
  s_nop 0
  s_cmp_eq_u32 s48, 0
  s_nop 1
  s_cbranch_scc1 L_ep_19
  s_mul_i32 s48, s48, 0x9e3779b1
  s_and_b32 s49, s48, 0xff
  s_bfe_u32 s50, s48, 0x80008
  s_bfe_u32 s51, s48, 0x80010
  s_lshr_b32 s52, s48, 24
L_nou0c:
  s_lshr_b32 s97, s48, 15
  s_xor_b32 s97, s97, s48
  s_mul_i32 s97, s97, 0x85ebca6b
  v_mov_b32 v4, s48
  v_mov_b32 v5, s97
  v_mov_b32 v249, s48
  v_mov_b32 v250, s97
  v_and_b32 v6, 4, v1
  v_cmp_eq_u32 vcc, 0, v6
  v_and_b32 v7, 3, v1
  v_lshlrev_b32 v7, 2, v7
  v_cndmask_b32 v4, v5, v4, vcc
  v_lshrrev_b32 v4, v7, v4
  v_lshrrev_b32 v5, 1, v4
  v_lshrrev_b32 v6, 2, v4
  v_lshrrev_b32 v7, 3, v4
  v_lshrrev_b32 v245, 4, v1
  v_and_b32 v246, 15, v1
  v_lshlrev_b32 v247, 2, v245
  v_xor_b32 v246, v246, v247
  v_lshlrev_b32 v246, 4, v246
  v_lshl_add_u32 v244, v245, 10, v246
  v_xor_b32 v245, 16, v244
  v_xor_b32 v246, 32, v244
  v_xor_b32 v247, 48, v244
  v_add_u32 v245, 3072, v245
  v_add_u32 v246, 6144, v246
  v_add_u32 v247, 9216, v247
  s_and_b32 s91, s3, 3
  s_lshl_b32 s90, s91, 15
  s_lshl_b32 s91, s91, 13
  s_lshl_b32 s92, s2, 17
  s_add_u32 s90, s90, s92
  s_bfe_u32 s93, s2, 0x20003
  s_lshl_b32 s92, s93, 15
  s_add_u32 s91, s91, s92
  s_lshl_b32 s92, s93, 8
  s_add_u32 s90, s90, s92
  s_mov_b64 s[36:37], s[6:7]
  s_mov_b32 s38, 0x2000000
  s_mov_b32 s39, 0x20000
  v_lshlrev_b32 v12, 21, v1
  v_add_u32 v12, 0xf000, v12
  s_mov_b64 exec, 0x3f
  buffer_load_dword v254, v12, s[32:35], 0 offen
  s_mov_b64 exec, -1
  s_and_b32 s81, s3, 3
  s_lshl_b32 s81, s81, 13
  s_add_u32 s81, s81, 0x10000
  v_lshlrev_b32 v8, 4, v1
  s_add_u32 s82, s81, 4096
  v_lshrrev_b32 v9, 4, v1
  v_lshlrev_b32 v9, 13, v9
  v_and_b32 v3, 15, v1
  v_lshl_add_u32 v9, v3, 4, v9
  s_and_b32 s93, s3, 3
  s_lshl_b32 s93, s93, 11
  s_and_b32 s97, s3, 1
  s_lshl_b32 s97, s97, 5
  s_add_u32 s93, s93, s97
  s_add_u32 s93, s93, 0x20000
  v_xor_b32 v9, s93, v9
  s_xor_b32 m0, s91, 4096
  s_xor_b32 s101, s90, 16384
  buffer_load_dwordx4 v244, s[36:39], s101 offen offset:0 nt lds
  s_waitcnt vmcnt(0)
  buffer_load_dwordx4 v245, s[36:39], s101 offen offset:1024 nt lds
  s_waitcnt vmcnt(2)
  buffer_load_dwordx4 v246, s[36:39], s101 offen offset:2048 nt lds
  s_waitcnt vmcnt(2)
  buffer_load_dwordx4 v247, s[36:39], s101 offen offset:3072 nt lds
  s_waitcnt vmcnt(2)
  s_xor_b32 m0, s91, 36864
  s_xor_b32 s101, s90, 16640
  buffer_load_dwordx4 v244, s[36:39], s101 offen offset:0 nt lds
  s_waitcnt vmcnt(2)
  buffer_load_dwordx4 v245, s[36:39], s101 offen offset:1024 nt lds
  s_waitcnt vmcnt(2)
  buffer_load_dwordx4 v246, s[36:39], s101 offen offset:2048 nt lds
  s_waitcnt vmcnt(2)
  buffer_load_dwordx4 v247, s[36:39], s101 offen offset:3072 nt lds
  s_waitcnt vmcnt(2)
  s_xor_b32 m0, s91, 69632
  s_xor_b32 s101, s90, 16896
  buffer_load_dwordx4 v244, s[36:39], s101 offen offset:0 nt lds
  buffer_load_dwordx4 v245, s[36:39], s101 offen offset:1024 nt lds
  buffer_load_dwordx4 v246, s[36:39], s101 offen offset:2048 nt lds
  buffer_load_dwordx4 v247, s[36:39], s101 offen offset:3072 nt lds
  s_mov_b64 s[40:41], s[26:27]
  s_mov_b32 s42, 0x300000
  s_mov_b32 s43, 0x20000
  v_lshrrev_b32 v13, 3, v1
  v_mul_u32_u24 v13, 24576, v13
  v_and_b32 v3, 7, v1
  v_lshl_add_u32 v13, v3, 4, v13
  s_lshr_b32 s94, s78, 5
  s_lshl_b32 s94, s94, 2
  s_and_b32 s97, s3, 3
  s_add_u32 s94, s94, s97
  s_lshl_b32 s95, s94, 6
  v_lshrrev_b32 v14, 3, v1
  v_lshlrev_b32 v14, 3, v14
  v_add_u32 v14, s95, v14
  s_mul_i32 s92, s94, 196608
  s_and_b32 s97, s2, 31
  s_lshl_b32 s97, s97, 7
  s_add_u32 s92, s92, s97
  s_add_u32 s92, s92, 0x800
  global_load_dwordx2 v[144:145], v14, s[24:25]
  buffer_load_dwordx4 v[128:131], v13, s[40:43], s92 offen nt
  s_add_u32 s92, s92, 6144
  buffer_load_dwordx4 v[132:135], v13, s[40:43], s92 offen nt
  s_add_u32 s92, s92, 6144
  buffer_load_dwordx4 v[136:139], v13, s[40:43], s92 offen nt
  s_add_u32 s92, s92, 6144
  buffer_load_dwordx4 v[140:143], v13, s[40:43], s92 offen nt
  v_lshrrev_b32 v253, 4, v1
  v_lshlrev_b32 v253, 13, v253
  v_and_b32 v3, 15, v1
  v_lshl_add_u32 v253, v3, 4, v253
  s_lshl_b32 s88, s77, 19
  s_bfe_u32 s97, s3, 0x10001
  s_lshl_b32 s97, s97, 18
  s_add_u32 s88, s88, s97
  s_and_b32 s97, s3, 1
  s_lshl_b32 s97, s97, 15
  s_add_u32 s88, s88, s97
  s_lshl_b32 s97, s76, 8
  s_add_u32 s88, s88, s97
  v_lshrrev_b32 v251, 5, v1
  v_mul_u32_u24 v251, 3584, v251
  v_and_b32 v3, 31, v1
  v_lshl_add_u32 v251, v3, 4, v251
  s_mul_i32 s89, s79, 114688
  s_and_b32 s97, s3, 3
  s_mul_i32 s97, s97, 28672
  s_add_u32 s89, s89, s97
  s_mul_i32 s97, s80, 448
  s_add_u32 s89, s89, s97
  s_barrier
  s_branch L_back1
L_back:
  v_lshlrev_b32 v12, 21, v1
  v_add_u32 v12, 0xf000, v12
  s_mov_b64 exec, 0x3f
  buffer_load_dword v254, v12, s[32:35], 0 offen
  s_mov_b64 exec, -1
  s_and_b32 s81, s3, 3
  s_lshl_b32 s81, s81, 13
  s_add_u32 s81, s81, 0x10000
  v_lshlrev_b32 v8, 4, v1
  s_add_u32 s82, s81, 4096
  v_lshrrev_b32 v9, 4, v1
  v_lshlrev_b32 v9, 13, v9
  v_and_b32 v3, 15, v1
  v_lshl_add_u32 v9, v3, 4, v9
  s_and_b32 s93, s3, 3
  s_lshl_b32 s93, s93, 11
  s_and_b32 s97, s3, 1
  s_lshl_b32 s97, s97, 5
  s_add_u32 s93, s93, s97
  s_add_u32 s93, s93, 0x20000
  v_xor_b32 v9, s93, v9
  v_lshrrev_b32 v253, 4, v1
  v_lshlrev_b32 v253, 13, v253
  v_and_b32 v3, 15, v1
  v_lshl_add_u32 v253, v3, 4, v253
  s_lshl_b32 s88, s77, 19
  s_bfe_u32 s97, s3, 0x10001
  s_lshl_b32 s97, s97, 18
  s_add_u32 s88, s88, s97
  s_and_b32 s97, s3, 1
  s_lshl_b32 s97, s97, 15
  s_add_u32 s88, s88, s97
  s_lshl_b32 s97, s76, 8
  s_add_u32 s88, s88, s97
  v_lshrrev_b32 v251, 4, v1
  v_lshlrev_b32 v251, 10, v251
  v_and_b32 v3, 15, v1
  v_lshl_add_u32 v251, v3, 4, v251
  s_lshl_b32 s89, s76, 17
  s_and_b32 s97, s3, 3
  s_lshl_b32 s97, s97, 15
  s_add_u32 s89, s89, s97
  s_lshl_b32 s97, s77, 8
  s_add_u32 s89, s89, s97
  s_barrier
L_back1:
  buffer_load_dwordx4 v[48:51], v8, s[32:35], s81 offen offset:0 sc1
  buffer_load_dwordx4 v[52:55], v8, s[32:35], s81 offen offset:1024 sc1
  buffer_load_dwordx4 v[56:59], v8, s[32:35], s81 offen offset:2048 sc1
  buffer_load_dwordx4 v[60:63], v8, s[32:35], s81 offen offset:3072 sc1
  buffer_load_dwordx4 v[64:67], v8, s[32:35], s82 offen offset:0 sc1
  buffer_load_dwordx4 v[68:71], v8, s[32:35], s82 offen offset:1024 sc1
  buffer_load_dwordx4 v[72:75], v8, s[32:35], s82 offen offset:2048 sc1
  buffer_load_dwordx4 v[76:79], v8, s[32:35], s82 offen offset:3072 sc1
  s_xor_b32 m0, s91, 102400
  s_xor_b32 s101, s90, 17152
  buffer_load_dwordx4 v244, s[36:39], s101 offen offset:0 nt lds
  buffer_load_dwordx4 v245, s[36:39], s101 offen offset:1024 nt lds
  buffer_load_dwordx4 v246, s[36:39], s101 offen offset:2048 nt lds
  buffer_load_dwordx4 v247, s[36:39], s101 offen offset:3072 nt lds
  s_branch L_setup
L_back2:
  s_mov_b64 s[60:61], -1
  s_mov_b64 s[62:63], -1
  s_mov_b64 s[64:65], -1
  s_mov_b64 s[66:67], -1
  s_mov_b64 s[68:69], -1
  s_mov_b64 s[70:71], -1
  s_mov_b64 s[72:73], -1
  s_mov_b64 s[74:75], -1
  s_waitcnt vmcnt(4)
  s_mov_b32 s100, 0
  s_branch L_gc_23
L_g_21:
  s_add_u32 s100, s100, 1
  s_cmp_gt_u32 s100, 100000
  s_cbranch_scc1 L_abort
  s_mov_b32 s92, 0
  s_cmp_lg_u32 s74, 0
  s_cselect_b32 s92, 7168, s92
  s_cmp_lg_u32 s72, 0
  s_cselect_b32 s92, 6144, s92
  s_cmp_lg_u32 s70, 0
  s_cselect_b32 s92, 5120, s92
  s_cmp_lg_u32 s68, 0
  s_cselect_b32 s92, 4096, s92
  s_cmp_lg_u32 s66, 0
  s_cselect_b32 s92, 3072, s92
  s_cmp_lg_u32 s64, 0
  s_cselect_b32 s92, 2048, s92
  s_cmp_lg_u32 s62, 0
  s_cselect_b32 s92, 1024, s92
  s_cmp_lg_u32 s60, 0
  s_cselect_b32 s92, 0, s92
  s_add_u32 s92, s92, s81
  s_mov_b64 exec, -1
L_qg_24:
  buffer_load_dwordx4 v[16:19], v8, s[32:35], s92 offen sc1
  s_add_u32 s100, s100, 1
  s_cmp_gt_u32 s100, 100000
  s_cbranch_scc1 L_abort
  s_waitcnt vmcnt(0)
  v_xor_b32 v16, v16, v4
  v_bitop3_b32 v16, v17, v5, v16 bitop3:0xbe
  v_bitop3_b32 v16, v18, v6, v16 bitop3:0xbe
  v_bitop3_b32 v16, v19, v7, v16 bitop3:0xbe
  v_and_b32 v16, s53, v16
  v_cmp_ne_u32 vcc, 0, v16
  s_nop 0
  s_cbranch_vccz L_qg_24x
  s_sleep 4
  s_branch L_qg_24
L_qg_24x:
L_gf_22:
  s_mov_b64 exec, s[60:61]
  s_cbranch_execz L_gs_25
  buffer_load_dwordx4 v[48:51], v8, s[32:35], s81 offen offset:0 sc1
L_gs_25:
  s_mov_b64 exec, s[62:63]
  s_cbranch_execz L_gs_26
  buffer_load_dwordx4 v[52:55], v8, s[32:35], s81 offen offset:1024 sc1
L_gs_26:
  s_mov_b64 exec, s[64:65]
  s_cbranch_execz L_gs_27
  buffer_load_dwordx4 v[56:59], v8, s[32:35], s81 offen offset:2048 sc1
L_gs_27:
  s_mov_b64 exec, s[66:67]
  s_cbranch_execz L_gs_28
  buffer_load_dwordx4 v[60:63], v8, s[32:35], s81 offen offset:3072 sc1
L_gs_28:
  s_mov_b64 exec, s[68:69]
  s_cbranch_execz L_gs_29
  buffer_load_dwordx4 v[64:67], v8, s[32:35], s82 offen offset:0 sc1
L_gs_29:
  s_mov_b64 exec, s[70:71]
  s_cbranch_execz L_gs_30
  buffer_load_dwordx4 v[68:71], v8, s[32:35], s82 offen offset:1024 sc1
L_gs_30:
  s_mov_b64 exec, s[72:73]
  s_cbranch_execz L_gs_31
  buffer_load_dwordx4 v[72:75], v8, s[32:35], s82 offen offset:2048 sc1
L_gs_31:
  s_mov_b64 exec, s[74:75]
  s_cbranch_execz L_gs_32
  buffer_load_dwordx4 v[76:79], v8, s[32:35], s82 offen offset:3072 sc1
L_gs_32:
  s_waitcnt vmcnt(0)
L_gc_23:
  s_mov_b64 exec, s[60:61]
  v_xor_b32 v44, v48, v4
  v_bitop3_b32 v44, v49, v5, v44 bitop3:0xbe
  v_bitop3_b32 v44, v50, v6, v44 bitop3:0xbe
  v_bitop3_b32 v44, v51, v7, v44 bitop3:0xbe
  v_and_b32 v44, s53, v44
  v_cmp_ne_u32 s[60:61], 0, v44
  s_nop 0
  s_cmp_lg_u64 s[60:61], 0
  s_cselect_b64 s[60:61], -1, 0
  s_mov_b64 exec, s[62:63]
  v_xor_b32 v44, v52, v4
  v_bitop3_b32 v44, v53, v5, v44 bitop3:0xbe
  v_bitop3_b32 v44, v54, v6, v44 bitop3:0xbe
  v_bitop3_b32 v44, v55, v7, v44 bitop3:0xbe
  v_and_b32 v44, s53, v44
  v_cmp_ne_u32 s[62:63], 0, v44
  s_nop 0
  s_cmp_lg_u64 s[62:63], 0
  s_cselect_b64 s[62:63], -1, 0
  s_mov_b64 exec, s[64:65]
  v_xor_b32 v44, v56, v4
  v_bitop3_b32 v44, v57, v5, v44 bitop3:0xbe
  v_bitop3_b32 v44, v58, v6, v44 bitop3:0xbe
  v_bitop3_b32 v44, v59, v7, v44 bitop3:0xbe
  v_and_b32 v44, s53, v44
  v_cmp_ne_u32 s[64:65], 0, v44
  s_nop 0
  s_cmp_lg_u64 s[64:65], 0
  s_cselect_b64 s[64:65], -1, 0
  s_mov_b64 exec, s[66:67]
  v_xor_b32 v44, v60, v4
  v_bitop3_b32 v44, v61, v5, v44 bitop3:0xbe
  v_bitop3_b32 v44, v62, v6, v44 bitop3:0xbe
  v_bitop3_b32 v44, v63, v7, v44 bitop3:0xbe
  v_and_b32 v44, s53, v44
  v_cmp_ne_u32 s[66:67], 0, v44
  s_nop 0
  s_cmp_lg_u64 s[66:67], 0
  s_cselect_b64 s[66:67], -1, 0
  s_mov_b64 exec, s[68:69]
  v_xor_b32 v44, v64, v4
  v_bitop3_b32 v44, v65, v5, v44 bitop3:0xbe
  v_bitop3_b32 v44, v66, v6, v44 bitop3:0xbe
  v_bitop3_b32 v44, v67, v7, v44 bitop3:0xbe
  v_and_b32 v44, s53, v44
  v_cmp_ne_u32 s[68:69], 0, v44
  s_nop 0
  s_cmp_lg_u64 s[68:69], 0
  s_cselect_b64 s[68:69], -1, 0
  s_mov_b64 exec, s[70:71]
  v_xor_b32 v44, v68, v4
  v_bitop3_b32 v44, v69, v5, v44 bitop3:0xbe
  v_bitop3_b32 v44, v70, v6, v44 bitop3:0xbe
  v_bitop3_b32 v44, v71, v7, v44 bitop3:0xbe
  v_and_b32 v44, s53, v44
  v_cmp_ne_u32 s[70:71], 0, v44
  s_nop 0
  s_cmp_lg_u64 s[70:71], 0
  s_cselect_b64 s[70:71], -1, 0
  s_mov_b64 exec, s[72:73]
  v_xor_b32 v44, v72, v4
  v_bitop3_b32 v44, v73, v5, v44 bitop3:0xbe
  v_bitop3_b32 v44, v74, v6, v44 bitop3:0xbe
  v_bitop3_b32 v44, v75, v7, v44 bitop3:0xbe
  v_and_b32 v44, s53, v44
  v_cmp_ne_u32 s[72:73], 0, v44
  s_nop 0
  s_cmp_lg_u64 s[72:73], 0
  s_cselect_b64 s[72:73], -1, 0
  s_mov_b64 exec, s[74:75]
  v_xor_b32 v44, v76, v4
  v_bitop3_b32 v44, v77, v5, v44 bitop3:0xbe
  v_bitop3_b32 v44, v78, v6, v44 bitop3:0xbe
  v_bitop3_b32 v44, v79, v7, v44 bitop3:0xbe
  v_and_b32 v44, s53, v44
  v_cmp_ne_u32 s[74:75], 0, v44
  s_nop 0
  s_cmp_lg_u64 s[74:75], 0
  s_cselect_b64 s[74:75], -1, 0
  s_or_b64 s[96:97], s[60:61], s[62:63]
  s_or_b64 s[96:97], s[96:97], s[64:65]
  s_or_b64 s[96:97], s[96:97], s[66:67]
  s_or_b64 s[96:97], s[96:97], s[68:69]
  s_or_b64 s[96:97], s[96:97], s[70:71]
  s_or_b64 s[96:97], s[96:97], s[72:73]
  s_or_b64 s[96:97], s[96:97], s[74:75]
  s_cbranch_scc1 L_g_21
  s_mov_b64 exec, -1
  s_mov_b32 s101, 0
  v_xor_b32 v10, 0, v9
  ds_write_b128 v10, v[48:51] offset:0
  v_xor_b32 v11, 64, v9
  ds_write_b128 v11, v[52:55] offset:256
  v_xor_b32 v10, 128, v9
  ds_write_b128 v10, v[56:59] offset:512
  v_xor_b32 v11, 192, v9
  ds_write_b128 v11, v[60:63] offset:768
  v_xor_b32 v10, 16, v9
  ds_write_b128 v10, v[64:67] offset:1024
  v_xor_b32 v11, 80, v9
  ds_write_b128 v11, v[68:71] offset:1280
  v_xor_b32 v10, 144, v9
  ds_write_b128 v10, v[72:75] offset:1536
  v_xor_b32 v11, 208, v9
  ds_write_b128 v11, v[76:79] offset:1792
  s_mov_b64 s[40:41], s[14:15]
  s_mov_b32 s42, 0x400000
  s_mov_b32 s43, 0x20000
  s_mov_b64 s[44:45], s[12:13]
  s_mov_b32 s46, 0x400000
  s_mov_b32 s47, 0x20000
  s_waitcnt lgkmcnt(0)
  s_setprio 3
  s_barrier
  s_cmp_lt_u32 s2, 128
  s_cbranch_scc0 L_lwB
  s_cmp_lg_u32 s101, 0
  s_cbranch_scc1 L_lwX
  buffer_load_dwordx4 v[176:179], v253, s[44:47], s88 offen nt
  s_add_u32 s88, s88, 65536
  buffer_load_dwordx4 v[180:183], v253, s[44:47], s88 offen nt
  s_add_u32 s88, s88, 65536
  buffer_load_dwordx4 v[184:187], v253, s[44:47], s88 offen nt
  s_add_u32 s88, s88, 65536
  buffer_load_dwordx4 v[188:191], v253, s[44:47], s88 offen nt
  buffer_load_dwordx4 v[208:211], v251, s[40:43], s89 offen nt
  s_add_u32 s89, s89, 4096
  buffer_load_dwordx4 v[212:215], v251, s[40:43], s89 offen nt
  s_add_u32 s89, s89, 4096
  buffer_load_dwordx4 v[216:219], v251, s[40:43], s89 offen nt
  s_add_u32 s89, s89, 4096
  buffer_load_dwordx4 v[220:223], v251, s[40:43], s89 offen nt
  s_add_u32 s89, s89, 4096
  buffer_load_dwordx4 v[224:227], v251, s[40:43], s89 offen nt
  s_add_u32 s89, s89, 4096
  buffer_load_dwordx4 v[228:231], v251, s[40:43], s89 offen nt
  s_add_u32 s89, s89, 4096
  buffer_load_dwordx4 v[232:235], v251, s[40:43], s89 offen nt
  s_add_u32 s89, s89, 4096
  buffer_load_dwordx4 v[236:239], v251, s[40:43], s89 offen nt
L_lwX:
  s_barrier
  s_waitcnt vmcnt(12)
  s_barrier
  s_barrier
  s_barrier
  s_branch L_pv
L_lwB:
  s_cmp_lg_u32 s101, 0
  s_cbranch_scc1 L_lwB2
  buffer_load_dwordx4 v[176:179], v253, s[44:47], s88 offen nt
  s_add_u32 s88, s88, 65536
  buffer_load_dwordx4 v[180:183], v253, s[44:47], s88 offen nt
  s_add_u32 s88, s88, 65536
  buffer_load_dwordx4 v[184:187], v253, s[44:47], s88 offen nt
  s_add_u32 s88, s88, 65536
  buffer_load_dwordx4 v[188:191], v253, s[44:47], s88 offen nt
  s_mov_b64 s[40:41], s[18:19]
  s_mov_b32 s42, 0x1c0000
  s_mov_b32 s43, 0x20000
  s_mov_b64 s[44:45], s[20:21]
  s_mov_b32 s46, 0x1c0000
  s_mov_b32 s47, 0x20000
  s_mov_b32 exec_lo, 0xfffffff
  s_mov_b32 exec_hi, 0xfffffff
  buffer_load_dwordx4 v[208:211], v251, s[40:43], s89 offen nt
  buffer_load_dwordx4 v[212:215], v251, s[44:47], s89 offen nt
  s_add_u32 s89, s89, 7168
  buffer_load_dwordx4 v[216:219], v251, s[40:43], s89 offen nt
  buffer_load_dwordx4 v[220:223], v251, s[44:47], s89 offen nt
  s_add_u32 s89, s89, 7168
  buffer_load_dwordx4 v[224:227], v251, s[40:43], s89 offen nt
  buffer_load_dwordx4 v[228:231], v251, s[44:47], s89 offen nt
  s_add_u32 s89, s89, 7168
  buffer_load_dwordx4 v[232:235], v251, s[40:43], s89 offen nt
  buffer_load_dwordx4 v[236:239], v251, s[44:47], s89 offen nt
  s_mov_b64 exec, -1
L_lwB2:
  s_and_b32 s74, s2, 31
  s_lshl_b32 s74, s74, 10
  s_lshr_b32 s97, s78, 5
  s_lshl_b32 s97, s97, 8
  s_add_u32 s74, s74, s97
  s_add_u32 s74, s74, 0x4000
  v_and_b32 v13, 7, v1
  v_lshlrev_b32 v13, 2, v13
  v_lshrrev_b32 v14, 4, v1
  v_add_u32 v13, v13, v14
  v_lshlrev_b32 v13, 5, v13
  s_lshl_b32 s92, s3, 2
  s_add_u32 s92, s92, 141296
  v_add_u32 v13, s92, v13
  v_lshlrev_b32 v14, 6, v1
  v_add_u32 v14, 141312, v14
  v_lshlrev_b32 v15, 4, v1
  v_xor_b32 v13, s59, v13
  v_xor_b32 v14, s59, v14
  s_waitcnt vmcnt(63)
  v_lshlrev_b32 v116, 16, v144
  v_and_b32 v117, 0xffff0000, v144
  v_lshlrev_b32 v118, 16, v145
  v_and_b32 v119, 0xffff0000, v145
  v_mul_f32 v112, 0xbfb8aa3b, v116
  v_mul_f32 v113, 0xbfb8aa3b, v117
  v_mul_f32 v114, 0xbfb8aa3b, v118
  v_mul_f32 v115, 0xbfb8aa3b, v119
  v_exp_f32 v112, v112
  v_exp_f32 v113, v113
  v_exp_f32 v114, v114
  v_exp_f32 v115, v115
  v_add_f32 v112, 1.0, v112
  v_add_f32 v113, 1.0, v113
  v_add_f32 v114, 1.0, v114
  v_add_f32 v115, 1.0, v115
  v_rcp_f32 v112, v112
  v_rcp_f32 v113, v113
  v_rcp_f32 v114, v114
  v_rcp_f32 v115, v115
  v_mul_f32 v116, v116, v112
  v_mul_f32 v117, v117, v113
  v_mul_f32 v118, v118, v114
  v_mul_f32 v119, v119, v115
  v_cvt_pk_bf16_f32 v116, v116, v116
  v_cvt_pk_bf16_f32 v117, v117, v117
  v_cvt_pk_bf16_f32 v118, v118, v118
  v_cvt_pk_bf16_f32 v119, v119, v119
  v_lshrrev_b32 v112, 16, v116
  v_lshrrev_b32 v113, 16, v117
  v_lshrrev_b32 v114, 16, v118
  v_lshrrev_b32 v115, 16, v119
  v_and_b32 v116, 0xffff0000, v116
  v_and_b32 v117, 0xffff0000, v117
  v_and_b32 v118, 0xffff0000, v118
  v_and_b32 v119, 0xffff0000, v119
  v_mov_b32 v96, 0
  v_mov_b32 v97, 0
  v_mov_b32 v98, 0
  v_mov_b32 v99, 0
  v_mov_b32 v100, 0
  v_mov_b32 v101, 0
  v_mov_b32 v102, 0
  v_mov_b32 v103, 0
  s_waitcnt vmcnt(63)
  v_dot2c_f32_bf16 v96, v112, v128
  v_dot2c_f32_bf16 v97, v116, v128
  v_dot2c_f32_bf16 v98, v112, v129
  v_dot2c_f32_bf16 v99, v116, v129
  v_dot2c_f32_bf16 v100, v112, v130
  v_dot2c_f32_bf16 v101, v116, v130
  v_dot2c_f32_bf16 v102, v112, v131
  v_dot2c_f32_bf16 v103, v116, v131
  s_waitcnt vmcnt(62)
  v_dot2c_f32_bf16 v96, v113, v132
  v_dot2c_f32_bf16 v97, v117, v132
  v_dot2c_f32_bf16 v98, v113, v133
  v_dot2c_f32_bf16 v99, v117, v133
  v_dot2c_f32_bf16 v100, v113, v134
  v_dot2c_f32_bf16 v101, v117, v134
  v_dot2c_f32_bf16 v102, v113, v135
  v_dot2c_f32_bf16 v103, v117, v135
  s_waitcnt vmcnt(61)
  v_dot2c_f32_bf16 v96, v114, v136
  v_dot2c_f32_bf16 v97, v118, v136
  v_dot2c_f32_bf16 v98, v114, v137
  v_dot2c_f32_bf16 v99, v118, v137
  v_dot2c_f32_bf16 v100, v114, v138
  v_dot2c_f32_bf16 v101, v118, v138
  v_dot2c_f32_bf16 v102, v114, v139
  v_dot2c_f32_bf16 v103, v118, v139
  s_waitcnt vmcnt(60)
  v_dot2c_f32_bf16 v96, v115, v140
  v_dot2c_f32_bf16 v97, v119, v140
  v_dot2c_f32_bf16 v98, v115, v141
  v_dot2c_f32_bf16 v99, v119, v141
  v_dot2c_f32_bf16 v100, v115, v142
  v_dot2c_f32_bf16 v101, v119, v142
  v_dot2c_f32_bf16 v102, v115, v143
  v_dot2c_f32_bf16 v103, v119, v143
  v_permlane32_swap_b32 v96, v100
  v_permlane32_swap_b32 v97, v101
  v_permlane32_swap_b32 v98, v102
  v_permlane32_swap_b32 v99, v103
  v_add_f32 v96, v96, v100
  v_add_f32 v97, v97, v101
  v_add_f32 v98, v98, v102
  v_add_f32 v99, v99, v103
  s_nop 0
  v_permlane16_swap_b32 v96, v98
  v_permlane16_swap_b32 v97, v99
  v_add_f32 v96, v96, v98
  v_add_f32 v97, v97, v99
  s_nop 0
  v_add_f32_dpp v96, v96, v96 row_ror:8 row_mask:0xf bank_mask:0xf
  v_add_f32_dpp v97, v97, v97 row_ror:8 row_mask:0xf bank_mask:0xf
  s_barrier
  s_waitcnt vmcnt(12)
  s_barrier
  ds_write2_b32 v13, v96, v97 offset0:0 offset1:4
  s_waitcnt lgkmcnt(0)
  s_barrier
  s_cmp_lg_u32 s3, 4
  s_cbranch_scc1 L_nopub_33
  s_mov_b64 exec, 0xffff
  ds_read_b128 v[128:131], v14 offset:0
  ds_read_b128 v[132:135], v14 offset:16
  ds_read_b128 v[136:139], v14 offset:32
  ds_read_b128 v[140:143], v14 offset:48
  s_waitcnt lgkmcnt(3)
  v_add_f32 v128, v128, v129
  v_add_f32 v130, v130, v131
  v_add_f32 v128, v128, v130
  s_waitcnt lgkmcnt(2)
  v_add_f32 v132, v132, v133
  v_add_f32 v134, v134, v135
  v_add_f32 v132, v132, v134
  s_waitcnt lgkmcnt(1)
  v_add_f32 v136, v136, v137
  v_add_f32 v138, v138, v139
  v_add_f32 v136, v136, v138
  s_waitcnt lgkmcnt(0)
  v_add_f32 v140, v140, v141
  v_add_f32 v142, v142, v143
  v_add_f32 v140, v140, v142
  v_and_or_b32 v100, v128, v2, s49
  v_and_or_b32 v101, v132, v2, s50
  v_and_or_b32 v102, v136, v2, s51
  v_and_or_b32 v103, v140, v2, s52
  buffer_store_dwordx4 v[100:103], v15, s[32:35], s74 offen sc1
L_nopub_33:
  s_mov_b64 exec, -1
  s_barrier
  s_branch L_pv
L_front:
  s_mov_b32 s100, 0
  s_waitcnt vmcnt(4)
  s_branch L_epc_35
L_ep_34:
  global_load_dword v252, v253, s[30:31] sc1
  s_add_u32 s100, s100, 1
  s_cmp_gt_u32 s100, 100000
  s_cbranch_scc1 L_abort
  s_waitcnt vmcnt(0)
L_epc_35:
  v_readfirstlane_b32 s48, v252
  s_nop 0
  s_cmp_eq_u32 s48, 0
  s_nop 1
  s_cbranch_scc1 L_ep_34
  s_mul_i32 s48, s48, 0x9e3779b1
  s_and_b32 s49, s48, 0xff
  s_bfe_u32 s50, s48, 0x80008
  s_bfe_u32 s51, s48, 0x80010
  s_lshr_b32 s52, s48, 24
  s_lshr_b32 s97, s48, 15
  s_xor_b32 s97, s97, s48
  s_mul_i32 s97, s97, 0x85ebca6b
  v_mov_b32 v4, s48
  v_mov_b32 v5, s97
  v_mov_b32 v249, s48
  v_mov_b32 v250, s97
  v_and_b32 v6, 4, v1
  v_cmp_eq_u32 vcc, 0, v6
  v_and_b32 v7, 3, v1
  v_lshlrev_b32 v7, 2, v7
  v_cndmask_b32 v4, v5, v4, vcc
  v_lshrrev_b32 v4, v7, v4
  v_lshrrev_b32 v5, 1, v4
  v_lshrrev_b32 v6, 2, v4
  v_lshrrev_b32 v7, 3, v4
L_setup:
  s_lshr_b32 s92, s3, 1
  s_lshl_b32 s92, s92, 15
  s_and_b32 s93, s3, 1
  v_lshlrev_b32 v34, 4, v1
  v_bfe_u32 v44, v1, 2, 2
  v_lshrrev_b32 v45, 5, v1
  v_lshl_add_u32 v46, v45, 2, v44
  v_lshlrev_b32 v46, 8, v46
  v_add_u32 v46, s92, v46
  v_and_b32 v47, 1, v1
  v_lshl_add_u32 v46, v47, 3, v46
  v_lshl_or_b32 v44, v44, 2, v45
  v_bfe_u32 v47, v1, 4, 1
  v_lshlrev_b32 v47, 1, v47
  v_xor_b32 v44, v44, v47
  v_bfe_u32 v47, v1, 1, 1
  v_xor_b32 v44, v44, v47
  s_lshl_b32 s94, s93, 3
  v_xor_b32 v44, s94, v44
  v_xor_b32 v47, 0, v44
  v_lshl_add_u32 v24, v47, 4, v46
  v_xor_b32 v47, 2, v44
  v_lshl_add_u32 v25, v47, 4, v46
  v_add_u32 v25, 2048, v25
  v_xor_b32 v47, 4, v44
  v_lshl_add_u32 v26, v47, 4, v46
  v_xor_b32 v47, 6, v44
  v_lshl_add_u32 v27, v47, 4, v46
  v_add_u32 v27, 2048, v27
  v_add_u32 v28, 132096, v34
  v_and_b32 v44, 31, v1
  v_lshlrev_b32 v29, 5, v44
  v_add_u32 v29, 131072, v29
  v_xor_b32 v28, s59, v28
  v_xor_b32 v29, s59, v29
  s_lshl_b32 s94, s93, 7
  s_add_u32 s94, s94, s92
  v_and_b32 v46, 3, v44
  v_lshlrev_b32 v46, 6, v46
  v_lshl_add_u32 v46, v44, 8, v46
  v_bfe_u32 v47, v44, 1, 2
  v_lshlrev_b32 v45, 1, v45
  v_xor_b32 v47, v47, v45
  v_lshl_add_u32 v46, v47, 4, v46
  v_xor_b32 v244, s94, v46
  v_xor_b32 v245, 16, v244
  v_xor_b32 v246, 64, v244
  v_xor_b32 v247, 0x50, v244
  v_lshrrev_b32 v44, 2, v1
  v_and_b32 v46, 3, v44
  v_lshlrev_b32 v46, 6, v46
  v_lshl_add_u32 v46, v44, 8, v46
  v_bfe_u32 v47, v44, 1, 2
  v_and_b32 v45, 3, v1
  v_xor_b32 v47, v47, v45
  v_lshl_add_u32 v46, v47, 4, v46
  v_xor_b32 v32, s94, v46
  v_xor_b32 v33, 64, v32
  v_lshrrev_b32 v44, 3, v1
  v_bfe_u32 v45, v1, 2, 1
  v_and_b32 v46, 3, v44
  v_xor_b32 v46, v46, v45
  v_lshlrev_b32 v46, 6, v46
  v_lshl_add_u32 v46, v44, 8, v46
  v_lshrrev_b32 v47, 1, v44
  v_and_b32 v45, 3, v1
  v_xor_b32 v47, v47, v45
  v_lshl_add_u32 v46, v47, 4, v46
  v_xor_b32 v32, s94, v46
  s_mul_i32 s87, s2, 32896
  s_lshl_b32 s97, s3, 12
  s_add_u32 s87, s87, s97
  s_add_u32 s87, s87, 0x200000
  s_lshl_b32 s94, s76, 4
  s_lshl_b32 s97, s3, 9
  s_add_u32 s94, s94, s97
  s_add_u32 s94, s94, 0x20000
  v_lshrrev_b32 v35, 3, v1
  v_lshlrev_b32 v35, 12, v35
  v_add_u32 v35, s94, v35
  v_lshlrev_b32 v248, 4, v1
  v_lshrrev_b32 v36, 3, v1
  v_mul_u32_u24 v36, 263168, v36
  v_and_b32 v3, 7, v1
  v_lshl_add_u32 v36, v3, 4, v36
  s_mul_i32 s94, s3, 32896
  s_lshl_b32 s97, s77, 12
  s_add_u32 s94, s94, s97
  s_lshl_b32 s97, s76, 7
  s_add_u32 s94, s94, s97
  s_add_u32 s83, s94, 6307840
  s_add_u32 s84, s94, 8413184
  s_add_u32 s85, s94, 2097152
  s_add_u32 s86, s94, 4202496
  s_mul_i32 s94, s3, 144
  s_add_u32 s94, s94, 0x14000
  v_and_b32 v37, 7, v1
  v_lshlrev_b32 v37, 4, v37
  v_lshrrev_b32 v3, 4, v1
  v_lshl_add_u32 v37, v3, 2, v37
  v_add_u32 v37, s94, v37
  v_and_b32 v38, 7, v1
  v_mul_u32_u24 v38, 144, v38
  v_lshrrev_b32 v3, 4, v1
  v_lshl_add_u32 v38, v3, 4, v38
  v_add_u32 v38, 81920, v38
  s_lshl_b32 s94, s3, 7
  s_add_u32 s94, s94, 0x16c00
  v_lshrrev_b32 v41, 4, v1
  v_lshlrev_b32 v41, 4, v41
  v_add_u32 v41, s94, v41
  v_and_b32 v40, 7, v1
  v_mul_u32_u24 v40, 272, v40
  v_lshrrev_b32 v3, 4, v1
  v_lshl_add_u32 v40, v3, 4, v40
  v_add_u32 v40, 94208, v40
  s_lshl_b32 s94, s76, 12
  s_lshl_b32 s97, s3, 6
  s_add_u32 s94, s94, s97
  s_add_u32 s94, s94, 0x40000
  v_bfe_u32 v39, v1, 2, 3
  v_lshlrev_b32 v39, 9, v39
  v_and_b32 v3, 3, v1
  v_lshl_add_u32 v39, v3, 4, v39
  v_add_u32 v39, s94, v39
  s_lshl_b32 s95, s77, 9
  s_add_u32 s16, s94, s95
  s_and_b32 s94, s3, 3
  s_mul_i32 s94, s94, 4864
  v_lshrrev_b32 v240, 4, v1
  v_mul_u32_u24 v240, 288, v240
  v_and_b32 v3, 15, v1
  v_lshl_add_u32 v240, v3, 4, v240
  v_add_u32 v240, s94, v240
  s_and_b32 s94, s3, 3
  s_mul_i32 s94, s94, 9728
  s_add_u32 s94, s94, 0x5000
  v_lshrrev_b32 v241, 4, v1
  v_mul_u32_u24 v241, 288, v241
  v_and_b32 v3, 15, v1
  v_lshl_add_u32 v241, v3, 4, v241
  v_add_u32 v241, s94, v241
  s_lshl_b32 s94, s3, 5
  v_lshrrev_b32 v242, 4, v1
  v_mul_u32_u24 v242, 2432, v242
  v_bfe_u32 v3, v1, 2, 2
  v_mul_u32_u24 v3, 288, v3
  v_add_u32 v242, v3, v242
  v_and_b32 v3, 3, v1
  v_lshl_add_u32 v242, v3, 3, v242
  v_add_u32 v242, s94, v242
  v_lshrrev_b32 v243, 4, v1
  v_mul_u32_u24 v243, 2432, v243
  v_bfe_u32 v3, v1, 2, 2
  v_mul_u32_u24 v3, 288, v3
  v_add_u32 v243, v3, v243
  v_and_b32 v3, 3, v1
  v_lshl_add_u32 v243, v3, 3, v243
  v_add_u32 v243, 20480, v243
  v_add_u32 v243, s94, v243
  v_bfe_u32 v43, v1, 2, 3
  v_mul_u32_u24 v43, 272, v43
  v_and_b32 v3, 3, v1
  v_lshl_add_u32 v43, v3, 3, v43
  v_add_u32 v43, 94208, v43
  v_add_u32 v43, s94, v43
  s_cmp_ge_u32 s3, 4
  s_cbranch_scc1 L_back2
  v_and_b32 v44, 31, v1
  v_and_b32 v46, 3, v44
  v_lshlrev_b32 v46, 2, v46
  v_bfe_u32 v47, v44, 2, 2
  v_or_b32 v46, v46, v47
  v_lshrrev_b32 v47, 5, v1
  v_xor_b32 v46, v46, v47
  v_lshlrev_b32 v45, 8, v44
  v_xor_b32 v47, 0, v46
  v_lshl_add_u32 v16, v47, 4, v45
  v_xor_b32 v47, 2, v46
  v_lshl_add_u32 v17, v47, 4, v45
  v_xor_b32 v47, 4, v46
  v_lshl_add_u32 v18, v47, 4, v45
  v_xor_b32 v47, 6, v46
  v_lshl_add_u32 v19, v47, 4, v45
  v_xor_b32 v47, 8, v46
  v_lshl_add_u32 v20, v47, 4, v45
  v_xor_b32 v47, 10, v46
  v_lshl_add_u32 v21, v47, 4, v45
  v_xor_b32 v47, 12, v46
  v_lshl_add_u32 v22, v47, 4, v45
  v_xor_b32 v47, 14, v46
  v_lshl_add_u32 v23, v47, 4, v45
  s_lshl_b32 s92, s17, 13
  s_add_u32 s92, s92, 131072
  v_add_u32 v8, s91, v16
  v_add_u32 v16, s92, v16
  v_add_u32 v9, s91, v17
  v_add_u32 v17, s92, v17
  v_add_u32 v10, s91, v18
  v_add_u32 v18, s92, v18
  v_add_u32 v11, s91, v19
  v_add_u32 v19, s92, v19
  v_add_u32 v12, s91, v20
  v_add_u32 v20, s92, v20
  v_add_u32 v13, s91, v21
  v_add_u32 v21, s92, v21
  v_add_u32 v14, s91, v22
  v_add_u32 v22, s92, v22
  v_add_u32 v15, s91, v23
  v_add_u32 v23, s92, v23
  s_lshl_b32 s92, s3, 2
  v_lshrrev_b32 v47, 5, v1
  v_lshl_add_u32 v30, v47, 4, v29
  v_add_u32 v30, s92, v30
  s_lshl_b32 s92, s3, 11
  v_add_u32 v31, s92, v28
  s_setprio 2
  s_mov_b32 s101, 1
  s_waitcnt vmcnt(4)
  s_barrier
  ds_read_b128 v[112:115], v8
  ds_read_b128 v[116:119], v16
  ds_read_b128 v[120:123], v9
  ds_read_b128 v[124:127], v17
  ds_read_b128 v[128:131], v10
  ds_read_b128 v[132:135], v18
  ds_read_b128 v[136:139], v11
  ds_read_b128 v[140:143], v19
  ds_read_b128 v[144:147], v12
  ds_read_b128 v[148:151], v20
  ds_read_b128 v[152:155], v13
  ds_read_b128 v[156:159], v21
  v_xor_b32 v8, 0x8000, v8
  v_xor_b32 v16, 0x2000, v16
  v_xor_b32 v9, 0x8000, v9
  v_xor_b32 v17, 0x2000, v17
  v_xor_b32 v10, 0x8000, v10
  v_xor_b32 v18, 0x2000, v18
  v_xor_b32 v11, 0x8000, v11
  v_xor_b32 v19, 0x2000, v19
  v_xor_b32 v12, 0x8000, v12
  v_xor_b32 v20, 0x2000, v20
  v_xor_b32 v13, 0x8000, v13
  v_xor_b32 v21, 0x2000, v21
  s_waitcnt lgkmcnt(10)
  v_mfma_f32_32x32x16_bf16 v[96:111], v[112:115], v[116:119], 0
  ds_read_b128 v[160:163], v14
  ds_read_b128 v[164:167], v22
  v_xor_b32 v14, 0x8000, v14
  v_xor_b32 v22, 0x2000, v22
  s_waitcnt lgkmcnt(10)
  v_mfma_f32_32x32x16_bf16 v[96:111], v[120:123], v[124:127], v[96:111]
  ds_read_b128 v[168:171], v15
  ds_read_b128 v[172:175], v23
  v_xor_b32 v15, 0x8000, v15
  v_xor_b32 v23, 0x2000, v23
  s_waitcnt lgkmcnt(10)
  v_mfma_f32_32x32x16_bf16 v[96:111], v[128:131], v[132:135], v[96:111]
  ds_read_b128 v[112:115], v8
  ds_read_b128 v[116:119], v16
  v_xor_b32 v8, 0x18000, v8
  v_xor_b32 v16, 0x6000, v16
  s_waitcnt lgkmcnt(10)
  v_mfma_f32_32x32x16_bf16 v[96:111], v[136:139], v[140:143], v[96:111]
  ds_read_b128 v[120:123], v9
  ds_read_b128 v[124:127], v17
  v_xor_b32 v9, 0x18000, v9
  v_xor_b32 v17, 0x6000, v17
  s_waitcnt lgkmcnt(10)
  v_mfma_f32_32x32x16_bf16 v[96:111], v[144:147], v[148:151], v[96:111]
  ds_read_b128 v[128:131], v10
  ds_read_b128 v[132:135], v18
  v_xor_b32 v10, 0x18000, v10
  v_xor_b32 v18, 0x6000, v18
  s_waitcnt lgkmcnt(10)
  v_mfma_f32_32x32x16_bf16 v[96:111], v[152:155], v[156:159], v[96:111]
  ds_read_b128 v[136:139], v11
  ds_read_b128 v[140:143], v19
  v_xor_b32 v11, 0x18000, v11
  v_xor_b32 v19, 0x6000, v19
  s_waitcnt lgkmcnt(10)
  v_mfma_f32_32x32x16_bf16 v[96:111], v[160:163], v[164:167], v[96:111]
  ds_read_b128 v[144:147], v12
  ds_read_b128 v[148:151], v20
  v_xor_b32 v12, 0x18000, v12
  v_xor_b32 v20, 0x6000, v20
  s_waitcnt lgkmcnt(10)
  v_mfma_f32_32x32x16_bf16 v[96:111], v[168:171], v[172:175], v[96:111]
  ds_read_b128 v[152:155], v13
  ds_read_b128 v[156:159], v21
  v_xor_b32 v13, 0x18000, v13
  v_xor_b32 v21, 0x6000, v21
  s_waitcnt lgkmcnt(10)
  v_mfma_f32_32x32x16_bf16 v[96:111], v[112:115], v[116:119], v[96:111]
  ds_read_b128 v[160:163], v14
  ds_read_b128 v[164:167], v22
  v_xor_b32 v14, 0x18000, v14
  v_xor_b32 v22, 0x6000, v22
  s_waitcnt lgkmcnt(10)
  v_mfma_f32_32x32x16_bf16 v[96:111], v[120:123], v[124:127], v[96:111]
  ds_read_b128 v[168:171], v15
  ds_read_b128 v[172:175], v23
  v_xor_b32 v15, 0x18000, v15
  v_xor_b32 v23, 0x6000, v23
  s_waitcnt lgkmcnt(10)
  v_mfma_f32_32x32x16_bf16 v[96:111], v[128:131], v[132:135], v[96:111]
  ds_read_b128 v[112:115], v8
  ds_read_b128 v[116:119], v16
  v_xor_b32 v8, 0x8000, v8
  v_xor_b32 v16, 0x2000, v16
  s_waitcnt lgkmcnt(10)
  v_mfma_f32_32x32x16_bf16 v[96:111], v[136:139], v[140:143], v[96:111]
  ds_read_b128 v[120:123], v9
  ds_read_b128 v[124:127], v17
  v_xor_b32 v9, 0x8000, v9
  v_xor_b32 v17, 0x2000, v17
  s_waitcnt lgkmcnt(10)
  v_mfma_f32_32x32x16_bf16 v[96:111], v[144:147], v[148:151], v[96:111]
  ds_read_b128 v[128:131], v10
  ds_read_b128 v[132:135], v18
  v_xor_b32 v10, 0x8000, v10
  v_xor_b32 v18, 0x2000, v18
  s_waitcnt lgkmcnt(10)
  v_mfma_f32_32x32x16_bf16 v[96:111], v[152:155], v[156:159], v[96:111]
  ds_read_b128 v[136:139], v11
  ds_read_b128 v[140:143], v19
  v_xor_b32 v11, 0x8000, v11
  v_xor_b32 v19, 0x2000, v19
  s_waitcnt lgkmcnt(10)
  v_mfma_f32_32x32x16_bf16 v[96:111], v[160:163], v[164:167], v[96:111]
  ds_read_b128 v[144:147], v12
  ds_read_b128 v[148:151], v20
  v_xor_b32 v12, 0x8000, v12
  v_xor_b32 v20, 0x2000, v20
  s_waitcnt lgkmcnt(10)
  v_mfma_f32_32x32x16_bf16 v[96:111], v[168:171], v[172:175], v[96:111]
  ds_read_b128 v[152:155], v13
  ds_read_b128 v[156:159], v21
  v_xor_b32 v13, 0x8000, v13
  v_xor_b32 v21, 0x2000, v21
  s_barrier
  s_waitcnt lgkmcnt(10)
  v_mfma_f32_32x32x16_bf16 v[96:111], v[112:115], v[116:119], v[96:111]
  ds_read_b128 v[160:163], v14
  ds_read_b128 v[164:167], v22
  v_xor_b32 v14, 0x8000, v14
  v_xor_b32 v22, 0x2000, v22
  s_waitcnt lgkmcnt(10)
  v_mfma_f32_32x32x16_bf16 v[96:111], v[120:123], v[124:127], v[96:111]
  ds_read_b128 v[168:171], v15
  ds_read_b128 v[172:175], v23
  v_xor_b32 v15, 0x8000, v15
  v_xor_b32 v23, 0x2000, v23
  s_waitcnt lgkmcnt(10)
  v_mfma_f32_32x32x16_bf16 v[96:111], v[128:131], v[132:135], v[96:111]
  s_waitcnt vmcnt(0)
  s_barrier
  ds_read_b128 v[112:115], v8
  ds_read_b128 v[116:119], v16
  s_waitcnt lgkmcnt(10)
  v_mfma_f32_32x32x16_bf16 v[96:111], v[136:139], v[140:143], v[96:111]
  ds_read_b128 v[120:123], v9
  ds_read_b128 v[124:127], v17
  s_waitcnt lgkmcnt(10)
  v_mfma_f32_32x32x16_bf16 v[96:111], v[144:147], v[148:151], v[96:111]
  ds_read_b128 v[128:131], v10
  ds_read_b128 v[132:135], v18
  s_waitcnt lgkmcnt(10)
  v_mfma_f32_32x32x16_bf16 v[96:111], v[152:155], v[156:159], v[96:111]
  ds_read_b128 v[136:139], v11
  ds_read_b128 v[140:143], v19
  s_waitcnt lgkmcnt(10)
  v_mfma_f32_32x32x16_bf16 v[96:111], v[160:163], v[164:167], v[96:111]
  ds_read_b128 v[144:147], v12
  ds_read_b128 v[148:151], v20
  s_waitcnt lgkmcnt(10)
  v_mfma_f32_32x32x16_bf16 v[96:111], v[168:171], v[172:175], v[96:111]
  ds_read_b128 v[152:155], v13
  ds_read_b128 v[156:159], v21
  s_waitcnt lgkmcnt(10)
  v_mfma_f32_32x32x16_bf16 v[96:111], v[112:115], v[116:119], v[96:111]
  ds_read_b128 v[160:163], v14
  ds_read_b128 v[164:167], v22
  s_waitcnt lgkmcnt(10)
  v_mfma_f32_32x32x16_bf16 v[96:111], v[120:123], v[124:127], v[96:111]
  ds_read_b128 v[168:171], v15
  ds_read_b128 v[172:175], v23
  s_waitcnt lgkmcnt(10)
  v_mfma_f32_32x32x16_bf16 v[96:111], v[128:131], v[132:135], v[96:111]
  s_waitcnt lgkmcnt(8)
  v_mfma_f32_32x32x16_bf16 v[96:111], v[136:139], v[140:143], v[96:111]
  s_waitcnt lgkmcnt(6)
  v_mfma_f32_32x32x16_bf16 v[96:111], v[144:147], v[148:151], v[96:111]
  s_waitcnt lgkmcnt(4)
  v_mfma_f32_32x32x16_bf16 v[96:111], v[152:155], v[156:159], v[96:111]
  s_waitcnt lgkmcnt(2)
  v_mfma_f32_32x32x16_bf16 v[96:111], v[160:163], v[164:167], v[96:111]
  s_waitcnt lgkmcnt(0)
  v_mfma_f32_32x32x16_bf16 v[96:111], v[168:171], v[172:175], v[96:111]
  s_nop 11
  v_max3_f32 v44, v96, v97, v98
  v_max3_f32 v45, v99, v100, v101
  v_max3_f32 v46, v102, v103, v104
  v_max3_f32 v47, v105, v106, v107
  v_max3_f32 v44, v44, v108, v109
  v_max3_f32 v45, v45, v110, v111
  v_max3_f32 v44, v44, v46, v47
  v_max_f32 v44, v44, v45
  ds_write_b32 v30, v44
  v_sub_f32 v96, v96, v44
  v_sub_f32 v97, v97, v44
  v_sub_f32 v98, v98, v44
  v_sub_f32 v99, v99, v44
  v_sub_f32 v100, v100, v44
  v_sub_f32 v101, v101, v44
  v_sub_f32 v102, v102, v44
  v_sub_f32 v103, v103, v44
  s_waitcnt lgkmcnt(0)
  s_barrier
  ds_read_b128 v[48:51], v29
  ds_read_b128 v[52:55], v29 offset:16
  v_exp_f32 v96, v96
  v_sub_f32 v104, v104, v44
  v_exp_f32 v97, v97
  v_sub_f32 v105, v105, v44
  v_exp_f32 v98, v98
  v_sub_f32 v106, v106, v44
  v_exp_f32 v99, v99
  v_sub_f32 v107, v107, v44
  v_exp_f32 v100, v100
  v_sub_f32 v108, v108, v44
  v_exp_f32 v101, v101
  v_sub_f32 v109, v109, v44
  v_exp_f32 v102, v102
  v_sub_f32 v110, v110, v44
  v_exp_f32 v103, v103
  v_sub_f32 v111, v111, v44
  s_waitcnt lgkmcnt(0)
  v_max3_f32 v45, v48, v49, v50
  v_max3_f32 v46, v51, v52, v53
  v_exp_f32 v104, v104
  v_max3_f32 v45, v45, v54, v55
  v_exp_f32 v105, v105
  v_max_f32 v45, v45, v46
  v_exp_f32 v106, v106
  v_sub_f32 v45, v44, v45
  v_exp_f32 v107, v107
  v_exp_f32 v45, v45
  v_exp_f32 v108, v108
  v_exp_f32 v109, v109
  v_exp_f32 v110, v110
  v_exp_f32 v111, v111
  v_mul_f32 v96, v96, v45
  v_mul_f32 v97, v97, v45
  v_mul_f32 v98, v98, v45
  v_mul_f32 v99, v99, v45
  v_mul_f32 v100, v100, v45
  v_mul_f32 v101, v101, v45
  v_mul_f32 v102, v102, v45
  v_mul_f32 v103, v103, v45
  v_cvt_pk_bf16_f32 v48, v96, v97
  v_cvt_pk_bf16_f32 v49, v98, v99
  v_cvt_pk_bf16_f32 v50, v100, v101
  v_cvt_pk_bf16_f32 v51, v102, v103
  ds_write_b128 v31, v[48:51] offset:0
  v_mul_f32 v104, v104, v45
  v_mul_f32 v105, v105, v45
  v_mul_f32 v106, v106, v45
  v_mul_f32 v107, v107, v45
  v_mul_f32 v108, v108, v45
  v_mul_f32 v109, v109, v45
  v_mul_f32 v110, v110, v45
  v_mul_f32 v111, v111, v45
  v_cvt_pk_bf16_f32 v52, v104, v105
  v_cvt_pk_bf16_f32 v53, v106, v107
  v_cvt_pk_bf16_f32 v54, v108, v109
  v_cvt_pk_bf16_f32 v55, v110, v111
  ds_write_b128 v31, v[52:55] offset:1024
  v_add_f32 v96, v96, v97
  v_add_f32 v98, v98, v99
  v_add_f32 v100, v100, v101
  v_add_f32 v102, v102, v103
  v_add_f32 v104, v104, v105
  v_add_f32 v106, v106, v107
  v_add_f32 v108, v108, v109
  v_add_f32 v110, v110, v111
  v_add_f32 v96, v96, v98
  v_add_f32 v100, v100, v102
  v_add_f32 v104, v104, v106
  v_add_f32 v108, v108, v110
  v_add_f32 v96, v96, v100
  v_add_f32 v104, v104, v108
  v_add_f32 v96, v96, v104
  ds_write_b32 v30, v96 offset:9216
  s_waitcnt lgkmcnt(0)
  s_barrier
L_pv:
  s_setprio 2
  ds_read_b128 v[48:51], v28 offset:0
  ds_read_b64_tr_b16 v[112:113], v24 offset:0
  ds_read_b64_tr_b16 v[114:115], v25 offset:0
  ds_read_b128 v[52:55], v28 offset:1024
  ds_read_b64_tr_b16 v[116:117], v24 offset:4096
  ds_read_b64_tr_b16 v[118:119], v25 offset:4096
  ds_read_b128 v[56:59], v28 offset:2048
  ds_read_b64_tr_b16 v[120:121], v24 offset:8192
  ds_read_b64_tr_b16 v[122:123], v25 offset:8192
  ds_read_b128 v[60:63], v28 offset:3072
  ds_read_b64_tr_b16 v[124:125], v24 offset:12288
  ds_read_b64_tr_b16 v[126:127], v25 offset:12288
  s_lshl_b32 s74, s2, 9
  s_add_u32 s74, s74, 0x20000
  s_mov_b32 s70, 0x10000
  s_mov_b32 s71, 0x18000
  s_mov_b32 s72, 0x8000
  s_cmp_lg_u32 s3, 7
  s_cbranch_scc1 L_nolse
  ds_read_b128 v[144:147], v29
  ds_read_b128 v[148:151], v29 offset:16
  s_waitcnt lgkmcnt(6)
  ds_read_b128 v[152:155], v29 offset:9216
  ds_read_b128 v[156:159], v29 offset:9232
  s_andn2_b32 s92, s48, 1
  v_mov_b32 v23, s92
  s_waitcnt lgkmcnt(2)
  v_max3_f32 v20, v144, v145, v146
  v_max3_f32 v21, v147, v148, v149
  v_max3_f32 v20, v20, v150, v151
  v_max_f32 v20, v20, v21
  s_waitcnt lgkmcnt(0)
  v_add_f32 v152, v152, v153
  v_add_f32 v154, v154, v155
  v_add_f32 v156, v156, v157
  v_add_f32 v158, v158, v159
  v_add_f32 v152, v152, v154
  v_add_f32 v156, v156, v158
  v_add_f32 v152, v152, v156
  v_mov_b32 v21, v152
  s_mov_b32 exec_hi, 0
  buffer_store_dwordx4 v[20:23], v248, s[32:35], s74 offen sc1
  s_mov_b32 exec_hi, -1
L_nolse:
  s_waitcnt lgkmcnt(9)
  v_mfma_f32_32x32x16_bf16 v[144:159], v[112:115], v[48:51], 0
  ds_read_b128 v[64:67], v28 offset:4096
  ds_read_b64_tr_b16 v[128:129], v24 offset:16384
  ds_read_b64_tr_b16 v[130:131], v25 offset:16384
  s_waitcnt lgkmcnt(9)
  v_mfma_f32_32x32x16_bf16 v[144:159], v[116:119], v[52:55], v[144:159]
  ds_read_b128 v[68:71], v28 offset:5120
  ds_read_b64_tr_b16 v[132:133], v24 offset:20480
  ds_read_b64_tr_b16 v[134:135], v25 offset:20480
  v_lshrrev_b32 v44, 5, v1
  v_lshlrev_b32 v44, 3, v44
  v_lshrrev_b32 v96, v44, v249
  v_lshrrev_b32 v104, v44, v250
  s_waitcnt lgkmcnt(9)
  v_mfma_f32_32x32x16_bf16 v[144:159], v[120:123], v[56:59], v[144:159]
  ds_read_b128 v[72:75], v28 offset:6144
  ds_read_b64_tr_b16 v[136:137], v24 offset:24576
  ds_read_b64_tr_b16 v[138:139], v25 offset:24576
  v_lshrrev_b32 v97, 1, v96
  v_lshrrev_b32 v98, 2, v96
  v_lshrrev_b32 v99, 3, v96
  s_waitcnt lgkmcnt(9)
  v_mfma_f32_32x32x16_bf16 v[144:159], v[124:127], v[60:63], v[144:159]
  ds_read_b128 v[76:79], v28 offset:7168
  ds_read_b64_tr_b16 v[140:141], v24 offset:28672
  ds_read_b64_tr_b16 v[142:143], v25 offset:28672
  v_lshrrev_b32 v100, 4, v96
  v_lshrrev_b32 v101, 5, v96
  v_lshrrev_b32 v102, 6, v96
  v_lshrrev_b32 v103, 7, v96
  s_waitcnt lgkmcnt(9)
  v_mfma_f32_32x32x16_bf16 v[144:159], v[128:131], v[64:67], v[144:159]
  ds_read_b64_tr_b16 v[112:113], v26 offset:0
  ds_read_b64_tr_b16 v[114:115], v27 offset:0
  v_lshrrev_b32 v105, 1, v104
  v_lshrrev_b32 v106, 2, v104
  v_lshrrev_b32 v107, 3, v104
  s_waitcnt lgkmcnt(8)
  v_mfma_f32_32x32x16_bf16 v[144:159], v[132:135], v[68:71], v[144:159]
  ds_read_b64_tr_b16 v[116:117], v26 offset:4096
  ds_read_b64_tr_b16 v[118:119], v27 offset:4096
  v_lshrrev_b32 v108, 4, v104
  v_lshrrev_b32 v109, 5, v104
  v_lshrrev_b32 v110, 6, v104
  v_lshrrev_b32 v111, 7, v104
  s_waitcnt lgkmcnt(7)
  v_mfma_f32_32x32x16_bf16 v[144:159], v[136:139], v[72:75], v[144:159]
  ds_read_b64_tr_b16 v[120:121], v26 offset:8192
  ds_read_b64_tr_b16 v[122:123], v27 offset:8192
  s_waitcnt lgkmcnt(6)
  v_mfma_f32_32x32x16_bf16 v[144:159], v[140:143], v[76:79], v[144:159]
  ds_read_b64_tr_b16 v[124:125], v26 offset:12288
  ds_read_b64_tr_b16 v[126:127], v27 offset:12288
  s_waitcnt lgkmcnt(6)
  v_mfma_f32_32x32x16_bf16 v[160:175], v[112:115], v[48:51], 0
  ds_read_b64_tr_b16 v[128:129], v26 offset:16384
  ds_read_b64_tr_b16 v[130:131], v27 offset:16384
  s_waitcnt lgkmcnt(6)
  v_mfma_f32_32x32x16_bf16 v[160:175], v[116:119], v[52:55], v[160:175]
  ds_read_b64_tr_b16 v[132:133], v26 offset:20480
  ds_read_b64_tr_b16 v[134:135], v27 offset:20480
  s_waitcnt lgkmcnt(6)
  v_mfma_f32_32x32x16_bf16 v[160:175], v[120:123], v[56:59], v[160:175]
  ds_read_b64_tr_b16 v[136:137], v26 offset:24576
  ds_read_b64_tr_b16 v[138:139], v27 offset:24576
  v_cvt_pk_bf16_f32 v80, v144, v145
  v_cvt_pk_bf16_f32 v81, v146, v147
  v_cvt_pk_bf16_f32 v82, v148, v149
  v_cvt_pk_bf16_f32 v83, v150, v151
  v_bfi_b32 v80, s53, v96, v80
  v_bfi_b32 v81, s53, v97, v81
  v_bfi_b32 v82, s53, v98, v82
  v_bfi_b32 v83, s53, v99, v83
  ds_write_b128 v244, v[80:83]
  s_waitcnt lgkmcnt(7)
  v_mfma_f32_32x32x16_bf16 v[160:175], v[124:127], v[60:63], v[160:175]
  ds_read_b64_tr_b16 v[140:141], v26 offset:28672
  ds_read_b64_tr_b16 v[142:143], v27 offset:28672
  v_cvt_pk_bf16_f32 v84, v152, v153
  v_cvt_pk_bf16_f32 v85, v154, v155
  v_cvt_pk_bf16_f32 v86, v156, v157
  v_cvt_pk_bf16_f32 v87, v158, v159
  v_bfi_b32 v84, s53, v100, v84
  v_bfi_b32 v85, s53, v101, v85
  v_bfi_b32 v86, s53, v102, v86
  v_bfi_b32 v87, s53, v103, v87
  ds_write_b128 v245, v[84:87]
  s_waitcnt lgkmcnt(8)
  v_mfma_f32_32x32x16_bf16 v[160:175], v[128:131], v[64:67], v[160:175]
  s_waitcnt lgkmcnt(6)
  v_mfma_f32_32x32x16_bf16 v[160:175], v[132:135], v[68:71], v[160:175]
  s_waitcnt lgkmcnt(4)
  v_mfma_f32_32x32x16_bf16 v[160:175], v[136:139], v[72:75], v[160:175]
  s_waitcnt lgkmcnt(1)
  v_mfma_f32_32x32x16_bf16 v[160:175], v[140:143], v[76:79], v[160:175]
  s_setprio 2
  s_nop 10
  v_cvt_pk_bf16_f32 v88, v160, v161
  v_cvt_pk_bf16_f32 v89, v162, v163
  v_cvt_pk_bf16_f32 v90, v164, v165
  v_cvt_pk_bf16_f32 v91, v166, v167
  v_bfi_b32 v88, s53, v104, v88
  v_bfi_b32 v89, s53, v105, v89
  v_bfi_b32 v90, s53, v106, v90
  v_bfi_b32 v91, s53, v107, v91
  ds_write_b128 v246, v[88:91]
  v_cvt_pk_bf16_f32 v92, v168, v169
  v_cvt_pk_bf16_f32 v93, v170, v171
  v_cvt_pk_bf16_f32 v94, v172, v173
  v_cvt_pk_bf16_f32 v95, v174, v175
  v_bfi_b32 v92, s53, v108, v92
  v_bfi_b32 v93, s53, v109, v93
  v_bfi_b32 v94, s53, v110, v94
  v_bfi_b32 v95, s53, v111, v95
  ds_write_b128 v247, v[92:95]
  ds_read_b128 v[112:115], v32 offset:0
  ds_read_b128 v[116:119], v32 offset:2048
  ds_read_b128 v[120:123], v32 offset:4096
  ds_read_b128 v[124:127], v32 offset:6144
  s_waitcnt lgkmcnt(3)
  buffer_store_dwordx4 v[112:115], v34, s[32:35], s87 offen offset:0 sc1
  s_waitcnt lgkmcnt(2)
  buffer_store_dwordx4 v[116:119], v34, s[32:35], s87 offen offset:1024 sc1
  s_waitcnt lgkmcnt(1)
  buffer_store_dwordx4 v[120:123], v34, s[32:35], s87 offen offset:2048 sc1
  s_waitcnt lgkmcnt(0)
  buffer_store_dwordx4 v[124:127], v34, s[32:35], s87 offen offset:3072 sc1
  s_setprio 0
  s_barrier
  s_cmp_lg_u32 s3, 7
  s_cbranch_scc1 L_nolse2
  v_or_b32 v23, 1, v23
  s_mov_b32 exec_hi, 0
  buffer_store_dwordx4 v[20:23], v248, s[32:35], s74 offen sc1
  s_mov_b32 exec_hi, -1
L_nolse2:
  s_mov_b32 s73, 0
  s_or_b32 s69, s48, 1
  buffer_load_dwordx4 v[8:11], v35, s[32:35], s70 offen offset:0 sc1
  buffer_load_dwordx4 v[12:15], v35, s[32:35], s71 offen offset:0 sc1
  buffer_load_dwordx4 v[16:19], v35, s[32:35], 0 offen offset:0 sc1
  buffer_load_dwordx4 v[20:23], v35, s[32:35], s72 offen offset:0 sc1
  s_cmp_lt_u32 s2, 128
  s_cbranch_scc1 L_prepA
  s_and_b32 s92, s3, 3
  s_mul_i32 s92, s92, 7552
  s_add_u32 s92, s92, 0x5000
  v_lshrrev_b32 v62, 5, v1
  v_mul_u32_u24 v62, 928, v62
  v_and_b32 v3, 31, v1
  v_lshl_add_u32 v62, v3, 4, v62
  v_add_u32 v62, s92, v62
  s_lshl_b32 s92, s3, 6
  v_lshrrev_b32 v63, 4, v1
  v_mul_u32_u24 v63, 7552, v63
  v_bfe_u32 v3, v1, 2, 2
  v_mul_u32_u24 v3, 928, v3
  v_add_u32 v63, v3, v63
  v_and_b32 v3, 3, v1
  v_lshl_add_u32 v63, v3, 3, v63
  v_add_u32 v63, 20480, v63
  v_add_u32 v63, s92, v63
  s_mul_i32 s82, s80, 28672
  s_lshl_b32 s97, s3, 12
  s_add_u32 s82, s82, s97
  s_lshl_b32 s97, s79, 8
  s_add_u32 s82, s82, s97
  s_lshr_b32 s92, s79, 1
  s_lshl_b32 s92, s92, 10
  s_and_b32 s97, s79, 1
  s_lshl_b32 s97, s97, 7
  s_add_u32 s92, s92, s97
  s_add_u32 s92, s92, 0x4000
  v_bfe_u32 v56, v1, 3, 1
  v_lshlrev_b32 v56, 13, v56
  v_lshrrev_b32 v3, 4, v1
  v_lshl_add_u32 v56, v3, 8, v56
  v_and_b32 v3, 7, v1
  v_lshl_add_u32 v56, v3, 4, v56
  v_add_u32 v56, s92, v56
  v_and_b32 v60, 31, v1
  v_lshlrev_b32 v60, 5, v60
  v_add_u32 v60, 90112, v60
  s_lshl_b32 s92, s3, 2
  s_add_u32 s92, s92, 0x16000
  v_and_b32 v59, 7, v1
  v_lshlrev_b32 v59, 7, v59
  v_lshrrev_b32 v3, 4, v1
  v_lshl_add_u32 v59, v3, 5, v59
  v_add_u32 v59, s92, v59
  s_lshl_b32 s92, s3, 7
  s_add_u32 s92, s92, 0x16c00
  v_and_b32 v57, 31, v1
  v_lshlrev_b32 v57, 1, v57
  v_add_u32 v57, s92, v57
  s_mul_i32 s90, s79, 4224
  s_lshl_b32 s97, s3, 9
  s_add_u32 s90, s90, s97
  s_add_u32 s90, s90, 0x60000
  v_and_b32 v61, 31, v1
  v_lshlrev_b32 v61, 4, v61
  v_and_b32 v58, 3, v1
  v_lshlrev_b32 v58, 6, v58
  v_lshrrev_b32 v3, 4, v1
  v_lshl_add_u32 v58, v3, 4, v58
  s_nop 0
  s_branch L_prep2
L_prepA:
  s_sub_u32 s92, s79, 7
  s_cmp_ge_u32 s79, 7
  s_cselect_b32 s92, s92, s79
  s_cselect_b32 s93, 1, 0
  s_mul_i32 s81, s80, 7
  s_add_u32 s81, s81, s92
  s_lshl_b32 s91, s81, 15
  s_lshl_b32 s97, s3, 12
  s_add_u32 s91, s91, s97
  s_lshl_b32 s97, s93, 9
  s_add_u32 s91, s91, s97
  s_mul_i32 s75, s77, 16896
  s_lshr_b32 s97, s3, 1
  s_mul_i32 s97, s97, 4224
  s_add_u32 s75, s75, s97
  s_lshl_b32 s97, s76, 7
  s_add_u32 s75, s75, s97
  s_and_b32 s97, s3, 1
  s_lshl_b32 s97, s97, 6
  s_add_u32 s75, s75, s97
  s_add_u32 s75, s75, 0x60000
  s_mul_i32 s90, s93, 67584
  s_mul_i32 s97, s3, 8448
  s_add_u32 s90, s90, s97
  s_lshl_b32 s97, s81, 7
  s_add_u32 s90, s90, s97
  s_add_u32 s90, s90, 0xa0000
  s_mul_i32 s92, s3, 2176
  s_lshr_b32 s97, s3, 1
  s_lshl_b32 s97, s97, 7
  s_add_u32 s92, s92, s97
  s_add_u32 s92, s92, 0xe800
  v_lshrrev_b32 v62, 5, v1
  v_mul_u32_u24 v62, 544, v62
  v_and_b32 v3, 31, v1
  v_lshl_add_u32 v62, v3, 4, v62
  v_add_u32 v62, s92, v62
  s_lshl_b32 s92, s3, 6
  v_lshrrev_b32 v63, 4, v1
  v_mul_u32_u24 v63, 4480, v63
  v_bfe_u32 v3, v1, 2, 2
  v_mul_u32_u24 v3, 544, v3
  v_add_u32 v63, v3, v63
  v_and_b32 v3, 3, v1
  v_lshl_add_u32 v63, v3, 3, v63
  v_add_u32 v63, 59392, v63
  v_add_u32 v63, s92, v63
  s_lshl_b32 s82, s81, 12
  s_lshl_b32 s97, s3, 9
  s_add_u32 s82, s82, s97
  s_add_u32 s82, s82, 0xd0000
  s_lshl_b32 s92, s3, 7
  s_add_u32 s92, s92, 0x16c00
  v_and_b32 v57, 7, v1
  v_lshlrev_b32 v57, 3, v57
  v_lshrrev_b32 v3, 4, v1
  v_lshl_add_u32 v57, v3, 1, v57
  v_add_u32 v57, s92, v57
  v_and_b32 v61, 31, v1
  v_lshlrev_b32 v61, 4, v61
  v_and_b32 v58, 1, v1
  v_lshlrev_b32 v58, 6, v58
  v_lshrrev_b32 v3, 4, v1
  v_lshl_add_u32 v58, v3, 4, v58
  s_lshl_b32 s92, s80, 11
  v_and_b32 v56, 15, v1
  v_lshlrev_b32 v56, 7, v56
  v_add_u32 v56, 98304, v56
  v_add_u32 v56, s92, v56
  s_lshl_b32 s92, s3, 2
  s_add_u32 s92, s92, 0x14800
  v_lshlrev_b32 v59, 5, v1
  v_add_u32 v59, s92, v59
  s_bfe_u32 s92, s3, 0x10002
  s_lshl_b32 s92, s92, 10
  s_and_b32 s97, s3, 3
  s_lshl_b32 s97, s97, 2
  s_add_u32 s92, s92, s97
  s_add_u32 s92, s92, 0x15800
  v_lshlrev_b32 v60, 4, v1
  v_add_u32 v60, s92, v60
L_prep2:
  s_cmp_lg_u32 s101, 0
  s_cbranch_scc1 L_nsg
  s_waitcnt vmcnt(8)
  ds_write_b128 v240, v[176:179] offset:0
  ds_write_b128 v240, v[180:183] offset:1152
  ds_write_b128 v240, v[184:187] offset:2432
  ds_write_b128 v240, v[188:191] offset:3584
  s_cmp_lt_u32 s2, 128
  s_cbranch_scc1 L_sf_36a
  s_mov_b32 exec_lo, 0xfffffff
  s_mov_b32 exec_hi, 0xfffffff
  ds_write_b128 v62, v[208:211] offset:0
  ds_write_b128 v62, v[212:215] offset:448
  ds_write_b128 v62, v[216:219] offset:1856
  ds_write_b128 v62, v[220:223] offset:2304
  ds_write_b128 v62, v[224:227] offset:3712
  ds_write_b128 v62, v[228:231] offset:4160
  ds_write_b128 v62, v[232:235] offset:5568
  ds_write_b128 v62, v[236:239] offset:6016
  s_mov_b64 exec, -1
  s_branch L_sf_36x
L_sf_36a:
  ds_write_b128 v241, v[208:211] offset:0
  ds_write_b128 v241, v[212:215] offset:1152
  ds_write_b128 v241, v[216:219] offset:2432
  ds_write_b128 v241, v[220:223] offset:3584
  ds_write_b128 v241, v[224:227] offset:4864
  ds_write_b128 v241, v[228:231] offset:6016
  ds_write_b128 v241, v[232:235] offset:7296
  ds_write_b128 v241, v[236:239] offset:8448
L_sf_36x:
L_nsg:
  s_waitcnt vmcnt(0)
  s_mov_b32 s100, 0
L_p1:
  v_cmp_ne_u32 s[60:61], s69, v11
  v_cmp_ne_u32 s[62:63], s69, v15
  v_cmp_ne_u32 s[64:65], s69, v19
  v_cmp_ne_u32 s[66:67], s69, v23
  v_xor_b32 v44, s69, v11
  v_bitop3_b32 v44, v15, s69, v44 bitop3:0xbe
  v_bitop3_b32 v44, v19, s69, v44 bitop3:0xbe
  v_bitop3_b32 v44, v23, s69, v44 bitop3:0xbe
  v_cmp_lt_u32 s[92:93], 1, v44
  s_mov_b32 s94, 0
  s_cmp_eq_u64 s[92:93], 0
  s_cbranch_scc1 L_p1d
  s_add_u32 s100, s100, 1
  s_cmp_gt_u32 s100, 100000
  s_cbranch_scc1 L_abort
  s_mov_b64 exec, s[60:61]
  s_cbranch_execz L_ll_37
  buffer_load_dwordx4 v[8:11], v35, s[32:35], s70 offen offset:0 sc1
L_ll_37:
  s_mov_b64 exec, s[62:63]
  s_cbranch_execz L_ll_38
  buffer_load_dwordx4 v[12:15], v35, s[32:35], s71 offen offset:0 sc1
L_ll_38:
  s_mov_b64 exec, s[64:65]
  s_cbranch_execz L_ll_39
  buffer_load_dwordx4 v[16:19], v35, s[32:35], 0 offen offset:0 sc1
L_ll_39:
  s_mov_b64 exec, s[66:67]
  s_cbranch_execz L_ll_40
  buffer_load_dwordx4 v[20:23], v35, s[32:35], s72 offen offset:0 sc1
L_ll_40:
  s_mov_b64 exec, -1
L_p1d:
  s_bitcmp1_b32 s73, 0
  s_cbranch_scc1 L_lp_41
  s_cmp_lg_u64 s[60:61], 0
  s_cbranch_scc1 L_lp_41
  s_bitset1_b32 s73, 0
  s_add_u32 s94, s94, 1
  buffer_load_dwordx4 v[128:131], v36, s[32:35], s83 offen offset:0 sc1
L_lp_41:
  s_bitcmp1_b32 s73, 1
  s_cbranch_scc1 L_lp_42
  s_cmp_lg_u64 s[62:63], 0
  s_cbranch_scc1 L_lp_42
  s_bitset1_b32 s73, 1
  s_add_u32 s94, s94, 1
  buffer_load_dwordx4 v[132:135], v36, s[32:35], s84 offen offset:0 sc1
L_lp_42:
  s_bitcmp1_b32 s73, 2
  s_cbranch_scc1 L_lp_43
  s_cmp_lg_u64 s[64:65], 0
  s_cbranch_scc1 L_lp_43
  s_bitset1_b32 s73, 2
  s_add_u32 s94, s94, 1
  buffer_load_dwordx4 v[136:139], v36, s[32:35], s85 offen offset:0 sc1
L_lp_43:
  s_bitcmp1_b32 s73, 3
  s_cbranch_scc1 L_lp_44
  s_cmp_lg_u64 s[66:67], 0
  s_cbranch_scc1 L_lp_44
  s_bitset1_b32 s73, 3
  s_add_u32 s94, s94, 1
  buffer_load_dwordx4 v[140:143], v36, s[32:35], s86 offen offset:0 sc1
L_lp_44:
  s_cmp_eq_u64 s[92:93], 0
  s_cbranch_scc1 L_p1x
  s_cmp_eq_u32 s94, 0
  s_cbranch_scc0 L_pw0
  s_waitcnt vmcnt(0)
  s_branch L_p1
L_pw0:
  s_cmp_eq_u32 s94, 1
  s_cbranch_scc0 L_pw1
  s_waitcnt vmcnt(1)
  s_branch L_p1
L_pw1:
  s_cmp_eq_u32 s94, 2
  s_cbranch_scc0 L_pw2
  s_waitcnt vmcnt(2)
  s_branch L_p1
L_pw2:
  s_cmp_eq_u32 s94, 3
  s_cbranch_scc0 L_pw3
  s_waitcnt vmcnt(3)
  s_branch L_p1
L_pw3:
  s_waitcnt vmcnt(4)
  s_branch L_p1
L_p1x:
  v_max3_f32 v44, v8, v12, v16
  v_max_f32 v44, v44, v20
  s_nop 1
  v_max_f32_dpp v44, v44, v44 row_ror:8 row_mask:0xf bank_mask:0xf
  v_mov_b32 v45, v44
  s_nop 1
  v_permlane16_swap_b32 v44, v45
  v_max_f32 v44, v44, v45
  v_mov_b32 v45, v44
  s_nop 1
  v_permlane32_swap_b32 v44, v45
  v_max_f32 v44, v44, v45
  s_lshl_b32 s92, s3, 2
  s_add_u32 s92, s92, 92160
  v_mov_b32 v47, s92
  v_mov_b32 v46, 92160
  ds_write_b32 v47, v44
  s_waitcnt lgkmcnt(0)
  s_barrier
  ds_read_b128 v[144:147], v46
  ds_read_b128 v[148:151], v46 offset:16
  ds_read_b64_tr_b16 v[48:49], v242 offset:0
  ds_read_b64_tr_b16 v[50:51], v242 offset:1152
  ds_read_b64_tr_b16 v[52:53], v242 offset:9728
  ds_read_b64_tr_b16 v[54:55], v242 offset:10880
  s_waitcnt lgkmcnt(4)
  v_max3_f32 v44, v144, v145, v146
  v_max3_f32 v45, v147, v148, v149
  v_max3_f32 v44, v44, v150, v151
  v_max_f32 v44, v44, v45
  v_sub_f32 v152, v8, v44
  v_sub_f32 v153, v12, v44
  v_sub_f32 v154, v16, v44
  v_sub_f32 v155, v20, v44
  v_exp_f32 v152, v152
  v_exp_f32 v153, v153
  v_exp_f32 v154, v154
  v_exp_f32 v155, v155
  v_cvt_pk_bf16_f32 v152, v152, v152
  v_cvt_pk_bf16_f32 v153, v153, v153
  v_cvt_pk_bf16_f32 v154, v154, v154
  v_cvt_pk_bf16_f32 v155, v155, v155
  v_lshrrev_b32 v156, 16, v152
  v_lshrrev_b32 v157, 16, v153
  v_lshrrev_b32 v158, 16, v154
  v_lshrrev_b32 v159, 16, v155
  v_and_b32 v152, 0xffff0000, v152
  v_and_b32 v153, 0xffff0000, v153
  v_and_b32 v154, 0xffff0000, v154
  v_and_b32 v155, 0xffff0000, v155
  v_mul_f32 v44, v152, v9
  v_fmac_f32 v44, v153, v13
  v_fmac_f32 v44, v154, v17
  v_fmac_f32 v44, v155, v21
  s_nop 1
  v_add_f32_dpp v44, v44, v44 row_ror:8 row_mask:0xf bank_mask:0xf
  v_mov_b32 v45, v44
  s_nop 1
  v_permlane16_swap_b32 v44, v45
  v_add_f32 v44, v44, v45
  v_mov_b32 v45, v44
  s_nop 1
  v_permlane32_swap_b32 v44, v45
  v_add_f32 v44, v44, v45
  ds_write_b32 v47, v44 offset:32
  s_cmp_lt_u32 s2, 128
  s_cbranch_scc1 L_fgA
  ds_read_b64_tr_b16 v[80:81], v63 offset:0
  ds_read_b64_tr_b16 v[82:83], v63 offset:3712
  ds_read_b64_tr_b16 v[84:85], v63 offset:32
  ds_read_b64_tr_b16 v[86:87], v63 offset:3744
  ds_read_b64_tr_b16 v[88:89], v63 offset:448
  ds_read_b64_tr_b16 v[90:91], v63 offset:4160
  ds_read_b64_tr_b16 v[92:93], v63 offset:480
  ds_read_b64_tr_b16 v[94:95], v63 offset:4192
  s_branch L_fgx
L_fgA:
  ds_read_b64_tr_b16 v[80:81], v243 offset:0
  ds_read_b64_tr_b16 v[82:83], v243 offset:1152
  ds_read_b64_tr_b16 v[84:85], v243 offset:9728
  ds_read_b64_tr_b16 v[86:87], v243 offset:10880
  ds_read_b64_tr_b16 v[88:89], v243 offset:19456
  ds_read_b64_tr_b16 v[90:91], v243 offset:20608
  ds_read_b64_tr_b16 v[92:93], v243 offset:29184
  ds_read_b64_tr_b16 v[94:95], v243 offset:30336
L_fgx:
  s_waitcnt lgkmcnt(0)
  s_barrier
  ds_read_b128 v[160:163], v46 offset:32
  ds_read_b128 v[164:167], v46 offset:48
  v_mov_b32 v144, 0
  v_mov_b32 v145, 0
  v_mov_b32 v146, 0
  v_mov_b32 v147, 0
  v_mov_b32 v148, 0
  v_mov_b32 v149, 0
  v_mov_b32 v150, 0
  v_mov_b32 v151, 0
  s_waitcnt lgkmcnt(0)
  v_add_f32 v160, v160, v161
  v_add_f32 v162, v162, v163
  v_add_f32 v164, v164, v165
  v_add_f32 v166, v166, v167
  v_add_f32 v160, v160, v162
  v_add_f32 v164, v164, v166
  v_add_f32 v160, v160, v164
  v_rcp_f32 v168, v160
  s_bitcmp1_b32 s73, 0
  s_cbranch_scc1 L_ir_45
  buffer_load_dwordx4 v[128:131], v36, s[32:35], s83 offen offset:0 sc1
L_ir_45:
  s_bitcmp1_b32 s73, 1
  s_cbranch_scc1 L_ir_46
  buffer_load_dwordx4 v[132:135], v36, s[32:35], s84 offen offset:0 sc1
L_ir_46:
  s_bitcmp1_b32 s73, 2
  s_cbranch_scc1 L_ir_47
  buffer_load_dwordx4 v[136:139], v36, s[32:35], s85 offen offset:0 sc1
L_ir_47:
  s_bitcmp1_b32 s73, 3
  s_cbranch_scc1 L_ir_48
  buffer_load_dwordx4 v[140:143], v36, s[32:35], s86 offen offset:0 sc1
L_ir_48:
  s_or_b32 s73, s73, 15
  s_mov_b32 s100, 0
L_p2:
  s_mov_b32 s95, s73
  s_waitcnt vmcnt(0)
  s_bitcmp1_b32 s95, 0
  s_cbranch_scc0 L_dc_49
  s_bitcmp1_b32 s95, 4
  s_cbranch_scc1 L_dc_49
  v_xor_b32 v44, v128, v4
  v_bitop3_b32 v44, v129, v5, v44 bitop3:0xbe
  v_bitop3_b32 v44, v130, v6, v44 bitop3:0xbe
  v_bitop3_b32 v44, v131, v7, v44 bitop3:0xbe
  v_and_b32 v44, s53, v44
  v_cmp_ne_u32 vcc, 0, v44
  s_nop 0
  s_cbranch_vccz L_dc_49k
  s_sleep 1
  buffer_load_dwordx4 v[128:131], v36, s[32:35], s83 offen offset:0 sc1
  s_branch L_dc_49
L_dc_49k:
  s_bitset1_b32 s73, 4
  v_dot2c_f32_bf16 v144, v156, v128
  v_dot2c_f32_bf16 v145, v152, v128
  v_dot2c_f32_bf16 v146, v156, v129
  v_dot2c_f32_bf16 v147, v152, v129
  v_dot2c_f32_bf16 v148, v156, v130
  v_dot2c_f32_bf16 v149, v152, v130
  v_dot2c_f32_bf16 v150, v156, v131
  v_dot2c_f32_bf16 v151, v152, v131
L_dc_49:
  s_bitcmp1_b32 s95, 1
  s_nop 0
  s_cbranch_scc0 L_dc_50
  s_bitcmp1_b32 s95, 5
  s_cbranch_scc1 L_dc_50
  v_xor_b32 v44, v132, v4
  v_bitop3_b32 v44, v133, v5, v44 bitop3:0xbe
  v_bitop3_b32 v44, v134, v6, v44 bitop3:0xbe
  v_bitop3_b32 v44, v135, v7, v44 bitop3:0xbe
  v_and_b32 v44, s53, v44
  v_cmp_ne_u32 vcc, 0, v44
  s_nop 0
  s_cbranch_vccz L_dc_50k
  s_sleep 1
  buffer_load_dwordx4 v[132:135], v36, s[32:35], s84 offen offset:0 sc1
  s_branch L_dc_50
L_dc_50k:
  s_bitset1_b32 s73, 5
  v_dot2c_f32_bf16 v144, v157, v132
  v_dot2c_f32_bf16 v145, v153, v132
  v_dot2c_f32_bf16 v146, v157, v133
  v_dot2c_f32_bf16 v147, v153, v133
  v_dot2c_f32_bf16 v148, v157, v134
  v_dot2c_f32_bf16 v149, v153, v134
  v_dot2c_f32_bf16 v150, v157, v135
  v_dot2c_f32_bf16 v151, v153, v135
L_dc_50:
  s_bitcmp1_b32 s95, 2
  s_nop 0
  s_cbranch_scc0 L_dc_51
  s_bitcmp1_b32 s95, 6
  s_cbranch_scc1 L_dc_51
  v_xor_b32 v44, v136, v4
  v_bitop3_b32 v44, v137, v5, v44 bitop3:0xbe
  v_bitop3_b32 v44, v138, v6, v44 bitop3:0xbe
  v_bitop3_b32 v44, v139, v7, v44 bitop3:0xbe
  v_and_b32 v44, s53, v44
  v_cmp_ne_u32 vcc, 0, v44
  s_nop 0
  s_cbranch_vccz L_dc_51k
  s_sleep 1
  buffer_load_dwordx4 v[136:139], v36, s[32:35], s85 offen offset:0 sc1
  s_branch L_dc_51
L_dc_51k:
  s_bitset1_b32 s73, 6
  v_dot2c_f32_bf16 v144, v158, v136
  v_dot2c_f32_bf16 v145, v154, v136
  v_dot2c_f32_bf16 v146, v158, v137
  v_dot2c_f32_bf16 v147, v154, v137
  v_dot2c_f32_bf16 v148, v158, v138
  v_dot2c_f32_bf16 v149, v154, v138
  v_dot2c_f32_bf16 v150, v158, v139
  v_dot2c_f32_bf16 v151, v154, v139
L_dc_51:
  s_bitcmp1_b32 s95, 3
  s_nop 0
  s_cbranch_scc0 L_dc_52
  s_bitcmp1_b32 s95, 7
  s_cbranch_scc1 L_dc_52
  v_xor_b32 v44, v140, v4
  v_bitop3_b32 v44, v141, v5, v44 bitop3:0xbe
  v_bitop3_b32 v44, v142, v6, v44 bitop3:0xbe
  v_bitop3_b32 v44, v143, v7, v44 bitop3:0xbe
  v_and_b32 v44, s53, v44
  v_cmp_ne_u32 vcc, 0, v44
  s_nop 0
  s_cbranch_vccz L_dc_52k
  s_sleep 1
  buffer_load_dwordx4 v[140:143], v36, s[32:35], s86 offen offset:0 sc1
  s_branch L_dc_52
L_dc_52k:
  s_bitset1_b32 s73, 7
  v_dot2c_f32_bf16 v144, v159, v140
  v_dot2c_f32_bf16 v145, v155, v140
  v_dot2c_f32_bf16 v146, v159, v141
  v_dot2c_f32_bf16 v147, v155, v141
  v_dot2c_f32_bf16 v148, v159, v142
  v_dot2c_f32_bf16 v149, v155, v142
  v_dot2c_f32_bf16 v150, v159, v143
  v_dot2c_f32_bf16 v151, v155, v143
L_dc_52:
  s_cmp_eq_u32 s73, 0xff
  s_nop 0
  s_cbranch_scc1 L_p2x
  s_add_u32 s100, s100, 1
  s_cmp_gt_u32 s100, 100000
  s_cbranch_scc1 L_abort
  s_branch L_p2
L_p2x:
  v_permlane32_swap_b32 v144, v148
  v_permlane32_swap_b32 v145, v149
  v_permlane32_swap_b32 v146, v150
  v_permlane32_swap_b32 v147, v151
  v_add_f32 v144, v144, v148
  v_add_f32 v145, v145, v149
  v_add_f32 v146, v146, v150
  v_add_f32 v147, v147, v151
  s_nop 0
  v_permlane16_swap_b32 v144, v146
  v_permlane16_swap_b32 v145, v147
  v_add_f32 v144, v144, v146
  v_add_f32 v145, v145, v147
  s_nop 0
  v_add_f32_dpp v144, v144, v144 row_ror:8 row_mask:0xf bank_mask:0xf
  v_add_f32_dpp v145, v145, v145 row_ror:8 row_mask:0xf bank_mask:0xf
  v_mul_f32 v144, v144, v168
  v_mul_f32 v145, v145, v168
  v_cvt_pk_bf16_f32 v44, v144, v145
  ds_write_b32 v37, v44
  s_waitcnt lgkmcnt(0)
  s_barrier
  ds_read_b128 v[160:163], v38
  ds_read_b128 v[164:167], v38 offset:64
  s_waitcnt lgkmcnt(1)
  v_mfma_f32_16x16x32_bf16 v[144:147], v[48:51], v[160:163], 0
  s_waitcnt lgkmcnt(0)
  v_mfma_f32_16x16x32_bf16 v[144:147], v[52:55], v[164:167], v[144:147]
  s_nop 7
  v_add_f32_dpp v144, v144, v144 quad_perm:[1,0,3,2] row_mask:0xf bank_mask:0xf
  v_add_f32_dpp v145, v145, v145 quad_perm:[1,0,3,2] row_mask:0xf bank_mask:0xf
  v_add_f32_dpp v146, v146, v146 quad_perm:[1,0,3,2] row_mask:0xf bank_mask:0xf
  v_add_f32_dpp v147, v147, v147 quad_perm:[1,0,3,2] row_mask:0xf bank_mask:0xf
  v_add_f32_dpp v144, v144, v144 quad_perm:[2,3,0,1] row_mask:0xf bank_mask:0xf
  v_add_f32_dpp v145, v145, v145 quad_perm:[2,3,0,1] row_mask:0xf bank_mask:0xf
  v_add_f32_dpp v146, v146, v146 quad_perm:[2,3,0,1] row_mask:0xf bank_mask:0xf
  v_add_f32_dpp v147, v147, v147 quad_perm:[2,3,0,1] row_mask:0xf bank_mask:0xf
  v_add_f32_dpp v144, v144, v144 row_half_mirror row_mask:0xf bank_mask:0xf
  v_add_f32_dpp v145, v145, v145 row_half_mirror row_mask:0xf bank_mask:0xf
  v_add_f32_dpp v146, v146, v146 row_half_mirror row_mask:0xf bank_mask:0xf
  v_add_f32_dpp v147, v147, v147 row_half_mirror row_mask:0xf bank_mask:0xf
  s_mov_b32 exec_lo, 0x10001
  s_mov_b32 exec_hi, 0x10001
  v_and_or_b32 v144, v144, v2, s49
  v_and_or_b32 v145, v145, v2, s50
  v_and_or_b32 v146, v146, v2, s51
  v_and_or_b32 v147, v147, v2, s52
  buffer_store_dwordx4 v[144:147], v1, s[32:35], s16 offen
  v_mov_b32 v8, v144
  v_mov_b32 v9, v145
  v_mov_b32 v10, v146
  v_mov_b32 v11, v147
  s_mov_b64 exec, -1
  s_mov_b32 s69, 0
  s_mov_b32 s66, 0
  s_cmp_lt_u32 s2, 128
  s_cbranch_scc0 L_X
  s_mov_b32 s60, 0xffffffff
  s_mov_b32 s61, 0x0
  s_mov_b32 s100, 0
  s_branch L_gf_54
L_g_53:
  s_add_u32 s100, s100, 1
  s_cmp_gt_u32 s100, 100000
  s_cbranch_scc1 L_abort
  s_sleep 1
  s_cmp_lg_u32 s100, 30
  s_cbranch_scc1 L_alt_56
  s_cmp_lg_u32 s69, 0
  s_cbranch_scc1 L_cg_57
  s_mov_b32 exec_lo, 0x10001
  s_mov_b32 exec_hi, 0x10001
  s_add_u32 s97, s16, 0x160000
  buffer_store_dwordx4 v[8:11], v1, s[32:35], s97 offen sc1
  s_mov_b32 s69, 1
  s_mov_b64 exec, -1
L_cg_57:
  s_add_u32 s66, s66, 0x160000
L_alt_56:
L_gf_54:
  s_mov_b64 exec, s[60:61]
  buffer_load_dwordx4 v[128:131], v39, s[32:35], s66 offen offset:0 sc1
  s_waitcnt vmcnt(0)
L_gc_55:
  s_mov_b64 exec, s[60:61]
  v_perm_b32 v44, v129, v128, s56
  v_perm_b32 v44, v130, v44, s57
  v_perm_b32 v44, v131, v44, s58
  v_cmp_ne_u32 s[60:61], s48, v44
  s_nop 0
  s_cmp_lg_u64 s[60:61], 0
  s_cbranch_scc1 L_g_53
  s_mov_b64 exec, -1
  v_cvt_pk_bf16_f32 v44, v128, v129
  v_cvt_pk_bf16_f32 v45, v130, v131
  s_mov_b32 exec_hi, 0
  ds_write_b64 v43, v[44:45]
  s_mov_b32 exec_hi, -1
  s_cmp_lg_u32 s69, 0
  s_cbranch_scc1 L_cg_59
  s_mov_b32 exec_lo, 0x10001
  s_mov_b32 exec_hi, 0x10001
  s_add_u32 s97, s16, 0x160000
  buffer_store_dwordx4 v[8:11], v1, s[32:35], s97 offen sc1
  s_mov_b32 s69, 1
  s_mov_b64 exec, -1
L_cg_59:
  s_waitcnt lgkmcnt(0)
  s_barrier
  ds_read_b128 v[128:131], v40 offset:0
  ds_read_b128 v[132:135], v40 offset:64
  ds_read_b128 v[136:139], v40 offset:128
  ds_read_b128 v[140:143], v40 offset:192
  s_waitcnt lgkmcnt(3)
  v_mfma_f32_16x16x32_bf16 v[144:147], v[80:83], v[128:131], 0
  s_waitcnt lgkmcnt(2)
  v_mfma_f32_16x16x32_bf16 v[144:147], v[84:87], v[132:135], v[144:147]
  s_waitcnt lgkmcnt(1)
  v_mfma_f32_16x16x32_bf16 v[144:147], v[88:91], v[136:139], v[144:147]
  s_waitcnt lgkmcnt(0)
  v_mfma_f32_16x16x32_bf16 v[144:147], v[92:95], v[140:143], v[144:147]
  s_nop 7
  v_add_f32_dpp v144, v144, v144 quad_perm:[1,0,3,2] row_mask:0xf bank_mask:0xf
  v_add_f32_dpp v145, v145, v145 quad_perm:[1,0,3,2] row_mask:0xf bank_mask:0xf
  v_add_f32_dpp v146, v146, v146 quad_perm:[1,0,3,2] row_mask:0xf bank_mask:0xf
  v_add_f32_dpp v147, v147, v147 quad_perm:[1,0,3,2] row_mask:0xf bank_mask:0xf
  v_add_f32_dpp v144, v144, v144 quad_perm:[2,3,0,1] row_mask:0xf bank_mask:0xf
  v_add_f32_dpp v145, v145, v145 quad_perm:[2,3,0,1] row_mask:0xf bank_mask:0xf
  v_add_f32_dpp v146, v146, v146 quad_perm:[2,3,0,1] row_mask:0xf bank_mask:0xf
  v_add_f32_dpp v147, v147, v147 quad_perm:[2,3,0,1] row_mask:0xf bank_mask:0xf
  v_add_f32_dpp v144, v144, v144 row_half_mirror row_mask:0xf bank_mask:0xf
  v_add_f32_dpp v145, v145, v145 row_half_mirror row_mask:0xf bank_mask:0xf
  v_add_f32_dpp v146, v146, v146 row_half_mirror row_mask:0xf bank_mask:0xf
  v_add_f32_dpp v147, v147, v147 row_half_mirror row_mask:0xf bank_mask:0xf
  s_mov_b32 exec_lo, 0x10001
  s_mov_b32 exec_hi, 0x10001
  v_and_or_b32 v144, v144, v2, s49
  v_and_or_b32 v145, v145, v2, s50
  v_and_or_b32 v146, v146, v2, s51
  v_and_or_b32 v147, v147, v2, s52
  buffer_store_dwordx4 v[144:147], v1, s[32:35], s75 offen sc1
  s_mov_b64 exec, -1
  s_branch L_Y
L_X:
  s_cmp_lg_u32 s69, 0
  s_cbranch_scc1 L_cg_60
  s_mov_b32 exec_lo, 0x10001
  s_mov_b32 exec_hi, 0x10001
  s_add_u32 s97, s16, 0x160000
  buffer_store_dwordx4 v[8:11], v1, s[32:35], s97 offen sc1
  s_mov_b32 s69, 1
  s_mov_b64 exec, -1
L_cg_60:
  s_lshl_b32 s92, s79, 6
  v_and_b32 v44, 31, v1
  v_lshlrev_b32 v44, 1, v44
  v_add_u32 v44, s92, v44
  global_load_ushort v66, v44, s[4:5]
  s_movk_i32 s68, 0x4000
  buffer_load_dwordx4 v[68:71], v56, s[32:35], 0 offen offset:0 sc1
  buffer_load_dwordx4 v[72:75], v56, s[32:35], s68 offen offset:0 sc1
  s_waitcnt vmcnt(0)
  s_mov_b64 s[60:61], -1
  s_waitcnt vmcnt(63)
  s_mov_b32 s100, 0
  s_branch L_gc_64
L_g_62:
  s_add_u32 s100, s100, 1
  s_cmp_gt_u32 s100, 100000
  s_cbranch_scc1 L_abort
  s_sleep 2
L_gf_63:
  s_mov_b64 exec, s[60:61]
  buffer_load_dwordx4 v[68:71], v56, s[32:35], 0 offen offset:0 sc1
  buffer_load_dwordx4 v[72:75], v56, s[32:35], s68 offen offset:0 sc1
  s_waitcnt vmcnt(0)
L_gc_64:
  s_mov_b64 exec, s[60:61]
  v_perm_b32 v44, v69, v68, s56
  v_perm_b32 v44, v70, v44, s57
  v_perm_b32 v44, v71, v44, s58
  v_cmp_ne_u32 s[60:61], s48, v44
  v_perm_b32 v44, v73, v72, s56
  v_perm_b32 v44, v74, v44, s57
  v_perm_b32 v44, v75, v44, s58
  v_cmp_ne_u32 vcc, s48, v44
  s_nop 0
  s_or_b64 s[60:61], s[60:61], vcc
  s_cmp_lg_u64 s[60:61], 0
  s_cbranch_scc1 L_g_62
  s_mov_b64 exec, -1
  v_permlane32_swap_b32 v68, v70
  v_permlane32_swap_b32 v69, v71
  v_add_f32 v68, v68, v70
  v_add_f32 v69, v69, v71
  s_nop 1
  v_permlane16_swap_b32 v68, v69
  v_add_f32 v68, v68, v69
  v_permlane32_swap_b32 v72, v74
  v_permlane32_swap_b32 v73, v75
  v_add_f32 v72, v72, v74
  v_add_f32 v73, v73, v75
  s_nop 1
  v_permlane16_swap_b32 v72, v73
  v_add_f32 v72, v72, v73
  v_cvt_pk_bf16_f32 v44, v68, v68
  v_and_b32 v68, 0xffff0000, v44
  v_cvt_pk_bf16_f32 v45, v72, v72
  v_and_b32 v72, 0xffff0000, v45
  v_and_b32 v44, 3, v1
  v_lshlrev_b32 v44, 6, v44
  v_bfe_u32 v3, v1, 2, 3
  v_lshl_add_u32 v44, v3, 2, v44
  ds_bpermute_b32 v76, v44, v68 offset:0
  ds_bpermute_b32 v77, v44, v68 offset:32
  ds_bpermute_b32 v78, v44, v72 offset:0
  ds_bpermute_b32 v79, v44, v72 offset:32
  s_lshr_b32 s92, s82, 12
  s_lshl_b32 s92, s92, 12
  s_add_u32 s94, s82, s92
  s_add_u32 s94, s94, 1114112
  s_add_u32 s82, s82, 851968
  v_bfe_u32 v45, v1, 2, 1
  v_lshlrev_b32 v45, 6, v45
  v_add_u32 v45, v45, v41
  v_bfe_u32 v69, v1, 2, 1
  v_lshlrev_b32 v69, 12, v69
  v_and_b32 v3, 3, v1
  v_lshl_add_u32 v69, v3, 6, v69
  v_lshrrev_b32 v3, 4, v1
  v_lshl_add_u32 v69, v3, 4, v69
  s_waitcnt lgkmcnt(0)
  v_add_f32 v78, 1.0, v78
  v_lshlrev_b32 v66, 16, v66
  v_cvt_pk_bf16_f32 v44, v78, v78
  v_and_b32 v78, 0xffff0000, v44
  s_cmp_eq_u32 s3, 7
  s_cbranch_scc1 L_ab_61
  ds_write_b16_d16_hi v57, v78
  ds_write_b16_d16_hi v57, v77 offset:64
  ds_read_b128 v[72:75], v45
  s_waitcnt lgkmcnt(0)
  v_mfma_f32_16x16x32_bf16 v[208:211], v[80:83], v[72:75], 0
  v_mfma_f32_16x16x32_bf16 v[212:215], v[84:87], v[72:75], 0
  v_mfma_f32_16x16x32_bf16 v[216:219], v[88:91], v[72:75], 0
  v_mfma_f32_16x16x32_bf16 v[220:223], v[92:95], v[72:75], 0
  s_mov_b32 exec_lo, 0x220022
  s_mov_b32 exec_hi, 0x220022
  s_nop 3
  v_mov_b32 v208, v212
  v_mov_b32 v209, v213
  v_mov_b32 v210, v214
  v_mov_b32 v211, v215
  s_mov_b32 exec_lo, 0x440044
  s_mov_b32 exec_hi, 0x440044
  v_mov_b32 v208, v216
  v_mov_b32 v209, v217
  v_mov_b32 v210, v218
  v_mov_b32 v211, v219
  s_mov_b32 exec_lo, 0x880088
  s_mov_b32 exec_hi, 0x880088
  v_mov_b32 v208, v220
  v_mov_b32 v209, v221
  v_mov_b32 v210, v222
  v_mov_b32 v211, v223
  s_mov_b32 exec_lo, 0xff00ff
  s_mov_b32 exec_hi, 0xff00ff
  v_and_or_b32 v208, v208, v2, s49
  v_and_or_b32 v209, v209, v2, s50
  v_and_or_b32 v210, v210, v2, s51
  v_and_or_b32 v211, v211, v2, s52
  buffer_store_dwordx4 v[208:211], v69, s[32:35], s94 offen sc1
  s_mov_b64 exec, -1
L_ab_61:
  v_mov_b32 v112, 0
  v_mov_b32 v113, 0
  v_mov_b32 v114, 0
  v_mov_b32 v115, 0
  s_mov_b32 s60, 0xffffffff
  s_mov_b32 s61, 0x0
  s_mov_b32 s100, 0
  s_branch L_gf_67
L_g_66:
  s_add_u32 s100, s100, 1
  s_cmp_gt_u32 s100, 100000
  s_cbranch_scc1 L_abort
  s_sleep 4
L_gf_67:
  s_mov_b64 exec, s[60:61]
  buffer_load_dwordx4 v[112:115], v61, s[32:35], s90 offen offset:0 sc1
  s_waitcnt vmcnt(0)
L_gc_68:
  s_mov_b64 exec, s[60:61]
  v_perm_b32 v44, v113, v112, s56
  v_perm_b32 v44, v114, v44, s57
  v_perm_b32 v44, v115, v44, s58
  v_cmp_ne_u32 s[60:61], s48, v44
  s_nop 0
  s_cmp_lg_u64 s[60:61], 0
  s_cbranch_scc1 L_g_66
  s_mov_b64 exec, -1
  v_permlane32_swap_b32 v112, v114
  v_permlane32_swap_b32 v113, v115
  v_add_f32 v112, v112, v114
  v_add_f32 v113, v113, v115
  s_nop 1
  v_permlane16_swap_b32 v112, v113
  v_add_f32 v112, v112, v113
  s_nop 1
  v_add_f32_dpp v112, v112, v112 row_ror:8 row_mask:0xf bank_mask:0xf
  ds_write_b32 v59, v112
  s_waitcnt lgkmcnt(0)
  s_barrier
  ds_read_b128 v[112:115], v60
  ds_read_b128 v[116:119], v60 offset:16
  s_waitcnt lgkmcnt(0)
  v_add_f32 v112, v112, v113
  v_add_f32 v114, v114, v115
  v_add_f32 v116, v116, v117
  v_add_f32 v118, v118, v119
  v_add_f32 v112, v112, v114
  v_add_f32 v116, v116, v118
  v_add_f32 v112, v112, v116
  v_cvt_pk_bf16_f32 v44, v112, v112
  v_and_b32 v112, 0xffff0000, v44
  v_mul_f32 v67, v76, v112
  v_cvt_pk_bf16_f32 v44, v67, v67
  v_and_b32 v67, 0xffff0000, v44
  v_add_f32 v67, v66, v67
  v_cvt_pk_bf16_f32 v44, v67, v67
  v_and_b32 v67, 0xffff0000, v44
  s_cmp_eq_u32 s3, 7
  s_cbranch_scc1 L_stat
  v_mul_f32 v44, v67, v78
  v_cvt_pk_bf16_f32 v44, v44, v44
  ds_write_b16 v57, v44
  ds_read_b128 v[160:163], v41
  s_mov_b32 s70, 0x20002
  s_mov_b32 s71, 0x20002
  s_mov_b32 s72, 0x40004
  s_mov_b32 s73, 0x40004
  s_mov_b32 s74, 0x80008
  s_mov_b32 s75, 0x80008
  s_waitcnt lgkmcnt(0)
  v_mfma_f32_16x16x32_bf16 v[128:131], v[80:83], v[160:163], 0
  v_mfma_f32_16x16x32_bf16 v[132:135], v[84:87], v[160:163], 0
  v_mfma_f32_16x16x32_bf16 v[136:139], v[88:91], v[160:163], 0
  v_mfma_f32_16x16x32_bf16 v[140:143], v[92:95], v[160:163], 0
  s_nop 5
  v_cndmask_b32 v128, v128, v132, s[70:71]
  v_cndmask_b32 v129, v129, v133, s[70:71]
  v_cndmask_b32 v130, v130, v134, s[70:71]
  v_cndmask_b32 v131, v131, v135, s[70:71]
  v_cndmask_b32 v128, v128, v136, s[72:73]
  v_cndmask_b32 v129, v129, v137, s[72:73]
  v_cndmask_b32 v130, v130, v138, s[72:73]
  v_cndmask_b32 v131, v131, v139, s[72:73]
  v_cndmask_b32 v128, v128, v140, s[74:75]
  v_cndmask_b32 v129, v129, v141, s[74:75]
  v_cndmask_b32 v130, v130, v142, s[74:75]
  v_cndmask_b32 v131, v131, v143, s[74:75]
  v_and_or_b32 v128, v128, v2, s49
  v_and_or_b32 v129, v129, v2, s50
  v_and_or_b32 v130, v130, v2, s51
  v_and_or_b32 v131, v131, v2, s52
  s_mov_b32 exec_lo, 0xf000f
  s_mov_b32 exec_hi, 0xf000f
  buffer_store_dwordx4 v[128:131], v58, s[32:35], s82 offen
  s_add_u32 s97, s82, 0xf0000
  buffer_store_dwordx4 v[128:131], v58, s[32:35], s97 offen sc1
  s_mov_b64 exec, -1
  s_branch L_xdone
L_stat:
  v_mov_b32 v130, v67
  v_mul_f32 v131, v67, v67
  s_nop 0
  v_add_f32_dpp v130, v130, v130 row_ror:8 row_mask:0xf bank_mask:0xf
  v_add_f32_dpp v131, v131, v131 row_ror:8 row_mask:0xf bank_mask:0xf
  s_nop 0
  v_add_f32_dpp v130, v130, v130 row_ror:4 row_mask:0xf bank_mask:0xf
  v_add_f32_dpp v131, v131, v131 row_ror:4 row_mask:0xf bank_mask:0xf
  s_nop 0
  v_add_f32_dpp v130, v130, v130 row_ror:2 row_mask:0xf bank_mask:0xf
  v_add_f32_dpp v131, v131, v131 row_ror:2 row_mask:0xf bank_mask:0xf
  s_nop 0
  v_add_f32_dpp v130, v130, v130 row_ror:1 row_mask:0xf bank_mask:0xf
  v_add_f32_dpp v131, v131, v131 row_ror:1 row_mask:0xf bank_mask:0xf
  v_mov_b32 v128, v130
  v_mov_b32 v129, v131
  s_nop 0
  v_permlane16_swap_b32 v130, v128
  v_permlane16_swap_b32 v131, v129
  v_add_f32 v130, v130, v128
  v_add_f32 v131, v131, v129
  v_and_b32 v128, v2, v130
  v_and_b32 v129, v2, v131
  v_sub_f32 v130, v130, v128
  v_sub_f32 v131, v131, v129
  v_and_or_b32 v128, v128, v2, s49
  v_and_or_b32 v129, v129, v2, s50
  v_and_or_b32 v130, v130, v2, s51
  v_and_or_b32 v131, v131, v2, s52
  s_lshl_b32 s92, s80, 11
  s_lshl_b32 s97, s79, 7
  s_add_u32 s92, s92, s97
  s_add_u32 s92, s92, 0x18000
  s_mov_b64 exec, 1
  buffer_store_dwordx4 v[128:131], v1, s[32:35], s92 offen
  s_add_u32 s97, s92, 0x1e0000
  buffer_store_dwordx4 v[128:131], v1, s[32:35], s97 offen sc1
  s_mov_b64 exec, -1
  v_mov_b32 v112, 0
L_xdone:
  s_and_b32 s92, s79, 7
  s_cmp_lg_u32 s80, s92
  s_cbranch_scc1 L_fin
  s_mul_i32 s90, s79, 8448
  s_lshl_b32 s97, s3, 10
  s_add_u32 s90, s90, s97
  s_add_u32 s90, s90, 0xa0000
  s_lshl_b32 s92, s79, 6
  v_and_b32 v46, 31, v1
  v_lshlrev_b32 v46, 1, v46
  v_add_u32 v46, s92, v46
  s_cmp_eq_u32 s3, 7
  s_cbranch_scc1 L_nof
  s_mov_b64 s[60:61], -1
  s_mov_b32 s100, 0
  s_branch L_gf_71
L_g_70:
  s_add_u32 s100, s100, 1
  s_cmp_gt_u32 s100, 100000
  s_cbranch_scc1 L_abort
  s_sleep 1
L_gf_71:
  s_mov_b64 exec, s[60:61]
  buffer_load_dwordx4 v[112:115], v34, s[32:35], s90 offen offset:0 sc1
  s_waitcnt vmcnt(0)
L_gc_72:
  s_mov_b64 exec, s[60:61]
  v_perm_b32 v44, v113, v112, s56
  v_perm_b32 v44, v114, v44, s57
  v_perm_b32 v44, v115, v44, s58
  v_cmp_ne_u32 s[60:61], s48, v44
  s_nop 0
  s_cmp_lg_u64 s[60:61], 0
  s_cbranch_scc1 L_g_70
  s_mov_b64 exec, -1
  v_permlane32_swap_b32 v112, v114
  v_permlane32_swap_b32 v113, v115
  v_add_f32 v112, v112, v114
  v_add_f32 v113, v113, v115
  s_nop 1
  v_permlane16_swap_b32 v112, v113
  v_add_f32 v112, v112, v113
  s_nop 1
  v_add_f32_dpp v112, v112, v112 row_ror:8 row_mask:0xf bank_mask:0xf
L_nof:
  ds_write_b32 v59, v112 offset:1024
  s_waitcnt lgkmcnt(0)
  s_barrier
  s_cmp_lg_u32 s3, 0
  s_cbranch_scc1 L_fin
  ds_read_b128 v[112:115], v60 offset:1024
  ds_read_b128 v[116:119], v60 offset:1040
  s_waitcnt lgkmcnt(0)
  v_add_f32 v112, v112, v113
  v_add_f32 v114, v114, v115
  v_add_f32 v116, v116, v117
  v_add_f32 v118, v118, v119
  v_add_f32 v112, v112, v114
  v_add_f32 v116, v116, v118
  v_add_f32 v112, v112, v116
  v_cvt_pk_bf16_f32 v45, v112, v112
  v_and_b32 v112, 0xffff0000, v45
  v_mul_f32 v44, v79, v112
  v_cvt_pk_bf16_f32 v45, v44, v44
  v_and_b32 v44, 0xffff0000, v45
  v_add_f32 v44, v67, v44
  v_cvt_pk_bf16_f32 v44, v44, v44
  s_mov_b32 exec_hi, 0
  global_store_short v46, v44, s[28:29]
  s_cmp_lg_u32 s2, 128
  s_cbranch_scc1 L_noep
  s_mov_b64 exec, 1
  v_mov_b32 v45, 0
  global_store_dword v45, v45, s[30:31]
L_noep:
L_fin:
  s_endpgm
L_Y:
  s_cmp_ge_u32 s2, 112
  s_cbranch_scc1 L_fin
  s_lshl_b32 s94, s81, 13
  s_lshl_b32 s97, s3, 10
  s_add_u32 s94, s94, s97
  s_add_u32 s94, s94, 0x110000
  s_mov_b64 s[40:41], s[22:23]
  s_mov_b32 s42, 0x1c0000
  s_mov_b32 s43, 0x20000
  v_lshrrev_b32 v44, 5, v1
  v_lshlrev_b32 v44, 10, v44
  v_and_b32 v3, 31, v1
  v_lshl_add_u32 v44, v3, 4, v44
  buffer_load_dwordx4 v[176:179], v44, s[40:43], s91 offen offset:0 nt
  buffer_load_dwordx4 v[180:183], v44, s[40:43], s91 offen offset:2048 nt
  v_mov_b32 v112, 0
  v_mov_b32 v113, 0
  v_mov_b32 v114, 0
  v_mov_b32 v115, 0
  v_lshlrev_b32 v46, 4, v1
  v_add_u32 v46, 88064, v46
  v_lshlrev_b32 v47, 5, v1
  v_add_u32 v47, 83968, v47
  s_waitcnt vmcnt(0)
  s_mov_b64 s[60:61], -1
  s_mov_b32 s100, 0
  s_branch L_gf_75
L_g_74:
  s_add_u32 s100, s100, 1
  s_cmp_gt_u32 s100, 100000
  s_cbranch_scc1 L_abort
  s_sleep 2
L_gf_75:
  s_mov_b64 exec, s[60:61]
  buffer_load_dwordx4 v[76:79], v34, s[32:35], s94 offen offset:0 sc1
  s_waitcnt vmcnt(0)
L_gc_76:
  s_mov_b64 exec, s[60:61]
  v_perm_b32 v44, v77, v76, s56
  v_perm_b32 v44, v78, v44, s57
  v_perm_b32 v44, v79, v44, s58
  v_cmp_ne_u32 s[60:61], s48, v44
  s_nop 0
  s_cmp_lg_u64 s[60:61], 0
  s_cbranch_scc1 L_g_74
  s_mov_b64 exec, -1
  v_permlane32_swap_b32 v76, v78
  v_permlane32_swap_b32 v77, v79
  v_add_f32 v76, v76, v78
  v_add_f32 v77, v77, v79
  s_nop 1
  v_permlane16_swap_b32 v76, v77
  v_add_f32 v76, v76, v77
  s_waitcnt vmcnt(0)
  ds_write_b128 v62, v[176:179] offset:0
  ds_write_b128 v62, v[180:183] offset:1088
  ds_write_b32 v60, v76
  s_waitcnt lgkmcnt(0)
  s_barrier
  ds_read_b128 v[128:131], v46
  ds_read_b128 v[132:135], v46 offset:1024
  ds_read_b64_tr_b16 v[68:69], v63 offset:0
  ds_read_b64_tr_b16 v[70:71], v63 offset:2176
  ds_read_b64_tr_b16 v[72:73], v63 offset:32
  ds_read_b64_tr_b16 v[74:75], v63 offset:2208
  s_waitcnt lgkmcnt(4)
  v_add_f32 v128, v128, v129
  v_add_f32 v130, v130, v131
  v_add_f32 v128, v128, v130
  v_add_f32 v132, v132, v133
  v_add_f32 v134, v134, v135
  v_add_f32 v132, v132, v134
  s_mov_b32 s66, 0
  s_mov_b32 s60, 0xffffffff
  s_mov_b32 s61, 0x0
  s_mov_b32 s62, 0xffff
  s_mov_b32 s63, 0x0
  s_mov_b32 s100, 0
  s_branch L_gf_79
L_g_78:
  s_add_u32 s100, s100, 1
  s_cmp_gt_u32 s100, 100000
  s_cbranch_scc1 L_abort
  s_sleep 1
  s_cmp_lg_u32 s100, 30
  s_cbranch_scc1 L_alt_81
  s_add_u32 s82, s82, 0xf0000
  s_add_u32 s66, s66, 0x1e0000
L_alt_81:
L_gf_79:
  s_mov_b64 exec, s[60:61]
  s_cbranch_execz L_gs_82
  buffer_load_dwordx4 v[112:115], v61, s[32:35], s82 offen offset:0 sc1
L_gs_82:
  s_mov_b64 exec, s[62:63]
  s_cbranch_execz L_gs_83
  buffer_load_dwordx4 v[136:139], v56, s[32:35], s66 offen offset:0 sc1
L_gs_83:
  s_waitcnt vmcnt(0)
L_gc_80:
  s_mov_b64 exec, s[60:61]
  v_perm_b32 v44, v113, v112, s56
  v_perm_b32 v44, v114, v44, s57
  v_perm_b32 v44, v115, v44, s58
  v_cmp_ne_u32 s[60:61], s48, v44
  s_mov_b64 exec, s[62:63]
  v_perm_b32 v44, v137, v136, s56
  v_perm_b32 v44, v138, v44, s57
  v_perm_b32 v44, v139, v44, s58
  v_cmp_ne_u32 s[62:63], s48, v44
  s_nop 0
  s_or_b64 s[96:97], s[60:61], s[62:63]
  s_cbranch_scc1 L_g_78
  s_mov_b64 exec, -1
  v_permlane32_swap_b32 v112, v114
  v_permlane32_swap_b32 v113, v115
  v_add_f32 v112, v112, v114
  v_add_f32 v113, v113, v115
  s_nop 1
  v_permlane16_swap_b32 v112, v113
  v_add_f32 v112, v112, v113
  ds_write_b32 v59, v112
  v_add_f32 v136, v136, v138
  v_add_f32 v137, v137, v139
  s_nop 0
  v_add_f32_dpp v136, v136, v136 quad_perm:[1,0,3,2] row_mask:0xf bank_mask:0xf
  v_add_f32_dpp v137, v137, v137 quad_perm:[1,0,3,2] row_mask:0xf bank_mask:0xf
  s_nop 0
  v_add_f32_dpp v136, v136, v136 quad_perm:[2,3,0,1] row_mask:0xf bank_mask:0xf
  v_add_f32_dpp v137, v137, v137 quad_perm:[2,3,0,1] row_mask:0xf bank_mask:0xf
  s_nop 0
  v_add_f32_dpp v136, v136, v136 row_half_mirror row_mask:0xf bank_mask:0xf
  v_add_f32_dpp v137, v137, v137 row_half_mirror row_mask:0xf bank_mask:0xf
  s_nop 0
  v_add_f32_dpp v136, v136, v136 row_ror:8 row_mask:0xf bank_mask:0xf
  v_add_f32_dpp v137, v137, v137 row_ror:8 row_mask:0xf bank_mask:0xf
  s_waitcnt lgkmcnt(0)
  s_barrier
  ds_read_b128 v[112:115], v47
  ds_read_b128 v[116:119], v47 offset:16
  v_readfirstlane_b32 s92, v136
  v_readfirstlane_b32 s93, v137
  v_mov_b32 v44, 0x3b000000
  v_mul_f32 v136, s92, v44
  v_mul_f32 v137, s93, v44
  v_fma_f32 v137, -v136, v136, v137
  v_max_f32 v137, 0, v137
  v_cvt_pk_bf16_f32 v45, v137, v137
  v_and_b32 v137, 0xffff0000, v45
  v_cvt_pk_bf16_f32 v44, v136, v136
  v_and_b32 v136, 0xffff0000, v44
  v_add_f32 v137, 0x3727c5ac, v137
  v_mul_f32 v128, v136, v128
  v_cvt_pk_bf16_f32 v45, v137, v137
  v_and_b32 v137, 0xffff0000, v45
  v_sqrt_f32 v137, v137
  s_nop 0
  v_cvt_pk_bf16_f32 v45, v137, v137
  v_and_b32 v137, 0xffff0000, v45
  v_rcp_f32 v137, v137
  s_waitcnt lgkmcnt(0)
  v_add_f32 v112, v112, v113
  v_add_f32 v114, v114, v115
  v_add_f32 v116, v116, v117
  v_add_f32 v118, v118, v119
  v_add_f32 v112, v112, v114
  v_add_f32 v116, v116, v118
  v_add_f32 v112, v112, v116
  v_sub_f32 v112, v112, v128
  v_fma_f32 v112, v112, v137, v132
  v_cvt_pk_bf16_f32 v44, v112, v112
  v_and_b32 v112, 0xffff0000, v44
  v_mul_f32 v44, v112, v112
  v_mov_b32 v45, 0xc0135761
  v_mov_b32_dpp v113, v112 row_ror:8 row_mask:0xf bank_mask:0xf
  v_fmac_f32 v45, 0xbdd2d3e8, v44
  v_mul_f32 v44, v45, v112
  v_exp_f32 v44, v44
  s_nop 0
  v_add_f32 v44, 1.0, v44
  v_rcp_f32 v44, v44
  s_nop 0
  v_mul_f32 v112, v112, v44
  v_cvt_pk_bf16_f32 v44, v112, v112
  v_and_b32 v112, 0xffff0000, v44
  v_mul_f32 v112, v112, v113
  v_cvt_pk_bf16_f32 v44, v112, v112
  s_mov_b32 exec_lo, 0xff00ff
  s_mov_b32 exec_hi, 0xff00ff
  ds_write_b16 v57, v44
  s_mov_b64 exec, -1
  ds_read_b128 v[160:163], v41
  s_mov_b32 s70, 0x20002
  s_mov_b32 s71, 0x20002
  s_waitcnt lgkmcnt(0)
  v_mfma_f32_16x16x32_bf16 v[144:147], v[68:71], v[160:163], 0
  v_mfma_f32_16x16x32_bf16 v[148:151], v[72:75], v[160:163], 0
  s_nop 7
  v_cndmask_b32 v144, v144, v148, s[70:71]
  v_cndmask_b32 v145, v145, v149, s[70:71]
  v_cndmask_b32 v146, v146, v150, s[70:71]
  v_cndmask_b32 v147, v147, v151, s[70:71]
  v_and_or_b32 v144, v144, v2, s49
  v_and_or_b32 v145, v145, v2, s50
  v_and_or_b32 v146, v146, v2, s51
  v_and_or_b32 v147, v147, v2, s52
  s_mov_b32 exec_lo, 0x30003
  s_mov_b32 exec_hi, 0x30003
  buffer_store_dwordx4 v[144:147], v58, s[32:35], s90 offen sc1
  s_endpgm
L_abort:
  s_endpgm
L_end:
  s_endpgm
L_codeend:
.section .rodata,"a"
.p2align 6
.amdhsa_kernel adaLN_cond__compressed_kv_cla__glu_gated_geglu__decode_kernel
  .amdhsa_next_free_vgpr 256
  .amdhsa_next_free_sgpr 102
  .amdhsa_accum_offset 256
  .amdhsa_group_segment_fixed_size 0
  .amdhsa_kernarg_size 120
  .amdhsa_user_sgpr_count 2
  .amdhsa_user_sgpr_kernarg_segment_ptr 1
  .amdhsa_system_sgpr_workgroup_id_x 1
.end_amdhsa_kernel
```

```asm
; @launch grid=(256,1,1) block=(512,1,1) lds=163840
.amdgcn_target "amdgcn-amd-amdhsa--gfx950"
.text
.globl adaLN_cond__compressed_kv_cla__glu_gated_geglu__decode_kernel
.p2align 8
.type adaLN_cond__compressed_kv_cla__glu_gated_geglu__decode_kernel,@function
adaLN_cond__compressed_kv_cla__glu_gated_geglu__decode_kernel:
  s_cmp_ge_u32 s2, 256
  s_cbranch_scc1 L_end
  s_load_dwordx16 s[4:19], s[0:1], 0
  s_load_dwordx8 s[20:27], s[0:1], 64
  s_load_dwordx4 s[28:31], s[0:1], 96
  s_load_dwordx2 s[32:33], s[0:1], 112
  v_lshrrev_b32 v1, 6, v0
  s_mov_b32 s34, 0x10000000
  s_mov_b32 s35, 0x20000
  v_readfirstlane_b32 s3, v1
  v_and_b32 v1, 63, v0
  v_mov_b32 v8, 0
  v_mov_b32 v20, 0
  v_mov_b32 v251, 0
  v_mov_b32 v253, 0
  s_cmp_lt_u32 s2, 128
  s_cbranch_scc0 L_B
  v_lshlrev_b32 v38, 4, v1
  s_bfe_u32 s82, s2, 0x30003
  s_lshl_b32 s82, s82, 19
  s_lshl_b32 s97, s3, 16
  s_add_u32 s82, s82, s97
  s_and_b32 s97, s2, 7
  s_lshl_b32 s97, s97, 10
  s_add_u32 s82, s82, s97
  s_mov_b32 s42, 0x400000
  s_mov_b32 s43, 0x20000
  s_bitcmp1_b32 s2, 6
  s_cbranch_scc1 L_K
  v_and_b32 v8, 15, v1
  v_lshlrev_b32 v8, 3, v8
  v_lshrrev_b32 v3, 4, v1
  v_lshl_add_u32 v8, v3, 1, v8
  s_bfe_u32 s92, s2, 0x30003
  s_lshl_b32 s92, s92, 7
  v_add_u32 v17, s92, v8
  s_bfe_u32 s81, s2, 0x10004
  s_xor_b32 s81, s81, 1
  s_lshl_b32 s81, s81, 16
  s_and_b32 s92, s3, 1
  s_lshl_b32 s92, s92, 7
  v_xor_b32 v39, s92, v38
  s_lshl_b32 s83, s3, 13
  s_add_u32 s83, s83, s81
  s_lshl_b32 s92, s2, 17
  v_mov_b32 v18, s92
  v_mov_b32 v19, 0xf000
  s_waitcnt lgkmcnt(0)
  s_mov_b64 s[40:41], s[8:9]
  global_load_dwordx4 v[12:15], v38, s[4:5]
  global_load_ushort v16, v17, s[4:5]
  v_xor_b32 v40, 0, v39
  s_add_u32 m0, s83, 0
  s_add_u32 s92, s82, 0
  buffer_load_dwordx4 v40, s[40:43], s92 offen nt lds
  v_xor_b32 v41, 32, v39
  s_add_u32 m0, s83, 1024
  s_add_u32 s92, s82, 8192
  buffer_load_dwordx4 v41, s[40:43], s92 offen nt lds
  v_xor_b32 v40, 64, v39
  s_add_u32 m0, s83, 2048
  s_add_u32 s92, s82, 16384
  buffer_load_dwordx4 v40, s[40:43], s92 offen nt lds
  v_xor_b32 v41, 96, v39
  s_add_u32 m0, s83, 3072
  s_add_u32 s92, s82, 24576
  buffer_load_dwordx4 v41, s[40:43], s92 offen nt lds
  v_xor_b32 v40, 0, v39
  s_add_u32 m0, s83, 4096
  s_add_u32 s92, s82, 32768
  buffer_load_dwordx4 v40, s[40:43], s92 offen nt lds
  v_xor_b32 v41, 32, v39
  s_add_u32 m0, s83, 5120
  s_add_u32 s92, s82, 40960
  buffer_load_dwordx4 v41, s[40:43], s92 offen nt lds
  v_xor_b32 v40, 64, v39
  s_add_u32 m0, s83, 6144
  s_add_u32 s92, s82, 49152
  buffer_load_dwordx4 v40, s[40:43], s92 offen nt lds
  v_xor_b32 v41, 96, v39
  s_add_u32 m0, s83, 7168
  s_add_u32 s92, s82, 57344
  buffer_load_dwordx4 v41, s[40:43], s92 offen nt lds
  s_cmp_lg_u32 s3, 7
  s_cbranch_scc1 L_nt_1
  s_mov_b64 exec, 1
  global_load_dword v20, v18, s[6:7] nt
  global_load_dword v21, v19, s[32:33]
  global_load_dword v22, v38, s[30:31] offset:128
  s_mov_b64 exec, -1
L_nt_1:
  s_branch L_Q2
L_K:
  s_bfe_u32 s81, s2, 0x10004
  s_xor_b32 s81, s81, 1
  s_lshl_b32 s81, s81, 16
  s_and_b32 s92, s3, 1
  s_lshl_b32 s92, s92, 7
  v_xor_b32 v39, s92, v38
  s_lshl_b32 s83, s3, 13
  s_add_u32 s83, s83, s81
  v_mov_b32 v19, 0xf000
  s_waitcnt lgkmcnt(0)
  s_mov_b64 s[40:41], s[10:11]
  s_mov_b64 exec, 1
  global_load_dword v21, v19, s[32:33]
  s_mov_b64 exec, -1
  v_xor_b32 v40, 0, v39
  s_add_u32 m0, s83, 0
  s_add_u32 s92, s82, 0
  buffer_load_dwordx4 v40, s[40:43], s92 offen nt lds
  v_xor_b32 v41, 16, v39
  s_add_u32 m0, s83, 1024
  s_add_u32 s92, s82, 8192
  buffer_load_dwordx4 v41, s[40:43], s92 offen nt lds
  v_xor_b32 v40, 32, v39
  s_add_u32 m0, s83, 2048
  s_add_u32 s92, s82, 16384
  buffer_load_dwordx4 v40, s[40:43], s92 offen nt lds
  v_xor_b32 v41, 48, v39
  s_add_u32 m0, s83, 3072
  s_add_u32 s92, s82, 24576
  buffer_load_dwordx4 v41, s[40:43], s92 offen nt lds
  v_xor_b32 v40, 64, v39
  s_add_u32 m0, s83, 4096
  s_add_u32 s92, s82, 32768
  buffer_load_dwordx4 v40, s[40:43], s92 offen nt lds
  v_xor_b32 v41, 80, v39
  s_add_u32 m0, s83, 5120
  s_add_u32 s92, s82, 40960
  buffer_load_dwordx4 v41, s[40:43], s92 offen nt lds
  v_xor_b32 v40, 96, v39
  s_add_u32 m0, s83, 6144
  s_add_u32 s92, s82, 49152
  buffer_load_dwordx4 v40, s[40:43], s92 offen nt lds
  v_xor_b32 v41, 112, v39
  s_add_u32 m0, s83, 7168
  s_add_u32 s92, s82, 57344
  buffer_load_dwordx4 v41, s[40:43], s92 offen nt lds
  s_branch L_K2
L_B:
  s_cmp_ge_u32 s3, 4
  s_cbranch_scc0 L_Bfront
  v_lshrrev_b32 v10, 3, v1
  v_mul_u32_u24 v5, 24576, v10
  v_lshlrev_b32 v10, 3, v10
  v_and_b32 v11, 7, v1
  v_lshl_add_u32 v5, v11, 4, v5
  s_bfe_u32 s94, s2, 0x20004
  s_and_b32 s95, s2, 15
  s_lshl_b32 s92, s94, 2
  s_add_u32 s92, s92, s3
  s_sub_u32 s92, s92, 4
  s_lshl_b32 s93, s92, 6
  v_add_u32 v10, s93, v10
  s_mul_i32 s92, s92, 196608
  s_lshl_b32 s93, s95, 7
  s_add_u32 s92, s92, s93
  s_mov_b32 s42, 0x300000
  s_mov_b32 s43, 0x20000
  v_mov_b32 v253, 0
  s_waitcnt lgkmcnt(0)
  s_mov_b64 s[40:41], s[26:27]
  s_bitcmp1_b32 s2, 6
  s_cbranch_scc1 L_nou0
  global_load_dwordx2 v[112:113], v10, s[24:25]
  buffer_load_dwordx4 v[124:127], v5, s[40:43], s92 offen nt
  s_add_u32 s92, s92, 6144
  buffer_load_dwordx4 v[128:131], v5, s[40:43], s92 offen nt
  s_add_u32 s92, s92, 6144
  buffer_load_dwordx4 v[132:135], v5, s[40:43], s92 offen nt
  s_add_u32 s92, s92, 6144
  buffer_load_dwordx4 v[136:139], v5, s[40:43], s92 offen nt
L_nou0:
  s_branch L_Bback2
L_Bfront:
  s_memrealtime s[62:63]
  s_bfe_u32 s64, s2, 0x40003
  s_xor_b32 s64, s64, 8
  s_or_b32 s64, s64, s3
  s_cbranch_scc1 L_nononce
  v_mov_b32 v18, 0
  v_mov_b32 v21, 0
  s_waitcnt lgkmcnt(0)
  s_or_b32 s62, s62, 1
  v_mov_b32 v20, s62
  s_mov_b64 exec, 1
  global_atomic_cmpswap v18, v[20:21], s[30:31] sc1
  s_mov_b64 exec, -1
L_nononce:
  v_lshrrev_b32 v245, 4, v1
  v_and_b32 v246, 15, v1
  v_lshlrev_b32 v247, 2, v245
  v_xor_b32 v246, v246, v247
  v_lshlrev_b32 v246, 4, v246
  v_lshl_add_u32 v244, v245, 10, v246
  v_xor_b32 v245, 16, v244
  v_xor_b32 v246, 32, v244
  v_xor_b32 v247, 48, v244
  v_add_u32 v245, 3072, v245
  v_add_u32 v246, 6144, v246
  v_add_u32 v247, 9216, v247
  s_and_b32 s91, s3, 3
  s_lshl_b32 s90, s91, 15
  s_lshl_b32 s91, s91, 13
  s_lshl_b32 s92, s2, 17
  s_add_u32 s90, s90, s92
  s_bfe_u32 s93, s2, 0x20003
  s_lshl_b32 s92, s93, 15
  s_add_u32 s91, s91, s92
  s_lshl_b32 s92, s93, 8
  s_add_u32 s90, s90, s92
  s_getpc_b64 s[94:95]
L_pc:
  s_sub_u32 s94, s94, L_pc-adaLN_cond__compressed_kv_cla__glu_gated_geglu__decode_kernel
  s_subb_u32 s95, s95, 0
  s_bfe_u32 s92, s2, 0x40003
  s_lshl_b32 s92, s92, 2
  s_add_u32 s92, s92, s3
  s_lshl_b32 s92, s92, 10
  v_lshlrev_b32 v11, 4, v1
  v_add_u32 v11, s92, v11
  s_mov_b32 s38, 0x2000000
  s_mov_b32 s39, 0x20000
  s_cmp_ge_u32 s92, L_codeend-adaLN_cond__compressed_kv_cla__glu_gated_geglu__decode_kernel
  s_cbranch_scc1 L_nopf
  v_min_u32 v11, L_codeend-adaLN_cond__compressed_kv_cla__glu_gated_geglu__decode_kernel-16, v11
  global_load_dwordx4 v[12:15], v11, s[94:95]
L_nopf:
  s_waitcnt lgkmcnt(0)
  s_mov_b64 s[36:37], s[6:7]
  s_barrier
  s_barrier
  s_mov_b32 s54, 0x05040100
  s_mov_b32 s55, 0x07060302
  s_mov_b32 s56, 0x0c0c0400
  s_mov_b32 s57, 0x0c040100
  s_mov_b32 s58, 0x04020100
  s_mov_b32 s53, 0x10001
  v_mov_b32 v2, 0xffffff00
  s_lshr_b32 s77, s2, 5
  s_and_b32 s78, s2, 127
  s_and_b32 s76, s2, 7
  s_lshl_b32 s76, s76, 2
  s_bfe_u32 s97, s2, 0x20003
  s_add_u32 s76, s76, s97
  s_bfe_u32 s79, s2, 0x40003
  s_and_b32 s80, s2, 7
  s_bfe_u32 s17, s2, 0x20003
  s_bfe_u32 s59, s2, 0x10004
  s_lshl_b32 s59, s59, 14
  s_xor_b32 m0, s91, 0
  s_xor_b32 s101, s90, 0
  buffer_load_dwordx4 v244, s[36:39], s101 offen offset:0 nt lds
  s_waitcnt vmcnt(0)
  buffer_load_dwordx4 v245, s[36:39], s101 offen offset:1024 nt lds
  s_waitcnt vmcnt(0)
  buffer_load_dwordx4 v246, s[36:39], s101 offen offset:2048 nt lds
  s_waitcnt vmcnt(0)
  buffer_load_dwordx4 v247, s[36:39], s101 offen offset:3072 nt lds
  s_waitcnt vmcnt(2)
  s_xor_b32 m0, s91, 32768
  s_xor_b32 s101, s90, 256
  buffer_load_dwordx4 v244, s[36:39], s101 offen offset:0 nt lds
  s_waitcnt vmcnt(2)
  buffer_load_dwordx4 v245, s[36:39], s101 offen offset:1024 nt lds
  s_waitcnt vmcnt(2)
  buffer_load_dwordx4 v246, s[36:39], s101 offen offset:2048 nt lds
  s_waitcnt vmcnt(2)
  buffer_load_dwordx4 v247, s[36:39], s101 offen offset:3072 nt lds
  s_waitcnt vmcnt(2)
  s_xor_b32 m0, s91, 65536
  s_xor_b32 s101, s90, 512
  buffer_load_dwordx4 v244, s[36:39], s101 offen offset:0 nt lds
  buffer_load_dwordx4 v245, s[36:39], s101 offen offset:1024 nt lds
  buffer_load_dwordx4 v246, s[36:39], s101 offen offset:2048 nt lds
  buffer_load_dwordx4 v247, s[36:39], s101 offen offset:3072 nt lds
  v_mov_b32 v253, 0
  global_load_dword v252, v253, s[30:31] sc1
  s_barrier
  s_xor_b32 m0, s91, 98304
  s_xor_b32 s101, s90, 768
  buffer_load_dwordx4 v244, s[36:39], s101 offen offset:0 nt lds
  buffer_load_dwordx4 v245, s[36:39], s101 offen offset:1024 nt lds
  buffer_load_dwordx4 v246, s[36:39], s101 offen offset:2048 nt lds
  buffer_load_dwordx4 v247, s[36:39], s101 offen offset:3072 nt lds
  s_branch L_front
L_Q2:
  s_mov_b32 s54, 0x05040100
  s_mov_b32 s55, 0x07060302
  s_mov_b32 s56, 0x0c0c0400
  s_mov_b32 s57, 0x0c040100
  s_mov_b32 s58, 0x04020100
  s_mov_b32 s53, 0x10001
  v_mov_b32 v2, 0xffffff00
  s_lshr_b32 s77, s2, 5
  s_and_b32 s78, s2, 127
  s_and_b32 s76, s2, 7
  s_lshl_b32 s76, s76, 2
  s_bfe_u32 s97, s2, 0x20003
  s_add_u32 s76, s76, s97
  s_bfe_u32 s79, s2, 0x40003
  s_and_b32 s80, s2, 7
  s_bfe_u32 s17, s2, 0x20003
  s_bfe_u32 s59, s2, 0x10004
  s_lshl_b32 s59, s59, 14
  v_lshrrev_b32 v245, 4, v1
  v_and_b32 v246, 15, v1
  v_lshlrev_b32 v247, 2, v245
  v_xor_b32 v246, v246, v247
  v_lshlrev_b32 v246, 4, v246
  v_lshl_add_u32 v244, v245, 10, v246
  v_xor_b32 v245, 16, v244
  v_xor_b32 v246, 32, v244
  v_xor_b32 v247, 48, v244
  v_add_u32 v245, 3072, v245
  v_add_u32 v246, 6144, v246
  v_add_u32 v247, 9216, v247
  s_and_b32 s91, s3, 3
  s_lshl_b32 s90, s91, 15
  s_lshl_b32 s91, s91, 13
  s_lshl_b32 s92, s2, 17
  s_add_u32 s90, s90, s92
  s_bfe_u32 s93, s2, 0x20003
  s_lshl_b32 s92, s93, 15
  s_add_u32 s91, s91, s92
  s_lshl_b32 s92, s93, 8
  s_add_u32 s90, s90, s92
  s_mov_b64 s[36:37], s[6:7]
  s_mov_b32 s38, 0x2000000
  s_mov_b32 s39, 0x20000
  s_barrier
  s_lshr_b32 s92, s3, 2
  s_lshl_b32 s93, s92, 12
  s_xor_b32 s93, s93, 0
  s_xor_b32 m0, s91, s93
  s_lshl_b32 s93, s92, 14
  s_xor_b32 s93, s93, 0
  s_xor_b32 s101, s90, s93
  buffer_load_dwordx4 v244, s[36:39], s101 offen offset:0 nt lds
  buffer_load_dwordx4 v245, s[36:39], s101 offen offset:1024 nt lds
  buffer_load_dwordx4 v246, s[36:39], s101 offen offset:2048 nt lds
  buffer_load_dwordx4 v247, s[36:39], s101 offen offset:3072 nt lds
  s_bfe_u32 s82, s2, 0x30003
  s_lshl_b32 s82, s82, 10
  s_add_u32 s83, s82, 8192
  s_lshl_b32 s92, s3, 7
  s_add_u32 s92, s92, 0x20000
  v_add_u32 v40, s92, v8
  v_lshrrev_b32 v41, 4, v1
  v_lshlrev_b32 v41, 4, v41
  v_add_u32 v41, s92, v41
  s_lshl_b32 s92, s3, 7
  s_add_u32 s92, s92, s81
  v_lshrrev_b32 v44, 4, v1
  v_lshlrev_b32 v44, 13, v44
  v_bfe_u32 v3, v1, 2, 2
  v_lshl_add_u32 v44, v3, 10, v44
  v_and_b32 v3, 3, v1
  v_lshl_add_u32 v44, v3, 3, v44
  v_add_u32 v44, s92, v44
  v_bfe_u32 v45, v1, 2, 2
  v_lshlrev_b32 v45, 5, v45
  v_bfe_u32 v3, v1, 4, 1
  v_lshl_add_u32 v45, v3, 7, v45
  v_xor_b32 v44, v44, v45
  v_and_b32 v39, 3, v1
  v_lshlrev_b32 v39, 6, v39
  v_lshrrev_b32 v3, 4, v1
  v_lshl_add_u32 v39, v3, 4, v39
  s_and_b32 s85, s2, 7
  s_lshl_b32 s85, s85, 14
  s_bfe_u32 s97, s2, 0x30003
  s_lshl_b32 s97, s97, 11
  s_add_u32 s85, s85, s97
  s_lshl_b32 s97, s3, 8
  s_add_u32 s85, s85, s97
  s_add_u32 s85, s85, 0x80000
  s_mov_b32 s70, 0x20002
  s_mov_b32 s71, 0x20002
  s_mov_b32 s72, 0x40004
  s_mov_b32 s73, 0x40004
  s_mov_b32 s74, 0x80008
  s_mov_b32 s75, 0x80008
  s_waitcnt vmcnt(12)
  v_lshlrev_b32 v92, 16, v12
  v_and_b32 v93, 0xffff0000, v12
  v_lshlrev_b32 v94, 16, v13
  v_and_b32 v95, 0xffff0000, v13
  v_lshlrev_b32 v96, 16, v14
  v_and_b32 v97, 0xffff0000, v14
  v_lshlrev_b32 v98, 16, v15
  v_and_b32 v99, 0xffff0000, v15
  v_add_f32 v100, v92, v93
  v_add_f32 v100, v100, v94
  v_add_f32 v100, v100, v95
  v_add_f32 v100, v100, v96
  v_add_f32 v100, v100, v97
  v_add_f32 v100, v100, v98
  v_add_f32 v100, v100, v99
  s_nop 1
  v_add_f32_dpp v100, v100, v100 row_ror:8 row_mask:0xf bank_mask:0xf
  s_nop 1
  v_add_f32_dpp v100, v100, v100 row_ror:4 row_mask:0xf bank_mask:0xf
  s_nop 1
  v_add_f32_dpp v100, v100, v100 row_ror:2 row_mask:0xf bank_mask:0xf
  s_nop 1
  v_add_f32_dpp v100, v100, v100 row_ror:1 row_mask:0xf bank_mask:0xf
  v_mov_b32 v101, v100
  s_nop 1
  v_permlane16_swap_b32 v100, v101
  v_add_f32 v100, v100, v101
  v_mov_b32 v101, v100
  s_nop 1
  v_permlane32_swap_b32 v100, v101
  v_add_f32 v100, v100, v101
  v_mul_f32 v100, 0x3b000000, v100
  v_sub_f32 v92, v92, v100
  v_sub_f32 v93, v93, v100
  v_sub_f32 v94, v94, v100
  v_sub_f32 v95, v95, v100
  v_sub_f32 v96, v96, v100
  v_sub_f32 v97, v97, v100
  v_sub_f32 v98, v98, v100
  v_sub_f32 v99, v99, v100
  v_mul_f32 v102, v92, v92
  v_fmac_f32 v102, v93, v93
  v_fmac_f32 v102, v94, v94
  v_fmac_f32 v102, v95, v95
  v_fmac_f32 v102, v96, v96
  v_fmac_f32 v102, v97, v97
  v_fmac_f32 v102, v98, v98
  v_fmac_f32 v102, v99, v99
  s_nop 1
  v_add_f32_dpp v102, v102, v102 row_ror:8 row_mask:0xf bank_mask:0xf
  s_nop 1
  v_add_f32_dpp v102, v102, v102 row_ror:4 row_mask:0xf bank_mask:0xf
  s_nop 1
  v_add_f32_dpp v102, v102, v102 row_ror:2 row_mask:0xf bank_mask:0xf
  s_nop 1
  v_add_f32_dpp v102, v102, v102 row_ror:1 row_mask:0xf bank_mask:0xf
  v_mov_b32 v101, v102
  s_nop 1
  v_permlane16_swap_b32 v102, v101
  v_add_f32 v102, v102, v101
  v_mov_b32 v101, v102
  s_nop 1
  v_permlane32_swap_b32 v102, v101
  v_add_f32 v102, v102, v101
  v_mul_f32 v102, 0x3b000000, v102
  v_cvt_pk_bf16_f32 v101, v100, v100
  v_and_b32 v100, 0xffff0000, v101
  v_cvt_pk_bf16_f32 v101, v102, v102
  v_and_b32 v102, 0xffff0000, v101
  v_add_f32 v102, 0x3727c5ac, v102
  v_cvt_pk_bf16_f32 v101, v102, v102
  v_and_b32 v102, 0xffff0000, v101
  v_sqrt_f32 v102, v102
  s_nop 0
  v_cvt_pk_bf16_f32 v101, v102, v102
  v_and_b32 v102, 0xffff0000, v101
  v_rcp_f32 v102, v102
  v_lshlrev_b32 v103, 16, v16
  v_sub_f32 v103, v103, v100
  v_cvt_pk_bf16_f32 v101, v103, v103
  v_and_b32 v103, 0xffff0000, v101
  v_mul_f32 v103, v103, v102
  v_cvt_pk_bf16_f32 v101, v103, v103
  v_and_b32 v103, 0xffff0000, v101
  v_mov_b32 v253, 0
  global_load_dword v252, v253, s[30:31] sc1
  buffer_load_dwordx4 v[20:23], v38, s[32:35], s82 offen offset:0 sc1
  buffer_load_dwordx4 v[24:27], v38, s[32:35], s83 offen offset:0 sc1
  s_waitcnt vmcnt(7)
  s_barrier
  v_xor_b32 v46, 0, v44
  ds_read_b64_tr_b16 v[112:113], v46 offset:0
  ds_read_b64_tr_b16 v[114:115], v46 offset:4096
  ds_read_b64_tr_b16 v[116:117], v46 offset:32768
  ds_read_b64_tr_b16 v[118:119], v46 offset:36864
  v_xor_b32 v47, 32, v44
  ds_read_b64_tr_b16 v[120:121], v47 offset:0
  ds_read_b64_tr_b16 v[122:123], v47 offset:4096
  ds_read_b64_tr_b16 v[124:125], v47 offset:32768
  ds_read_b64_tr_b16 v[126:127], v47 offset:36864
  v_xor_b32 v46, 64, v44
  ds_read_b64_tr_b16 v[128:129], v46 offset:0
  ds_read_b64_tr_b16 v[130:131], v46 offset:4096
  ds_read_b64_tr_b16 v[132:133], v46 offset:32768
  ds_read_b64_tr_b16 v[134:135], v46 offset:36864
  s_waitcnt lgkmcnt(4)
  v_xor_b32 v47, 96, v44
  ds_read_b64_tr_b16 v[136:137], v47 offset:0
  ds_read_b64_tr_b16 v[138:139], v47 offset:4096
  ds_read_b64_tr_b16 v[140:141], v47 offset:32768
  ds_read_b64_tr_b16 v[142:143], v47 offset:36864
  s_mov_b32 s100, 0
  s_waitcnt vmcnt(2)
  s_branch L_epc_3
L_ep_2:
  global_load_dword v252, v253, s[30:31] sc1
  s_add_u32 s100, s100, 1
  s_cmp_gt_u32 s100, 100000
  s_cbranch_scc1 L_abort
  s_waitcnt vmcnt(0)
L_epc_3:
  v_readfirstlane_b32 s48, v252
  s_nop 0
  s_cmp_eq_u32 s48, 0
  s_nop 1
  s_cbranch_scc1 L_ep_2
  s_mul_i32 s48, s48, 0x9e3779b1
  s_and_b32 s49, s48, 0xff
  s_bfe_u32 s50, s48, 0x80008
  s_bfe_u32 s51, s48, 0x80010
  s_lshr_b32 s52, s48, 24
  s_lshr_b32 s97, s48, 15
  s_xor_b32 s97, s97, s48
  s_mul_i32 s97, s97, 0x85ebca6b
  v_mov_b32 v4, s48
  v_mov_b32 v5, s97
  v_mov_b32 v249, s48
  v_mov_b32 v250, s97
  v_and_b32 v6, 4, v1
  v_cmp_eq_u32 vcc, 0, v6
  v_and_b32 v7, 3, v1
  v_lshlrev_b32 v7, 2, v7
  v_cndmask_b32 v4, v5, v4, vcc
  v_lshrrev_b32 v4, v7, v4
  v_lshrrev_b32 v5, 1, v4
  v_lshrrev_b32 v6, 2, v4
  v_lshrrev_b32 v7, 3, v4
  s_waitcnt lgkmcnt(0)
  s_barrier
  s_mov_b64 s[60:61], -1
  s_waitcnt vmcnt(0)
  s_mov_b32 s100, 0
  s_branch L_gc_6
L_g_4:
  s_add_u32 s100, s100, 1
  s_cmp_gt_u32 s100, 100000
  s_cbranch_scc1 L_abort
  s_sleep 2
L_gf_5:
  s_mov_b64 exec, s[60:61]
  buffer_load_dwordx4 v[20:23], v38, s[32:35], s82 offen offset:0 sc1
  buffer_load_dwordx4 v[24:27], v38, s[32:35], s83 offen offset:0 sc1
  s_waitcnt vmcnt(0)
L_gc_6:
  s_mov_b64 exec, s[60:61]
  v_perm_b32 v92, v21, v20, s56
  v_perm_b32 v92, v22, v92, s57
  v_perm_b32 v92, v23, v92, s58
  v_cmp_ne_u32 s[60:61], s48, v92
  v_perm_b32 v92, v25, v24, s56
  v_perm_b32 v92, v26, v92, s57
  v_perm_b32 v92, v27, v92, s58
  v_cmp_ne_u32 vcc, s48, v92
  s_nop 0
  s_or_b64 s[60:61], s[60:61], vcc
  s_cmp_lg_u64 s[60:61], 0
  s_cbranch_scc1 L_g_4
  s_mov_b64 exec, -1
  v_permlane32_swap_b32 v20, v22
  v_permlane32_swap_b32 v21, v23
  v_permlane32_swap_b32 v24, v26
  v_permlane32_swap_b32 v25, v27
  v_add_f32 v20, v20, v22
  v_add_f32 v21, v21, v23
  v_add_f32 v24, v24, v26
  v_add_f32 v25, v25, v27
  v_permlane16_swap_b32 v20, v21
  s_nop 0
  v_permlane16_swap_b32 v24, v25
  v_add_f32 v20, v20, v21
  v_add_f32 v24, v24, v25
  v_cvt_pk_bf16_f32 v25, v24, v24
  v_and_b32 v24, 0xffff0000, v25
  v_cvt_pk_bf16_f32 v21, v20, v20
  v_and_b32 v20, 0xffff0000, v21
  v_add_f32 v24, 1.0, v24
  v_cvt_pk_bf16_f32 v25, v24, v24
  v_and_b32 v24, 0xffff0000, v25
  v_mul_f32 v24, v103, v24
  v_cvt_pk_bf16_f32 v25, v24, v24
  v_and_b32 v24, 0xffff0000, v25
  v_add_f32 v24, v24, v20
  v_cvt_pk_bf16_f32 v24, v24, v24
  ds_write_b16 v40, v24
  ds_read_b128 v[28:31], v41
  ds_read_b128 v[32:35], v41 offset:64
  s_waitcnt lgkmcnt(1)
  v_mfma_f32_16x16x32_bf16 v[80:83], v[112:115], v[28:31], 0
  v_mfma_f32_16x16x32_bf16 v[84:87], v[120:123], v[28:31], 0
  v_mfma_f32_16x16x32_bf16 v[88:91], v[128:131], v[28:31], 0
  v_mfma_f32_16x16x32_bf16 v[92:95], v[136:139], v[28:31], 0
  s_waitcnt lgkmcnt(0)
  v_mfma_f32_16x16x32_bf16 v[80:83], v[116:119], v[32:35], v[80:83]
  v_mfma_f32_16x16x32_bf16 v[84:87], v[124:127], v[32:35], v[84:87]
  v_mfma_f32_16x16x32_bf16 v[88:91], v[132:135], v[32:35], v[88:91]
  v_mfma_f32_16x16x32_bf16 v[92:95], v[140:143], v[32:35], v[92:95]
  s_nop 5
  v_cndmask_b32 v80, v80, v84, s[70:71]
  v_cndmask_b32 v81, v81, v85, s[70:71]
  v_cndmask_b32 v82, v82, v86, s[70:71]
  v_cndmask_b32 v83, v83, v87, s[70:71]
  v_cndmask_b32 v80, v80, v88, s[72:73]
  v_cndmask_b32 v81, v81, v89, s[72:73]
  v_cndmask_b32 v82, v82, v90, s[72:73]
  v_cndmask_b32 v83, v83, v91, s[72:73]
  v_cndmask_b32 v80, v80, v92, s[74:75]
  v_cndmask_b32 v81, v81, v93, s[74:75]
  v_cndmask_b32 v82, v82, v94, s[74:75]
  v_cndmask_b32 v83, v83, v95, s[74:75]
  v_and_or_b32 v80, v80, v2, s49
  v_and_or_b32 v81, v81, v2, s50
  v_and_or_b32 v82, v82, v2, s51
  v_and_or_b32 v83, v83, v2, s52
  s_mov_b32 exec_lo, 0xf000f
  s_mov_b32 exec_hi, 0xf000f
  buffer_store_dwordx4 v[80:83], v39, s[32:35], s85 offen
  s_add_u32 s97, s85, 0x100000
  buffer_store_dwordx4 v[80:83], v39, s[32:35], s97 offen sc1
  s_mov_b64 exec, -1
  s_barrier
  s_lshr_b32 s92, s3, 2
  s_lshl_b32 s93, s92, 12
  s_xor_b32 s93, s93, 32768
  s_xor_b32 m0, s91, s93
  s_lshl_b32 s93, s92, 14
  s_xor_b32 s93, s93, 256
  s_xor_b32 s101, s90, s93
  buffer_load_dwordx4 v244, s[36:39], s101 offen offset:0 nt lds
  buffer_load_dwordx4 v245, s[36:39], s101 offen offset:1024 nt lds
  buffer_load_dwordx4 v246, s[36:39], s101 offen offset:2048 nt lds
  buffer_load_dwordx4 v247, s[36:39], s101 offen offset:3072 nt lds
  s_lshr_b32 s92, s3, 2
  s_lshl_b32 s93, s92, 12
  s_xor_b32 s93, s93, 65536
  s_xor_b32 m0, s91, s93
  s_lshl_b32 s93, s92, 14
  s_xor_b32 s93, s93, 512
  s_xor_b32 s101, s90, s93
  buffer_load_dwordx4 v244, s[36:39], s101 offen offset:0 nt lds
  buffer_load_dwordx4 v245, s[36:39], s101 offen offset:1024 nt lds
  buffer_load_dwordx4 v246, s[36:39], s101 offen offset:2048 nt lds
  buffer_load_dwordx4 v247, s[36:39], s101 offen offset:3072 nt lds
  s_cmp_ge_u32 s3, 4
  s_cbranch_scc1 L_back
  s_barrier
  s_xor_b32 m0, s91, 98304
  s_xor_b32 s101, s90, 768
  buffer_load_dwordx4 v244, s[36:39], s101 offen offset:0 nt lds
  buffer_load_dwordx4 v245, s[36:39], s101 offen offset:1024 nt lds
  buffer_load_dwordx4 v246, s[36:39], s101 offen offset:2048 nt lds
  buffer_load_dwordx4 v247, s[36:39], s101 offen offset:3072 nt lds
  s_branch L_setup
L_K2:
  s_mov_b32 s54, 0x05040100
  s_mov_b32 s55, 0x07060302
  s_mov_b32 s56, 0x0c0c0400
  s_mov_b32 s57, 0x0c040100
  s_mov_b32 s58, 0x04020100
  s_mov_b32 s53, 0x10001
  v_mov_b32 v2, 0xffffff00
  s_lshr_b32 s77, s2, 5
  s_and_b32 s78, s2, 127
  s_and_b32 s76, s2, 7
  s_lshl_b32 s76, s76, 2
  s_bfe_u32 s97, s2, 0x20003
  s_add_u32 s76, s76, s97
  s_bfe_u32 s79, s2, 0x40003
  s_and_b32 s80, s2, 7
  s_bfe_u32 s17, s2, 0x20003
  s_bfe_u32 s59, s2, 0x10004
  s_lshl_b32 s59, s59, 14
  v_lshrrev_b32 v245, 4, v1
  v_and_b32 v246, 15, v1
  v_lshlrev_b32 v247, 2, v245
  v_xor_b32 v246, v246, v247
  v_lshlrev_b32 v246, 4, v246
  v_lshl_add_u32 v244, v245, 10, v246
  v_xor_b32 v245, 16, v244
  v_xor_b32 v246, 32, v244
  v_xor_b32 v247, 48, v244
  v_add_u32 v245, 3072, v245
  v_add_u32 v246, 6144, v246
  v_add_u32 v247, 9216, v247
  s_and_b32 s91, s3, 3
  s_lshl_b32 s90, s91, 15
  s_lshl_b32 s91, s91, 13
  s_lshl_b32 s92, s2, 17
  s_add_u32 s90, s90, s92
  s_bfe_u32 s93, s2, 0x20003
  s_lshl_b32 s92, s93, 15
  s_add_u32 s91, s91, s92
  s_lshl_b32 s92, s93, 8
  s_add_u32 s90, s90, s92
  s_mov_b64 s[36:37], s[6:7]
  s_mov_b32 s38, 0x2000000
  s_mov_b32 s39, 0x20000
  s_barrier
  s_lshr_b32 s92, s3, 2
  s_lshl_b32 s93, s92, 12
  s_xor_b32 s93, s93, 0
  s_xor_b32 m0, s91, s93
  s_lshl_b32 s93, s92, 14
  s_xor_b32 s93, s93, 0
  s_xor_b32 s101, s90, s93
  buffer_load_dwordx4 v244, s[36:39], s101 offen offset:0 nt lds
  buffer_load_dwordx4 v245, s[36:39], s101 offen offset:1024 nt lds
  buffer_load_dwordx4 v246, s[36:39], s101 offen offset:2048 nt lds
  buffer_load_dwordx4 v247, s[36:39], s101 offen offset:3072 nt lds
  s_lshr_b32 s92, s3, 2
  s_lshl_b32 s93, s92, 12
  s_xor_b32 s93, s93, 32768
  s_xor_b32 m0, s91, s93
  s_lshl_b32 s93, s92, 14
  s_xor_b32 s93, s93, 256
  s_xor_b32 s101, s90, s93
  buffer_load_dwordx4 v244, s[36:39], s101 offen offset:0 nt lds
  buffer_load_dwordx4 v245, s[36:39], s101 offen offset:1024 nt lds
  buffer_load_dwordx4 v246, s[36:39], s101 offen offset:2048 nt lds
  buffer_load_dwordx4 v247, s[36:39], s101 offen offset:3072 nt lds
  s_and_b32 s92, s3, 1
  s_lshl_b32 s92, s92, 15
  s_lshr_b32 s97, s3, 1
  s_lshl_b32 s97, s97, 8
  s_add_u32 s92, s92, s97
  s_add_u32 s92, s92, s81
  v_and_b32 v45, 15, v1
  v_mul_u32_u24 v45, 1040, v45
  v_add_u32 v45, s92, v45
  v_lshrrev_b32 v34, 4, v1
  v_lshlrev_b32 v34, 4, v34
  v_xor_b32 v45, v45, v34
  v_lshrrev_b32 v37, 4, v1
  v_lshlrev_b32 v37, 11, v37
  v_and_b32 v3, 15, v1
  v_lshl_add_u32 v37, v3, 4, v37
  s_and_b32 s83, s2, 7
  s_lshl_b32 s83, s83, 14
  s_lshl_b32 s97, s3, 8
  s_add_u32 s83, s83, s97
  s_add_u32 s83, s83, 0x80000
  s_add_u32 s85, s83, 8192
  s_lshl_b32 s92, s3, 7
  s_add_u32 s92, s92, 0x21000
  v_and_b32 v47, 15, v1
  v_lshlrev_b32 v47, 3, v47
  v_lshrrev_b32 v3, 4, v1
  v_lshl_add_u32 v47, v3, 1, v47
  v_add_u32 v47, s92, v47
  s_lshr_b32 s92, s3, 1
  s_lshl_b32 s92, s92, 8
  s_add_u32 s92, s92, 0x21000
  v_lshrrev_b32 v35, 4, v1
  v_lshlrev_b32 v35, 4, v35
  v_add_u32 v35, s92, v35
  v_bfe_u32 v39, v1, 4, 1
  v_lshlrev_b32 v39, 5, v39
  v_lshrrev_b32 v3, 5, v1
  v_lshl_add_u32 v39, v3, 4, v39
  s_and_b32 s84, s2, 7
  s_lshl_b32 s84, s84, 12
  s_lshr_b32 s97, s3, 1
  s_lshl_b32 s97, s97, 10
  s_add_u32 s84, s84, s97
  s_bfe_u32 s97, s2, 0x30003
  s_lshl_b32 s97, s97, 7
  s_add_u32 s84, s84, s97
  s_and_b32 s97, s3, 1
  s_lshl_b32 s97, s97, 6
  s_add_u32 s84, s84, s97
  s_add_u32 s84, s84, 0x10000
  s_waitcnt vmcnt(8)
  s_barrier
  v_xor_b32 v32, 0, v45
  ds_read_b128 v[112:115], v32 offset:0
  v_xor_b32 v33, 64, v45
  ds_read_b128 v[116:119], v33 offset:0
  v_xor_b32 v32, 128, v45
  ds_read_b128 v[120:123], v32 offset:0
  v_xor_b32 v33, 192, v45
  ds_read_b128 v[124:127], v33 offset:0
  v_xor_b32 v32, 0, v45
  ds_read_b128 v[128:131], v32 offset:16384
  v_xor_b32 v33, 64, v45
  ds_read_b128 v[132:135], v33 offset:16384
  v_xor_b32 v32, 128, v45
  ds_read_b128 v[136:139], v32 offset:16384
  v_xor_b32 v33, 192, v45
  ds_read_b128 v[140:143], v33 offset:16384
  s_waitcnt lgkmcnt(0)
  s_barrier
  s_mov_b32 s100, 0
  v_mov_b32 v253, 0
L_ep_8:
  global_load_dword v252, v253, s[30:31] sc1
  s_add_u32 s100, s100, 1
  s_cmp_gt_u32 s100, 100000
  s_cbranch_scc1 L_abort
  s_waitcnt vmcnt(0)
L_epc_9:
  v_readfirstlane_b32 s48, v252
  s_nop 0
  s_cmp_eq_u32 s48, 0
  s_nop 1
  s_cbranch_scc1 L_ep_8
  s_mul_i32 s48, s48, 0x9e3779b1
  s_and_b32 s49, s48, 0xff
  s_bfe_u32 s50, s48, 0x80008
  s_bfe_u32 s51, s48, 0x80010
  s_lshr_b32 s52, s48, 24
  s_lshr_b32 s97, s48, 15
  s_xor_b32 s97, s97, s48
  s_mul_i32 s97, s97, 0x85ebca6b
  v_mov_b32 v4, s48
  v_mov_b32 v5, s97
  v_mov_b32 v249, s48
  v_mov_b32 v250, s97
  v_and_b32 v6, 4, v1
  v_cmp_eq_u32 vcc, 0, v6
  v_and_b32 v7, 3, v1
  v_lshlrev_b32 v7, 2, v7
  v_cndmask_b32 v4, v5, v4, vcc
  v_lshrrev_b32 v4, v7, v4
  v_lshrrev_b32 v5, 1, v4
  v_lshrrev_b32 v6, 2, v4
  v_lshrrev_b32 v7, 3, v4
  s_and_b32 s92, s3, 1
  s_sub_u32 s74, 0, s92
  s_mov_b32 s75, s74
  v_bfe_u32 v28, v1, 4, 1
  v_lshlrev_b32 v28, 3, v28
  v_lshrrev_b32 v3, 5, v1
  v_lshl_add_u32 v28, v3, 2, v28
  v_mov_b32 v68, s48
  v_mov_b32 v69, s97
  v_cndmask_b32 v68, v68, v69, s[74:75]
  v_lshrrev_b32 v68, v28, v68
  v_lshrrev_b32 v69, 1, v68
  v_lshrrev_b32 v70, 2, v68
  v_lshrrev_b32 v71, 3, v68
  s_mov_b64 s[60:61], -1
  s_mov_b64 s[62:63], -1
  s_mov_b32 s100, 0
  s_branch L_gf_11
L_g_10:
  s_add_u32 s100, s100, 1
  s_cmp_gt_u32 s100, 100000
  s_cbranch_scc1 L_abort
  s_sleep 1
  s_cmp_lg_u32 s100, 40
  s_cbranch_scc1 L_alt_13
  s_add_u32 s83, s83, 0x100000
  s_add_u32 s85, s85, 0x100000
L_alt_13:
L_gf_11:
  s_mov_b64 exec, s[60:61]
  s_cbranch_execz L_gs_14
  buffer_load_dwordx4 v[20:23], v37, s[32:35], s83 offen offset:0 sc1
L_gs_14:
  s_mov_b64 exec, s[62:63]
  s_cbranch_execz L_gs_15
  buffer_load_dwordx4 v[24:27], v37, s[32:35], s85 offen offset:0 sc1
L_gs_15:
  s_waitcnt vmcnt(0)
L_gc_12:
  s_mov_b64 exec, s[60:61]
  v_perm_b32 v92, v21, v20, s56
  v_perm_b32 v92, v22, v92, s57
  v_perm_b32 v92, v23, v92, s58
  v_cmp_ne_u32 s[60:61], s48, v92
  s_mov_b64 exec, s[62:63]
  v_perm_b32 v92, v25, v24, s56
  v_perm_b32 v92, v26, v92, s57
  v_perm_b32 v92, v27, v92, s58
  v_cmp_ne_u32 s[62:63], s48, v92
  s_nop 0
  s_or_b64 s[96:97], s[60:61], s[62:63]
  s_cbranch_scc1 L_g_10
  s_mov_b64 exec, -1
  v_add_f32 v20, v20, v24
  v_add_f32 v21, v21, v25
  v_add_f32 v22, v22, v26
  v_add_f32 v23, v23, v27
  s_nop 0
  v_permlane32_swap_b32 v20, v22
  v_permlane32_swap_b32 v21, v23
  v_add_f32 v20, v20, v22
  v_add_f32 v21, v21, v23
  s_nop 1
  v_permlane16_swap_b32 v20, v21
  v_add_f32 v20, v20, v21
  v_cvt_pk_bf16_f32 v20, v20, v20
  ds_write_b16 v47, v20
  s_waitcnt lgkmcnt(0)
  s_barrier
  ds_read_b128 v[52:55], v35 offset:0
  ds_read_b128 v[56:59], v35 offset:64
  ds_read_b128 v[60:63], v35 offset:128
  ds_read_b128 v[64:67], v35 offset:192
  s_waitcnt lgkmcnt(3)
  v_mfma_f32_16x16x32_bf16 v[80:83], v[112:115], v[52:55], 0
  v_mfma_f32_16x16x32_bf16 v[84:87], v[128:131], v[52:55], 0
  s_waitcnt lgkmcnt(2)
  v_mfma_f32_16x16x32_bf16 v[80:83], v[116:119], v[56:59], v[80:83]
  v_mfma_f32_16x16x32_bf16 v[84:87], v[132:135], v[56:59], v[84:87]
  s_waitcnt lgkmcnt(1)
  v_mfma_f32_16x16x32_bf16 v[80:83], v[120:123], v[60:63], v[80:83]
  v_mfma_f32_16x16x32_bf16 v[84:87], v[136:139], v[60:63], v[84:87]
  s_waitcnt lgkmcnt(0)
  v_mfma_f32_16x16x32_bf16 v[80:83], v[124:127], v[64:67], v[80:83]
  v_mfma_f32_16x16x32_bf16 v[84:87], v[140:143], v[64:67], v[84:87]
  s_nop 6
  v_mul_f32 v80, 0x3e0293ee, v80
  v_mul_f32 v81, 0x3e0293ee, v81
  v_mul_f32 v82, 0x3e0293ee, v82
  v_mul_f32 v83, 0x3e0293ee, v83
  v_mul_f32 v84, 0x3e0293ee, v84
  v_mul_f32 v85, 0x3e0293ee, v85
  v_mul_f32 v86, 0x3e0293ee, v86
  v_mul_f32 v87, 0x3e0293ee, v87
  v_cvt_pk_bf16_f32 v20, v80, v81
  v_cvt_pk_bf16_f32 v21, v82, v83
  v_cvt_pk_bf16_f32 v22, v84, v85
  v_cvt_pk_bf16_f32 v23, v86, v87
  s_nop 0
  v_permlane16_swap_b32 v20, v22
  v_permlane16_swap_b32 v21, v23
  v_bfi_b32 v20, s53, v68, v20
  v_bfi_b32 v21, s53, v69, v21
  v_bfi_b32 v22, s53, v70, v22
  v_bfi_b32 v23, s53, v71, v23
  s_mov_b32 exec_lo, 0x10001
  s_mov_b32 exec_hi, 0x10001
  buffer_store_dwordx4 v[20:23], v39, s[32:35], s84 offen sc1
  s_mov_b64 exec, -1
  s_barrier
  s_lshr_b32 s92, s3, 2
  s_lshl_b32 s93, s92, 12
  s_xor_b32 s93, s93, 65536
  s_xor_b32 m0, s91, s93
  s_lshl_b32 s93, s92, 14
  s_xor_b32 s93, s93, 512
  s_xor_b32 s101, s90, s93
  buffer_load_dwordx4 v244, s[36:39], s101 offen offset:0 nt lds
  buffer_load_dwordx4 v245, s[36:39], s101 offen offset:1024 nt lds
  buffer_load_dwordx4 v246, s[36:39], s101 offen offset:2048 nt lds
  buffer_load_dwordx4 v247, s[36:39], s101 offen offset:3072 nt lds
  s_cmp_ge_u32 s3, 4
  s_cbranch_scc0 L_kf
  s_branch L_back
L_kf:
  s_xor_b32 m0, s91, 98304
  s_xor_b32 s101, s90, 768
  buffer_load_dwordx4 v244, s[36:39], s101 offen offset:0 nt lds
  buffer_load_dwordx4 v245, s[36:39], s101 offen offset:1024 nt lds
  buffer_load_dwordx4 v246, s[36:39], s101 offen offset:2048 nt lds
  buffer_load_dwordx4 v247, s[36:39], s101 offen offset:3072 nt lds
  s_barrier
  s_branch L_setup
L_Bback2:
  s_mov_b32 s54, 0x05040100
  s_mov_b32 s55, 0x07060302
  s_mov_b32 s56, 0x0c0c0400
  s_mov_b32 s57, 0x0c040100
  s_mov_b32 s58, 0x04020100
  s_mov_b32 s53, 0x10001
  v_mov_b32 v2, 0xffffff00
  s_lshr_b32 s77, s2, 5
  s_and_b32 s78, s2, 127
  s_and_b32 s76, s2, 7
  s_lshl_b32 s76, s76, 2
  s_bfe_u32 s97, s2, 0x20003
  s_add_u32 s76, s76, s97
  s_bfe_u32 s79, s2, 0x40003
  s_and_b32 s80, s2, 7
  s_bfe_u32 s17, s2, 0x20003
  s_bfe_u32 s59, s2, 0x10004
  s_lshl_b32 s59, s59, 14
  s_lshl_b32 s81, s95, 2
  s_add_u32 s81, s81, s94
  s_lshl_b32 s81, s81, 8
  s_add_u32 s81, s81, 0
  v_and_b32 v8, 7, v1
  v_lshlrev_b32 v8, 2, v8
  v_lshrrev_b32 v9, 4, v1
  v_add_u32 v8, v8, v9
  v_lshlrev_b32 v8, 5, v8
  s_lshl_b32 s92, s3, 2
  s_add_u32 s92, s92, 139248
  v_add_u32 v8, s92, v8
  v_lshlrev_b32 v9, 6, v1
  v_add_u32 v9, 139264, v9
  v_lshlrev_b32 v10, 4, v1
  s_bitcmp1_b32 s2, 6
  s_cbranch_scc1 L_nou0b
  s_waitcnt vmcnt(4)
  v_mov_b32 v253, 0
  global_load_dword v252, v253, s[30:31] sc1
  v_lshlrev_b32 v120, 16, v112
  v_and_b32 v121, 0xffff0000, v112
  v_lshlrev_b32 v122, 16, v113
  v_and_b32 v123, 0xffff0000, v113
  v_mul_f32 v116, 0xbfb8aa3b, v120
  v_mul_f32 v117, 0xbfb8aa3b, v121
  v_mul_f32 v118, 0xbfb8aa3b, v122
  v_mul_f32 v119, 0xbfb8aa3b, v123
  v_exp_f32 v116, v116
  v_exp_f32 v117, v117
  v_exp_f32 v118, v118
  v_exp_f32 v119, v119
  v_add_f32 v116, 1.0, v116
  v_add_f32 v117, 1.0, v117
  v_add_f32 v118, 1.0, v118
  v_add_f32 v119, 1.0, v119
  v_rcp_f32 v116, v116
  v_rcp_f32 v117, v117
  v_rcp_f32 v118, v118
  v_rcp_f32 v119, v119
  v_mul_f32 v120, v120, v116
  v_mul_f32 v121, v121, v117
  v_mul_f32 v122, v122, v118
  v_mul_f32 v123, v123, v119
  v_cvt_pk_bf16_f32 v120, v120, v120
  v_cvt_pk_bf16_f32 v121, v121, v121
  v_cvt_pk_bf16_f32 v122, v122, v122
  v_cvt_pk_bf16_f32 v123, v123, v123
  v_lshrrev_b32 v116, 16, v120
  v_lshrrev_b32 v117, 16, v121
  v_lshrrev_b32 v118, 16, v122
  v_lshrrev_b32 v119, 16, v123
  v_and_b32 v120, 0xffff0000, v120
  v_and_b32 v121, 0xffff0000, v121
  v_and_b32 v122, 0xffff0000, v122
  v_and_b32 v123, 0xffff0000, v123
  v_mov_b32 v96, 0
  v_mov_b32 v97, 0
  v_mov_b32 v98, 0
  v_mov_b32 v99, 0
  v_mov_b32 v100, 0
  v_mov_b32 v101, 0
  v_mov_b32 v102, 0
  v_mov_b32 v103, 0
  s_waitcnt vmcnt(4)
  v_dot2c_f32_bf16 v96, v116, v124
  v_dot2c_f32_bf16 v97, v120, v124
  v_dot2c_f32_bf16 v98, v116, v125
  v_dot2c_f32_bf16 v99, v120, v125
  v_dot2c_f32_bf16 v100, v116, v126
  v_dot2c_f32_bf16 v101, v120, v126
  v_dot2c_f32_bf16 v102, v116, v127
  v_dot2c_f32_bf16 v103, v120, v127
  s_waitcnt vmcnt(3)
  v_dot2c_f32_bf16 v96, v117, v128
  v_dot2c_f32_bf16 v97, v121, v128
  v_dot2c_f32_bf16 v98, v117, v129
  v_dot2c_f32_bf16 v99, v121, v129
  v_dot2c_f32_bf16 v100, v117, v130
  v_dot2c_f32_bf16 v101, v121, v130
  v_dot2c_f32_bf16 v102, v117, v131
  v_dot2c_f32_bf16 v103, v121, v131
  s_waitcnt vmcnt(2)
  v_dot2c_f32_bf16 v96, v118, v132
  v_dot2c_f32_bf16 v97, v122, v132
  v_dot2c_f32_bf16 v98, v118, v133
  v_dot2c_f32_bf16 v99, v122, v133
  v_dot2c_f32_bf16 v100, v118, v134
  v_dot2c_f32_bf16 v101, v122, v134
  v_dot2c_f32_bf16 v102, v118, v135
  v_dot2c_f32_bf16 v103, v122, v135
  s_waitcnt vmcnt(1)
  v_dot2c_f32_bf16 v96, v119, v136
  v_dot2c_f32_bf16 v97, v123, v136
  v_dot2c_f32_bf16 v98, v119, v137
  v_dot2c_f32_bf16 v99, v123, v137
  v_dot2c_f32_bf16 v100, v119, v138
  v_dot2c_f32_bf16 v101, v123, v138
  v_dot2c_f32_bf16 v102, v119, v139
  v_dot2c_f32_bf16 v103, v123, v139
  v_permlane32_swap_b32 v96, v100
  v_permlane32_swap_b32 v97, v101
  v_permlane32_swap_b32 v98, v102
  v_permlane32_swap_b32 v99, v103
  v_add_f32 v96, v96, v100
  v_add_f32 v97, v97, v101
  v_add_f32 v98, v98, v102
  v_add_f32 v99, v99, v103
  s_nop 0
  v_permlane16_swap_b32 v96, v98
  v_permlane16_swap_b32 v97, v99
  v_add_f32 v96, v96, v98
  v_add_f32 v97, v97, v99
  s_nop 0
  v_add_f32_dpp v96, v96, v96 row_ror:8 row_mask:0xf bank_mask:0xf
  v_add_f32_dpp v97, v97, v97 row_ror:8 row_mask:0xf bank_mask:0xf
  s_mov_b32 s100, 0
  s_waitcnt vmcnt(0)
  s_branch L_epc_17
L_ep_16:
  global_load_dword v252, v253, s[30:31] sc1
  s_add_u32 s100, s100, 1
  s_cmp_gt_u32 s100, 100000
  s_cbranch_scc1 L_abort
  s_waitcnt vmcnt(0)
L_epc_17:
  v_readfirstlane_b32 s48, v252
  s_nop 0
  s_cmp_eq_u32 s48, 0
  s_nop 1
  s_cbranch_scc1 L_ep_16
  s_mul_i32 s48, s48, 0x9e3779b1
  s_and_b32 s49, s48, 0xff
  s_bfe_u32 s50, s48, 0x80008
  s_bfe_u32 s51, s48, 0x80010
  s_lshr_b32 s52, s48, 24
  ds_write2_b32 v8, v96, v97 offset0:0 offset1:4
  s_waitcnt lgkmcnt(0)
  s_barrier
  s_cmp_lg_u32 s3, 4
  s_cbranch_scc1 L_nopub_18
  s_mov_b64 exec, 0xffff
  ds_read_b128 v[124:127], v9 offset:0
  ds_read_b128 v[128:131], v9 offset:16
  ds_read_b128 v[132:135], v9 offset:32
  ds_read_b128 v[136:139], v9 offset:48
  s_waitcnt lgkmcnt(3)
  v_add_f32 v124, v124, v125
  v_add_f32 v126, v126, v127
  v_add_f32 v124, v124, v126
  s_waitcnt lgkmcnt(2)
  v_add_f32 v128, v128, v129
  v_add_f32 v130, v130, v131
  v_add_f32 v128, v128, v130
  s_waitcnt lgkmcnt(1)
  v_add_f32 v132, v132, v133
  v_add_f32 v134, v134, v135
  v_add_f32 v132, v132, v134
  s_waitcnt lgkmcnt(0)
  v_add_f32 v136, v136, v137
  v_add_f32 v138, v138, v139
  v_add_f32 v136, v136, v138
  v_and_or_b32 v100, v124, v2, s49
  v_and_or_b32 v101, v128, v2, s50
  v_and_or_b32 v102, v132, v2, s51
  v_and_or_b32 v103, v136, v2, s52
  buffer_store_dwordx4 v[100:103], v10, s[32:35], s81 offen sc1
L_nopub_18:
  s_mov_b64 exec, -1
  s_barrier
  s_branch L_nou0c
L_nou0b:
  v_lshlrev_b32 v12, 7, v1
  v_lshlrev_b32 v14, 9, v1
  s_bfe_u32 s93, s2, 0x30003
  s_and_b32 s94, s2, 7
  s_cmp_lg_u32 s3, 4
  s_cbranch_scc1 L_ew5
  s_mov_b32 exec_hi, 0
  s_lshl_b32 s92, s93, 12
  s_add_u32 s92, s92, 0x10000
  buffer_load_dword v254, v12, s[32:35], s92 offen sc1
  s_lshl_b32 s92, s93, 14
  s_lshr_b32 s97, s94, 1
  s_lshl_b32 s97, s97, 7
  s_add_u32 s92, s92, s97
  s_add_u32 s92, s92, 0x20000
  buffer_load_dword v254, v14, s[32:35], s92 offen sc1
  s_mov_b32 exec_lo, 0xffff
  s_lshl_b32 s92, s94, 14
  s_lshl_b32 s97, s93, 11
  s_add_u32 s92, s92, s97
  s_add_u32 s92, s92, 0x80000
  buffer_load_dword v254, v12, s[32:35], s92 offen sc1
  s_lshl_b32 s92, s94, 11
  s_add_u32 s92, s92, 0x18000
  buffer_load_dword v254, v12, s[32:35], s92 offen sc1
  s_lshl_b32 s92, s93, 11
  buffer_load_dword v254, v12, s[32:35], s92 offen sc1
  s_branch L_ewx
L_ew5:
  s_cmp_lg_u32 s3, 5
  s_cbranch_scc1 L_ew6
  s_mov_b32 exec_hi, 0
  s_min_u32 s95, s93, 6
  s_mul_i32 s92, s94, 28672
  s_lshl_b32 s97, s95, 12
  s_add_u32 s92, s92, s97
  s_add_u32 s92, s92, 0xd0000
  buffer_load_dword v254, v12, s[32:35], s92 offen sc1
  s_branch L_ewx
L_ew6:
  s_cmp_lg_u32 s3, 6
  s_cbranch_scc1 L_ew7
  s_mov_b32 exec_hi, 0
  s_cmp_lg_u32 s94, 0
  s_cbranch_scc1 L_ewx
  s_mul_i32 s92, s93, 8448
  s_add_u32 s92, s92, 0x60000
  buffer_load_dword v254, v12, s[32:35], s92 offen sc1
  s_add_u32 s92, s92, 4224
  buffer_load_dword v254, v12, s[32:35], s92 offen sc1
  s_branch L_ewx
L_ew7:
  s_cmp_ge_u32 s93, 4
  s_cbranch_scc1 L_ew7b
  s_mov_b32 exec_hi, 0
  s_lshl_b32 s92, s94, 14
  s_lshl_b32 s97, s93, 12
  s_add_u32 s92, s92, s97
  s_add_u32 s92, s92, 0x40000
  buffer_load_dword v254, v12, s[32:35], s92 offen sc1
  s_branch L_ewx
L_ew7b:
  s_mul_i32 s92, s94, 8448
  s_and_b32 s97, s93, 1
  s_mul_i32 s97, s97, 67584
  s_add_u32 s92, s92, s97
  s_add_u32 s92, s92, 0xa0000
  buffer_load_dword v254, v12, s[32:35], s92 offen sc1
L_ewx:
  s_mov_b64 exec, -1
  s_barrier
  s_barrier
  s_mov_b32 s100, 0
  v_mov_b32 v253, 0
L_ep_19:
  global_load_dword v252, v253, s[30:31] sc1
  s_add_u32 s100, s100, 1
  s_cmp_gt_u32 s100, 100000
  s_cbranch_scc1 L_abort
  s_waitcnt vmcnt(0)
L_epc_20:
  v_readfirstlane_b32 s48, v252
  s_nop 0
  s_cmp_eq_u32 s48, 0
  s_nop 1
  s_cbranch_scc1 L_ep_19
  s_mul_i32 s48, s48, 0x9e3779b1
  s_and_b32 s49, s48, 0xff
  s_bfe_u32 s50, s48, 0x80008
  s_bfe_u32 s51, s48, 0x80010
  s_lshr_b32 s52, s48, 24
L_nou0c:
  s_lshr_b32 s97, s48, 15
  s_xor_b32 s97, s97, s48
  s_mul_i32 s97, s97, 0x85ebca6b
  v_mov_b32 v4, s48
  v_mov_b32 v5, s97
  v_mov_b32 v249, s48
  v_mov_b32 v250, s97
  v_and_b32 v6, 4, v1
  v_cmp_eq_u32 vcc, 0, v6
  v_and_b32 v7, 3, v1
  v_lshlrev_b32 v7, 2, v7
  v_cndmask_b32 v4, v5, v4, vcc
  v_lshrrev_b32 v4, v7, v4
  v_lshrrev_b32 v5, 1, v4
  v_lshrrev_b32 v6, 2, v4
  v_lshrrev_b32 v7, 3, v4
  v_lshrrev_b32 v245, 4, v1
  v_and_b32 v246, 15, v1
  v_lshlrev_b32 v247, 2, v245
  v_xor_b32 v246, v246, v247
  v_lshlrev_b32 v246, 4, v246
  v_lshl_add_u32 v244, v245, 10, v246
  v_xor_b32 v245, 16, v244
  v_xor_b32 v246, 32, v244
  v_xor_b32 v247, 48, v244
  v_add_u32 v245, 3072, v245
  v_add_u32 v246, 6144, v246
  v_add_u32 v247, 9216, v247
  s_and_b32 s91, s3, 3
  s_lshl_b32 s90, s91, 15
  s_lshl_b32 s91, s91, 13
  s_lshl_b32 s92, s2, 17
  s_add_u32 s90, s90, s92
  s_bfe_u32 s93, s2, 0x20003
  s_lshl_b32 s92, s93, 15
  s_add_u32 s91, s91, s92
  s_lshl_b32 s92, s93, 8
  s_add_u32 s90, s90, s92
  s_mov_b64 s[36:37], s[6:7]
  s_mov_b32 s38, 0x2000000
  s_mov_b32 s39, 0x20000
  v_lshlrev_b32 v12, 21, v1
  v_add_u32 v12, 0xf000, v12
  s_mov_b64 exec, 0x3f
  buffer_load_dword v254, v12, s[32:35], 0 offen
  s_mov_b64 exec, -1
  s_and_b32 s81, s3, 3
  s_lshl_b32 s81, s81, 13
  s_add_u32 s81, s81, 0x10000
  v_lshlrev_b32 v8, 4, v1
  s_add_u32 s82, s81, 4096
  v_lshrrev_b32 v9, 4, v1
  v_lshlrev_b32 v9, 13, v9
  v_and_b32 v3, 15, v1
  v_lshl_add_u32 v9, v3, 4, v9
  s_and_b32 s93, s3, 3
  s_lshl_b32 s93, s93, 11
  s_and_b32 s97, s3, 1
  s_lshl_b32 s97, s97, 5
  s_add_u32 s93, s93, s97
  s_add_u32 s93, s93, 0x20000
  v_xor_b32 v9, s93, v9
  s_xor_b32 m0, s91, 4096
  s_xor_b32 s101, s90, 16384
  buffer_load_dwordx4 v244, s[36:39], s101 offen offset:0 nt lds
  s_waitcnt vmcnt(0)
  buffer_load_dwordx4 v245, s[36:39], s101 offen offset:1024 nt lds
  s_waitcnt vmcnt(0)
  buffer_load_dwordx4 v246, s[36:39], s101 offen offset:2048 nt lds
  s_waitcnt vmcnt(2)
  buffer_load_dwordx4 v247, s[36:39], s101 offen offset:3072 nt lds
  s_waitcnt vmcnt(2)
  s_xor_b32 m0, s91, 36864
  s_xor_b32 s101, s90, 16640
  buffer_load_dwordx4 v244, s[36:39], s101 offen offset:0 nt lds
  s_waitcnt vmcnt(2)
  buffer_load_dwordx4 v245, s[36:39], s101 offen offset:1024 nt lds
  s_waitcnt vmcnt(2)
  buffer_load_dwordx4 v246, s[36:39], s101 offen offset:2048 nt lds
  s_waitcnt vmcnt(2)
  buffer_load_dwordx4 v247, s[36:39], s101 offen offset:3072 nt lds
  s_waitcnt vmcnt(2)
  s_xor_b32 m0, s91, 69632
  s_xor_b32 s101, s90, 16896
  buffer_load_dwordx4 v244, s[36:39], s101 offen offset:0 nt lds
  buffer_load_dwordx4 v245, s[36:39], s101 offen offset:1024 nt lds
  buffer_load_dwordx4 v246, s[36:39], s101 offen offset:2048 nt lds
  buffer_load_dwordx4 v247, s[36:39], s101 offen offset:3072 nt lds
  s_mov_b64 s[40:41], s[26:27]
  s_mov_b32 s42, 0x300000
  s_mov_b32 s43, 0x20000
  v_lshrrev_b32 v13, 3, v1
  v_mul_u32_u24 v13, 24576, v13
  v_and_b32 v3, 7, v1
  v_lshl_add_u32 v13, v3, 4, v13
  s_lshr_b32 s94, s78, 5
  s_lshl_b32 s94, s94, 2
  s_and_b32 s97, s3, 3
  s_add_u32 s94, s94, s97
  s_lshl_b32 s95, s94, 6
  v_lshrrev_b32 v14, 3, v1
  v_lshlrev_b32 v14, 3, v14
  v_add_u32 v14, s95, v14
  s_mul_i32 s92, s94, 196608
  s_and_b32 s97, s2, 31
  s_lshl_b32 s97, s97, 7
  s_add_u32 s92, s92, s97
  s_add_u32 s92, s92, 0x800
  global_load_dwordx2 v[144:145], v14, s[24:25]
  buffer_load_dwordx4 v[128:131], v13, s[40:43], s92 offen nt
  s_add_u32 s92, s92, 6144
  buffer_load_dwordx4 v[132:135], v13, s[40:43], s92 offen nt
  s_add_u32 s92, s92, 6144
  buffer_load_dwordx4 v[136:139], v13, s[40:43], s92 offen nt
  s_add_u32 s92, s92, 6144
  buffer_load_dwordx4 v[140:143], v13, s[40:43], s92 offen nt
  v_lshrrev_b32 v253, 4, v1
  v_lshlrev_b32 v253, 13, v253
  v_and_b32 v3, 15, v1
  v_lshl_add_u32 v253, v3, 4, v253
  s_lshl_b32 s88, s77, 19
  s_bfe_u32 s97, s3, 0x10001
  s_lshl_b32 s97, s97, 18
  s_add_u32 s88, s88, s97
  s_and_b32 s97, s3, 1
  s_lshl_b32 s97, s97, 15
  s_add_u32 s88, s88, s97
  s_lshl_b32 s97, s76, 8
  s_add_u32 s88, s88, s97
  v_lshrrev_b32 v251, 5, v1
  v_mul_u32_u24 v251, 3584, v251
  v_and_b32 v3, 31, v1
  v_lshl_add_u32 v251, v3, 4, v251
  s_mul_i32 s89, s79, 114688
  s_and_b32 s97, s3, 3
  s_mul_i32 s97, s97, 28672
  s_add_u32 s89, s89, s97
  s_mul_i32 s97, s80, 448
  s_add_u32 s89, s89, s97
  s_barrier
  s_branch L_back1
L_back:
  v_lshlrev_b32 v12, 21, v1
  v_add_u32 v12, 0xf000, v12
  s_mov_b64 exec, 0x3f
  buffer_load_dword v254, v12, s[32:35], 0 offen
  s_mov_b64 exec, -1
  s_and_b32 s81, s3, 3
  s_lshl_b32 s81, s81, 13
  s_add_u32 s81, s81, 0x10000
  v_lshlrev_b32 v8, 4, v1
  s_add_u32 s82, s81, 4096
  v_lshrrev_b32 v9, 4, v1
  v_lshlrev_b32 v9, 13, v9
  v_and_b32 v3, 15, v1
  v_lshl_add_u32 v9, v3, 4, v9
  s_and_b32 s93, s3, 3
  s_lshl_b32 s93, s93, 11
  s_and_b32 s97, s3, 1
  s_lshl_b32 s97, s97, 5
  s_add_u32 s93, s93, s97
  s_add_u32 s93, s93, 0x20000
  v_xor_b32 v9, s93, v9
  v_lshrrev_b32 v253, 4, v1
  v_lshlrev_b32 v253, 13, v253
  v_and_b32 v3, 15, v1
  v_lshl_add_u32 v253, v3, 4, v253
  s_lshl_b32 s88, s77, 19
  s_bfe_u32 s97, s3, 0x10001
  s_lshl_b32 s97, s97, 18
  s_add_u32 s88, s88, s97
  s_and_b32 s97, s3, 1
  s_lshl_b32 s97, s97, 15
  s_add_u32 s88, s88, s97
  s_lshl_b32 s97, s76, 8
  s_add_u32 s88, s88, s97
  v_lshrrev_b32 v251, 4, v1
  v_lshlrev_b32 v251, 10, v251
  v_and_b32 v3, 15, v1
  v_lshl_add_u32 v251, v3, 4, v251
  s_lshl_b32 s89, s76, 17
  s_and_b32 s97, s3, 3
  s_lshl_b32 s97, s97, 15
  s_add_u32 s89, s89, s97
  s_lshl_b32 s97, s77, 8
  s_add_u32 s89, s89, s97
  s_barrier
L_back1:
  buffer_load_dwordx4 v[48:51], v8, s[32:35], s81 offen offset:0 sc1
  buffer_load_dwordx4 v[52:55], v8, s[32:35], s81 offen offset:1024 sc1
  buffer_load_dwordx4 v[56:59], v8, s[32:35], s81 offen offset:2048 sc1
  buffer_load_dwordx4 v[60:63], v8, s[32:35], s81 offen offset:3072 sc1
  buffer_load_dwordx4 v[64:67], v8, s[32:35], s82 offen offset:0 sc1
  buffer_load_dwordx4 v[68:71], v8, s[32:35], s82 offen offset:1024 sc1
  buffer_load_dwordx4 v[72:75], v8, s[32:35], s82 offen offset:2048 sc1
  buffer_load_dwordx4 v[76:79], v8, s[32:35], s82 offen offset:3072 sc1
  s_xor_b32 m0, s91, 102400
  s_xor_b32 s101, s90, 17152
  buffer_load_dwordx4 v244, s[36:39], s101 offen offset:0 nt lds
  buffer_load_dwordx4 v245, s[36:39], s101 offen offset:1024 nt lds
  buffer_load_dwordx4 v246, s[36:39], s101 offen offset:2048 nt lds
  buffer_load_dwordx4 v247, s[36:39], s101 offen offset:3072 nt lds
  s_branch L_setup
L_back2:
  s_mov_b32 s101, 0
  s_mov_b64 s[60:61], -1
  s_mov_b64 s[62:63], -1
  s_mov_b64 s[64:65], -1
  s_mov_b64 s[66:67], -1
  s_mov_b64 s[68:69], -1
  s_mov_b64 s[70:71], -1
  s_mov_b64 s[72:73], -1
  s_mov_b64 s[74:75], -1
  s_waitcnt vmcnt(4)
  s_mov_b32 s100, 0
  s_branch L_gc_23
L_g_21:
  s_add_u32 s100, s100, 1
  s_cmp_gt_u32 s100, 100000
  s_cbranch_scc1 L_abort
  s_mov_b32 s92, 0
  s_cmp_lg_u32 s74, 0
  s_cselect_b32 s92, 7168, s92
  s_cmp_lg_u32 s72, 0
  s_cselect_b32 s92, 6144, s92
  s_cmp_lg_u32 s70, 0
  s_cselect_b32 s92, 5120, s92
  s_cmp_lg_u32 s68, 0
  s_cselect_b32 s92, 4096, s92
  s_cmp_lg_u32 s66, 0
  s_cselect_b32 s92, 3072, s92
  s_cmp_lg_u32 s64, 0
  s_cselect_b32 s92, 2048, s92
  s_cmp_lg_u32 s62, 0
  s_cselect_b32 s92, 1024, s92
  s_cmp_lg_u32 s60, 0
  s_cselect_b32 s92, 0, s92
  s_add_u32 s92, s92, s81
  s_mov_b64 exec, -1
L_qg_24:
  buffer_load_dwordx4 v[16:19], v8, s[32:35], s92 offen sc1
  s_add_u32 s100, s100, 1
  s_cmp_gt_u32 s100, 100000
  s_cbranch_scc1 L_abort
  s_waitcnt vmcnt(0)
  v_xor_b32 v16, v16, v4
  v_bitop3_b32 v16, v17, v5, v16 bitop3:0xbe
  v_bitop3_b32 v16, v18, v6, v16 bitop3:0xbe
  v_bitop3_b32 v16, v19, v7, v16 bitop3:0xbe
  v_and_b32 v16, s53, v16
  v_cmp_ne_u32 vcc, 0, v16
  s_nop 0
  s_cbranch_vccz L_qg_24x
  s_sleep 4
  s_branch L_qg_24
L_qg_24x:
L_gf_22:
  s_mov_b64 exec, s[60:61]
  s_cbranch_execz L_gs_25
  buffer_load_dwordx4 v[48:51], v8, s[32:35], s81 offen offset:0 sc1
L_gs_25:
  s_mov_b64 exec, s[62:63]
  s_cbranch_execz L_gs_26
  buffer_load_dwordx4 v[52:55], v8, s[32:35], s81 offen offset:1024 sc1
L_gs_26:
  s_mov_b64 exec, s[64:65]
  s_cbranch_execz L_gs_27
  buffer_load_dwordx4 v[56:59], v8, s[32:35], s81 offen offset:2048 sc1
L_gs_27:
  s_mov_b64 exec, s[66:67]
  s_cbranch_execz L_gs_28
  buffer_load_dwordx4 v[60:63], v8, s[32:35], s81 offen offset:3072 sc1
L_gs_28:
  s_mov_b64 exec, s[68:69]
  s_cbranch_execz L_gs_29
  buffer_load_dwordx4 v[64:67], v8, s[32:35], s82 offen offset:0 sc1
L_gs_29:
  s_mov_b64 exec, s[70:71]
  s_cbranch_execz L_gs_30
  buffer_load_dwordx4 v[68:71], v8, s[32:35], s82 offen offset:1024 sc1
L_gs_30:
  s_mov_b64 exec, s[72:73]
  s_cbranch_execz L_gs_31
  buffer_load_dwordx4 v[72:75], v8, s[32:35], s82 offen offset:2048 sc1
L_gs_31:
  s_mov_b64 exec, s[74:75]
  s_cbranch_execz L_gs_32
  buffer_load_dwordx4 v[76:79], v8, s[32:35], s82 offen offset:3072 sc1
L_gs_32:
  s_waitcnt vmcnt(0)
L_gc_23:
  s_mov_b64 exec, s[60:61]
  v_xor_b32 v44, v48, v4
  v_bitop3_b32 v44, v49, v5, v44 bitop3:0xbe
  v_bitop3_b32 v44, v50, v6, v44 bitop3:0xbe
  v_bitop3_b32 v44, v51, v7, v44 bitop3:0xbe
  v_and_b32 v44, s53, v44
  v_cmp_ne_u32 s[60:61], 0, v44
  s_nop 0
  s_cmp_lg_u64 s[60:61], 0
  s_cselect_b64 s[60:61], -1, 0
  s_mov_b64 exec, s[62:63]
  v_xor_b32 v44, v52, v4
  v_bitop3_b32 v44, v53, v5, v44 bitop3:0xbe
  v_bitop3_b32 v44, v54, v6, v44 bitop3:0xbe
  v_bitop3_b32 v44, v55, v7, v44 bitop3:0xbe
  v_and_b32 v44, s53, v44
  v_cmp_ne_u32 s[62:63], 0, v44
  s_nop 0
  s_cmp_lg_u64 s[62:63], 0
  s_cselect_b64 s[62:63], -1, 0
  s_mov_b64 exec, s[64:65]
  v_xor_b32 v44, v56, v4
  v_bitop3_b32 v44, v57, v5, v44 bitop3:0xbe
  v_bitop3_b32 v44, v58, v6, v44 bitop3:0xbe
  v_bitop3_b32 v44, v59, v7, v44 bitop3:0xbe
  v_and_b32 v44, s53, v44
  v_cmp_ne_u32 s[64:65], 0, v44
  s_nop 0
  s_cmp_lg_u64 s[64:65], 0
  s_cselect_b64 s[64:65], -1, 0
  s_mov_b64 exec, s[66:67]
  v_xor_b32 v44, v60, v4
  v_bitop3_b32 v44, v61, v5, v44 bitop3:0xbe
  v_bitop3_b32 v44, v62, v6, v44 bitop3:0xbe
  v_bitop3_b32 v44, v63, v7, v44 bitop3:0xbe
  v_and_b32 v44, s53, v44
  v_cmp_ne_u32 s[66:67], 0, v44
  s_nop 0
  s_cmp_lg_u64 s[66:67], 0
  s_cselect_b64 s[66:67], -1, 0
  s_mov_b64 exec, s[68:69]
  v_xor_b32 v44, v64, v4
  v_bitop3_b32 v44, v65, v5, v44 bitop3:0xbe
  v_bitop3_b32 v44, v66, v6, v44 bitop3:0xbe
  v_bitop3_b32 v44, v67, v7, v44 bitop3:0xbe
  v_and_b32 v44, s53, v44
  v_cmp_ne_u32 s[68:69], 0, v44
  s_nop 0
  s_cmp_lg_u64 s[68:69], 0
  s_cselect_b64 s[68:69], -1, 0
  s_mov_b64 exec, s[70:71]
  v_xor_b32 v44, v68, v4
  v_bitop3_b32 v44, v69, v5, v44 bitop3:0xbe
  v_bitop3_b32 v44, v70, v6, v44 bitop3:0xbe
  v_bitop3_b32 v44, v71, v7, v44 bitop3:0xbe
  v_and_b32 v44, s53, v44
  v_cmp_ne_u32 s[70:71], 0, v44
  s_nop 0
  s_cmp_lg_u64 s[70:71], 0
  s_cselect_b64 s[70:71], -1, 0
  s_mov_b64 exec, s[72:73]
  v_xor_b32 v44, v72, v4
  v_bitop3_b32 v44, v73, v5, v44 bitop3:0xbe
  v_bitop3_b32 v44, v74, v6, v44 bitop3:0xbe
  v_bitop3_b32 v44, v75, v7, v44 bitop3:0xbe
  v_and_b32 v44, s53, v44
  v_cmp_ne_u32 s[72:73], 0, v44
  s_nop 0
  s_cmp_lg_u64 s[72:73], 0
  s_cselect_b64 s[72:73], -1, 0
  s_mov_b64 exec, s[74:75]
  v_xor_b32 v44, v76, v4
  v_bitop3_b32 v44, v77, v5, v44 bitop3:0xbe
  v_bitop3_b32 v44, v78, v6, v44 bitop3:0xbe
  v_bitop3_b32 v44, v79, v7, v44 bitop3:0xbe
  v_and_b32 v44, s53, v44
  v_cmp_ne_u32 s[74:75], 0, v44
  s_nop 0
  s_cmp_lg_u64 s[74:75], 0
  s_cselect_b64 s[74:75], -1, 0
  s_or_b64 s[96:97], s[60:61], s[62:63]
  s_or_b64 s[96:97], s[96:97], s[64:65]
  s_or_b64 s[96:97], s[96:97], s[66:67]
  s_or_b64 s[96:97], s[96:97], s[68:69]
  s_or_b64 s[96:97], s[96:97], s[70:71]
  s_or_b64 s[96:97], s[96:97], s[72:73]
  s_or_b64 s[96:97], s[96:97], s[74:75]
  s_cbranch_scc1 L_g_21
  s_mov_b64 exec, -1
  s_mov_b32 s101, 0
  v_xor_b32 v10, 0, v9
  ds_write_b128 v10, v[48:51] offset:0
  v_xor_b32 v11, 64, v9
  ds_write_b128 v11, v[52:55] offset:256
  v_xor_b32 v10, 128, v9
  ds_write_b128 v10, v[56:59] offset:512
  v_xor_b32 v11, 192, v9
  ds_write_b128 v11, v[60:63] offset:768
  v_xor_b32 v10, 16, v9
  ds_write_b128 v10, v[64:67] offset:1024
  v_xor_b32 v11, 80, v9
  ds_write_b128 v11, v[68:71] offset:1280
  v_xor_b32 v10, 144, v9
  ds_write_b128 v10, v[72:75] offset:1536
  v_xor_b32 v11, 208, v9
  ds_write_b128 v11, v[76:79] offset:1792
  s_mov_b64 s[40:41], s[14:15]
  s_mov_b32 s42, 0x400000
  s_mov_b32 s43, 0x20000
  s_mov_b64 s[44:45], s[12:13]
  s_mov_b32 s46, 0x400000
  s_mov_b32 s47, 0x20000
  s_waitcnt lgkmcnt(0)
  s_setprio 3
  s_barrier
  s_cmp_lt_u32 s2, 128
  s_cbranch_scc0 L_lwB
  s_cmp_lg_u32 s101, 0
  s_cbranch_scc1 L_lwX
  buffer_load_dwordx4 v[176:179], v253, s[44:47], s88 offen nt
  s_add_u32 s88, s88, 65536
  buffer_load_dwordx4 v[180:183], v253, s[44:47], s88 offen nt
  s_add_u32 s88, s88, 65536
  buffer_load_dwordx4 v[184:187], v253, s[44:47], s88 offen nt
  s_add_u32 s88, s88, 65536
  buffer_load_dwordx4 v[188:191], v253, s[44:47], s88 offen nt
  buffer_load_dwordx4 v[208:211], v251, s[40:43], s89 offen nt
  s_add_u32 s89, s89, 4096
  buffer_load_dwordx4 v[212:215], v251, s[40:43], s89 offen nt
  s_add_u32 s89, s89, 4096
  buffer_load_dwordx4 v[216:219], v251, s[40:43], s89 offen nt
  s_add_u32 s89, s89, 4096
  buffer_load_dwordx4 v[220:223], v251, s[40:43], s89 offen nt
  s_add_u32 s89, s89, 4096
  buffer_load_dwordx4 v[224:227], v251, s[40:43], s89 offen nt
  s_add_u32 s89, s89, 4096
  buffer_load_dwordx4 v[228:231], v251, s[40:43], s89 offen nt
  s_add_u32 s89, s89, 4096
  buffer_load_dwordx4 v[232:235], v251, s[40:43], s89 offen nt
  s_add_u32 s89, s89, 4096
  buffer_load_dwordx4 v[236:239], v251, s[40:43], s89 offen nt
L_lwX:
  s_barrier
  s_waitcnt vmcnt(12)
  s_barrier
  s_barrier
  s_barrier
  s_branch L_pv
L_lwB:
  s_cmp_lg_u32 s101, 0
  s_cbranch_scc1 L_lwB2
  buffer_load_dwordx4 v[176:179], v253, s[44:47], s88 offen nt
  s_add_u32 s88, s88, 65536
  buffer_load_dwordx4 v[180:183], v253, s[44:47], s88 offen nt
  s_add_u32 s88, s88, 65536
  buffer_load_dwordx4 v[184:187], v253, s[44:47], s88 offen nt
  s_add_u32 s88, s88, 65536
  buffer_load_dwordx4 v[188:191], v253, s[44:47], s88 offen nt
  s_mov_b64 s[40:41], s[18:19]
  s_mov_b32 s42, 0x1c0000
  s_mov_b32 s43, 0x20000
  s_mov_b64 s[44:45], s[20:21]
  s_mov_b32 s46, 0x1c0000
  s_mov_b32 s47, 0x20000
  s_mov_b32 exec_lo, 0xfffffff
  s_mov_b32 exec_hi, 0xfffffff
  buffer_load_dwordx4 v[208:211], v251, s[40:43], s89 offen nt
  buffer_load_dwordx4 v[212:215], v251, s[44:47], s89 offen nt
  s_add_u32 s89, s89, 7168
  buffer_load_dwordx4 v[216:219], v251, s[40:43], s89 offen nt
  buffer_load_dwordx4 v[220:223], v251, s[44:47], s89 offen nt
  s_add_u32 s89, s89, 7168
  buffer_load_dwordx4 v[224:227], v251, s[40:43], s89 offen nt
  buffer_load_dwordx4 v[228:231], v251, s[44:47], s89 offen nt
  s_add_u32 s89, s89, 7168
  buffer_load_dwordx4 v[232:235], v251, s[40:43], s89 offen nt
  buffer_load_dwordx4 v[236:239], v251, s[44:47], s89 offen nt
  s_mov_b64 exec, -1
L_lwB2:
  s_and_b32 s74, s2, 31
  s_lshl_b32 s74, s74, 10
  s_lshr_b32 s97, s78, 5
  s_lshl_b32 s97, s97, 8
  s_add_u32 s74, s74, s97
  s_add_u32 s74, s74, 0x4000
  v_and_b32 v13, 7, v1
  v_lshlrev_b32 v13, 2, v13
  v_lshrrev_b32 v14, 4, v1
  v_add_u32 v13, v13, v14
  v_lshlrev_b32 v13, 5, v13
  s_lshl_b32 s92, s3, 2
  s_add_u32 s92, s92, 141296
  v_add_u32 v13, s92, v13
  v_lshlrev_b32 v14, 6, v1
  v_add_u32 v14, 141312, v14
  v_lshlrev_b32 v15, 4, v1
  v_xor_b32 v13, s59, v13
  v_xor_b32 v14, s59, v14
  s_waitcnt vmcnt(63)
  v_lshlrev_b32 v116, 16, v144
  v_and_b32 v117, 0xffff0000, v144
  v_lshlrev_b32 v118, 16, v145
  v_and_b32 v119, 0xffff0000, v145
  v_mul_f32 v112, 0xbfb8aa3b, v116
  v_mul_f32 v113, 0xbfb8aa3b, v117
  v_mul_f32 v114, 0xbfb8aa3b, v118
  v_mul_f32 v115, 0xbfb8aa3b, v119
  v_exp_f32 v112, v112
  v_exp_f32 v113, v113
  v_exp_f32 v114, v114
  v_exp_f32 v115, v115
  v_add_f32 v112, 1.0, v112
  v_add_f32 v113, 1.0, v113
  v_add_f32 v114, 1.0, v114
  v_add_f32 v115, 1.0, v115
  v_rcp_f32 v112, v112
  v_rcp_f32 v113, v113
  v_rcp_f32 v114, v114
  v_rcp_f32 v115, v115
  v_mul_f32 v116, v116, v112
  v_mul_f32 v117, v117, v113
  v_mul_f32 v118, v118, v114
  v_mul_f32 v119, v119, v115
  v_cvt_pk_bf16_f32 v116, v116, v116
  v_cvt_pk_bf16_f32 v117, v117, v117
  v_cvt_pk_bf16_f32 v118, v118, v118
  v_cvt_pk_bf16_f32 v119, v119, v119
  v_lshrrev_b32 v112, 16, v116
  v_lshrrev_b32 v113, 16, v117
  v_lshrrev_b32 v114, 16, v118
  v_lshrrev_b32 v115, 16, v119
  v_and_b32 v116, 0xffff0000, v116
  v_and_b32 v117, 0xffff0000, v117
  v_and_b32 v118, 0xffff0000, v118
  v_and_b32 v119, 0xffff0000, v119
  v_mov_b32 v96, 0
  v_mov_b32 v97, 0
  v_mov_b32 v98, 0
  v_mov_b32 v99, 0
  v_mov_b32 v100, 0
  v_mov_b32 v101, 0
  v_mov_b32 v102, 0
  v_mov_b32 v103, 0
  s_waitcnt vmcnt(63)
  v_dot2c_f32_bf16 v96, v112, v128
  v_dot2c_f32_bf16 v97, v116, v128
  v_dot2c_f32_bf16 v98, v112, v129
  v_dot2c_f32_bf16 v99, v116, v129
  v_dot2c_f32_bf16 v100, v112, v130
  v_dot2c_f32_bf16 v101, v116, v130
  v_dot2c_f32_bf16 v102, v112, v131
  v_dot2c_f32_bf16 v103, v116, v131
  s_waitcnt vmcnt(62)
  v_dot2c_f32_bf16 v96, v113, v132
  v_dot2c_f32_bf16 v97, v117, v132
  v_dot2c_f32_bf16 v98, v113, v133
  v_dot2c_f32_bf16 v99, v117, v133
  v_dot2c_f32_bf16 v100, v113, v134
  v_dot2c_f32_bf16 v101, v117, v134
  v_dot2c_f32_bf16 v102, v113, v135
  v_dot2c_f32_bf16 v103, v117, v135
  s_waitcnt vmcnt(61)
  v_dot2c_f32_bf16 v96, v114, v136
  v_dot2c_f32_bf16 v97, v118, v136
  v_dot2c_f32_bf16 v98, v114, v137
  v_dot2c_f32_bf16 v99, v118, v137
  v_dot2c_f32_bf16 v100, v114, v138
  v_dot2c_f32_bf16 v101, v118, v138
  v_dot2c_f32_bf16 v102, v114, v139
  v_dot2c_f32_bf16 v103, v118, v139
  s_waitcnt vmcnt(60)
  v_dot2c_f32_bf16 v96, v115, v140
  v_dot2c_f32_bf16 v97, v119, v140
  v_dot2c_f32_bf16 v98, v115, v141
  v_dot2c_f32_bf16 v99, v119, v141
  v_dot2c_f32_bf16 v100, v115, v142
  v_dot2c_f32_bf16 v101, v119, v142
  v_dot2c_f32_bf16 v102, v115, v143
  v_dot2c_f32_bf16 v103, v119, v143
  v_permlane32_swap_b32 v96, v100
  v_permlane32_swap_b32 v97, v101
  v_permlane32_swap_b32 v98, v102
  v_permlane32_swap_b32 v99, v103
  v_add_f32 v96, v96, v100
  v_add_f32 v97, v97, v101
  v_add_f32 v98, v98, v102
  v_add_f32 v99, v99, v103
  s_nop 0
  v_permlane16_swap_b32 v96, v98
  v_permlane16_swap_b32 v97, v99
  v_add_f32 v96, v96, v98
  v_add_f32 v97, v97, v99
  s_nop 0
  v_add_f32_dpp v96, v96, v96 row_ror:8 row_mask:0xf bank_mask:0xf
  v_add_f32_dpp v97, v97, v97 row_ror:8 row_mask:0xf bank_mask:0xf
  s_barrier
  s_waitcnt vmcnt(12)
  s_barrier
  ds_write2_b32 v13, v96, v97 offset0:0 offset1:4
  s_waitcnt lgkmcnt(0)
  s_barrier
  s_cmp_lg_u32 s3, 4
  s_cbranch_scc1 L_nopub_33
  s_mov_b64 exec, 0xffff
  ds_read_b128 v[128:131], v14 offset:0
  ds_read_b128 v[132:135], v14 offset:16
  ds_read_b128 v[136:139], v14 offset:32
  ds_read_b128 v[140:143], v14 offset:48
  s_waitcnt lgkmcnt(3)
  v_add_f32 v128, v128, v129
  v_add_f32 v130, v130, v131
  v_add_f32 v128, v128, v130
  s_waitcnt lgkmcnt(2)
  v_add_f32 v132, v132, v133
  v_add_f32 v134, v134, v135
  v_add_f32 v132, v132, v134
  s_waitcnt lgkmcnt(1)
  v_add_f32 v136, v136, v137
  v_add_f32 v138, v138, v139
  v_add_f32 v136, v136, v138
  s_waitcnt lgkmcnt(0)
  v_add_f32 v140, v140, v141
  v_add_f32 v142, v142, v143
  v_add_f32 v140, v140, v142
  v_and_or_b32 v100, v128, v2, s49
  v_and_or_b32 v101, v132, v2, s50
  v_and_or_b32 v102, v136, v2, s51
  v_and_or_b32 v103, v140, v2, s52
  buffer_store_dwordx4 v[100:103], v15, s[32:35], s74 offen sc1
L_nopub_33:
  s_mov_b64 exec, -1
  s_barrier
  s_branch L_pv
L_front:
  s_mov_b32 s100, 0
  s_waitcnt vmcnt(4)
  s_branch L_epc_35
L_ep_34:
  global_load_dword v252, v253, s[30:31] sc1
  s_add_u32 s100, s100, 1
  s_cmp_gt_u32 s100, 100000
  s_cbranch_scc1 L_abort
  s_waitcnt vmcnt(0)
L_epc_35:
  v_readfirstlane_b32 s48, v252
  s_nop 0
  s_cmp_eq_u32 s48, 0
  s_nop 1
  s_cbranch_scc1 L_ep_34
  s_mul_i32 s48, s48, 0x9e3779b1
  s_and_b32 s49, s48, 0xff
  s_bfe_u32 s50, s48, 0x80008
  s_bfe_u32 s51, s48, 0x80010
  s_lshr_b32 s52, s48, 24
  s_lshr_b32 s97, s48, 15
  s_xor_b32 s97, s97, s48
  s_mul_i32 s97, s97, 0x85ebca6b
  v_mov_b32 v4, s48
  v_mov_b32 v5, s97
  v_mov_b32 v249, s48
  v_mov_b32 v250, s97
  v_and_b32 v6, 4, v1
  v_cmp_eq_u32 vcc, 0, v6
  v_and_b32 v7, 3, v1
  v_lshlrev_b32 v7, 2, v7
  v_cndmask_b32 v4, v5, v4, vcc
  v_lshrrev_b32 v4, v7, v4
  v_lshrrev_b32 v5, 1, v4
  v_lshrrev_b32 v6, 2, v4
  v_lshrrev_b32 v7, 3, v4
L_setup:
  s_lshr_b32 s92, s3, 1
  s_lshl_b32 s92, s92, 15
  s_and_b32 s93, s3, 1
  v_lshlrev_b32 v34, 4, v1
  v_bfe_u32 v44, v1, 2, 2
  v_lshrrev_b32 v45, 5, v1
  v_lshl_add_u32 v46, v45, 2, v44
  v_lshlrev_b32 v46, 8, v46
  v_add_u32 v46, s92, v46
  v_and_b32 v47, 1, v1
  v_lshl_add_u32 v46, v47, 3, v46
  v_lshl_or_b32 v44, v44, 2, v45
  v_bfe_u32 v47, v1, 4, 1
  v_lshlrev_b32 v47, 1, v47
  v_xor_b32 v44, v44, v47
  v_bfe_u32 v47, v1, 1, 1
  v_xor_b32 v44, v44, v47
  s_lshl_b32 s94, s93, 3
  v_xor_b32 v44, s94, v44
  v_xor_b32 v47, 0, v44
  v_lshl_add_u32 v24, v47, 4, v46
  v_xor_b32 v47, 2, v44
  v_lshl_add_u32 v25, v47, 4, v46
  v_add_u32 v25, 2048, v25
  v_xor_b32 v47, 4, v44
  v_lshl_add_u32 v26, v47, 4, v46
  v_xor_b32 v47, 6, v44
  v_lshl_add_u32 v27, v47, 4, v46
  v_add_u32 v27, 2048, v27
  v_add_u32 v28, 132096, v34
  v_and_b32 v44, 31, v1
  v_lshlrev_b32 v29, 5, v44
  v_add_u32 v29, 131072, v29
  v_xor_b32 v28, s59, v28
  v_xor_b32 v29, s59, v29
  s_lshl_b32 s94, s93, 7
  s_add_u32 s94, s94, s92
  v_and_b32 v46, 3, v44
  v_lshlrev_b32 v46, 6, v46
  v_lshl_add_u32 v46, v44, 8, v46
  v_bfe_u32 v47, v44, 1, 2
  v_lshlrev_b32 v45, 1, v45
  v_xor_b32 v47, v47, v45
  v_lshl_add_u32 v46, v47, 4, v46
  v_xor_b32 v244, s94, v46
  v_xor_b32 v245, 16, v244
  v_xor_b32 v246, 64, v244
  v_xor_b32 v247, 0x50, v244
  v_lshrrev_b32 v44, 2, v1
  v_and_b32 v46, 3, v44
  v_lshlrev_b32 v46, 6, v46
  v_lshl_add_u32 v46, v44, 8, v46
  v_bfe_u32 v47, v44, 1, 2
  v_and_b32 v45, 3, v1
  v_xor_b32 v47, v47, v45
  v_lshl_add_u32 v46, v47, 4, v46
  v_xor_b32 v32, s94, v46
  v_xor_b32 v33, 64, v32
  v_lshrrev_b32 v44, 3, v1
  v_bfe_u32 v45, v1, 2, 1
  v_and_b32 v46, 3, v44
  v_xor_b32 v46, v46, v45
  v_lshlrev_b32 v46, 6, v46
  v_lshl_add_u32 v46, v44, 8, v46
  v_lshrrev_b32 v47, 1, v44
  v_and_b32 v45, 3, v1
  v_xor_b32 v47, v47, v45
  v_lshl_add_u32 v46, v47, 4, v46
  v_xor_b32 v32, s94, v46
  s_mul_i32 s87, s2, 32896
  s_lshl_b32 s97, s3, 12
  s_add_u32 s87, s87, s97
  s_add_u32 s87, s87, 0x200000
  s_lshl_b32 s94, s76, 4
  s_lshl_b32 s97, s3, 9
  s_add_u32 s94, s94, s97
  s_add_u32 s94, s94, 0x20000
  v_lshrrev_b32 v35, 3, v1
  v_lshlrev_b32 v35, 12, v35
  v_add_u32 v35, s94, v35
  v_lshlrev_b32 v248, 4, v1
  v_lshrrev_b32 v36, 3, v1
  v_mul_u32_u24 v36, 263168, v36
  v_and_b32 v3, 7, v1
  v_lshl_add_u32 v36, v3, 4, v36
  s_mul_i32 s94, s3, 32896
  s_lshl_b32 s97, s77, 12
  s_add_u32 s94, s94, s97
  s_lshl_b32 s97, s76, 7
  s_add_u32 s94, s94, s97
  s_add_u32 s83, s94, 6307840
  s_add_u32 s84, s94, 8413184
  s_add_u32 s85, s94, 2097152
  s_add_u32 s86, s94, 4202496
  s_mul_i32 s94, s3, 144
  s_add_u32 s94, s94, 0x14000
  v_and_b32 v37, 7, v1
  v_lshlrev_b32 v37, 4, v37
  v_lshrrev_b32 v3, 4, v1
  v_lshl_add_u32 v37, v3, 2, v37
  v_add_u32 v37, s94, v37
  v_and_b32 v38, 7, v1
  v_mul_u32_u24 v38, 144, v38
  v_lshrrev_b32 v3, 4, v1
  v_lshl_add_u32 v38, v3, 4, v38
  v_add_u32 v38, 81920, v38
  s_lshl_b32 s94, s3, 7
  s_add_u32 s94, s94, 0x16c00
  v_lshrrev_b32 v41, 4, v1
  v_lshlrev_b32 v41, 4, v41
  v_add_u32 v41, s94, v41
  v_and_b32 v40, 7, v1
  v_mul_u32_u24 v40, 272, v40
  v_lshrrev_b32 v3, 4, v1
  v_lshl_add_u32 v40, v3, 4, v40
  v_add_u32 v40, 94208, v40
  s_lshl_b32 s94, s76, 12
  s_lshl_b32 s97, s3, 6
  s_add_u32 s94, s94, s97
  s_add_u32 s94, s94, 0x40000
  v_bfe_u32 v39, v1, 2, 3
  v_lshlrev_b32 v39, 9, v39
  v_and_b32 v3, 3, v1
  v_lshl_add_u32 v39, v3, 4, v39
  v_add_u32 v39, s94, v39
  s_lshl_b32 s95, s77, 9
  s_add_u32 s16, s94, s95
  s_and_b32 s94, s3, 3
  s_mul_i32 s94, s94, 4864
  v_lshrrev_b32 v240, 4, v1
  v_mul_u32_u24 v240, 288, v240
  v_and_b32 v3, 15, v1
  v_lshl_add_u32 v240, v3, 4, v240
  v_add_u32 v240, s94, v240
  s_and_b32 s94, s3, 3
  s_mul_i32 s94, s94, 9728
  s_add_u32 s94, s94, 0x5000
  v_lshrrev_b32 v241, 4, v1
  v_mul_u32_u24 v241, 288, v241
  v_and_b32 v3, 15, v1
  v_lshl_add_u32 v241, v3, 4, v241
  v_add_u32 v241, s94, v241
  s_lshl_b32 s94, s3, 5
  v_lshrrev_b32 v242, 4, v1
  v_mul_u32_u24 v242, 2432, v242
  v_bfe_u32 v3, v1, 2, 2
  v_mul_u32_u24 v3, 288, v3
  v_add_u32 v242, v3, v242
  v_and_b32 v3, 3, v1
  v_lshl_add_u32 v242, v3, 3, v242
  v_add_u32 v242, s94, v242
  v_lshrrev_b32 v243, 4, v1
  v_mul_u32_u24 v243, 2432, v243
  v_bfe_u32 v3, v1, 2, 2
  v_mul_u32_u24 v3, 288, v3
  v_add_u32 v243, v3, v243
  v_and_b32 v3, 3, v1
  v_lshl_add_u32 v243, v3, 3, v243
  v_add_u32 v243, 20480, v243
  v_add_u32 v243, s94, v243
  v_bfe_u32 v43, v1, 2, 3
  v_mul_u32_u24 v43, 272, v43
  v_and_b32 v3, 3, v1
  v_lshl_add_u32 v43, v3, 3, v43
  v_add_u32 v43, 94208, v43
  v_add_u32 v43, s94, v43
  s_cmp_ge_u32 s3, 4
  s_cbranch_scc1 L_back2
  v_and_b32 v44, 31, v1
  v_and_b32 v46, 3, v44
  v_lshlrev_b32 v46, 2, v46
  v_bfe_u32 v47, v44, 2, 2
  v_or_b32 v46, v46, v47
  v_lshrrev_b32 v47, 5, v1
  v_xor_b32 v46, v46, v47
  v_lshlrev_b32 v45, 8, v44
  v_xor_b32 v47, 0, v46
  v_lshl_add_u32 v16, v47, 4, v45
  v_xor_b32 v47, 2, v46
  v_lshl_add_u32 v17, v47, 4, v45
  v_xor_b32 v47, 4, v46
  v_lshl_add_u32 v18, v47, 4, v45
  v_xor_b32 v47, 6, v46
  v_lshl_add_u32 v19, v47, 4, v45
  v_xor_b32 v47, 8, v46
  v_lshl_add_u32 v20, v47, 4, v45
  v_xor_b32 v47, 10, v46
  v_lshl_add_u32 v21, v47, 4, v45
  v_xor_b32 v47, 12, v46
  v_lshl_add_u32 v22, v47, 4, v45
  v_xor_b32 v47, 14, v46
  v_lshl_add_u32 v23, v47, 4, v45
  s_lshl_b32 s92, s17, 13
  s_add_u32 s92, s92, 131072
  v_add_u32 v8, s91, v16
  v_add_u32 v16, s92, v16
  v_add_u32 v9, s91, v17
  v_add_u32 v17, s92, v17
  v_add_u32 v10, s91, v18
  v_add_u32 v18, s92, v18
  v_add_u32 v11, s91, v19
  v_add_u32 v19, s92, v19
  v_add_u32 v12, s91, v20
  v_add_u32 v20, s92, v20
  v_add_u32 v13, s91, v21
  v_add_u32 v21, s92, v21
  v_add_u32 v14, s91, v22
  v_add_u32 v22, s92, v22
  v_add_u32 v15, s91, v23
  v_add_u32 v23, s92, v23
  s_lshl_b32 s92, s3, 2
  v_lshrrev_b32 v47, 5, v1
  v_lshl_add_u32 v30, v47, 4, v29
  v_add_u32 v30, s92, v30
  s_lshl_b32 s92, s3, 11
  v_add_u32 v31, s92, v28
  s_setprio 2
  s_mov_b32 s101, 1
  s_waitcnt vmcnt(4)
  s_barrier
  ds_read_b128 v[112:115], v8
  ds_read_b128 v[116:119], v16
  ds_read_b128 v[120:123], v9
  ds_read_b128 v[124:127], v17
  ds_read_b128 v[128:131], v10
  ds_read_b128 v[132:135], v18
  ds_read_b128 v[136:139], v11
  ds_read_b128 v[140:143], v19
  ds_read_b128 v[144:147], v12
  ds_read_b128 v[148:151], v20
  ds_read_b128 v[152:155], v13
  ds_read_b128 v[156:159], v21
  v_xor_b32 v8, 0x8000, v8
  v_xor_b32 v16, 0x2000, v16
  v_xor_b32 v9, 0x8000, v9
  v_xor_b32 v17, 0x2000, v17
  v_xor_b32 v10, 0x8000, v10
  v_xor_b32 v18, 0x2000, v18
  v_xor_b32 v11, 0x8000, v11
  v_xor_b32 v19, 0x2000, v19
  v_xor_b32 v12, 0x8000, v12
  v_xor_b32 v20, 0x2000, v20
  v_xor_b32 v13, 0x8000, v13
  v_xor_b32 v21, 0x2000, v21
  s_waitcnt lgkmcnt(10)
  v_mfma_f32_32x32x16_bf16 v[96:111], v[112:115], v[116:119], 0
  ds_read_b128 v[160:163], v14
  ds_read_b128 v[164:167], v22
  v_xor_b32 v14, 0x8000, v14
  v_xor_b32 v22, 0x2000, v22
  s_waitcnt lgkmcnt(10)
  v_mfma_f32_32x32x16_bf16 v[96:111], v[120:123], v[124:127], v[96:111]
  ds_read_b128 v[168:171], v15
  ds_read_b128 v[172:175], v23
  v_xor_b32 v15, 0x8000, v15
  v_xor_b32 v23, 0x2000, v23
  s_waitcnt lgkmcnt(10)
  v_mfma_f32_32x32x16_bf16 v[96:111], v[128:131], v[132:135], v[96:111]
  ds_read_b128 v[112:115], v8
  ds_read_b128 v[116:119], v16
  v_xor_b32 v8, 0x18000, v8
  v_xor_b32 v16, 0x6000, v16
  s_waitcnt lgkmcnt(10)
  v_mfma_f32_32x32x16_bf16 v[96:111], v[136:139], v[140:143], v[96:111]
  ds_read_b128 v[120:123], v9
  ds_read_b128 v[124:127], v17
  v_xor_b32 v9, 0x18000, v9
  v_xor_b32 v17, 0x6000, v17
  s_waitcnt lgkmcnt(10)
  v_mfma_f32_32x32x16_bf16 v[96:111], v[144:147], v[148:151], v[96:111]
  ds_read_b128 v[128:131], v10
  ds_read_b128 v[132:135], v18
  v_xor_b32 v10, 0x18000, v10
  v_xor_b32 v18, 0x6000, v18
  s_waitcnt lgkmcnt(10)
  v_mfma_f32_32x32x16_bf16 v[96:111], v[152:155], v[156:159], v[96:111]
  ds_read_b128 v[136:139], v11
  ds_read_b128 v[140:143], v19
  v_xor_b32 v11, 0x18000, v11
  v_xor_b32 v19, 0x6000, v19
  s_waitcnt lgkmcnt(10)
  v_mfma_f32_32x32x16_bf16 v[96:111], v[160:163], v[164:167], v[96:111]
  ds_read_b128 v[144:147], v12
  ds_read_b128 v[148:151], v20
  v_xor_b32 v12, 0x18000, v12
  v_xor_b32 v20, 0x6000, v20
  s_waitcnt lgkmcnt(10)
  v_mfma_f32_32x32x16_bf16 v[96:111], v[168:171], v[172:175], v[96:111]
  ds_read_b128 v[152:155], v13
  ds_read_b128 v[156:159], v21
  v_xor_b32 v13, 0x18000, v13
  v_xor_b32 v21, 0x6000, v21
  s_waitcnt lgkmcnt(10)
  v_mfma_f32_32x32x16_bf16 v[96:111], v[112:115], v[116:119], v[96:111]
  ds_read_b128 v[160:163], v14
  ds_read_b128 v[164:167], v22
  v_xor_b32 v14, 0x18000, v14
  v_xor_b32 v22, 0x6000, v22
  s_waitcnt lgkmcnt(10)
  v_mfma_f32_32x32x16_bf16 v[96:111], v[120:123], v[124:127], v[96:111]
  ds_read_b128 v[168:171], v15
  ds_read_b128 v[172:175], v23
  v_xor_b32 v15, 0x18000, v15
  v_xor_b32 v23, 0x6000, v23
  s_waitcnt lgkmcnt(10)
  v_mfma_f32_32x32x16_bf16 v[96:111], v[128:131], v[132:135], v[96:111]
  ds_read_b128 v[112:115], v8
  ds_read_b128 v[116:119], v16
  v_xor_b32 v8, 0x8000, v8
  v_xor_b32 v16, 0x2000, v16
  s_waitcnt lgkmcnt(10)
  v_mfma_f32_32x32x16_bf16 v[96:111], v[136:139], v[140:143], v[96:111]
  ds_read_b128 v[120:123], v9
  ds_read_b128 v[124:127], v17
  v_xor_b32 v9, 0x8000, v9
  v_xor_b32 v17, 0x2000, v17
  s_waitcnt lgkmcnt(10)
  v_mfma_f32_32x32x16_bf16 v[96:111], v[144:147], v[148:151], v[96:111]
  ds_read_b128 v[128:131], v10
  ds_read_b128 v[132:135], v18
  v_xor_b32 v10, 0x8000, v10
  v_xor_b32 v18, 0x2000, v18
  s_waitcnt lgkmcnt(10)
  v_mfma_f32_32x32x16_bf16 v[96:111], v[152:155], v[156:159], v[96:111]
  ds_read_b128 v[136:139], v11
  ds_read_b128 v[140:143], v19
  v_xor_b32 v11, 0x8000, v11
  v_xor_b32 v19, 0x2000, v19
  s_waitcnt lgkmcnt(10)
  v_mfma_f32_32x32x16_bf16 v[96:111], v[160:163], v[164:167], v[96:111]
  ds_read_b128 v[144:147], v12
  ds_read_b128 v[148:151], v20
  v_xor_b32 v12, 0x8000, v12
  v_xor_b32 v20, 0x2000, v20
  s_waitcnt lgkmcnt(10)
  v_mfma_f32_32x32x16_bf16 v[96:111], v[168:171], v[172:175], v[96:111]
  ds_read_b128 v[152:155], v13
  ds_read_b128 v[156:159], v21
  v_xor_b32 v13, 0x8000, v13
  v_xor_b32 v21, 0x2000, v21
  s_barrier
  s_waitcnt lgkmcnt(10)
  v_mfma_f32_32x32x16_bf16 v[96:111], v[112:115], v[116:119], v[96:111]
  ds_read_b128 v[160:163], v14
  ds_read_b128 v[164:167], v22
  v_xor_b32 v14, 0x8000, v14
  v_xor_b32 v22, 0x2000, v22
  s_waitcnt lgkmcnt(10)
  v_mfma_f32_32x32x16_bf16 v[96:111], v[120:123], v[124:127], v[96:111]
  ds_read_b128 v[168:171], v15
  ds_read_b128 v[172:175], v23
  v_xor_b32 v15, 0x8000, v15
  v_xor_b32 v23, 0x2000, v23
  s_waitcnt lgkmcnt(10)
  v_mfma_f32_32x32x16_bf16 v[96:111], v[128:131], v[132:135], v[96:111]
  s_waitcnt vmcnt(0)
  s_barrier
  ds_read_b128 v[112:115], v8
  ds_read_b128 v[116:119], v16
  s_waitcnt lgkmcnt(10)
  v_mfma_f32_32x32x16_bf16 v[96:111], v[136:139], v[140:143], v[96:111]
  ds_read_b128 v[120:123], v9
  ds_read_b128 v[124:127], v17
  s_waitcnt lgkmcnt(10)
  v_mfma_f32_32x32x16_bf16 v[96:111], v[144:147], v[148:151], v[96:111]
  ds_read_b128 v[128:131], v10
  ds_read_b128 v[132:135], v18
  s_waitcnt lgkmcnt(10)
  v_mfma_f32_32x32x16_bf16 v[96:111], v[152:155], v[156:159], v[96:111]
  ds_read_b128 v[136:139], v11
  ds_read_b128 v[140:143], v19
  s_waitcnt lgkmcnt(10)
  v_mfma_f32_32x32x16_bf16 v[96:111], v[160:163], v[164:167], v[96:111]
  ds_read_b128 v[144:147], v12
  ds_read_b128 v[148:151], v20
  s_waitcnt lgkmcnt(10)
  v_mfma_f32_32x32x16_bf16 v[96:111], v[168:171], v[172:175], v[96:111]
  ds_read_b128 v[152:155], v13
  ds_read_b128 v[156:159], v21
  s_waitcnt lgkmcnt(10)
  v_mfma_f32_32x32x16_bf16 v[96:111], v[112:115], v[116:119], v[96:111]
  ds_read_b128 v[160:163], v14
  ds_read_b128 v[164:167], v22
  s_waitcnt lgkmcnt(10)
  v_mfma_f32_32x32x16_bf16 v[96:111], v[120:123], v[124:127], v[96:111]
  ds_read_b128 v[168:171], v15
  ds_read_b128 v[172:175], v23
  s_waitcnt lgkmcnt(10)
  v_mfma_f32_32x32x16_bf16 v[96:111], v[128:131], v[132:135], v[96:111]
  s_waitcnt lgkmcnt(8)
  v_mfma_f32_32x32x16_bf16 v[96:111], v[136:139], v[140:143], v[96:111]
  s_waitcnt lgkmcnt(6)
  v_mfma_f32_32x32x16_bf16 v[96:111], v[144:147], v[148:151], v[96:111]
  s_waitcnt lgkmcnt(4)
  v_mfma_f32_32x32x16_bf16 v[96:111], v[152:155], v[156:159], v[96:111]
  s_waitcnt lgkmcnt(2)
  v_mfma_f32_32x32x16_bf16 v[96:111], v[160:163], v[164:167], v[96:111]
  s_waitcnt lgkmcnt(0)
  v_mfma_f32_32x32x16_bf16 v[96:111], v[168:171], v[172:175], v[96:111]
  s_nop 11
  v_max3_f32 v44, v96, v97, v98
  v_max3_f32 v45, v99, v100, v101
  v_max3_f32 v46, v102, v103, v104
  v_max3_f32 v47, v105, v106, v107
  v_max3_f32 v44, v44, v108, v109
  v_max3_f32 v45, v45, v110, v111
  v_max3_f32 v44, v44, v46, v47
  v_max_f32 v44, v44, v45
  ds_write_b32 v30, v44
  v_sub_f32 v96, v96, v44
  v_sub_f32 v97, v97, v44
  v_sub_f32 v98, v98, v44
  v_sub_f32 v99, v99, v44
  v_sub_f32 v100, v100, v44
  v_sub_f32 v101, v101, v44
  v_sub_f32 v102, v102, v44
  v_sub_f32 v103, v103, v44
  s_waitcnt lgkmcnt(0)
  s_barrier
  ds_read_b128 v[48:51], v29
  ds_read_b128 v[52:55], v29 offset:16
  v_exp_f32 v96, v96
  v_sub_f32 v104, v104, v44
  v_exp_f32 v97, v97
  v_sub_f32 v105, v105, v44
  v_exp_f32 v98, v98
  v_sub_f32 v106, v106, v44
  v_exp_f32 v99, v99
  v_sub_f32 v107, v107, v44
  v_exp_f32 v100, v100
  v_sub_f32 v108, v108, v44
  v_exp_f32 v101, v101
  v_sub_f32 v109, v109, v44
  v_exp_f32 v102, v102
  v_sub_f32 v110, v110, v44
  v_exp_f32 v103, v103
  v_sub_f32 v111, v111, v44
  s_waitcnt lgkmcnt(0)
  v_max3_f32 v45, v48, v49, v50
  v_max3_f32 v46, v51, v52, v53
  v_exp_f32 v104, v104
  v_max3_f32 v45, v45, v54, v55
  v_exp_f32 v105, v105
  v_max_f32 v45, v45, v46
  v_exp_f32 v106, v106
  v_sub_f32 v45, v44, v45
  v_exp_f32 v107, v107
  v_exp_f32 v45, v45
  v_exp_f32 v108, v108
  v_exp_f32 v109, v109
  v_exp_f32 v110, v110
  v_exp_f32 v111, v111
  v_mul_f32 v96, v96, v45
  v_mul_f32 v97, v97, v45
  v_mul_f32 v98, v98, v45
  v_mul_f32 v99, v99, v45
  v_mul_f32 v100, v100, v45
  v_mul_f32 v101, v101, v45
  v_mul_f32 v102, v102, v45
  v_mul_f32 v103, v103, v45
  v_cvt_pk_bf16_f32 v48, v96, v97
  v_cvt_pk_bf16_f32 v49, v98, v99
  v_cvt_pk_bf16_f32 v50, v100, v101
  v_cvt_pk_bf16_f32 v51, v102, v103
  ds_write_b128 v31, v[48:51] offset:0
  v_mul_f32 v104, v104, v45
  v_mul_f32 v105, v105, v45
  v_mul_f32 v106, v106, v45
  v_mul_f32 v107, v107, v45
  v_mul_f32 v108, v108, v45
  v_mul_f32 v109, v109, v45
  v_mul_f32 v110, v110, v45
  v_mul_f32 v111, v111, v45
  v_cvt_pk_bf16_f32 v52, v104, v105
  v_cvt_pk_bf16_f32 v53, v106, v107
  v_cvt_pk_bf16_f32 v54, v108, v109
  v_cvt_pk_bf16_f32 v55, v110, v111
  ds_write_b128 v31, v[52:55] offset:1024
  v_add_f32 v96, v96, v97
  v_add_f32 v98, v98, v99
  v_add_f32 v100, v100, v101
  v_add_f32 v102, v102, v103
  v_add_f32 v104, v104, v105
  v_add_f32 v106, v106, v107
  v_add_f32 v108, v108, v109
  v_add_f32 v110, v110, v111
  v_add_f32 v96, v96, v98
  v_add_f32 v100, v100, v102
  v_add_f32 v104, v104, v106
  v_add_f32 v108, v108, v110
  v_add_f32 v96, v96, v100
  v_add_f32 v104, v104, v108
  v_add_f32 v96, v96, v104
  ds_write_b32 v30, v96 offset:9216
  s_waitcnt lgkmcnt(0)
  s_barrier
L_pv:
  s_setprio 2
  ds_read_b128 v[48:51], v28 offset:0
  ds_read_b64_tr_b16 v[112:113], v24 offset:0
  ds_read_b64_tr_b16 v[114:115], v25 offset:0
  ds_read_b128 v[52:55], v28 offset:1024
  ds_read_b64_tr_b16 v[116:117], v24 offset:4096
  ds_read_b64_tr_b16 v[118:119], v25 offset:4096
  ds_read_b128 v[56:59], v28 offset:2048
  ds_read_b64_tr_b16 v[120:121], v24 offset:8192
  ds_read_b64_tr_b16 v[122:123], v25 offset:8192
  ds_read_b128 v[60:63], v28 offset:3072
  ds_read_b64_tr_b16 v[124:125], v24 offset:12288
  ds_read_b64_tr_b16 v[126:127], v25 offset:12288
  s_lshl_b32 s74, s2, 9
  s_add_u32 s74, s74, 0x20000
  s_mov_b32 s70, 0x10000
  s_mov_b32 s71, 0x18000
  s_mov_b32 s72, 0x8000
  s_cmp_lg_u32 s3, 7
  s_cbranch_scc1 L_nolse
  ds_read_b128 v[144:147], v29
  ds_read_b128 v[148:151], v29 offset:16
  s_waitcnt lgkmcnt(6)
  ds_read_b128 v[152:155], v29 offset:9216
  ds_read_b128 v[156:159], v29 offset:9232
  s_andn2_b32 s92, s48, 1
  v_mov_b32 v23, s92
  s_waitcnt lgkmcnt(2)
  v_max3_f32 v20, v144, v145, v146
  v_max3_f32 v21, v147, v148, v149
  v_max3_f32 v20, v20, v150, v151
  v_max_f32 v20, v20, v21
  s_waitcnt lgkmcnt(0)
  v_add_f32 v152, v152, v153
  v_add_f32 v154, v154, v155
  v_add_f32 v156, v156, v157
  v_add_f32 v158, v158, v159
  v_add_f32 v152, v152, v154
  v_add_f32 v156, v156, v158
  v_add_f32 v152, v152, v156
  v_mov_b32 v21, v152
  s_mov_b32 exec_hi, 0
  buffer_store_dwordx4 v[20:23], v248, s[32:35], s74 offen sc1
  s_mov_b32 exec_hi, -1
L_nolse:
  s_waitcnt lgkmcnt(9)
  v_mfma_f32_32x32x16_bf16 v[144:159], v[112:115], v[48:51], 0
  ds_read_b128 v[64:67], v28 offset:4096
  ds_read_b64_tr_b16 v[128:129], v24 offset:16384
  ds_read_b64_tr_b16 v[130:131], v25 offset:16384
  s_waitcnt lgkmcnt(9)
  v_mfma_f32_32x32x16_bf16 v[144:159], v[116:119], v[52:55], v[144:159]
  ds_read_b128 v[68:71], v28 offset:5120
  ds_read_b64_tr_b16 v[132:133], v24 offset:20480
  ds_read_b64_tr_b16 v[134:135], v25 offset:20480
  v_lshrrev_b32 v44, 5, v1
  v_lshlrev_b32 v44, 3, v44
  v_lshrrev_b32 v96, v44, v249
  v_lshrrev_b32 v104, v44, v250
  s_waitcnt lgkmcnt(9)
  v_mfma_f32_32x32x16_bf16 v[144:159], v[120:123], v[56:59], v[144:159]
  ds_read_b128 v[72:75], v28 offset:6144
  ds_read_b64_tr_b16 v[136:137], v24 offset:24576
  ds_read_b64_tr_b16 v[138:139], v25 offset:24576
  v_lshrrev_b32 v97, 1, v96
  v_lshrrev_b32 v98, 2, v96
  v_lshrrev_b32 v99, 3, v96
  s_waitcnt lgkmcnt(9)
  v_mfma_f32_32x32x16_bf16 v[144:159], v[124:127], v[60:63], v[144:159]
  ds_read_b128 v[76:79], v28 offset:7168
  ds_read_b64_tr_b16 v[140:141], v24 offset:28672
  ds_read_b64_tr_b16 v[142:143], v25 offset:28672
  v_lshrrev_b32 v100, 4, v96
  v_lshrrev_b32 v101, 5, v96
  v_lshrrev_b32 v102, 6, v96
  v_lshrrev_b32 v103, 7, v96
  s_waitcnt lgkmcnt(9)
  v_mfma_f32_32x32x16_bf16 v[144:159], v[128:131], v[64:67], v[144:159]
  ds_read_b64_tr_b16 v[112:113], v26 offset:0
  ds_read_b64_tr_b16 v[114:115], v27 offset:0
  v_lshrrev_b32 v105, 1, v104
  v_lshrrev_b32 v106, 2, v104
  v_lshrrev_b32 v107, 3, v104
  s_waitcnt lgkmcnt(8)
  v_mfma_f32_32x32x16_bf16 v[144:159], v[132:135], v[68:71], v[144:159]
  ds_read_b64_tr_b16 v[116:117], v26 offset:4096
  ds_read_b64_tr_b16 v[118:119], v27 offset:4096
  v_lshrrev_b32 v108, 4, v104
  v_lshrrev_b32 v109, 5, v104
  v_lshrrev_b32 v110, 6, v104
  v_lshrrev_b32 v111, 7, v104
  s_waitcnt lgkmcnt(7)
  v_mfma_f32_32x32x16_bf16 v[144:159], v[136:139], v[72:75], v[144:159]
  ds_read_b64_tr_b16 v[120:121], v26 offset:8192
  ds_read_b64_tr_b16 v[122:123], v27 offset:8192
  s_waitcnt lgkmcnt(6)
  v_mfma_f32_32x32x16_bf16 v[144:159], v[140:143], v[76:79], v[144:159]
  ds_read_b64_tr_b16 v[124:125], v26 offset:12288
  ds_read_b64_tr_b16 v[126:127], v27 offset:12288
  s_waitcnt lgkmcnt(6)
  v_mfma_f32_32x32x16_bf16 v[160:175], v[112:115], v[48:51], 0
  ds_read_b64_tr_b16 v[128:129], v26 offset:16384
  ds_read_b64_tr_b16 v[130:131], v27 offset:16384
  s_waitcnt lgkmcnt(6)
  v_mfma_f32_32x32x16_bf16 v[160:175], v[116:119], v[52:55], v[160:175]
  ds_read_b64_tr_b16 v[132:133], v26 offset:20480
  ds_read_b64_tr_b16 v[134:135], v27 offset:20480
  s_waitcnt lgkmcnt(6)
  v_mfma_f32_32x32x16_bf16 v[160:175], v[120:123], v[56:59], v[160:175]
  ds_read_b64_tr_b16 v[136:137], v26 offset:24576
  ds_read_b64_tr_b16 v[138:139], v27 offset:24576
  v_cvt_pk_bf16_f32 v80, v144, v145
  v_cvt_pk_bf16_f32 v81, v146, v147
  v_cvt_pk_bf16_f32 v82, v148, v149
  v_cvt_pk_bf16_f32 v83, v150, v151
  v_bfi_b32 v80, s53, v96, v80
  v_bfi_b32 v81, s53, v97, v81
  v_bfi_b32 v82, s53, v98, v82
  v_bfi_b32 v83, s53, v99, v83
  ds_write_b128 v244, v[80:83]
  s_waitcnt lgkmcnt(7)
  v_mfma_f32_32x32x16_bf16 v[160:175], v[124:127], v[60:63], v[160:175]
  ds_read_b64_tr_b16 v[140:141], v26 offset:28672
  ds_read_b64_tr_b16 v[142:143], v27 offset:28672
  v_cvt_pk_bf16_f32 v84, v152, v153
  v_cvt_pk_bf16_f32 v85, v154, v155
  v_cvt_pk_bf16_f32 v86, v156, v157
  v_cvt_pk_bf16_f32 v87, v158, v159
  v_bfi_b32 v84, s53, v100, v84
  v_bfi_b32 v85, s53, v101, v85
  v_bfi_b32 v86, s53, v102, v86
  v_bfi_b32 v87, s53, v103, v87
  ds_write_b128 v245, v[84:87]
  s_waitcnt lgkmcnt(8)
  v_mfma_f32_32x32x16_bf16 v[160:175], v[128:131], v[64:67], v[160:175]
  s_waitcnt lgkmcnt(6)
  v_mfma_f32_32x32x16_bf16 v[160:175], v[132:135], v[68:71], v[160:175]
  s_waitcnt lgkmcnt(4)
  v_mfma_f32_32x32x16_bf16 v[160:175], v[136:139], v[72:75], v[160:175]
  s_waitcnt lgkmcnt(1)
  v_mfma_f32_32x32x16_bf16 v[160:175], v[140:143], v[76:79], v[160:175]
  s_setprio 2
  s_nop 10
  v_cvt_pk_bf16_f32 v88, v160, v161
  v_cvt_pk_bf16_f32 v89, v162, v163
  v_cvt_pk_bf16_f32 v90, v164, v165
  v_cvt_pk_bf16_f32 v91, v166, v167
  v_bfi_b32 v88, s53, v104, v88
  v_bfi_b32 v89, s53, v105, v89
  v_bfi_b32 v90, s53, v106, v90
  v_bfi_b32 v91, s53, v107, v91
  ds_write_b128 v246, v[88:91]
  v_cvt_pk_bf16_f32 v92, v168, v169
  v_cvt_pk_bf16_f32 v93, v170, v171
  v_cvt_pk_bf16_f32 v94, v172, v173
  v_cvt_pk_bf16_f32 v95, v174, v175
  v_bfi_b32 v92, s53, v108, v92
  v_bfi_b32 v93, s53, v109, v93
  v_bfi_b32 v94, s53, v110, v94
  v_bfi_b32 v95, s53, v111, v95
  ds_write_b128 v247, v[92:95]
  ds_read_b128 v[112:115], v32 offset:0
  ds_read_b128 v[116:119], v32 offset:2048
  ds_read_b128 v[120:123], v32 offset:4096
  ds_read_b128 v[124:127], v32 offset:6144
  s_waitcnt lgkmcnt(3)
  buffer_store_dwordx4 v[112:115], v34, s[32:35], s87 offen offset:0 sc1
  s_waitcnt lgkmcnt(2)
  buffer_store_dwordx4 v[116:119], v34, s[32:35], s87 offen offset:1024 sc1
  s_waitcnt lgkmcnt(1)
  buffer_store_dwordx4 v[120:123], v34, s[32:35], s87 offen offset:2048 sc1
  s_waitcnt lgkmcnt(0)
  buffer_store_dwordx4 v[124:127], v34, s[32:35], s87 offen offset:3072 sc1
  s_setprio 0
  s_barrier
  s_cmp_lg_u32 s3, 7
  s_cbranch_scc1 L_nolse2
  v_or_b32 v23, 1, v23
  s_mov_b32 exec_hi, 0
  buffer_store_dwordx4 v[20:23], v248, s[32:35], s74 offen sc1
  s_mov_b32 exec_hi, -1
L_nolse2:
  s_mov_b32 s73, 0
  s_or_b32 s69, s48, 1
  buffer_load_dwordx4 v[8:11], v35, s[32:35], s70 offen offset:0 sc1
  buffer_load_dwordx4 v[12:15], v35, s[32:35], s71 offen offset:0 sc1
  buffer_load_dwordx4 v[16:19], v35, s[32:35], 0 offen offset:0 sc1
  buffer_load_dwordx4 v[20:23], v35, s[32:35], s72 offen offset:0 sc1
  s_cmp_lt_u32 s2, 128
  s_cbranch_scc1 L_prepA
  s_and_b32 s92, s3, 3
  s_mul_i32 s92, s92, 7552
  s_add_u32 s92, s92, 0x5000
  v_lshrrev_b32 v62, 5, v1
  v_mul_u32_u24 v62, 928, v62
  v_and_b32 v3, 31, v1
  v_lshl_add_u32 v62, v3, 4, v62
  v_add_u32 v62, s92, v62
  s_lshl_b32 s92, s3, 6
  v_lshrrev_b32 v63, 4, v1
  v_mul_u32_u24 v63, 7552, v63
  v_bfe_u32 v3, v1, 2, 2
  v_mul_u32_u24 v3, 928, v3
  v_add_u32 v63, v3, v63
  v_and_b32 v3, 3, v1
  v_lshl_add_u32 v63, v3, 3, v63
  v_add_u32 v63, 20480, v63
  v_add_u32 v63, s92, v63
  s_mul_i32 s82, s80, 28672
  s_lshl_b32 s97, s3, 12
  s_add_u32 s82, s82, s97
  s_lshl_b32 s97, s79, 8
  s_add_u32 s82, s82, s97
  s_lshr_b32 s92, s79, 1
  s_lshl_b32 s92, s92, 10
  s_and_b32 s97, s79, 1
  s_lshl_b32 s97, s97, 7
  s_add_u32 s92, s92, s97
  s_add_u32 s92, s92, 0x4000
  v_bfe_u32 v56, v1, 3, 1
  v_lshlrev_b32 v56, 13, v56
  v_lshrrev_b32 v3, 4, v1
  v_lshl_add_u32 v56, v3, 8, v56
  v_and_b32 v3, 7, v1
  v_lshl_add_u32 v56, v3, 4, v56
  v_add_u32 v56, s92, v56
  v_and_b32 v60, 31, v1
  v_lshlrev_b32 v60, 5, v60
  v_add_u32 v60, 90112, v60
  s_lshl_b32 s92, s3, 2
  s_add_u32 s92, s92, 0x16000
  v_and_b32 v59, 7, v1
  v_lshlrev_b32 v59, 7, v59
  v_lshrrev_b32 v3, 4, v1
  v_lshl_add_u32 v59, v3, 5, v59
  v_add_u32 v59, s92, v59
  s_lshl_b32 s92, s3, 7
  s_add_u32 s92, s92, 0x16c00
  v_and_b32 v57, 31, v1
  v_lshlrev_b32 v57, 1, v57
  v_add_u32 v57, s92, v57
  s_mul_i32 s90, s79, 4224
  s_lshl_b32 s97, s3, 9
  s_add_u32 s90, s90, s97
  s_add_u32 s90, s90, 0x60000
  v_and_b32 v61, 31, v1
  v_lshlrev_b32 v61, 4, v61
  v_and_b32 v58, 3, v1
  v_lshlrev_b32 v58, 6, v58
  v_lshrrev_b32 v3, 4, v1
  v_lshl_add_u32 v58, v3, 4, v58
  s_nop 0
  s_branch L_prep2
L_prepA:
  s_sub_u32 s92, s79, 7
  s_cmp_ge_u32 s79, 7
  s_cselect_b32 s92, s92, s79
  s_cselect_b32 s93, 1, 0
  s_mul_i32 s81, s80, 7
  s_add_u32 s81, s81, s92
  s_lshl_b32 s91, s81, 15
  s_lshl_b32 s97, s3, 12
  s_add_u32 s91, s91, s97
  s_lshl_b32 s97, s93, 9
  s_add_u32 s91, s91, s97
  s_mul_i32 s75, s77, 16896
  s_lshr_b32 s97, s3, 1
  s_mul_i32 s97, s97, 4224
  s_add_u32 s75, s75, s97
  s_lshl_b32 s97, s76, 7
  s_add_u32 s75, s75, s97
  s_and_b32 s97, s3, 1
  s_lshl_b32 s97, s97, 6
  s_add_u32 s75, s75, s97
  s_add_u32 s75, s75, 0x60000
  s_mul_i32 s90, s93, 67584
  s_mul_i32 s97, s3, 8448
  s_add_u32 s90, s90, s97
  s_lshl_b32 s97, s81, 7
  s_add_u32 s90, s90, s97
  s_add_u32 s90, s90, 0xa0000
  s_mul_i32 s92, s3, 2176
  s_lshr_b32 s97, s3, 1
  s_lshl_b32 s97, s97, 7
  s_add_u32 s92, s92, s97
  s_add_u32 s92, s92, 0xe800
  v_lshrrev_b32 v62, 5, v1
  v_mul_u32_u24 v62, 544, v62
  v_and_b32 v3, 31, v1
  v_lshl_add_u32 v62, v3, 4, v62
  v_add_u32 v62, s92, v62
  s_lshl_b32 s92, s3, 6
  v_lshrrev_b32 v63, 4, v1
  v_mul_u32_u24 v63, 4480, v63
  v_bfe_u32 v3, v1, 2, 2
  v_mul_u32_u24 v3, 544, v3
  v_add_u32 v63, v3, v63
  v_and_b32 v3, 3, v1
  v_lshl_add_u32 v63, v3, 3, v63
  v_add_u32 v63, 59392, v63
  v_add_u32 v63, s92, v63
  s_lshl_b32 s82, s81, 12
  s_lshl_b32 s97, s3, 9
  s_add_u32 s82, s82, s97
  s_add_u32 s82, s82, 0xd0000
  s_lshl_b32 s92, s3, 7
  s_add_u32 s92, s92, 0x16c00
  v_and_b32 v57, 7, v1
  v_lshlrev_b32 v57, 3, v57
  v_lshrrev_b32 v3, 4, v1
  v_lshl_add_u32 v57, v3, 1, v57
  v_add_u32 v57, s92, v57
  v_and_b32 v61, 31, v1
  v_lshlrev_b32 v61, 4, v61
  v_and_b32 v58, 1, v1
  v_lshlrev_b32 v58, 6, v58
  v_lshrrev_b32 v3, 4, v1
  v_lshl_add_u32 v58, v3, 4, v58
  s_lshl_b32 s92, s80, 11
  v_and_b32 v56, 15, v1
  v_lshlrev_b32 v56, 7, v56
  v_add_u32 v56, 98304, v56
  v_add_u32 v56, s92, v56
  s_lshl_b32 s92, s3, 2
  s_add_u32 s92, s92, 0x14800
  v_lshlrev_b32 v59, 5, v1
  v_add_u32 v59, s92, v59
  s_bfe_u32 s92, s3, 0x10002
  s_lshl_b32 s92, s92, 10
  s_and_b32 s97, s3, 3
  s_lshl_b32 s97, s97, 2
  s_add_u32 s92, s92, s97
  s_add_u32 s92, s92, 0x15800
  v_lshlrev_b32 v60, 4, v1
  v_add_u32 v60, s92, v60
L_prep2:
  s_cmp_eq_u32 s101, 1
  s_cbranch_scc1 L_nsg
  s_cmp_eq_u32 s101, 2
  s_cbranch_scc1 L_nsg
  s_waitcnt vmcnt(8)
  ds_write_b128 v240, v[176:179] offset:0
  ds_write_b128 v240, v[180:183] offset:1152
  ds_write_b128 v240, v[184:187] offset:2432
  ds_write_b128 v240, v[188:191] offset:3584
  s_cmp_lt_u32 s2, 128
  s_cbranch_scc1 L_sf_36a
  s_mov_b32 exec_lo, 0xfffffff
  s_mov_b32 exec_hi, 0xfffffff
  ds_write_b128 v62, v[208:211] offset:0
  ds_write_b128 v62, v[212:215] offset:448
  ds_write_b128 v62, v[216:219] offset:1856
  ds_write_b128 v62, v[220:223] offset:2304
  ds_write_b128 v62, v[224:227] offset:3712
  ds_write_b128 v62, v[228:231] offset:4160
  ds_write_b128 v62, v[232:235] offset:5568
  ds_write_b128 v62, v[236:239] offset:6016
  s_mov_b64 exec, -1
  s_branch L_sf_36x
L_sf_36a:
  ds_write_b128 v241, v[208:211] offset:0
  ds_write_b128 v241, v[212:215] offset:1152
  ds_write_b128 v241, v[216:219] offset:2432
  ds_write_b128 v241, v[220:223] offset:3584
  ds_write_b128 v241, v[224:227] offset:4864
  ds_write_b128 v241, v[228:231] offset:6016
  ds_write_b128 v241, v[232:235] offset:7296
  ds_write_b128 v241, v[236:239] offset:8448
L_sf_36x:
L_nsg:
  s_waitcnt vmcnt(0)
  s_mov_b32 s100, 0
L_p1:
  v_cmp_ne_u32 s[60:61], s69, v11
  v_cmp_ne_u32 s[62:63], s69, v15
  v_cmp_ne_u32 s[64:65], s69, v19
  v_cmp_ne_u32 s[66:67], s69, v23
  v_xor_b32 v44, s69, v11
  v_bitop3_b32 v44, v15, s69, v44 bitop3:0xbe
  v_bitop3_b32 v44, v19, s69, v44 bitop3:0xbe
  v_bitop3_b32 v44, v23, s69, v44 bitop3:0xbe
  v_cmp_lt_u32 s[92:93], 1, v44
  s_mov_b32 s94, 0
  s_cmp_eq_u64 s[92:93], 0
  s_cbranch_scc1 L_p1d
  s_add_u32 s100, s100, 1
  s_cmp_gt_u32 s100, 100000
  s_cbranch_scc1 L_abort
  s_mov_b64 exec, s[60:61]
  s_cbranch_execz L_ll_37
  buffer_load_dwordx4 v[8:11], v35, s[32:35], s70 offen offset:0 sc1
L_ll_37:
  s_mov_b64 exec, s[62:63]
  s_cbranch_execz L_ll_38
  buffer_load_dwordx4 v[12:15], v35, s[32:35], s71 offen offset:0 sc1
L_ll_38:
  s_mov_b64 exec, s[64:65]
  s_cbranch_execz L_ll_39
  buffer_load_dwordx4 v[16:19], v35, s[32:35], 0 offen offset:0 sc1
L_ll_39:
  s_mov_b64 exec, s[66:67]
  s_cbranch_execz L_ll_40
  buffer_load_dwordx4 v[20:23], v35, s[32:35], s72 offen offset:0 sc1
L_ll_40:
  s_mov_b64 exec, -1
L_p1d:
  s_bitcmp1_b32 s73, 0
  s_cbranch_scc1 L_lp_41
  s_cmp_lg_u64 s[60:61], 0
  s_cbranch_scc1 L_lp_41
  s_bitset1_b32 s73, 0
  s_add_u32 s94, s94, 1
  buffer_load_dwordx4 v[128:131], v36, s[32:35], s83 offen offset:0 sc1
L_lp_41:
  s_bitcmp1_b32 s73, 1
  s_cbranch_scc1 L_lp_42
  s_cmp_lg_u64 s[62:63], 0
  s_cbranch_scc1 L_lp_42
  s_bitset1_b32 s73, 1
  s_add_u32 s94, s94, 1
  buffer_load_dwordx4 v[132:135], v36, s[32:35], s84 offen offset:0 sc1
L_lp_42:
  s_bitcmp1_b32 s73, 2
  s_cbranch_scc1 L_lp_43
  s_cmp_lg_u64 s[64:65], 0
  s_cbranch_scc1 L_lp_43
  s_bitset1_b32 s73, 2
  s_add_u32 s94, s94, 1
  buffer_load_dwordx4 v[136:139], v36, s[32:35], s85 offen offset:0 sc1
L_lp_43:
  s_bitcmp1_b32 s73, 3
  s_cbranch_scc1 L_lp_44
  s_cmp_lg_u64 s[66:67], 0
  s_cbranch_scc1 L_lp_44
  s_bitset1_b32 s73, 3
  s_add_u32 s94, s94, 1
  buffer_load_dwordx4 v[140:143], v36, s[32:35], s86 offen offset:0 sc1
L_lp_44:
  s_cmp_eq_u64 s[92:93], 0
  s_cbranch_scc1 L_p1x
  s_cmp_eq_u32 s94, 0
  s_cbranch_scc0 L_pw0
  s_waitcnt vmcnt(0)
  s_branch L_p1
L_pw0:
  s_cmp_eq_u32 s94, 1
  s_cbranch_scc0 L_pw1
  s_waitcnt vmcnt(1)
  s_branch L_p1
L_pw1:
  s_cmp_eq_u32 s94, 2
  s_cbranch_scc0 L_pw2
  s_waitcnt vmcnt(2)
  s_branch L_p1
L_pw2:
  s_cmp_eq_u32 s94, 3
  s_cbranch_scc0 L_pw3
  s_waitcnt vmcnt(3)
  s_branch L_p1
L_pw3:
  s_waitcnt vmcnt(4)
  s_branch L_p1
L_p1x:
  v_max3_f32 v44, v8, v12, v16
  v_max_f32 v44, v44, v20
  s_nop 1
  v_max_f32_dpp v44, v44, v44 row_ror:8 row_mask:0xf bank_mask:0xf
  v_mov_b32 v45, v44
  s_nop 1
  v_permlane16_swap_b32 v44, v45
  v_max_f32 v44, v44, v45
  v_mov_b32 v45, v44
  s_nop 1
  v_permlane32_swap_b32 v44, v45
  v_max_f32 v44, v44, v45
  s_lshl_b32 s92, s3, 2
  s_add_u32 s92, s92, 92160
  v_mov_b32 v47, s92
  v_mov_b32 v46, 92160
  ds_write_b32 v47, v44
  s_waitcnt lgkmcnt(0)
  s_barrier
  ds_read_b128 v[144:147], v46
  ds_read_b128 v[148:151], v46 offset:16
  ds_read_b64_tr_b16 v[48:49], v242 offset:0
  ds_read_b64_tr_b16 v[50:51], v242 offset:1152
  ds_read_b64_tr_b16 v[52:53], v242 offset:9728
  ds_read_b64_tr_b16 v[54:55], v242 offset:10880
  s_waitcnt lgkmcnt(4)
  v_max3_f32 v44, v144, v145, v146
  v_max3_f32 v45, v147, v148, v149
  v_max3_f32 v44, v44, v150, v151
  v_max_f32 v44, v44, v45
  v_sub_f32 v152, v8, v44
  v_sub_f32 v153, v12, v44
  v_sub_f32 v154, v16, v44
  v_sub_f32 v155, v20, v44
  v_exp_f32 v152, v152
  v_exp_f32 v153, v153
  v_exp_f32 v154, v154
  v_exp_f32 v155, v155
  v_cvt_pk_bf16_f32 v152, v152, v152
  v_cvt_pk_bf16_f32 v153, v153, v153
  v_cvt_pk_bf16_f32 v154, v154, v154
  v_cvt_pk_bf16_f32 v155, v155, v155
  v_lshrrev_b32 v156, 16, v152
  v_lshrrev_b32 v157, 16, v153
  v_lshrrev_b32 v158, 16, v154
  v_lshrrev_b32 v159, 16, v155
  v_and_b32 v152, 0xffff0000, v152
  v_and_b32 v153, 0xffff0000, v153
  v_and_b32 v154, 0xffff0000, v154
  v_and_b32 v155, 0xffff0000, v155
  v_mul_f32 v44, v152, v9
  v_fmac_f32 v44, v153, v13
  v_fmac_f32 v44, v154, v17
  v_fmac_f32 v44, v155, v21
  s_nop 1
  v_add_f32_dpp v44, v44, v44 row_ror:8 row_mask:0xf bank_mask:0xf
  v_mov_b32 v45, v44
  s_nop 1
  v_permlane16_swap_b32 v44, v45
  v_add_f32 v44, v44, v45
  v_mov_b32 v45, v44
  s_nop 1
  v_permlane32_swap_b32 v44, v45
  v_add_f32 v44, v44, v45
  ds_write_b32 v47, v44 offset:32
  s_cmp_lt_u32 s2, 128
  s_cbranch_scc1 L_fgA
  ds_read_b64_tr_b16 v[80:81], v63 offset:0
  ds_read_b64_tr_b16 v[82:83], v63 offset:3712
  ds_read_b64_tr_b16 v[84:85], v63 offset:32
  ds_read_b64_tr_b16 v[86:87], v63 offset:3744
  ds_read_b64_tr_b16 v[88:89], v63 offset:448
  ds_read_b64_tr_b16 v[90:91], v63 offset:4160
  ds_read_b64_tr_b16 v[92:93], v63 offset:480
  ds_read_b64_tr_b16 v[94:95], v63 offset:4192
  s_branch L_fgx
L_fgA:
  ds_read_b64_tr_b16 v[80:81], v243 offset:0
  ds_read_b64_tr_b16 v[82:83], v243 offset:1152
  ds_read_b64_tr_b16 v[84:85], v243 offset:9728
  ds_read_b64_tr_b16 v[86:87], v243 offset:10880
  ds_read_b64_tr_b16 v[88:89], v243 offset:19456
  ds_read_b64_tr_b16 v[90:91], v243 offset:20608
  ds_read_b64_tr_b16 v[92:93], v243 offset:29184
  ds_read_b64_tr_b16 v[94:95], v243 offset:30336
L_fgx:
  s_waitcnt lgkmcnt(0)
  s_barrier
  ds_read_b128 v[160:163], v46 offset:32
  ds_read_b128 v[164:167], v46 offset:48
  v_mov_b32 v144, 0
  v_mov_b32 v145, 0
  v_mov_b32 v146, 0
  v_mov_b32 v147, 0
  v_mov_b32 v148, 0
  v_mov_b32 v149, 0
  v_mov_b32 v150, 0
  v_mov_b32 v151, 0
  s_waitcnt lgkmcnt(0)
  v_add_f32 v160, v160, v161
  v_add_f32 v162, v162, v163
  v_add_f32 v164, v164, v165
  v_add_f32 v166, v166, v167
  v_add_f32 v160, v160, v162
  v_add_f32 v164, v164, v166
  v_add_f32 v160, v160, v164
  v_rcp_f32 v168, v160
  s_bitcmp1_b32 s73, 0
  s_cbranch_scc1 L_ir_45
  buffer_load_dwordx4 v[128:131], v36, s[32:35], s83 offen offset:0 sc1
L_ir_45:
  s_bitcmp1_b32 s73, 1
  s_cbranch_scc1 L_ir_46
  buffer_load_dwordx4 v[132:135], v36, s[32:35], s84 offen offset:0 sc1
L_ir_46:
  s_bitcmp1_b32 s73, 2
  s_cbranch_scc1 L_ir_47
  buffer_load_dwordx4 v[136:139], v36, s[32:35], s85 offen offset:0 sc1
L_ir_47:
  s_bitcmp1_b32 s73, 3
  s_cbranch_scc1 L_ir_48
  buffer_load_dwordx4 v[140:143], v36, s[32:35], s86 offen offset:0 sc1
L_ir_48:
  s_or_b32 s73, s73, 15
  s_mov_b32 s100, 0
L_p2:
  s_mov_b32 s95, s73
  s_waitcnt vmcnt(0)
  s_bitcmp1_b32 s95, 0
  s_cbranch_scc0 L_dc_49
  s_bitcmp1_b32 s95, 4
  s_cbranch_scc1 L_dc_49
  v_xor_b32 v44, v128, v4
  v_bitop3_b32 v44, v129, v5, v44 bitop3:0xbe
  v_bitop3_b32 v44, v130, v6, v44 bitop3:0xbe
  v_bitop3_b32 v44, v131, v7, v44 bitop3:0xbe
  v_and_b32 v44, s53, v44
  v_cmp_ne_u32 vcc, 0, v44
  s_nop 0
  s_cbranch_vccz L_dc_49k
  s_sleep 1
  buffer_load_dwordx4 v[128:131], v36, s[32:35], s83 offen offset:0 sc1
  s_branch L_dc_49
L_dc_49k:
  s_bitset1_b32 s73, 4
  v_dot2c_f32_bf16 v144, v156, v128
  v_dot2c_f32_bf16 v145, v152, v128
  v_dot2c_f32_bf16 v146, v156, v129
  v_dot2c_f32_bf16 v147, v152, v129
  v_dot2c_f32_bf16 v148, v156, v130
  v_dot2c_f32_bf16 v149, v152, v130
  v_dot2c_f32_bf16 v150, v156, v131
  v_dot2c_f32_bf16 v151, v152, v131
L_dc_49:
  s_bitcmp1_b32 s95, 1
  s_nop 0
  s_cbranch_scc0 L_dc_50
  s_bitcmp1_b32 s95, 5
  s_cbranch_scc1 L_dc_50
  v_xor_b32 v44, v132, v4
  v_bitop3_b32 v44, v133, v5, v44 bitop3:0xbe
  v_bitop3_b32 v44, v134, v6, v44 bitop3:0xbe
  v_bitop3_b32 v44, v135, v7, v44 bitop3:0xbe
  v_and_b32 v44, s53, v44
  v_cmp_ne_u32 vcc, 0, v44
  s_nop 0
  s_cbranch_vccz L_dc_50k
  s_sleep 1
  buffer_load_dwordx4 v[132:135], v36, s[32:35], s84 offen offset:0 sc1
  s_branch L_dc_50
L_dc_50k:
  s_bitset1_b32 s73, 5
  v_dot2c_f32_bf16 v144, v157, v132
  v_dot2c_f32_bf16 v145, v153, v132
  v_dot2c_f32_bf16 v146, v157, v133
  v_dot2c_f32_bf16 v147, v153, v133
  v_dot2c_f32_bf16 v148, v157, v134
  v_dot2c_f32_bf16 v149, v153, v134
  v_dot2c_f32_bf16 v150, v157, v135
  v_dot2c_f32_bf16 v151, v153, v135
L_dc_50:
  s_bitcmp1_b32 s95, 2
  s_nop 0
  s_cbranch_scc0 L_dc_51
  s_bitcmp1_b32 s95, 6
  s_cbranch_scc1 L_dc_51
  v_xor_b32 v44, v136, v4
  v_bitop3_b32 v44, v137, v5, v44 bitop3:0xbe
  v_bitop3_b32 v44, v138, v6, v44 bitop3:0xbe
  v_bitop3_b32 v44, v139, v7, v44 bitop3:0xbe
  v_and_b32 v44, s53, v44
  v_cmp_ne_u32 vcc, 0, v44
  s_nop 0
  s_cbranch_vccz L_dc_51k
  s_sleep 1
  buffer_load_dwordx4 v[136:139], v36, s[32:35], s85 offen offset:0 sc1
  s_branch L_dc_51
L_dc_51k:
  s_bitset1_b32 s73, 6
  v_dot2c_f32_bf16 v144, v158, v136
  v_dot2c_f32_bf16 v145, v154, v136
  v_dot2c_f32_bf16 v146, v158, v137
  v_dot2c_f32_bf16 v147, v154, v137
  v_dot2c_f32_bf16 v148, v158, v138
  v_dot2c_f32_bf16 v149, v154, v138
  v_dot2c_f32_bf16 v150, v158, v139
  v_dot2c_f32_bf16 v151, v154, v139
L_dc_51:
  s_bitcmp1_b32 s95, 3
  s_nop 0
  s_cbranch_scc0 L_dc_52
  s_bitcmp1_b32 s95, 7
  s_cbranch_scc1 L_dc_52
  v_xor_b32 v44, v140, v4
  v_bitop3_b32 v44, v141, v5, v44 bitop3:0xbe
  v_bitop3_b32 v44, v142, v6, v44 bitop3:0xbe
  v_bitop3_b32 v44, v143, v7, v44 bitop3:0xbe
  v_and_b32 v44, s53, v44
  v_cmp_ne_u32 vcc, 0, v44
  s_nop 0
  s_cbranch_vccz L_dc_52k
  s_sleep 1
  buffer_load_dwordx4 v[140:143], v36, s[32:35], s86 offen offset:0 sc1
  s_branch L_dc_52
L_dc_52k:
  s_bitset1_b32 s73, 7
  v_dot2c_f32_bf16 v144, v159, v140
  v_dot2c_f32_bf16 v145, v155, v140
  v_dot2c_f32_bf16 v146, v159, v141
  v_dot2c_f32_bf16 v147, v155, v141
  v_dot2c_f32_bf16 v148, v159, v142
  v_dot2c_f32_bf16 v149, v155, v142
  v_dot2c_f32_bf16 v150, v159, v143
  v_dot2c_f32_bf16 v151, v155, v143
L_dc_52:
  s_cmp_eq_u32 s73, 0xff
  s_nop 0
  s_cbranch_scc1 L_p2x
  s_add_u32 s100, s100, 1
  s_cmp_gt_u32 s100, 100000
  s_cbranch_scc1 L_abort
  s_branch L_p2
L_p2x:
  v_permlane32_swap_b32 v144, v148
  v_permlane32_swap_b32 v145, v149
  v_permlane32_swap_b32 v146, v150
  v_permlane32_swap_b32 v147, v151
  v_add_f32 v144, v144, v148
  v_add_f32 v145, v145, v149
  v_add_f32 v146, v146, v150
  v_add_f32 v147, v147, v151
  s_nop 0
  v_permlane16_swap_b32 v144, v146
  v_permlane16_swap_b32 v145, v147
  v_add_f32 v144, v144, v146
  v_add_f32 v145, v145, v147
  s_nop 0
  v_add_f32_dpp v144, v144, v144 row_ror:8 row_mask:0xf bank_mask:0xf
  v_add_f32_dpp v145, v145, v145 row_ror:8 row_mask:0xf bank_mask:0xf
  v_mul_f32 v144, v144, v168
  v_mul_f32 v145, v145, v168
  v_cvt_pk_bf16_f32 v44, v144, v145
  ds_write_b32 v37, v44
  s_waitcnt lgkmcnt(0)
  s_barrier
  ds_read_b128 v[160:163], v38
  ds_read_b128 v[164:167], v38 offset:64
  s_waitcnt lgkmcnt(1)
  v_mfma_f32_16x16x32_bf16 v[144:147], v[48:51], v[160:163], 0
  s_waitcnt lgkmcnt(0)
  v_mfma_f32_16x16x32_bf16 v[144:147], v[52:55], v[164:167], v[144:147]
  s_nop 7
  v_add_f32_dpp v144, v144, v144 quad_perm:[1,0,3,2] row_mask:0xf bank_mask:0xf
  v_add_f32_dpp v145, v145, v145 quad_perm:[1,0,3,2] row_mask:0xf bank_mask:0xf
  v_add_f32_dpp v146, v146, v146 quad_perm:[1,0,3,2] row_mask:0xf bank_mask:0xf
  v_add_f32_dpp v147, v147, v147 quad_perm:[1,0,3,2] row_mask:0xf bank_mask:0xf
  v_add_f32_dpp v144, v144, v144 quad_perm:[2,3,0,1] row_mask:0xf bank_mask:0xf
  v_add_f32_dpp v145, v145, v145 quad_perm:[2,3,0,1] row_mask:0xf bank_mask:0xf
  v_add_f32_dpp v146, v146, v146 quad_perm:[2,3,0,1] row_mask:0xf bank_mask:0xf
  v_add_f32_dpp v147, v147, v147 quad_perm:[2,3,0,1] row_mask:0xf bank_mask:0xf
  v_add_f32_dpp v144, v144, v144 row_half_mirror row_mask:0xf bank_mask:0xf
  v_add_f32_dpp v145, v145, v145 row_half_mirror row_mask:0xf bank_mask:0xf
  v_add_f32_dpp v146, v146, v146 row_half_mirror row_mask:0xf bank_mask:0xf
  v_add_f32_dpp v147, v147, v147 row_half_mirror row_mask:0xf bank_mask:0xf
  s_mov_b32 exec_lo, 0x10001
  s_mov_b32 exec_hi, 0x10001
  v_and_or_b32 v144, v144, v2, s49
  v_and_or_b32 v145, v145, v2, s50
  v_and_or_b32 v146, v146, v2, s51
  v_and_or_b32 v147, v147, v2, s52
  buffer_store_dwordx4 v[144:147], v1, s[32:35], s16 offen
  v_mov_b32 v8, v144
  v_mov_b32 v9, v145
  v_mov_b32 v10, v146
  v_mov_b32 v11, v147
  s_mov_b64 exec, -1
  s_mov_b32 s69, 0
  s_mov_b32 s66, 0
  s_cmp_lt_u32 s2, 128
  s_cbranch_scc0 L_X
  s_mov_b32 s60, 0xffffffff
  s_mov_b32 s61, 0x0
  s_mov_b32 s100, 0
  s_branch L_gf_54
L_g_53:
  s_add_u32 s100, s100, 1
  s_cmp_gt_u32 s100, 100000
  s_cbranch_scc1 L_abort
  s_sleep 1
  s_cmp_lg_u32 s100, 30
  s_cbranch_scc1 L_alt_56
  s_cmp_lg_u32 s69, 0
  s_cbranch_scc1 L_cg_57
  s_mov_b32 exec_lo, 0x10001
  s_mov_b32 exec_hi, 0x10001
  s_add_u32 s97, s16, 0x160000
  buffer_store_dwordx4 v[8:11], v1, s[32:35], s97 offen sc1
  s_mov_b32 s69, 1
  s_mov_b64 exec, -1
L_cg_57:
  s_add_u32 s66, s66, 0x160000
L_alt_56:
L_gf_54:
  s_mov_b64 exec, s[60:61]
  buffer_load_dwordx4 v[128:131], v39, s[32:35], s66 offen offset:0 sc1
  s_waitcnt vmcnt(0)
L_gc_55:
  s_mov_b64 exec, s[60:61]
  v_perm_b32 v44, v129, v128, s56
  v_perm_b32 v44, v130, v44, s57
  v_perm_b32 v44, v131, v44, s58
  v_cmp_ne_u32 s[60:61], s48, v44
  s_nop 0
  s_cmp_lg_u64 s[60:61], 0
  s_cbranch_scc1 L_g_53
  s_mov_b64 exec, -1
  v_cvt_pk_bf16_f32 v44, v128, v129
  v_cvt_pk_bf16_f32 v45, v130, v131
  s_mov_b32 exec_hi, 0
  ds_write_b64 v43, v[44:45]
  s_mov_b32 exec_hi, -1
  s_cmp_lg_u32 s69, 0
  s_cbranch_scc1 L_cg_59
  s_mov_b32 exec_lo, 0x10001
  s_mov_b32 exec_hi, 0x10001
  s_add_u32 s97, s16, 0x160000
  buffer_store_dwordx4 v[8:11], v1, s[32:35], s97 offen sc1
  s_mov_b32 s69, 1
  s_mov_b64 exec, -1
L_cg_59:
  s_waitcnt lgkmcnt(0)
  s_barrier
  ds_read_b128 v[128:131], v40 offset:0
  ds_read_b128 v[132:135], v40 offset:64
  ds_read_b128 v[136:139], v40 offset:128
  ds_read_b128 v[140:143], v40 offset:192
  s_waitcnt lgkmcnt(3)
  v_mfma_f32_16x16x32_bf16 v[144:147], v[80:83], v[128:131], 0
  s_waitcnt lgkmcnt(2)
  v_mfma_f32_16x16x32_bf16 v[144:147], v[84:87], v[132:135], v[144:147]
  s_waitcnt lgkmcnt(1)
  v_mfma_f32_16x16x32_bf16 v[144:147], v[88:91], v[136:139], v[144:147]
  s_waitcnt lgkmcnt(0)
  v_mfma_f32_16x16x32_bf16 v[144:147], v[92:95], v[140:143], v[144:147]
  s_nop 7
  v_add_f32_dpp v144, v144, v144 quad_perm:[1,0,3,2] row_mask:0xf bank_mask:0xf
  v_add_f32_dpp v145, v145, v145 quad_perm:[1,0,3,2] row_mask:0xf bank_mask:0xf
  v_add_f32_dpp v146, v146, v146 quad_perm:[1,0,3,2] row_mask:0xf bank_mask:0xf
  v_add_f32_dpp v147, v147, v147 quad_perm:[1,0,3,2] row_mask:0xf bank_mask:0xf
  v_add_f32_dpp v144, v144, v144 quad_perm:[2,3,0,1] row_mask:0xf bank_mask:0xf
  v_add_f32_dpp v145, v145, v145 quad_perm:[2,3,0,1] row_mask:0xf bank_mask:0xf
  v_add_f32_dpp v146, v146, v146 quad_perm:[2,3,0,1] row_mask:0xf bank_mask:0xf
  v_add_f32_dpp v147, v147, v147 quad_perm:[2,3,0,1] row_mask:0xf bank_mask:0xf
  v_add_f32_dpp v144, v144, v144 row_half_mirror row_mask:0xf bank_mask:0xf
  v_add_f32_dpp v145, v145, v145 row_half_mirror row_mask:0xf bank_mask:0xf
  v_add_f32_dpp v146, v146, v146 row_half_mirror row_mask:0xf bank_mask:0xf
  v_add_f32_dpp v147, v147, v147 row_half_mirror row_mask:0xf bank_mask:0xf
  s_mov_b32 exec_lo, 0x10001
  s_mov_b32 exec_hi, 0x10001
  v_and_or_b32 v144, v144, v2, s49
  v_and_or_b32 v145, v145, v2, s50
  v_and_or_b32 v146, v146, v2, s51
  v_and_or_b32 v147, v147, v2, s52
  buffer_store_dwordx4 v[144:147], v1, s[32:35], s75 offen sc1
  s_mov_b64 exec, -1
  s_branch L_Y
L_X:
  s_cmp_lg_u32 s69, 0
  s_cbranch_scc1 L_cg_60
  s_mov_b32 exec_lo, 0x10001
  s_mov_b32 exec_hi, 0x10001
  s_add_u32 s97, s16, 0x160000
  buffer_store_dwordx4 v[8:11], v1, s[32:35], s97 offen sc1
  s_mov_b32 s69, 1
  s_mov_b64 exec, -1
L_cg_60:
  s_lshl_b32 s92, s79, 6
  v_and_b32 v44, 31, v1
  v_lshlrev_b32 v44, 1, v44
  v_add_u32 v44, s92, v44
  global_load_ushort v66, v44, s[4:5]
  s_movk_i32 s68, 0x4000
  buffer_load_dwordx4 v[68:71], v56, s[32:35], 0 offen offset:0 sc1
  buffer_load_dwordx4 v[72:75], v56, s[32:35], s68 offen offset:0 sc1
  s_waitcnt vmcnt(0)
  s_mov_b64 s[60:61], -1
  s_waitcnt vmcnt(63)
  s_mov_b32 s100, 0
  s_branch L_gc_64
L_g_62:
  s_add_u32 s100, s100, 1
  s_cmp_gt_u32 s100, 100000
  s_cbranch_scc1 L_abort
  s_sleep 2
L_gf_63:
  s_mov_b64 exec, s[60:61]
  buffer_load_dwordx4 v[68:71], v56, s[32:35], 0 offen offset:0 sc1
  buffer_load_dwordx4 v[72:75], v56, s[32:35], s68 offen offset:0 sc1
  s_waitcnt vmcnt(0)
L_gc_64:
  s_mov_b64 exec, s[60:61]
  v_perm_b32 v44, v69, v68, s56
  v_perm_b32 v44, v70, v44, s57
  v_perm_b32 v44, v71, v44, s58
  v_cmp_ne_u32 s[60:61], s48, v44
  v_perm_b32 v44, v73, v72, s56
  v_perm_b32 v44, v74, v44, s57
  v_perm_b32 v44, v75, v44, s58
  v_cmp_ne_u32 vcc, s48, v44
  s_nop 0
  s_or_b64 s[60:61], s[60:61], vcc
  s_cmp_lg_u64 s[60:61], 0
  s_cbranch_scc1 L_g_62
  s_mov_b64 exec, -1
  v_permlane32_swap_b32 v68, v70
  v_permlane32_swap_b32 v69, v71
  v_add_f32 v68, v68, v70
  v_add_f32 v69, v69, v71
  s_nop 1
  v_permlane16_swap_b32 v68, v69
  v_add_f32 v68, v68, v69
  v_permlane32_swap_b32 v72, v74
  v_permlane32_swap_b32 v73, v75
  v_add_f32 v72, v72, v74
  v_add_f32 v73, v73, v75
  s_nop 1
  v_permlane16_swap_b32 v72, v73
  v_add_f32 v72, v72, v73
  v_cvt_pk_bf16_f32 v44, v68, v68
  v_and_b32 v68, 0xffff0000, v44
  v_cvt_pk_bf16_f32 v45, v72, v72
  v_and_b32 v72, 0xffff0000, v45
  v_and_b32 v44, 3, v1
  v_lshlrev_b32 v44, 6, v44
  v_bfe_u32 v3, v1, 2, 3
  v_lshl_add_u32 v44, v3, 2, v44
  ds_bpermute_b32 v76, v44, v68 offset:0
  ds_bpermute_b32 v77, v44, v68 offset:32
  ds_bpermute_b32 v78, v44, v72 offset:0
  ds_bpermute_b32 v79, v44, v72 offset:32
  s_lshr_b32 s92, s82, 12
  s_lshl_b32 s92, s92, 12
  s_add_u32 s94, s82, s92
  s_add_u32 s94, s94, 1114112
  s_add_u32 s82, s82, 851968
  v_bfe_u32 v45, v1, 2, 1
  v_lshlrev_b32 v45, 6, v45
  v_add_u32 v45, v45, v41
  v_bfe_u32 v69, v1, 2, 1
  v_lshlrev_b32 v69, 12, v69
  v_and_b32 v3, 3, v1
  v_lshl_add_u32 v69, v3, 6, v69
  v_lshrrev_b32 v3, 4, v1
  v_lshl_add_u32 v69, v3, 4, v69
  s_waitcnt lgkmcnt(0)
  v_add_f32 v78, 1.0, v78
  v_lshlrev_b32 v66, 16, v66
  v_cvt_pk_bf16_f32 v44, v78, v78
  v_and_b32 v78, 0xffff0000, v44
  s_cmp_eq_u32 s3, 7
  s_cbranch_scc1 L_ab_61
  ds_write_b16_d16_hi v57, v78
  ds_write_b16_d16_hi v57, v77 offset:64
  ds_read_b128 v[72:75], v45
  s_waitcnt lgkmcnt(0)
  v_mfma_f32_16x16x32_bf16 v[208:211], v[80:83], v[72:75], 0
  v_mfma_f32_16x16x32_bf16 v[212:215], v[84:87], v[72:75], 0
  v_mfma_f32_16x16x32_bf16 v[216:219], v[88:91], v[72:75], 0
  v_mfma_f32_16x16x32_bf16 v[220:223], v[92:95], v[72:75], 0
  s_mov_b32 exec_lo, 0x220022
  s_mov_b32 exec_hi, 0x220022
  s_nop 3
  v_mov_b32 v208, v212
  v_mov_b32 v209, v213
  v_mov_b32 v210, v214
  v_mov_b32 v211, v215
  s_mov_b32 exec_lo, 0x440044
  s_mov_b32 exec_hi, 0x440044
  v_mov_b32 v208, v216
  v_mov_b32 v209, v217
  v_mov_b32 v210, v218
  v_mov_b32 v211, v219
  s_mov_b32 exec_lo, 0x880088
  s_mov_b32 exec_hi, 0x880088
  v_mov_b32 v208, v220
  v_mov_b32 v209, v221
  v_mov_b32 v210, v222
  v_mov_b32 v211, v223
  s_mov_b32 exec_lo, 0xff00ff
  s_mov_b32 exec_hi, 0xff00ff
  v_and_or_b32 v208, v208, v2, s49
  v_and_or_b32 v209, v209, v2, s50
  v_and_or_b32 v210, v210, v2, s51
  v_and_or_b32 v211, v211, v2, s52
  buffer_store_dwordx4 v[208:211], v69, s[32:35], s94 offen sc1
  s_mov_b64 exec, -1
L_ab_61:
  v_mov_b32 v112, 0
  v_mov_b32 v113, 0
  v_mov_b32 v114, 0
  v_mov_b32 v115, 0
  s_mov_b32 s60, 0xffffffff
  s_mov_b32 s61, 0x0
  s_mov_b32 s100, 0
  s_branch L_gf_67
L_g_66:
  s_add_u32 s100, s100, 1
  s_cmp_gt_u32 s100, 100000
  s_cbranch_scc1 L_abort
  s_sleep 4
L_gf_67:
  s_mov_b64 exec, s[60:61]
  buffer_load_dwordx4 v[112:115], v61, s[32:35], s90 offen offset:0 sc1
  s_waitcnt vmcnt(0)
L_gc_68:
  s_mov_b64 exec, s[60:61]
  v_perm_b32 v44, v113, v112, s56
  v_perm_b32 v44, v114, v44, s57
  v_perm_b32 v44, v115, v44, s58
  v_cmp_ne_u32 s[60:61], s48, v44
  s_nop 0
  s_cmp_lg_u64 s[60:61], 0
  s_cbranch_scc1 L_g_66
  s_mov_b64 exec, -1
  v_permlane32_swap_b32 v112, v114
  v_permlane32_swap_b32 v113, v115
  v_add_f32 v112, v112, v114
  v_add_f32 v113, v113, v115
  s_nop 1
  v_permlane16_swap_b32 v112, v113
  v_add_f32 v112, v112, v113
  s_nop 1
  v_add_f32_dpp v112, v112, v112 row_ror:8 row_mask:0xf bank_mask:0xf
  ds_write_b32 v59, v112
  s_waitcnt lgkmcnt(0)
  s_barrier
  ds_read_b128 v[112:115], v60
  ds_read_b128 v[116:119], v60 offset:16
  s_waitcnt lgkmcnt(0)
  v_add_f32 v112, v112, v113
  v_add_f32 v114, v114, v115
  v_add_f32 v116, v116, v117
  v_add_f32 v118, v118, v119
  v_add_f32 v112, v112, v114
  v_add_f32 v116, v116, v118
  v_add_f32 v112, v112, v116
  v_cvt_pk_bf16_f32 v44, v112, v112
  v_and_b32 v112, 0xffff0000, v44
  v_mul_f32 v67, v76, v112
  v_cvt_pk_bf16_f32 v44, v67, v67
  v_and_b32 v67, 0xffff0000, v44
  v_add_f32 v67, v66, v67
  v_cvt_pk_bf16_f32 v44, v67, v67
  v_and_b32 v67, 0xffff0000, v44
  s_cmp_eq_u32 s3, 7
  s_cbranch_scc1 L_stat
  v_mul_f32 v44, v67, v78
  v_cvt_pk_bf16_f32 v44, v44, v44
  ds_write_b16 v57, v44
  ds_read_b128 v[160:163], v41
  s_mov_b32 s70, 0x20002
  s_mov_b32 s71, 0x20002
  s_mov_b32 s72, 0x40004
  s_mov_b32 s73, 0x40004
  s_mov_b32 s74, 0x80008
  s_mov_b32 s75, 0x80008
  s_waitcnt lgkmcnt(0)
  v_mfma_f32_16x16x32_bf16 v[128:131], v[80:83], v[160:163], 0
  v_mfma_f32_16x16x32_bf16 v[132:135], v[84:87], v[160:163], 0
  v_mfma_f32_16x16x32_bf16 v[136:139], v[88:91], v[160:163], 0
  v_mfma_f32_16x16x32_bf16 v[140:143], v[92:95], v[160:163], 0
  s_nop 5
  v_cndmask_b32 v128, v128, v132, s[70:71]
  v_cndmask_b32 v129, v129, v133, s[70:71]
  v_cndmask_b32 v130, v130, v134, s[70:71]
  v_cndmask_b32 v131, v131, v135, s[70:71]
  v_cndmask_b32 v128, v128, v136, s[72:73]
  v_cndmask_b32 v129, v129, v137, s[72:73]
  v_cndmask_b32 v130, v130, v138, s[72:73]
  v_cndmask_b32 v131, v131, v139, s[72:73]
  v_cndmask_b32 v128, v128, v140, s[74:75]
  v_cndmask_b32 v129, v129, v141, s[74:75]
  v_cndmask_b32 v130, v130, v142, s[74:75]
  v_cndmask_b32 v131, v131, v143, s[74:75]
  v_and_or_b32 v128, v128, v2, s49
  v_and_or_b32 v129, v129, v2, s50
  v_and_or_b32 v130, v130, v2, s51
  v_and_or_b32 v131, v131, v2, s52
  s_mov_b32 exec_lo, 0xf000f
  s_mov_b32 exec_hi, 0xf000f
  buffer_store_dwordx4 v[128:131], v58, s[32:35], s82 offen
  s_add_u32 s97, s82, 0xf0000
  buffer_store_dwordx4 v[128:131], v58, s[32:35], s97 offen sc1
  s_mov_b64 exec, -1
  s_branch L_xdone
L_stat:
  v_mov_b32 v130, v67
  v_mul_f32 v131, v67, v67
  s_nop 0
  v_add_f32_dpp v130, v130, v130 row_ror:8 row_mask:0xf bank_mask:0xf
  v_add_f32_dpp v131, v131, v131 row_ror:8 row_mask:0xf bank_mask:0xf
  s_nop 0
  v_add_f32_dpp v130, v130, v130 row_ror:4 row_mask:0xf bank_mask:0xf
  v_add_f32_dpp v131, v131, v131 row_ror:4 row_mask:0xf bank_mask:0xf
  s_nop 0
  v_add_f32_dpp v130, v130, v130 row_ror:2 row_mask:0xf bank_mask:0xf
  v_add_f32_dpp v131, v131, v131 row_ror:2 row_mask:0xf bank_mask:0xf
  s_nop 0
  v_add_f32_dpp v130, v130, v130 row_ror:1 row_mask:0xf bank_mask:0xf
  v_add_f32_dpp v131, v131, v131 row_ror:1 row_mask:0xf bank_mask:0xf
  v_mov_b32 v128, v130
  v_mov_b32 v129, v131
  s_nop 0
  v_permlane16_swap_b32 v130, v128
  v_permlane16_swap_b32 v131, v129
  v_add_f32 v130, v130, v128
  v_add_f32 v131, v131, v129
  v_and_b32 v128, v2, v130
  v_and_b32 v129, v2, v131
  v_sub_f32 v130, v130, v128
  v_sub_f32 v131, v131, v129
  v_and_or_b32 v128, v128, v2, s49
  v_and_or_b32 v129, v129, v2, s50
  v_and_or_b32 v130, v130, v2, s51
  v_and_or_b32 v131, v131, v2, s52
  s_lshl_b32 s92, s80, 11
  s_lshl_b32 s97, s79, 7
  s_add_u32 s92, s92, s97
  s_add_u32 s92, s92, 0x18000
  s_mov_b64 exec, 1
  buffer_store_dwordx4 v[128:131], v1, s[32:35], s92 offen
  s_add_u32 s97, s92, 0x1e0000
  buffer_store_dwordx4 v[128:131], v1, s[32:35], s97 offen sc1
  s_mov_b64 exec, -1
  v_mov_b32 v112, 0
L_xdone:
  s_and_b32 s92, s79, 7
  s_cmp_lg_u32 s80, s92
  s_cbranch_scc1 L_fin
  s_mul_i32 s90, s79, 8448
  s_lshl_b32 s97, s3, 10
  s_add_u32 s90, s90, s97
  s_add_u32 s90, s90, 0xa0000
  s_lshl_b32 s92, s79, 6
  v_and_b32 v46, 31, v1
  v_lshlrev_b32 v46, 1, v46
  v_add_u32 v46, s92, v46
  s_cmp_eq_u32 s3, 7
  s_cbranch_scc1 L_nof
  s_mov_b64 s[60:61], -1
  s_mov_b32 s100, 0
  s_branch L_gf_71
L_g_70:
  s_add_u32 s100, s100, 1
  s_cmp_gt_u32 s100, 100000
  s_cbranch_scc1 L_abort
  s_sleep 1
L_gf_71:
  s_mov_b64 exec, s[60:61]
  buffer_load_dwordx4 v[112:115], v34, s[32:35], s90 offen offset:0 sc1
  s_waitcnt vmcnt(0)
L_gc_72:
  s_mov_b64 exec, s[60:61]
  v_perm_b32 v44, v113, v112, s56
  v_perm_b32 v44, v114, v44, s57
  v_perm_b32 v44, v115, v44, s58
  v_cmp_ne_u32 s[60:61], s48, v44
  s_nop 0
  s_cmp_lg_u64 s[60:61], 0
  s_cbranch_scc1 L_g_70
  s_mov_b64 exec, -1
  v_permlane32_swap_b32 v112, v114
  v_permlane32_swap_b32 v113, v115
  v_add_f32 v112, v112, v114
  v_add_f32 v113, v113, v115
  s_nop 1
  v_permlane16_swap_b32 v112, v113
  v_add_f32 v112, v112, v113
  s_nop 1
  v_add_f32_dpp v112, v112, v112 row_ror:8 row_mask:0xf bank_mask:0xf
L_nof:
  ds_write_b32 v59, v112 offset:1024
  s_waitcnt lgkmcnt(0)
  s_barrier
  s_cmp_lg_u32 s3, 0
  s_cbranch_scc1 L_fin
  ds_read_b128 v[112:115], v60 offset:1024
  ds_read_b128 v[116:119], v60 offset:1040
  s_waitcnt lgkmcnt(0)
  v_add_f32 v112, v112, v113
  v_add_f32 v114, v114, v115
  v_add_f32 v116, v116, v117
  v_add_f32 v118, v118, v119
  v_add_f32 v112, v112, v114
  v_add_f32 v116, v116, v118
  v_add_f32 v112, v112, v116
  v_cvt_pk_bf16_f32 v45, v112, v112
  v_and_b32 v112, 0xffff0000, v45
  v_mul_f32 v44, v79, v112
  v_cvt_pk_bf16_f32 v45, v44, v44
  v_and_b32 v44, 0xffff0000, v45
  v_add_f32 v44, v67, v44
  v_cvt_pk_bf16_f32 v44, v44, v44
  s_mov_b32 exec_hi, 0
  global_store_short v46, v44, s[28:29]
  s_cmp_lg_u32 s2, 128
  s_cbranch_scc1 L_noep
  s_mov_b64 exec, 1
  v_mov_b32 v45, 0
  global_store_dword v45, v45, s[30:31]
L_noep:
L_fin:
  s_endpgm
L_Y:
  s_cmp_ge_u32 s2, 112
  s_cbranch_scc1 L_fin
  s_lshl_b32 s94, s81, 13
  s_lshl_b32 s97, s3, 10
  s_add_u32 s94, s94, s97
  s_add_u32 s94, s94, 0x110000
  s_mov_b64 s[40:41], s[22:23]
  s_mov_b32 s42, 0x1c0000
  s_mov_b32 s43, 0x20000
  v_lshrrev_b32 v44, 5, v1
  v_lshlrev_b32 v44, 10, v44
  v_and_b32 v3, 31, v1
  v_lshl_add_u32 v44, v3, 4, v44
  buffer_load_dwordx4 v[176:179], v44, s[40:43], s91 offen offset:0 nt
  buffer_load_dwordx4 v[180:183], v44, s[40:43], s91 offen offset:2048 nt
  v_mov_b32 v112, 0
  v_mov_b32 v113, 0
  v_mov_b32 v114, 0
  v_mov_b32 v115, 0
  v_lshlrev_b32 v46, 4, v1
  v_add_u32 v46, 88064, v46
  v_lshlrev_b32 v47, 5, v1
  v_add_u32 v47, 83968, v47
  s_waitcnt vmcnt(0)
  s_mov_b64 s[60:61], -1
  s_mov_b32 s100, 0
  s_branch L_gf_75
L_g_74:
  s_add_u32 s100, s100, 1
  s_cmp_gt_u32 s100, 100000
  s_cbranch_scc1 L_abort
  s_sleep 2
L_gf_75:
  s_mov_b64 exec, s[60:61]
  buffer_load_dwordx4 v[76:79], v34, s[32:35], s94 offen offset:0 sc1
  s_waitcnt vmcnt(0)
L_gc_76:
  s_mov_b64 exec, s[60:61]
  v_perm_b32 v44, v77, v76, s56
  v_perm_b32 v44, v78, v44, s57
  v_perm_b32 v44, v79, v44, s58
  v_cmp_ne_u32 s[60:61], s48, v44
  s_nop 0
  s_cmp_lg_u64 s[60:61], 0
  s_cbranch_scc1 L_g_74
  s_mov_b64 exec, -1
  v_permlane32_swap_b32 v76, v78
  v_permlane32_swap_b32 v77, v79
  v_add_f32 v76, v76, v78
  v_add_f32 v77, v77, v79
  s_nop 1
  v_permlane16_swap_b32 v76, v77
  v_add_f32 v76, v76, v77
  s_waitcnt vmcnt(0)
  ds_write_b128 v62, v[176:179] offset:0
  ds_write_b128 v62, v[180:183] offset:1088
  ds_write_b32 v60, v76
  s_waitcnt lgkmcnt(0)
  s_barrier
  ds_read_b128 v[128:131], v46
  ds_read_b128 v[132:135], v46 offset:1024
  ds_read_b64_tr_b16 v[68:69], v63 offset:0
  ds_read_b64_tr_b16 v[70:71], v63 offset:2176
  ds_read_b64_tr_b16 v[72:73], v63 offset:32
  ds_read_b64_tr_b16 v[74:75], v63 offset:2208
  s_waitcnt lgkmcnt(4)
  v_add_f32 v128, v128, v129
  v_add_f32 v130, v130, v131
  v_add_f32 v128, v128, v130
  v_add_f32 v132, v132, v133
  v_add_f32 v134, v134, v135
  v_add_f32 v132, v132, v134
  s_mov_b32 s66, 0
  s_mov_b32 s60, 0xffffffff
  s_mov_b32 s61, 0x0
  s_mov_b32 s62, 0xffff
  s_mov_b32 s63, 0x0
  s_mov_b32 s100, 0
  s_branch L_gf_79
L_g_78:
  s_add_u32 s100, s100, 1
  s_cmp_gt_u32 s100, 100000
  s_cbranch_scc1 L_abort
  s_sleep 1
  s_cmp_lg_u32 s100, 30
  s_cbranch_scc1 L_alt_81
  s_add_u32 s82, s82, 0xf0000
  s_add_u32 s66, s66, 0x1e0000
L_alt_81:
L_gf_79:
  s_mov_b64 exec, s[60:61]
  s_cbranch_execz L_gs_82
  buffer_load_dwordx4 v[112:115], v61, s[32:35], s82 offen offset:0 sc1
L_gs_82:
  s_mov_b64 exec, s[62:63]
  s_cbranch_execz L_gs_83
  buffer_load_dwordx4 v[136:139], v56, s[32:35], s66 offen offset:0 sc1
L_gs_83:
  s_waitcnt vmcnt(0)
L_gc_80:
  s_mov_b64 exec, s[60:61]
  v_perm_b32 v44, v113, v112, s56
  v_perm_b32 v44, v114, v44, s57
  v_perm_b32 v44, v115, v44, s58
  v_cmp_ne_u32 s[60:61], s48, v44
  s_mov_b64 exec, s[62:63]
  v_perm_b32 v44, v137, v136, s56
  v_perm_b32 v44, v138, v44, s57
  v_perm_b32 v44, v139, v44, s58
  v_cmp_ne_u32 s[62:63], s48, v44
  s_nop 0
  s_or_b64 s[96:97], s[60:61], s[62:63]
  s_cbranch_scc1 L_g_78
  s_mov_b64 exec, -1
  v_permlane32_swap_b32 v112, v114
  v_permlane32_swap_b32 v113, v115
  v_add_f32 v112, v112, v114
  v_add_f32 v113, v113, v115
  s_nop 1
  v_permlane16_swap_b32 v112, v113
  v_add_f32 v112, v112, v113
  ds_write_b32 v59, v112
  v_add_f32 v136, v136, v138
  v_add_f32 v137, v137, v139
  s_nop 0
  v_add_f32_dpp v136, v136, v136 quad_perm:[1,0,3,2] row_mask:0xf bank_mask:0xf
  v_add_f32_dpp v137, v137, v137 quad_perm:[1,0,3,2] row_mask:0xf bank_mask:0xf
  s_nop 0
  v_add_f32_dpp v136, v136, v136 quad_perm:[2,3,0,1] row_mask:0xf bank_mask:0xf
  v_add_f32_dpp v137, v137, v137 quad_perm:[2,3,0,1] row_mask:0xf bank_mask:0xf
  s_nop 0
  v_add_f32_dpp v136, v136, v136 row_half_mirror row_mask:0xf bank_mask:0xf
  v_add_f32_dpp v137, v137, v137 row_half_mirror row_mask:0xf bank_mask:0xf
  s_nop 0
  v_add_f32_dpp v136, v136, v136 row_ror:8 row_mask:0xf bank_mask:0xf
  v_add_f32_dpp v137, v137, v137 row_ror:8 row_mask:0xf bank_mask:0xf
  s_waitcnt lgkmcnt(0)
  s_barrier
  ds_read_b128 v[112:115], v47
  ds_read_b128 v[116:119], v47 offset:16
  v_readfirstlane_b32 s92, v136
  v_readfirstlane_b32 s93, v137
  v_mov_b32 v44, 0x3b000000
  v_mul_f32 v136, s92, v44
  v_mul_f32 v137, s93, v44
  v_fma_f32 v137, -v136, v136, v137
  v_max_f32 v137, 0, v137
  v_cvt_pk_bf16_f32 v45, v137, v137
  v_and_b32 v137, 0xffff0000, v45
  v_cvt_pk_bf16_f32 v44, v136, v136
  v_and_b32 v136, 0xffff0000, v44
  v_add_f32 v137, 0x3727c5ac, v137
  v_mul_f32 v128, v136, v128
  v_cvt_pk_bf16_f32 v45, v137, v137
  v_and_b32 v137, 0xffff0000, v45
  v_sqrt_f32 v137, v137
  s_nop 0
  v_cvt_pk_bf16_f32 v45, v137, v137
  v_and_b32 v137, 0xffff0000, v45
  v_rcp_f32 v137, v137
  s_waitcnt lgkmcnt(0)
  v_add_f32 v112, v112, v113
  v_add_f32 v114, v114, v115
  v_add_f32 v116, v116, v117
  v_add_f32 v118, v118, v119
  v_add_f32 v112, v112, v114
  v_add_f32 v116, v116, v118
  v_add_f32 v112, v112, v116
  v_sub_f32 v112, v112, v128
  v_fma_f32 v112, v112, v137, v132
  v_cvt_pk_bf16_f32 v44, v112, v112
  v_and_b32 v112, 0xffff0000, v44
  v_mul_f32 v44, v112, v112
  v_mov_b32 v45, 0xc0135761
  v_mov_b32_dpp v113, v112 row_ror:8 row_mask:0xf bank_mask:0xf
  v_fmac_f32 v45, 0xbdd2d3e8, v44
  v_mul_f32 v44, v45, v112
  v_exp_f32 v44, v44
  s_nop 0
  v_add_f32 v44, 1.0, v44
  v_rcp_f32 v44, v44
  s_nop 0
  v_mul_f32 v112, v112, v44
  v_cvt_pk_bf16_f32 v44, v112, v112
  v_and_b32 v112, 0xffff0000, v44
  v_mul_f32 v112, v112, v113
  v_cvt_pk_bf16_f32 v44, v112, v112
  s_mov_b32 exec_lo, 0xff00ff
  s_mov_b32 exec_hi, 0xff00ff
  ds_write_b16 v57, v44
  s_mov_b64 exec, -1
  ds_read_b128 v[160:163], v41
  s_mov_b32 s70, 0x20002
  s_mov_b32 s71, 0x20002
  s_waitcnt lgkmcnt(0)
  v_mfma_f32_16x16x32_bf16 v[144:147], v[68:71], v[160:163], 0
  v_mfma_f32_16x16x32_bf16 v[148:151], v[72:75], v[160:163], 0
  s_nop 7
  v_cndmask_b32 v144, v144, v148, s[70:71]
  v_cndmask_b32 v145, v145, v149, s[70:71]
  v_cndmask_b32 v146, v146, v150, s[70:71]
  v_cndmask_b32 v147, v147, v151, s[70:71]
  v_and_or_b32 v144, v144, v2, s49
  v_and_or_b32 v145, v145, v2, s50
  v_and_or_b32 v146, v146, v2, s51
  v_and_or_b32 v147, v147, v2, s52
  s_mov_b32 exec_lo, 0x30003
  s_mov_b32 exec_hi, 0x30003
  buffer_store_dwordx4 v[144:147], v58, s[32:35], s90 offen sc1
  s_endpgm
L_abort:
  s_endpgm
L_end:
  s_endpgm
L_codeend:
.section .rodata,"a"
.p2align 6
.amdhsa_kernel adaLN_cond__compressed_kv_cla__glu_gated_geglu__decode_kernel
  .amdhsa_next_free_vgpr 256
  .amdhsa_next_free_sgpr 102
  .amdhsa_accum_offset 256
  .amdhsa_group_segment_fixed_size 0
  .amdhsa_kernarg_size 120
  .amdhsa_user_sgpr_count 2
  .amdhsa_user_sgpr_kernarg_segment_ptr 1
  .amdhsa_system_sgpr_workgroup_id_x 1
.end_amdhsa_kernel
```

```asm
; @launch grid=(256,1,1) block=(512,1,1) lds=163840
.amdgcn_target "amdgcn-amd-amdhsa--gfx950"
.text
.globl adaLN_cond__compressed_kv_cla__glu_gated_geglu__decode_kernel
.p2align 8
.type adaLN_cond__compressed_kv_cla__glu_gated_geglu__decode_kernel,@function
adaLN_cond__compressed_kv_cla__glu_gated_geglu__decode_kernel:
  s_cmp_ge_u32 s2, 256
  s_cbranch_scc1 L_end
  s_load_dwordx16 s[4:19], s[0:1], 0
  s_load_dwordx8 s[20:27], s[0:1], 64
  s_load_dwordx4 s[28:31], s[0:1], 96
  s_load_dwordx2 s[32:33], s[0:1], 112
  v_lshrrev_b32 v1, 6, v0
  s_mov_b32 s34, 0x10000000
  s_mov_b32 s35, 0x20000
  v_readfirstlane_b32 s3, v1
  v_and_b32 v1, 63, v0
  v_mov_b32 v8, 0
  v_mov_b32 v20, 0
  v_mov_b32 v251, 0
  v_mov_b32 v42, 0
  s_cmp_lt_u32 s2, 128
  s_cbranch_scc0 L_B
  v_lshlrev_b32 v38, 4, v1
  s_bfe_u32 s82, s2, 0x30003
  s_lshl_b32 s82, s82, 19
  s_lshl_b32 s97, s3, 16
  s_add_u32 s82, s82, s97
  s_and_b32 s97, s2, 7
  s_lshl_b32 s97, s97, 10
  s_add_u32 s82, s82, s97
  s_mov_b32 s42, 0x400000
  s_mov_b32 s43, 0x20000
  s_bitcmp1_b32 s2, 6
  s_cbranch_scc1 L_K
  v_and_b32 v8, 15, v1
  v_lshlrev_b32 v8, 3, v8
  v_lshrrev_b32 v3, 4, v1
  v_lshl_add_u32 v8, v3, 1, v8
  s_bfe_u32 s92, s2, 0x30003
  s_lshl_b32 s92, s92, 7
  v_add_u32 v17, s92, v8
  s_bfe_u32 s81, s2, 0x10004
  s_xor_b32 s81, s81, 1
  s_lshl_b32 s81, s81, 16
  s_and_b32 s92, s3, 1
  s_lshl_b32 s92, s92, 7
  v_xor_b32 v39, s92, v38
  s_lshl_b32 s83, s3, 13
  s_add_u32 s83, s83, s81
  s_lshl_b32 s92, s2, 17
  v_mov_b32 v18, s92
  v_mov_b32 v19, 0xf000
  s_waitcnt lgkmcnt(0)
  s_mov_b64 s[40:41], s[8:9]
  global_load_dwordx4 v[12:15], v38, s[4:5]
  global_load_ushort v16, v17, s[4:5]
  v_xor_b32 v40, 0, v39
  s_add_u32 m0, s83, 0
  s_add_u32 s92, s82, 0
  buffer_load_dwordx4 v40, s[40:43], s92 offen nt lds
  v_xor_b32 v41, 32, v39
  s_add_u32 m0, s83, 1024
  s_add_u32 s92, s82, 8192
  buffer_load_dwordx4 v41, s[40:43], s92 offen nt lds
  v_xor_b32 v40, 64, v39
  s_add_u32 m0, s83, 2048
  s_add_u32 s92, s82, 16384
  buffer_load_dwordx4 v40, s[40:43], s92 offen nt lds
  v_xor_b32 v41, 96, v39
  s_add_u32 m0, s83, 3072
  s_add_u32 s92, s82, 24576
  buffer_load_dwordx4 v41, s[40:43], s92 offen nt lds
  v_xor_b32 v40, 0, v39
  s_add_u32 m0, s83, 4096
  s_add_u32 s92, s82, 32768
  buffer_load_dwordx4 v40, s[40:43], s92 offen nt lds
  v_xor_b32 v41, 32, v39
  s_add_u32 m0, s83, 5120
  s_add_u32 s92, s82, 40960
  buffer_load_dwordx4 v41, s[40:43], s92 offen nt lds
  v_xor_b32 v40, 64, v39
  s_add_u32 m0, s83, 6144
  s_add_u32 s92, s82, 49152
  buffer_load_dwordx4 v40, s[40:43], s92 offen nt lds
  v_xor_b32 v41, 96, v39
  s_add_u32 m0, s83, 7168
  s_add_u32 s92, s82, 57344
  buffer_load_dwordx4 v41, s[40:43], s92 offen nt lds
  s_cmp_lg_u32 s3, 7
  s_cbranch_scc1 L_nt_1
  s_mov_b64 exec, 1
  global_load_dword v20, v18, s[6:7] nt
  global_load_dword v21, v19, s[32:33]
  global_load_dword v22, v38, s[30:31] offset:128
  s_mov_b64 exec, -1
L_nt_1:
  s_branch L_Q2
L_K:
  s_bfe_u32 s81, s2, 0x10004
  s_xor_b32 s81, s81, 1
  s_lshl_b32 s81, s81, 16
  s_and_b32 s92, s3, 1
  s_lshl_b32 s92, s92, 7
  v_xor_b32 v39, s92, v38
  s_lshl_b32 s83, s3, 13
  s_add_u32 s83, s83, s81
  v_mov_b32 v19, 0xf000
  s_waitcnt lgkmcnt(0)
  s_mov_b64 s[40:41], s[10:11]
  s_mov_b64 exec, 1
  global_load_dword v21, v19, s[32:33]
  s_mov_b64 exec, -1
  v_xor_b32 v40, 0, v39
  s_add_u32 m0, s83, 0
  s_add_u32 s92, s82, 0
  buffer_load_dwordx4 v40, s[40:43], s92 offen nt lds
  v_xor_b32 v41, 16, v39
  s_add_u32 m0, s83, 1024
  s_add_u32 s92, s82, 8192
  buffer_load_dwordx4 v41, s[40:43], s92 offen nt lds
  v_xor_b32 v40, 32, v39
  s_add_u32 m0, s83, 2048
  s_add_u32 s92, s82, 16384
  buffer_load_dwordx4 v40, s[40:43], s92 offen nt lds
  v_xor_b32 v41, 48, v39
  s_add_u32 m0, s83, 3072
  s_add_u32 s92, s82, 24576
  buffer_load_dwordx4 v41, s[40:43], s92 offen nt lds
  v_xor_b32 v40, 64, v39
  s_add_u32 m0, s83, 4096
  s_add_u32 s92, s82, 32768
  buffer_load_dwordx4 v40, s[40:43], s92 offen nt lds
  v_xor_b32 v41, 80, v39
  s_add_u32 m0, s83, 5120
  s_add_u32 s92, s82, 40960
  buffer_load_dwordx4 v41, s[40:43], s92 offen nt lds
  v_xor_b32 v40, 96, v39
  s_add_u32 m0, s83, 6144
  s_add_u32 s92, s82, 49152
  buffer_load_dwordx4 v40, s[40:43], s92 offen nt lds
  v_xor_b32 v41, 112, v39
  s_add_u32 m0, s83, 7168
  s_add_u32 s92, s82, 57344
  buffer_load_dwordx4 v41, s[40:43], s92 offen nt lds
  s_branch L_K2
L_B:
  s_cmp_ge_u32 s3, 4
  s_cbranch_scc0 L_Bfront
  v_lshrrev_b32 v10, 3, v1
  v_mul_u32_u24 v5, 24576, v10
  v_lshlrev_b32 v10, 3, v10
  v_and_b32 v11, 7, v1
  v_lshl_add_u32 v5, v11, 4, v5
  s_bfe_u32 s94, s2, 0x20004
  s_and_b32 s95, s2, 15
  s_lshl_b32 s92, s94, 2
  s_add_u32 s92, s92, s3
  s_sub_u32 s92, s92, 4
  s_lshl_b32 s93, s92, 6
  v_add_u32 v10, s93, v10
  s_mul_i32 s92, s92, 196608
  s_lshl_b32 s93, s95, 7
  s_add_u32 s92, s92, s93
  s_mov_b32 s42, 0x300000
  s_mov_b32 s43, 0x20000
  v_mov_b32 v253, 0
  s_waitcnt lgkmcnt(0)
  s_mov_b64 s[40:41], s[26:27]
  s_bitcmp1_b32 s2, 6
  s_cbranch_scc1 L_nou0
  global_load_dwordx2 v[112:113], v10, s[24:25]
  buffer_load_dwordx4 v[124:127], v5, s[40:43], s92 offen nt
  s_add_u32 s92, s92, 6144
  buffer_load_dwordx4 v[128:131], v5, s[40:43], s92 offen nt
  s_add_u32 s92, s92, 6144
  buffer_load_dwordx4 v[132:135], v5, s[40:43], s92 offen nt
  s_add_u32 s92, s92, 6144
  buffer_load_dwordx4 v[136:139], v5, s[40:43], s92 offen nt
L_nou0:
  s_branch L_Bback2
L_Bfront:
  s_memrealtime s[62:63]
  s_bfe_u32 s64, s2, 0x40003
  s_xor_b32 s64, s64, 8
  s_or_b32 s64, s64, s3
  s_cbranch_scc1 L_nononce
  v_mov_b32 v18, 0
  v_mov_b32 v21, 0
  s_waitcnt lgkmcnt(0)
  s_or_b32 s62, s62, 1
  v_mov_b32 v20, s62
  s_mov_b64 exec, 1
  global_atomic_cmpswap v18, v[20:21], s[30:31] sc1
  s_mov_b64 exec, -1
L_nononce:
  v_lshrrev_b32 v245, 4, v1
  v_and_b32 v246, 15, v1
  v_lshlrev_b32 v247, 2, v245
  v_xor_b32 v246, v246, v247
  v_lshlrev_b32 v246, 4, v246
  v_lshl_add_u32 v244, v245, 10, v246
  v_xor_b32 v245, 16, v244
  v_xor_b32 v246, 32, v244
  v_xor_b32 v247, 48, v244
  v_add_u32 v245, 3072, v245
  v_add_u32 v246, 6144, v246
  v_add_u32 v247, 9216, v247
  s_and_b32 s91, s3, 3
  s_lshl_b32 s90, s91, 15
  s_lshl_b32 s91, s91, 13
  s_lshl_b32 s92, s2, 17
  s_add_u32 s90, s90, s92
  s_bfe_u32 s93, s2, 0x20003
  s_lshl_b32 s92, s93, 15
  s_add_u32 s91, s91, s92
  s_lshl_b32 s92, s93, 8
  s_add_u32 s90, s90, s92
  s_getpc_b64 s[94:95]
L_pc:
  s_sub_u32 s94, s94, L_pc-adaLN_cond__compressed_kv_cla__glu_gated_geglu__decode_kernel
  s_subb_u32 s95, s95, 0
  s_bfe_u32 s92, s2, 0x40003
  s_lshl_b32 s92, s92, 2
  s_add_u32 s92, s92, s3
  s_lshl_b32 s92, s92, 10
  v_lshlrev_b32 v11, 4, v1
  v_add_u32 v11, s92, v11
  s_mov_b32 s38, 0x2000000
  s_mov_b32 s39, 0x20000
  s_cmp_ge_u32 s92, L_codeend-adaLN_cond__compressed_kv_cla__glu_gated_geglu__decode_kernel
  s_cbranch_scc1 L_nopf
  v_min_u32 v11, L_codeend-adaLN_cond__compressed_kv_cla__glu_gated_geglu__decode_kernel-16, v11
  global_load_dwordx4 v[12:15], v11, s[94:95]
L_nopf:
  s_waitcnt lgkmcnt(0)
  s_mov_b64 s[36:37], s[6:7]
  s_barrier
  s_barrier
  s_mov_b32 s54, 0x05040100
  s_mov_b32 s55, 0x07060302
  s_mov_b32 s56, 0x0c0c0400
  s_mov_b32 s57, 0x0c040100
  s_mov_b32 s58, 0x04020100
  s_mov_b32 s53, 0x10001
  v_mov_b32 v2, 0xffffff00
  s_lshr_b32 s77, s2, 5
  s_and_b32 s78, s2, 127
  s_and_b32 s76, s2, 7
  s_lshl_b32 s76, s76, 2
  s_bfe_u32 s97, s2, 0x20003
  s_add_u32 s76, s76, s97
  s_bfe_u32 s79, s2, 0x40003
  s_and_b32 s80, s2, 7
  s_bfe_u32 s17, s2, 0x20003
  s_bfe_u32 s59, s2, 0x10004
  s_lshl_b32 s59, s59, 14
  s_xor_b32 m0, s91, 0
  s_xor_b32 s101, s90, 0
  buffer_load_dwordx4 v244, s[36:39], s101 offen offset:0 nt lds
  s_waitcnt vmcnt(0)
  buffer_load_dwordx4 v245, s[36:39], s101 offen offset:1024 nt lds
  s_waitcnt vmcnt(0)
  buffer_load_dwordx4 v246, s[36:39], s101 offen offset:2048 nt lds
  s_waitcnt vmcnt(0)
  buffer_load_dwordx4 v247, s[36:39], s101 offen offset:3072 nt lds
  s_waitcnt vmcnt(2)
  s_xor_b32 m0, s91, 32768
  s_xor_b32 s101, s90, 256
  buffer_load_dwordx4 v244, s[36:39], s101 offen offset:0 nt lds
  s_waitcnt vmcnt(2)
  buffer_load_dwordx4 v245, s[36:39], s101 offen offset:1024 nt lds
  s_waitcnt vmcnt(2)
  buffer_load_dwordx4 v246, s[36:39], s101 offen offset:2048 nt lds
  s_waitcnt vmcnt(2)
  buffer_load_dwordx4 v247, s[36:39], s101 offen offset:3072 nt lds
  s_waitcnt vmcnt(2)
  s_xor_b32 m0, s91, 65536
  s_xor_b32 s101, s90, 512
  buffer_load_dwordx4 v244, s[36:39], s101 offen offset:0 nt lds
  buffer_load_dwordx4 v245, s[36:39], s101 offen offset:1024 nt lds
  buffer_load_dwordx4 v246, s[36:39], s101 offen offset:2048 nt lds
  buffer_load_dwordx4 v247, s[36:39], s101 offen offset:3072 nt lds
  v_mov_b32 v253, 0
  global_load_dword v252, v253, s[30:31] sc1
  s_barrier
  s_xor_b32 m0, s91, 98304
  s_xor_b32 s101, s90, 768
  buffer_load_dwordx4 v244, s[36:39], s101 offen offset:0 nt lds
  buffer_load_dwordx4 v245, s[36:39], s101 offen offset:1024 nt lds
  buffer_load_dwordx4 v246, s[36:39], s101 offen offset:2048 nt lds
  buffer_load_dwordx4 v247, s[36:39], s101 offen offset:3072 nt lds
  s_branch L_front
L_Q2:
  s_mov_b32 s54, 0x05040100
  s_mov_b32 s55, 0x07060302
  s_mov_b32 s56, 0x0c0c0400
  s_mov_b32 s57, 0x0c040100
  s_mov_b32 s58, 0x04020100
  s_mov_b32 s53, 0x10001
  v_mov_b32 v2, 0xffffff00
  s_lshr_b32 s77, s2, 5
  s_and_b32 s78, s2, 127
  s_and_b32 s76, s2, 7
  s_lshl_b32 s76, s76, 2
  s_bfe_u32 s97, s2, 0x20003
  s_add_u32 s76, s76, s97
  s_bfe_u32 s79, s2, 0x40003
  s_and_b32 s80, s2, 7
  s_bfe_u32 s17, s2, 0x20003
  s_bfe_u32 s59, s2, 0x10004
  s_lshl_b32 s59, s59, 14
  v_lshrrev_b32 v245, 4, v1
  v_and_b32 v246, 15, v1
  v_lshlrev_b32 v247, 2, v245
  v_xor_b32 v246, v246, v247
  v_lshlrev_b32 v246, 4, v246
  v_lshl_add_u32 v244, v245, 10, v246
  v_xor_b32 v245, 16, v244
  v_xor_b32 v246, 32, v244
  v_xor_b32 v247, 48, v244
  v_add_u32 v245, 3072, v245
  v_add_u32 v246, 6144, v246
  v_add_u32 v247, 9216, v247
  s_and_b32 s91, s3, 3
  s_lshl_b32 s90, s91, 15
  s_lshl_b32 s91, s91, 13
  s_lshl_b32 s92, s2, 17
  s_add_u32 s90, s90, s92
  s_bfe_u32 s93, s2, 0x20003
  s_lshl_b32 s92, s93, 15
  s_add_u32 s91, s91, s92
  s_lshl_b32 s92, s93, 8
  s_add_u32 s90, s90, s92
  s_mov_b64 s[36:37], s[6:7]
  s_mov_b32 s38, 0x2000000
  s_mov_b32 s39, 0x20000
  s_barrier
  s_lshr_b32 s92, s3, 2
  s_lshl_b32 s93, s92, 12
  s_xor_b32 s93, s93, 0
  s_xor_b32 m0, s91, s93
  s_lshl_b32 s93, s92, 14
  s_xor_b32 s93, s93, 0
  s_xor_b32 s101, s90, s93
  buffer_load_dwordx4 v244, s[36:39], s101 offen offset:0 nt lds
  buffer_load_dwordx4 v245, s[36:39], s101 offen offset:1024 nt lds
  buffer_load_dwordx4 v246, s[36:39], s101 offen offset:2048 nt lds
  buffer_load_dwordx4 v247, s[36:39], s101 offen offset:3072 nt lds
  s_bfe_u32 s82, s2, 0x30003
  s_lshl_b32 s82, s82, 10
  s_add_u32 s83, s82, 8192
  s_lshl_b32 s92, s3, 7
  s_add_u32 s92, s92, 0x20000
  v_add_u32 v40, s92, v8
  v_lshrrev_b32 v41, 4, v1
  v_lshlrev_b32 v41, 4, v41
  v_add_u32 v41, s92, v41
  s_lshl_b32 s92, s3, 7
  s_add_u32 s92, s92, s81
  v_lshrrev_b32 v44, 4, v1
  v_lshlrev_b32 v44, 13, v44
  v_bfe_u32 v3, v1, 2, 2
  v_lshl_add_u32 v44, v3, 10, v44
  v_and_b32 v3, 3, v1
  v_lshl_add_u32 v44, v3, 3, v44
  v_add_u32 v44, s92, v44
  v_bfe_u32 v45, v1, 2, 2
  v_lshlrev_b32 v45, 5, v45
  v_bfe_u32 v3, v1, 4, 1
  v_lshl_add_u32 v45, v3, 7, v45
  v_xor_b32 v44, v44, v45
  v_and_b32 v39, 3, v1
  v_lshlrev_b32 v39, 6, v39
  v_lshrrev_b32 v3, 4, v1
  v_lshl_add_u32 v39, v3, 4, v39
  s_and_b32 s85, s2, 7
  s_lshl_b32 s85, s85, 14
  s_bfe_u32 s97, s2, 0x30003
  s_lshl_b32 s97, s97, 11
  s_add_u32 s85, s85, s97
  s_lshl_b32 s97, s3, 8
  s_add_u32 s85, s85, s97
  s_add_u32 s85, s85, 0x80000
  s_mov_b32 s70, 0x20002
  s_mov_b32 s71, 0x20002
  s_mov_b32 s72, 0x40004
  s_mov_b32 s73, 0x40004
  s_mov_b32 s74, 0x80008
  s_mov_b32 s75, 0x80008
  s_waitcnt vmcnt(12)
  v_lshlrev_b32 v92, 16, v12
  v_and_b32 v93, 0xffff0000, v12
  v_lshlrev_b32 v94, 16, v13
  v_and_b32 v95, 0xffff0000, v13
  v_lshlrev_b32 v96, 16, v14
  v_and_b32 v97, 0xffff0000, v14
  v_lshlrev_b32 v98, 16, v15
  v_and_b32 v99, 0xffff0000, v15
  v_add_f32 v100, v92, v93
  v_add_f32 v100, v100, v94
  v_add_f32 v100, v100, v95
  v_add_f32 v100, v100, v96
  v_add_f32 v100, v100, v97
  v_add_f32 v100, v100, v98
  v_add_f32 v100, v100, v99
  s_nop 1
  v_add_f32_dpp v100, v100, v100 row_ror:8 row_mask:0xf bank_mask:0xf
  s_nop 1
  v_add_f32_dpp v100, v100, v100 row_ror:4 row_mask:0xf bank_mask:0xf
  s_nop 1
  v_add_f32_dpp v100, v100, v100 row_ror:2 row_mask:0xf bank_mask:0xf
  s_nop 1
  v_add_f32_dpp v100, v100, v100 row_ror:1 row_mask:0xf bank_mask:0xf
  v_mov_b32 v101, v100
  s_nop 1
  v_permlane16_swap_b32 v100, v101
  v_add_f32 v100, v100, v101
  v_mov_b32 v101, v100
  s_nop 1
  v_permlane32_swap_b32 v100, v101
  v_add_f32 v100, v100, v101
  v_mul_f32 v100, 0x3b000000, v100
  v_sub_f32 v92, v92, v100
  v_sub_f32 v93, v93, v100
  v_sub_f32 v94, v94, v100
  v_sub_f32 v95, v95, v100
  v_sub_f32 v96, v96, v100
  v_sub_f32 v97, v97, v100
  v_sub_f32 v98, v98, v100
  v_sub_f32 v99, v99, v100
  v_mul_f32 v102, v92, v92
  v_fmac_f32 v102, v93, v93
  v_fmac_f32 v102, v94, v94
  v_fmac_f32 v102, v95, v95
  v_fmac_f32 v102, v96, v96
  v_fmac_f32 v102, v97, v97
  v_fmac_f32 v102, v98, v98
  v_fmac_f32 v102, v99, v99
  s_nop 1
  v_add_f32_dpp v102, v102, v102 row_ror:8 row_mask:0xf bank_mask:0xf
  s_nop 1
  v_add_f32_dpp v102, v102, v102 row_ror:4 row_mask:0xf bank_mask:0xf
  s_nop 1
  v_add_f32_dpp v102, v102, v102 row_ror:2 row_mask:0xf bank_mask:0xf
  s_nop 1
  v_add_f32_dpp v102, v102, v102 row_ror:1 row_mask:0xf bank_mask:0xf
  v_mov_b32 v101, v102
  s_nop 1
  v_permlane16_swap_b32 v102, v101
  v_add_f32 v102, v102, v101
  v_mov_b32 v101, v102
  s_nop 1
  v_permlane32_swap_b32 v102, v101
  v_add_f32 v102, v102, v101
  v_mul_f32 v102, 0x3b000000, v102
  v_cvt_pk_bf16_f32 v101, v100, v100
  v_and_b32 v100, 0xffff0000, v101
  v_cvt_pk_bf16_f32 v101, v102, v102
  v_and_b32 v102, 0xffff0000, v101
  v_add_f32 v102, 0x3727c5ac, v102
  v_cvt_pk_bf16_f32 v101, v102, v102
  v_and_b32 v102, 0xffff0000, v101
  v_sqrt_f32 v102, v102
  s_nop 0
  v_cvt_pk_bf16_f32 v101, v102, v102
  v_and_b32 v102, 0xffff0000, v101
  v_rcp_f32 v102, v102
  v_lshlrev_b32 v103, 16, v16
  v_sub_f32 v103, v103, v100
  v_cvt_pk_bf16_f32 v101, v103, v103
  v_and_b32 v103, 0xffff0000, v101
  v_mul_f32 v103, v103, v102
  v_cvt_pk_bf16_f32 v101, v103, v103
  v_and_b32 v103, 0xffff0000, v101
  v_mov_b32 v253, 0
  global_load_dword v252, v253, s[30:31] sc1
  buffer_load_dwordx4 v[20:23], v38, s[32:35], s82 offen offset:0 sc1
  buffer_load_dwordx4 v[24:27], v38, s[32:35], s83 offen offset:0 sc1
  s_waitcnt vmcnt(7)
  s_barrier
  v_xor_b32 v46, 0, v44
  ds_read_b64_tr_b16 v[112:113], v46 offset:0
  ds_read_b64_tr_b16 v[114:115], v46 offset:4096
  ds_read_b64_tr_b16 v[116:117], v46 offset:32768
  ds_read_b64_tr_b16 v[118:119], v46 offset:36864
  v_xor_b32 v47, 32, v44
  ds_read_b64_tr_b16 v[120:121], v47 offset:0
  ds_read_b64_tr_b16 v[122:123], v47 offset:4096
  ds_read_b64_tr_b16 v[124:125], v47 offset:32768
  ds_read_b64_tr_b16 v[126:127], v47 offset:36864
  v_xor_b32 v46, 64, v44
  ds_read_b64_tr_b16 v[128:129], v46 offset:0
  ds_read_b64_tr_b16 v[130:131], v46 offset:4096
  ds_read_b64_tr_b16 v[132:133], v46 offset:32768
  ds_read_b64_tr_b16 v[134:135], v46 offset:36864
  s_waitcnt lgkmcnt(4)
  v_xor_b32 v47, 96, v44
  ds_read_b64_tr_b16 v[136:137], v47 offset:0
  ds_read_b64_tr_b16 v[138:139], v47 offset:4096
  ds_read_b64_tr_b16 v[140:141], v47 offset:32768
  ds_read_b64_tr_b16 v[142:143], v47 offset:36864
  s_mov_b32 s100, 0
  s_waitcnt vmcnt(2)
  s_branch L_epc_3
L_ep_2:
  global_load_dword v252, v253, s[30:31] sc1
  s_add_u32 s100, s100, 1
  s_cmp_gt_u32 s100, 100000
  s_cbranch_scc1 L_abort
  s_waitcnt vmcnt(0)
L_epc_3:
  v_readfirstlane_b32 s48, v252
  s_nop 0
  s_cmp_eq_u32 s48, 0
  s_nop 1
  s_cbranch_scc1 L_ep_2
  s_mul_i32 s48, s48, 0x9e3779b1
  s_and_b32 s49, s48, 0xff
  s_bfe_u32 s50, s48, 0x80008
  s_bfe_u32 s51, s48, 0x80010
  s_lshr_b32 s52, s48, 24
  s_lshr_b32 s97, s48, 15
  s_xor_b32 s97, s97, s48
  s_mul_i32 s97, s97, 0x85ebca6b
  v_mov_b32 v4, s48
  v_mov_b32 v5, s97
  v_mov_b32 v249, s48
  v_mov_b32 v250, s97
  v_and_b32 v6, 4, v1
  v_cmp_eq_u32 vcc, 0, v6
  v_and_b32 v7, 3, v1
  v_lshlrev_b32 v7, 2, v7
  v_cndmask_b32 v4, v5, v4, vcc
  v_lshrrev_b32 v4, v7, v4
  v_lshrrev_b32 v5, 1, v4
  v_lshrrev_b32 v6, 2, v4
  v_lshrrev_b32 v7, 3, v4
  s_waitcnt lgkmcnt(0)
  s_barrier
  s_mov_b64 s[60:61], -1
  s_waitcnt vmcnt(0)
  s_mov_b32 s100, 0
  s_branch L_gc_6
L_g_4:
  s_add_u32 s100, s100, 1
  s_cmp_gt_u32 s100, 100000
  s_cbranch_scc1 L_abort
  s_sleep 2
L_gf_5:
  s_mov_b64 exec, s[60:61]
  buffer_load_dwordx4 v[20:23], v38, s[32:35], s82 offen offset:0 sc1
  buffer_load_dwordx4 v[24:27], v38, s[32:35], s83 offen offset:0 sc1
  s_waitcnt vmcnt(0)
L_gc_6:
  s_mov_b64 exec, s[60:61]
  v_perm_b32 v92, v21, v20, s56
  v_perm_b32 v92, v22, v92, s57
  v_perm_b32 v92, v23, v92, s58
  v_cmp_ne_u32 s[60:61], s48, v92
  v_perm_b32 v92, v25, v24, s56
  v_perm_b32 v92, v26, v92, s57
  v_perm_b32 v92, v27, v92, s58
  v_cmp_ne_u32 vcc, s48, v92
  s_nop 0
  s_or_b64 s[60:61], s[60:61], vcc
  s_cmp_lg_u64 s[60:61], 0
  s_cbranch_scc1 L_g_4
  s_mov_b64 exec, -1
  v_permlane32_swap_b32 v20, v22
  v_permlane32_swap_b32 v21, v23
  v_permlane32_swap_b32 v24, v26
  v_permlane32_swap_b32 v25, v27
  v_add_f32 v20, v20, v22
  v_add_f32 v21, v21, v23
  v_add_f32 v24, v24, v26
  v_add_f32 v25, v25, v27
  v_permlane16_swap_b32 v20, v21
  s_nop 0
  v_permlane16_swap_b32 v24, v25
  v_add_f32 v20, v20, v21
  v_add_f32 v24, v24, v25
  v_cvt_pk_bf16_f32 v25, v24, v24
  v_and_b32 v24, 0xffff0000, v25
  v_cvt_pk_bf16_f32 v21, v20, v20
  v_and_b32 v20, 0xffff0000, v21
  v_add_f32 v24, 1.0, v24
  v_cvt_pk_bf16_f32 v25, v24, v24
  v_and_b32 v24, 0xffff0000, v25
  v_mul_f32 v24, v103, v24
  v_cvt_pk_bf16_f32 v25, v24, v24
  v_and_b32 v24, 0xffff0000, v25
  v_add_f32 v24, v24, v20
  v_cvt_pk_bf16_f32 v24, v24, v24
  ds_write_b16 v40, v24
  ds_read_b128 v[28:31], v41
  ds_read_b128 v[32:35], v41 offset:64
  s_waitcnt lgkmcnt(1)
  v_mfma_f32_16x16x32_bf16 v[80:83], v[112:115], v[28:31], 0
  v_mfma_f32_16x16x32_bf16 v[84:87], v[120:123], v[28:31], 0
  v_mfma_f32_16x16x32_bf16 v[88:91], v[128:131], v[28:31], 0
  v_mfma_f32_16x16x32_bf16 v[92:95], v[136:139], v[28:31], 0
  s_waitcnt lgkmcnt(0)
  v_mfma_f32_16x16x32_bf16 v[80:83], v[116:119], v[32:35], v[80:83]
  v_mfma_f32_16x16x32_bf16 v[84:87], v[124:127], v[32:35], v[84:87]
  v_mfma_f32_16x16x32_bf16 v[88:91], v[132:135], v[32:35], v[88:91]
  v_mfma_f32_16x16x32_bf16 v[92:95], v[140:143], v[32:35], v[92:95]
  s_nop 5
  v_cndmask_b32 v80, v80, v84, s[70:71]
  v_cndmask_b32 v81, v81, v85, s[70:71]
  v_cndmask_b32 v82, v82, v86, s[70:71]
  v_cndmask_b32 v83, v83, v87, s[70:71]
  v_cndmask_b32 v80, v80, v88, s[72:73]
  v_cndmask_b32 v81, v81, v89, s[72:73]
  v_cndmask_b32 v82, v82, v90, s[72:73]
  v_cndmask_b32 v83, v83, v91, s[72:73]
  v_cndmask_b32 v80, v80, v92, s[74:75]
  v_cndmask_b32 v81, v81, v93, s[74:75]
  v_cndmask_b32 v82, v82, v94, s[74:75]
  v_cndmask_b32 v83, v83, v95, s[74:75]
  v_and_or_b32 v80, v80, v2, s49
  v_and_or_b32 v81, v81, v2, s50
  v_and_or_b32 v82, v82, v2, s51
  v_and_or_b32 v83, v83, v2, s52
  s_mov_b32 exec_lo, 0xf000f
  s_mov_b32 exec_hi, 0xf000f
  buffer_store_dwordx4 v[80:83], v39, s[32:35], s85 offen
  s_add_u32 s97, s85, 0x100000
  buffer_store_dwordx4 v[80:83], v39, s[32:35], s97 offen sc1
  s_mov_b64 exec, -1
  s_barrier
  s_lshr_b32 s92, s3, 2
  s_lshl_b32 s93, s92, 12
  s_xor_b32 s93, s93, 32768
  s_xor_b32 m0, s91, s93
  s_lshl_b32 s93, s92, 14
  s_xor_b32 s93, s93, 256
  s_xor_b32 s101, s90, s93
  buffer_load_dwordx4 v244, s[36:39], s101 offen offset:0 nt lds
  buffer_load_dwordx4 v245, s[36:39], s101 offen offset:1024 nt lds
  buffer_load_dwordx4 v246, s[36:39], s101 offen offset:2048 nt lds
  buffer_load_dwordx4 v247, s[36:39], s101 offen offset:3072 nt lds
  s_lshr_b32 s92, s3, 2
  s_lshl_b32 s93, s92, 12
  s_xor_b32 s93, s93, 65536
  s_xor_b32 m0, s91, s93
  s_lshl_b32 s93, s92, 14
  s_xor_b32 s93, s93, 512
  s_xor_b32 s101, s90, s93
  buffer_load_dwordx4 v244, s[36:39], s101 offen offset:0 nt lds
  buffer_load_dwordx4 v245, s[36:39], s101 offen offset:1024 nt lds
  buffer_load_dwordx4 v246, s[36:39], s101 offen offset:2048 nt lds
  buffer_load_dwordx4 v247, s[36:39], s101 offen offset:3072 nt lds
  s_cmp_ge_u32 s3, 4
  s_cbranch_scc1 L_back
  s_barrier
  s_xor_b32 m0, s91, 98304
  s_xor_b32 s101, s90, 768
  buffer_load_dwordx4 v244, s[36:39], s101 offen offset:0 nt lds
  buffer_load_dwordx4 v245, s[36:39], s101 offen offset:1024 nt lds
  buffer_load_dwordx4 v246, s[36:39], s101 offen offset:2048 nt lds
  buffer_load_dwordx4 v247, s[36:39], s101 offen offset:3072 nt lds
  s_branch L_setup
L_K2:
  s_mov_b32 s54, 0x05040100
  s_mov_b32 s55, 0x07060302
  s_mov_b32 s56, 0x0c0c0400
  s_mov_b32 s57, 0x0c040100
  s_mov_b32 s58, 0x04020100
  s_mov_b32 s53, 0x10001
  v_mov_b32 v2, 0xffffff00
  s_lshr_b32 s77, s2, 5
  s_and_b32 s78, s2, 127
  s_and_b32 s76, s2, 7
  s_lshl_b32 s76, s76, 2
  s_bfe_u32 s97, s2, 0x20003
  s_add_u32 s76, s76, s97
  s_bfe_u32 s79, s2, 0x40003
  s_and_b32 s80, s2, 7
  s_bfe_u32 s17, s2, 0x20003
  s_bfe_u32 s59, s2, 0x10004
  s_lshl_b32 s59, s59, 14
  v_lshrrev_b32 v245, 4, v1
  v_and_b32 v246, 15, v1
  v_lshlrev_b32 v247, 2, v245
  v_xor_b32 v246, v246, v247
  v_lshlrev_b32 v246, 4, v246
  v_lshl_add_u32 v244, v245, 10, v246
  v_xor_b32 v245, 16, v244
  v_xor_b32 v246, 32, v244
  v_xor_b32 v247, 48, v244
  v_add_u32 v245, 3072, v245
  v_add_u32 v246, 6144, v246
  v_add_u32 v247, 9216, v247
  s_and_b32 s91, s3, 3
  s_lshl_b32 s90, s91, 15
  s_lshl_b32 s91, s91, 13
  s_lshl_b32 s92, s2, 17
  s_add_u32 s90, s90, s92
  s_bfe_u32 s93, s2, 0x20003
  s_lshl_b32 s92, s93, 15
  s_add_u32 s91, s91, s92
  s_lshl_b32 s92, s93, 8
  s_add_u32 s90, s90, s92
  s_mov_b64 s[36:37], s[6:7]
  s_mov_b32 s38, 0x2000000
  s_mov_b32 s39, 0x20000
  s_barrier
  s_lshr_b32 s92, s3, 2
  s_lshl_b32 s93, s92, 12
  s_xor_b32 s93, s93, 0
  s_xor_b32 m0, s91, s93
  s_lshl_b32 s93, s92, 14
  s_xor_b32 s93, s93, 0
  s_xor_b32 s101, s90, s93
  buffer_load_dwordx4 v244, s[36:39], s101 offen offset:0 nt lds
  buffer_load_dwordx4 v245, s[36:39], s101 offen offset:1024 nt lds
  buffer_load_dwordx4 v246, s[36:39], s101 offen offset:2048 nt lds
  buffer_load_dwordx4 v247, s[36:39], s101 offen offset:3072 nt lds
  s_lshr_b32 s92, s3, 2
  s_lshl_b32 s93, s92, 12
  s_xor_b32 s93, s93, 32768
  s_xor_b32 m0, s91, s93
  s_lshl_b32 s93, s92, 14
  s_xor_b32 s93, s93, 256
  s_xor_b32 s101, s90, s93
  buffer_load_dwordx4 v244, s[36:39], s101 offen offset:0 nt lds
  buffer_load_dwordx4 v245, s[36:39], s101 offen offset:1024 nt lds
  buffer_load_dwordx4 v246, s[36:39], s101 offen offset:2048 nt lds
  buffer_load_dwordx4 v247, s[36:39], s101 offen offset:3072 nt lds
  s_and_b32 s92, s3, 1
  s_lshl_b32 s92, s92, 15
  s_lshr_b32 s97, s3, 1
  s_lshl_b32 s97, s97, 8
  s_add_u32 s92, s92, s97
  s_add_u32 s92, s92, s81
  v_and_b32 v45, 15, v1
  v_mul_u32_u24 v45, 1040, v45
  v_add_u32 v45, s92, v45
  v_lshrrev_b32 v34, 4, v1
  v_lshlrev_b32 v34, 4, v34
  v_xor_b32 v45, v45, v34
  v_lshrrev_b32 v37, 4, v1
  v_lshlrev_b32 v37, 11, v37
  v_and_b32 v3, 15, v1
  v_lshl_add_u32 v37, v3, 4, v37
  s_and_b32 s83, s2, 7
  s_lshl_b32 s83, s83, 14
  s_lshl_b32 s97, s3, 8
  s_add_u32 s83, s83, s97
  s_add_u32 s83, s83, 0x80000
  s_add_u32 s85, s83, 8192
  s_lshl_b32 s92, s3, 7
  s_add_u32 s92, s92, 0x21000
  v_and_b32 v47, 15, v1
  v_lshlrev_b32 v47, 3, v47
  v_lshrrev_b32 v3, 4, v1
  v_lshl_add_u32 v47, v3, 1, v47
  v_add_u32 v47, s92, v47
  s_lshr_b32 s92, s3, 1
  s_lshl_b32 s92, s92, 8
  s_add_u32 s92, s92, 0x21000
  v_lshrrev_b32 v35, 4, v1
  v_lshlrev_b32 v35, 4, v35
  v_add_u32 v35, s92, v35
  v_bfe_u32 v39, v1, 4, 1
  v_lshlrev_b32 v39, 5, v39
  v_lshrrev_b32 v3, 5, v1
  v_lshl_add_u32 v39, v3, 4, v39
  s_and_b32 s84, s2, 7
  s_lshl_b32 s84, s84, 12
  s_lshr_b32 s97, s3, 1
  s_lshl_b32 s97, s97, 10
  s_add_u32 s84, s84, s97
  s_bfe_u32 s97, s2, 0x30003
  s_lshl_b32 s97, s97, 7
  s_add_u32 s84, s84, s97
  s_and_b32 s97, s3, 1
  s_lshl_b32 s97, s97, 6
  s_add_u32 s84, s84, s97
  s_add_u32 s84, s84, 0x10000
  s_waitcnt vmcnt(8)
  s_barrier
  v_xor_b32 v32, 0, v45
  ds_read_b128 v[112:115], v32 offset:0
  v_xor_b32 v33, 64, v45
  ds_read_b128 v[116:119], v33 offset:0
  v_xor_b32 v32, 128, v45
  ds_read_b128 v[120:123], v32 offset:0
  v_xor_b32 v33, 192, v45
  ds_read_b128 v[124:127], v33 offset:0
  v_xor_b32 v32, 0, v45
  ds_read_b128 v[128:131], v32 offset:16384
  v_xor_b32 v33, 64, v45
  ds_read_b128 v[132:135], v33 offset:16384
  v_xor_b32 v32, 128, v45
  ds_read_b128 v[136:139], v32 offset:16384
  v_xor_b32 v33, 192, v45
  ds_read_b128 v[140:143], v33 offset:16384
  s_waitcnt lgkmcnt(0)
  s_barrier
  s_mov_b32 s100, 0
  v_mov_b32 v253, 0
L_ep_8:
  global_load_dword v252, v253, s[30:31] sc1
  s_add_u32 s100, s100, 1
  s_cmp_gt_u32 s100, 100000
  s_cbranch_scc1 L_abort
  s_waitcnt vmcnt(0)
L_epc_9:
  v_readfirstlane_b32 s48, v252
  s_nop 0
  s_cmp_eq_u32 s48, 0
  s_nop 1
  s_cbranch_scc1 L_ep_8
  s_mul_i32 s48, s48, 0x9e3779b1
  s_and_b32 s49, s48, 0xff
  s_bfe_u32 s50, s48, 0x80008
  s_bfe_u32 s51, s48, 0x80010
  s_lshr_b32 s52, s48, 24
  s_lshr_b32 s97, s48, 15
  s_xor_b32 s97, s97, s48
  s_mul_i32 s97, s97, 0x85ebca6b
  v_mov_b32 v4, s48
  v_mov_b32 v5, s97
  v_mov_b32 v249, s48
  v_mov_b32 v250, s97
  v_and_b32 v6, 4, v1
  v_cmp_eq_u32 vcc, 0, v6
  v_and_b32 v7, 3, v1
  v_lshlrev_b32 v7, 2, v7
  v_cndmask_b32 v4, v5, v4, vcc
  v_lshrrev_b32 v4, v7, v4
  v_lshrrev_b32 v5, 1, v4
  v_lshrrev_b32 v6, 2, v4
  v_lshrrev_b32 v7, 3, v4
  s_and_b32 s92, s3, 1
  s_sub_u32 s74, 0, s92
  s_mov_b32 s75, s74
  v_bfe_u32 v28, v1, 4, 1
  v_lshlrev_b32 v28, 3, v28
  v_lshrrev_b32 v3, 5, v1
  v_lshl_add_u32 v28, v3, 2, v28
  v_mov_b32 v68, s48
  v_mov_b32 v69, s97
  v_cndmask_b32 v68, v68, v69, s[74:75]
  v_lshrrev_b32 v68, v28, v68
  v_lshrrev_b32 v69, 1, v68
  v_lshrrev_b32 v70, 2, v68
  v_lshrrev_b32 v71, 3, v68
  s_mov_b64 s[60:61], -1
  s_mov_b64 s[62:63], -1
  s_mov_b32 s100, 0
  s_branch L_gf_11
L_g_10:
  s_add_u32 s100, s100, 1
  s_cmp_gt_u32 s100, 100000
  s_cbranch_scc1 L_abort
  s_sleep 1
  s_cmp_lg_u32 s100, 40
  s_cbranch_scc1 L_alt_13
  s_add_u32 s83, s83, 0x100000
  s_add_u32 s85, s85, 0x100000
L_alt_13:
L_gf_11:
  s_mov_b64 exec, s[60:61]
  s_cbranch_execz L_gs_14
  buffer_load_dwordx4 v[20:23], v37, s[32:35], s83 offen offset:0 sc1
L_gs_14:
  s_mov_b64 exec, s[62:63]
  s_cbranch_execz L_gs_15
  buffer_load_dwordx4 v[24:27], v37, s[32:35], s85 offen offset:0 sc1
L_gs_15:
  s_waitcnt vmcnt(0)
L_gc_12:
  s_mov_b64 exec, s[60:61]
  v_perm_b32 v92, v21, v20, s56
  v_perm_b32 v92, v22, v92, s57
  v_perm_b32 v92, v23, v92, s58
  v_cmp_ne_u32 s[60:61], s48, v92
  s_mov_b64 exec, s[62:63]
  v_perm_b32 v92, v25, v24, s56
  v_perm_b32 v92, v26, v92, s57
  v_perm_b32 v92, v27, v92, s58
  v_cmp_ne_u32 s[62:63], s48, v92
  s_nop 0
  s_or_b64 s[96:97], s[60:61], s[62:63]
  s_cbranch_scc1 L_g_10
  s_mov_b64 exec, -1
  v_add_f32 v20, v20, v24
  v_add_f32 v21, v21, v25
  v_add_f32 v22, v22, v26
  v_add_f32 v23, v23, v27
  s_nop 0
  v_permlane32_swap_b32 v20, v22
  v_permlane32_swap_b32 v21, v23
  v_add_f32 v20, v20, v22
  v_add_f32 v21, v21, v23
  s_nop 1
  v_permlane16_swap_b32 v20, v21
  v_add_f32 v20, v20, v21
  v_cvt_pk_bf16_f32 v20, v20, v20
  ds_write_b16 v47, v20
  s_waitcnt lgkmcnt(0)
  s_barrier
  ds_read_b128 v[52:55], v35 offset:0
  ds_read_b128 v[56:59], v35 offset:64
  ds_read_b128 v[60:63], v35 offset:128
  ds_read_b128 v[64:67], v35 offset:192
  s_waitcnt lgkmcnt(3)
  v_mfma_f32_16x16x32_bf16 v[80:83], v[112:115], v[52:55], 0
  v_mfma_f32_16x16x32_bf16 v[84:87], v[128:131], v[52:55], 0
  s_waitcnt lgkmcnt(2)
  v_mfma_f32_16x16x32_bf16 v[80:83], v[116:119], v[56:59], v[80:83]
  v_mfma_f32_16x16x32_bf16 v[84:87], v[132:135], v[56:59], v[84:87]
  s_waitcnt lgkmcnt(1)
  v_mfma_f32_16x16x32_bf16 v[80:83], v[120:123], v[60:63], v[80:83]
  v_mfma_f32_16x16x32_bf16 v[84:87], v[136:139], v[60:63], v[84:87]
  s_waitcnt lgkmcnt(0)
  v_mfma_f32_16x16x32_bf16 v[80:83], v[124:127], v[64:67], v[80:83]
  v_mfma_f32_16x16x32_bf16 v[84:87], v[140:143], v[64:67], v[84:87]
  s_nop 6
  v_mul_f32 v80, 0x3e0293ee, v80
  v_mul_f32 v81, 0x3e0293ee, v81
  v_mul_f32 v82, 0x3e0293ee, v82
  v_mul_f32 v83, 0x3e0293ee, v83
  v_mul_f32 v84, 0x3e0293ee, v84
  v_mul_f32 v85, 0x3e0293ee, v85
  v_mul_f32 v86, 0x3e0293ee, v86
  v_mul_f32 v87, 0x3e0293ee, v87
  v_cvt_pk_bf16_f32 v20, v80, v81
  v_cvt_pk_bf16_f32 v21, v82, v83
  v_cvt_pk_bf16_f32 v22, v84, v85
  v_cvt_pk_bf16_f32 v23, v86, v87
  s_nop 0
  v_permlane16_swap_b32 v20, v22
  v_permlane16_swap_b32 v21, v23
  v_bfi_b32 v20, s53, v68, v20
  v_bfi_b32 v21, s53, v69, v21
  v_bfi_b32 v22, s53, v70, v22
  v_bfi_b32 v23, s53, v71, v23
  s_mov_b32 exec_lo, 0x10001
  s_mov_b32 exec_hi, 0x10001
  buffer_store_dwordx4 v[20:23], v39, s[32:35], s84 offen sc1
  s_mov_b64 exec, -1
  s_barrier
  s_lshr_b32 s92, s3, 2
  s_lshl_b32 s93, s92, 12
  s_xor_b32 s93, s93, 65536
  s_xor_b32 m0, s91, s93
  s_lshl_b32 s93, s92, 14
  s_xor_b32 s93, s93, 512
  s_xor_b32 s101, s90, s93
  buffer_load_dwordx4 v244, s[36:39], s101 offen offset:0 nt lds
  buffer_load_dwordx4 v245, s[36:39], s101 offen offset:1024 nt lds
  buffer_load_dwordx4 v246, s[36:39], s101 offen offset:2048 nt lds
  buffer_load_dwordx4 v247, s[36:39], s101 offen offset:3072 nt lds
  s_cmp_ge_u32 s3, 4
  s_cbranch_scc0 L_kf
  s_branch L_back
L_kf:
  s_xor_b32 m0, s91, 98304
  s_xor_b32 s101, s90, 768
  buffer_load_dwordx4 v244, s[36:39], s101 offen offset:0 nt lds
  buffer_load_dwordx4 v245, s[36:39], s101 offen offset:1024 nt lds
  buffer_load_dwordx4 v246, s[36:39], s101 offen offset:2048 nt lds
  buffer_load_dwordx4 v247, s[36:39], s101 offen offset:3072 nt lds
  s_barrier
  s_branch L_setup
L_Bback2:
  s_mov_b32 s54, 0x05040100
  s_mov_b32 s55, 0x07060302
  s_mov_b32 s56, 0x0c0c0400
  s_mov_b32 s57, 0x0c040100
  s_mov_b32 s58, 0x04020100
  s_mov_b32 s53, 0x10001
  v_mov_b32 v2, 0xffffff00
  s_lshr_b32 s77, s2, 5
  s_and_b32 s78, s2, 127
  s_and_b32 s76, s2, 7
  s_lshl_b32 s76, s76, 2
  s_bfe_u32 s97, s2, 0x20003
  s_add_u32 s76, s76, s97
  s_bfe_u32 s79, s2, 0x40003
  s_and_b32 s80, s2, 7
  s_bfe_u32 s17, s2, 0x20003
  s_bfe_u32 s59, s2, 0x10004
  s_lshl_b32 s59, s59, 14
  s_lshl_b32 s81, s95, 2
  s_add_u32 s81, s81, s94
  s_lshl_b32 s81, s81, 8
  s_add_u32 s81, s81, 0
  v_and_b32 v8, 7, v1
  v_lshlrev_b32 v8, 2, v8
  v_lshrrev_b32 v9, 4, v1
  v_add_u32 v8, v8, v9
  v_lshlrev_b32 v8, 5, v8
  s_lshl_b32 s92, s3, 2
  s_add_u32 s92, s92, 139248
  v_add_u32 v8, s92, v8
  v_lshlrev_b32 v9, 6, v1
  v_add_u32 v9, 139264, v9
  v_lshlrev_b32 v10, 4, v1
  s_bitcmp1_b32 s2, 6
  s_cbranch_scc1 L_nou0b
  s_waitcnt vmcnt(4)
  v_mov_b32 v253, 0
  global_load_dword v252, v253, s[30:31] sc1
  v_lshlrev_b32 v120, 16, v112
  v_and_b32 v121, 0xffff0000, v112
  v_lshlrev_b32 v122, 16, v113
  v_and_b32 v123, 0xffff0000, v113
  v_mul_f32 v116, 0xbfb8aa3b, v120
  v_mul_f32 v117, 0xbfb8aa3b, v121
  v_mul_f32 v118, 0xbfb8aa3b, v122
  v_mul_f32 v119, 0xbfb8aa3b, v123
  v_exp_f32 v116, v116
  v_exp_f32 v117, v117
  v_exp_f32 v118, v118
  v_exp_f32 v119, v119
  v_add_f32 v116, 1.0, v116
  v_add_f32 v117, 1.0, v117
  v_add_f32 v118, 1.0, v118
  v_add_f32 v119, 1.0, v119
  v_rcp_f32 v116, v116
  v_rcp_f32 v117, v117
  v_rcp_f32 v118, v118
  v_rcp_f32 v119, v119
  v_mul_f32 v120, v120, v116
  v_mul_f32 v121, v121, v117
  v_mul_f32 v122, v122, v118
  v_mul_f32 v123, v123, v119
  v_cvt_pk_bf16_f32 v120, v120, v120
  v_cvt_pk_bf16_f32 v121, v121, v121
  v_cvt_pk_bf16_f32 v122, v122, v122
  v_cvt_pk_bf16_f32 v123, v123, v123
  v_lshrrev_b32 v116, 16, v120
  v_lshrrev_b32 v117, 16, v121
  v_lshrrev_b32 v118, 16, v122
  v_lshrrev_b32 v119, 16, v123
  v_and_b32 v120, 0xffff0000, v120
  v_and_b32 v121, 0xffff0000, v121
  v_and_b32 v122, 0xffff0000, v122
  v_and_b32 v123, 0xffff0000, v123
  v_mov_b32 v96, 0
  v_mov_b32 v97, 0
  v_mov_b32 v98, 0
  v_mov_b32 v99, 0
  v_mov_b32 v100, 0
  v_mov_b32 v101, 0
  v_mov_b32 v102, 0
  v_mov_b32 v103, 0
  s_waitcnt vmcnt(4)
  v_dot2c_f32_bf16 v96, v116, v124
  v_dot2c_f32_bf16 v97, v120, v124
  v_dot2c_f32_bf16 v98, v116, v125
  v_dot2c_f32_bf16 v99, v120, v125
  v_dot2c_f32_bf16 v100, v116, v126
  v_dot2c_f32_bf16 v101, v120, v126
  v_dot2c_f32_bf16 v102, v116, v127
  v_dot2c_f32_bf16 v103, v120, v127
  s_waitcnt vmcnt(3)
  v_dot2c_f32_bf16 v96, v117, v128
  v_dot2c_f32_bf16 v97, v121, v128
  v_dot2c_f32_bf16 v98, v117, v129
  v_dot2c_f32_bf16 v99, v121, v129
  v_dot2c_f32_bf16 v100, v117, v130
  v_dot2c_f32_bf16 v101, v121, v130
  v_dot2c_f32_bf16 v102, v117, v131
  v_dot2c_f32_bf16 v103, v121, v131
  s_waitcnt vmcnt(2)
  v_dot2c_f32_bf16 v96, v118, v132
  v_dot2c_f32_bf16 v97, v122, v132
  v_dot2c_f32_bf16 v98, v118, v133
  v_dot2c_f32_bf16 v99, v122, v133
  v_dot2c_f32_bf16 v100, v118, v134
  v_dot2c_f32_bf16 v101, v122, v134
  v_dot2c_f32_bf16 v102, v118, v135
  v_dot2c_f32_bf16 v103, v122, v135
  s_waitcnt vmcnt(1)
  v_dot2c_f32_bf16 v96, v119, v136
  v_dot2c_f32_bf16 v97, v123, v136
  v_dot2c_f32_bf16 v98, v119, v137
  v_dot2c_f32_bf16 v99, v123, v137
  v_dot2c_f32_bf16 v100, v119, v138
  v_dot2c_f32_bf16 v101, v123, v138
  v_dot2c_f32_bf16 v102, v119, v139
  v_dot2c_f32_bf16 v103, v123, v139
  v_permlane32_swap_b32 v96, v100
  v_permlane32_swap_b32 v97, v101
  v_permlane32_swap_b32 v98, v102
  v_permlane32_swap_b32 v99, v103
  v_add_f32 v96, v96, v100
  v_add_f32 v97, v97, v101
  v_add_f32 v98, v98, v102
  v_add_f32 v99, v99, v103
  s_nop 0
  v_permlane16_swap_b32 v96, v98
  v_permlane16_swap_b32 v97, v99
  v_add_f32 v96, v96, v98
  v_add_f32 v97, v97, v99
  s_nop 0
  v_add_f32_dpp v96, v96, v96 row_ror:8 row_mask:0xf bank_mask:0xf
  v_add_f32_dpp v97, v97, v97 row_ror:8 row_mask:0xf bank_mask:0xf
  s_mov_b32 s100, 0
  s_waitcnt vmcnt(0)
  s_branch L_epc_17
L_ep_16:
  global_load_dword v252, v253, s[30:31] sc1
  s_add_u32 s100, s100, 1
  s_cmp_gt_u32 s100, 100000
  s_cbranch_scc1 L_abort
  s_waitcnt vmcnt(0)
L_epc_17:
  v_readfirstlane_b32 s48, v252
  s_nop 0
  s_cmp_eq_u32 s48, 0
  s_nop 1
  s_cbranch_scc1 L_ep_16
  s_mul_i32 s48, s48, 0x9e3779b1
  s_and_b32 s49, s48, 0xff
  s_bfe_u32 s50, s48, 0x80008
  s_bfe_u32 s51, s48, 0x80010
  s_lshr_b32 s52, s48, 24
  ds_write2_b32 v8, v96, v97 offset0:0 offset1:4
  s_waitcnt lgkmcnt(0)
  s_barrier
  s_cmp_lg_u32 s3, 4
  s_cbranch_scc1 L_nopub_18
  s_mov_b64 exec, 0xffff
  ds_read_b128 v[124:127], v9 offset:0
  ds_read_b128 v[128:131], v9 offset:16
  ds_read_b128 v[132:135], v9 offset:32
  ds_read_b128 v[136:139], v9 offset:48
  s_waitcnt lgkmcnt(3)
  v_add_f32 v124, v124, v125
  v_add_f32 v126, v126, v127
  v_add_f32 v124, v124, v126
  s_waitcnt lgkmcnt(2)
  v_add_f32 v128, v128, v129
  v_add_f32 v130, v130, v131
  v_add_f32 v128, v128, v130
  s_waitcnt lgkmcnt(1)
  v_add_f32 v132, v132, v133
  v_add_f32 v134, v134, v135
  v_add_f32 v132, v132, v134
  s_waitcnt lgkmcnt(0)
  v_add_f32 v136, v136, v137
  v_add_f32 v138, v138, v139
  v_add_f32 v136, v136, v138
  v_and_or_b32 v100, v124, v2, s49
  v_and_or_b32 v101, v128, v2, s50
  v_and_or_b32 v102, v132, v2, s51
  v_and_or_b32 v103, v136, v2, s52
  buffer_store_dwordx4 v[100:103], v10, s[32:35], s81 offen sc1
L_nopub_18:
  s_mov_b64 exec, -1
  s_barrier
  s_branch L_nou0c
L_nou0b:
  v_lshlrev_b32 v12, 7, v1
  v_lshlrev_b32 v14, 9, v1
  s_bfe_u32 s93, s2, 0x30003
  s_and_b32 s94, s2, 7
  s_cmp_lg_u32 s3, 4
  s_cbranch_scc1 L_ew5
  s_mov_b32 exec_hi, 0
  s_lshl_b32 s92, s93, 12
  s_add_u32 s92, s92, 0x10000
  buffer_load_dword v254, v12, s[32:35], s92 offen sc1
  s_lshl_b32 s92, s93, 14
  s_lshr_b32 s97, s94, 1
  s_lshl_b32 s97, s97, 7
  s_add_u32 s92, s92, s97
  s_add_u32 s92, s92, 0x20000
  buffer_load_dword v254, v14, s[32:35], s92 offen sc1
  s_mov_b32 exec_lo, 0xffff
  s_lshl_b32 s92, s94, 14
  s_lshl_b32 s97, s93, 11
  s_add_u32 s92, s92, s97
  s_add_u32 s92, s92, 0x80000
  buffer_load_dword v254, v12, s[32:35], s92 offen sc1
  s_lshl_b32 s92, s94, 11
  s_add_u32 s92, s92, 0x18000
  buffer_load_dword v254, v12, s[32:35], s92 offen sc1
  s_lshl_b32 s92, s93, 11
  buffer_load_dword v254, v12, s[32:35], s92 offen sc1
  s_branch L_ewx
L_ew5:
  s_cmp_lg_u32 s3, 5
  s_cbranch_scc1 L_ew6
  s_mov_b32 exec_hi, 0
  s_min_u32 s95, s93, 6
  s_mul_i32 s92, s94, 28672
  s_lshl_b32 s97, s95, 12
  s_add_u32 s92, s92, s97
  s_add_u32 s92, s92, 0xd0000
  buffer_load_dword v254, v12, s[32:35], s92 offen sc1
  s_branch L_ewx
L_ew6:
  s_cmp_lg_u32 s3, 6
  s_cbranch_scc1 L_ew7
  s_mov_b32 exec_hi, 0
  s_cmp_lg_u32 s94, 0
  s_cbranch_scc1 L_ewx
  s_mul_i32 s92, s93, 8448
  s_add_u32 s92, s92, 0x60000
  buffer_load_dword v254, v12, s[32:35], s92 offen sc1
  s_add_u32 s92, s92, 4224
  buffer_load_dword v254, v12, s[32:35], s92 offen sc1
  s_branch L_ewx
L_ew7:
  s_cmp_ge_u32 s93, 4
  s_cbranch_scc1 L_ew7b
  s_mov_b32 exec_hi, 0
  s_lshl_b32 s92, s94, 14
  s_lshl_b32 s97, s93, 12
  s_add_u32 s92, s92, s97
  s_add_u32 s92, s92, 0x40000
  buffer_load_dword v254, v12, s[32:35], s92 offen sc1
  s_branch L_ewx
L_ew7b:
  s_mul_i32 s92, s94, 8448
  s_and_b32 s97, s93, 1
  s_mul_i32 s97, s97, 67584
  s_add_u32 s92, s92, s97
  s_add_u32 s92, s92, 0xa0000
  buffer_load_dword v254, v12, s[32:35], s92 offen sc1
L_ewx:
  s_mov_b64 exec, -1
  s_barrier
  s_barrier
  s_mov_b32 s100, 0
  v_mov_b32 v253, 0
L_ep_19:
  global_load_dword v252, v253, s[30:31] sc1
  s_add_u32 s100, s100, 1
  s_cmp_gt_u32 s100, 100000
  s_cbranch_scc1 L_abort
  s_waitcnt vmcnt(0)
L_epc_20:
  v_readfirstlane_b32 s48, v252
  s_nop 0
  s_cmp_eq_u32 s48, 0
  s_nop 1
  s_cbranch_scc1 L_ep_19
  s_mul_i32 s48, s48, 0x9e3779b1
  s_and_b32 s49, s48, 0xff
  s_bfe_u32 s50, s48, 0x80008
  s_bfe_u32 s51, s48, 0x80010
  s_lshr_b32 s52, s48, 24
L_nou0c:
  s_lshr_b32 s97, s48, 15
  s_xor_b32 s97, s97, s48
  s_mul_i32 s97, s97, 0x85ebca6b
  v_mov_b32 v4, s48
  v_mov_b32 v5, s97
  v_mov_b32 v249, s48
  v_mov_b32 v250, s97
  v_and_b32 v6, 4, v1
  v_cmp_eq_u32 vcc, 0, v6
  v_and_b32 v7, 3, v1
  v_lshlrev_b32 v7, 2, v7
  v_cndmask_b32 v4, v5, v4, vcc
  v_lshrrev_b32 v4, v7, v4
  v_lshrrev_b32 v5, 1, v4
  v_lshrrev_b32 v6, 2, v4
  v_lshrrev_b32 v7, 3, v4
  v_lshrrev_b32 v245, 4, v1
  v_and_b32 v246, 15, v1
  v_lshlrev_b32 v247, 2, v245
  v_xor_b32 v246, v246, v247
  v_lshlrev_b32 v246, 4, v246
  v_lshl_add_u32 v244, v245, 10, v246
  v_xor_b32 v245, 16, v244
  v_xor_b32 v246, 32, v244
  v_xor_b32 v247, 48, v244
  v_add_u32 v245, 3072, v245
  v_add_u32 v246, 6144, v246
  v_add_u32 v247, 9216, v247
  s_and_b32 s91, s3, 3
  s_lshl_b32 s90, s91, 15
  s_lshl_b32 s91, s91, 13
  s_lshl_b32 s92, s2, 17
  s_add_u32 s90, s90, s92
  s_bfe_u32 s93, s2, 0x20003
  s_lshl_b32 s92, s93, 15
  s_add_u32 s91, s91, s92
  s_lshl_b32 s92, s93, 8
  s_add_u32 s90, s90, s92
  s_mov_b64 s[36:37], s[6:7]
  s_mov_b32 s38, 0x2000000
  s_mov_b32 s39, 0x20000
  v_lshlrev_b32 v12, 21, v1
  v_add_u32 v12, 0xf000, v12
  s_mov_b64 exec, 0x3f
  buffer_load_dword v254, v12, s[32:35], 0 offen
  s_mov_b64 exec, -1
  s_and_b32 s81, s3, 3
  s_lshl_b32 s81, s81, 13
  s_add_u32 s81, s81, 0x10000
  v_lshlrev_b32 v8, 4, v1
  s_add_u32 s82, s81, 4096
  v_lshrrev_b32 v9, 4, v1
  v_lshlrev_b32 v9, 13, v9
  v_and_b32 v3, 15, v1
  v_lshl_add_u32 v9, v3, 4, v9
  s_and_b32 s93, s3, 3
  s_lshl_b32 s93, s93, 11
  s_and_b32 s97, s3, 1
  s_lshl_b32 s97, s97, 5
  s_add_u32 s93, s93, s97
  s_add_u32 s93, s93, 0x20000
  v_xor_b32 v9, s93, v9
  s_xor_b32 m0, s91, 4096
  s_xor_b32 s101, s90, 16384
  buffer_load_dwordx4 v244, s[36:39], s101 offen offset:0 nt lds
  s_waitcnt vmcnt(0)
  buffer_load_dwordx4 v245, s[36:39], s101 offen offset:1024 nt lds
  s_waitcnt vmcnt(0)
  buffer_load_dwordx4 v246, s[36:39], s101 offen offset:2048 nt lds
  s_waitcnt vmcnt(2)
  buffer_load_dwordx4 v247, s[36:39], s101 offen offset:3072 nt lds
  s_waitcnt vmcnt(2)
  s_xor_b32 m0, s91, 36864
  s_xor_b32 s101, s90, 16640
  buffer_load_dwordx4 v244, s[36:39], s101 offen offset:0 nt lds
  s_waitcnt vmcnt(2)
  buffer_load_dwordx4 v245, s[36:39], s101 offen offset:1024 nt lds
  s_waitcnt vmcnt(2)
  buffer_load_dwordx4 v246, s[36:39], s101 offen offset:2048 nt lds
  s_waitcnt vmcnt(2)
  buffer_load_dwordx4 v247, s[36:39], s101 offen offset:3072 nt lds
  s_waitcnt vmcnt(2)
  s_xor_b32 m0, s91, 69632
  s_xor_b32 s101, s90, 16896
  buffer_load_dwordx4 v244, s[36:39], s101 offen offset:0 nt lds
  buffer_load_dwordx4 v245, s[36:39], s101 offen offset:1024 nt lds
  buffer_load_dwordx4 v246, s[36:39], s101 offen offset:2048 nt lds
  buffer_load_dwordx4 v247, s[36:39], s101 offen offset:3072 nt lds
  s_mov_b64 s[40:41], s[26:27]
  s_mov_b32 s42, 0x300000
  s_mov_b32 s43, 0x20000
  v_lshrrev_b32 v13, 3, v1
  v_mul_u32_u24 v13, 24576, v13
  v_and_b32 v3, 7, v1
  v_lshl_add_u32 v13, v3, 4, v13
  s_lshr_b32 s94, s78, 5
  s_lshl_b32 s94, s94, 2
  s_and_b32 s97, s3, 3
  s_add_u32 s94, s94, s97
  s_lshl_b32 s95, s94, 6
  v_lshrrev_b32 v14, 3, v1
  v_lshlrev_b32 v14, 3, v14
  v_add_u32 v14, s95, v14
  s_mul_i32 s92, s94, 196608
  s_and_b32 s97, s2, 31
  s_lshl_b32 s97, s97, 7
  s_add_u32 s92, s92, s97
  s_add_u32 s92, s92, 0x800
  global_load_dwordx2 v[144:145], v14, s[24:25]
  buffer_load_dwordx4 v[128:131], v13, s[40:43], s92 offen nt
  s_add_u32 s92, s92, 6144
  buffer_load_dwordx4 v[132:135], v13, s[40:43], s92 offen nt
  s_add_u32 s92, s92, 6144
  buffer_load_dwordx4 v[136:139], v13, s[40:43], s92 offen nt
  s_add_u32 s92, s92, 6144
  buffer_load_dwordx4 v[140:143], v13, s[40:43], s92 offen nt
  v_lshrrev_b32 v42, 4, v1
  v_lshlrev_b32 v42, 13, v42
  v_and_b32 v3, 15, v1
  v_lshl_add_u32 v42, v3, 4, v42
  s_lshl_b32 s88, s77, 19
  s_bfe_u32 s97, s3, 0x10001
  s_lshl_b32 s97, s97, 18
  s_add_u32 s88, s88, s97
  s_and_b32 s97, s3, 1
  s_lshl_b32 s97, s97, 15
  s_add_u32 s88, s88, s97
  s_lshl_b32 s97, s76, 8
  s_add_u32 s88, s88, s97
  v_lshrrev_b32 v251, 5, v1
  v_mul_u32_u24 v251, 3584, v251
  v_and_b32 v3, 31, v1
  v_lshl_add_u32 v251, v3, 4, v251
  s_mul_i32 s89, s79, 114688
  s_and_b32 s97, s3, 3
  s_mul_i32 s97, s97, 28672
  s_add_u32 s89, s89, s97
  s_mul_i32 s97, s80, 448
  s_add_u32 s89, s89, s97
  s_barrier
  s_branch L_back1
L_back:
  v_lshlrev_b32 v12, 21, v1
  v_add_u32 v12, 0xf000, v12
  s_mov_b64 exec, 0x3f
  buffer_load_dword v254, v12, s[32:35], 0 offen
  s_mov_b64 exec, -1
  s_and_b32 s81, s3, 3
  s_lshl_b32 s81, s81, 13
  s_add_u32 s81, s81, 0x10000
  v_lshlrev_b32 v8, 4, v1
  s_add_u32 s82, s81, 4096
  v_lshrrev_b32 v9, 4, v1
  v_lshlrev_b32 v9, 13, v9
  v_and_b32 v3, 15, v1
  v_lshl_add_u32 v9, v3, 4, v9
  s_and_b32 s93, s3, 3
  s_lshl_b32 s93, s93, 11
  s_and_b32 s97, s3, 1
  s_lshl_b32 s97, s97, 5
  s_add_u32 s93, s93, s97
  s_add_u32 s93, s93, 0x20000
  v_xor_b32 v9, s93, v9
  v_lshrrev_b32 v42, 4, v1
  v_lshlrev_b32 v42, 13, v42
  v_and_b32 v3, 15, v1
  v_lshl_add_u32 v42, v3, 4, v42
  s_lshl_b32 s88, s77, 19
  s_bfe_u32 s97, s3, 0x10001
  s_lshl_b32 s97, s97, 18
  s_add_u32 s88, s88, s97
  s_and_b32 s97, s3, 1
  s_lshl_b32 s97, s97, 15
  s_add_u32 s88, s88, s97
  s_lshl_b32 s97, s76, 8
  s_add_u32 s88, s88, s97
  v_lshrrev_b32 v251, 4, v1
  v_lshlrev_b32 v251, 10, v251
  v_and_b32 v3, 15, v1
  v_lshl_add_u32 v251, v3, 4, v251
  s_lshl_b32 s89, s76, 17
  s_and_b32 s97, s3, 3
  s_lshl_b32 s97, s97, 15
  s_add_u32 s89, s89, s97
  s_lshl_b32 s97, s77, 8
  s_add_u32 s89, s89, s97
  s_barrier
L_back1:
  buffer_load_dwordx4 v[48:51], v8, s[32:35], s81 offen offset:0 sc1
  buffer_load_dwordx4 v[52:55], v8, s[32:35], s81 offen offset:1024 sc1
  buffer_load_dwordx4 v[56:59], v8, s[32:35], s81 offen offset:2048 sc1
  buffer_load_dwordx4 v[60:63], v8, s[32:35], s81 offen offset:3072 sc1
  buffer_load_dwordx4 v[64:67], v8, s[32:35], s82 offen offset:0 sc1
  buffer_load_dwordx4 v[68:71], v8, s[32:35], s82 offen offset:1024 sc1
  buffer_load_dwordx4 v[72:75], v8, s[32:35], s82 offen offset:2048 sc1
  buffer_load_dwordx4 v[76:79], v8, s[32:35], s82 offen offset:3072 sc1
  s_xor_b32 m0, s91, 102400
  s_xor_b32 s101, s90, 17152
  buffer_load_dwordx4 v244, s[36:39], s101 offen offset:0 nt lds
  buffer_load_dwordx4 v245, s[36:39], s101 offen offset:1024 nt lds
  buffer_load_dwordx4 v246, s[36:39], s101 offen offset:2048 nt lds
  buffer_load_dwordx4 v247, s[36:39], s101 offen offset:3072 nt lds
  s_branch L_setup
L_back2:
  s_mov_b32 s101, 0
  s_mov_b64 s[60:61], -1
  s_mov_b64 s[62:63], -1
  s_mov_b64 s[64:65], -1
  s_mov_b64 s[66:67], -1
  s_mov_b64 s[68:69], -1
  s_mov_b64 s[70:71], -1
  s_mov_b64 s[72:73], -1
  s_mov_b64 s[74:75], -1
  s_waitcnt vmcnt(4)
  s_mov_b32 s100, 0
  s_branch L_gc_23
L_g_21:
  s_add_u32 s100, s100, 1
  s_cmp_gt_u32 s100, 100000
  s_cbranch_scc1 L_abort
  s_mov_b32 s92, 0
  s_cmp_lg_u32 s74, 0
  s_cselect_b32 s92, 7168, s92
  s_cmp_lg_u32 s72, 0
  s_cselect_b32 s92, 6144, s92
  s_cmp_lg_u32 s70, 0
  s_cselect_b32 s92, 5120, s92
  s_cmp_lg_u32 s68, 0
  s_cselect_b32 s92, 4096, s92
  s_cmp_lg_u32 s66, 0
  s_cselect_b32 s92, 3072, s92
  s_cmp_lg_u32 s64, 0
  s_cselect_b32 s92, 2048, s92
  s_cmp_lg_u32 s62, 0
  s_cselect_b32 s92, 1024, s92
  s_cmp_lg_u32 s60, 0
  s_cselect_b32 s92, 0, s92
  s_add_u32 s92, s92, s81
  s_mov_b64 exec, -1
L_qg_24:
  buffer_load_dwordx4 v[16:19], v8, s[32:35], s92 offen sc1
  s_add_u32 s100, s100, 1
  s_cmp_gt_u32 s100, 100000
  s_cbranch_scc1 L_abort
  s_waitcnt vmcnt(0)
  v_xor_b32 v16, v16, v4
  v_bitop3_b32 v16, v17, v5, v16 bitop3:0xbe
  v_bitop3_b32 v16, v18, v6, v16 bitop3:0xbe
  v_bitop3_b32 v16, v19, v7, v16 bitop3:0xbe
  v_and_b32 v16, s53, v16
  v_cmp_ne_u32 vcc, 0, v16
  s_nop 0
  s_cbranch_vccz L_qg_24x
  s_sleep 4
  s_branch L_qg_24
L_qg_24x:
L_gf_22:
  s_mov_b64 exec, s[60:61]
  s_cbranch_execz L_gs_25
  buffer_load_dwordx4 v[48:51], v8, s[32:35], s81 offen offset:0 sc1
L_gs_25:
  s_mov_b64 exec, s[62:63]
  s_cbranch_execz L_gs_26
  buffer_load_dwordx4 v[52:55], v8, s[32:35], s81 offen offset:1024 sc1
L_gs_26:
  s_mov_b64 exec, s[64:65]
  s_cbranch_execz L_gs_27
  buffer_load_dwordx4 v[56:59], v8, s[32:35], s81 offen offset:2048 sc1
L_gs_27:
  s_mov_b64 exec, s[66:67]
  s_cbranch_execz L_gs_28
  buffer_load_dwordx4 v[60:63], v8, s[32:35], s81 offen offset:3072 sc1
L_gs_28:
  s_mov_b64 exec, s[68:69]
  s_cbranch_execz L_gs_29
  buffer_load_dwordx4 v[64:67], v8, s[32:35], s82 offen offset:0 sc1
L_gs_29:
  s_mov_b64 exec, s[70:71]
  s_cbranch_execz L_gs_30
  buffer_load_dwordx4 v[68:71], v8, s[32:35], s82 offen offset:1024 sc1
L_gs_30:
  s_mov_b64 exec, s[72:73]
  s_cbranch_execz L_gs_31
  buffer_load_dwordx4 v[72:75], v8, s[32:35], s82 offen offset:2048 sc1
L_gs_31:
  s_mov_b64 exec, s[74:75]
  s_cbranch_execz L_gs_32
  buffer_load_dwordx4 v[76:79], v8, s[32:35], s82 offen offset:3072 sc1
L_gs_32:
  s_waitcnt vmcnt(0)
L_gc_23:
  s_mov_b64 exec, s[60:61]
  v_xor_b32 v44, v48, v4
  v_bitop3_b32 v44, v49, v5, v44 bitop3:0xbe
  v_bitop3_b32 v44, v50, v6, v44 bitop3:0xbe
  v_bitop3_b32 v44, v51, v7, v44 bitop3:0xbe
  v_and_b32 v44, s53, v44
  v_cmp_ne_u32 s[60:61], 0, v44
  s_nop 0
  s_cmp_lg_u64 s[60:61], 0
  s_cselect_b64 s[60:61], -1, 0
  s_mov_b64 exec, s[62:63]
  v_xor_b32 v44, v52, v4
  v_bitop3_b32 v44, v53, v5, v44 bitop3:0xbe
  v_bitop3_b32 v44, v54, v6, v44 bitop3:0xbe
  v_bitop3_b32 v44, v55, v7, v44 bitop3:0xbe
  v_and_b32 v44, s53, v44
  v_cmp_ne_u32 s[62:63], 0, v44
  s_nop 0
  s_cmp_lg_u64 s[62:63], 0
  s_cselect_b64 s[62:63], -1, 0
  s_mov_b64 exec, s[64:65]
  v_xor_b32 v44, v56, v4
  v_bitop3_b32 v44, v57, v5, v44 bitop3:0xbe
  v_bitop3_b32 v44, v58, v6, v44 bitop3:0xbe
  v_bitop3_b32 v44, v59, v7, v44 bitop3:0xbe
  v_and_b32 v44, s53, v44
  v_cmp_ne_u32 s[64:65], 0, v44
  s_nop 0
  s_cmp_lg_u64 s[64:65], 0
  s_cselect_b64 s[64:65], -1, 0
  s_mov_b64 exec, s[66:67]
  v_xor_b32 v44, v60, v4
  v_bitop3_b32 v44, v61, v5, v44 bitop3:0xbe
  v_bitop3_b32 v44, v62, v6, v44 bitop3:0xbe
  v_bitop3_b32 v44, v63, v7, v44 bitop3:0xbe
  v_and_b32 v44, s53, v44
  v_cmp_ne_u32 s[66:67], 0, v44
  s_nop 0
  s_cmp_lg_u64 s[66:67], 0
  s_cselect_b64 s[66:67], -1, 0
  s_mov_b64 exec, s[68:69]
  v_xor_b32 v44, v64, v4
  v_bitop3_b32 v44, v65, v5, v44 bitop3:0xbe
  v_bitop3_b32 v44, v66, v6, v44 bitop3:0xbe
  v_bitop3_b32 v44, v67, v7, v44 bitop3:0xbe
  v_and_b32 v44, s53, v44
  v_cmp_ne_u32 s[68:69], 0, v44
  s_nop 0
  s_cmp_lg_u64 s[68:69], 0
  s_cselect_b64 s[68:69], -1, 0
  s_mov_b64 exec, s[70:71]
  v_xor_b32 v44, v68, v4
  v_bitop3_b32 v44, v69, v5, v44 bitop3:0xbe
  v_bitop3_b32 v44, v70, v6, v44 bitop3:0xbe
  v_bitop3_b32 v44, v71, v7, v44 bitop3:0xbe
  v_and_b32 v44, s53, v44
  v_cmp_ne_u32 s[70:71], 0, v44
  s_nop 0
  s_cmp_lg_u64 s[70:71], 0
  s_cselect_b64 s[70:71], -1, 0
  s_mov_b64 exec, s[72:73]
  v_xor_b32 v44, v72, v4
  v_bitop3_b32 v44, v73, v5, v44 bitop3:0xbe
  v_bitop3_b32 v44, v74, v6, v44 bitop3:0xbe
  v_bitop3_b32 v44, v75, v7, v44 bitop3:0xbe
  v_and_b32 v44, s53, v44
  v_cmp_ne_u32 s[72:73], 0, v44
  s_nop 0
  s_cmp_lg_u64 s[72:73], 0
  s_cselect_b64 s[72:73], -1, 0
  s_mov_b64 exec, s[74:75]
  v_xor_b32 v44, v76, v4
  v_bitop3_b32 v44, v77, v5, v44 bitop3:0xbe
  v_bitop3_b32 v44, v78, v6, v44 bitop3:0xbe
  v_bitop3_b32 v44, v79, v7, v44 bitop3:0xbe
  v_and_b32 v44, s53, v44
  v_cmp_ne_u32 s[74:75], 0, v44
  s_nop 0
  s_cmp_lg_u64 s[74:75], 0
  s_cselect_b64 s[74:75], -1, 0
  s_or_b64 s[96:97], s[60:61], s[62:63]
  s_or_b64 s[96:97], s[96:97], s[64:65]
  s_or_b64 s[96:97], s[96:97], s[66:67]
  s_or_b64 s[96:97], s[96:97], s[68:69]
  s_or_b64 s[96:97], s[96:97], s[70:71]
  s_or_b64 s[96:97], s[96:97], s[72:73]
  s_or_b64 s[96:97], s[96:97], s[74:75]
  s_cbranch_scc1 L_g_21
  s_mov_b64 exec, -1
  s_mov_b32 s101, 0
  v_xor_b32 v10, 0, v9
  ds_write_b128 v10, v[48:51] offset:0
  v_xor_b32 v11, 64, v9
  ds_write_b128 v11, v[52:55] offset:256
  v_xor_b32 v10, 128, v9
  ds_write_b128 v10, v[56:59] offset:512
  v_xor_b32 v11, 192, v9
  ds_write_b128 v11, v[60:63] offset:768
  v_xor_b32 v10, 16, v9
  ds_write_b128 v10, v[64:67] offset:1024
  v_xor_b32 v11, 80, v9
  ds_write_b128 v11, v[68:71] offset:1280
  v_xor_b32 v10, 144, v9
  ds_write_b128 v10, v[72:75] offset:1536
  v_xor_b32 v11, 208, v9
  ds_write_b128 v11, v[76:79] offset:1792
  s_mov_b64 s[40:41], s[14:15]
  s_mov_b32 s42, 0x400000
  s_mov_b32 s43, 0x20000
  s_mov_b64 s[44:45], s[12:13]
  s_mov_b32 s46, 0x400000
  s_mov_b32 s47, 0x20000
  s_waitcnt lgkmcnt(0)
  s_setprio 3
  s_barrier
  s_cmp_lt_u32 s2, 128
  s_cbranch_scc0 L_lwB
  s_cmp_lg_u32 s101, 0
  s_cbranch_scc1 L_lwX
  buffer_load_dwordx4 v[176:179], v42, s[44:47], s88 offen nt
  s_add_u32 s88, s88, 65536
  buffer_load_dwordx4 v[180:183], v42, s[44:47], s88 offen nt
  s_add_u32 s88, s88, 65536
  buffer_load_dwordx4 v[184:187], v42, s[44:47], s88 offen nt
  s_add_u32 s88, s88, 65536
  buffer_load_dwordx4 v[188:191], v42, s[44:47], s88 offen nt
  buffer_load_dwordx4 v[208:211], v251, s[40:43], s89 offen nt
  s_add_u32 s89, s89, 4096
  buffer_load_dwordx4 v[212:215], v251, s[40:43], s89 offen nt
  s_add_u32 s89, s89, 4096
  buffer_load_dwordx4 v[216:219], v251, s[40:43], s89 offen nt
  s_add_u32 s89, s89, 4096
  buffer_load_dwordx4 v[220:223], v251, s[40:43], s89 offen nt
  s_add_u32 s89, s89, 4096
  buffer_load_dwordx4 v[224:227], v251, s[40:43], s89 offen nt
  s_add_u32 s89, s89, 4096
  buffer_load_dwordx4 v[228:231], v251, s[40:43], s89 offen nt
  s_add_u32 s89, s89, 4096
  buffer_load_dwordx4 v[232:235], v251, s[40:43], s89 offen nt
  s_add_u32 s89, s89, 4096
  buffer_load_dwordx4 v[236:239], v251, s[40:43], s89 offen nt
L_lwX:
  s_barrier
  s_waitcnt vmcnt(12)
  s_barrier
  s_barrier
  s_barrier
  s_branch L_pv
L_lwB:
  s_cmp_lg_u32 s101, 0
  s_cbranch_scc1 L_lwB2
  buffer_load_dwordx4 v[176:179], v42, s[44:47], s88 offen nt
  s_add_u32 s88, s88, 65536
  buffer_load_dwordx4 v[180:183], v42, s[44:47], s88 offen nt
  s_add_u32 s88, s88, 65536
  buffer_load_dwordx4 v[184:187], v42, s[44:47], s88 offen nt
  s_add_u32 s88, s88, 65536
  buffer_load_dwordx4 v[188:191], v42, s[44:47], s88 offen nt
  s_mov_b64 s[40:41], s[18:19]
  s_mov_b32 s42, 0x1c0000
  s_mov_b32 s43, 0x20000
  s_mov_b64 s[44:45], s[20:21]
  s_mov_b32 s46, 0x1c0000
  s_mov_b32 s47, 0x20000
  s_mov_b32 exec_lo, 0xfffffff
  s_mov_b32 exec_hi, 0xfffffff
  buffer_load_dwordx4 v[208:211], v251, s[40:43], s89 offen nt
  buffer_load_dwordx4 v[212:215], v251, s[44:47], s89 offen nt
  s_add_u32 s89, s89, 7168
  buffer_load_dwordx4 v[216:219], v251, s[40:43], s89 offen nt
  buffer_load_dwordx4 v[220:223], v251, s[44:47], s89 offen nt
  s_add_u32 s89, s89, 7168
  buffer_load_dwordx4 v[224:227], v251, s[40:43], s89 offen nt
  buffer_load_dwordx4 v[228:231], v251, s[44:47], s89 offen nt
  s_add_u32 s89, s89, 7168
  buffer_load_dwordx4 v[232:235], v251, s[40:43], s89 offen nt
  buffer_load_dwordx4 v[236:239], v251, s[44:47], s89 offen nt
  s_mov_b64 exec, -1
L_lwB2:
  s_and_b32 s74, s2, 31
  s_lshl_b32 s74, s74, 10
  s_lshr_b32 s97, s78, 5
  s_lshl_b32 s97, s97, 8
  s_add_u32 s74, s74, s97
  s_add_u32 s74, s74, 0x4000
  v_and_b32 v13, 7, v1
  v_lshlrev_b32 v13, 2, v13
  v_lshrrev_b32 v14, 4, v1
  v_add_u32 v13, v13, v14
  v_lshlrev_b32 v13, 5, v13
  s_lshl_b32 s92, s3, 2
  s_add_u32 s92, s92, 141296
  v_add_u32 v13, s92, v13
  v_lshlrev_b32 v14, 6, v1
  v_add_u32 v14, 141312, v14
  v_lshlrev_b32 v15, 4, v1
  v_xor_b32 v13, s59, v13
  v_xor_b32 v14, s59, v14
  s_waitcnt vmcnt(63)
  v_lshlrev_b32 v116, 16, v144
  v_and_b32 v117, 0xffff0000, v144
  v_lshlrev_b32 v118, 16, v145
  v_and_b32 v119, 0xffff0000, v145
  v_mul_f32 v112, 0xbfb8aa3b, v116
  v_mul_f32 v113, 0xbfb8aa3b, v117
  v_mul_f32 v114, 0xbfb8aa3b, v118
  v_mul_f32 v115, 0xbfb8aa3b, v119
  v_exp_f32 v112, v112
  v_exp_f32 v113, v113
  v_exp_f32 v114, v114
  v_exp_f32 v115, v115
  v_add_f32 v112, 1.0, v112
  v_add_f32 v113, 1.0, v113
  v_add_f32 v114, 1.0, v114
  v_add_f32 v115, 1.0, v115
  v_rcp_f32 v112, v112
  v_rcp_f32 v113, v113
  v_rcp_f32 v114, v114
  v_rcp_f32 v115, v115
  v_mul_f32 v116, v116, v112
  v_mul_f32 v117, v117, v113
  v_mul_f32 v118, v118, v114
  v_mul_f32 v119, v119, v115
  v_cvt_pk_bf16_f32 v116, v116, v116
  v_cvt_pk_bf16_f32 v117, v117, v117
  v_cvt_pk_bf16_f32 v118, v118, v118
  v_cvt_pk_bf16_f32 v119, v119, v119
  v_lshrrev_b32 v112, 16, v116
  v_lshrrev_b32 v113, 16, v117
  v_lshrrev_b32 v114, 16, v118
  v_lshrrev_b32 v115, 16, v119
  v_and_b32 v116, 0xffff0000, v116
  v_and_b32 v117, 0xffff0000, v117
  v_and_b32 v118, 0xffff0000, v118
  v_and_b32 v119, 0xffff0000, v119
  v_mov_b32 v96, 0
  v_mov_b32 v97, 0
  v_mov_b32 v98, 0
  v_mov_b32 v99, 0
  v_mov_b32 v100, 0
  v_mov_b32 v101, 0
  v_mov_b32 v102, 0
  v_mov_b32 v103, 0
  s_waitcnt vmcnt(63)
  v_dot2c_f32_bf16 v96, v112, v128
  v_dot2c_f32_bf16 v97, v116, v128
  v_dot2c_f32_bf16 v98, v112, v129
  v_dot2c_f32_bf16 v99, v116, v129
  v_dot2c_f32_bf16 v100, v112, v130
  v_dot2c_f32_bf16 v101, v116, v130
  v_dot2c_f32_bf16 v102, v112, v131
  v_dot2c_f32_bf16 v103, v116, v131
  s_waitcnt vmcnt(62)
  v_dot2c_f32_bf16 v96, v113, v132
  v_dot2c_f32_bf16 v97, v117, v132
  v_dot2c_f32_bf16 v98, v113, v133
  v_dot2c_f32_bf16 v99, v117, v133
  v_dot2c_f32_bf16 v100, v113, v134
  v_dot2c_f32_bf16 v101, v117, v134
  v_dot2c_f32_bf16 v102, v113, v135
  v_dot2c_f32_bf16 v103, v117, v135
  s_waitcnt vmcnt(61)
  v_dot2c_f32_bf16 v96, v114, v136
  v_dot2c_f32_bf16 v97, v118, v136
  v_dot2c_f32_bf16 v98, v114, v137
  v_dot2c_f32_bf16 v99, v118, v137
  v_dot2c_f32_bf16 v100, v114, v138
  v_dot2c_f32_bf16 v101, v118, v138
  v_dot2c_f32_bf16 v102, v114, v139
  v_dot2c_f32_bf16 v103, v118, v139
  s_waitcnt vmcnt(60)
  v_dot2c_f32_bf16 v96, v115, v140
  v_dot2c_f32_bf16 v97, v119, v140
  v_dot2c_f32_bf16 v98, v115, v141
  v_dot2c_f32_bf16 v99, v119, v141
  v_dot2c_f32_bf16 v100, v115, v142
  v_dot2c_f32_bf16 v101, v119, v142
  v_dot2c_f32_bf16 v102, v115, v143
  v_dot2c_f32_bf16 v103, v119, v143
  v_permlane32_swap_b32 v96, v100
  v_permlane32_swap_b32 v97, v101
  v_permlane32_swap_b32 v98, v102
  v_permlane32_swap_b32 v99, v103
  v_add_f32 v96, v96, v100
  v_add_f32 v97, v97, v101
  v_add_f32 v98, v98, v102
  v_add_f32 v99, v99, v103
  s_nop 0
  v_permlane16_swap_b32 v96, v98
  v_permlane16_swap_b32 v97, v99
  v_add_f32 v96, v96, v98
  v_add_f32 v97, v97, v99
  s_nop 0
  v_add_f32_dpp v96, v96, v96 row_ror:8 row_mask:0xf bank_mask:0xf
  v_add_f32_dpp v97, v97, v97 row_ror:8 row_mask:0xf bank_mask:0xf
  s_barrier
  s_waitcnt vmcnt(12)
  s_barrier
  ds_write2_b32 v13, v96, v97 offset0:0 offset1:4
  s_waitcnt lgkmcnt(0)
  s_barrier
  s_cmp_lg_u32 s3, 4
  s_cbranch_scc1 L_nopub_33
  s_mov_b64 exec, 0xffff
  ds_read_b128 v[128:131], v14 offset:0
  ds_read_b128 v[132:135], v14 offset:16
  ds_read_b128 v[136:139], v14 offset:32
  ds_read_b128 v[140:143], v14 offset:48
  s_waitcnt lgkmcnt(3)
  v_add_f32 v128, v128, v129
  v_add_f32 v130, v130, v131
  v_add_f32 v128, v128, v130
  s_waitcnt lgkmcnt(2)
  v_add_f32 v132, v132, v133
  v_add_f32 v134, v134, v135
  v_add_f32 v132, v132, v134
  s_waitcnt lgkmcnt(1)
  v_add_f32 v136, v136, v137
  v_add_f32 v138, v138, v139
  v_add_f32 v136, v136, v138
  s_waitcnt lgkmcnt(0)
  v_add_f32 v140, v140, v141
  v_add_f32 v142, v142, v143
  v_add_f32 v140, v140, v142
  v_and_or_b32 v100, v128, v2, s49
  v_and_or_b32 v101, v132, v2, s50
  v_and_or_b32 v102, v136, v2, s51
  v_and_or_b32 v103, v140, v2, s52
  buffer_store_dwordx4 v[100:103], v15, s[32:35], s74 offen sc1
L_nopub_33:
  s_mov_b64 exec, -1
  s_barrier
  s_branch L_pv
L_front:
  s_mov_b32 s100, 0
  s_waitcnt vmcnt(4)
  s_branch L_epc_35
L_ep_34:
  global_load_dword v252, v253, s[30:31] sc1
  s_add_u32 s100, s100, 1
  s_cmp_gt_u32 s100, 100000
  s_cbranch_scc1 L_abort
  s_waitcnt vmcnt(0)
L_epc_35:
  v_readfirstlane_b32 s48, v252
  s_nop 0
  s_cmp_eq_u32 s48, 0
  s_nop 1
  s_cbranch_scc1 L_ep_34
  s_mul_i32 s48, s48, 0x9e3779b1
  s_and_b32 s49, s48, 0xff
  s_bfe_u32 s50, s48, 0x80008
  s_bfe_u32 s51, s48, 0x80010
  s_lshr_b32 s52, s48, 24
  s_lshr_b32 s97, s48, 15
  s_xor_b32 s97, s97, s48
  s_mul_i32 s97, s97, 0x85ebca6b
  v_mov_b32 v4, s48
  v_mov_b32 v5, s97
  v_mov_b32 v249, s48
  v_mov_b32 v250, s97
  v_and_b32 v6, 4, v1
  v_cmp_eq_u32 vcc, 0, v6
  v_and_b32 v7, 3, v1
  v_lshlrev_b32 v7, 2, v7
  v_cndmask_b32 v4, v5, v4, vcc
  v_lshrrev_b32 v4, v7, v4
  v_lshrrev_b32 v5, 1, v4
  v_lshrrev_b32 v6, 2, v4
  v_lshrrev_b32 v7, 3, v4
L_setup:
  s_lshr_b32 s92, s3, 1
  s_lshl_b32 s92, s92, 15
  s_and_b32 s93, s3, 1
  v_lshlrev_b32 v34, 4, v1
  v_bfe_u32 v44, v1, 2, 2
  v_lshrrev_b32 v45, 5, v1
  v_lshl_add_u32 v46, v45, 2, v44
  v_lshlrev_b32 v46, 8, v46
  v_add_u32 v46, s92, v46
  v_and_b32 v47, 1, v1
  v_lshl_add_u32 v46, v47, 3, v46
  v_lshl_or_b32 v44, v44, 2, v45
  v_bfe_u32 v47, v1, 4, 1
  v_lshlrev_b32 v47, 1, v47
  v_xor_b32 v44, v44, v47
  v_bfe_u32 v47, v1, 1, 1
  v_xor_b32 v44, v44, v47
  s_lshl_b32 s94, s93, 3
  v_xor_b32 v44, s94, v44
  v_xor_b32 v47, 0, v44
  v_lshl_add_u32 v24, v47, 4, v46
  v_xor_b32 v47, 2, v44
  v_lshl_add_u32 v25, v47, 4, v46
  v_add_u32 v25, 2048, v25
  v_xor_b32 v47, 4, v44
  v_lshl_add_u32 v26, v47, 4, v46
  v_xor_b32 v47, 6, v44
  v_lshl_add_u32 v27, v47, 4, v46
  v_add_u32 v27, 2048, v27
  v_add_u32 v28, 132096, v34
  v_and_b32 v44, 31, v1
  v_lshlrev_b32 v29, 5, v44
  v_add_u32 v29, 131072, v29
  v_xor_b32 v28, s59, v28
  v_xor_b32 v29, s59, v29
  s_lshl_b32 s94, s93, 7
  s_add_u32 s94, s94, s92
  v_and_b32 v46, 3, v44
  v_lshlrev_b32 v46, 6, v46
  v_lshl_add_u32 v46, v44, 8, v46
  v_bfe_u32 v47, v44, 1, 2
  v_lshlrev_b32 v45, 1, v45
  v_xor_b32 v47, v47, v45
  v_lshl_add_u32 v46, v47, 4, v46
  v_xor_b32 v244, s94, v46
  v_xor_b32 v245, 16, v244
  v_xor_b32 v246, 64, v244
  v_xor_b32 v247, 0x50, v244
  v_lshrrev_b32 v44, 2, v1
  v_and_b32 v46, 3, v44
  v_lshlrev_b32 v46, 6, v46
  v_lshl_add_u32 v46, v44, 8, v46
  v_bfe_u32 v47, v44, 1, 2
  v_and_b32 v45, 3, v1
  v_xor_b32 v47, v47, v45
  v_lshl_add_u32 v46, v47, 4, v46
  v_xor_b32 v32, s94, v46
  v_xor_b32 v33, 64, v32
  v_lshrrev_b32 v44, 3, v1
  v_bfe_u32 v45, v1, 2, 1
  v_and_b32 v46, 3, v44
  v_xor_b32 v46, v46, v45
  v_lshlrev_b32 v46, 6, v46
  v_lshl_add_u32 v46, v44, 8, v46
  v_lshrrev_b32 v47, 1, v44
  v_and_b32 v45, 3, v1
  v_xor_b32 v47, v47, v45
  v_lshl_add_u32 v46, v47, 4, v46
  v_xor_b32 v32, s94, v46
  s_mul_i32 s87, s2, 32896
  s_lshl_b32 s97, s3, 12
  s_add_u32 s87, s87, s97
  s_add_u32 s87, s87, 0x200000
  s_lshl_b32 s94, s76, 4
  s_lshl_b32 s97, s3, 9
  s_add_u32 s94, s94, s97
  s_add_u32 s94, s94, 0x20000
  v_lshrrev_b32 v35, 3, v1
  v_lshlrev_b32 v35, 12, v35
  v_add_u32 v35, s94, v35
  v_lshlrev_b32 v248, 4, v1
  v_lshrrev_b32 v36, 3, v1
  v_mul_u32_u24 v36, 263168, v36
  v_and_b32 v3, 7, v1
  v_lshl_add_u32 v36, v3, 4, v36
  s_mul_i32 s94, s3, 32896
  s_lshl_b32 s97, s77, 12
  s_add_u32 s94, s94, s97
  s_lshl_b32 s97, s76, 7
  s_add_u32 s94, s94, s97
  s_add_u32 s83, s94, 6307840
  s_add_u32 s84, s94, 8413184
  s_add_u32 s85, s94, 2097152
  s_add_u32 s86, s94, 4202496
  s_mul_i32 s94, s3, 144
  s_add_u32 s94, s94, 0x14000
  v_and_b32 v37, 7, v1
  v_lshlrev_b32 v37, 4, v37
  v_lshrrev_b32 v3, 4, v1
  v_lshl_add_u32 v37, v3, 2, v37
  v_add_u32 v37, s94, v37
  v_and_b32 v38, 7, v1
  v_mul_u32_u24 v38, 144, v38
  v_lshrrev_b32 v3, 4, v1
  v_lshl_add_u32 v38, v3, 4, v38
  v_add_u32 v38, 81920, v38
  s_lshl_b32 s94, s3, 7
  s_add_u32 s94, s94, 0x16c00
  v_lshrrev_b32 v41, 4, v1
  v_lshlrev_b32 v41, 4, v41
  v_add_u32 v41, s94, v41
  v_and_b32 v40, 7, v1
  v_mul_u32_u24 v40, 272, v40
  v_lshrrev_b32 v3, 4, v1
  v_lshl_add_u32 v40, v3, 4, v40
  v_add_u32 v40, 94208, v40
  s_lshl_b32 s94, s76, 12
  s_lshl_b32 s97, s3, 6
  s_add_u32 s94, s94, s97
  s_add_u32 s94, s94, 0x40000
  v_bfe_u32 v39, v1, 2, 3
  v_lshlrev_b32 v39, 9, v39
  v_and_b32 v3, 3, v1
  v_lshl_add_u32 v39, v3, 4, v39
  v_add_u32 v39, s94, v39
  s_lshl_b32 s95, s77, 9
  s_add_u32 s16, s94, s95
  s_and_b32 s94, s3, 3
  s_mul_i32 s94, s94, 4864
  v_lshrrev_b32 v240, 4, v1
  v_mul_u32_u24 v240, 288, v240
  v_and_b32 v3, 15, v1
  v_lshl_add_u32 v240, v3, 4, v240
  v_add_u32 v240, s94, v240
  s_and_b32 s94, s3, 3
  s_mul_i32 s94, s94, 9728
  s_add_u32 s94, s94, 0x5000
  v_lshrrev_b32 v241, 4, v1
  v_mul_u32_u24 v241, 288, v241
  v_and_b32 v3, 15, v1
  v_lshl_add_u32 v241, v3, 4, v241
  v_add_u32 v241, s94, v241
  s_lshl_b32 s94, s3, 5
  v_lshrrev_b32 v242, 4, v1
  v_mul_u32_u24 v242, 2432, v242
  v_bfe_u32 v3, v1, 2, 2
  v_mul_u32_u24 v3, 288, v3
  v_add_u32 v242, v3, v242
  v_and_b32 v3, 3, v1
  v_lshl_add_u32 v242, v3, 3, v242
  v_add_u32 v242, s94, v242
  v_lshrrev_b32 v243, 4, v1
  v_mul_u32_u24 v243, 2432, v243
  v_bfe_u32 v3, v1, 2, 2
  v_mul_u32_u24 v3, 288, v3
  v_add_u32 v243, v3, v243
  v_and_b32 v3, 3, v1
  v_lshl_add_u32 v243, v3, 3, v243
  v_add_u32 v243, 20480, v243
  v_add_u32 v243, s94, v243
  v_bfe_u32 v43, v1, 2, 3
  v_mul_u32_u24 v43, 272, v43
  v_and_b32 v3, 3, v1
  v_lshl_add_u32 v43, v3, 3, v43
  v_add_u32 v43, 94208, v43
  v_add_u32 v43, s94, v43
  s_cmp_ge_u32 s3, 4
  s_cbranch_scc1 L_back2
  v_and_b32 v44, 31, v1
  v_and_b32 v46, 3, v44
  v_lshlrev_b32 v46, 2, v46
  v_bfe_u32 v47, v44, 2, 2
  v_or_b32 v46, v46, v47
  v_lshrrev_b32 v47, 5, v1
  v_xor_b32 v46, v46, v47
  v_lshlrev_b32 v45, 8, v44
  v_xor_b32 v47, 0, v46
  v_lshl_add_u32 v16, v47, 4, v45
  v_xor_b32 v47, 2, v46
  v_lshl_add_u32 v17, v47, 4, v45
  v_xor_b32 v47, 4, v46
  v_lshl_add_u32 v18, v47, 4, v45
  v_xor_b32 v47, 6, v46
  v_lshl_add_u32 v19, v47, 4, v45
  v_xor_b32 v47, 8, v46
  v_lshl_add_u32 v20, v47, 4, v45
  v_xor_b32 v47, 10, v46
  v_lshl_add_u32 v21, v47, 4, v45
  v_xor_b32 v47, 12, v46
  v_lshl_add_u32 v22, v47, 4, v45
  v_xor_b32 v47, 14, v46
  v_lshl_add_u32 v23, v47, 4, v45
  s_lshl_b32 s92, s17, 13
  s_add_u32 s92, s92, 131072
  v_add_u32 v8, s91, v16
  v_add_u32 v16, s92, v16
  v_add_u32 v9, s91, v17
  v_add_u32 v17, s92, v17
  v_add_u32 v10, s91, v18
  v_add_u32 v18, s92, v18
  v_add_u32 v11, s91, v19
  v_add_u32 v19, s92, v19
  v_add_u32 v12, s91, v20
  v_add_u32 v20, s92, v20
  v_add_u32 v13, s91, v21
  v_add_u32 v21, s92, v21
  v_add_u32 v14, s91, v22
  v_add_u32 v22, s92, v22
  v_add_u32 v15, s91, v23
  v_add_u32 v23, s92, v23
  s_lshl_b32 s92, s3, 2
  v_lshrrev_b32 v47, 5, v1
  v_lshl_add_u32 v30, v47, 4, v29
  v_add_u32 v30, s92, v30
  s_lshl_b32 s92, s3, 11
  v_add_u32 v31, s92, v28
  s_setprio 2
  s_mov_b32 s101, 1
  s_waitcnt vmcnt(4)
  s_barrier
  ds_read_b128 v[112:115], v8
  ds_read_b128 v[116:119], v16
  ds_read_b128 v[120:123], v9
  ds_read_b128 v[124:127], v17
  ds_read_b128 v[128:131], v10
  ds_read_b128 v[132:135], v18
  ds_read_b128 v[136:139], v11
  ds_read_b128 v[140:143], v19
  ds_read_b128 v[144:147], v12
  ds_read_b128 v[148:151], v20
  ds_read_b128 v[152:155], v13
  ds_read_b128 v[156:159], v21
  v_xor_b32 v8, 0x8000, v8
  v_xor_b32 v16, 0x2000, v16
  v_xor_b32 v9, 0x8000, v9
  v_xor_b32 v17, 0x2000, v17
  v_xor_b32 v10, 0x8000, v10
  v_xor_b32 v18, 0x2000, v18
  v_xor_b32 v11, 0x8000, v11
  v_xor_b32 v19, 0x2000, v19
  v_xor_b32 v12, 0x8000, v12
  v_xor_b32 v20, 0x2000, v20
  v_xor_b32 v13, 0x8000, v13
  v_xor_b32 v21, 0x2000, v21
  s_waitcnt lgkmcnt(10)
  v_mfma_f32_32x32x16_bf16 v[96:111], v[112:115], v[116:119], 0
  ds_read_b128 v[160:163], v14
  ds_read_b128 v[164:167], v22
  v_xor_b32 v14, 0x8000, v14
  v_xor_b32 v22, 0x2000, v22
  s_waitcnt lgkmcnt(10)
  v_mfma_f32_32x32x16_bf16 v[96:111], v[120:123], v[124:127], v[96:111]
  ds_read_b128 v[168:171], v15
  ds_read_b128 v[172:175], v23
  v_xor_b32 v15, 0x8000, v15
  v_xor_b32 v23, 0x2000, v23
  s_waitcnt lgkmcnt(10)
  v_mfma_f32_32x32x16_bf16 v[96:111], v[128:131], v[132:135], v[96:111]
  ds_read_b128 v[112:115], v8
  ds_read_b128 v[116:119], v16
  v_xor_b32 v8, 0x18000, v8
  v_xor_b32 v16, 0x6000, v16
  s_waitcnt lgkmcnt(10)
  v_mfma_f32_32x32x16_bf16 v[96:111], v[136:139], v[140:143], v[96:111]
  ds_read_b128 v[120:123], v9
  ds_read_b128 v[124:127], v17
  v_xor_b32 v9, 0x18000, v9
  v_xor_b32 v17, 0x6000, v17
  s_waitcnt lgkmcnt(10)
  v_mfma_f32_32x32x16_bf16 v[96:111], v[144:147], v[148:151], v[96:111]
  ds_read_b128 v[128:131], v10
  ds_read_b128 v[132:135], v18
  v_xor_b32 v10, 0x18000, v10
  v_xor_b32 v18, 0x6000, v18
  s_waitcnt lgkmcnt(10)
  v_mfma_f32_32x32x16_bf16 v[96:111], v[152:155], v[156:159], v[96:111]
  ds_read_b128 v[136:139], v11
  ds_read_b128 v[140:143], v19
  v_xor_b32 v11, 0x18000, v11
  v_xor_b32 v19, 0x6000, v19
  s_waitcnt lgkmcnt(10)
  v_mfma_f32_32x32x16_bf16 v[96:111], v[160:163], v[164:167], v[96:111]
  ds_read_b128 v[144:147], v12
  ds_read_b128 v[148:151], v20
  v_xor_b32 v12, 0x18000, v12
  v_xor_b32 v20, 0x6000, v20
  s_waitcnt lgkmcnt(10)
  v_mfma_f32_32x32x16_bf16 v[96:111], v[168:171], v[172:175], v[96:111]
  ds_read_b128 v[152:155], v13
  ds_read_b128 v[156:159], v21
  v_xor_b32 v13, 0x18000, v13
  v_xor_b32 v21, 0x6000, v21
  s_waitcnt lgkmcnt(10)
  v_mfma_f32_32x32x16_bf16 v[96:111], v[112:115], v[116:119], v[96:111]
  ds_read_b128 v[160:163], v14
  ds_read_b128 v[164:167], v22
  v_xor_b32 v14, 0x18000, v14
  v_xor_b32 v22, 0x6000, v22
  s_waitcnt lgkmcnt(10)
  v_mfma_f32_32x32x16_bf16 v[96:111], v[120:123], v[124:127], v[96:111]
  ds_read_b128 v[168:171], v15
  ds_read_b128 v[172:175], v23
  v_xor_b32 v15, 0x18000, v15
  v_xor_b32 v23, 0x6000, v23
  s_waitcnt lgkmcnt(10)
  v_mfma_f32_32x32x16_bf16 v[96:111], v[128:131], v[132:135], v[96:111]
  ds_read_b128 v[112:115], v8
  ds_read_b128 v[116:119], v16
  v_xor_b32 v8, 0x8000, v8
  v_xor_b32 v16, 0x2000, v16
  s_waitcnt lgkmcnt(10)
  v_mfma_f32_32x32x16_bf16 v[96:111], v[136:139], v[140:143], v[96:111]
  ds_read_b128 v[120:123], v9
  ds_read_b128 v[124:127], v17
  v_xor_b32 v9, 0x8000, v9
  v_xor_b32 v17, 0x2000, v17
  s_waitcnt lgkmcnt(10)
  v_mfma_f32_32x32x16_bf16 v[96:111], v[144:147], v[148:151], v[96:111]
  ds_read_b128 v[128:131], v10
  ds_read_b128 v[132:135], v18
  v_xor_b32 v10, 0x8000, v10
  v_xor_b32 v18, 0x2000, v18
  s_waitcnt lgkmcnt(10)
  v_mfma_f32_32x32x16_bf16 v[96:111], v[152:155], v[156:159], v[96:111]
  ds_read_b128 v[136:139], v11
  ds_read_b128 v[140:143], v19
  v_xor_b32 v11, 0x8000, v11
  v_xor_b32 v19, 0x2000, v19
  s_waitcnt lgkmcnt(10)
  v_mfma_f32_32x32x16_bf16 v[96:111], v[160:163], v[164:167], v[96:111]
  ds_read_b128 v[144:147], v12
  ds_read_b128 v[148:151], v20
  v_xor_b32 v12, 0x8000, v12
  v_xor_b32 v20, 0x2000, v20
  s_waitcnt lgkmcnt(10)
  v_mfma_f32_32x32x16_bf16 v[96:111], v[168:171], v[172:175], v[96:111]
  ds_read_b128 v[152:155], v13
  ds_read_b128 v[156:159], v21
  v_xor_b32 v13, 0x8000, v13
  v_xor_b32 v21, 0x2000, v21
  s_barrier
  s_waitcnt lgkmcnt(10)
  v_mfma_f32_32x32x16_bf16 v[96:111], v[112:115], v[116:119], v[96:111]
  ds_read_b128 v[160:163], v14
  ds_read_b128 v[164:167], v22
  v_xor_b32 v14, 0x8000, v14
  v_xor_b32 v22, 0x2000, v22
  s_waitcnt lgkmcnt(10)
  v_mfma_f32_32x32x16_bf16 v[96:111], v[120:123], v[124:127], v[96:111]
  ds_read_b128 v[168:171], v15
  ds_read_b128 v[172:175], v23
  v_xor_b32 v15, 0x8000, v15
  v_xor_b32 v23, 0x2000, v23
  s_waitcnt lgkmcnt(10)
  v_mfma_f32_32x32x16_bf16 v[96:111], v[128:131], v[132:135], v[96:111]
  s_waitcnt vmcnt(0)
  s_barrier
  ds_read_b128 v[112:115], v8
  ds_read_b128 v[116:119], v16
  s_waitcnt lgkmcnt(10)
  v_mfma_f32_32x32x16_bf16 v[96:111], v[136:139], v[140:143], v[96:111]
  ds_read_b128 v[120:123], v9
  ds_read_b128 v[124:127], v17
  s_waitcnt lgkmcnt(10)
  v_mfma_f32_32x32x16_bf16 v[96:111], v[144:147], v[148:151], v[96:111]
  ds_read_b128 v[128:131], v10
  ds_read_b128 v[132:135], v18
  s_waitcnt lgkmcnt(10)
  v_mfma_f32_32x32x16_bf16 v[96:111], v[152:155], v[156:159], v[96:111]
  ds_read_b128 v[136:139], v11
  ds_read_b128 v[140:143], v19
  s_waitcnt lgkmcnt(10)
  v_mfma_f32_32x32x16_bf16 v[96:111], v[160:163], v[164:167], v[96:111]
  ds_read_b128 v[144:147], v12
  ds_read_b128 v[148:151], v20
  s_waitcnt lgkmcnt(10)
  v_mfma_f32_32x32x16_bf16 v[96:111], v[168:171], v[172:175], v[96:111]
  ds_read_b128 v[152:155], v13
  ds_read_b128 v[156:159], v21
  s_waitcnt lgkmcnt(10)
  v_mfma_f32_32x32x16_bf16 v[96:111], v[112:115], v[116:119], v[96:111]
  ds_read_b128 v[160:163], v14
  ds_read_b128 v[164:167], v22
  s_waitcnt lgkmcnt(10)
  v_mfma_f32_32x32x16_bf16 v[96:111], v[120:123], v[124:127], v[96:111]
  ds_read_b128 v[168:171], v15
  ds_read_b128 v[172:175], v23
  s_waitcnt lgkmcnt(10)
  v_mfma_f32_32x32x16_bf16 v[96:111], v[128:131], v[132:135], v[96:111]
  s_waitcnt lgkmcnt(8)
  v_mfma_f32_32x32x16_bf16 v[96:111], v[136:139], v[140:143], v[96:111]
  s_waitcnt lgkmcnt(6)
  v_mfma_f32_32x32x16_bf16 v[96:111], v[144:147], v[148:151], v[96:111]
  s_waitcnt lgkmcnt(4)
  v_mfma_f32_32x32x16_bf16 v[96:111], v[152:155], v[156:159], v[96:111]
  s_waitcnt lgkmcnt(2)
  v_mfma_f32_32x32x16_bf16 v[96:111], v[160:163], v[164:167], v[96:111]
  s_waitcnt lgkmcnt(0)
  v_mfma_f32_32x32x16_bf16 v[96:111], v[168:171], v[172:175], v[96:111]
  s_nop 11
  v_max3_f32 v44, v96, v97, v98
  v_max3_f32 v45, v99, v100, v101
  v_max3_f32 v46, v102, v103, v104
  v_max3_f32 v47, v105, v106, v107
  v_max3_f32 v44, v44, v108, v109
  v_max3_f32 v45, v45, v110, v111
  v_max3_f32 v44, v44, v46, v47
  v_max_f32 v44, v44, v45
  ds_write_b32 v30, v44
  v_sub_f32 v96, v96, v44
  v_sub_f32 v97, v97, v44
  v_sub_f32 v98, v98, v44
  v_sub_f32 v99, v99, v44
  v_sub_f32 v100, v100, v44
  v_sub_f32 v101, v101, v44
  v_sub_f32 v102, v102, v44
  v_sub_f32 v103, v103, v44
  s_waitcnt lgkmcnt(0)
  s_barrier
  ds_read_b128 v[48:51], v29
  ds_read_b128 v[52:55], v29 offset:16
  v_exp_f32 v96, v96
  v_sub_f32 v104, v104, v44
  v_exp_f32 v97, v97
  v_sub_f32 v105, v105, v44
  v_exp_f32 v98, v98
  v_sub_f32 v106, v106, v44
  v_exp_f32 v99, v99
  v_sub_f32 v107, v107, v44
  v_exp_f32 v100, v100
  v_sub_f32 v108, v108, v44
  v_exp_f32 v101, v101
  v_sub_f32 v109, v109, v44
  v_exp_f32 v102, v102
  v_sub_f32 v110, v110, v44
  v_exp_f32 v103, v103
  v_sub_f32 v111, v111, v44
  s_waitcnt lgkmcnt(0)
  v_max3_f32 v45, v48, v49, v50
  v_max3_f32 v46, v51, v52, v53
  v_exp_f32 v104, v104
  v_max3_f32 v45, v45, v54, v55
  v_exp_f32 v105, v105
  v_max_f32 v45, v45, v46
  v_exp_f32 v106, v106
  v_sub_f32 v45, v44, v45
  v_exp_f32 v107, v107
  v_exp_f32 v45, v45
  v_exp_f32 v108, v108
  v_exp_f32 v109, v109
  v_exp_f32 v110, v110
  v_exp_f32 v111, v111
  v_mul_f32 v96, v96, v45
  v_mul_f32 v97, v97, v45
  v_mul_f32 v98, v98, v45
  v_mul_f32 v99, v99, v45
  v_mul_f32 v100, v100, v45
  v_mul_f32 v101, v101, v45
  v_mul_f32 v102, v102, v45
  v_mul_f32 v103, v103, v45
  v_cvt_pk_bf16_f32 v48, v96, v97
  v_cvt_pk_bf16_f32 v49, v98, v99
  v_cvt_pk_bf16_f32 v50, v100, v101
  v_cvt_pk_bf16_f32 v51, v102, v103
  ds_write_b128 v31, v[48:51] offset:0
  v_mul_f32 v104, v104, v45
  v_mul_f32 v105, v105, v45
  v_mul_f32 v106, v106, v45
  v_mul_f32 v107, v107, v45
  v_mul_f32 v108, v108, v45
  v_mul_f32 v109, v109, v45
  v_mul_f32 v110, v110, v45
  v_mul_f32 v111, v111, v45
  v_cvt_pk_bf16_f32 v52, v104, v105
  v_cvt_pk_bf16_f32 v53, v106, v107
  v_cvt_pk_bf16_f32 v54, v108, v109
  v_cvt_pk_bf16_f32 v55, v110, v111
  ds_write_b128 v31, v[52:55] offset:1024
  v_add_f32 v96, v96, v97
  v_add_f32 v98, v98, v99
  v_add_f32 v100, v100, v101
  v_add_f32 v102, v102, v103
  v_add_f32 v104, v104, v105
  v_add_f32 v106, v106, v107
  v_add_f32 v108, v108, v109
  v_add_f32 v110, v110, v111
  v_add_f32 v96, v96, v98
  v_add_f32 v100, v100, v102
  v_add_f32 v104, v104, v106
  v_add_f32 v108, v108, v110
  v_add_f32 v96, v96, v100
  v_add_f32 v104, v104, v108
  v_add_f32 v96, v96, v104
  ds_write_b32 v30, v96 offset:9216
  s_waitcnt lgkmcnt(0)
  s_barrier
L_pv:
  s_setprio 2
  ds_read_b128 v[48:51], v28 offset:0
  ds_read_b64_tr_b16 v[112:113], v24 offset:0
  ds_read_b64_tr_b16 v[114:115], v25 offset:0
  ds_read_b128 v[52:55], v28 offset:1024
  ds_read_b64_tr_b16 v[116:117], v24 offset:4096
  ds_read_b64_tr_b16 v[118:119], v25 offset:4096
  ds_read_b128 v[56:59], v28 offset:2048
  ds_read_b64_tr_b16 v[120:121], v24 offset:8192
  ds_read_b64_tr_b16 v[122:123], v25 offset:8192
  ds_read_b128 v[60:63], v28 offset:3072
  ds_read_b64_tr_b16 v[124:125], v24 offset:12288
  ds_read_b64_tr_b16 v[126:127], v25 offset:12288
  s_lshl_b32 s74, s2, 9
  s_add_u32 s74, s74, 0x20000
  s_mov_b32 s70, 0x10000
  s_mov_b32 s71, 0x18000
  s_mov_b32 s72, 0x8000
  s_cmp_lg_u32 s3, 7
  s_cbranch_scc1 L_nolse
  ds_read_b128 v[144:147], v29
  ds_read_b128 v[148:151], v29 offset:16
  s_waitcnt lgkmcnt(6)
  ds_read_b128 v[152:155], v29 offset:9216
  ds_read_b128 v[156:159], v29 offset:9232
  s_andn2_b32 s92, s48, 1
  v_mov_b32 v23, s92
  s_waitcnt lgkmcnt(2)
  v_max3_f32 v20, v144, v145, v146
  v_max3_f32 v21, v147, v148, v149
  v_max3_f32 v20, v20, v150, v151
  v_max_f32 v20, v20, v21
  s_waitcnt lgkmcnt(0)
  v_add_f32 v152, v152, v153
  v_add_f32 v154, v154, v155
  v_add_f32 v156, v156, v157
  v_add_f32 v158, v158, v159
  v_add_f32 v152, v152, v154
  v_add_f32 v156, v156, v158
  v_add_f32 v152, v152, v156
  v_mov_b32 v21, v152
  s_mov_b32 exec_hi, 0
  buffer_store_dwordx4 v[20:23], v248, s[32:35], s74 offen sc1
  s_mov_b32 exec_hi, -1
L_nolse:
  s_waitcnt lgkmcnt(9)
  v_mfma_f32_32x32x16_bf16 v[144:159], v[112:115], v[48:51], 0
  ds_read_b128 v[64:67], v28 offset:4096
  ds_read_b64_tr_b16 v[128:129], v24 offset:16384
  ds_read_b64_tr_b16 v[130:131], v25 offset:16384
  s_waitcnt lgkmcnt(9)
  v_mfma_f32_32x32x16_bf16 v[144:159], v[116:119], v[52:55], v[144:159]
  ds_read_b128 v[68:71], v28 offset:5120
  ds_read_b64_tr_b16 v[132:133], v24 offset:20480
  ds_read_b64_tr_b16 v[134:135], v25 offset:20480
  v_lshrrev_b32 v44, 5, v1
  v_lshlrev_b32 v44, 3, v44
  v_lshrrev_b32 v96, v44, v249
  v_lshrrev_b32 v104, v44, v250
  s_waitcnt lgkmcnt(9)
  v_mfma_f32_32x32x16_bf16 v[144:159], v[120:123], v[56:59], v[144:159]
  ds_read_b128 v[72:75], v28 offset:6144
  ds_read_b64_tr_b16 v[136:137], v24 offset:24576
  ds_read_b64_tr_b16 v[138:139], v25 offset:24576
  v_lshrrev_b32 v97, 1, v96
  v_lshrrev_b32 v98, 2, v96
  v_lshrrev_b32 v99, 3, v96
  s_waitcnt lgkmcnt(9)
  v_mfma_f32_32x32x16_bf16 v[144:159], v[124:127], v[60:63], v[144:159]
  ds_read_b128 v[76:79], v28 offset:7168
  ds_read_b64_tr_b16 v[140:141], v24 offset:28672
  ds_read_b64_tr_b16 v[142:143], v25 offset:28672
  v_lshrrev_b32 v100, 4, v96
  v_lshrrev_b32 v101, 5, v96
  v_lshrrev_b32 v102, 6, v96
  v_lshrrev_b32 v103, 7, v96
  s_waitcnt lgkmcnt(9)
  v_mfma_f32_32x32x16_bf16 v[144:159], v[128:131], v[64:67], v[144:159]
  ds_read_b64_tr_b16 v[112:113], v26 offset:0
  ds_read_b64_tr_b16 v[114:115], v27 offset:0
  v_lshrrev_b32 v105, 1, v104
  v_lshrrev_b32 v106, 2, v104
  v_lshrrev_b32 v107, 3, v104
  s_waitcnt lgkmcnt(8)
  v_mfma_f32_32x32x16_bf16 v[144:159], v[132:135], v[68:71], v[144:159]
  ds_read_b64_tr_b16 v[116:117], v26 offset:4096
  ds_read_b64_tr_b16 v[118:119], v27 offset:4096
  v_lshrrev_b32 v108, 4, v104
  v_lshrrev_b32 v109, 5, v104
  v_lshrrev_b32 v110, 6, v104
  v_lshrrev_b32 v111, 7, v104
  s_waitcnt lgkmcnt(7)
  v_mfma_f32_32x32x16_bf16 v[144:159], v[136:139], v[72:75], v[144:159]
  ds_read_b64_tr_b16 v[120:121], v26 offset:8192
  ds_read_b64_tr_b16 v[122:123], v27 offset:8192
  s_waitcnt lgkmcnt(6)
  v_mfma_f32_32x32x16_bf16 v[144:159], v[140:143], v[76:79], v[144:159]
  ds_read_b64_tr_b16 v[124:125], v26 offset:12288
  ds_read_b64_tr_b16 v[126:127], v27 offset:12288
  s_waitcnt lgkmcnt(6)
  v_mfma_f32_32x32x16_bf16 v[160:175], v[112:115], v[48:51], 0
  ds_read_b64_tr_b16 v[128:129], v26 offset:16384
  ds_read_b64_tr_b16 v[130:131], v27 offset:16384
  s_waitcnt lgkmcnt(6)
  v_mfma_f32_32x32x16_bf16 v[160:175], v[116:119], v[52:55], v[160:175]
  ds_read_b64_tr_b16 v[132:133], v26 offset:20480
  ds_read_b64_tr_b16 v[134:135], v27 offset:20480
  s_waitcnt lgkmcnt(6)
  v_mfma_f32_32x32x16_bf16 v[160:175], v[120:123], v[56:59], v[160:175]
  ds_read_b64_tr_b16 v[136:137], v26 offset:24576
  ds_read_b64_tr_b16 v[138:139], v27 offset:24576
  v_cvt_pk_bf16_f32 v80, v144, v145
  v_cvt_pk_bf16_f32 v81, v146, v147
  v_cvt_pk_bf16_f32 v82, v148, v149
  v_cvt_pk_bf16_f32 v83, v150, v151
  v_bfi_b32 v80, s53, v96, v80
  v_bfi_b32 v81, s53, v97, v81
  v_bfi_b32 v82, s53, v98, v82
  v_bfi_b32 v83, s53, v99, v83
  ds_write_b128 v244, v[80:83]
  s_waitcnt lgkmcnt(7)
  v_mfma_f32_32x32x16_bf16 v[160:175], v[124:127], v[60:63], v[160:175]
  ds_read_b64_tr_b16 v[140:141], v26 offset:28672
  ds_read_b64_tr_b16 v[142:143], v27 offset:28672
  v_cvt_pk_bf16_f32 v84, v152, v153
  v_cvt_pk_bf16_f32 v85, v154, v155
  v_cvt_pk_bf16_f32 v86, v156, v157
  v_cvt_pk_bf16_f32 v87, v158, v159
  v_bfi_b32 v84, s53, v100, v84
  v_bfi_b32 v85, s53, v101, v85
  v_bfi_b32 v86, s53, v102, v86
  v_bfi_b32 v87, s53, v103, v87
  ds_write_b128 v245, v[84:87]
  s_waitcnt lgkmcnt(8)
  v_mfma_f32_32x32x16_bf16 v[160:175], v[128:131], v[64:67], v[160:175]
  s_waitcnt lgkmcnt(6)
  v_mfma_f32_32x32x16_bf16 v[160:175], v[132:135], v[68:71], v[160:175]
  s_waitcnt lgkmcnt(4)
  v_mfma_f32_32x32x16_bf16 v[160:175], v[136:139], v[72:75], v[160:175]
  s_waitcnt lgkmcnt(1)
  v_mfma_f32_32x32x16_bf16 v[160:175], v[140:143], v[76:79], v[160:175]
  s_setprio 2
  s_nop 10
  v_cvt_pk_bf16_f32 v88, v160, v161
  v_cvt_pk_bf16_f32 v89, v162, v163
  v_cvt_pk_bf16_f32 v90, v164, v165
  v_cvt_pk_bf16_f32 v91, v166, v167
  v_bfi_b32 v88, s53, v104, v88
  v_bfi_b32 v89, s53, v105, v89
  v_bfi_b32 v90, s53, v106, v90
  v_bfi_b32 v91, s53, v107, v91
  ds_write_b128 v246, v[88:91]
  v_cvt_pk_bf16_f32 v92, v168, v169
  v_cvt_pk_bf16_f32 v93, v170, v171
  v_cvt_pk_bf16_f32 v94, v172, v173
  v_cvt_pk_bf16_f32 v95, v174, v175
  v_bfi_b32 v92, s53, v108, v92
  v_bfi_b32 v93, s53, v109, v93
  v_bfi_b32 v94, s53, v110, v94
  v_bfi_b32 v95, s53, v111, v95
  ds_write_b128 v247, v[92:95]
  ds_read_b128 v[112:115], v32 offset:0
  ds_read_b128 v[116:119], v32 offset:2048
  ds_read_b128 v[120:123], v32 offset:4096
  ds_read_b128 v[124:127], v32 offset:6144
  s_waitcnt lgkmcnt(3)
  buffer_store_dwordx4 v[112:115], v34, s[32:35], s87 offen offset:0 sc1
  s_waitcnt lgkmcnt(2)
  buffer_store_dwordx4 v[116:119], v34, s[32:35], s87 offen offset:1024 sc1
  s_waitcnt lgkmcnt(1)
  buffer_store_dwordx4 v[120:123], v34, s[32:35], s87 offen offset:2048 sc1
  s_waitcnt lgkmcnt(0)
  buffer_store_dwordx4 v[124:127], v34, s[32:35], s87 offen offset:3072 sc1
  s_setprio 0
  s_barrier
  s_cmp_lg_u32 s3, 7
  s_cbranch_scc1 L_nolse2
  v_or_b32 v23, 1, v23
  s_mov_b32 exec_hi, 0
  buffer_store_dwordx4 v[20:23], v248, s[32:35], s74 offen sc1
  s_mov_b32 exec_hi, -1
L_nolse2:
  s_mov_b32 s73, 0
  s_or_b32 s69, s48, 1
  buffer_load_dwordx4 v[8:11], v35, s[32:35], s70 offen offset:0 sc1
  buffer_load_dwordx4 v[12:15], v35, s[32:35], s71 offen offset:0 sc1
  buffer_load_dwordx4 v[16:19], v35, s[32:35], 0 offen offset:0 sc1
  buffer_load_dwordx4 v[20:23], v35, s[32:35], s72 offen offset:0 sc1
  s_cmp_lt_u32 s2, 128
  s_cbranch_scc1 L_prepA
  s_and_b32 s92, s3, 3
  s_mul_i32 s92, s92, 7552
  s_add_u32 s92, s92, 0x5000
  v_lshrrev_b32 v62, 5, v1
  v_mul_u32_u24 v62, 928, v62
  v_and_b32 v3, 31, v1
  v_lshl_add_u32 v62, v3, 4, v62
  v_add_u32 v62, s92, v62
  s_lshl_b32 s92, s3, 6
  v_lshrrev_b32 v63, 4, v1
  v_mul_u32_u24 v63, 7552, v63
  v_bfe_u32 v3, v1, 2, 2
  v_mul_u32_u24 v3, 928, v3
  v_add_u32 v63, v3, v63
  v_and_b32 v3, 3, v1
  v_lshl_add_u32 v63, v3, 3, v63
  v_add_u32 v63, 20480, v63
  v_add_u32 v63, s92, v63
  s_mul_i32 s82, s80, 28672
  s_lshl_b32 s97, s3, 12
  s_add_u32 s82, s82, s97
  s_lshl_b32 s97, s79, 8
  s_add_u32 s82, s82, s97
  s_lshr_b32 s92, s79, 1
  s_lshl_b32 s92, s92, 10
  s_and_b32 s97, s79, 1
  s_lshl_b32 s97, s97, 7
  s_add_u32 s92, s92, s97
  s_add_u32 s92, s92, 0x4000
  v_bfe_u32 v56, v1, 3, 1
  v_lshlrev_b32 v56, 13, v56
  v_lshrrev_b32 v3, 4, v1
  v_lshl_add_u32 v56, v3, 8, v56
  v_and_b32 v3, 7, v1
  v_lshl_add_u32 v56, v3, 4, v56
  v_add_u32 v56, s92, v56
  v_and_b32 v60, 31, v1
  v_lshlrev_b32 v60, 5, v60
  v_add_u32 v60, 90112, v60
  s_lshl_b32 s92, s3, 2
  s_add_u32 s92, s92, 0x16000
  v_and_b32 v59, 7, v1
  v_lshlrev_b32 v59, 7, v59
  v_lshrrev_b32 v3, 4, v1
  v_lshl_add_u32 v59, v3, 5, v59
  v_add_u32 v59, s92, v59
  s_lshl_b32 s92, s3, 7
  s_add_u32 s92, s92, 0x16c00
  v_and_b32 v57, 31, v1
  v_lshlrev_b32 v57, 1, v57
  v_add_u32 v57, s92, v57
  s_mul_i32 s90, s79, 4224
  s_lshl_b32 s97, s3, 9
  s_add_u32 s90, s90, s97
  s_add_u32 s90, s90, 0x60000
  v_and_b32 v61, 31, v1
  v_lshlrev_b32 v61, 4, v61
  v_and_b32 v58, 3, v1
  v_lshlrev_b32 v58, 6, v58
  v_lshrrev_b32 v3, 4, v1
  v_lshl_add_u32 v58, v3, 4, v58
  s_nop 0
  s_branch L_prep2
L_prepA:
  s_sub_u32 s92, s79, 7
  s_cmp_ge_u32 s79, 7
  s_cselect_b32 s92, s92, s79
  s_cselect_b32 s93, 1, 0
  s_mul_i32 s81, s80, 7
  s_add_u32 s81, s81, s92
  s_lshl_b32 s91, s81, 15
  s_lshl_b32 s97, s3, 12
  s_add_u32 s91, s91, s97
  s_lshl_b32 s97, s93, 9
  s_add_u32 s91, s91, s97
  s_mul_i32 s75, s77, 16896
  s_lshr_b32 s97, s3, 1
  s_mul_i32 s97, s97, 4224
  s_add_u32 s75, s75, s97
  s_lshl_b32 s97, s76, 7
  s_add_u32 s75, s75, s97
  s_and_b32 s97, s3, 1
  s_lshl_b32 s97, s97, 6
  s_add_u32 s75, s75, s97
  s_add_u32 s75, s75, 0x60000
  s_mul_i32 s90, s93, 67584
  s_mul_i32 s97, s3, 8448
  s_add_u32 s90, s90, s97
  s_lshl_b32 s97, s81, 7
  s_add_u32 s90, s90, s97
  s_add_u32 s90, s90, 0xa0000
  s_mul_i32 s92, s3, 2176
  s_lshr_b32 s97, s3, 1
  s_lshl_b32 s97, s97, 7
  s_add_u32 s92, s92, s97
  s_add_u32 s92, s92, 0xe800
  v_lshrrev_b32 v62, 5, v1
  v_mul_u32_u24 v62, 544, v62
  v_and_b32 v3, 31, v1
  v_lshl_add_u32 v62, v3, 4, v62
  v_add_u32 v62, s92, v62
  s_lshl_b32 s92, s3, 6
  v_lshrrev_b32 v63, 4, v1
  v_mul_u32_u24 v63, 4480, v63
  v_bfe_u32 v3, v1, 2, 2
  v_mul_u32_u24 v3, 544, v3
  v_add_u32 v63, v3, v63
  v_and_b32 v3, 3, v1
  v_lshl_add_u32 v63, v3, 3, v63
  v_add_u32 v63, 59392, v63
  v_add_u32 v63, s92, v63
  s_lshl_b32 s82, s81, 12
  s_lshl_b32 s97, s3, 9
  s_add_u32 s82, s82, s97
  s_add_u32 s82, s82, 0xd0000
  s_lshl_b32 s92, s3, 7
  s_add_u32 s92, s92, 0x16c00
  v_and_b32 v57, 7, v1
  v_lshlrev_b32 v57, 3, v57
  v_lshrrev_b32 v3, 4, v1
  v_lshl_add_u32 v57, v3, 1, v57
  v_add_u32 v57, s92, v57
  v_and_b32 v61, 31, v1
  v_lshlrev_b32 v61, 4, v61
  v_and_b32 v58, 1, v1
  v_lshlrev_b32 v58, 6, v58
  v_lshrrev_b32 v3, 4, v1
  v_lshl_add_u32 v58, v3, 4, v58
  s_lshl_b32 s92, s80, 11
  v_and_b32 v56, 15, v1
  v_lshlrev_b32 v56, 7, v56
  v_add_u32 v56, 98304, v56
  v_add_u32 v56, s92, v56
  s_lshl_b32 s92, s3, 2
  s_add_u32 s92, s92, 0x14800
  v_lshlrev_b32 v59, 5, v1
  v_add_u32 v59, s92, v59
  s_bfe_u32 s92, s3, 0x10002
  s_lshl_b32 s92, s92, 10
  s_and_b32 s97, s3, 3
  s_lshl_b32 s97, s97, 2
  s_add_u32 s92, s92, s97
  s_add_u32 s92, s92, 0x15800
  v_lshlrev_b32 v60, 4, v1
  v_add_u32 v60, s92, v60
L_prep2:
  s_cmp_eq_u32 s101, 1
  s_cbranch_scc1 L_nsg
  s_cmp_eq_u32 s101, 2
  s_cbranch_scc1 L_nsg
  s_waitcnt vmcnt(8)
  ds_write_b128 v240, v[176:179] offset:0
  ds_write_b128 v240, v[180:183] offset:1152
  ds_write_b128 v240, v[184:187] offset:2432
  ds_write_b128 v240, v[188:191] offset:3584
  s_cmp_lt_u32 s2, 128
  s_cbranch_scc1 L_sf_36a
  s_mov_b32 exec_lo, 0xfffffff
  s_mov_b32 exec_hi, 0xfffffff
  ds_write_b128 v62, v[208:211] offset:0
  ds_write_b128 v62, v[212:215] offset:448
  ds_write_b128 v62, v[216:219] offset:1856
  ds_write_b128 v62, v[220:223] offset:2304
  ds_write_b128 v62, v[224:227] offset:3712
  ds_write_b128 v62, v[228:231] offset:4160
  ds_write_b128 v62, v[232:235] offset:5568
  ds_write_b128 v62, v[236:239] offset:6016
  s_mov_b64 exec, -1
  s_branch L_sf_36x
L_sf_36a:
  ds_write_b128 v241, v[208:211] offset:0
  ds_write_b128 v241, v[212:215] offset:1152
  ds_write_b128 v241, v[216:219] offset:2432
  ds_write_b128 v241, v[220:223] offset:3584
  ds_write_b128 v241, v[224:227] offset:4864
  ds_write_b128 v241, v[228:231] offset:6016
  ds_write_b128 v241, v[232:235] offset:7296
  ds_write_b128 v241, v[236:239] offset:8448
L_sf_36x:
L_nsg:
  s_waitcnt vmcnt(0)
  s_mov_b32 s100, 0
L_p1:
  v_cmp_ne_u32 s[60:61], s69, v11
  v_cmp_ne_u32 s[62:63], s69, v15
  v_cmp_ne_u32 s[64:65], s69, v19
  v_cmp_ne_u32 s[66:67], s69, v23
  v_xor_b32 v44, s69, v11
  v_bitop3_b32 v44, v15, s69, v44 bitop3:0xbe
  v_bitop3_b32 v44, v19, s69, v44 bitop3:0xbe
  v_bitop3_b32 v44, v23, s69, v44 bitop3:0xbe
  v_cmp_lt_u32 s[92:93], 1, v44
  s_mov_b32 s94, 0
  s_cmp_eq_u64 s[92:93], 0
  s_cbranch_scc1 L_p1d
  s_add_u32 s100, s100, 1
  s_cmp_gt_u32 s100, 100000
  s_cbranch_scc1 L_abort
  s_mov_b64 exec, s[60:61]
  s_cbranch_execz L_ll_37
  buffer_load_dwordx4 v[8:11], v35, s[32:35], s70 offen offset:0 sc1
L_ll_37:
  s_mov_b64 exec, s[62:63]
  s_cbranch_execz L_ll_38
  buffer_load_dwordx4 v[12:15], v35, s[32:35], s71 offen offset:0 sc1
L_ll_38:
  s_mov_b64 exec, s[64:65]
  s_cbranch_execz L_ll_39
  buffer_load_dwordx4 v[16:19], v35, s[32:35], 0 offen offset:0 sc1
L_ll_39:
  s_mov_b64 exec, s[66:67]
  s_cbranch_execz L_ll_40
  buffer_load_dwordx4 v[20:23], v35, s[32:35], s72 offen offset:0 sc1
L_ll_40:
  s_mov_b64 exec, -1
L_p1d:
  s_bitcmp1_b32 s73, 0
  s_cbranch_scc1 L_lp_41
  s_cmp_lg_u64 s[60:61], 0
  s_cbranch_scc1 L_lp_41
  s_bitset1_b32 s73, 0
  s_add_u32 s94, s94, 1
  buffer_load_dwordx4 v[128:131], v36, s[32:35], s83 offen offset:0 sc1
L_lp_41:
  s_bitcmp1_b32 s73, 1
  s_cbranch_scc1 L_lp_42
  s_cmp_lg_u64 s[62:63], 0
  s_cbranch_scc1 L_lp_42
  s_bitset1_b32 s73, 1
  s_add_u32 s94, s94, 1
  buffer_load_dwordx4 v[132:135], v36, s[32:35], s84 offen offset:0 sc1
L_lp_42:
  s_bitcmp1_b32 s73, 2
  s_cbranch_scc1 L_lp_43
  s_cmp_lg_u64 s[64:65], 0
  s_cbranch_scc1 L_lp_43
  s_bitset1_b32 s73, 2
  s_add_u32 s94, s94, 1
  buffer_load_dwordx4 v[136:139], v36, s[32:35], s85 offen offset:0 sc1
L_lp_43:
  s_bitcmp1_b32 s73, 3
  s_cbranch_scc1 L_lp_44
  s_cmp_lg_u64 s[66:67], 0
  s_cbranch_scc1 L_lp_44
  s_bitset1_b32 s73, 3
  s_add_u32 s94, s94, 1
  buffer_load_dwordx4 v[140:143], v36, s[32:35], s86 offen offset:0 sc1
L_lp_44:
  s_cmp_eq_u64 s[92:93], 0
  s_cbranch_scc1 L_p1x
  s_cmp_eq_u32 s94, 0
  s_cbranch_scc0 L_pw0
  s_waitcnt vmcnt(0)
  s_branch L_p1
L_pw0:
  s_cmp_eq_u32 s94, 1
  s_cbranch_scc0 L_pw1
  s_waitcnt vmcnt(1)
  s_branch L_p1
L_pw1:
  s_cmp_eq_u32 s94, 2
  s_cbranch_scc0 L_pw2
  s_waitcnt vmcnt(2)
  s_branch L_p1
L_pw2:
  s_cmp_eq_u32 s94, 3
  s_cbranch_scc0 L_pw3
  s_waitcnt vmcnt(3)
  s_branch L_p1
L_pw3:
  s_waitcnt vmcnt(4)
  s_branch L_p1
L_p1x:
  v_max3_f32 v44, v8, v12, v16
  v_max_f32 v44, v44, v20
  s_nop 1
  v_max_f32_dpp v44, v44, v44 row_ror:8 row_mask:0xf bank_mask:0xf
  v_mov_b32 v45, v44
  s_nop 1
  v_permlane16_swap_b32 v44, v45
  v_max_f32 v44, v44, v45
  v_mov_b32 v45, v44
  s_nop 1
  v_permlane32_swap_b32 v44, v45
  v_max_f32 v44, v44, v45
  s_lshl_b32 s92, s3, 2
  s_add_u32 s92, s92, 92160
  v_mov_b32 v47, s92
  v_mov_b32 v46, 92160
  ds_write_b32 v47, v44
  s_waitcnt lgkmcnt(0)
  s_barrier
  ds_read_b128 v[144:147], v46
  ds_read_b128 v[148:151], v46 offset:16
  ds_read_b64_tr_b16 v[48:49], v242 offset:0
  ds_read_b64_tr_b16 v[50:51], v242 offset:1152
  ds_read_b64_tr_b16 v[52:53], v242 offset:9728
  ds_read_b64_tr_b16 v[54:55], v242 offset:10880
  s_waitcnt lgkmcnt(4)
  v_max3_f32 v44, v144, v145, v146
  v_max3_f32 v45, v147, v148, v149
  v_max3_f32 v44, v44, v150, v151
  v_max_f32 v44, v44, v45
  v_sub_f32 v152, v8, v44
  v_sub_f32 v153, v12, v44
  v_sub_f32 v154, v16, v44
  v_sub_f32 v155, v20, v44
  v_exp_f32 v152, v152
  v_exp_f32 v153, v153
  v_exp_f32 v154, v154
  v_exp_f32 v155, v155
  v_cvt_pk_bf16_f32 v152, v152, v152
  v_cvt_pk_bf16_f32 v153, v153, v153
  v_cvt_pk_bf16_f32 v154, v154, v154
  v_cvt_pk_bf16_f32 v155, v155, v155
  v_lshrrev_b32 v156, 16, v152
  v_lshrrev_b32 v157, 16, v153
  v_lshrrev_b32 v158, 16, v154
  v_lshrrev_b32 v159, 16, v155
  v_and_b32 v152, 0xffff0000, v152
  v_and_b32 v153, 0xffff0000, v153
  v_and_b32 v154, 0xffff0000, v154
  v_and_b32 v155, 0xffff0000, v155
  v_mul_f32 v44, v152, v9
  v_fmac_f32 v44, v153, v13
  v_fmac_f32 v44, v154, v17
  v_fmac_f32 v44, v155, v21
  s_nop 1
  v_add_f32_dpp v44, v44, v44 row_ror:8 row_mask:0xf bank_mask:0xf
  v_mov_b32 v45, v44
  s_nop 1
  v_permlane16_swap_b32 v44, v45
  v_add_f32 v44, v44, v45
  v_mov_b32 v45, v44
  s_nop 1
  v_permlane32_swap_b32 v44, v45
  v_add_f32 v44, v44, v45
  ds_write_b32 v47, v44 offset:32
  s_cmp_lt_u32 s2, 128
  s_cbranch_scc1 L_fgA
  ds_read_b64_tr_b16 v[80:81], v63 offset:0
  ds_read_b64_tr_b16 v[82:83], v63 offset:3712
  ds_read_b64_tr_b16 v[84:85], v63 offset:32
  ds_read_b64_tr_b16 v[86:87], v63 offset:3744
  ds_read_b64_tr_b16 v[88:89], v63 offset:448
  ds_read_b64_tr_b16 v[90:91], v63 offset:4160
  ds_read_b64_tr_b16 v[92:93], v63 offset:480
  ds_read_b64_tr_b16 v[94:95], v63 offset:4192
  s_branch L_fgx
L_fgA:
  ds_read_b64_tr_b16 v[80:81], v243 offset:0
  ds_read_b64_tr_b16 v[82:83], v243 offset:1152
  ds_read_b64_tr_b16 v[84:85], v243 offset:9728
  ds_read_b64_tr_b16 v[86:87], v243 offset:10880
  ds_read_b64_tr_b16 v[88:89], v243 offset:19456
  ds_read_b64_tr_b16 v[90:91], v243 offset:20608
  ds_read_b64_tr_b16 v[92:93], v243 offset:29184
  ds_read_b64_tr_b16 v[94:95], v243 offset:30336
L_fgx:
  s_waitcnt lgkmcnt(0)
  s_barrier
  ds_read_b128 v[160:163], v46 offset:32
  ds_read_b128 v[164:167], v46 offset:48
  v_mov_b32 v144, 0
  v_mov_b32 v145, 0
  v_mov_b32 v146, 0
  v_mov_b32 v147, 0
  v_mov_b32 v148, 0
  v_mov_b32 v149, 0
  v_mov_b32 v150, 0
  v_mov_b32 v151, 0
  s_waitcnt lgkmcnt(0)
  v_add_f32 v160, v160, v161
  v_add_f32 v162, v162, v163
  v_add_f32 v164, v164, v165
  v_add_f32 v166, v166, v167
  v_add_f32 v160, v160, v162
  v_add_f32 v164, v164, v166
  v_add_f32 v160, v160, v164
  v_rcp_f32 v168, v160
  s_bitcmp1_b32 s73, 0
  s_cbranch_scc1 L_ir_45
  buffer_load_dwordx4 v[128:131], v36, s[32:35], s83 offen offset:0 sc1
L_ir_45:
  s_bitcmp1_b32 s73, 1
  s_cbranch_scc1 L_ir_46
  buffer_load_dwordx4 v[132:135], v36, s[32:35], s84 offen offset:0 sc1
L_ir_46:
  s_bitcmp1_b32 s73, 2
  s_cbranch_scc1 L_ir_47
  buffer_load_dwordx4 v[136:139], v36, s[32:35], s85 offen offset:0 sc1
L_ir_47:
  s_bitcmp1_b32 s73, 3
  s_cbranch_scc1 L_ir_48
  buffer_load_dwordx4 v[140:143], v36, s[32:35], s86 offen offset:0 sc1
L_ir_48:
  s_or_b32 s73, s73, 15
  s_mov_b32 s100, 0
L_p2:
  s_mov_b32 s95, s73
  s_waitcnt vmcnt(0)
  s_bitcmp1_b32 s95, 0
  s_cbranch_scc0 L_dc_49
  s_bitcmp1_b32 s95, 4
  s_cbranch_scc1 L_dc_49
  v_xor_b32 v44, v128, v4
  v_bitop3_b32 v44, v129, v5, v44 bitop3:0xbe
  v_bitop3_b32 v44, v130, v6, v44 bitop3:0xbe
  v_bitop3_b32 v44, v131, v7, v44 bitop3:0xbe
  v_and_b32 v44, s53, v44
  v_cmp_ne_u32 vcc, 0, v44
  s_nop 0
  s_cbranch_vccz L_dc_49k
  s_sleep 1
  buffer_load_dwordx4 v[128:131], v36, s[32:35], s83 offen offset:0 sc1
  s_branch L_dc_49
L_dc_49k:
  s_bitset1_b32 s73, 4
  v_dot2c_f32_bf16 v144, v156, v128
  v_dot2c_f32_bf16 v145, v152, v128
  v_dot2c_f32_bf16 v146, v156, v129
  v_dot2c_f32_bf16 v147, v152, v129
  v_dot2c_f32_bf16 v148, v156, v130
  v_dot2c_f32_bf16 v149, v152, v130
  v_dot2c_f32_bf16 v150, v156, v131
  v_dot2c_f32_bf16 v151, v152, v131
L_dc_49:
  s_bitcmp1_b32 s95, 1
  s_nop 0
  s_cbranch_scc0 L_dc_50
  s_bitcmp1_b32 s95, 5
  s_cbranch_scc1 L_dc_50
  v_xor_b32 v44, v132, v4
  v_bitop3_b32 v44, v133, v5, v44 bitop3:0xbe
  v_bitop3_b32 v44, v134, v6, v44 bitop3:0xbe
  v_bitop3_b32 v44, v135, v7, v44 bitop3:0xbe
  v_and_b32 v44, s53, v44
  v_cmp_ne_u32 vcc, 0, v44
  s_nop 0
  s_cbranch_vccz L_dc_50k
  s_sleep 1
  buffer_load_dwordx4 v[132:135], v36, s[32:35], s84 offen offset:0 sc1
  s_branch L_dc_50
L_dc_50k:
  s_bitset1_b32 s73, 5
  v_dot2c_f32_bf16 v144, v157, v132
  v_dot2c_f32_bf16 v145, v153, v132
  v_dot2c_f32_bf16 v146, v157, v133
  v_dot2c_f32_bf16 v147, v153, v133
  v_dot2c_f32_bf16 v148, v157, v134
  v_dot2c_f32_bf16 v149, v153, v134
  v_dot2c_f32_bf16 v150, v157, v135
  v_dot2c_f32_bf16 v151, v153, v135
L_dc_50:
  s_bitcmp1_b32 s95, 2
  s_nop 0
  s_cbranch_scc0 L_dc_51
  s_bitcmp1_b32 s95, 6
  s_cbranch_scc1 L_dc_51
  v_xor_b32 v44, v136, v4
  v_bitop3_b32 v44, v137, v5, v44 bitop3:0xbe
  v_bitop3_b32 v44, v138, v6, v44 bitop3:0xbe
  v_bitop3_b32 v44, v139, v7, v44 bitop3:0xbe
  v_and_b32 v44, s53, v44
  v_cmp_ne_u32 vcc, 0, v44
  s_nop 0
  s_cbranch_vccz L_dc_51k
  s_sleep 1
  buffer_load_dwordx4 v[136:139], v36, s[32:35], s85 offen offset:0 sc1
  s_branch L_dc_51
L_dc_51k:
  s_bitset1_b32 s73, 6
  v_dot2c_f32_bf16 v144, v158, v136
  v_dot2c_f32_bf16 v145, v154, v136
  v_dot2c_f32_bf16 v146, v158, v137
  v_dot2c_f32_bf16 v147, v154, v137
  v_dot2c_f32_bf16 v148, v158, v138
  v_dot2c_f32_bf16 v149, v154, v138
  v_dot2c_f32_bf16 v150, v158, v139
  v_dot2c_f32_bf16 v151, v154, v139
L_dc_51:
  s_bitcmp1_b32 s95, 3
  s_nop 0
  s_cbranch_scc0 L_dc_52
  s_bitcmp1_b32 s95, 7
  s_cbranch_scc1 L_dc_52
  v_xor_b32 v44, v140, v4
  v_bitop3_b32 v44, v141, v5, v44 bitop3:0xbe
  v_bitop3_b32 v44, v142, v6, v44 bitop3:0xbe
  v_bitop3_b32 v44, v143, v7, v44 bitop3:0xbe
  v_and_b32 v44, s53, v44
  v_cmp_ne_u32 vcc, 0, v44
  s_nop 0
  s_cbranch_vccz L_dc_52k
  s_sleep 1
  buffer_load_dwordx4 v[140:143], v36, s[32:35], s86 offen offset:0 sc1
  s_branch L_dc_52
L_dc_52k:
  s_bitset1_b32 s73, 7
  v_dot2c_f32_bf16 v144, v159, v140
  v_dot2c_f32_bf16 v145, v155, v140
  v_dot2c_f32_bf16 v146, v159, v141
  v_dot2c_f32_bf16 v147, v155, v141
  v_dot2c_f32_bf16 v148, v159, v142
  v_dot2c_f32_bf16 v149, v155, v142
  v_dot2c_f32_bf16 v150, v159, v143
  v_dot2c_f32_bf16 v151, v155, v143
L_dc_52:
  s_cmp_eq_u32 s73, 0xff
  s_nop 0
  s_cbranch_scc1 L_p2x
  s_add_u32 s100, s100, 1
  s_cmp_gt_u32 s100, 100000
  s_cbranch_scc1 L_abort
  s_branch L_p2
L_p2x:
  v_permlane32_swap_b32 v144, v148
  v_permlane32_swap_b32 v145, v149
  v_permlane32_swap_b32 v146, v150
  v_permlane32_swap_b32 v147, v151
  v_add_f32 v144, v144, v148
  v_add_f32 v145, v145, v149
  v_add_f32 v146, v146, v150
  v_add_f32 v147, v147, v151
  s_nop 0
  v_permlane16_swap_b32 v144, v146
  v_permlane16_swap_b32 v145, v147
  v_add_f32 v144, v144, v146
  v_add_f32 v145, v145, v147
  s_nop 0
  v_add_f32_dpp v144, v144, v144 row_ror:8 row_mask:0xf bank_mask:0xf
  v_add_f32_dpp v145, v145, v145 row_ror:8 row_mask:0xf bank_mask:0xf
  v_mul_f32 v144, v144, v168
  v_mul_f32 v145, v145, v168
  v_cvt_pk_bf16_f32 v44, v144, v145
  ds_write_b32 v37, v44
  s_waitcnt lgkmcnt(0)
  s_barrier
  ds_read_b128 v[160:163], v38
  ds_read_b128 v[164:167], v38 offset:64
  s_waitcnt lgkmcnt(1)
  v_mfma_f32_16x16x32_bf16 v[144:147], v[48:51], v[160:163], 0
  s_waitcnt lgkmcnt(0)
  v_mfma_f32_16x16x32_bf16 v[144:147], v[52:55], v[164:167], v[144:147]
  s_nop 7
  v_add_f32_dpp v144, v144, v144 quad_perm:[1,0,3,2] row_mask:0xf bank_mask:0xf
  v_add_f32_dpp v145, v145, v145 quad_perm:[1,0,3,2] row_mask:0xf bank_mask:0xf
  v_add_f32_dpp v146, v146, v146 quad_perm:[1,0,3,2] row_mask:0xf bank_mask:0xf
  v_add_f32_dpp v147, v147, v147 quad_perm:[1,0,3,2] row_mask:0xf bank_mask:0xf
  v_add_f32_dpp v144, v144, v144 quad_perm:[2,3,0,1] row_mask:0xf bank_mask:0xf
  v_add_f32_dpp v145, v145, v145 quad_perm:[2,3,0,1] row_mask:0xf bank_mask:0xf
  v_add_f32_dpp v146, v146, v146 quad_perm:[2,3,0,1] row_mask:0xf bank_mask:0xf
  v_add_f32_dpp v147, v147, v147 quad_perm:[2,3,0,1] row_mask:0xf bank_mask:0xf
  v_add_f32_dpp v144, v144, v144 row_half_mirror row_mask:0xf bank_mask:0xf
  v_add_f32_dpp v145, v145, v145 row_half_mirror row_mask:0xf bank_mask:0xf
  v_add_f32_dpp v146, v146, v146 row_half_mirror row_mask:0xf bank_mask:0xf
  v_add_f32_dpp v147, v147, v147 row_half_mirror row_mask:0xf bank_mask:0xf
  s_mov_b32 exec_lo, 0x10001
  s_mov_b32 exec_hi, 0x10001
  v_and_or_b32 v144, v144, v2, s49
  v_and_or_b32 v145, v145, v2, s50
  v_and_or_b32 v146, v146, v2, s51
  v_and_or_b32 v147, v147, v2, s52
  buffer_store_dwordx4 v[144:147], v1, s[32:35], s16 offen
  v_mov_b32 v8, v144
  v_mov_b32 v9, v145
  v_mov_b32 v10, v146
  v_mov_b32 v11, v147
  s_mov_b64 exec, -1
  s_mov_b32 s69, 0
  s_mov_b32 s66, 0
  s_cmp_lt_u32 s2, 128
  s_cbranch_scc0 L_X
  s_mov_b32 s60, 0xffffffff
  s_mov_b32 s61, 0x0
  s_mov_b32 s100, 0
  s_branch L_gf_54
L_g_53:
  s_add_u32 s100, s100, 1
  s_cmp_gt_u32 s100, 100000
  s_cbranch_scc1 L_abort
  s_sleep 1
  s_cmp_lg_u32 s100, 30
  s_cbranch_scc1 L_alt_56
  s_cmp_lg_u32 s69, 0
  s_cbranch_scc1 L_cg_57
  s_mov_b32 exec_lo, 0x10001
  s_mov_b32 exec_hi, 0x10001
  s_add_u32 s97, s16, 0x160000
  buffer_store_dwordx4 v[8:11], v1, s[32:35], s97 offen sc1
  s_mov_b32 s69, 1
  s_mov_b64 exec, -1
L_cg_57:
  s_add_u32 s66, s66, 0x160000
L_alt_56:
L_gf_54:
  s_mov_b64 exec, s[60:61]
  buffer_load_dwordx4 v[128:131], v39, s[32:35], s66 offen offset:0 sc1
  s_waitcnt vmcnt(0)
L_gc_55:
  s_mov_b64 exec, s[60:61]
  v_perm_b32 v44, v129, v128, s56
  v_perm_b32 v44, v130, v44, s57
  v_perm_b32 v44, v131, v44, s58
  v_cmp_ne_u32 s[60:61], s48, v44
  s_nop 0
  s_cmp_lg_u64 s[60:61], 0
  s_cbranch_scc1 L_g_53
  s_mov_b64 exec, -1
  v_cvt_pk_bf16_f32 v44, v128, v129
  v_cvt_pk_bf16_f32 v45, v130, v131
  s_mov_b32 exec_hi, 0
  ds_write_b64 v43, v[44:45]
  s_mov_b32 exec_hi, -1
  s_cmp_lg_u32 s69, 0
  s_cbranch_scc1 L_cg_59
  s_mov_b32 exec_lo, 0x10001
  s_mov_b32 exec_hi, 0x10001
  s_add_u32 s97, s16, 0x160000
  buffer_store_dwordx4 v[8:11], v1, s[32:35], s97 offen sc1
  s_mov_b32 s69, 1
  s_mov_b64 exec, -1
L_cg_59:
  s_waitcnt lgkmcnt(0)
  s_barrier
  ds_read_b128 v[128:131], v40 offset:0
  ds_read_b128 v[132:135], v40 offset:64
  ds_read_b128 v[136:139], v40 offset:128
  ds_read_b128 v[140:143], v40 offset:192
  s_waitcnt lgkmcnt(3)
  v_mfma_f32_16x16x32_bf16 v[144:147], v[80:83], v[128:131], 0
  s_waitcnt lgkmcnt(2)
  v_mfma_f32_16x16x32_bf16 v[144:147], v[84:87], v[132:135], v[144:147]
  s_waitcnt lgkmcnt(1)
  v_mfma_f32_16x16x32_bf16 v[144:147], v[88:91], v[136:139], v[144:147]
  s_waitcnt lgkmcnt(0)
  v_mfma_f32_16x16x32_bf16 v[144:147], v[92:95], v[140:143], v[144:147]
  s_nop 7
  v_add_f32_dpp v144, v144, v144 quad_perm:[1,0,3,2] row_mask:0xf bank_mask:0xf
  v_add_f32_dpp v145, v145, v145 quad_perm:[1,0,3,2] row_mask:0xf bank_mask:0xf
  v_add_f32_dpp v146, v146, v146 quad_perm:[1,0,3,2] row_mask:0xf bank_mask:0xf
  v_add_f32_dpp v147, v147, v147 quad_perm:[1,0,3,2] row_mask:0xf bank_mask:0xf
  v_add_f32_dpp v144, v144, v144 quad_perm:[2,3,0,1] row_mask:0xf bank_mask:0xf
  v_add_f32_dpp v145, v145, v145 quad_perm:[2,3,0,1] row_mask:0xf bank_mask:0xf
  v_add_f32_dpp v146, v146, v146 quad_perm:[2,3,0,1] row_mask:0xf bank_mask:0xf
  v_add_f32_dpp v147, v147, v147 quad_perm:[2,3,0,1] row_mask:0xf bank_mask:0xf
  v_add_f32_dpp v144, v144, v144 row_half_mirror row_mask:0xf bank_mask:0xf
  v_add_f32_dpp v145, v145, v145 row_half_mirror row_mask:0xf bank_mask:0xf
  v_add_f32_dpp v146, v146, v146 row_half_mirror row_mask:0xf bank_mask:0xf
  v_add_f32_dpp v147, v147, v147 row_half_mirror row_mask:0xf bank_mask:0xf
  s_mov_b32 exec_lo, 0x10001
  s_mov_b32 exec_hi, 0x10001
  v_and_or_b32 v144, v144, v2, s49
  v_and_or_b32 v145, v145, v2, s50
  v_and_or_b32 v146, v146, v2, s51
  v_and_or_b32 v147, v147, v2, s52
  buffer_store_dwordx4 v[144:147], v1, s[32:35], s75 offen sc1
  s_mov_b64 exec, -1
  s_branch L_Y
L_X:
  s_cmp_lg_u32 s69, 0
  s_cbranch_scc1 L_cg_60
  s_mov_b32 exec_lo, 0x10001
  s_mov_b32 exec_hi, 0x10001
  s_add_u32 s97, s16, 0x160000
  buffer_store_dwordx4 v[8:11], v1, s[32:35], s97 offen sc1
  s_mov_b32 s69, 1
  s_mov_b64 exec, -1
L_cg_60:
  s_lshl_b32 s92, s79, 6
  v_and_b32 v44, 31, v1
  v_lshlrev_b32 v44, 1, v44
  v_add_u32 v44, s92, v44
  global_load_ushort v66, v44, s[4:5]
  s_movk_i32 s68, 0x4000
  buffer_load_dwordx4 v[68:71], v56, s[32:35], 0 offen offset:0 sc1
  buffer_load_dwordx4 v[72:75], v56, s[32:35], s68 offen offset:0 sc1
  s_waitcnt vmcnt(0)
  s_mov_b64 s[60:61], -1
  s_waitcnt vmcnt(63)
  s_mov_b32 s100, 0
  s_branch L_gc_64
L_g_62:
  s_add_u32 s100, s100, 1
  s_cmp_gt_u32 s100, 100000
  s_cbranch_scc1 L_abort
  s_sleep 2
L_gf_63:
  s_mov_b64 exec, s[60:61]
  buffer_load_dwordx4 v[68:71], v56, s[32:35], 0 offen offset:0 sc1
  buffer_load_dwordx4 v[72:75], v56, s[32:35], s68 offen offset:0 sc1
  s_waitcnt vmcnt(0)
L_gc_64:
  s_mov_b64 exec, s[60:61]
  v_perm_b32 v44, v69, v68, s56
  v_perm_b32 v44, v70, v44, s57
  v_perm_b32 v44, v71, v44, s58
  v_cmp_ne_u32 s[60:61], s48, v44
  v_perm_b32 v44, v73, v72, s56
  v_perm_b32 v44, v74, v44, s57
  v_perm_b32 v44, v75, v44, s58
  v_cmp_ne_u32 vcc, s48, v44
  s_nop 0
  s_or_b64 s[60:61], s[60:61], vcc
  s_cmp_lg_u64 s[60:61], 0
  s_cbranch_scc1 L_g_62
  s_mov_b64 exec, -1
  v_permlane32_swap_b32 v68, v70
  v_permlane32_swap_b32 v69, v71
  v_add_f32 v68, v68, v70
  v_add_f32 v69, v69, v71
  s_nop 1
  v_permlane16_swap_b32 v68, v69
  v_add_f32 v68, v68, v69
  v_permlane32_swap_b32 v72, v74
  v_permlane32_swap_b32 v73, v75
  v_add_f32 v72, v72, v74
  v_add_f32 v73, v73, v75
  s_nop 1
  v_permlane16_swap_b32 v72, v73
  v_add_f32 v72, v72, v73
  v_cvt_pk_bf16_f32 v44, v68, v68
  v_and_b32 v68, 0xffff0000, v44
  v_cvt_pk_bf16_f32 v45, v72, v72
  v_and_b32 v72, 0xffff0000, v45
  v_and_b32 v44, 3, v1
  v_lshlrev_b32 v44, 6, v44
  v_bfe_u32 v3, v1, 2, 3
  v_lshl_add_u32 v44, v3, 2, v44
  ds_bpermute_b32 v76, v44, v68 offset:0
  ds_bpermute_b32 v77, v44, v68 offset:32
  ds_bpermute_b32 v78, v44, v72 offset:0
  ds_bpermute_b32 v79, v44, v72 offset:32
  s_lshr_b32 s92, s82, 12
  s_lshl_b32 s92, s92, 12
  s_add_u32 s94, s82, s92
  s_add_u32 s94, s94, 1114112
  s_add_u32 s82, s82, 851968
  v_bfe_u32 v45, v1, 2, 1
  v_lshlrev_b32 v45, 6, v45
  v_add_u32 v45, v45, v41
  v_bfe_u32 v69, v1, 2, 1
  v_lshlrev_b32 v69, 12, v69
  v_and_b32 v3, 3, v1
  v_lshl_add_u32 v69, v3, 6, v69
  v_lshrrev_b32 v3, 4, v1
  v_lshl_add_u32 v69, v3, 4, v69
  s_waitcnt lgkmcnt(0)
  v_add_f32 v78, 1.0, v78
  v_lshlrev_b32 v66, 16, v66
  v_cvt_pk_bf16_f32 v44, v78, v78
  v_and_b32 v78, 0xffff0000, v44
  s_cmp_eq_u32 s3, 7
  s_cbranch_scc1 L_ab_61
  ds_write_b16_d16_hi v57, v78
  ds_write_b16_d16_hi v57, v77 offset:64
  ds_read_b128 v[72:75], v45
  s_waitcnt lgkmcnt(0)
  v_mfma_f32_16x16x32_bf16 v[208:211], v[80:83], v[72:75], 0
  v_mfma_f32_16x16x32_bf16 v[212:215], v[84:87], v[72:75], 0
  v_mfma_f32_16x16x32_bf16 v[216:219], v[88:91], v[72:75], 0
  v_mfma_f32_16x16x32_bf16 v[220:223], v[92:95], v[72:75], 0
  s_mov_b32 exec_lo, 0x220022
  s_mov_b32 exec_hi, 0x220022
  s_nop 3
  v_mov_b32 v208, v212
  v_mov_b32 v209, v213
  v_mov_b32 v210, v214
  v_mov_b32 v211, v215
  s_mov_b32 exec_lo, 0x440044
  s_mov_b32 exec_hi, 0x440044
  v_mov_b32 v208, v216
  v_mov_b32 v209, v217
  v_mov_b32 v210, v218
  v_mov_b32 v211, v219
  s_mov_b32 exec_lo, 0x880088
  s_mov_b32 exec_hi, 0x880088
  v_mov_b32 v208, v220
  v_mov_b32 v209, v221
  v_mov_b32 v210, v222
  v_mov_b32 v211, v223
  s_mov_b32 exec_lo, 0xff00ff
  s_mov_b32 exec_hi, 0xff00ff
  v_and_or_b32 v208, v208, v2, s49
  v_and_or_b32 v209, v209, v2, s50
  v_and_or_b32 v210, v210, v2, s51
  v_and_or_b32 v211, v211, v2, s52
  buffer_store_dwordx4 v[208:211], v69, s[32:35], s94 offen sc1
  s_mov_b64 exec, -1
L_ab_61:
  v_mov_b32 v112, 0
  v_mov_b32 v113, 0
  v_mov_b32 v114, 0
  v_mov_b32 v115, 0
  s_mov_b32 s60, 0xffffffff
  s_mov_b32 s61, 0x0
  s_mov_b32 s100, 0
  s_branch L_gf_67
L_g_66:
  s_add_u32 s100, s100, 1
  s_cmp_gt_u32 s100, 100000
  s_cbranch_scc1 L_abort
  s_sleep 4
L_gf_67:
  s_mov_b64 exec, s[60:61]
  buffer_load_dwordx4 v[112:115], v61, s[32:35], s90 offen offset:0 sc1
  s_waitcnt vmcnt(0)
L_gc_68:
  s_mov_b64 exec, s[60:61]
  v_perm_b32 v44, v113, v112, s56
  v_perm_b32 v44, v114, v44, s57
  v_perm_b32 v44, v115, v44, s58
  v_cmp_ne_u32 s[60:61], s48, v44
  s_nop 0
  s_cmp_lg_u64 s[60:61], 0
  s_cbranch_scc1 L_g_66
  s_mov_b64 exec, -1
  v_permlane32_swap_b32 v112, v114
  v_permlane32_swap_b32 v113, v115
  v_add_f32 v112, v112, v114
  v_add_f32 v113, v113, v115
  s_nop 1
  v_permlane16_swap_b32 v112, v113
  v_add_f32 v112, v112, v113
  s_nop 1
  v_add_f32_dpp v112, v112, v112 row_ror:8 row_mask:0xf bank_mask:0xf
  ds_write_b32 v59, v112
  s_waitcnt lgkmcnt(0)
  s_barrier
  ds_read_b128 v[112:115], v60
  ds_read_b128 v[116:119], v60 offset:16
  s_waitcnt lgkmcnt(0)
  v_add_f32 v112, v112, v113
  v_add_f32 v114, v114, v115
  v_add_f32 v116, v116, v117
  v_add_f32 v118, v118, v119
  v_add_f32 v112, v112, v114
  v_add_f32 v116, v116, v118
  v_add_f32 v112, v112, v116
  v_cvt_pk_bf16_f32 v44, v112, v112
  v_and_b32 v112, 0xffff0000, v44
  v_mul_f32 v67, v76, v112
  v_cvt_pk_bf16_f32 v44, v67, v67
  v_and_b32 v67, 0xffff0000, v44
  v_add_f32 v67, v66, v67
  v_cvt_pk_bf16_f32 v44, v67, v67
  v_and_b32 v67, 0xffff0000, v44
  s_cmp_eq_u32 s3, 7
  s_cbranch_scc1 L_stat
  v_mul_f32 v44, v67, v78
  v_cvt_pk_bf16_f32 v44, v44, v44
  ds_write_b16 v57, v44
  ds_read_b128 v[160:163], v41
  s_mov_b32 s70, 0x20002
  s_mov_b32 s71, 0x20002
  s_mov_b32 s72, 0x40004
  s_mov_b32 s73, 0x40004
  s_mov_b32 s74, 0x80008
  s_mov_b32 s75, 0x80008
  s_waitcnt lgkmcnt(0)
  v_mfma_f32_16x16x32_bf16 v[128:131], v[80:83], v[160:163], 0
  v_mfma_f32_16x16x32_bf16 v[132:135], v[84:87], v[160:163], 0
  v_mfma_f32_16x16x32_bf16 v[136:139], v[88:91], v[160:163], 0
  v_mfma_f32_16x16x32_bf16 v[140:143], v[92:95], v[160:163], 0
  s_nop 5
  v_cndmask_b32 v128, v128, v132, s[70:71]
  v_cndmask_b32 v129, v129, v133, s[70:71]
  v_cndmask_b32 v130, v130, v134, s[70:71]
  v_cndmask_b32 v131, v131, v135, s[70:71]
  v_cndmask_b32 v128, v128, v136, s[72:73]
  v_cndmask_b32 v129, v129, v137, s[72:73]
  v_cndmask_b32 v130, v130, v138, s[72:73]
  v_cndmask_b32 v131, v131, v139, s[72:73]
  v_cndmask_b32 v128, v128, v140, s[74:75]
  v_cndmask_b32 v129, v129, v141, s[74:75]
  v_cndmask_b32 v130, v130, v142, s[74:75]
  v_cndmask_b32 v131, v131, v143, s[74:75]
  v_and_or_b32 v128, v128, v2, s49
  v_and_or_b32 v129, v129, v2, s50
  v_and_or_b32 v130, v130, v2, s51
  v_and_or_b32 v131, v131, v2, s52
  s_mov_b32 exec_lo, 0xf000f
  s_mov_b32 exec_hi, 0xf000f
  buffer_store_dwordx4 v[128:131], v58, s[32:35], s82 offen
  s_add_u32 s97, s82, 0xf0000
  buffer_store_dwordx4 v[128:131], v58, s[32:35], s97 offen sc1
  s_mov_b64 exec, -1
  s_branch L_xdone
L_stat:
  v_mov_b32 v130, v67
  v_mul_f32 v131, v67, v67
  s_nop 0
  v_add_f32_dpp v130, v130, v130 row_ror:8 row_mask:0xf bank_mask:0xf
  v_add_f32_dpp v131, v131, v131 row_ror:8 row_mask:0xf bank_mask:0xf
  s_nop 0
  v_add_f32_dpp v130, v130, v130 row_ror:4 row_mask:0xf bank_mask:0xf
  v_add_f32_dpp v131, v131, v131 row_ror:4 row_mask:0xf bank_mask:0xf
  s_nop 0
  v_add_f32_dpp v130, v130, v130 row_ror:2 row_mask:0xf bank_mask:0xf
  v_add_f32_dpp v131, v131, v131 row_ror:2 row_mask:0xf bank_mask:0xf
  s_nop 0
  v_add_f32_dpp v130, v130, v130 row_ror:1 row_mask:0xf bank_mask:0xf
  v_add_f32_dpp v131, v131, v131 row_ror:1 row_mask:0xf bank_mask:0xf
  v_mov_b32 v128, v130
  v_mov_b32 v129, v131
  s_nop 0
  v_permlane16_swap_b32 v130, v128
  v_permlane16_swap_b32 v131, v129
  v_add_f32 v130, v130, v128
  v_add_f32 v131, v131, v129
  v_and_b32 v128, v2, v130
  v_and_b32 v129, v2, v131
  v_sub_f32 v130, v130, v128
  v_sub_f32 v131, v131, v129
  v_and_or_b32 v128, v128, v2, s49
  v_and_or_b32 v129, v129, v2, s50
  v_and_or_b32 v130, v130, v2, s51
  v_and_or_b32 v131, v131, v2, s52
  s_lshl_b32 s92, s80, 11
  s_lshl_b32 s97, s79, 7
  s_add_u32 s92, s92, s97
  s_add_u32 s92, s92, 0x18000
  s_mov_b64 exec, 1
  buffer_store_dwordx4 v[128:131], v1, s[32:35], s92 offen
  s_add_u32 s97, s92, 0x1e0000
  buffer_store_dwordx4 v[128:131], v1, s[32:35], s97 offen sc1
  s_mov_b64 exec, -1
  v_mov_b32 v112, 0
L_xdone:
  s_and_b32 s92, s79, 7
  s_cmp_lg_u32 s80, s92
  s_cbranch_scc1 L_fin
  s_mul_i32 s90, s79, 8448
  s_lshl_b32 s97, s3, 10
  s_add_u32 s90, s90, s97
  s_add_u32 s90, s90, 0xa0000
  s_lshl_b32 s92, s79, 6
  v_and_b32 v46, 31, v1
  v_lshlrev_b32 v46, 1, v46
  v_add_u32 v46, s92, v46
  s_cmp_eq_u32 s3, 7
  s_cbranch_scc1 L_nof
  s_mov_b64 s[60:61], -1
  s_mov_b32 s100, 0
  s_branch L_gf_71
L_g_70:
  s_add_u32 s100, s100, 1
  s_cmp_gt_u32 s100, 100000
  s_cbranch_scc1 L_abort
  s_sleep 1
L_gf_71:
  s_mov_b64 exec, s[60:61]
  buffer_load_dwordx4 v[112:115], v34, s[32:35], s90 offen offset:0 sc1
  s_waitcnt vmcnt(0)
L_gc_72:
  s_mov_b64 exec, s[60:61]
  v_perm_b32 v44, v113, v112, s56
  v_perm_b32 v44, v114, v44, s57
  v_perm_b32 v44, v115, v44, s58
  v_cmp_ne_u32 s[60:61], s48, v44
  s_nop 0
  s_cmp_lg_u64 s[60:61], 0
  s_cbranch_scc1 L_g_70
  s_mov_b64 exec, -1
  v_permlane32_swap_b32 v112, v114
  v_permlane32_swap_b32 v113, v115
  v_add_f32 v112, v112, v114
  v_add_f32 v113, v113, v115
  s_nop 1
  v_permlane16_swap_b32 v112, v113
  v_add_f32 v112, v112, v113
  s_nop 1
  v_add_f32_dpp v112, v112, v112 row_ror:8 row_mask:0xf bank_mask:0xf
L_nof:
  ds_write_b32 v59, v112 offset:1024
  s_waitcnt lgkmcnt(0)
  s_barrier
  s_cmp_lg_u32 s3, 0
  s_cbranch_scc1 L_fin
  ds_read_b128 v[112:115], v60 offset:1024
  ds_read_b128 v[116:119], v60 offset:1040
  s_waitcnt lgkmcnt(0)
  v_add_f32 v112, v112, v113
  v_add_f32 v114, v114, v115
  v_add_f32 v116, v116, v117
  v_add_f32 v118, v118, v119
  v_add_f32 v112, v112, v114
  v_add_f32 v116, v116, v118
  v_add_f32 v112, v112, v116
  v_cvt_pk_bf16_f32 v45, v112, v112
  v_and_b32 v112, 0xffff0000, v45
  v_mul_f32 v44, v79, v112
  v_cvt_pk_bf16_f32 v45, v44, v44
  v_and_b32 v44, 0xffff0000, v45
  v_add_f32 v44, v67, v44
  v_cvt_pk_bf16_f32 v44, v44, v44
  s_mov_b32 exec_hi, 0
  global_store_short v46, v44, s[28:29]
  s_cmp_lg_u32 s2, 128
  s_cbranch_scc1 L_noep
  s_mov_b64 exec, 1
  v_mov_b32 v45, 0
  global_store_dword v45, v45, s[30:31]
L_noep:
L_fin:
  s_endpgm
L_Y:
  s_cmp_ge_u32 s2, 112
  s_cbranch_scc1 L_fin
  s_lshl_b32 s94, s81, 13
  s_lshl_b32 s97, s3, 10
  s_add_u32 s94, s94, s97
  s_add_u32 s94, s94, 0x110000
  s_mov_b64 s[40:41], s[22:23]
  s_mov_b32 s42, 0x1c0000
  s_mov_b32 s43, 0x20000
  v_lshrrev_b32 v44, 5, v1
  v_lshlrev_b32 v44, 10, v44
  v_and_b32 v3, 31, v1
  v_lshl_add_u32 v44, v3, 4, v44
  buffer_load_dwordx4 v[176:179], v44, s[40:43], s91 offen offset:0 nt
  buffer_load_dwordx4 v[180:183], v44, s[40:43], s91 offen offset:2048 nt
  v_mov_b32 v112, 0
  v_mov_b32 v113, 0
  v_mov_b32 v114, 0
  v_mov_b32 v115, 0
  v_lshlrev_b32 v46, 4, v1
  v_add_u32 v46, 88064, v46
  v_lshlrev_b32 v47, 5, v1
  v_add_u32 v47, 83968, v47
  s_waitcnt vmcnt(0)
  s_mov_b64 s[60:61], -1
  s_mov_b32 s100, 0
  s_branch L_gf_75
L_g_74:
  s_add_u32 s100, s100, 1
  s_cmp_gt_u32 s100, 100000
  s_cbranch_scc1 L_abort
  s_sleep 2
L_gf_75:
  s_mov_b64 exec, s[60:61]
  buffer_load_dwordx4 v[76:79], v34, s[32:35], s94 offen offset:0 sc1
  s_waitcnt vmcnt(0)
L_gc_76:
  s_mov_b64 exec, s[60:61]
  v_perm_b32 v44, v77, v76, s56
  v_perm_b32 v44, v78, v44, s57
  v_perm_b32 v44, v79, v44, s58
  v_cmp_ne_u32 s[60:61], s48, v44
  s_nop 0
  s_cmp_lg_u64 s[60:61], 0
  s_cbranch_scc1 L_g_74
  s_mov_b64 exec, -1
  v_permlane32_swap_b32 v76, v78
  v_permlane32_swap_b32 v77, v79
  v_add_f32 v76, v76, v78
  v_add_f32 v77, v77, v79
  s_nop 1
  v_permlane16_swap_b32 v76, v77
  v_add_f32 v76, v76, v77
  s_waitcnt vmcnt(0)
  ds_write_b128 v62, v[176:179] offset:0
  ds_write_b128 v62, v[180:183] offset:1088
  ds_write_b32 v60, v76
  s_waitcnt lgkmcnt(0)
  s_barrier
  ds_read_b128 v[128:131], v46
  ds_read_b128 v[132:135], v46 offset:1024
  ds_read_b64_tr_b16 v[68:69], v63 offset:0
  ds_read_b64_tr_b16 v[70:71], v63 offset:2176
  ds_read_b64_tr_b16 v[72:73], v63 offset:32
  ds_read_b64_tr_b16 v[74:75], v63 offset:2208
  s_waitcnt lgkmcnt(4)
  v_add_f32 v128, v128, v129
  v_add_f32 v130, v130, v131
  v_add_f32 v128, v128, v130
  v_add_f32 v132, v132, v133
  v_add_f32 v134, v134, v135
  v_add_f32 v132, v132, v134
  s_mov_b32 s66, 0
  s_mov_b32 s60, 0xffffffff
  s_mov_b32 s61, 0x0
  s_mov_b32 s62, 0xffff
  s_mov_b32 s63, 0x0
  s_mov_b32 s100, 0
  s_branch L_gf_79
L_g_78:
  s_add_u32 s100, s100, 1
  s_cmp_gt_u32 s100, 100000
  s_cbranch_scc1 L_abort
  s_sleep 1
  s_cmp_lg_u32 s100, 30
  s_cbranch_scc1 L_alt_81
  s_add_u32 s82, s82, 0xf0000
  s_add_u32 s66, s66, 0x1e0000
L_alt_81:
L_gf_79:
  s_mov_b64 exec, s[60:61]
  s_cbranch_execz L_gs_82
  buffer_load_dwordx4 v[112:115], v61, s[32:35], s82 offen offset:0 sc1
L_gs_82:
  s_mov_b64 exec, s[62:63]
  s_cbranch_execz L_gs_83
  buffer_load_dwordx4 v[136:139], v56, s[32:35], s66 offen offset:0 sc1
L_gs_83:
  s_waitcnt vmcnt(0)
L_gc_80:
  s_mov_b64 exec, s[60:61]
  v_perm_b32 v44, v113, v112, s56
  v_perm_b32 v44, v114, v44, s57
  v_perm_b32 v44, v115, v44, s58
  v_cmp_ne_u32 s[60:61], s48, v44
  s_mov_b64 exec, s[62:63]
  v_perm_b32 v44, v137, v136, s56
  v_perm_b32 v44, v138, v44, s57
  v_perm_b32 v44, v139, v44, s58
  v_cmp_ne_u32 s[62:63], s48, v44
  s_nop 0
  s_or_b64 s[96:97], s[60:61], s[62:63]
  s_cbranch_scc1 L_g_78
  s_mov_b64 exec, -1
  v_permlane32_swap_b32 v112, v114
  v_permlane32_swap_b32 v113, v115
  v_add_f32 v112, v112, v114
  v_add_f32 v113, v113, v115
  s_nop 1
  v_permlane16_swap_b32 v112, v113
  v_add_f32 v112, v112, v113
  ds_write_b32 v59, v112
  v_add_f32 v136, v136, v138
  v_add_f32 v137, v137, v139
  s_nop 0
  v_add_f32_dpp v136, v136, v136 quad_perm:[1,0,3,2] row_mask:0xf bank_mask:0xf
  v_add_f32_dpp v137, v137, v137 quad_perm:[1,0,3,2] row_mask:0xf bank_mask:0xf
  s_nop 0
  v_add_f32_dpp v136, v136, v136 quad_perm:[2,3,0,1] row_mask:0xf bank_mask:0xf
  v_add_f32_dpp v137, v137, v137 quad_perm:[2,3,0,1] row_mask:0xf bank_mask:0xf
  s_nop 0
  v_add_f32_dpp v136, v136, v136 row_half_mirror row_mask:0xf bank_mask:0xf
  v_add_f32_dpp v137, v137, v137 row_half_mirror row_mask:0xf bank_mask:0xf
  s_nop 0
  v_add_f32_dpp v136, v136, v136 row_ror:8 row_mask:0xf bank_mask:0xf
  v_add_f32_dpp v137, v137, v137 row_ror:8 row_mask:0xf bank_mask:0xf
  s_waitcnt lgkmcnt(0)
  s_barrier
  ds_read_b128 v[112:115], v47
  ds_read_b128 v[116:119], v47 offset:16
  v_readfirstlane_b32 s92, v136
  v_readfirstlane_b32 s93, v137
  v_mov_b32 v44, 0x3b000000
  v_mul_f32 v136, s92, v44
  v_mul_f32 v137, s93, v44
  v_fma_f32 v137, -v136, v136, v137
  v_max_f32 v137, 0, v137
  v_cvt_pk_bf16_f32 v45, v137, v137
  v_and_b32 v137, 0xffff0000, v45
  v_cvt_pk_bf16_f32 v44, v136, v136
  v_and_b32 v136, 0xffff0000, v44
  v_add_f32 v137, 0x3727c5ac, v137
  v_mul_f32 v128, v136, v128
  v_cvt_pk_bf16_f32 v45, v137, v137
  v_and_b32 v137, 0xffff0000, v45
  v_sqrt_f32 v137, v137
  s_nop 0
  v_cvt_pk_bf16_f32 v45, v137, v137
  v_and_b32 v137, 0xffff0000, v45
  v_rcp_f32 v137, v137
  s_waitcnt lgkmcnt(0)
  v_add_f32 v112, v112, v113
  v_add_f32 v114, v114, v115
  v_add_f32 v116, v116, v117
  v_add_f32 v118, v118, v119
  v_add_f32 v112, v112, v114
  v_add_f32 v116, v116, v118
  v_add_f32 v112, v112, v116
  v_sub_f32 v112, v112, v128
  v_fma_f32 v112, v112, v137, v132
  v_cvt_pk_bf16_f32 v44, v112, v112
  v_and_b32 v112, 0xffff0000, v44
  v_mul_f32 v44, v112, v112
  v_mov_b32 v45, 0xc0135761
  v_mov_b32_dpp v113, v112 row_ror:8 row_mask:0xf bank_mask:0xf
  v_fmac_f32 v45, 0xbdd2d3e8, v44
  v_mul_f32 v44, v45, v112
  v_exp_f32 v44, v44
  s_nop 0
  v_add_f32 v44, 1.0, v44
  v_rcp_f32 v44, v44
  s_nop 0
  v_mul_f32 v112, v112, v44
  v_cvt_pk_bf16_f32 v44, v112, v112
  v_and_b32 v112, 0xffff0000, v44
  v_mul_f32 v112, v112, v113
  v_cvt_pk_bf16_f32 v44, v112, v112
  s_mov_b32 exec_lo, 0xff00ff
  s_mov_b32 exec_hi, 0xff00ff
  ds_write_b16 v57, v44
  s_mov_b64 exec, -1
  ds_read_b128 v[160:163], v41
  s_mov_b32 s70, 0x20002
  s_mov_b32 s71, 0x20002
  s_waitcnt lgkmcnt(0)
  v_mfma_f32_16x16x32_bf16 v[144:147], v[68:71], v[160:163], 0
  v_mfma_f32_16x16x32_bf16 v[148:151], v[72:75], v[160:163], 0
  s_nop 7
  v_cndmask_b32 v144, v144, v148, s[70:71]
  v_cndmask_b32 v145, v145, v149, s[70:71]
  v_cndmask_b32 v146, v146, v150, s[70:71]
  v_cndmask_b32 v147, v147, v151, s[70:71]
  v_and_or_b32 v144, v144, v2, s49
  v_and_or_b32 v145, v145, v2, s50
  v_and_or_b32 v146, v146, v2, s51
  v_and_or_b32 v147, v147, v2, s52
  s_mov_b32 exec_lo, 0x30003
  s_mov_b32 exec_hi, 0x30003
  buffer_store_dwordx4 v[144:147], v58, s[32:35], s90 offen sc1
  s_endpgm
L_abort:
  s_endpgm
L_end:
  s_endpgm
L_codeend:
.section .rodata,"a"
.p2align 6
.amdhsa_kernel adaLN_cond__compressed_kv_cla__glu_gated_geglu__decode_kernel
  .amdhsa_next_free_vgpr 256
  .amdhsa_next_free_sgpr 102
  .amdhsa_accum_offset 256
  .amdhsa_group_segment_fixed_size 0
  .amdhsa_kernarg_size 120
  .amdhsa_user_sgpr_count 2
  .amdhsa_user_sgpr_kernarg_segment_ptr 1
  .amdhsa_system_sgpr_workgroup_id_x 1
.end_amdhsa_kernel
```

```asm
; @launch grid=(256,1,1) block=(512,1,1) lds=163840
.amdgcn_target "amdgcn-amd-amdhsa--gfx950"
.text
.globl adaLN_cond__compressed_kv_cla__glu_gated_geglu__decode_kernel
.p2align 8
.type adaLN_cond__compressed_kv_cla__glu_gated_geglu__decode_kernel,@function
adaLN_cond__compressed_kv_cla__glu_gated_geglu__decode_kernel:
  s_cmp_ge_u32 s2, 256
  s_cbranch_scc1 L_end
  s_load_dwordx16 s[4:19], s[0:1], 0
  s_load_dwordx8 s[20:27], s[0:1], 64
  s_load_dwordx4 s[28:31], s[0:1], 96
  s_load_dwordx2 s[32:33], s[0:1], 112
  v_lshrrev_b32 v1, 6, v0
  s_mov_b32 s34, 0x10000000
  s_mov_b32 s35, 0x20000
  v_readfirstlane_b32 s3, v1
  v_and_b32 v1, 63, v0
  v_mov_b32 v8, 0
  v_mov_b32 v20, 0
  v_mov_b32 v251, 0
  v_mov_b32 v42, 0
  s_cmp_lt_u32 s2, 128
  s_cbranch_scc0 L_B
  v_lshlrev_b32 v38, 4, v1
  s_bfe_u32 s82, s2, 0x30003
  s_lshl_b32 s82, s82, 19
  s_lshl_b32 s97, s3, 16
  s_add_u32 s82, s82, s97
  s_and_b32 s97, s2, 7
  s_lshl_b32 s97, s97, 10
  s_add_u32 s82, s82, s97
  s_mov_b32 s42, 0x400000
  s_mov_b32 s43, 0x20000
  s_bitcmp1_b32 s2, 6
  s_cbranch_scc1 L_K
  v_and_b32 v8, 15, v1
  v_lshlrev_b32 v8, 3, v8
  v_lshrrev_b32 v3, 4, v1
  v_lshl_add_u32 v8, v3, 1, v8
  s_bfe_u32 s92, s2, 0x30003
  s_lshl_b32 s92, s92, 7
  v_add_u32 v17, s92, v8
  s_bfe_u32 s81, s2, 0x10004
  s_xor_b32 s81, s81, 1
  s_lshl_b32 s81, s81, 16
  s_and_b32 s92, s3, 1
  s_lshl_b32 s92, s92, 7
  v_xor_b32 v39, s92, v38
  s_lshl_b32 s83, s3, 13
  s_add_u32 s83, s83, s81
  s_lshl_b32 s92, s2, 17
  v_mov_b32 v18, s92
  v_mov_b32 v19, 0xf000
  s_waitcnt lgkmcnt(0)
  s_mov_b64 s[40:41], s[8:9]
  global_load_dwordx4 v[12:15], v38, s[4:5]
  global_load_ushort v16, v17, s[4:5]
  v_xor_b32 v40, 0, v39
  s_add_u32 m0, s83, 0
  s_add_u32 s92, s82, 0
  buffer_load_dwordx4 v40, s[40:43], s92 offen nt lds
  v_xor_b32 v41, 32, v39
  s_add_u32 m0, s83, 1024
  s_add_u32 s92, s82, 8192
  buffer_load_dwordx4 v41, s[40:43], s92 offen nt lds
  v_xor_b32 v40, 64, v39
  s_add_u32 m0, s83, 2048
  s_add_u32 s92, s82, 16384
  buffer_load_dwordx4 v40, s[40:43], s92 offen nt lds
  v_xor_b32 v41, 96, v39
  s_add_u32 m0, s83, 3072
  s_add_u32 s92, s82, 24576
  buffer_load_dwordx4 v41, s[40:43], s92 offen nt lds
  v_xor_b32 v40, 0, v39
  s_add_u32 m0, s83, 4096
  s_add_u32 s92, s82, 32768
  buffer_load_dwordx4 v40, s[40:43], s92 offen nt lds
  v_xor_b32 v41, 32, v39
  s_add_u32 m0, s83, 5120
  s_add_u32 s92, s82, 40960
  buffer_load_dwordx4 v41, s[40:43], s92 offen nt lds
  v_xor_b32 v40, 64, v39
  s_add_u32 m0, s83, 6144
  s_add_u32 s92, s82, 49152
  buffer_load_dwordx4 v40, s[40:43], s92 offen nt lds
  v_xor_b32 v41, 96, v39
  s_add_u32 m0, s83, 7168
  s_add_u32 s92, s82, 57344
  buffer_load_dwordx4 v41, s[40:43], s92 offen nt lds
  s_cmp_lg_u32 s3, 7
  s_cbranch_scc1 L_nt_1
  s_mov_b64 exec, 1
  global_load_dword v20, v18, s[6:7] nt
  global_load_dword v21, v19, s[32:33]
  global_load_dword v22, v38, s[30:31] offset:128
  s_mov_b64 exec, -1
L_nt_1:
  s_branch L_Q2
L_K:
  s_bfe_u32 s81, s2, 0x10004
  s_xor_b32 s81, s81, 1
  s_lshl_b32 s81, s81, 16
  s_and_b32 s92, s3, 1
  s_lshl_b32 s92, s92, 7
  v_xor_b32 v39, s92, v38
  s_lshl_b32 s83, s3, 13
  s_add_u32 s83, s83, s81
  v_mov_b32 v19, 0xf000
  s_waitcnt lgkmcnt(0)
  s_mov_b64 s[40:41], s[10:11]
  s_mov_b64 exec, 1
  global_load_dword v21, v19, s[32:33]
  s_mov_b64 exec, -1
  v_xor_b32 v40, 0, v39
  s_add_u32 m0, s83, 0
  s_add_u32 s92, s82, 0
  buffer_load_dwordx4 v40, s[40:43], s92 offen nt lds
  v_xor_b32 v41, 16, v39
  s_add_u32 m0, s83, 1024
  s_add_u32 s92, s82, 8192
  buffer_load_dwordx4 v41, s[40:43], s92 offen nt lds
  v_xor_b32 v40, 32, v39
  s_add_u32 m0, s83, 2048
  s_add_u32 s92, s82, 16384
  buffer_load_dwordx4 v40, s[40:43], s92 offen nt lds
  v_xor_b32 v41, 48, v39
  s_add_u32 m0, s83, 3072
  s_add_u32 s92, s82, 24576
  buffer_load_dwordx4 v41, s[40:43], s92 offen nt lds
  v_xor_b32 v40, 64, v39
  s_add_u32 m0, s83, 4096
  s_add_u32 s92, s82, 32768
  buffer_load_dwordx4 v40, s[40:43], s92 offen nt lds
  v_xor_b32 v41, 80, v39
  s_add_u32 m0, s83, 5120
  s_add_u32 s92, s82, 40960
  buffer_load_dwordx4 v41, s[40:43], s92 offen nt lds
  v_xor_b32 v40, 96, v39
  s_add_u32 m0, s83, 6144
  s_add_u32 s92, s82, 49152
  buffer_load_dwordx4 v40, s[40:43], s92 offen nt lds
  v_xor_b32 v41, 112, v39
  s_add_u32 m0, s83, 7168
  s_add_u32 s92, s82, 57344
  buffer_load_dwordx4 v41, s[40:43], s92 offen nt lds
  s_branch L_K2
L_B:
  s_cmp_ge_u32 s3, 4
  s_cbranch_scc0 L_Bfront
  v_lshrrev_b32 v10, 3, v1
  v_mul_u32_u24 v5, 24576, v10
  v_lshlrev_b32 v10, 3, v10
  v_and_b32 v11, 7, v1
  v_lshl_add_u32 v5, v11, 4, v5
  s_bfe_u32 s94, s2, 0x20004
  s_and_b32 s95, s2, 15
  s_lshl_b32 s92, s94, 2
  s_add_u32 s92, s92, s3
  s_sub_u32 s92, s92, 4
  s_lshl_b32 s93, s92, 6
  v_add_u32 v10, s93, v10
  s_mul_i32 s92, s92, 196608
  s_lshl_b32 s93, s95, 7
  s_add_u32 s92, s92, s93
  s_mov_b32 s42, 0x300000
  s_mov_b32 s43, 0x20000
  v_mov_b32 v253, 0
  s_waitcnt lgkmcnt(0)
  s_mov_b64 s[40:41], s[26:27]
  s_bitcmp1_b32 s2, 6
  s_cbranch_scc1 L_nou0
  global_load_dwordx2 v[112:113], v10, s[24:25]
  buffer_load_dwordx4 v[124:127], v5, s[40:43], s92 offen nt
  s_add_u32 s92, s92, 6144
  buffer_load_dwordx4 v[128:131], v5, s[40:43], s92 offen nt
  s_add_u32 s92, s92, 6144
  buffer_load_dwordx4 v[132:135], v5, s[40:43], s92 offen nt
  s_add_u32 s92, s92, 6144
  buffer_load_dwordx4 v[136:139], v5, s[40:43], s92 offen nt
L_nou0:
  s_branch L_Bback2
L_Bfront:
  s_memrealtime s[62:63]
  s_bfe_u32 s64, s2, 0x40003
  s_xor_b32 s64, s64, 8
  s_or_b32 s64, s64, s3
  s_cbranch_scc1 L_nononce
  v_mov_b32 v18, 0
  v_mov_b32 v21, 0
  s_waitcnt lgkmcnt(0)
  s_or_b32 s62, s62, 1
  v_mov_b32 v20, s62
  s_mov_b64 exec, 1
  global_atomic_cmpswap v18, v[20:21], s[30:31] sc1
  s_mov_b64 exec, -1
L_nononce:
  v_lshrrev_b32 v245, 4, v1
  v_and_b32 v246, 15, v1
  v_lshlrev_b32 v247, 2, v245
  v_xor_b32 v246, v246, v247
  v_lshlrev_b32 v246, 4, v246
  v_lshl_add_u32 v244, v245, 10, v246
  v_xor_b32 v245, 16, v244
  v_xor_b32 v246, 32, v244
  v_xor_b32 v247, 48, v244
  v_add_u32 v245, 3072, v245
  v_add_u32 v246, 6144, v246
  v_add_u32 v247, 9216, v247
  s_and_b32 s91, s3, 3
  s_lshl_b32 s90, s91, 15
  s_lshl_b32 s91, s91, 13
  s_lshl_b32 s92, s2, 17
  s_add_u32 s90, s90, s92
  s_bfe_u32 s93, s2, 0x20003
  s_lshl_b32 s92, s93, 15
  s_add_u32 s91, s91, s92
  s_lshl_b32 s92, s93, 8
  s_add_u32 s90, s90, s92
  s_getpc_b64 s[94:95]
L_pc:
  s_sub_u32 s94, s94, L_pc-adaLN_cond__compressed_kv_cla__glu_gated_geglu__decode_kernel
  s_subb_u32 s95, s95, 0
  s_bfe_u32 s92, s2, 0x40003
  s_lshl_b32 s92, s92, 2
  s_add_u32 s92, s92, s3
  s_lshl_b32 s92, s92, 10
  v_lshlrev_b32 v11, 4, v1
  v_add_u32 v11, s92, v11
  s_mov_b32 s38, 0x2000000
  s_mov_b32 s39, 0x20000
  s_cmp_ge_u32 s92, L_codeend-adaLN_cond__compressed_kv_cla__glu_gated_geglu__decode_kernel
  s_cbranch_scc1 L_nopf
  v_min_u32 v11, L_codeend-adaLN_cond__compressed_kv_cla__glu_gated_geglu__decode_kernel-16, v11
  global_load_dwordx4 v[12:15], v11, s[94:95]
L_nopf:
  s_waitcnt lgkmcnt(0)
  s_mov_b64 s[36:37], s[6:7]
  s_barrier
  s_barrier
  s_mov_b32 s54, 0x05040100
  s_mov_b32 s55, 0x07060302
  s_mov_b32 s56, 0x0c0c0400
  s_mov_b32 s57, 0x0c040100
  s_mov_b32 s58, 0x04020100
  s_mov_b32 s53, 0x10001
  v_mov_b32 v2, 0xffffff00
  s_lshr_b32 s77, s2, 5
  s_and_b32 s78, s2, 127
  s_and_b32 s76, s2, 7
  s_lshl_b32 s76, s76, 2
  s_bfe_u32 s97, s2, 0x20003
  s_add_u32 s76, s76, s97
  s_bfe_u32 s79, s2, 0x40003
  s_and_b32 s80, s2, 7
  s_bfe_u32 s17, s2, 0x20003
  s_bfe_u32 s59, s2, 0x10004
  s_lshl_b32 s59, s59, 14
  s_xor_b32 m0, s91, 0
  s_xor_b32 s101, s90, 0
  buffer_load_dwordx4 v244, s[36:39], s101 offen offset:0 nt lds
  s_waitcnt vmcnt(0)
  buffer_load_dwordx4 v245, s[36:39], s101 offen offset:1024 nt lds
  s_waitcnt vmcnt(0)
  buffer_load_dwordx4 v246, s[36:39], s101 offen offset:2048 nt lds
  s_waitcnt vmcnt(0)
  buffer_load_dwordx4 v247, s[36:39], s101 offen offset:3072 nt lds
  s_waitcnt vmcnt(2)
  s_xor_b32 m0, s91, 32768
  s_xor_b32 s101, s90, 256
  buffer_load_dwordx4 v244, s[36:39], s101 offen offset:0 nt lds
  s_waitcnt vmcnt(2)
  buffer_load_dwordx4 v245, s[36:39], s101 offen offset:1024 nt lds
  s_waitcnt vmcnt(2)
  buffer_load_dwordx4 v246, s[36:39], s101 offen offset:2048 nt lds
  s_waitcnt vmcnt(2)
  buffer_load_dwordx4 v247, s[36:39], s101 offen offset:3072 nt lds
  s_waitcnt vmcnt(2)
  s_xor_b32 m0, s91, 65536
  s_xor_b32 s101, s90, 512
  buffer_load_dwordx4 v244, s[36:39], s101 offen offset:0 nt lds
  buffer_load_dwordx4 v245, s[36:39], s101 offen offset:1024 nt lds
  buffer_load_dwordx4 v246, s[36:39], s101 offen offset:2048 nt lds
  buffer_load_dwordx4 v247, s[36:39], s101 offen offset:3072 nt lds
  v_mov_b32 v253, 0
  global_load_dword v252, v253, s[30:31] sc1
  s_barrier
  s_xor_b32 m0, s91, 98304
  s_xor_b32 s101, s90, 768
  buffer_load_dwordx4 v244, s[36:39], s101 offen offset:0 nt lds
  buffer_load_dwordx4 v245, s[36:39], s101 offen offset:1024 nt lds
  buffer_load_dwordx4 v246, s[36:39], s101 offen offset:2048 nt lds
  buffer_load_dwordx4 v247, s[36:39], s101 offen offset:3072 nt lds
  s_branch L_front
L_Q2:
  s_mov_b32 s54, 0x05040100
  s_mov_b32 s55, 0x07060302
  s_mov_b32 s56, 0x0c0c0400
  s_mov_b32 s57, 0x0c040100
  s_mov_b32 s58, 0x04020100
  s_mov_b32 s53, 0x10001
  v_mov_b32 v2, 0xffffff00
  s_lshr_b32 s77, s2, 5
  s_and_b32 s78, s2, 127
  s_and_b32 s76, s2, 7
  s_lshl_b32 s76, s76, 2
  s_bfe_u32 s97, s2, 0x20003
  s_add_u32 s76, s76, s97
  s_bfe_u32 s79, s2, 0x40003
  s_and_b32 s80, s2, 7
  s_bfe_u32 s17, s2, 0x20003
  s_bfe_u32 s59, s2, 0x10004
  s_lshl_b32 s59, s59, 14
  v_lshrrev_b32 v245, 4, v1
  v_and_b32 v246, 15, v1
  v_lshlrev_b32 v247, 2, v245
  v_xor_b32 v246, v246, v247
  v_lshlrev_b32 v246, 4, v246
  v_lshl_add_u32 v244, v245, 10, v246
  v_xor_b32 v245, 16, v244
  v_xor_b32 v246, 32, v244
  v_xor_b32 v247, 48, v244
  v_add_u32 v245, 3072, v245
  v_add_u32 v246, 6144, v246
  v_add_u32 v247, 9216, v247
  s_and_b32 s91, s3, 3
  s_lshl_b32 s90, s91, 15
  s_lshl_b32 s91, s91, 13
  s_lshl_b32 s92, s2, 17
  s_add_u32 s90, s90, s92
  s_bfe_u32 s93, s2, 0x20003
  s_lshl_b32 s92, s93, 15
  s_add_u32 s91, s91, s92
  s_lshl_b32 s92, s93, 8
  s_add_u32 s90, s90, s92
  s_mov_b64 s[36:37], s[6:7]
  s_mov_b32 s38, 0x2000000
  s_mov_b32 s39, 0x20000
  s_barrier
  s_lshr_b32 s92, s3, 2
  s_lshl_b32 s93, s92, 12
  s_xor_b32 s93, s93, 0
  s_xor_b32 m0, s91, s93
  s_lshl_b32 s93, s92, 14
  s_xor_b32 s93, s93, 0
  s_xor_b32 s101, s90, s93
  buffer_load_dwordx4 v244, s[36:39], s101 offen offset:0 nt lds
  buffer_load_dwordx4 v245, s[36:39], s101 offen offset:1024 nt lds
  buffer_load_dwordx4 v246, s[36:39], s101 offen offset:2048 nt lds
  buffer_load_dwordx4 v247, s[36:39], s101 offen offset:3072 nt lds
  s_bfe_u32 s82, s2, 0x30003
  s_lshl_b32 s82, s82, 10
  s_add_u32 s83, s82, 8192
  s_lshl_b32 s92, s3, 7
  s_add_u32 s92, s92, 0x20000
  v_add_u32 v40, s92, v8
  v_lshrrev_b32 v41, 4, v1
  v_lshlrev_b32 v41, 4, v41
  v_add_u32 v41, s92, v41
  s_lshl_b32 s92, s3, 7
  s_add_u32 s92, s92, s81
  v_lshrrev_b32 v44, 4, v1
  v_lshlrev_b32 v44, 13, v44
  v_bfe_u32 v3, v1, 2, 2
  v_lshl_add_u32 v44, v3, 10, v44
  v_and_b32 v3, 3, v1
  v_lshl_add_u32 v44, v3, 3, v44
  v_add_u32 v44, s92, v44
  v_bfe_u32 v45, v1, 2, 2
  v_lshlrev_b32 v45, 5, v45
  v_bfe_u32 v3, v1, 4, 1
  v_lshl_add_u32 v45, v3, 7, v45
  v_xor_b32 v44, v44, v45
  v_and_b32 v39, 3, v1
  v_lshlrev_b32 v39, 6, v39
  v_lshrrev_b32 v3, 4, v1
  v_lshl_add_u32 v39, v3, 4, v39
  s_and_b32 s85, s2, 7
  s_lshl_b32 s85, s85, 14
  s_bfe_u32 s97, s2, 0x30003
  s_lshl_b32 s97, s97, 11
  s_add_u32 s85, s85, s97
  s_lshl_b32 s97, s3, 8
  s_add_u32 s85, s85, s97
  s_add_u32 s85, s85, 0x80000
  s_mov_b32 s70, 0x20002
  s_mov_b32 s71, 0x20002
  s_mov_b32 s72, 0x40004
  s_mov_b32 s73, 0x40004
  s_mov_b32 s74, 0x80008
  s_mov_b32 s75, 0x80008
  s_waitcnt vmcnt(12)
  v_lshlrev_b32 v92, 16, v12
  v_and_b32 v93, 0xffff0000, v12
  v_lshlrev_b32 v94, 16, v13
  v_and_b32 v95, 0xffff0000, v13
  v_lshlrev_b32 v96, 16, v14
  v_and_b32 v97, 0xffff0000, v14
  v_lshlrev_b32 v98, 16, v15
  v_and_b32 v99, 0xffff0000, v15
  v_add_f32 v100, v92, v93
  v_add_f32 v100, v100, v94
  v_add_f32 v100, v100, v95
  v_add_f32 v100, v100, v96
  v_add_f32 v100, v100, v97
  v_add_f32 v100, v100, v98
  v_add_f32 v100, v100, v99
  s_nop 1
  v_add_f32_dpp v100, v100, v100 row_ror:8 row_mask:0xf bank_mask:0xf
  s_nop 1
  v_add_f32_dpp v100, v100, v100 row_ror:4 row_mask:0xf bank_mask:0xf
  s_nop 1
  v_add_f32_dpp v100, v100, v100 row_ror:2 row_mask:0xf bank_mask:0xf
  s_nop 1
  v_add_f32_dpp v100, v100, v100 row_ror:1 row_mask:0xf bank_mask:0xf
  v_mov_b32 v101, v100
  s_nop 1
  v_permlane16_swap_b32 v100, v101
  v_add_f32 v100, v100, v101
  v_mov_b32 v101, v100
  s_nop 1
  v_permlane32_swap_b32 v100, v101
  v_add_f32 v100, v100, v101
  v_mul_f32 v100, 0x3b000000, v100
  v_sub_f32 v92, v92, v100
  v_sub_f32 v93, v93, v100
  v_sub_f32 v94, v94, v100
  v_sub_f32 v95, v95, v100
  v_sub_f32 v96, v96, v100
  v_sub_f32 v97, v97, v100
  v_sub_f32 v98, v98, v100
  v_sub_f32 v99, v99, v100
  v_mul_f32 v102, v92, v92
  v_fmac_f32 v102, v93, v93
  v_fmac_f32 v102, v94, v94
  v_fmac_f32 v102, v95, v95
  v_fmac_f32 v102, v96, v96
  v_fmac_f32 v102, v97, v97
  v_fmac_f32 v102, v98, v98
  v_fmac_f32 v102, v99, v99
  s_nop 1
  v_add_f32_dpp v102, v102, v102 row_ror:8 row_mask:0xf bank_mask:0xf
  s_nop 1
  v_add_f32_dpp v102, v102, v102 row_ror:4 row_mask:0xf bank_mask:0xf
  s_nop 1
  v_add_f32_dpp v102, v102, v102 row_ror:2 row_mask:0xf bank_mask:0xf
  s_nop 1
  v_add_f32_dpp v102, v102, v102 row_ror:1 row_mask:0xf bank_mask:0xf
  v_mov_b32 v101, v102
  s_nop 1
  v_permlane16_swap_b32 v102, v101
  v_add_f32 v102, v102, v101
  v_mov_b32 v101, v102
  s_nop 1
  v_permlane32_swap_b32 v102, v101
  v_add_f32 v102, v102, v101
  v_mul_f32 v102, 0x3b000000, v102
  v_cvt_pk_bf16_f32 v101, v100, v100
  v_and_b32 v100, 0xffff0000, v101
  v_cvt_pk_bf16_f32 v101, v102, v102
  v_and_b32 v102, 0xffff0000, v101
  v_add_f32 v102, 0x3727c5ac, v102
  v_cvt_pk_bf16_f32 v101, v102, v102
  v_and_b32 v102, 0xffff0000, v101
  v_sqrt_f32 v102, v102
  s_nop 0
  v_cvt_pk_bf16_f32 v101, v102, v102
  v_and_b32 v102, 0xffff0000, v101
  v_rcp_f32 v102, v102
  v_lshlrev_b32 v103, 16, v16
  v_sub_f32 v103, v103, v100
  v_cvt_pk_bf16_f32 v101, v103, v103
  v_and_b32 v103, 0xffff0000, v101
  v_mul_f32 v103, v103, v102
  v_cvt_pk_bf16_f32 v101, v103, v103
  v_and_b32 v103, 0xffff0000, v101
  v_mov_b32 v253, 0
  global_load_dword v252, v253, s[30:31] sc1
  buffer_load_dwordx4 v[20:23], v38, s[32:35], s82 offen offset:0 sc1
  buffer_load_dwordx4 v[24:27], v38, s[32:35], s83 offen offset:0 sc1
  s_waitcnt vmcnt(7)
  s_barrier
  v_xor_b32 v46, 0, v44
  ds_read_b64_tr_b16 v[112:113], v46 offset:0
  ds_read_b64_tr_b16 v[114:115], v46 offset:4096
  ds_read_b64_tr_b16 v[116:117], v46 offset:32768
  ds_read_b64_tr_b16 v[118:119], v46 offset:36864
  v_xor_b32 v47, 32, v44
  ds_read_b64_tr_b16 v[120:121], v47 offset:0
  ds_read_b64_tr_b16 v[122:123], v47 offset:4096
  ds_read_b64_tr_b16 v[124:125], v47 offset:32768
  ds_read_b64_tr_b16 v[126:127], v47 offset:36864
  v_xor_b32 v46, 64, v44
  ds_read_b64_tr_b16 v[128:129], v46 offset:0
  ds_read_b64_tr_b16 v[130:131], v46 offset:4096
  ds_read_b64_tr_b16 v[132:133], v46 offset:32768
  ds_read_b64_tr_b16 v[134:135], v46 offset:36864
  s_waitcnt lgkmcnt(4)
  v_xor_b32 v47, 96, v44
  ds_read_b64_tr_b16 v[136:137], v47 offset:0
  ds_read_b64_tr_b16 v[138:139], v47 offset:4096
  ds_read_b64_tr_b16 v[140:141], v47 offset:32768
  ds_read_b64_tr_b16 v[142:143], v47 offset:36864
  s_mov_b32 s100, 0
  s_waitcnt vmcnt(2)
  s_branch L_epc_3
L_ep_2:
  global_load_dword v252, v253, s[30:31] sc1
  s_add_u32 s100, s100, 1
  s_cmp_gt_u32 s100, 100000
  s_cbranch_scc1 L_abort
  s_waitcnt vmcnt(0)
L_epc_3:
  v_readfirstlane_b32 s48, v252
  s_nop 0
  s_cmp_eq_u32 s48, 0
  s_nop 1
  s_cbranch_scc1 L_ep_2
  s_mul_i32 s48, s48, 0x9e3779b1
  s_and_b32 s49, s48, 0xff
  s_bfe_u32 s50, s48, 0x80008
  s_bfe_u32 s51, s48, 0x80010
  s_lshr_b32 s52, s48, 24
  s_lshr_b32 s97, s48, 15
  s_xor_b32 s97, s97, s48
  s_mul_i32 s97, s97, 0x85ebca6b
  v_mov_b32 v4, s48
  v_mov_b32 v5, s97
  v_mov_b32 v249, s48
  v_mov_b32 v250, s97
  v_and_b32 v6, 4, v1
  v_cmp_eq_u32 vcc, 0, v6
  v_and_b32 v7, 3, v1
  v_lshlrev_b32 v7, 2, v7
  v_cndmask_b32 v4, v5, v4, vcc
  v_lshrrev_b32 v4, v7, v4
  v_lshrrev_b32 v5, 1, v4
  v_lshrrev_b32 v6, 2, v4
  v_lshrrev_b32 v7, 3, v4
  s_waitcnt lgkmcnt(0)
  s_barrier
  s_mov_b64 s[60:61], -1
  s_waitcnt vmcnt(0)
  s_mov_b32 s100, 0
  s_branch L_gc_6
L_g_4:
  s_add_u32 s100, s100, 1
  s_cmp_gt_u32 s100, 100000
  s_cbranch_scc1 L_abort
  s_sleep 2
L_gf_5:
  s_mov_b64 exec, s[60:61]
  buffer_load_dwordx4 v[20:23], v38, s[32:35], s82 offen offset:0 sc1
  buffer_load_dwordx4 v[24:27], v38, s[32:35], s83 offen offset:0 sc1
  s_waitcnt vmcnt(0)
L_gc_6:
  s_mov_b64 exec, s[60:61]
  v_perm_b32 v92, v21, v20, s56
  v_perm_b32 v92, v22, v92, s57
  v_perm_b32 v92, v23, v92, s58
  v_cmp_ne_u32 s[60:61], s48, v92
  v_perm_b32 v92, v25, v24, s56
  v_perm_b32 v92, v26, v92, s57
  v_perm_b32 v92, v27, v92, s58
  v_cmp_ne_u32 vcc, s48, v92
  s_nop 0
  s_or_b64 s[60:61], s[60:61], vcc
  s_cmp_lg_u64 s[60:61], 0
  s_cbranch_scc1 L_g_4
  s_mov_b64 exec, -1
  v_permlane32_swap_b32 v20, v22
  v_permlane32_swap_b32 v21, v23
  v_permlane32_swap_b32 v24, v26
  v_permlane32_swap_b32 v25, v27
  v_add_f32 v20, v20, v22
  v_add_f32 v21, v21, v23
  v_add_f32 v24, v24, v26
  v_add_f32 v25, v25, v27
  v_permlane16_swap_b32 v20, v21
  s_nop 0
  v_permlane16_swap_b32 v24, v25
  v_add_f32 v20, v20, v21
  v_add_f32 v24, v24, v25
  v_cvt_pk_bf16_f32 v25, v24, v24
  v_and_b32 v24, 0xffff0000, v25
  v_cvt_pk_bf16_f32 v21, v20, v20
  v_and_b32 v20, 0xffff0000, v21
  v_add_f32 v24, 1.0, v24
  v_cvt_pk_bf16_f32 v25, v24, v24
  v_and_b32 v24, 0xffff0000, v25
  v_mul_f32 v24, v103, v24
  v_cvt_pk_bf16_f32 v25, v24, v24
  v_and_b32 v24, 0xffff0000, v25
  v_add_f32 v24, v24, v20
  v_cvt_pk_bf16_f32 v24, v24, v24
  ds_write_b16 v40, v24
  ds_read_b128 v[28:31], v41
  ds_read_b128 v[32:35], v41 offset:64
  s_waitcnt lgkmcnt(1)
  v_mfma_f32_16x16x32_bf16 v[80:83], v[112:115], v[28:31], 0
  v_mfma_f32_16x16x32_bf16 v[84:87], v[120:123], v[28:31], 0
  v_mfma_f32_16x16x32_bf16 v[88:91], v[128:131], v[28:31], 0
  v_mfma_f32_16x16x32_bf16 v[92:95], v[136:139], v[28:31], 0
  s_waitcnt lgkmcnt(0)
  v_mfma_f32_16x16x32_bf16 v[80:83], v[116:119], v[32:35], v[80:83]
  v_mfma_f32_16x16x32_bf16 v[84:87], v[124:127], v[32:35], v[84:87]
  v_mfma_f32_16x16x32_bf16 v[88:91], v[132:135], v[32:35], v[88:91]
  v_mfma_f32_16x16x32_bf16 v[92:95], v[140:143], v[32:35], v[92:95]
  s_nop 5
  v_cndmask_b32 v80, v80, v84, s[70:71]
  v_cndmask_b32 v81, v81, v85, s[70:71]
  v_cndmask_b32 v82, v82, v86, s[70:71]
  v_cndmask_b32 v83, v83, v87, s[70:71]
  v_cndmask_b32 v80, v80, v88, s[72:73]
  v_cndmask_b32 v81, v81, v89, s[72:73]
  v_cndmask_b32 v82, v82, v90, s[72:73]
  v_cndmask_b32 v83, v83, v91, s[72:73]
  v_cndmask_b32 v80, v80, v92, s[74:75]
  v_cndmask_b32 v81, v81, v93, s[74:75]
  v_cndmask_b32 v82, v82, v94, s[74:75]
  v_cndmask_b32 v83, v83, v95, s[74:75]
  v_and_or_b32 v80, v80, v2, s49
  v_and_or_b32 v81, v81, v2, s50
  v_and_or_b32 v82, v82, v2, s51
  v_and_or_b32 v83, v83, v2, s52
  s_mov_b32 exec_lo, 0xf000f
  s_mov_b32 exec_hi, 0xf000f
  buffer_store_dwordx4 v[80:83], v39, s[32:35], s85 offen
  s_add_u32 s97, s85, 0x100000
  buffer_store_dwordx4 v[80:83], v39, s[32:35], s97 offen sc1
  s_mov_b64 exec, -1
  s_barrier
  s_lshr_b32 s92, s3, 2
  s_lshl_b32 s93, s92, 12
  s_xor_b32 s93, s93, 32768
  s_xor_b32 m0, s91, s93
  s_lshl_b32 s93, s92, 14
  s_xor_b32 s93, s93, 256
  s_xor_b32 s101, s90, s93
  buffer_load_dwordx4 v244, s[36:39], s101 offen offset:0 nt lds
  buffer_load_dwordx4 v245, s[36:39], s101 offen offset:1024 nt lds
  buffer_load_dwordx4 v246, s[36:39], s101 offen offset:2048 nt lds
  buffer_load_dwordx4 v247, s[36:39], s101 offen offset:3072 nt lds
  s_lshr_b32 s92, s3, 2
  s_lshl_b32 s93, s92, 12
  s_xor_b32 s93, s93, 65536
  s_xor_b32 m0, s91, s93
  s_lshl_b32 s93, s92, 14
  s_xor_b32 s93, s93, 512
  s_xor_b32 s101, s90, s93
  buffer_load_dwordx4 v244, s[36:39], s101 offen offset:0 nt lds
  buffer_load_dwordx4 v245, s[36:39], s101 offen offset:1024 nt lds
  buffer_load_dwordx4 v246, s[36:39], s101 offen offset:2048 nt lds
  buffer_load_dwordx4 v247, s[36:39], s101 offen offset:3072 nt lds
  s_cmp_ge_u32 s3, 4
  s_cbranch_scc1 L_back
  s_barrier
  s_xor_b32 m0, s91, 98304
  s_xor_b32 s101, s90, 768
  buffer_load_dwordx4 v244, s[36:39], s101 offen offset:0 nt lds
  buffer_load_dwordx4 v245, s[36:39], s101 offen offset:1024 nt lds
  buffer_load_dwordx4 v246, s[36:39], s101 offen offset:2048 nt lds
  buffer_load_dwordx4 v247, s[36:39], s101 offen offset:3072 nt lds
  s_branch L_setup
L_K2:
  s_mov_b32 s54, 0x05040100
  s_mov_b32 s55, 0x07060302
  s_mov_b32 s56, 0x0c0c0400
  s_mov_b32 s57, 0x0c040100
  s_mov_b32 s58, 0x04020100
  s_mov_b32 s53, 0x10001
  v_mov_b32 v2, 0xffffff00
  s_lshr_b32 s77, s2, 5
  s_and_b32 s78, s2, 127
  s_and_b32 s76, s2, 7
  s_lshl_b32 s76, s76, 2
  s_bfe_u32 s97, s2, 0x20003
  s_add_u32 s76, s76, s97
  s_bfe_u32 s79, s2, 0x40003
  s_and_b32 s80, s2, 7
  s_bfe_u32 s17, s2, 0x20003
  s_bfe_u32 s59, s2, 0x10004
  s_lshl_b32 s59, s59, 14
  v_lshrrev_b32 v245, 4, v1
  v_and_b32 v246, 15, v1
  v_lshlrev_b32 v247, 2, v245
  v_xor_b32 v246, v246, v247
  v_lshlrev_b32 v246, 4, v246
  v_lshl_add_u32 v244, v245, 10, v246
  v_xor_b32 v245, 16, v244
  v_xor_b32 v246, 32, v244
  v_xor_b32 v247, 48, v244
  v_add_u32 v245, 3072, v245
  v_add_u32 v246, 6144, v246
  v_add_u32 v247, 9216, v247
  s_and_b32 s91, s3, 3
  s_lshl_b32 s90, s91, 15
  s_lshl_b32 s91, s91, 13
  s_lshl_b32 s92, s2, 17
  s_add_u32 s90, s90, s92
  s_bfe_u32 s93, s2, 0x20003
  s_lshl_b32 s92, s93, 15
  s_add_u32 s91, s91, s92
  s_lshl_b32 s92, s93, 8
  s_add_u32 s90, s90, s92
  s_mov_b64 s[36:37], s[6:7]
  s_mov_b32 s38, 0x2000000
  s_mov_b32 s39, 0x20000
  s_barrier
  s_lshr_b32 s92, s3, 2
  s_lshl_b32 s93, s92, 12
  s_xor_b32 s93, s93, 0
  s_xor_b32 m0, s91, s93
  s_lshl_b32 s93, s92, 14
  s_xor_b32 s93, s93, 0
  s_xor_b32 s101, s90, s93
  buffer_load_dwordx4 v244, s[36:39], s101 offen offset:0 nt lds
  buffer_load_dwordx4 v245, s[36:39], s101 offen offset:1024 nt lds
  buffer_load_dwordx4 v246, s[36:39], s101 offen offset:2048 nt lds
  buffer_load_dwordx4 v247, s[36:39], s101 offen offset:3072 nt lds
  s_lshr_b32 s92, s3, 2
  s_lshl_b32 s93, s92, 12
  s_xor_b32 s93, s93, 32768
  s_xor_b32 m0, s91, s93
  s_lshl_b32 s93, s92, 14
  s_xor_b32 s93, s93, 256
  s_xor_b32 s101, s90, s93
  buffer_load_dwordx4 v244, s[36:39], s101 offen offset:0 nt lds
  buffer_load_dwordx4 v245, s[36:39], s101 offen offset:1024 nt lds
  buffer_load_dwordx4 v246, s[36:39], s101 offen offset:2048 nt lds
  buffer_load_dwordx4 v247, s[36:39], s101 offen offset:3072 nt lds
  s_and_b32 s92, s3, 1
  s_lshl_b32 s92, s92, 15
  s_lshr_b32 s97, s3, 1
  s_lshl_b32 s97, s97, 8
  s_add_u32 s92, s92, s97
  s_add_u32 s92, s92, s81
  v_and_b32 v45, 15, v1
  v_mul_u32_u24 v45, 1040, v45
  v_add_u32 v45, s92, v45
  v_lshrrev_b32 v34, 4, v1
  v_lshlrev_b32 v34, 4, v34
  v_xor_b32 v45, v45, v34
  v_lshrrev_b32 v37, 4, v1
  v_lshlrev_b32 v37, 11, v37
  v_and_b32 v3, 15, v1
  v_lshl_add_u32 v37, v3, 4, v37
  s_and_b32 s83, s2, 7
  s_lshl_b32 s83, s83, 14
  s_lshl_b32 s97, s3, 8
  s_add_u32 s83, s83, s97
  s_add_u32 s83, s83, 0x80000
  s_add_u32 s85, s83, 8192
  s_lshl_b32 s92, s3, 7
  s_add_u32 s92, s92, 0x21000
  v_and_b32 v47, 15, v1
  v_lshlrev_b32 v47, 3, v47
  v_lshrrev_b32 v3, 4, v1
  v_lshl_add_u32 v47, v3, 1, v47
  v_add_u32 v47, s92, v47
  s_lshr_b32 s92, s3, 1
  s_lshl_b32 s92, s92, 8
  s_add_u32 s92, s92, 0x21000
  v_lshrrev_b32 v35, 4, v1
  v_lshlrev_b32 v35, 4, v35
  v_add_u32 v35, s92, v35
  v_bfe_u32 v39, v1, 4, 1
  v_lshlrev_b32 v39, 5, v39
  v_lshrrev_b32 v3, 5, v1
  v_lshl_add_u32 v39, v3, 4, v39
  s_and_b32 s84, s2, 7
  s_lshl_b32 s84, s84, 12
  s_lshr_b32 s97, s3, 1
  s_lshl_b32 s97, s97, 10
  s_add_u32 s84, s84, s97
  s_bfe_u32 s97, s2, 0x30003
  s_lshl_b32 s97, s97, 7
  s_add_u32 s84, s84, s97
  s_and_b32 s97, s3, 1
  s_lshl_b32 s97, s97, 6
  s_add_u32 s84, s84, s97
  s_add_u32 s84, s84, 0x10000
  s_waitcnt vmcnt(8)
  s_barrier
  v_xor_b32 v32, 0, v45
  ds_read_b128 v[112:115], v32 offset:0
  v_xor_b32 v33, 64, v45
  ds_read_b128 v[116:119], v33 offset:0
  v_xor_b32 v32, 128, v45
  ds_read_b128 v[120:123], v32 offset:0
  v_xor_b32 v33, 192, v45
  ds_read_b128 v[124:127], v33 offset:0
  v_xor_b32 v32, 0, v45
  ds_read_b128 v[128:131], v32 offset:16384
  v_xor_b32 v33, 64, v45
  ds_read_b128 v[132:135], v33 offset:16384
  v_xor_b32 v32, 128, v45
  ds_read_b128 v[136:139], v32 offset:16384
  v_xor_b32 v33, 192, v45
  ds_read_b128 v[140:143], v33 offset:16384
  s_waitcnt lgkmcnt(0)
  s_barrier
  s_mov_b32 s100, 0
  v_mov_b32 v253, 0
L_ep_8:
  global_load_dword v252, v253, s[30:31] sc1
  s_add_u32 s100, s100, 1
  s_cmp_gt_u32 s100, 100000
  s_cbranch_scc1 L_abort
  s_waitcnt vmcnt(0)
L_epc_9:
  v_readfirstlane_b32 s48, v252
  s_nop 0
  s_cmp_eq_u32 s48, 0
  s_nop 1
  s_cbranch_scc1 L_ep_8
  s_mul_i32 s48, s48, 0x9e3779b1
  s_and_b32 s49, s48, 0xff
  s_bfe_u32 s50, s48, 0x80008
  s_bfe_u32 s51, s48, 0x80010
  s_lshr_b32 s52, s48, 24
  s_lshr_b32 s97, s48, 15
  s_xor_b32 s97, s97, s48
  s_mul_i32 s97, s97, 0x85ebca6b
  v_mov_b32 v4, s48
  v_mov_b32 v5, s97
  v_mov_b32 v249, s48
  v_mov_b32 v250, s97
  v_and_b32 v6, 4, v1
  v_cmp_eq_u32 vcc, 0, v6
  v_and_b32 v7, 3, v1
  v_lshlrev_b32 v7, 2, v7
  v_cndmask_b32 v4, v5, v4, vcc
  v_lshrrev_b32 v4, v7, v4
  v_lshrrev_b32 v5, 1, v4
  v_lshrrev_b32 v6, 2, v4
  v_lshrrev_b32 v7, 3, v4
  s_and_b32 s92, s3, 1
  s_sub_u32 s74, 0, s92
  s_mov_b32 s75, s74
  v_bfe_u32 v28, v1, 4, 1
  v_lshlrev_b32 v28, 3, v28
  v_lshrrev_b32 v3, 5, v1
  v_lshl_add_u32 v28, v3, 2, v28
  v_mov_b32 v68, s48
  v_mov_b32 v69, s97
  v_cndmask_b32 v68, v68, v69, s[74:75]
  v_lshrrev_b32 v68, v28, v68
  v_lshrrev_b32 v69, 1, v68
  v_lshrrev_b32 v70, 2, v68
  v_lshrrev_b32 v71, 3, v68
  s_mov_b64 s[60:61], -1
  s_mov_b64 s[62:63], -1
  s_mov_b32 s100, 0
  s_branch L_gf_11
L_g_10:
  s_add_u32 s100, s100, 1
  s_cmp_gt_u32 s100, 100000
  s_cbranch_scc1 L_abort
  s_sleep 1
  s_cmp_lg_u32 s100, 40
  s_cbranch_scc1 L_alt_13
  s_add_u32 s83, s83, 0x100000
  s_add_u32 s85, s85, 0x100000
L_alt_13:
L_gf_11:
  s_mov_b64 exec, s[60:61]
  s_cbranch_execz L_gs_14
  buffer_load_dwordx4 v[20:23], v37, s[32:35], s83 offen offset:0 sc1
L_gs_14:
  s_mov_b64 exec, s[62:63]
  s_cbranch_execz L_gs_15
  buffer_load_dwordx4 v[24:27], v37, s[32:35], s85 offen offset:0 sc1
L_gs_15:
  s_waitcnt vmcnt(0)
L_gc_12:
  s_mov_b64 exec, s[60:61]
  v_perm_b32 v92, v21, v20, s56
  v_perm_b32 v92, v22, v92, s57
  v_perm_b32 v92, v23, v92, s58
  v_cmp_ne_u32 s[60:61], s48, v92
  s_mov_b64 exec, s[62:63]
  v_perm_b32 v92, v25, v24, s56
  v_perm_b32 v92, v26, v92, s57
  v_perm_b32 v92, v27, v92, s58
  v_cmp_ne_u32 s[62:63], s48, v92
  s_nop 0
  s_or_b64 s[96:97], s[60:61], s[62:63]
  s_cbranch_scc1 L_g_10
  s_mov_b64 exec, -1
  v_add_f32 v20, v20, v24
  v_add_f32 v21, v21, v25
  v_add_f32 v22, v22, v26
  v_add_f32 v23, v23, v27
  s_nop 0
  v_permlane32_swap_b32 v20, v22
  v_permlane32_swap_b32 v21, v23
  v_add_f32 v20, v20, v22
  v_add_f32 v21, v21, v23
  s_nop 1
  v_permlane16_swap_b32 v20, v21
  v_add_f32 v20, v20, v21
  v_cvt_pk_bf16_f32 v20, v20, v20
  ds_write_b16 v47, v20
  s_waitcnt lgkmcnt(0)
  s_barrier
  ds_read_b128 v[52:55], v35 offset:0
  ds_read_b128 v[56:59], v35 offset:64
  ds_read_b128 v[60:63], v35 offset:128
  ds_read_b128 v[64:67], v35 offset:192
  s_waitcnt lgkmcnt(3)
  v_mfma_f32_16x16x32_bf16 v[80:83], v[112:115], v[52:55], 0
  v_mfma_f32_16x16x32_bf16 v[84:87], v[128:131], v[52:55], 0
  s_waitcnt lgkmcnt(2)
  v_mfma_f32_16x16x32_bf16 v[80:83], v[116:119], v[56:59], v[80:83]
  v_mfma_f32_16x16x32_bf16 v[84:87], v[132:135], v[56:59], v[84:87]
  s_waitcnt lgkmcnt(1)
  v_mfma_f32_16x16x32_bf16 v[80:83], v[120:123], v[60:63], v[80:83]
  v_mfma_f32_16x16x32_bf16 v[84:87], v[136:139], v[60:63], v[84:87]
  s_waitcnt lgkmcnt(0)
  v_mfma_f32_16x16x32_bf16 v[80:83], v[124:127], v[64:67], v[80:83]
  v_mfma_f32_16x16x32_bf16 v[84:87], v[140:143], v[64:67], v[84:87]
  s_nop 6
  v_mul_f32 v80, 0x3e0293ee, v80
  v_mul_f32 v81, 0x3e0293ee, v81
  v_mul_f32 v82, 0x3e0293ee, v82
  v_mul_f32 v83, 0x3e0293ee, v83
  v_mul_f32 v84, 0x3e0293ee, v84
  v_mul_f32 v85, 0x3e0293ee, v85
  v_mul_f32 v86, 0x3e0293ee, v86
  v_mul_f32 v87, 0x3e0293ee, v87
  v_cvt_pk_bf16_f32 v20, v80, v81
  v_cvt_pk_bf16_f32 v21, v82, v83
  v_cvt_pk_bf16_f32 v22, v84, v85
  v_cvt_pk_bf16_f32 v23, v86, v87
  s_nop 0
  v_permlane16_swap_b32 v20, v22
  v_permlane16_swap_b32 v21, v23
  v_bfi_b32 v20, s53, v68, v20
  v_bfi_b32 v21, s53, v69, v21
  v_bfi_b32 v22, s53, v70, v22
  v_bfi_b32 v23, s53, v71, v23
  s_mov_b32 exec_lo, 0x10001
  s_mov_b32 exec_hi, 0x10001
  buffer_store_dwordx4 v[20:23], v39, s[32:35], s84 offen sc1
  s_mov_b64 exec, -1
  s_barrier
  s_lshr_b32 s92, s3, 2
  s_lshl_b32 s93, s92, 12
  s_xor_b32 s93, s93, 65536
  s_xor_b32 m0, s91, s93
  s_lshl_b32 s93, s92, 14
  s_xor_b32 s93, s93, 512
  s_xor_b32 s101, s90, s93
  buffer_load_dwordx4 v244, s[36:39], s101 offen offset:0 nt lds
  buffer_load_dwordx4 v245, s[36:39], s101 offen offset:1024 nt lds
  buffer_load_dwordx4 v246, s[36:39], s101 offen offset:2048 nt lds
  buffer_load_dwordx4 v247, s[36:39], s101 offen offset:3072 nt lds
  s_cmp_ge_u32 s3, 4
  s_cbranch_scc0 L_kf
  s_branch L_back
L_kf:
  s_xor_b32 m0, s91, 98304
  s_xor_b32 s101, s90, 768
  buffer_load_dwordx4 v244, s[36:39], s101 offen offset:0 nt lds
  buffer_load_dwordx4 v245, s[36:39], s101 offen offset:1024 nt lds
  buffer_load_dwordx4 v246, s[36:39], s101 offen offset:2048 nt lds
  buffer_load_dwordx4 v247, s[36:39], s101 offen offset:3072 nt lds
  s_barrier
  s_branch L_setup
L_Bback2:
  s_mov_b32 s54, 0x05040100
  s_mov_b32 s55, 0x07060302
  s_mov_b32 s56, 0x0c0c0400
  s_mov_b32 s57, 0x0c040100
  s_mov_b32 s58, 0x04020100
  s_mov_b32 s53, 0x10001
  v_mov_b32 v2, 0xffffff00
  s_lshr_b32 s77, s2, 5
  s_and_b32 s78, s2, 127
  s_and_b32 s76, s2, 7
  s_lshl_b32 s76, s76, 2
  s_bfe_u32 s97, s2, 0x20003
  s_add_u32 s76, s76, s97
  s_bfe_u32 s79, s2, 0x40003
  s_and_b32 s80, s2, 7
  s_bfe_u32 s17, s2, 0x20003
  s_bfe_u32 s59, s2, 0x10004
  s_lshl_b32 s59, s59, 14
  s_lshl_b32 s81, s95, 2
  s_add_u32 s81, s81, s94
  s_lshl_b32 s81, s81, 8
  s_add_u32 s81, s81, 0
  v_and_b32 v8, 7, v1
  v_lshlrev_b32 v8, 2, v8
  v_lshrrev_b32 v9, 4, v1
  v_add_u32 v8, v8, v9
  v_lshlrev_b32 v8, 5, v8
  s_lshl_b32 s92, s3, 2
  s_add_u32 s92, s92, 139248
  v_add_u32 v8, s92, v8
  v_lshlrev_b32 v9, 6, v1
  v_add_u32 v9, 139264, v9
  v_lshlrev_b32 v10, 4, v1
  s_bitcmp1_b32 s2, 6
  s_cbranch_scc1 L_nou0b
  s_waitcnt vmcnt(4)
  v_mov_b32 v253, 0
  global_load_dword v252, v253, s[30:31] sc1
  v_lshlrev_b32 v120, 16, v112
  v_and_b32 v121, 0xffff0000, v112
  v_lshlrev_b32 v122, 16, v113
  v_and_b32 v123, 0xffff0000, v113
  v_mul_f32 v116, 0xbfb8aa3b, v120
  v_mul_f32 v117, 0xbfb8aa3b, v121
  v_mul_f32 v118, 0xbfb8aa3b, v122
  v_mul_f32 v119, 0xbfb8aa3b, v123
  v_exp_f32 v116, v116
  v_exp_f32 v117, v117
  v_exp_f32 v118, v118
  v_exp_f32 v119, v119
  v_add_f32 v116, 1.0, v116
  v_add_f32 v117, 1.0, v117
  v_add_f32 v118, 1.0, v118
  v_add_f32 v119, 1.0, v119
  v_rcp_f32 v116, v116
  v_rcp_f32 v117, v117
  v_rcp_f32 v118, v118
  v_rcp_f32 v119, v119
  v_mul_f32 v120, v120, v116
  v_mul_f32 v121, v121, v117
  v_mul_f32 v122, v122, v118
  v_mul_f32 v123, v123, v119
  v_cvt_pk_bf16_f32 v120, v120, v120
  v_cvt_pk_bf16_f32 v121, v121, v121
  v_cvt_pk_bf16_f32 v122, v122, v122
  v_cvt_pk_bf16_f32 v123, v123, v123
  v_lshrrev_b32 v116, 16, v120
  v_lshrrev_b32 v117, 16, v121
  v_lshrrev_b32 v118, 16, v122
  v_lshrrev_b32 v119, 16, v123
  v_and_b32 v120, 0xffff0000, v120
  v_and_b32 v121, 0xffff0000, v121
  v_and_b32 v122, 0xffff0000, v122
  v_and_b32 v123, 0xffff0000, v123
  v_mov_b32 v96, 0
  v_mov_b32 v97, 0
  v_mov_b32 v98, 0
  v_mov_b32 v99, 0
  v_mov_b32 v100, 0
  v_mov_b32 v101, 0
  v_mov_b32 v102, 0
  v_mov_b32 v103, 0
  s_waitcnt vmcnt(4)
  v_dot2c_f32_bf16 v96, v116, v124
  v_dot2c_f32_bf16 v97, v120, v124
  v_dot2c_f32_bf16 v98, v116, v125
  v_dot2c_f32_bf16 v99, v120, v125
  v_dot2c_f32_bf16 v100, v116, v126
  v_dot2c_f32_bf16 v101, v120, v126
  v_dot2c_f32_bf16 v102, v116, v127
  v_dot2c_f32_bf16 v103, v120, v127
  s_waitcnt vmcnt(3)
  v_dot2c_f32_bf16 v96, v117, v128
  v_dot2c_f32_bf16 v97, v121, v128
  v_dot2c_f32_bf16 v98, v117, v129
  v_dot2c_f32_bf16 v99, v121, v129
  v_dot2c_f32_bf16 v100, v117, v130
  v_dot2c_f32_bf16 v101, v121, v130
  v_dot2c_f32_bf16 v102, v117, v131
  v_dot2c_f32_bf16 v103, v121, v131
  s_waitcnt vmcnt(2)
  v_dot2c_f32_bf16 v96, v118, v132
  v_dot2c_f32_bf16 v97, v122, v132
  v_dot2c_f32_bf16 v98, v118, v133
  v_dot2c_f32_bf16 v99, v122, v133
  v_dot2c_f32_bf16 v100, v118, v134
  v_dot2c_f32_bf16 v101, v122, v134
  v_dot2c_f32_bf16 v102, v118, v135
  v_dot2c_f32_bf16 v103, v122, v135
  s_waitcnt vmcnt(1)
  v_dot2c_f32_bf16 v96, v119, v136
  v_dot2c_f32_bf16 v97, v123, v136
  v_dot2c_f32_bf16 v98, v119, v137
  v_dot2c_f32_bf16 v99, v123, v137
  v_dot2c_f32_bf16 v100, v119, v138
  v_dot2c_f32_bf16 v101, v123, v138
  v_dot2c_f32_bf16 v102, v119, v139
  v_dot2c_f32_bf16 v103, v123, v139
  v_permlane32_swap_b32 v96, v100
  v_permlane32_swap_b32 v97, v101
  v_permlane32_swap_b32 v98, v102
  v_permlane32_swap_b32 v99, v103
  v_add_f32 v96, v96, v100
  v_add_f32 v97, v97, v101
  v_add_f32 v98, v98, v102
  v_add_f32 v99, v99, v103
  s_nop 0
  v_permlane16_swap_b32 v96, v98
  v_permlane16_swap_b32 v97, v99
  v_add_f32 v96, v96, v98
  v_add_f32 v97, v97, v99
  s_nop 0
  v_add_f32_dpp v96, v96, v96 row_ror:8 row_mask:0xf bank_mask:0xf
  v_add_f32_dpp v97, v97, v97 row_ror:8 row_mask:0xf bank_mask:0xf
  s_mov_b32 s100, 0
  s_waitcnt vmcnt(0)
  s_branch L_epc_17
L_ep_16:
  global_load_dword v252, v253, s[30:31] sc1
  s_add_u32 s100, s100, 1
  s_cmp_gt_u32 s100, 100000
  s_cbranch_scc1 L_abort
  s_waitcnt vmcnt(0)
L_epc_17:
  v_readfirstlane_b32 s48, v252
  s_nop 0
  s_cmp_eq_u32 s48, 0
  s_nop 1
  s_cbranch_scc1 L_ep_16
  s_mul_i32 s48, s48, 0x9e3779b1
  s_and_b32 s49, s48, 0xff
  s_bfe_u32 s50, s48, 0x80008
  s_bfe_u32 s51, s48, 0x80010
  s_lshr_b32 s52, s48, 24
  ds_write2_b32 v8, v96, v97 offset0:0 offset1:4
  s_waitcnt lgkmcnt(0)
  s_barrier
  s_cmp_lg_u32 s3, 4
  s_cbranch_scc1 L_nopub_18
  s_mov_b64 exec, 0xffff
  ds_read_b128 v[124:127], v9 offset:0
  ds_read_b128 v[128:131], v9 offset:16
  ds_read_b128 v[132:135], v9 offset:32
  ds_read_b128 v[136:139], v9 offset:48
  s_waitcnt lgkmcnt(3)
  v_add_f32 v124, v124, v125
  v_add_f32 v126, v126, v127
  v_add_f32 v124, v124, v126
  s_waitcnt lgkmcnt(2)
  v_add_f32 v128, v128, v129
  v_add_f32 v130, v130, v131
  v_add_f32 v128, v128, v130
  s_waitcnt lgkmcnt(1)
  v_add_f32 v132, v132, v133
  v_add_f32 v134, v134, v135
  v_add_f32 v132, v132, v134
  s_waitcnt lgkmcnt(0)
  v_add_f32 v136, v136, v137
  v_add_f32 v138, v138, v139
  v_add_f32 v136, v136, v138
  v_and_or_b32 v100, v124, v2, s49
  v_and_or_b32 v101, v128, v2, s50
  v_and_or_b32 v102, v132, v2, s51
  v_and_or_b32 v103, v136, v2, s52
  buffer_store_dwordx4 v[100:103], v10, s[32:35], s81 offen sc1
L_nopub_18:
  s_mov_b64 exec, -1
  s_barrier
  s_branch L_nou0c
L_nou0b:
  v_lshlrev_b32 v12, 7, v1
  v_lshlrev_b32 v14, 9, v1
  s_bfe_u32 s93, s2, 0x30003
  s_and_b32 s94, s2, 7
  s_cmp_lg_u32 s3, 4
  s_cbranch_scc1 L_ew5
  s_mov_b32 exec_hi, 0
  s_lshl_b32 s92, s93, 12
  s_add_u32 s92, s92, 0x10000
  buffer_load_dword v254, v12, s[32:35], s92 offen sc1
  s_lshl_b32 s92, s93, 14
  s_lshr_b32 s97, s94, 1
  s_lshl_b32 s97, s97, 7
  s_add_u32 s92, s92, s97
  s_add_u32 s92, s92, 0x20000
  buffer_load_dword v254, v14, s[32:35], s92 offen sc1
  s_mov_b32 exec_lo, 0xffff
  s_lshl_b32 s92, s94, 14
  s_lshl_b32 s97, s93, 11
  s_add_u32 s92, s92, s97
  s_add_u32 s92, s92, 0x80000
  buffer_load_dword v254, v12, s[32:35], s92 offen sc1
  s_lshl_b32 s92, s94, 11
  s_add_u32 s92, s92, 0x18000
  buffer_load_dword v254, v12, s[32:35], s92 offen sc1
  s_lshl_b32 s92, s93, 11
  buffer_load_dword v254, v12, s[32:35], s92 offen sc1
  s_branch L_ewx
L_ew5:
  s_cmp_lg_u32 s3, 5
  s_cbranch_scc1 L_ew6
  s_mov_b32 exec_hi, 0
  s_min_u32 s95, s93, 6
  s_mul_i32 s92, s94, 28672
  s_lshl_b32 s97, s95, 12
  s_add_u32 s92, s92, s97
  s_add_u32 s92, s92, 0xd0000
  buffer_load_dword v254, v12, s[32:35], s92 offen sc1
  s_branch L_ewx
L_ew6:
  s_cmp_lg_u32 s3, 6
  s_cbranch_scc1 L_ew7
  s_mov_b32 exec_hi, 0
  s_cmp_lg_u32 s94, 0
  s_cbranch_scc1 L_ewx
  s_mul_i32 s92, s93, 8448
  s_add_u32 s92, s92, 0x60000
  buffer_load_dword v254, v12, s[32:35], s92 offen sc1
  s_add_u32 s92, s92, 4224
  buffer_load_dword v254, v12, s[32:35], s92 offen sc1
  s_branch L_ewx
L_ew7:
  s_cmp_ge_u32 s93, 4
  s_cbranch_scc1 L_ew7b
  s_mov_b32 exec_hi, 0
  s_lshl_b32 s92, s94, 14
  s_lshl_b32 s97, s93, 12
  s_add_u32 s92, s92, s97
  s_add_u32 s92, s92, 0x40000
  buffer_load_dword v254, v12, s[32:35], s92 offen sc1
  s_branch L_ewx
L_ew7b:
  s_mul_i32 s92, s94, 8448
  s_and_b32 s97, s93, 1
  s_mul_i32 s97, s97, 67584
  s_add_u32 s92, s92, s97
  s_add_u32 s92, s92, 0xa0000
  buffer_load_dword v254, v12, s[32:35], s92 offen sc1
L_ewx:
  s_mov_b64 exec, -1
  s_barrier
  s_barrier
  s_mov_b32 s100, 0
  v_mov_b32 v253, 0
L_ep_19:
  global_load_dword v252, v253, s[30:31] sc1
  s_add_u32 s100, s100, 1
  s_cmp_gt_u32 s100, 100000
  s_cbranch_scc1 L_abort
  s_waitcnt vmcnt(0)
L_epc_20:
  v_readfirstlane_b32 s48, v252
  s_nop 0
  s_cmp_eq_u32 s48, 0
  s_nop 1
  s_cbranch_scc1 L_ep_19
  s_mul_i32 s48, s48, 0x9e3779b1
  s_and_b32 s49, s48, 0xff
  s_bfe_u32 s50, s48, 0x80008
  s_bfe_u32 s51, s48, 0x80010
  s_lshr_b32 s52, s48, 24
L_nou0c:
  s_lshr_b32 s97, s48, 15
  s_xor_b32 s97, s97, s48
  s_mul_i32 s97, s97, 0x85ebca6b
  v_mov_b32 v4, s48
  v_mov_b32 v5, s97
  v_mov_b32 v249, s48
  v_mov_b32 v250, s97
  v_and_b32 v6, 4, v1
  v_cmp_eq_u32 vcc, 0, v6
  v_and_b32 v7, 3, v1
  v_lshlrev_b32 v7, 2, v7
  v_cndmask_b32 v4, v5, v4, vcc
  v_lshrrev_b32 v4, v7, v4
  v_lshrrev_b32 v5, 1, v4
  v_lshrrev_b32 v6, 2, v4
  v_lshrrev_b32 v7, 3, v4
  v_lshrrev_b32 v245, 4, v1
  v_and_b32 v246, 15, v1
  v_lshlrev_b32 v247, 2, v245
  v_xor_b32 v246, v246, v247
  v_lshlrev_b32 v246, 4, v246
  v_lshl_add_u32 v244, v245, 10, v246
  v_xor_b32 v245, 16, v244
  v_xor_b32 v246, 32, v244
  v_xor_b32 v247, 48, v244
  v_add_u32 v245, 3072, v245
  v_add_u32 v246, 6144, v246
  v_add_u32 v247, 9216, v247
  s_and_b32 s91, s3, 3
  s_lshl_b32 s90, s91, 15
  s_lshl_b32 s91, s91, 13
  s_lshl_b32 s92, s2, 17
  s_add_u32 s90, s90, s92
  s_bfe_u32 s93, s2, 0x20003
  s_lshl_b32 s92, s93, 15
  s_add_u32 s91, s91, s92
  s_lshl_b32 s92, s93, 8
  s_add_u32 s90, s90, s92
  s_mov_b64 s[36:37], s[6:7]
  s_mov_b32 s38, 0x2000000
  s_mov_b32 s39, 0x20000
  v_lshlrev_b32 v12, 21, v1
  v_add_u32 v12, 0xf000, v12
  s_mov_b64 exec, 0x3f
  buffer_load_dword v254, v12, s[32:35], 0 offen
  s_mov_b64 exec, -1
  s_and_b32 s81, s3, 3
  s_lshl_b32 s81, s81, 13
  s_add_u32 s81, s81, 0x10000
  v_lshlrev_b32 v8, 4, v1
  s_add_u32 s82, s81, 4096
  v_lshrrev_b32 v9, 4, v1
  v_lshlrev_b32 v9, 13, v9
  v_and_b32 v3, 15, v1
  v_lshl_add_u32 v9, v3, 4, v9
  s_and_b32 s93, s3, 3
  s_lshl_b32 s93, s93, 11
  s_and_b32 s97, s3, 1
  s_lshl_b32 s97, s97, 5
  s_add_u32 s93, s93, s97
  s_add_u32 s93, s93, 0x20000
  v_xor_b32 v9, s93, v9
  s_xor_b32 m0, s91, 4096
  s_xor_b32 s101, s90, 16384
  buffer_load_dwordx4 v244, s[36:39], s101 offen offset:0 nt lds
  s_waitcnt vmcnt(0)
  buffer_load_dwordx4 v245, s[36:39], s101 offen offset:1024 nt lds
  s_waitcnt vmcnt(0)
  buffer_load_dwordx4 v246, s[36:39], s101 offen offset:2048 nt lds
  s_waitcnt vmcnt(2)
  buffer_load_dwordx4 v247, s[36:39], s101 offen offset:3072 nt lds
  s_waitcnt vmcnt(2)
  s_xor_b32 m0, s91, 36864
  s_xor_b32 s101, s90, 16640
  buffer_load_dwordx4 v244, s[36:39], s101 offen offset:0 nt lds
  s_waitcnt vmcnt(2)
  buffer_load_dwordx4 v245, s[36:39], s101 offen offset:1024 nt lds
  s_waitcnt vmcnt(2)
  buffer_load_dwordx4 v246, s[36:39], s101 offen offset:2048 nt lds
  s_waitcnt vmcnt(2)
  buffer_load_dwordx4 v247, s[36:39], s101 offen offset:3072 nt lds
  s_waitcnt vmcnt(2)
  s_xor_b32 m0, s91, 69632
  s_xor_b32 s101, s90, 16896
  buffer_load_dwordx4 v244, s[36:39], s101 offen offset:0 nt lds
  buffer_load_dwordx4 v245, s[36:39], s101 offen offset:1024 nt lds
  buffer_load_dwordx4 v246, s[36:39], s101 offen offset:2048 nt lds
  buffer_load_dwordx4 v247, s[36:39], s101 offen offset:3072 nt lds
  s_mov_b64 s[40:41], s[26:27]
  s_mov_b32 s42, 0x300000
  s_mov_b32 s43, 0x20000
  v_lshrrev_b32 v13, 3, v1
  v_mul_u32_u24 v13, 24576, v13
  v_and_b32 v3, 7, v1
  v_lshl_add_u32 v13, v3, 4, v13
  s_lshr_b32 s94, s78, 5
  s_lshl_b32 s94, s94, 2
  s_and_b32 s97, s3, 3
  s_add_u32 s94, s94, s97
  s_lshl_b32 s95, s94, 6
  v_lshrrev_b32 v14, 3, v1
  v_lshlrev_b32 v14, 3, v14
  v_add_u32 v14, s95, v14
  s_mul_i32 s92, s94, 196608
  s_and_b32 s97, s2, 31
  s_lshl_b32 s97, s97, 7
  s_add_u32 s92, s92, s97
  s_add_u32 s92, s92, 0x800
  global_load_dwordx2 v[144:145], v14, s[24:25]
  buffer_load_dwordx4 v[128:131], v13, s[40:43], s92 offen nt
  s_add_u32 s92, s92, 6144
  buffer_load_dwordx4 v[132:135], v13, s[40:43], s92 offen nt
  s_add_u32 s92, s92, 6144
  buffer_load_dwordx4 v[136:139], v13, s[40:43], s92 offen nt
  s_add_u32 s92, s92, 6144
  buffer_load_dwordx4 v[140:143], v13, s[40:43], s92 offen nt
  v_lshrrev_b32 v42, 4, v1
  v_lshlrev_b32 v42, 13, v42
  v_and_b32 v3, 15, v1
  v_lshl_add_u32 v42, v3, 4, v42
  s_lshl_b32 s88, s77, 19
  s_bfe_u32 s97, s3, 0x10001
  s_lshl_b32 s97, s97, 18
  s_add_u32 s88, s88, s97
  s_and_b32 s97, s3, 1
  s_lshl_b32 s97, s97, 15
  s_add_u32 s88, s88, s97
  s_lshl_b32 s97, s76, 8
  s_add_u32 s88, s88, s97
  v_lshrrev_b32 v251, 5, v1
  v_mul_u32_u24 v251, 3584, v251
  v_and_b32 v3, 31, v1
  v_lshl_add_u32 v251, v3, 4, v251
  s_mul_i32 s89, s79, 114688
  s_and_b32 s97, s3, 3
  s_mul_i32 s97, s97, 28672
  s_add_u32 s89, s89, s97
  s_mul_i32 s97, s80, 448
  s_add_u32 s89, s89, s97
  s_barrier
  s_branch L_back1
L_back:
  v_lshlrev_b32 v12, 21, v1
  v_add_u32 v12, 0xf000, v12
  s_mov_b64 exec, 0x3f
  buffer_load_dword v254, v12, s[32:35], 0 offen
  s_mov_b64 exec, -1
  s_and_b32 s81, s3, 3
  s_lshl_b32 s81, s81, 13
  s_add_u32 s81, s81, 0x10000
  v_lshlrev_b32 v8, 4, v1
  s_add_u32 s82, s81, 4096
  v_lshrrev_b32 v9, 4, v1
  v_lshlrev_b32 v9, 13, v9
  v_and_b32 v3, 15, v1
  v_lshl_add_u32 v9, v3, 4, v9
  s_and_b32 s93, s3, 3
  s_lshl_b32 s93, s93, 11
  s_and_b32 s97, s3, 1
  s_lshl_b32 s97, s97, 5
  s_add_u32 s93, s93, s97
  s_add_u32 s93, s93, 0x20000
  v_xor_b32 v9, s93, v9
  v_lshrrev_b32 v42, 4, v1
  v_lshlrev_b32 v42, 13, v42
  v_and_b32 v3, 15, v1
  v_lshl_add_u32 v42, v3, 4, v42
  s_lshl_b32 s88, s77, 19
  s_bfe_u32 s97, s3, 0x10001
  s_lshl_b32 s97, s97, 18
  s_add_u32 s88, s88, s97
  s_and_b32 s97, s3, 1
  s_lshl_b32 s97, s97, 15
  s_add_u32 s88, s88, s97
  s_lshl_b32 s97, s76, 8
  s_add_u32 s88, s88, s97
  v_lshrrev_b32 v251, 4, v1
  v_lshlrev_b32 v251, 10, v251
  v_and_b32 v3, 15, v1
  v_lshl_add_u32 v251, v3, 4, v251
  s_lshl_b32 s89, s76, 17
  s_and_b32 s97, s3, 3
  s_lshl_b32 s97, s97, 15
  s_add_u32 s89, s89, s97
  s_lshl_b32 s97, s77, 8
  s_add_u32 s89, s89, s97
  s_barrier
L_back1:
  buffer_load_dwordx4 v[48:51], v8, s[32:35], s81 offen offset:0 sc1
  buffer_load_dwordx4 v[52:55], v8, s[32:35], s81 offen offset:1024 sc1
  buffer_load_dwordx4 v[56:59], v8, s[32:35], s81 offen offset:2048 sc1
  buffer_load_dwordx4 v[60:63], v8, s[32:35], s81 offen offset:3072 sc1
  buffer_load_dwordx4 v[64:67], v8, s[32:35], s82 offen offset:0 sc1
  buffer_load_dwordx4 v[68:71], v8, s[32:35], s82 offen offset:1024 sc1
  buffer_load_dwordx4 v[72:75], v8, s[32:35], s82 offen offset:2048 sc1
  buffer_load_dwordx4 v[76:79], v8, s[32:35], s82 offen offset:3072 sc1
  s_xor_b32 m0, s91, 102400
  s_xor_b32 s101, s90, 17152
  buffer_load_dwordx4 v244, s[36:39], s101 offen offset:0 nt lds
  buffer_load_dwordx4 v245, s[36:39], s101 offen offset:1024 nt lds
  buffer_load_dwordx4 v246, s[36:39], s101 offen offset:2048 nt lds
  buffer_load_dwordx4 v247, s[36:39], s101 offen offset:3072 nt lds
  s_branch L_setup
L_back2:
  s_mov_b32 s101, 0
  s_mov_b64 s[60:61], -1
  s_mov_b64 s[62:63], -1
  s_mov_b64 s[64:65], -1
  s_mov_b64 s[66:67], -1
  s_mov_b64 s[68:69], -1
  s_mov_b64 s[70:71], -1
  s_mov_b64 s[72:73], -1
  s_mov_b64 s[74:75], -1
  s_waitcnt vmcnt(4)
  s_mov_b32 s100, 0
  s_branch L_gc_23
L_g_21:
  s_add_u32 s100, s100, 1
  s_cmp_gt_u32 s100, 100000
  s_cbranch_scc1 L_abort
  s_mov_b32 s92, 0
  s_cmp_lg_u32 s74, 0
  s_cselect_b32 s92, 7168, s92
  s_cmp_lg_u32 s72, 0
  s_cselect_b32 s92, 6144, s92
  s_cmp_lg_u32 s70, 0
  s_cselect_b32 s92, 5120, s92
  s_cmp_lg_u32 s68, 0
  s_cselect_b32 s92, 4096, s92
  s_cmp_lg_u32 s66, 0
  s_cselect_b32 s92, 3072, s92
  s_cmp_lg_u32 s64, 0
  s_cselect_b32 s92, 2048, s92
  s_cmp_lg_u32 s62, 0
  s_cselect_b32 s92, 1024, s92
  s_cmp_lg_u32 s60, 0
  s_cselect_b32 s92, 0, s92
  s_add_u32 s92, s92, s81
  s_mov_b64 exec, -1
L_qg_24:
  buffer_load_dwordx4 v[16:19], v8, s[32:35], s92 offen sc1
  s_add_u32 s100, s100, 1
  s_cmp_gt_u32 s100, 100000
  s_cbranch_scc1 L_abort
  s_waitcnt vmcnt(0)
  v_xor_b32 v16, v16, v4
  v_bitop3_b32 v16, v17, v5, v16 bitop3:0xbe
  v_bitop3_b32 v16, v18, v6, v16 bitop3:0xbe
  v_bitop3_b32 v16, v19, v7, v16 bitop3:0xbe
  v_and_b32 v16, s53, v16
  v_cmp_ne_u32 vcc, 0, v16
  s_nop 0
  s_cbranch_vccz L_qg_24x
  s_sleep 4
  s_branch L_qg_24
L_qg_24x:
L_gf_22:
  s_mov_b64 exec, s[60:61]
  s_cbranch_execz L_gs_25
  buffer_load_dwordx4 v[48:51], v8, s[32:35], s81 offen offset:0 sc1
L_gs_25:
  s_mov_b64 exec, s[62:63]
  s_cbranch_execz L_gs_26
  buffer_load_dwordx4 v[52:55], v8, s[32:35], s81 offen offset:1024 sc1
L_gs_26:
  s_mov_b64 exec, s[64:65]
  s_cbranch_execz L_gs_27
  buffer_load_dwordx4 v[56:59], v8, s[32:35], s81 offen offset:2048 sc1
L_gs_27:
  s_mov_b64 exec, s[66:67]
  s_cbranch_execz L_gs_28
  buffer_load_dwordx4 v[60:63], v8, s[32:35], s81 offen offset:3072 sc1
L_gs_28:
  s_mov_b64 exec, s[68:69]
  s_cbranch_execz L_gs_29
  buffer_load_dwordx4 v[64:67], v8, s[32:35], s82 offen offset:0 sc1
L_gs_29:
  s_mov_b64 exec, s[70:71]
  s_cbranch_execz L_gs_30
  buffer_load_dwordx4 v[68:71], v8, s[32:35], s82 offen offset:1024 sc1
L_gs_30:
  s_mov_b64 exec, s[72:73]
  s_cbranch_execz L_gs_31
  buffer_load_dwordx4 v[72:75], v8, s[32:35], s82 offen offset:2048 sc1
L_gs_31:
  s_mov_b64 exec, s[74:75]
  s_cbranch_execz L_gs_32
  buffer_load_dwordx4 v[76:79], v8, s[32:35], s82 offen offset:3072 sc1
L_gs_32:
  s_waitcnt vmcnt(0)
L_gc_23:
  s_mov_b64 exec, s[60:61]
  v_xor_b32 v44, v48, v4
  v_bitop3_b32 v44, v49, v5, v44 bitop3:0xbe
  v_bitop3_b32 v44, v50, v6, v44 bitop3:0xbe
  v_bitop3_b32 v44, v51, v7, v44 bitop3:0xbe
  v_and_b32 v44, s53, v44
  v_cmp_ne_u32 s[60:61], 0, v44
  s_nop 0
  s_cmp_lg_u64 s[60:61], 0
  s_cselect_b64 s[60:61], -1, 0
  s_mov_b64 exec, s[62:63]
  v_xor_b32 v44, v52, v4
  v_bitop3_b32 v44, v53, v5, v44 bitop3:0xbe
  v_bitop3_b32 v44, v54, v6, v44 bitop3:0xbe
  v_bitop3_b32 v44, v55, v7, v44 bitop3:0xbe
  v_and_b32 v44, s53, v44
  v_cmp_ne_u32 s[62:63], 0, v44
  s_nop 0
  s_cmp_lg_u64 s[62:63], 0
  s_cselect_b64 s[62:63], -1, 0
  s_mov_b64 exec, s[64:65]
  v_xor_b32 v44, v56, v4
  v_bitop3_b32 v44, v57, v5, v44 bitop3:0xbe
  v_bitop3_b32 v44, v58, v6, v44 bitop3:0xbe
  v_bitop3_b32 v44, v59, v7, v44 bitop3:0xbe
  v_and_b32 v44, s53, v44
  v_cmp_ne_u32 s[64:65], 0, v44
  s_nop 0
  s_cmp_lg_u64 s[64:65], 0
  s_cselect_b64 s[64:65], -1, 0
  s_mov_b64 exec, s[66:67]
  v_xor_b32 v44, v60, v4
  v_bitop3_b32 v44, v61, v5, v44 bitop3:0xbe
  v_bitop3_b32 v44, v62, v6, v44 bitop3:0xbe
  v_bitop3_b32 v44, v63, v7, v44 bitop3:0xbe
  v_and_b32 v44, s53, v44
  v_cmp_ne_u32 s[66:67], 0, v44
  s_nop 0
  s_cmp_lg_u64 s[66:67], 0
  s_cselect_b64 s[66:67], -1, 0
  s_mov_b64 exec, s[68:69]
  v_xor_b32 v44, v64, v4
  v_bitop3_b32 v44, v65, v5, v44 bitop3:0xbe
  v_bitop3_b32 v44, v66, v6, v44 bitop3:0xbe
  v_bitop3_b32 v44, v67, v7, v44 bitop3:0xbe
  v_and_b32 v44, s53, v44
  v_cmp_ne_u32 s[68:69], 0, v44
  s_nop 0
  s_cmp_lg_u64 s[68:69], 0
  s_cselect_b64 s[68:69], -1, 0
  s_mov_b64 exec, s[70:71]
  v_xor_b32 v44, v68, v4
  v_bitop3_b32 v44, v69, v5, v44 bitop3:0xbe
  v_bitop3_b32 v44, v70, v6, v44 bitop3:0xbe
  v_bitop3_b32 v44, v71, v7, v44 bitop3:0xbe
  v_and_b32 v44, s53, v44
  v_cmp_ne_u32 s[70:71], 0, v44
  s_nop 0
  s_cmp_lg_u64 s[70:71], 0
  s_cselect_b64 s[70:71], -1, 0
  s_mov_b64 exec, s[72:73]
  v_xor_b32 v44, v72, v4
  v_bitop3_b32 v44, v73, v5, v44 bitop3:0xbe
  v_bitop3_b32 v44, v74, v6, v44 bitop3:0xbe
  v_bitop3_b32 v44, v75, v7, v44 bitop3:0xbe
  v_and_b32 v44, s53, v44
  v_cmp_ne_u32 s[72:73], 0, v44
  s_nop 0
  s_cmp_lg_u64 s[72:73], 0
  s_cselect_b64 s[72:73], -1, 0
  s_mov_b64 exec, s[74:75]
  v_xor_b32 v44, v76, v4
  v_bitop3_b32 v44, v77, v5, v44 bitop3:0xbe
  v_bitop3_b32 v44, v78, v6, v44 bitop3:0xbe
  v_bitop3_b32 v44, v79, v7, v44 bitop3:0xbe
  v_and_b32 v44, s53, v44
  v_cmp_ne_u32 s[74:75], 0, v44
  s_nop 0
  s_cmp_lg_u64 s[74:75], 0
  s_cselect_b64 s[74:75], -1, 0
  s_or_b64 s[96:97], s[60:61], s[62:63]
  s_or_b64 s[96:97], s[96:97], s[64:65]
  s_or_b64 s[96:97], s[96:97], s[66:67]
  s_or_b64 s[96:97], s[96:97], s[68:69]
  s_or_b64 s[96:97], s[96:97], s[70:71]
  s_or_b64 s[96:97], s[96:97], s[72:73]
  s_or_b64 s[96:97], s[96:97], s[74:75]
  s_cbranch_scc1 L_g_21
  s_mov_b64 exec, -1
  s_mov_b32 s101, 0
  v_xor_b32 v10, 0, v9
  ds_write_b128 v10, v[48:51] offset:0
  v_xor_b32 v11, 64, v9
  ds_write_b128 v11, v[52:55] offset:256
  v_xor_b32 v10, 128, v9
  ds_write_b128 v10, v[56:59] offset:512
  v_xor_b32 v11, 192, v9
  ds_write_b128 v11, v[60:63] offset:768
  v_xor_b32 v10, 16, v9
  ds_write_b128 v10, v[64:67] offset:1024
  v_xor_b32 v11, 80, v9
  ds_write_b128 v11, v[68:71] offset:1280
  v_xor_b32 v10, 144, v9
  ds_write_b128 v10, v[72:75] offset:1536
  v_xor_b32 v11, 208, v9
  ds_write_b128 v11, v[76:79] offset:1792
  s_mov_b64 s[40:41], s[14:15]
  s_mov_b32 s42, 0x400000
  s_mov_b32 s43, 0x20000
  s_mov_b64 s[44:45], s[12:13]
  s_mov_b32 s46, 0x400000
  s_mov_b32 s47, 0x20000
  s_waitcnt lgkmcnt(0)
  s_setprio 3
  s_barrier
  s_cmp_lt_u32 s2, 128
  s_cbranch_scc0 L_lwB
  s_cmp_lg_u32 s101, 0
  s_cbranch_scc1 L_lwX
  buffer_load_dwordx4 v[176:179], v42, s[44:47], s88 offen nt
  s_add_u32 s88, s88, 65536
  buffer_load_dwordx4 v[180:183], v42, s[44:47], s88 offen nt
  s_add_u32 s88, s88, 65536
  buffer_load_dwordx4 v[184:187], v42, s[44:47], s88 offen nt
  s_add_u32 s88, s88, 65536
  buffer_load_dwordx4 v[188:191], v42, s[44:47], s88 offen nt
  buffer_load_dwordx4 v[208:211], v251, s[40:43], s89 offen nt
  s_add_u32 s89, s89, 4096
  buffer_load_dwordx4 v[212:215], v251, s[40:43], s89 offen nt
  s_add_u32 s89, s89, 4096
  buffer_load_dwordx4 v[216:219], v251, s[40:43], s89 offen nt
  s_add_u32 s89, s89, 4096
  buffer_load_dwordx4 v[220:223], v251, s[40:43], s89 offen nt
  s_add_u32 s89, s89, 4096
  buffer_load_dwordx4 v[224:227], v251, s[40:43], s89 offen nt
  s_add_u32 s89, s89, 4096
  buffer_load_dwordx4 v[228:231], v251, s[40:43], s89 offen nt
  s_add_u32 s89, s89, 4096
  buffer_load_dwordx4 v[232:235], v251, s[40:43], s89 offen nt
  s_add_u32 s89, s89, 4096
  buffer_load_dwordx4 v[236:239], v251, s[40:43], s89 offen nt
L_lwX:
  s_barrier
  s_waitcnt vmcnt(12)
  s_barrier
  s_barrier
  s_barrier
  s_branch L_pv
L_lwB:
  s_cmp_lg_u32 s101, 0
  s_cbranch_scc1 L_lwB2
  buffer_load_dwordx4 v[176:179], v42, s[44:47], s88 offen nt
  s_add_u32 s88, s88, 65536
  buffer_load_dwordx4 v[180:183], v42, s[44:47], s88 offen nt
  s_add_u32 s88, s88, 65536
  buffer_load_dwordx4 v[184:187], v42, s[44:47], s88 offen nt
  s_add_u32 s88, s88, 65536
  buffer_load_dwordx4 v[188:191], v42, s[44:47], s88 offen nt
  s_mov_b64 s[40:41], s[18:19]
  s_mov_b32 s42, 0x1c0000
  s_mov_b32 s43, 0x20000
  s_mov_b64 s[44:45], s[20:21]
  s_mov_b32 s46, 0x1c0000
  s_mov_b32 s47, 0x20000
  s_mov_b32 exec_lo, 0xfffffff
  s_mov_b32 exec_hi, 0xfffffff
  buffer_load_dwordx4 v[208:211], v251, s[40:43], s89 offen nt
  buffer_load_dwordx4 v[212:215], v251, s[44:47], s89 offen nt
  s_add_u32 s89, s89, 7168
  buffer_load_dwordx4 v[216:219], v251, s[40:43], s89 offen nt
  buffer_load_dwordx4 v[220:223], v251, s[44:47], s89 offen nt
  s_add_u32 s89, s89, 7168
  buffer_load_dwordx4 v[224:227], v251, s[40:43], s89 offen nt
  buffer_load_dwordx4 v[228:231], v251, s[44:47], s89 offen nt
  s_add_u32 s89, s89, 7168
  buffer_load_dwordx4 v[232:235], v251, s[40:43], s89 offen nt
  buffer_load_dwordx4 v[236:239], v251, s[44:47], s89 offen nt
  s_mov_b64 exec, -1
L_lwB2:
  s_and_b32 s74, s2, 31
  s_lshl_b32 s74, s74, 10
  s_lshr_b32 s97, s78, 5
  s_lshl_b32 s97, s97, 8
  s_add_u32 s74, s74, s97
  s_add_u32 s74, s74, 0x4000
  v_and_b32 v13, 7, v1
  v_lshlrev_b32 v13, 2, v13
  v_lshrrev_b32 v14, 4, v1
  v_add_u32 v13, v13, v14
  v_lshlrev_b32 v13, 5, v13
  s_lshl_b32 s92, s3, 2
  s_add_u32 s92, s92, 141296
  v_add_u32 v13, s92, v13
  v_lshlrev_b32 v14, 6, v1
  v_add_u32 v14, 141312, v14
  v_lshlrev_b32 v15, 4, v1
  v_xor_b32 v13, s59, v13
  v_xor_b32 v14, s59, v14
  s_waitcnt vmcnt(63)
  v_lshlrev_b32 v116, 16, v144
  v_and_b32 v117, 0xffff0000, v144
  v_lshlrev_b32 v118, 16, v145
  v_and_b32 v119, 0xffff0000, v145
  v_mul_f32 v112, 0xbfb8aa3b, v116
  v_mul_f32 v113, 0xbfb8aa3b, v117
  v_mul_f32 v114, 0xbfb8aa3b, v118
  v_mul_f32 v115, 0xbfb8aa3b, v119
  v_exp_f32 v112, v112
  v_exp_f32 v113, v113
  v_exp_f32 v114, v114
  v_exp_f32 v115, v115
  v_add_f32 v112, 1.0, v112
  v_add_f32 v113, 1.0, v113
  v_add_f32 v114, 1.0, v114
  v_add_f32 v115, 1.0, v115
  v_rcp_f32 v112, v112
  v_rcp_f32 v113, v113
  v_rcp_f32 v114, v114
  v_rcp_f32 v115, v115
  v_mul_f32 v116, v116, v112
  v_mul_f32 v117, v117, v113
  v_mul_f32 v118, v118, v114
  v_mul_f32 v119, v119, v115
  v_cvt_pk_bf16_f32 v116, v116, v116
  v_cvt_pk_bf16_f32 v117, v117, v117
  v_cvt_pk_bf16_f32 v118, v118, v118
  v_cvt_pk_bf16_f32 v119, v119, v119
  v_lshrrev_b32 v112, 16, v116
  v_lshrrev_b32 v113, 16, v117
  v_lshrrev_b32 v114, 16, v118
  v_lshrrev_b32 v115, 16, v119
  v_and_b32 v116, 0xffff0000, v116
  v_and_b32 v117, 0xffff0000, v117
  v_and_b32 v118, 0xffff0000, v118
  v_and_b32 v119, 0xffff0000, v119
  v_mov_b32 v96, 0
  v_mov_b32 v97, 0
  v_mov_b32 v98, 0
  v_mov_b32 v99, 0
  v_mov_b32 v100, 0
  v_mov_b32 v101, 0
  v_mov_b32 v102, 0
  v_mov_b32 v103, 0
  s_waitcnt vmcnt(63)
  v_dot2c_f32_bf16 v96, v112, v128
  v_dot2c_f32_bf16 v97, v116, v128
  v_dot2c_f32_bf16 v98, v112, v129
  v_dot2c_f32_bf16 v99, v116, v129
  v_dot2c_f32_bf16 v100, v112, v130
  v_dot2c_f32_bf16 v101, v116, v130
  v_dot2c_f32_bf16 v102, v112, v131
  v_dot2c_f32_bf16 v103, v116, v131
  s_waitcnt vmcnt(62)
  v_dot2c_f32_bf16 v96, v113, v132
  v_dot2c_f32_bf16 v97, v117, v132
  v_dot2c_f32_bf16 v98, v113, v133
  v_dot2c_f32_bf16 v99, v117, v133
  v_dot2c_f32_bf16 v100, v113, v134
  v_dot2c_f32_bf16 v101, v117, v134
  v_dot2c_f32_bf16 v102, v113, v135
  v_dot2c_f32_bf16 v103, v117, v135
  s_waitcnt vmcnt(61)
  v_dot2c_f32_bf16 v96, v114, v136
  v_dot2c_f32_bf16 v97, v118, v136
  v_dot2c_f32_bf16 v98, v114, v137
  v_dot2c_f32_bf16 v99, v118, v137
  v_dot2c_f32_bf16 v100, v114, v138
  v_dot2c_f32_bf16 v101, v118, v138
  v_dot2c_f32_bf16 v102, v114, v139
  v_dot2c_f32_bf16 v103, v118, v139
  s_waitcnt vmcnt(60)
  v_dot2c_f32_bf16 v96, v115, v140
  v_dot2c_f32_bf16 v97, v119, v140
  v_dot2c_f32_bf16 v98, v115, v141
  v_dot2c_f32_bf16 v99, v119, v141
  v_dot2c_f32_bf16 v100, v115, v142
  v_dot2c_f32_bf16 v101, v119, v142
  v_dot2c_f32_bf16 v102, v115, v143
  v_dot2c_f32_bf16 v103, v119, v143
  v_permlane32_swap_b32 v96, v100
  v_permlane32_swap_b32 v97, v101
  v_permlane32_swap_b32 v98, v102
  v_permlane32_swap_b32 v99, v103
  v_add_f32 v96, v96, v100
  v_add_f32 v97, v97, v101
  v_add_f32 v98, v98, v102
  v_add_f32 v99, v99, v103
  s_nop 0
  v_permlane16_swap_b32 v96, v98
  v_permlane16_swap_b32 v97, v99
  v_add_f32 v96, v96, v98
  v_add_f32 v97, v97, v99
  s_nop 0
  v_add_f32_dpp v96, v96, v96 row_ror:8 row_mask:0xf bank_mask:0xf
  v_add_f32_dpp v97, v97, v97 row_ror:8 row_mask:0xf bank_mask:0xf
  s_barrier
  s_waitcnt vmcnt(12)
  s_barrier
  ds_write2_b32 v13, v96, v97 offset0:0 offset1:4
  s_waitcnt lgkmcnt(0)
  s_barrier
  s_cmp_lg_u32 s3, 4
  s_cbranch_scc1 L_nopub_33
  s_mov_b64 exec, 0xffff
  ds_read_b128 v[128:131], v14 offset:0
  ds_read_b128 v[132:135], v14 offset:16
  ds_read_b128 v[136:139], v14 offset:32
  ds_read_b128 v[140:143], v14 offset:48
  s_waitcnt lgkmcnt(3)
  v_add_f32 v128, v128, v129
  v_add_f32 v130, v130, v131
  v_add_f32 v128, v128, v130
  s_waitcnt lgkmcnt(2)
  v_add_f32 v132, v132, v133
  v_add_f32 v134, v134, v135
  v_add_f32 v132, v132, v134
  s_waitcnt lgkmcnt(1)
  v_add_f32 v136, v136, v137
  v_add_f32 v138, v138, v139
  v_add_f32 v136, v136, v138
  s_waitcnt lgkmcnt(0)
  v_add_f32 v140, v140, v141
  v_add_f32 v142, v142, v143
  v_add_f32 v140, v140, v142
  v_and_or_b32 v100, v128, v2, s49
  v_and_or_b32 v101, v132, v2, s50
  v_and_or_b32 v102, v136, v2, s51
  v_and_or_b32 v103, v140, v2, s52
  buffer_store_dwordx4 v[100:103], v15, s[32:35], s74 offen sc1
L_nopub_33:
  s_mov_b64 exec, -1
  s_barrier
  s_branch L_pv
L_front:
  s_mov_b32 s100, 0
  s_waitcnt vmcnt(4)
  s_branch L_epc_35
L_ep_34:
  global_load_dword v252, v253, s[30:31] sc1
  s_add_u32 s100, s100, 1
  s_cmp_gt_u32 s100, 100000
  s_cbranch_scc1 L_abort
  s_waitcnt vmcnt(0)
L_epc_35:
  v_readfirstlane_b32 s48, v252
  s_nop 0
  s_cmp_eq_u32 s48, 0
  s_nop 1
  s_cbranch_scc1 L_ep_34
  s_mul_i32 s48, s48, 0x9e3779b1
  s_and_b32 s49, s48, 0xff
  s_bfe_u32 s50, s48, 0x80008
  s_bfe_u32 s51, s48, 0x80010
  s_lshr_b32 s52, s48, 24
  s_lshr_b32 s97, s48, 15
  s_xor_b32 s97, s97, s48
  s_mul_i32 s97, s97, 0x85ebca6b
  v_mov_b32 v4, s48
  v_mov_b32 v5, s97
  v_mov_b32 v249, s48
  v_mov_b32 v250, s97
  v_and_b32 v6, 4, v1
  v_cmp_eq_u32 vcc, 0, v6
  v_and_b32 v7, 3, v1
  v_lshlrev_b32 v7, 2, v7
  v_cndmask_b32 v4, v5, v4, vcc
  v_lshrrev_b32 v4, v7, v4
  v_lshrrev_b32 v5, 1, v4
  v_lshrrev_b32 v6, 2, v4
  v_lshrrev_b32 v7, 3, v4
L_setup:
  s_lshr_b32 s92, s3, 1
  s_lshl_b32 s92, s92, 15
  s_and_b32 s93, s3, 1
  v_lshlrev_b32 v34, 4, v1
  v_bfe_u32 v44, v1, 2, 2
  v_lshrrev_b32 v45, 5, v1
  v_lshl_add_u32 v46, v45, 2, v44
  v_lshlrev_b32 v46, 8, v46
  v_add_u32 v46, s92, v46
  v_and_b32 v47, 1, v1
  v_lshl_add_u32 v46, v47, 3, v46
  v_lshl_or_b32 v44, v44, 2, v45
  v_bfe_u32 v47, v1, 4, 1
  v_lshlrev_b32 v47, 1, v47
  v_xor_b32 v44, v44, v47
  v_bfe_u32 v47, v1, 1, 1
  v_xor_b32 v44, v44, v47
  s_lshl_b32 s94, s93, 3
  v_xor_b32 v44, s94, v44
  v_xor_b32 v47, 0, v44
  v_lshl_add_u32 v24, v47, 4, v46
  v_xor_b32 v47, 2, v44
  v_lshl_add_u32 v25, v47, 4, v46
  v_add_u32 v25, 2048, v25
  v_xor_b32 v47, 4, v44
  v_lshl_add_u32 v26, v47, 4, v46
  v_xor_b32 v47, 6, v44
  v_lshl_add_u32 v27, v47, 4, v46
  v_add_u32 v27, 2048, v27
  v_add_u32 v28, 132096, v34
  v_and_b32 v44, 31, v1
  v_lshlrev_b32 v29, 5, v44
  v_add_u32 v29, 131072, v29
  v_xor_b32 v28, s59, v28
  v_xor_b32 v29, s59, v29
  s_lshl_b32 s94, s93, 7
  s_add_u32 s94, s94, s92
  v_and_b32 v46, 3, v44
  v_lshlrev_b32 v46, 6, v46
  v_lshl_add_u32 v46, v44, 8, v46
  v_bfe_u32 v47, v44, 1, 2
  v_lshlrev_b32 v45, 1, v45
  v_xor_b32 v47, v47, v45
  v_lshl_add_u32 v46, v47, 4, v46
  v_xor_b32 v244, s94, v46
  v_xor_b32 v245, 16, v244
  v_xor_b32 v246, 64, v244
  v_xor_b32 v247, 0x50, v244
  v_lshrrev_b32 v44, 2, v1
  v_and_b32 v46, 3, v44
  v_lshlrev_b32 v46, 6, v46
  v_lshl_add_u32 v46, v44, 8, v46
  v_bfe_u32 v47, v44, 1, 2
  v_and_b32 v45, 3, v1
  v_xor_b32 v47, v47, v45
  v_lshl_add_u32 v46, v47, 4, v46
  v_xor_b32 v32, s94, v46
  v_xor_b32 v33, 64, v32
  v_lshrrev_b32 v44, 3, v1
  v_bfe_u32 v45, v1, 2, 1
  v_and_b32 v46, 3, v44
  v_xor_b32 v46, v46, v45
  v_lshlrev_b32 v46, 6, v46
  v_lshl_add_u32 v46, v44, 8, v46
  v_lshrrev_b32 v47, 1, v44
  v_and_b32 v45, 3, v1
  v_xor_b32 v47, v47, v45
  v_lshl_add_u32 v46, v47, 4, v46
  v_xor_b32 v32, s94, v46
  s_mul_i32 s87, s2, 32896
  s_lshl_b32 s97, s3, 12
  s_add_u32 s87, s87, s97
  s_add_u32 s87, s87, 0x200000
  s_lshl_b32 s94, s76, 4
  s_lshl_b32 s97, s3, 9
  s_add_u32 s94, s94, s97
  s_add_u32 s94, s94, 0x20000
  v_lshrrev_b32 v35, 3, v1
  v_lshlrev_b32 v35, 12, v35
  v_add_u32 v35, s94, v35
  v_lshlrev_b32 v248, 4, v1
  v_lshrrev_b32 v36, 3, v1
  v_mul_u32_u24 v36, 263168, v36
  v_and_b32 v3, 7, v1
  v_lshl_add_u32 v36, v3, 4, v36
  s_mul_i32 s94, s3, 32896
  s_lshl_b32 s97, s77, 12
  s_add_u32 s94, s94, s97
  s_lshl_b32 s97, s76, 7
  s_add_u32 s94, s94, s97
  s_add_u32 s83, s94, 6307840
  s_add_u32 s84, s94, 8413184
  s_add_u32 s85, s94, 2097152
  s_add_u32 s86, s94, 4202496
  s_mul_i32 s94, s3, 144
  s_add_u32 s94, s94, 0x14000
  v_and_b32 v37, 7, v1
  v_lshlrev_b32 v37, 4, v37
  v_lshrrev_b32 v3, 4, v1
  v_lshl_add_u32 v37, v3, 2, v37
  v_add_u32 v37, s94, v37
  v_and_b32 v38, 7, v1
  v_mul_u32_u24 v38, 144, v38
  v_lshrrev_b32 v3, 4, v1
  v_lshl_add_u32 v38, v3, 4, v38
  v_add_u32 v38, 81920, v38
  s_lshl_b32 s94, s3, 7
  s_add_u32 s94, s94, 0x16c00
  v_lshrrev_b32 v41, 4, v1
  v_lshlrev_b32 v41, 4, v41
  v_add_u32 v41, s94, v41
  v_and_b32 v40, 7, v1
  v_mul_u32_u24 v40, 272, v40
  v_lshrrev_b32 v3, 4, v1
  v_lshl_add_u32 v40, v3, 4, v40
  v_add_u32 v40, 94208, v40
  s_lshl_b32 s94, s76, 12
  s_lshl_b32 s97, s3, 6
  s_add_u32 s94, s94, s97
  s_add_u32 s94, s94, 0x40000
  v_bfe_u32 v39, v1, 2, 3
  v_lshlrev_b32 v39, 9, v39
  v_and_b32 v3, 3, v1
  v_lshl_add_u32 v39, v3, 4, v39
  v_add_u32 v39, s94, v39
  s_lshl_b32 s95, s77, 9
  s_add_u32 s16, s94, s95
  s_and_b32 s94, s3, 3
  s_mul_i32 s94, s94, 4864
  v_lshrrev_b32 v240, 4, v1
  v_mul_u32_u24 v240, 288, v240
  v_and_b32 v3, 15, v1
  v_lshl_add_u32 v240, v3, 4, v240
  v_add_u32 v240, s94, v240
  s_and_b32 s94, s3, 3
  s_mul_i32 s94, s94, 9728
  s_add_u32 s94, s94, 0x5000
  v_lshrrev_b32 v241, 4, v1
  v_mul_u32_u24 v241, 288, v241
  v_and_b32 v3, 15, v1
  v_lshl_add_u32 v241, v3, 4, v241
  v_add_u32 v241, s94, v241
  s_lshl_b32 s94, s3, 5
  v_lshrrev_b32 v242, 4, v1
  v_mul_u32_u24 v242, 2432, v242
  v_bfe_u32 v3, v1, 2, 2
  v_mul_u32_u24 v3, 288, v3
  v_add_u32 v242, v3, v242
  v_and_b32 v3, 3, v1
  v_lshl_add_u32 v242, v3, 3, v242
  v_add_u32 v242, s94, v242
  v_bfe_u32 v43, v1, 2, 3
  v_mul_u32_u24 v43, 272, v43
  v_and_b32 v3, 3, v1
  v_lshl_add_u32 v43, v3, 3, v43
  v_add_u32 v43, 94208, v43
  v_add_u32 v43, s94, v43
  v_lshrrev_b32 v243, 4, v1
  v_mul_u32_u24 v243, 2432, v243
  v_bfe_u32 v3, v1, 2, 2
  v_mul_u32_u24 v3, 288, v3
  v_add_u32 v243, v3, v243
  v_and_b32 v3, 3, v1
  v_lshl_add_u32 v243, v3, 3, v243
  v_add_u32 v243, 20480, v243
  v_add_u32 v243, s94, v243
  s_cmp_ge_u32 s3, 4
  s_cbranch_scc1 L_back2
  v_and_b32 v44, 31, v1
  v_and_b32 v46, 3, v44
  v_lshlrev_b32 v46, 2, v46
  v_bfe_u32 v47, v44, 2, 2
  v_or_b32 v46, v46, v47
  v_lshrrev_b32 v47, 5, v1
  v_xor_b32 v46, v46, v47
  v_lshlrev_b32 v45, 8, v44
  v_xor_b32 v47, 0, v46
  v_lshl_add_u32 v16, v47, 4, v45
  v_xor_b32 v47, 2, v46
  v_lshl_add_u32 v17, v47, 4, v45
  v_xor_b32 v47, 4, v46
  v_lshl_add_u32 v18, v47, 4, v45
  v_xor_b32 v47, 6, v46
  v_lshl_add_u32 v19, v47, 4, v45
  v_xor_b32 v47, 8, v46
  v_lshl_add_u32 v20, v47, 4, v45
  v_xor_b32 v47, 10, v46
  v_lshl_add_u32 v21, v47, 4, v45
  v_xor_b32 v47, 12, v46
  v_lshl_add_u32 v22, v47, 4, v45
  v_xor_b32 v47, 14, v46
  v_lshl_add_u32 v23, v47, 4, v45
  s_lshl_b32 s92, s17, 13
  s_add_u32 s92, s92, 131072
  v_add_u32 v8, s91, v16
  v_add_u32 v16, s92, v16
  v_add_u32 v9, s91, v17
  v_add_u32 v17, s92, v17
  v_add_u32 v10, s91, v18
  v_add_u32 v18, s92, v18
  v_add_u32 v11, s91, v19
  v_add_u32 v19, s92, v19
  v_add_u32 v12, s91, v20
  v_add_u32 v20, s92, v20
  v_add_u32 v13, s91, v21
  v_add_u32 v21, s92, v21
  v_add_u32 v14, s91, v22
  v_add_u32 v22, s92, v22
  v_add_u32 v15, s91, v23
  v_add_u32 v23, s92, v23
  s_lshl_b32 s92, s3, 2
  v_lshrrev_b32 v47, 5, v1
  v_lshl_add_u32 v30, v47, 4, v29
  v_add_u32 v30, s92, v30
  s_lshl_b32 s92, s3, 11
  v_add_u32 v31, s92, v28
  s_setprio 2
  s_mov_b32 s101, 1
  s_waitcnt vmcnt(4)
  s_barrier
  ds_read_b128 v[112:115], v8
  ds_read_b128 v[116:119], v16
  ds_read_b128 v[120:123], v9
  ds_read_b128 v[124:127], v17
  ds_read_b128 v[128:131], v10
  ds_read_b128 v[132:135], v18
  ds_read_b128 v[136:139], v11
  ds_read_b128 v[140:143], v19
  ds_read_b128 v[144:147], v12
  ds_read_b128 v[148:151], v20
  ds_read_b128 v[152:155], v13
  ds_read_b128 v[156:159], v21
  v_xor_b32 v8, 0x8000, v8
  v_xor_b32 v16, 0x2000, v16
  v_xor_b32 v9, 0x8000, v9
  v_xor_b32 v17, 0x2000, v17
  v_xor_b32 v10, 0x8000, v10
  v_xor_b32 v18, 0x2000, v18
  v_xor_b32 v11, 0x8000, v11
  v_xor_b32 v19, 0x2000, v19
  v_xor_b32 v12, 0x8000, v12
  v_xor_b32 v20, 0x2000, v20
  v_xor_b32 v13, 0x8000, v13
  v_xor_b32 v21, 0x2000, v21
  s_waitcnt lgkmcnt(10)
  v_mfma_f32_32x32x16_bf16 v[96:111], v[112:115], v[116:119], 0
  ds_read_b128 v[160:163], v14
  ds_read_b128 v[164:167], v22
  v_xor_b32 v14, 0x8000, v14
  v_xor_b32 v22, 0x2000, v22
  s_waitcnt lgkmcnt(10)
  v_mfma_f32_32x32x16_bf16 v[96:111], v[120:123], v[124:127], v[96:111]
  ds_read_b128 v[168:171], v15
  ds_read_b128 v[172:175], v23
  v_xor_b32 v15, 0x8000, v15
  v_xor_b32 v23, 0x2000, v23
  s_waitcnt lgkmcnt(10)
  v_mfma_f32_32x32x16_bf16 v[96:111], v[128:131], v[132:135], v[96:111]
  ds_read_b128 v[112:115], v8
  ds_read_b128 v[116:119], v16
  v_xor_b32 v8, 0x18000, v8
  v_xor_b32 v16, 0x6000, v16
  s_waitcnt lgkmcnt(10)
  v_mfma_f32_32x32x16_bf16 v[96:111], v[136:139], v[140:143], v[96:111]
  ds_read_b128 v[120:123], v9
  ds_read_b128 v[124:127], v17
  v_xor_b32 v9, 0x18000, v9
  v_xor_b32 v17, 0x6000, v17
  s_waitcnt lgkmcnt(10)
  v_mfma_f32_32x32x16_bf16 v[96:111], v[144:147], v[148:151], v[96:111]
  ds_read_b128 v[128:131], v10
  ds_read_b128 v[132:135], v18
  v_xor_b32 v10, 0x18000, v10
  v_xor_b32 v18, 0x6000, v18
  s_waitcnt lgkmcnt(10)
  v_mfma_f32_32x32x16_bf16 v[96:111], v[152:155], v[156:159], v[96:111]
  ds_read_b128 v[136:139], v11
  ds_read_b128 v[140:143], v19
  v_xor_b32 v11, 0x18000, v11
  v_xor_b32 v19, 0x6000, v19
  s_waitcnt lgkmcnt(10)
  v_mfma_f32_32x32x16_bf16 v[96:111], v[160:163], v[164:167], v[96:111]
  ds_read_b128 v[144:147], v12
  ds_read_b128 v[148:151], v20
  v_xor_b32 v12, 0x18000, v12
  v_xor_b32 v20, 0x6000, v20
  s_waitcnt lgkmcnt(10)
  v_mfma_f32_32x32x16_bf16 v[96:111], v[168:171], v[172:175], v[96:111]
  ds_read_b128 v[152:155], v13
  ds_read_b128 v[156:159], v21
  v_xor_b32 v13, 0x18000, v13
  v_xor_b32 v21, 0x6000, v21
  s_waitcnt lgkmcnt(10)
  v_mfma_f32_32x32x16_bf16 v[96:111], v[112:115], v[116:119], v[96:111]
  ds_read_b128 v[160:163], v14
  ds_read_b128 v[164:167], v22
  v_xor_b32 v14, 0x18000, v14
  v_xor_b32 v22, 0x6000, v22
  s_waitcnt lgkmcnt(10)
  v_mfma_f32_32x32x16_bf16 v[96:111], v[120:123], v[124:127], v[96:111]
  ds_read_b128 v[168:171], v15
  ds_read_b128 v[172:175], v23
  v_xor_b32 v15, 0x18000, v15
  v_xor_b32 v23, 0x6000, v23
  s_waitcnt lgkmcnt(10)
  v_mfma_f32_32x32x16_bf16 v[96:111], v[128:131], v[132:135], v[96:111]
  ds_read_b128 v[112:115], v8
  ds_read_b128 v[116:119], v16
  v_xor_b32 v8, 0x8000, v8
  v_xor_b32 v16, 0x2000, v16
  s_waitcnt lgkmcnt(10)
  v_mfma_f32_32x32x16_bf16 v[96:111], v[136:139], v[140:143], v[96:111]
  ds_read_b128 v[120:123], v9
  ds_read_b128 v[124:127], v17
  v_xor_b32 v9, 0x8000, v9
  v_xor_b32 v17, 0x2000, v17
  s_waitcnt lgkmcnt(10)
  v_mfma_f32_32x32x16_bf16 v[96:111], v[144:147], v[148:151], v[96:111]
  ds_read_b128 v[128:131], v10
  ds_read_b128 v[132:135], v18
  v_xor_b32 v10, 0x8000, v10
  v_xor_b32 v18, 0x2000, v18
  s_waitcnt lgkmcnt(10)
  v_mfma_f32_32x32x16_bf16 v[96:111], v[152:155], v[156:159], v[96:111]
  ds_read_b128 v[136:139], v11
  ds_read_b128 v[140:143], v19
  v_xor_b32 v11, 0x8000, v11
  v_xor_b32 v19, 0x2000, v19
  s_waitcnt lgkmcnt(10)
  v_mfma_f32_32x32x16_bf16 v[96:111], v[160:163], v[164:167], v[96:111]
  ds_read_b128 v[144:147], v12
  ds_read_b128 v[148:151], v20
  v_xor_b32 v12, 0x8000, v12
  v_xor_b32 v20, 0x2000, v20
  s_waitcnt lgkmcnt(10)
  v_mfma_f32_32x32x16_bf16 v[96:111], v[168:171], v[172:175], v[96:111]
  ds_read_b128 v[152:155], v13
  ds_read_b128 v[156:159], v21
  v_xor_b32 v13, 0x8000, v13
  v_xor_b32 v21, 0x2000, v21
  s_barrier
  s_waitcnt lgkmcnt(10)
  v_mfma_f32_32x32x16_bf16 v[96:111], v[112:115], v[116:119], v[96:111]
  ds_read_b128 v[160:163], v14
  ds_read_b128 v[164:167], v22
  v_xor_b32 v14, 0x8000, v14
  v_xor_b32 v22, 0x2000, v22
  s_waitcnt lgkmcnt(10)
  v_mfma_f32_32x32x16_bf16 v[96:111], v[120:123], v[124:127], v[96:111]
  ds_read_b128 v[168:171], v15
  ds_read_b128 v[172:175], v23
  v_xor_b32 v15, 0x8000, v15
  v_xor_b32 v23, 0x2000, v23
  s_waitcnt lgkmcnt(10)
  v_mfma_f32_32x32x16_bf16 v[96:111], v[128:131], v[132:135], v[96:111]
  s_waitcnt vmcnt(0)
  s_barrier
  ds_read_b128 v[112:115], v8
  ds_read_b128 v[116:119], v16
  s_waitcnt lgkmcnt(10)
  v_mfma_f32_32x32x16_bf16 v[96:111], v[136:139], v[140:143], v[96:111]
  ds_read_b128 v[120:123], v9
  ds_read_b128 v[124:127], v17
  s_waitcnt lgkmcnt(10)
  v_mfma_f32_32x32x16_bf16 v[96:111], v[144:147], v[148:151], v[96:111]
  ds_read_b128 v[128:131], v10
  ds_read_b128 v[132:135], v18
  s_waitcnt lgkmcnt(10)
  v_mfma_f32_32x32x16_bf16 v[96:111], v[152:155], v[156:159], v[96:111]
  ds_read_b128 v[136:139], v11
  ds_read_b128 v[140:143], v19
  s_waitcnt lgkmcnt(10)
  v_mfma_f32_32x32x16_bf16 v[96:111], v[160:163], v[164:167], v[96:111]
  ds_read_b128 v[144:147], v12
  ds_read_b128 v[148:151], v20
  s_waitcnt lgkmcnt(10)
  v_mfma_f32_32x32x16_bf16 v[96:111], v[168:171], v[172:175], v[96:111]
  ds_read_b128 v[152:155], v13
  ds_read_b128 v[156:159], v21
  s_waitcnt lgkmcnt(10)
  v_mfma_f32_32x32x16_bf16 v[96:111], v[112:115], v[116:119], v[96:111]
  ds_read_b128 v[160:163], v14
  ds_read_b128 v[164:167], v22
  s_waitcnt lgkmcnt(10)
  v_mfma_f32_32x32x16_bf16 v[96:111], v[120:123], v[124:127], v[96:111]
  ds_read_b128 v[168:171], v15
  ds_read_b128 v[172:175], v23
  s_waitcnt lgkmcnt(10)
  v_mfma_f32_32x32x16_bf16 v[96:111], v[128:131], v[132:135], v[96:111]
  s_waitcnt lgkmcnt(8)
  v_mfma_f32_32x32x16_bf16 v[96:111], v[136:139], v[140:143], v[96:111]
  s_waitcnt lgkmcnt(6)
  v_mfma_f32_32x32x16_bf16 v[96:111], v[144:147], v[148:151], v[96:111]
  s_waitcnt lgkmcnt(4)
  v_mfma_f32_32x32x16_bf16 v[96:111], v[152:155], v[156:159], v[96:111]
  s_waitcnt lgkmcnt(2)
  v_mfma_f32_32x32x16_bf16 v[96:111], v[160:163], v[164:167], v[96:111]
  s_waitcnt lgkmcnt(0)
  v_mfma_f32_32x32x16_bf16 v[96:111], v[168:171], v[172:175], v[96:111]
  s_nop 11
  v_max3_f32 v44, v96, v97, v98
  v_max3_f32 v45, v99, v100, v101
  v_max3_f32 v46, v102, v103, v104
  v_max3_f32 v47, v105, v106, v107
  v_max3_f32 v44, v44, v108, v109
  v_max3_f32 v45, v45, v110, v111
  v_max3_f32 v44, v44, v46, v47
  v_max_f32 v44, v44, v45
  ds_write_b32 v30, v44
  v_sub_f32 v96, v96, v44
  v_sub_f32 v97, v97, v44
  v_sub_f32 v98, v98, v44
  v_sub_f32 v99, v99, v44
  v_sub_f32 v100, v100, v44
  v_sub_f32 v101, v101, v44
  v_sub_f32 v102, v102, v44
  v_sub_f32 v103, v103, v44
  s_waitcnt lgkmcnt(0)
  s_barrier
  ds_read_b128 v[48:51], v29
  ds_read_b128 v[52:55], v29 offset:16
  v_exp_f32 v96, v96
  v_sub_f32 v104, v104, v44
  v_exp_f32 v97, v97
  v_sub_f32 v105, v105, v44
  v_exp_f32 v98, v98
  v_sub_f32 v106, v106, v44
  v_exp_f32 v99, v99
  v_sub_f32 v107, v107, v44
  v_exp_f32 v100, v100
  v_sub_f32 v108, v108, v44
  v_exp_f32 v101, v101
  v_sub_f32 v109, v109, v44
  v_exp_f32 v102, v102
  v_sub_f32 v110, v110, v44
  v_exp_f32 v103, v103
  v_sub_f32 v111, v111, v44
  s_waitcnt lgkmcnt(0)
  v_max3_f32 v45, v48, v49, v50
  v_max3_f32 v46, v51, v52, v53
  v_exp_f32 v104, v104
  v_max3_f32 v45, v45, v54, v55
  v_exp_f32 v105, v105
  v_max_f32 v45, v45, v46
  v_exp_f32 v106, v106
  v_sub_f32 v45, v44, v45
  v_exp_f32 v107, v107
  v_exp_f32 v45, v45
  v_exp_f32 v108, v108
  v_exp_f32 v109, v109
  v_exp_f32 v110, v110
  v_exp_f32 v111, v111
  v_mul_f32 v96, v96, v45
  v_mul_f32 v97, v97, v45
  v_mul_f32 v98, v98, v45
  v_mul_f32 v99, v99, v45
  v_mul_f32 v100, v100, v45
  v_mul_f32 v101, v101, v45
  v_mul_f32 v102, v102, v45
  v_mul_f32 v103, v103, v45
  v_cvt_pk_bf16_f32 v48, v96, v97
  v_cvt_pk_bf16_f32 v49, v98, v99
  v_cvt_pk_bf16_f32 v50, v100, v101
  v_cvt_pk_bf16_f32 v51, v102, v103
  ds_write_b128 v31, v[48:51] offset:0
  v_mul_f32 v104, v104, v45
  v_mul_f32 v105, v105, v45
  v_mul_f32 v106, v106, v45
  v_mul_f32 v107, v107, v45
  v_mul_f32 v108, v108, v45
  v_mul_f32 v109, v109, v45
  v_mul_f32 v110, v110, v45
  v_mul_f32 v111, v111, v45
  v_cvt_pk_bf16_f32 v52, v104, v105
  v_cvt_pk_bf16_f32 v53, v106, v107
  v_cvt_pk_bf16_f32 v54, v108, v109
  v_cvt_pk_bf16_f32 v55, v110, v111
  ds_write_b128 v31, v[52:55] offset:1024
  v_add_f32 v96, v96, v97
  v_add_f32 v98, v98, v99
  v_add_f32 v100, v100, v101
  v_add_f32 v102, v102, v103
  v_add_f32 v104, v104, v105
  v_add_f32 v106, v106, v107
  v_add_f32 v108, v108, v109
  v_add_f32 v110, v110, v111
  v_add_f32 v96, v96, v98
  v_add_f32 v100, v100, v102
  v_add_f32 v104, v104, v106
  v_add_f32 v108, v108, v110
  v_add_f32 v96, v96, v100
  v_add_f32 v104, v104, v108
  v_add_f32 v96, v96, v104
  ds_write_b32 v30, v96 offset:9216
  s_waitcnt lgkmcnt(0)
  s_barrier
L_pv:
  s_setprio 2
  ds_read_b128 v[48:51], v28 offset:0
  ds_read_b64_tr_b16 v[112:113], v24 offset:0
  ds_read_b64_tr_b16 v[114:115], v25 offset:0
  ds_read_b128 v[52:55], v28 offset:1024
  ds_read_b64_tr_b16 v[116:117], v24 offset:4096
  ds_read_b64_tr_b16 v[118:119], v25 offset:4096
  ds_read_b128 v[56:59], v28 offset:2048
  ds_read_b64_tr_b16 v[120:121], v24 offset:8192
  ds_read_b64_tr_b16 v[122:123], v25 offset:8192
  ds_read_b128 v[60:63], v28 offset:3072
  ds_read_b64_tr_b16 v[124:125], v24 offset:12288
  ds_read_b64_tr_b16 v[126:127], v25 offset:12288
  s_lshl_b32 s74, s2, 9
  s_add_u32 s74, s74, 0x20000
  s_mov_b32 s70, 0x10000
  s_mov_b32 s71, 0x18000
  s_mov_b32 s72, 0x8000
  s_cmp_lg_u32 s3, 7
  s_cbranch_scc1 L_nolse
  ds_read_b128 v[144:147], v29
  ds_read_b128 v[148:151], v29 offset:16
  s_waitcnt lgkmcnt(6)
  ds_read_b128 v[152:155], v29 offset:9216
  ds_read_b128 v[156:159], v29 offset:9232
  s_andn2_b32 s92, s48, 1
  v_mov_b32 v23, s92
  s_waitcnt lgkmcnt(2)
  v_max3_f32 v20, v144, v145, v146
  v_max3_f32 v21, v147, v148, v149
  v_max3_f32 v20, v20, v150, v151
  v_max_f32 v20, v20, v21
  s_waitcnt lgkmcnt(0)
  v_add_f32 v152, v152, v153
  v_add_f32 v154, v154, v155
  v_add_f32 v156, v156, v157
  v_add_f32 v158, v158, v159
  v_add_f32 v152, v152, v154
  v_add_f32 v156, v156, v158
  v_add_f32 v152, v152, v156
  v_mov_b32 v21, v152
  s_mov_b32 exec_hi, 0
  buffer_store_dwordx4 v[20:23], v248, s[32:35], s74 offen sc1
  s_mov_b32 exec_hi, -1
L_nolse:
  s_waitcnt lgkmcnt(9)
  v_mfma_f32_32x32x16_bf16 v[144:159], v[112:115], v[48:51], 0
  ds_read_b128 v[64:67], v28 offset:4096
  ds_read_b64_tr_b16 v[128:129], v24 offset:16384
  ds_read_b64_tr_b16 v[130:131], v25 offset:16384
  s_waitcnt lgkmcnt(9)
  v_mfma_f32_32x32x16_bf16 v[144:159], v[116:119], v[52:55], v[144:159]
  ds_read_b128 v[68:71], v28 offset:5120
  ds_read_b64_tr_b16 v[132:133], v24 offset:20480
  ds_read_b64_tr_b16 v[134:135], v25 offset:20480
  v_lshrrev_b32 v44, 5, v1
  v_lshlrev_b32 v44, 3, v44
  v_lshrrev_b32 v96, v44, v249
  v_lshrrev_b32 v104, v44, v250
  s_waitcnt lgkmcnt(9)
  v_mfma_f32_32x32x16_bf16 v[144:159], v[120:123], v[56:59], v[144:159]
  ds_read_b128 v[72:75], v28 offset:6144
  ds_read_b64_tr_b16 v[136:137], v24 offset:24576
  ds_read_b64_tr_b16 v[138:139], v25 offset:24576
  v_lshrrev_b32 v97, 1, v96
  v_lshrrev_b32 v98, 2, v96
  v_lshrrev_b32 v99, 3, v96
  s_waitcnt lgkmcnt(9)
  v_mfma_f32_32x32x16_bf16 v[144:159], v[124:127], v[60:63], v[144:159]
  ds_read_b128 v[76:79], v28 offset:7168
  ds_read_b64_tr_b16 v[140:141], v24 offset:28672
  ds_read_b64_tr_b16 v[142:143], v25 offset:28672
  v_lshrrev_b32 v100, 4, v96
  v_lshrrev_b32 v101, 5, v96
  v_lshrrev_b32 v102, 6, v96
  v_lshrrev_b32 v103, 7, v96
  s_waitcnt lgkmcnt(9)
  v_mfma_f32_32x32x16_bf16 v[144:159], v[128:131], v[64:67], v[144:159]
  ds_read_b64_tr_b16 v[112:113], v26 offset:0
  ds_read_b64_tr_b16 v[114:115], v27 offset:0
  v_lshrrev_b32 v105, 1, v104
  v_lshrrev_b32 v106, 2, v104
  v_lshrrev_b32 v107, 3, v104
  s_waitcnt lgkmcnt(8)
  v_mfma_f32_32x32x16_bf16 v[144:159], v[132:135], v[68:71], v[144:159]
  ds_read_b64_tr_b16 v[116:117], v26 offset:4096
  ds_read_b64_tr_b16 v[118:119], v27 offset:4096
  v_lshrrev_b32 v108, 4, v104
  v_lshrrev_b32 v109, 5, v104
  v_lshrrev_b32 v110, 6, v104
  v_lshrrev_b32 v111, 7, v104
  s_waitcnt lgkmcnt(7)
  v_mfma_f32_32x32x16_bf16 v[144:159], v[136:139], v[72:75], v[144:159]
  ds_read_b64_tr_b16 v[120:121], v26 offset:8192
  ds_read_b64_tr_b16 v[122:123], v27 offset:8192
  s_waitcnt lgkmcnt(6)
  v_mfma_f32_32x32x16_bf16 v[144:159], v[140:143], v[76:79], v[144:159]
  ds_read_b64_tr_b16 v[124:125], v26 offset:12288
  ds_read_b64_tr_b16 v[126:127], v27 offset:12288
  s_waitcnt lgkmcnt(6)
  v_mfma_f32_32x32x16_bf16 v[160:175], v[112:115], v[48:51], 0
  ds_read_b64_tr_b16 v[128:129], v26 offset:16384
  ds_read_b64_tr_b16 v[130:131], v27 offset:16384
  s_waitcnt lgkmcnt(6)
  v_mfma_f32_32x32x16_bf16 v[160:175], v[116:119], v[52:55], v[160:175]
  ds_read_b64_tr_b16 v[132:133], v26 offset:20480
  ds_read_b64_tr_b16 v[134:135], v27 offset:20480
  s_waitcnt lgkmcnt(6)
  v_mfma_f32_32x32x16_bf16 v[160:175], v[120:123], v[56:59], v[160:175]
  ds_read_b64_tr_b16 v[136:137], v26 offset:24576
  ds_read_b64_tr_b16 v[138:139], v27 offset:24576
  v_cvt_pk_bf16_f32 v80, v144, v145
  v_cvt_pk_bf16_f32 v81, v146, v147
  v_cvt_pk_bf16_f32 v82, v148, v149
  v_cvt_pk_bf16_f32 v83, v150, v151
  v_bfi_b32 v80, s53, v96, v80
  v_bfi_b32 v81, s53, v97, v81
  v_bfi_b32 v82, s53, v98, v82
  v_bfi_b32 v83, s53, v99, v83
  ds_write_b128 v244, v[80:83]
  s_waitcnt lgkmcnt(7)
  v_mfma_f32_32x32x16_bf16 v[160:175], v[124:127], v[60:63], v[160:175]
  ds_read_b64_tr_b16 v[140:141], v26 offset:28672
  ds_read_b64_tr_b16 v[142:143], v27 offset:28672
  v_cvt_pk_bf16_f32 v84, v152, v153
  v_cvt_pk_bf16_f32 v85, v154, v155
  v_cvt_pk_bf16_f32 v86, v156, v157
  v_cvt_pk_bf16_f32 v87, v158, v159
  v_bfi_b32 v84, s53, v100, v84
  v_bfi_b32 v85, s53, v101, v85
  v_bfi_b32 v86, s53, v102, v86
  v_bfi_b32 v87, s53, v103, v87
  ds_write_b128 v245, v[84:87]
  s_waitcnt lgkmcnt(8)
  v_mfma_f32_32x32x16_bf16 v[160:175], v[128:131], v[64:67], v[160:175]
  s_waitcnt lgkmcnt(6)
  v_mfma_f32_32x32x16_bf16 v[160:175], v[132:135], v[68:71], v[160:175]
  s_waitcnt lgkmcnt(4)
  v_mfma_f32_32x32x16_bf16 v[160:175], v[136:139], v[72:75], v[160:175]
  s_waitcnt lgkmcnt(1)
  v_mfma_f32_32x32x16_bf16 v[160:175], v[140:143], v[76:79], v[160:175]
  s_setprio 2
  s_nop 10
  v_cvt_pk_bf16_f32 v88, v160, v161
  v_cvt_pk_bf16_f32 v89, v162, v163
  v_cvt_pk_bf16_f32 v90, v164, v165
  v_cvt_pk_bf16_f32 v91, v166, v167
  v_bfi_b32 v88, s53, v104, v88
  v_bfi_b32 v89, s53, v105, v89
  v_bfi_b32 v90, s53, v106, v90
  v_bfi_b32 v91, s53, v107, v91
  ds_write_b128 v246, v[88:91]
  v_cvt_pk_bf16_f32 v92, v168, v169
  v_cvt_pk_bf16_f32 v93, v170, v171
  v_cvt_pk_bf16_f32 v94, v172, v173
  v_cvt_pk_bf16_f32 v95, v174, v175
  v_bfi_b32 v92, s53, v108, v92
  v_bfi_b32 v93, s53, v109, v93
  v_bfi_b32 v94, s53, v110, v94
  v_bfi_b32 v95, s53, v111, v95
  ds_write_b128 v247, v[92:95]
  ds_read_b128 v[112:115], v32 offset:0
  ds_read_b128 v[116:119], v32 offset:2048
  ds_read_b128 v[120:123], v32 offset:4096
  ds_read_b128 v[124:127], v32 offset:6144
  s_waitcnt lgkmcnt(3)
  buffer_store_dwordx4 v[112:115], v34, s[32:35], s87 offen offset:0 sc1
  s_waitcnt lgkmcnt(2)
  buffer_store_dwordx4 v[116:119], v34, s[32:35], s87 offen offset:1024 sc1
  s_waitcnt lgkmcnt(1)
  buffer_store_dwordx4 v[120:123], v34, s[32:35], s87 offen offset:2048 sc1
  s_waitcnt lgkmcnt(0)
  buffer_store_dwordx4 v[124:127], v34, s[32:35], s87 offen offset:3072 sc1
  s_setprio 0
  s_barrier
  s_cmp_lg_u32 s3, 7
  s_cbranch_scc1 L_nolse2
  v_or_b32 v23, 1, v23
  s_mov_b32 exec_hi, 0
  buffer_store_dwordx4 v[20:23], v248, s[32:35], s74 offen sc1
  s_mov_b32 exec_hi, -1
L_nolse2:
  s_mov_b32 s73, 0
  s_or_b32 s69, s48, 1
  buffer_load_dwordx4 v[8:11], v35, s[32:35], s70 offen offset:0 sc1
  buffer_load_dwordx4 v[12:15], v35, s[32:35], s71 offen offset:0 sc1
  buffer_load_dwordx4 v[16:19], v35, s[32:35], 0 offen offset:0 sc1
  buffer_load_dwordx4 v[20:23], v35, s[32:35], s72 offen offset:0 sc1
  s_cmp_lt_u32 s2, 128
  s_cbranch_scc1 L_prepA
  s_and_b32 s92, s3, 3
  s_mul_i32 s92, s92, 7552
  s_add_u32 s92, s92, 0x5000
  v_lshrrev_b32 v62, 5, v1
  v_mul_u32_u24 v62, 928, v62
  v_and_b32 v3, 31, v1
  v_lshl_add_u32 v62, v3, 4, v62
  v_add_u32 v62, s92, v62
  s_lshl_b32 s92, s3, 6
  v_lshrrev_b32 v63, 4, v1
  v_mul_u32_u24 v63, 7552, v63
  v_bfe_u32 v3, v1, 2, 2
  v_mul_u32_u24 v3, 928, v3
  v_add_u32 v63, v3, v63
  v_and_b32 v3, 3, v1
  v_lshl_add_u32 v63, v3, 3, v63
  v_add_u32 v63, 20480, v63
  v_add_u32 v63, s92, v63
  s_mul_i32 s82, s80, 28672
  s_lshl_b32 s97, s3, 12
  s_add_u32 s82, s82, s97
  s_lshl_b32 s97, s79, 8
  s_add_u32 s82, s82, s97
  s_lshr_b32 s92, s79, 1
  s_lshl_b32 s92, s92, 10
  s_and_b32 s97, s79, 1
  s_lshl_b32 s97, s97, 7
  s_add_u32 s92, s92, s97
  s_add_u32 s92, s92, 0x4000
  v_bfe_u32 v56, v1, 3, 1
  v_lshlrev_b32 v56, 13, v56
  v_lshrrev_b32 v3, 4, v1
  v_lshl_add_u32 v56, v3, 8, v56
  v_and_b32 v3, 7, v1
  v_lshl_add_u32 v56, v3, 4, v56
  v_add_u32 v56, s92, v56
  v_and_b32 v60, 31, v1
  v_lshlrev_b32 v60, 5, v60
  v_add_u32 v60, 90112, v60
  s_lshl_b32 s92, s3, 2
  s_add_u32 s92, s92, 0x16000
  v_and_b32 v59, 7, v1
  v_lshlrev_b32 v59, 7, v59
  v_lshrrev_b32 v3, 4, v1
  v_lshl_add_u32 v59, v3, 5, v59
  v_add_u32 v59, s92, v59
  s_lshl_b32 s92, s3, 7
  s_add_u32 s92, s92, 0x16c00
  v_and_b32 v57, 31, v1
  v_lshlrev_b32 v57, 1, v57
  v_add_u32 v57, s92, v57
  s_mul_i32 s90, s79, 4224
  s_lshl_b32 s97, s3, 9
  s_add_u32 s90, s90, s97
  s_add_u32 s90, s90, 0x60000
  v_and_b32 v61, 31, v1
  v_lshlrev_b32 v61, 4, v61
  v_and_b32 v58, 3, v1
  v_lshlrev_b32 v58, 6, v58
  v_lshrrev_b32 v3, 4, v1
  v_lshl_add_u32 v58, v3, 4, v58
  s_nop 0
  s_branch L_prep2
L_prepA:
  s_sub_u32 s92, s79, 7
  s_cmp_ge_u32 s79, 7
  s_cselect_b32 s92, s92, s79
  s_cselect_b32 s93, 1, 0
  s_mul_i32 s81, s80, 7
  s_add_u32 s81, s81, s92
  s_lshl_b32 s91, s81, 15
  s_lshl_b32 s97, s3, 12
  s_add_u32 s91, s91, s97
  s_lshl_b32 s97, s93, 9
  s_add_u32 s91, s91, s97
  s_mul_i32 s75, s77, 16896
  s_lshr_b32 s97, s3, 1
  s_mul_i32 s97, s97, 4224
  s_add_u32 s75, s75, s97
  s_lshl_b32 s97, s76, 7
  s_add_u32 s75, s75, s97
  s_and_b32 s97, s3, 1
  s_lshl_b32 s97, s97, 6
  s_add_u32 s75, s75, s97
  s_add_u32 s75, s75, 0x60000
  s_mul_i32 s90, s93, 67584
  s_mul_i32 s97, s3, 8448
  s_add_u32 s90, s90, s97
  s_lshl_b32 s97, s81, 7
  s_add_u32 s90, s90, s97
  s_add_u32 s90, s90, 0xa0000
  s_mul_i32 s92, s3, 2176
  s_lshr_b32 s97, s3, 1
  s_lshl_b32 s97, s97, 7
  s_add_u32 s92, s92, s97
  s_add_u32 s92, s92, 0xe800
  v_lshrrev_b32 v62, 5, v1
  v_mul_u32_u24 v62, 544, v62
  v_and_b32 v3, 31, v1
  v_lshl_add_u32 v62, v3, 4, v62
  v_add_u32 v62, s92, v62
  s_lshl_b32 s92, s3, 6
  v_lshrrev_b32 v63, 4, v1
  v_mul_u32_u24 v63, 4480, v63
  v_bfe_u32 v3, v1, 2, 2
  v_mul_u32_u24 v3, 544, v3
  v_add_u32 v63, v3, v63
  v_and_b32 v3, 3, v1
  v_lshl_add_u32 v63, v3, 3, v63
  v_add_u32 v63, 59392, v63
  v_add_u32 v63, s92, v63
  s_lshl_b32 s82, s81, 12
  s_lshl_b32 s97, s3, 9
  s_add_u32 s82, s82, s97
  s_add_u32 s82, s82, 0xd0000
  s_lshl_b32 s92, s3, 7
  s_add_u32 s92, s92, 0x16c00
  v_and_b32 v57, 7, v1
  v_lshlrev_b32 v57, 3, v57
  v_lshrrev_b32 v3, 4, v1
  v_lshl_add_u32 v57, v3, 1, v57
  v_add_u32 v57, s92, v57
  v_and_b32 v61, 31, v1
  v_lshlrev_b32 v61, 4, v61
  v_and_b32 v58, 1, v1
  v_lshlrev_b32 v58, 6, v58
  v_lshrrev_b32 v3, 4, v1
  v_lshl_add_u32 v58, v3, 4, v58
  s_lshl_b32 s92, s80, 11
  v_and_b32 v56, 15, v1
  v_lshlrev_b32 v56, 7, v56
  v_add_u32 v56, 98304, v56
  v_add_u32 v56, s92, v56
  s_lshl_b32 s92, s3, 2
  s_add_u32 s92, s92, 0x14800
  v_lshlrev_b32 v59, 5, v1
  v_add_u32 v59, s92, v59
  s_bfe_u32 s92, s3, 0x10002
  s_lshl_b32 s92, s92, 10
  s_and_b32 s97, s3, 3
  s_lshl_b32 s97, s97, 2
  s_add_u32 s92, s92, s97
  s_add_u32 s92, s92, 0x15800
  v_lshlrev_b32 v60, 4, v1
  v_add_u32 v60, s92, v60
L_prep2:
  s_cmp_eq_u32 s101, 1
  s_cbranch_scc1 L_nsg
  s_cmp_eq_u32 s101, 2
  s_cbranch_scc1 L_nsg
  s_waitcnt vmcnt(8)
  ds_write_b128 v240, v[176:179] offset:0
  ds_write_b128 v240, v[180:183] offset:1152
  ds_write_b128 v240, v[184:187] offset:2432
  ds_write_b128 v240, v[188:191] offset:3584
  s_cmp_lt_u32 s2, 128
  s_cbranch_scc1 L_sf_36a
  s_mov_b32 exec_lo, 0xfffffff
  s_mov_b32 exec_hi, 0xfffffff
  ds_write_b128 v62, v[208:211] offset:0
  ds_write_b128 v62, v[212:215] offset:448
  ds_write_b128 v62, v[216:219] offset:1856
  ds_write_b128 v62, v[220:223] offset:2304
  ds_write_b128 v62, v[224:227] offset:3712
  ds_write_b128 v62, v[228:231] offset:4160
  ds_write_b128 v62, v[232:235] offset:5568
  ds_write_b128 v62, v[236:239] offset:6016
  s_mov_b64 exec, -1
  s_branch L_sf_36x
L_sf_36a:
  ds_write_b128 v241, v[208:211] offset:0
  ds_write_b128 v241, v[212:215] offset:1152
  ds_write_b128 v241, v[216:219] offset:2432
  ds_write_b128 v241, v[220:223] offset:3584
  ds_write_b128 v241, v[224:227] offset:4864
  ds_write_b128 v241, v[228:231] offset:6016
  ds_write_b128 v241, v[232:235] offset:7296
  ds_write_b128 v241, v[236:239] offset:8448
L_sf_36x:
L_nsg:
  s_waitcnt vmcnt(0)
  s_mov_b32 s100, 0
L_p1:
  v_cmp_ne_u32 s[60:61], s69, v11
  v_cmp_ne_u32 s[62:63], s69, v15
  v_cmp_ne_u32 s[64:65], s69, v19
  v_cmp_ne_u32 s[66:67], s69, v23
  v_xor_b32 v44, s69, v11
  v_bitop3_b32 v44, v15, s69, v44 bitop3:0xbe
  v_bitop3_b32 v44, v19, s69, v44 bitop3:0xbe
  v_bitop3_b32 v44, v23, s69, v44 bitop3:0xbe
  v_cmp_lt_u32 s[92:93], 1, v44
  s_mov_b32 s94, 0
  s_cmp_eq_u64 s[92:93], 0
  s_cbranch_scc1 L_p1d
  s_add_u32 s100, s100, 1
  s_cmp_gt_u32 s100, 100000
  s_cbranch_scc1 L_abort
  s_mov_b64 exec, s[60:61]
  s_cbranch_execz L_ll_37
  buffer_load_dwordx4 v[8:11], v35, s[32:35], s70 offen offset:0 sc1
L_ll_37:
  s_mov_b64 exec, s[62:63]
  s_cbranch_execz L_ll_38
  buffer_load_dwordx4 v[12:15], v35, s[32:35], s71 offen offset:0 sc1
L_ll_38:
  s_mov_b64 exec, s[64:65]
  s_cbranch_execz L_ll_39
  buffer_load_dwordx4 v[16:19], v35, s[32:35], 0 offen offset:0 sc1
L_ll_39:
  s_mov_b64 exec, s[66:67]
  s_cbranch_execz L_ll_40
  buffer_load_dwordx4 v[20:23], v35, s[32:35], s72 offen offset:0 sc1
L_ll_40:
  s_mov_b64 exec, -1
L_p1d:
  s_bitcmp1_b32 s73, 0
  s_cbranch_scc1 L_lp_41
  s_cmp_lg_u64 s[60:61], 0
  s_cbranch_scc1 L_lp_41
  s_bitset1_b32 s73, 0
  s_add_u32 s94, s94, 1
  buffer_load_dwordx4 v[128:131], v36, s[32:35], s83 offen offset:0 sc1
L_lp_41:
  s_bitcmp1_b32 s73, 1
  s_cbranch_scc1 L_lp_42
  s_cmp_lg_u64 s[62:63], 0
  s_cbranch_scc1 L_lp_42
  s_bitset1_b32 s73, 1
  s_add_u32 s94, s94, 1
  buffer_load_dwordx4 v[132:135], v36, s[32:35], s84 offen offset:0 sc1
L_lp_42:
  s_bitcmp1_b32 s73, 2
  s_cbranch_scc1 L_lp_43
  s_cmp_lg_u64 s[64:65], 0
  s_cbranch_scc1 L_lp_43
  s_bitset1_b32 s73, 2
  s_add_u32 s94, s94, 1
  buffer_load_dwordx4 v[136:139], v36, s[32:35], s85 offen offset:0 sc1
L_lp_43:
  s_bitcmp1_b32 s73, 3
  s_cbranch_scc1 L_lp_44
  s_cmp_lg_u64 s[66:67], 0
  s_cbranch_scc1 L_lp_44
  s_bitset1_b32 s73, 3
  s_add_u32 s94, s94, 1
  buffer_load_dwordx4 v[140:143], v36, s[32:35], s86 offen offset:0 sc1
L_lp_44:
  s_cmp_eq_u64 s[92:93], 0
  s_cbranch_scc1 L_p1x
  s_cmp_eq_u32 s94, 0
  s_cbranch_scc0 L_pw0
  s_waitcnt vmcnt(0)
  s_branch L_p1
L_pw0:
  s_cmp_eq_u32 s94, 1
  s_cbranch_scc0 L_pw1
  s_waitcnt vmcnt(1)
  s_branch L_p1
L_pw1:
  s_cmp_eq_u32 s94, 2
  s_cbranch_scc0 L_pw2
  s_waitcnt vmcnt(2)
  s_branch L_p1
L_pw2:
  s_cmp_eq_u32 s94, 3
  s_cbranch_scc0 L_pw3
  s_waitcnt vmcnt(3)
  s_branch L_p1
L_pw3:
  s_waitcnt vmcnt(4)
  s_branch L_p1
L_p1x:
  v_max3_f32 v44, v8, v12, v16
  v_max_f32 v44, v44, v20
  s_nop 1
  v_max_f32_dpp v44, v44, v44 row_ror:8 row_mask:0xf bank_mask:0xf
  v_mov_b32 v45, v44
  s_nop 1
  v_permlane16_swap_b32 v44, v45
  v_max_f32 v44, v44, v45
  v_mov_b32 v45, v44
  s_nop 1
  v_permlane32_swap_b32 v44, v45
  v_max_f32 v44, v44, v45
  s_lshl_b32 s92, s3, 2
  s_add_u32 s92, s92, 92160
  v_mov_b32 v47, s92
  v_mov_b32 v46, 92160
  ds_write_b32 v47, v44
  s_waitcnt lgkmcnt(0)
  s_barrier
  ds_read_b128 v[144:147], v46
  ds_read_b128 v[148:151], v46 offset:16
  ds_read_b64_tr_b16 v[48:49], v242 offset:0
  ds_read_b64_tr_b16 v[50:51], v242 offset:1152
  ds_read_b64_tr_b16 v[52:53], v242 offset:9728
  ds_read_b64_tr_b16 v[54:55], v242 offset:10880
  s_waitcnt lgkmcnt(4)
  v_max3_f32 v44, v144, v145, v146
  v_max3_f32 v45, v147, v148, v149
  v_max3_f32 v44, v44, v150, v151
  v_max_f32 v44, v44, v45
  v_sub_f32 v152, v8, v44
  v_sub_f32 v153, v12, v44
  v_sub_f32 v154, v16, v44
  v_sub_f32 v155, v20, v44
  v_exp_f32 v152, v152
  v_exp_f32 v153, v153
  v_exp_f32 v154, v154
  v_exp_f32 v155, v155
  v_cvt_pk_bf16_f32 v152, v152, v152
  v_cvt_pk_bf16_f32 v153, v153, v153
  v_cvt_pk_bf16_f32 v154, v154, v154
  v_cvt_pk_bf16_f32 v155, v155, v155
  v_lshrrev_b32 v156, 16, v152
  v_lshrrev_b32 v157, 16, v153
  v_lshrrev_b32 v158, 16, v154
  v_lshrrev_b32 v159, 16, v155
  v_and_b32 v152, 0xffff0000, v152
  v_and_b32 v153, 0xffff0000, v153
  v_and_b32 v154, 0xffff0000, v154
  v_and_b32 v155, 0xffff0000, v155
  v_mul_f32 v44, v152, v9
  v_fmac_f32 v44, v153, v13
  v_fmac_f32 v44, v154, v17
  v_fmac_f32 v44, v155, v21
  s_nop 1
  v_add_f32_dpp v44, v44, v44 row_ror:8 row_mask:0xf bank_mask:0xf
  v_mov_b32 v45, v44
  s_nop 1
  v_permlane16_swap_b32 v44, v45
  v_add_f32 v44, v44, v45
  v_mov_b32 v45, v44
  s_nop 1
  v_permlane32_swap_b32 v44, v45
  v_add_f32 v44, v44, v45
  ds_write_b32 v47, v44 offset:32
  s_cmp_lt_u32 s2, 128
  s_cbranch_scc1 L_fgA
  ds_read_b64_tr_b16 v[80:81], v63 offset:0
  ds_read_b64_tr_b16 v[82:83], v63 offset:3712
  ds_read_b64_tr_b16 v[84:85], v63 offset:32
  ds_read_b64_tr_b16 v[86:87], v63 offset:3744
  ds_read_b64_tr_b16 v[88:89], v63 offset:448
  ds_read_b64_tr_b16 v[90:91], v63 offset:4160
  ds_read_b64_tr_b16 v[92:93], v63 offset:480
  ds_read_b64_tr_b16 v[94:95], v63 offset:4192
  s_branch L_fgx
L_fgA:
  ds_read_b64_tr_b16 v[80:81], v243 offset:0
  ds_read_b64_tr_b16 v[82:83], v243 offset:1152
  ds_read_b64_tr_b16 v[84:85], v243 offset:9728
  ds_read_b64_tr_b16 v[86:87], v243 offset:10880
  ds_read_b64_tr_b16 v[88:89], v243 offset:19456
  ds_read_b64_tr_b16 v[90:91], v243 offset:20608
  ds_read_b64_tr_b16 v[92:93], v243 offset:29184
  ds_read_b64_tr_b16 v[94:95], v243 offset:30336
L_fgx:
  s_waitcnt lgkmcnt(0)
  s_barrier
  ds_read_b128 v[160:163], v46 offset:32
  ds_read_b128 v[164:167], v46 offset:48
  v_mov_b32 v144, 0
  v_mov_b32 v145, 0
  v_mov_b32 v146, 0
  v_mov_b32 v147, 0
  v_mov_b32 v148, 0
  v_mov_b32 v149, 0
  v_mov_b32 v150, 0
  v_mov_b32 v151, 0
  s_waitcnt lgkmcnt(0)
  v_add_f32 v160, v160, v161
  v_add_f32 v162, v162, v163
  v_add_f32 v164, v164, v165
  v_add_f32 v166, v166, v167
  v_add_f32 v160, v160, v162
  v_add_f32 v164, v164, v166
  v_add_f32 v160, v160, v164
  v_rcp_f32 v168, v160
  s_bitcmp1_b32 s73, 0
  s_cbranch_scc1 L_ir_45
  buffer_load_dwordx4 v[128:131], v36, s[32:35], s83 offen offset:0 sc1
L_ir_45:
  s_bitcmp1_b32 s73, 1
  s_cbranch_scc1 L_ir_46
  buffer_load_dwordx4 v[132:135], v36, s[32:35], s84 offen offset:0 sc1
L_ir_46:
  s_bitcmp1_b32 s73, 2
  s_cbranch_scc1 L_ir_47
  buffer_load_dwordx4 v[136:139], v36, s[32:35], s85 offen offset:0 sc1
L_ir_47:
  s_bitcmp1_b32 s73, 3
  s_cbranch_scc1 L_ir_48
  buffer_load_dwordx4 v[140:143], v36, s[32:35], s86 offen offset:0 sc1
L_ir_48:
  s_or_b32 s73, s73, 15
  s_mov_b32 s100, 0
L_p2:
  s_mov_b32 s95, s73
  s_waitcnt vmcnt(0)
  s_bitcmp1_b32 s95, 0
  s_cbranch_scc0 L_dc_49
  s_bitcmp1_b32 s95, 4
  s_cbranch_scc1 L_dc_49
  v_xor_b32 v44, v128, v4
  v_bitop3_b32 v44, v129, v5, v44 bitop3:0xbe
  v_bitop3_b32 v44, v130, v6, v44 bitop3:0xbe
  v_bitop3_b32 v44, v131, v7, v44 bitop3:0xbe
  v_and_b32 v44, s53, v44
  v_cmp_ne_u32 vcc, 0, v44
  s_nop 0
  s_cbranch_vccz L_dc_49k
  s_sleep 1
  buffer_load_dwordx4 v[128:131], v36, s[32:35], s83 offen offset:0 sc1
  s_branch L_dc_49
L_dc_49k:
  s_bitset1_b32 s73, 4
  v_dot2c_f32_bf16 v144, v156, v128
  v_dot2c_f32_bf16 v145, v152, v128
  v_dot2c_f32_bf16 v146, v156, v129
  v_dot2c_f32_bf16 v147, v152, v129
  v_dot2c_f32_bf16 v148, v156, v130
  v_dot2c_f32_bf16 v149, v152, v130
  v_dot2c_f32_bf16 v150, v156, v131
  v_dot2c_f32_bf16 v151, v152, v131
L_dc_49:
  s_bitcmp1_b32 s95, 1
  s_nop 0
  s_cbranch_scc0 L_dc_50
  s_bitcmp1_b32 s95, 5
  s_cbranch_scc1 L_dc_50
  v_xor_b32 v44, v132, v4
  v_bitop3_b32 v44, v133, v5, v44 bitop3:0xbe
  v_bitop3_b32 v44, v134, v6, v44 bitop3:0xbe
  v_bitop3_b32 v44, v135, v7, v44 bitop3:0xbe
  v_and_b32 v44, s53, v44
  v_cmp_ne_u32 vcc, 0, v44
  s_nop 0
  s_cbranch_vccz L_dc_50k
  s_sleep 1
  buffer_load_dwordx4 v[132:135], v36, s[32:35], s84 offen offset:0 sc1
  s_branch L_dc_50
L_dc_50k:
  s_bitset1_b32 s73, 5
  v_dot2c_f32_bf16 v144, v157, v132
  v_dot2c_f32_bf16 v145, v153, v132
  v_dot2c_f32_bf16 v146, v157, v133
  v_dot2c_f32_bf16 v147, v153, v133
  v_dot2c_f32_bf16 v148, v157, v134
  v_dot2c_f32_bf16 v149, v153, v134
  v_dot2c_f32_bf16 v150, v157, v135
  v_dot2c_f32_bf16 v151, v153, v135
L_dc_50:
  s_bitcmp1_b32 s95, 2
  s_nop 0
  s_cbranch_scc0 L_dc_51
  s_bitcmp1_b32 s95, 6
  s_cbranch_scc1 L_dc_51
  v_xor_b32 v44, v136, v4
  v_bitop3_b32 v44, v137, v5, v44 bitop3:0xbe
  v_bitop3_b32 v44, v138, v6, v44 bitop3:0xbe
  v_bitop3_b32 v44, v139, v7, v44 bitop3:0xbe
  v_and_b32 v44, s53, v44
  v_cmp_ne_u32 vcc, 0, v44
  s_nop 0
  s_cbranch_vccz L_dc_51k
  s_sleep 1
  buffer_load_dwordx4 v[136:139], v36, s[32:35], s85 offen offset:0 sc1
  s_branch L_dc_51
L_dc_51k:
  s_bitset1_b32 s73, 6
  v_dot2c_f32_bf16 v144, v158, v136
  v_dot2c_f32_bf16 v145, v154, v136
  v_dot2c_f32_bf16 v146, v158, v137
  v_dot2c_f32_bf16 v147, v154, v137
  v_dot2c_f32_bf16 v148, v158, v138
  v_dot2c_f32_bf16 v149, v154, v138
  v_dot2c_f32_bf16 v150, v158, v139
  v_dot2c_f32_bf16 v151, v154, v139
L_dc_51:
  s_bitcmp1_b32 s95, 3
  s_nop 0
  s_cbranch_scc0 L_dc_52
  s_bitcmp1_b32 s95, 7
  s_cbranch_scc1 L_dc_52
  v_xor_b32 v44, v140, v4
  v_bitop3_b32 v44, v141, v5, v44 bitop3:0xbe
  v_bitop3_b32 v44, v142, v6, v44 bitop3:0xbe
  v_bitop3_b32 v44, v143, v7, v44 bitop3:0xbe
  v_and_b32 v44, s53, v44
  v_cmp_ne_u32 vcc, 0, v44
  s_nop 0
  s_cbranch_vccz L_dc_52k
  s_sleep 1
  buffer_load_dwordx4 v[140:143], v36, s[32:35], s86 offen offset:0 sc1
  s_branch L_dc_52
L_dc_52k:
  s_bitset1_b32 s73, 7
  v_dot2c_f32_bf16 v144, v159, v140
  v_dot2c_f32_bf16 v145, v155, v140
  v_dot2c_f32_bf16 v146, v159, v141
  v_dot2c_f32_bf16 v147, v155, v141
  v_dot2c_f32_bf16 v148, v159, v142
  v_dot2c_f32_bf16 v149, v155, v142
  v_dot2c_f32_bf16 v150, v159, v143
  v_dot2c_f32_bf16 v151, v155, v143
L_dc_52:
  s_cmp_eq_u32 s73, 0xff
  s_nop 0
  s_cbranch_scc1 L_p2x
  s_add_u32 s100, s100, 1
  s_cmp_gt_u32 s100, 100000
  s_cbranch_scc1 L_abort
  s_branch L_p2
L_p2x:
  v_permlane32_swap_b32 v144, v148
  v_permlane32_swap_b32 v145, v149
  v_permlane32_swap_b32 v146, v150
  v_permlane32_swap_b32 v147, v151
  v_add_f32 v144, v144, v148
  v_add_f32 v145, v145, v149
  v_add_f32 v146, v146, v150
  v_add_f32 v147, v147, v151
  s_nop 0
  v_permlane16_swap_b32 v144, v146
  v_permlane16_swap_b32 v145, v147
  v_add_f32 v144, v144, v146
  v_add_f32 v145, v145, v147
  s_nop 0
  v_add_f32_dpp v144, v144, v144 row_ror:8 row_mask:0xf bank_mask:0xf
  v_add_f32_dpp v145, v145, v145 row_ror:8 row_mask:0xf bank_mask:0xf
  v_mul_f32 v144, v144, v168
  v_mul_f32 v145, v145, v168
  v_cvt_pk_bf16_f32 v44, v144, v145
  ds_write_b32 v37, v44
  s_waitcnt lgkmcnt(0)
  s_barrier
  ds_read_b128 v[160:163], v38
  ds_read_b128 v[164:167], v38 offset:64
  s_waitcnt lgkmcnt(1)
  v_mfma_f32_16x16x32_bf16 v[144:147], v[48:51], v[160:163], 0
  s_waitcnt lgkmcnt(0)
  v_mfma_f32_16x16x32_bf16 v[144:147], v[52:55], v[164:167], v[144:147]
  s_nop 7
  v_add_f32_dpp v144, v144, v144 quad_perm:[1,0,3,2] row_mask:0xf bank_mask:0xf
  v_add_f32_dpp v145, v145, v145 quad_perm:[1,0,3,2] row_mask:0xf bank_mask:0xf
  v_add_f32_dpp v146, v146, v146 quad_perm:[1,0,3,2] row_mask:0xf bank_mask:0xf
  v_add_f32_dpp v147, v147, v147 quad_perm:[1,0,3,2] row_mask:0xf bank_mask:0xf
  v_add_f32_dpp v144, v144, v144 quad_perm:[2,3,0,1] row_mask:0xf bank_mask:0xf
  v_add_f32_dpp v145, v145, v145 quad_perm:[2,3,0,1] row_mask:0xf bank_mask:0xf
  v_add_f32_dpp v146, v146, v146 quad_perm:[2,3,0,1] row_mask:0xf bank_mask:0xf
  v_add_f32_dpp v147, v147, v147 quad_perm:[2,3,0,1] row_mask:0xf bank_mask:0xf
  v_add_f32_dpp v144, v144, v144 row_half_mirror row_mask:0xf bank_mask:0xf
  v_add_f32_dpp v145, v145, v145 row_half_mirror row_mask:0xf bank_mask:0xf
  v_add_f32_dpp v146, v146, v146 row_half_mirror row_mask:0xf bank_mask:0xf
  v_add_f32_dpp v147, v147, v147 row_half_mirror row_mask:0xf bank_mask:0xf
  s_mov_b32 exec_lo, 0x10001
  s_mov_b32 exec_hi, 0x10001
  v_and_or_b32 v144, v144, v2, s49
  v_and_or_b32 v145, v145, v2, s50
  v_and_or_b32 v146, v146, v2, s51
  v_and_or_b32 v147, v147, v2, s52
  buffer_store_dwordx4 v[144:147], v1, s[32:35], s16 offen
  v_mov_b32 v8, v144
  v_mov_b32 v9, v145
  v_mov_b32 v10, v146
  v_mov_b32 v11, v147
  s_mov_b64 exec, -1
  s_mov_b32 s69, 0
  s_mov_b32 s66, 0
  s_cmp_lt_u32 s2, 128
  s_cbranch_scc0 L_X
  s_mov_b32 s60, 0xffffffff
  s_mov_b32 s61, 0x0
  s_mov_b32 s100, 0
  s_branch L_gf_54
L_g_53:
  s_add_u32 s100, s100, 1
  s_cmp_gt_u32 s100, 100000
  s_cbranch_scc1 L_abort
  s_sleep 1
  s_cmp_lg_u32 s100, 30
  s_cbranch_scc1 L_alt_56
  s_cmp_lg_u32 s69, 0
  s_cbranch_scc1 L_cg_57
  s_mov_b32 exec_lo, 0x10001
  s_mov_b32 exec_hi, 0x10001
  s_add_u32 s97, s16, 0x160000
  buffer_store_dwordx4 v[8:11], v1, s[32:35], s97 offen sc1
  s_mov_b32 s69, 1
  s_mov_b64 exec, -1
L_cg_57:
  s_add_u32 s66, s66, 0x160000
L_alt_56:
L_gf_54:
  s_mov_b64 exec, s[60:61]
  buffer_load_dwordx4 v[128:131], v39, s[32:35], s66 offen offset:0 sc1
  s_waitcnt vmcnt(0)
L_gc_55:
  s_mov_b64 exec, s[60:61]
  v_perm_b32 v44, v129, v128, s56
  v_perm_b32 v44, v130, v44, s57
  v_perm_b32 v44, v131, v44, s58
  v_cmp_ne_u32 s[60:61], s48, v44
  s_nop 0
  s_cmp_lg_u64 s[60:61], 0
  s_cbranch_scc1 L_g_53
  s_mov_b64 exec, -1
  v_cvt_pk_bf16_f32 v44, v128, v129
  v_cvt_pk_bf16_f32 v45, v130, v131
  s_mov_b32 exec_hi, 0
  ds_write_b64 v43, v[44:45]
  s_mov_b32 exec_hi, -1
  s_cmp_lg_u32 s69, 0
  s_cbranch_scc1 L_cg_59
  s_mov_b32 exec_lo, 0x10001
  s_mov_b32 exec_hi, 0x10001
  s_add_u32 s97, s16, 0x160000
  buffer_store_dwordx4 v[8:11], v1, s[32:35], s97 offen sc1
  s_mov_b32 s69, 1
  s_mov_b64 exec, -1
L_cg_59:
  s_waitcnt lgkmcnt(0)
  s_barrier
  ds_read_b128 v[128:131], v40 offset:0
  ds_read_b128 v[132:135], v40 offset:64
  ds_read_b128 v[136:139], v40 offset:128
  ds_read_b128 v[140:143], v40 offset:192
  s_waitcnt lgkmcnt(3)
  v_mfma_f32_16x16x32_bf16 v[144:147], v[80:83], v[128:131], 0
  s_waitcnt lgkmcnt(2)
  v_mfma_f32_16x16x32_bf16 v[144:147], v[84:87], v[132:135], v[144:147]
  s_waitcnt lgkmcnt(1)
  v_mfma_f32_16x16x32_bf16 v[144:147], v[88:91], v[136:139], v[144:147]
  s_waitcnt lgkmcnt(0)
  v_mfma_f32_16x16x32_bf16 v[144:147], v[92:95], v[140:143], v[144:147]
  s_nop 7
  v_add_f32_dpp v144, v144, v144 quad_perm:[1,0,3,2] row_mask:0xf bank_mask:0xf
  v_add_f32_dpp v145, v145, v145 quad_perm:[1,0,3,2] row_mask:0xf bank_mask:0xf
  v_add_f32_dpp v146, v146, v146 quad_perm:[1,0,3,2] row_mask:0xf bank_mask:0xf
  v_add_f32_dpp v147, v147, v147 quad_perm:[1,0,3,2] row_mask:0xf bank_mask:0xf
  v_add_f32_dpp v144, v144, v144 quad_perm:[2,3,0,1] row_mask:0xf bank_mask:0xf
  v_add_f32_dpp v145, v145, v145 quad_perm:[2,3,0,1] row_mask:0xf bank_mask:0xf
  v_add_f32_dpp v146, v146, v146 quad_perm:[2,3,0,1] row_mask:0xf bank_mask:0xf
  v_add_f32_dpp v147, v147, v147 quad_perm:[2,3,0,1] row_mask:0xf bank_mask:0xf
  v_add_f32_dpp v144, v144, v144 row_half_mirror row_mask:0xf bank_mask:0xf
  v_add_f32_dpp v145, v145, v145 row_half_mirror row_mask:0xf bank_mask:0xf
  v_add_f32_dpp v146, v146, v146 row_half_mirror row_mask:0xf bank_mask:0xf
  v_add_f32_dpp v147, v147, v147 row_half_mirror row_mask:0xf bank_mask:0xf
  s_mov_b32 exec_lo, 0x10001
  s_mov_b32 exec_hi, 0x10001
  v_and_or_b32 v144, v144, v2, s49
  v_and_or_b32 v145, v145, v2, s50
  v_and_or_b32 v146, v146, v2, s51
  v_and_or_b32 v147, v147, v2, s52
  buffer_store_dwordx4 v[144:147], v1, s[32:35], s75 offen sc1
  s_mov_b64 exec, -1
  s_branch L_Y
L_X:
  s_cmp_lg_u32 s69, 0
  s_cbranch_scc1 L_cg_60
  s_mov_b32 exec_lo, 0x10001
  s_mov_b32 exec_hi, 0x10001
  s_add_u32 s97, s16, 0x160000
  buffer_store_dwordx4 v[8:11], v1, s[32:35], s97 offen sc1
  s_mov_b32 s69, 1
  s_mov_b64 exec, -1
L_cg_60:
  s_lshl_b32 s92, s79, 6
  v_and_b32 v44, 31, v1
  v_lshlrev_b32 v44, 1, v44
  v_add_u32 v44, s92, v44
  global_load_ushort v66, v44, s[4:5]
  s_movk_i32 s68, 0x4000
  buffer_load_dwordx4 v[68:71], v56, s[32:35], 0 offen offset:0 sc1
  buffer_load_dwordx4 v[72:75], v56, s[32:35], s68 offen offset:0 sc1
  s_waitcnt vmcnt(0)
  s_mov_b64 s[60:61], -1
  s_waitcnt vmcnt(63)
  s_mov_b32 s100, 0
  s_branch L_gc_64
L_g_62:
  s_add_u32 s100, s100, 1
  s_cmp_gt_u32 s100, 100000
  s_cbranch_scc1 L_abort
  s_sleep 2
L_gf_63:
  s_mov_b64 exec, s[60:61]
  buffer_load_dwordx4 v[68:71], v56, s[32:35], 0 offen offset:0 sc1
  buffer_load_dwordx4 v[72:75], v56, s[32:35], s68 offen offset:0 sc1
  s_waitcnt vmcnt(0)
L_gc_64:
  s_mov_b64 exec, s[60:61]
  v_perm_b32 v44, v69, v68, s56
  v_perm_b32 v44, v70, v44, s57
  v_perm_b32 v44, v71, v44, s58
  v_cmp_ne_u32 s[60:61], s48, v44
  v_perm_b32 v44, v73, v72, s56
  v_perm_b32 v44, v74, v44, s57
  v_perm_b32 v44, v75, v44, s58
  v_cmp_ne_u32 vcc, s48, v44
  s_nop 0
  s_or_b64 s[60:61], s[60:61], vcc
  s_cmp_lg_u64 s[60:61], 0
  s_cbranch_scc1 L_g_62
  s_mov_b64 exec, -1
  v_permlane32_swap_b32 v68, v70
  v_permlane32_swap_b32 v69, v71
  v_add_f32 v68, v68, v70
  v_add_f32 v69, v69, v71
  s_nop 1
  v_permlane16_swap_b32 v68, v69
  v_add_f32 v68, v68, v69
  v_permlane32_swap_b32 v72, v74
  v_permlane32_swap_b32 v73, v75
  v_add_f32 v72, v72, v74
  v_add_f32 v73, v73, v75
  s_nop 1
  v_permlane16_swap_b32 v72, v73
  v_add_f32 v72, v72, v73
  v_cvt_pk_bf16_f32 v44, v68, v68
  v_and_b32 v68, 0xffff0000, v44
  v_cvt_pk_bf16_f32 v45, v72, v72
  v_and_b32 v72, 0xffff0000, v45
  v_and_b32 v44, 3, v1
  v_lshlrev_b32 v44, 6, v44
  v_bfe_u32 v3, v1, 2, 3
  v_lshl_add_u32 v44, v3, 2, v44
  ds_bpermute_b32 v76, v44, v68 offset:0
  ds_bpermute_b32 v77, v44, v68 offset:32
  ds_bpermute_b32 v78, v44, v72 offset:0
  ds_bpermute_b32 v79, v44, v72 offset:32
  s_lshr_b32 s92, s82, 12
  s_lshl_b32 s92, s92, 12
  s_add_u32 s94, s82, s92
  s_add_u32 s94, s94, 1114112
  s_add_u32 s82, s82, 851968
  v_bfe_u32 v45, v1, 2, 1
  v_lshlrev_b32 v45, 6, v45
  v_add_u32 v45, v45, v41
  v_bfe_u32 v69, v1, 2, 1
  v_lshlrev_b32 v69, 12, v69
  v_and_b32 v3, 3, v1
  v_lshl_add_u32 v69, v3, 6, v69
  v_lshrrev_b32 v3, 4, v1
  v_lshl_add_u32 v69, v3, 4, v69
  s_waitcnt lgkmcnt(0)
  v_add_f32 v78, 1.0, v78
  v_lshlrev_b32 v66, 16, v66
  v_cvt_pk_bf16_f32 v44, v78, v78
  v_and_b32 v78, 0xffff0000, v44
  s_cmp_eq_u32 s3, 7
  s_cbranch_scc1 L_ab_61
  ds_write_b16_d16_hi v57, v78
  ds_write_b16_d16_hi v57, v77 offset:64
  ds_read_b128 v[72:75], v45
  s_waitcnt lgkmcnt(0)
  v_mfma_f32_16x16x32_bf16 v[208:211], v[80:83], v[72:75], 0
  v_mfma_f32_16x16x32_bf16 v[212:215], v[84:87], v[72:75], 0
  v_mfma_f32_16x16x32_bf16 v[216:219], v[88:91], v[72:75], 0
  v_mfma_f32_16x16x32_bf16 v[220:223], v[92:95], v[72:75], 0
  s_mov_b32 exec_lo, 0x220022
  s_mov_b32 exec_hi, 0x220022
  s_nop 3
  v_mov_b32 v208, v212
  v_mov_b32 v209, v213
  v_mov_b32 v210, v214
  v_mov_b32 v211, v215
  s_mov_b32 exec_lo, 0x440044
  s_mov_b32 exec_hi, 0x440044
  v_mov_b32 v208, v216
  v_mov_b32 v209, v217
  v_mov_b32 v210, v218
  v_mov_b32 v211, v219
  s_mov_b32 exec_lo, 0x880088
  s_mov_b32 exec_hi, 0x880088
  v_mov_b32 v208, v220
  v_mov_b32 v209, v221
  v_mov_b32 v210, v222
  v_mov_b32 v211, v223
  s_mov_b32 exec_lo, 0xff00ff
  s_mov_b32 exec_hi, 0xff00ff
  v_and_or_b32 v208, v208, v2, s49
  v_and_or_b32 v209, v209, v2, s50
  v_and_or_b32 v210, v210, v2, s51
  v_and_or_b32 v211, v211, v2, s52
  buffer_store_dwordx4 v[208:211], v69, s[32:35], s94 offen sc1
  s_mov_b64 exec, -1
L_ab_61:
  v_mov_b32 v112, 0
  v_mov_b32 v113, 0
  v_mov_b32 v114, 0
  v_mov_b32 v115, 0
  s_mov_b32 s60, 0xffffffff
  s_mov_b32 s61, 0x0
  s_mov_b32 s100, 0
  s_branch L_gf_67
L_g_66:
  s_add_u32 s100, s100, 1
  s_cmp_gt_u32 s100, 100000
  s_cbranch_scc1 L_abort
  s_sleep 4
L_gf_67:
  s_mov_b64 exec, s[60:61]
  buffer_load_dwordx4 v[112:115], v61, s[32:35], s90 offen offset:0 sc1
  s_waitcnt vmcnt(0)
L_gc_68:
  s_mov_b64 exec, s[60:61]
  v_perm_b32 v44, v113, v112, s56
  v_perm_b32 v44, v114, v44, s57
  v_perm_b32 v44, v115, v44, s58
  v_cmp_ne_u32 s[60:61], s48, v44
  s_nop 0
  s_cmp_lg_u64 s[60:61], 0
  s_cbranch_scc1 L_g_66
  s_mov_b64 exec, -1
  v_permlane32_swap_b32 v112, v114
  v_permlane32_swap_b32 v113, v115
  v_add_f32 v112, v112, v114
  v_add_f32 v113, v113, v115
  s_nop 1
  v_permlane16_swap_b32 v112, v113
  v_add_f32 v112, v112, v113
  s_nop 1
  v_add_f32_dpp v112, v112, v112 row_ror:8 row_mask:0xf bank_mask:0xf
  ds_write_b32 v59, v112
  s_waitcnt lgkmcnt(0)
  s_barrier
  ds_read_b128 v[112:115], v60
  ds_read_b128 v[116:119], v60 offset:16
  s_waitcnt lgkmcnt(0)
  v_add_f32 v112, v112, v113
  v_add_f32 v114, v114, v115
  v_add_f32 v116, v116, v117
  v_add_f32 v118, v118, v119
  v_add_f32 v112, v112, v114
  v_add_f32 v116, v116, v118
  v_add_f32 v112, v112, v116
  v_cvt_pk_bf16_f32 v44, v112, v112
  v_and_b32 v112, 0xffff0000, v44
  v_mul_f32 v67, v76, v112
  v_cvt_pk_bf16_f32 v44, v67, v67
  v_and_b32 v67, 0xffff0000, v44
  v_add_f32 v67, v66, v67
  v_cvt_pk_bf16_f32 v44, v67, v67
  v_and_b32 v67, 0xffff0000, v44
  s_cmp_eq_u32 s3, 7
  s_cbranch_scc1 L_stat
  v_mul_f32 v44, v67, v78
  v_cvt_pk_bf16_f32 v44, v44, v44
  ds_write_b16 v57, v44
  ds_read_b128 v[160:163], v41
  s_mov_b32 s70, 0x20002
  s_mov_b32 s71, 0x20002
  s_mov_b32 s72, 0x40004
  s_mov_b32 s73, 0x40004
  s_mov_b32 s74, 0x80008
  s_mov_b32 s75, 0x80008
  s_waitcnt lgkmcnt(0)
  v_mfma_f32_16x16x32_bf16 v[128:131], v[80:83], v[160:163], 0
  v_mfma_f32_16x16x32_bf16 v[132:135], v[84:87], v[160:163], 0
  v_mfma_f32_16x16x32_bf16 v[136:139], v[88:91], v[160:163], 0
  v_mfma_f32_16x16x32_bf16 v[140:143], v[92:95], v[160:163], 0
  s_nop 5
  v_cndmask_b32 v128, v128, v132, s[70:71]
  v_cndmask_b32 v129, v129, v133, s[70:71]
  v_cndmask_b32 v130, v130, v134, s[70:71]
  v_cndmask_b32 v131, v131, v135, s[70:71]
  v_cndmask_b32 v128, v128, v136, s[72:73]
  v_cndmask_b32 v129, v129, v137, s[72:73]
  v_cndmask_b32 v130, v130, v138, s[72:73]
  v_cndmask_b32 v131, v131, v139, s[72:73]
  v_cndmask_b32 v128, v128, v140, s[74:75]
  v_cndmask_b32 v129, v129, v141, s[74:75]
  v_cndmask_b32 v130, v130, v142, s[74:75]
  v_cndmask_b32 v131, v131, v143, s[74:75]
  v_and_or_b32 v128, v128, v2, s49
  v_and_or_b32 v129, v129, v2, s50
  v_and_or_b32 v130, v130, v2, s51
  v_and_or_b32 v131, v131, v2, s52
  s_mov_b32 exec_lo, 0xf000f
  s_mov_b32 exec_hi, 0xf000f
  buffer_store_dwordx4 v[128:131], v58, s[32:35], s82 offen
  s_add_u32 s97, s82, 0xf0000
  buffer_store_dwordx4 v[128:131], v58, s[32:35], s97 offen sc1
  s_mov_b64 exec, -1
  s_branch L_xdone
L_stat:
  v_mov_b32 v130, v67
  v_mul_f32 v131, v67, v67
  s_nop 0
  v_add_f32_dpp v130, v130, v130 row_ror:8 row_mask:0xf bank_mask:0xf
  v_add_f32_dpp v131, v131, v131 row_ror:8 row_mask:0xf bank_mask:0xf
  s_nop 0
  v_add_f32_dpp v130, v130, v130 row_ror:4 row_mask:0xf bank_mask:0xf
  v_add_f32_dpp v131, v131, v131 row_ror:4 row_mask:0xf bank_mask:0xf
  s_nop 0
  v_add_f32_dpp v130, v130, v130 row_ror:2 row_mask:0xf bank_mask:0xf
  v_add_f32_dpp v131, v131, v131 row_ror:2 row_mask:0xf bank_mask:0xf
  s_nop 0
  v_add_f32_dpp v130, v130, v130 row_ror:1 row_mask:0xf bank_mask:0xf
  v_add_f32_dpp v131, v131, v131 row_ror:1 row_mask:0xf bank_mask:0xf
  v_mov_b32 v128, v130
  v_mov_b32 v129, v131
  s_nop 0
  v_permlane16_swap_b32 v130, v128
  v_permlane16_swap_b32 v131, v129
  v_add_f32 v130, v130, v128
  v_add_f32 v131, v131, v129
  v_and_b32 v128, v2, v130
  v_and_b32 v129, v2, v131
  v_sub_f32 v130, v130, v128
  v_sub_f32 v131, v131, v129
  v_and_or_b32 v128, v128, v2, s49
  v_and_or_b32 v129, v129, v2, s50
  v_and_or_b32 v130, v130, v2, s51
  v_and_or_b32 v131, v131, v2, s52
  s_lshl_b32 s92, s80, 11
  s_lshl_b32 s97, s79, 7
  s_add_u32 s92, s92, s97
  s_add_u32 s92, s92, 0x18000
  s_mov_b64 exec, 1
  buffer_store_dwordx4 v[128:131], v1, s[32:35], s92 offen
  s_add_u32 s97, s92, 0x1e0000
  buffer_store_dwordx4 v[128:131], v1, s[32:35], s97 offen sc1
  s_mov_b64 exec, -1
  v_mov_b32 v112, 0
L_xdone:
  s_and_b32 s92, s79, 7
  s_cmp_lg_u32 s80, s92
  s_cbranch_scc1 L_fin
  s_mul_i32 s90, s79, 8448
  s_lshl_b32 s97, s3, 10
  s_add_u32 s90, s90, s97
  s_add_u32 s90, s90, 0xa0000
  s_lshl_b32 s92, s79, 6
  v_and_b32 v46, 31, v1
  v_lshlrev_b32 v46, 1, v46
  v_add_u32 v46, s92, v46
  s_cmp_eq_u32 s3, 7
  s_cbranch_scc1 L_nof
  s_mov_b64 s[60:61], -1
  s_mov_b32 s100, 0
  s_branch L_gf_71
L_g_70:
  s_add_u32 s100, s100, 1
  s_cmp_gt_u32 s100, 100000
  s_cbranch_scc1 L_abort
  s_sleep 1
L_gf_71:
  s_mov_b64 exec, s[60:61]
  buffer_load_dwordx4 v[112:115], v34, s[32:35], s90 offen offset:0 sc1
  s_waitcnt vmcnt(0)
L_gc_72:
  s_mov_b64 exec, s[60:61]
  v_perm_b32 v44, v113, v112, s56
  v_perm_b32 v44, v114, v44, s57
  v_perm_b32 v44, v115, v44, s58
  v_cmp_ne_u32 s[60:61], s48, v44
  s_nop 0
  s_cmp_lg_u64 s[60:61], 0
  s_cbranch_scc1 L_g_70
  s_mov_b64 exec, -1
  v_permlane32_swap_b32 v112, v114
  v_permlane32_swap_b32 v113, v115
  v_add_f32 v112, v112, v114
  v_add_f32 v113, v113, v115
  s_nop 1
  v_permlane16_swap_b32 v112, v113
  v_add_f32 v112, v112, v113
  s_nop 1
  v_add_f32_dpp v112, v112, v112 row_ror:8 row_mask:0xf bank_mask:0xf
L_nof:
  ds_write_b32 v59, v112 offset:1024
  s_waitcnt lgkmcnt(0)
  s_barrier
  s_cmp_lg_u32 s3, 0
  s_cbranch_scc1 L_fin
  ds_read_b128 v[112:115], v60 offset:1024
  ds_read_b128 v[116:119], v60 offset:1040
  s_waitcnt lgkmcnt(0)
  v_add_f32 v112, v112, v113
  v_add_f32 v114, v114, v115
  v_add_f32 v116, v116, v117
  v_add_f32 v118, v118, v119
  v_add_f32 v112, v112, v114
  v_add_f32 v116, v116, v118
  v_add_f32 v112, v112, v116
  v_cvt_pk_bf16_f32 v45, v112, v112
  v_and_b32 v112, 0xffff0000, v45
  v_mul_f32 v44, v79, v112
  v_cvt_pk_bf16_f32 v45, v44, v44
  v_and_b32 v44, 0xffff0000, v45
  v_add_f32 v44, v67, v44
  v_cvt_pk_bf16_f32 v44, v44, v44
  s_mov_b32 exec_hi, 0
  global_store_short v46, v44, s[28:29]
  s_cmp_lg_u32 s2, 128
  s_cbranch_scc1 L_noep
  s_mov_b64 exec, 1
  v_mov_b32 v45, 0
  global_store_dword v45, v45, s[30:31]
L_noep:
L_fin:
  s_endpgm
L_Y:
  s_cmp_ge_u32 s2, 112
  s_cbranch_scc1 L_fin
  s_lshl_b32 s94, s81, 13
  s_lshl_b32 s97, s3, 10
  s_add_u32 s94, s94, s97
  s_add_u32 s94, s94, 0x110000
  s_mov_b64 s[40:41], s[22:23]
  s_mov_b32 s42, 0x1c0000
  s_mov_b32 s43, 0x20000
  v_lshrrev_b32 v44, 5, v1
  v_lshlrev_b32 v44, 10, v44
  v_and_b32 v3, 31, v1
  v_lshl_add_u32 v44, v3, 4, v44
  buffer_load_dwordx4 v[176:179], v44, s[40:43], s91 offen offset:0 nt
  buffer_load_dwordx4 v[180:183], v44, s[40:43], s91 offen offset:2048 nt
  v_mov_b32 v112, 0
  v_mov_b32 v113, 0
  v_mov_b32 v114, 0
  v_mov_b32 v115, 0
  v_lshlrev_b32 v46, 4, v1
  v_add_u32 v46, 88064, v46
  v_lshlrev_b32 v47, 5, v1
  v_add_u32 v47, 83968, v47
  s_waitcnt vmcnt(0)
  s_mov_b64 s[60:61], -1
  s_mov_b32 s100, 0
  s_branch L_gf_75
L_g_74:
  s_add_u32 s100, s100, 1
  s_cmp_gt_u32 s100, 100000
  s_cbranch_scc1 L_abort
  s_sleep 2
L_gf_75:
  s_mov_b64 exec, s[60:61]
  buffer_load_dwordx4 v[76:79], v34, s[32:35], s94 offen offset:0 sc1
  s_waitcnt vmcnt(0)
L_gc_76:
  s_mov_b64 exec, s[60:61]
  v_perm_b32 v44, v77, v76, s56
  v_perm_b32 v44, v78, v44, s57
  v_perm_b32 v44, v79, v44, s58
  v_cmp_ne_u32 s[60:61], s48, v44
  s_nop 0
  s_cmp_lg_u64 s[60:61], 0
  s_cbranch_scc1 L_g_74
  s_mov_b64 exec, -1
  v_permlane32_swap_b32 v76, v78
  v_permlane32_swap_b32 v77, v79
  v_add_f32 v76, v76, v78
  v_add_f32 v77, v77, v79
  s_nop 1
  v_permlane16_swap_b32 v76, v77
  v_add_f32 v76, v76, v77
  s_waitcnt vmcnt(0)
  ds_write_b128 v62, v[176:179] offset:0
  ds_write_b128 v62, v[180:183] offset:1088
  ds_write_b32 v60, v76
  s_waitcnt lgkmcnt(0)
  s_barrier
  ds_read_b128 v[128:131], v46
  ds_read_b128 v[132:135], v46 offset:1024
  ds_read_b64_tr_b16 v[68:69], v63 offset:0
  ds_read_b64_tr_b16 v[70:71], v63 offset:2176
  ds_read_b64_tr_b16 v[72:73], v63 offset:32
  ds_read_b64_tr_b16 v[74:75], v63 offset:2208
  s_waitcnt lgkmcnt(4)
  v_add_f32 v128, v128, v129
  v_add_f32 v130, v130, v131
  v_add_f32 v128, v128, v130
  v_add_f32 v132, v132, v133
  v_add_f32 v134, v134, v135
  v_add_f32 v132, v132, v134
  s_mov_b32 s66, 0
  s_mov_b32 s60, 0xffffffff
  s_mov_b32 s61, 0x0
  s_mov_b32 s62, 0xffff
  s_mov_b32 s63, 0x0
  s_mov_b32 s100, 0
  s_branch L_gf_79
L_g_78:
  s_add_u32 s100, s100, 1
  s_cmp_gt_u32 s100, 100000
  s_cbranch_scc1 L_abort
  s_sleep 1
  s_cmp_lg_u32 s100, 30
  s_cbranch_scc1 L_alt_81
  s_add_u32 s82, s82, 0xf0000
  s_add_u32 s66, s66, 0x1e0000
L_alt_81:
L_gf_79:
  s_mov_b64 exec, s[60:61]
  s_cbranch_execz L_gs_82
  buffer_load_dwordx4 v[112:115], v61, s[32:35], s82 offen offset:0 sc1
L_gs_82:
  s_mov_b64 exec, s[62:63]
  s_cbranch_execz L_gs_83
  buffer_load_dwordx4 v[136:139], v56, s[32:35], s66 offen offset:0 sc1
L_gs_83:
  s_waitcnt vmcnt(0)
L_gc_80:
  s_mov_b64 exec, s[60:61]
  v_perm_b32 v44, v113, v112, s56
  v_perm_b32 v44, v114, v44, s57
  v_perm_b32 v44, v115, v44, s58
  v_cmp_ne_u32 s[60:61], s48, v44
  s_mov_b64 exec, s[62:63]
  v_perm_b32 v44, v137, v136, s56
  v_perm_b32 v44, v138, v44, s57
  v_perm_b32 v44, v139, v44, s58
  v_cmp_ne_u32 s[62:63], s48, v44
  s_nop 0
  s_or_b64 s[96:97], s[60:61], s[62:63]
  s_cbranch_scc1 L_g_78
  s_mov_b64 exec, -1
  v_permlane32_swap_b32 v112, v114
  v_permlane32_swap_b32 v113, v115
  v_add_f32 v112, v112, v114
  v_add_f32 v113, v113, v115
  s_nop 1
  v_permlane16_swap_b32 v112, v113
  v_add_f32 v112, v112, v113
  ds_write_b32 v59, v112
  v_add_f32 v136, v136, v138
  v_add_f32 v137, v137, v139
  s_nop 0
  v_add_f32_dpp v136, v136, v136 quad_perm:[1,0,3,2] row_mask:0xf bank_mask:0xf
  v_add_f32_dpp v137, v137, v137 quad_perm:[1,0,3,2] row_mask:0xf bank_mask:0xf
  s_nop 0
  v_add_f32_dpp v136, v136, v136 quad_perm:[2,3,0,1] row_mask:0xf bank_mask:0xf
  v_add_f32_dpp v137, v137, v137 quad_perm:[2,3,0,1] row_mask:0xf bank_mask:0xf
  s_nop 0
  v_add_f32_dpp v136, v136, v136 row_half_mirror row_mask:0xf bank_mask:0xf
  v_add_f32_dpp v137, v137, v137 row_half_mirror row_mask:0xf bank_mask:0xf
  s_nop 0
  v_add_f32_dpp v136, v136, v136 row_ror:8 row_mask:0xf bank_mask:0xf
  v_add_f32_dpp v137, v137, v137 row_ror:8 row_mask:0xf bank_mask:0xf
  s_waitcnt lgkmcnt(0)
  s_barrier
  ds_read_b128 v[112:115], v47
  ds_read_b128 v[116:119], v47 offset:16
  v_readfirstlane_b32 s92, v136
  v_readfirstlane_b32 s93, v137
  v_mov_b32 v44, 0x3b000000
  v_mul_f32 v136, s92, v44
  v_mul_f32 v137, s93, v44
  v_fma_f32 v137, -v136, v136, v137
  v_max_f32 v137, 0, v137
  v_cvt_pk_bf16_f32 v45, v137, v137
  v_and_b32 v137, 0xffff0000, v45
  v_cvt_pk_bf16_f32 v44, v136, v136
  v_and_b32 v136, 0xffff0000, v44
  v_add_f32 v137, 0x3727c5ac, v137
  v_mul_f32 v128, v136, v128
  v_cvt_pk_bf16_f32 v45, v137, v137
  v_and_b32 v137, 0xffff0000, v45
  v_sqrt_f32 v137, v137
  s_nop 0
  v_cvt_pk_bf16_f32 v45, v137, v137
  v_and_b32 v137, 0xffff0000, v45
  v_rcp_f32 v137, v137
  s_waitcnt lgkmcnt(0)
  v_add_f32 v112, v112, v113
  v_add_f32 v114, v114, v115
  v_add_f32 v116, v116, v117
  v_add_f32 v118, v118, v119
  v_add_f32 v112, v112, v114
  v_add_f32 v116, v116, v118
  v_add_f32 v112, v112, v116
  v_sub_f32 v112, v112, v128
  v_fma_f32 v112, v112, v137, v132
  v_cvt_pk_bf16_f32 v44, v112, v112
  v_and_b32 v112, 0xffff0000, v44
  v_mul_f32 v44, v112, v112
  v_mov_b32 v45, 0xc0135761
  v_mov_b32_dpp v113, v112 row_ror:8 row_mask:0xf bank_mask:0xf
  v_fmac_f32 v45, 0xbdd2d3e8, v44
  v_mul_f32 v44, v45, v112
  v_exp_f32 v44, v44
  s_nop 0
  v_add_f32 v44, 1.0, v44
  v_rcp_f32 v44, v44
  s_nop 0
  v_mul_f32 v112, v112, v44
  v_cvt_pk_bf16_f32 v44, v112, v112
  v_and_b32 v112, 0xffff0000, v44
  v_mul_f32 v112, v112, v113
  v_cvt_pk_bf16_f32 v44, v112, v112
  s_mov_b32 exec_lo, 0xff00ff
  s_mov_b32 exec_hi, 0xff00ff
  ds_write_b16 v57, v44
  s_mov_b64 exec, -1
  ds_read_b128 v[160:163], v41
  s_mov_b32 s70, 0x20002
  s_mov_b32 s71, 0x20002
  s_waitcnt lgkmcnt(0)
  v_mfma_f32_16x16x32_bf16 v[144:147], v[68:71], v[160:163], 0
  v_mfma_f32_16x16x32_bf16 v[148:151], v[72:75], v[160:163], 0
  s_nop 7
  v_cndmask_b32 v144, v144, v148, s[70:71]
  v_cndmask_b32 v145, v145, v149, s[70:71]
  v_cndmask_b32 v146, v146, v150, s[70:71]
  v_cndmask_b32 v147, v147, v151, s[70:71]
  v_and_or_b32 v144, v144, v2, s49
  v_and_or_b32 v145, v145, v2, s50
  v_and_or_b32 v146, v146, v2, s51
  v_and_or_b32 v147, v147, v2, s52
  s_mov_b32 exec_lo, 0x30003
  s_mov_b32 exec_hi, 0x30003
  buffer_store_dwordx4 v[144:147], v58, s[32:35], s90 offen sc1
  s_endpgm
L_abort:
  s_endpgm
L_end:
  s_endpgm
L_codeend:
.section .rodata,"a"
.p2align 6
.amdhsa_kernel adaLN_cond__compressed_kv_cla__glu_gated_geglu__decode_kernel
  .amdhsa_next_free_vgpr 256
  .amdhsa_next_free_sgpr 102
  .amdhsa_accum_offset 256
  .amdhsa_group_segment_fixed_size 0
  .amdhsa_kernarg_size 120
  .amdhsa_user_sgpr_count 2
  .amdhsa_user_sgpr_kernarg_segment_ptr 1
  .amdhsa_system_sgpr_workgroup_id_x 1
.end_amdhsa_kernel
```
